```python
import torch

def _softmax(x, axis=-1):
    return torch.softmax(x, dim=axis)
def _gelu(x):
    return torch.nn.functional.gelu(x, approximate="tanh")
def _silu(x):
    return torch.nn.functional.silu(x)
def _sigmoid(x):
    return torch.sigmoid(x)
def _layernorm(x, axis=-1, eps=1e-5):
    m = x.mean(dim=axis, keepdim=True)
    v = x.var(dim=axis, keepdim=True, unbiased=False)
    return (x - m) / torch.sqrt(v + eps)
def _scatter_add(tgt, idx, src, axis=0):
    return tgt.clone().index_add_(axis, idx, src)
def _segment_sum(src, seg, n):
    out = torch.zeros((n,) + src.shape[1:], dtype=src.dtype)
    return out.index_add_(0, seg, src)
def _pad(x, pw):
    flat = tuple(v for pair in reversed(pw) for v in pair)
    return torch.nn.functional.pad(x, flat)

kernel_name = 'sequential_preLN__spectral_fnet__moe_arch_mod__prompt'

def setup_inputs():

    _w = (lambda a: (lambda t: t.to(torch.bfloat16) if t.is_floating_point() else t)(torch.as_tensor(a)))
    def _A_setup():
        B, S, D = 1, 2048, 1024
        ns = torch.arange(S)[:, None] * torch.arange(S)[None, :]
        nd = torch.arange(D)[:, None] * torch.arange(D)[None, :]
        Ws_re = torch.cos(-2.0 * torch.pi * ns / S).to(float)
        Ws_im = torch.sin(-2.0 * torch.pi * ns / S).to(float)
        Wd_re = torch.cos(-2.0 * torch.pi * nd / D).to(float)
        Wd_im = torch.sin(-2.0 * torch.pi * nd / D).to(float)
        return {
            "x": _w((lambda *s: torch.randn(*s, dtype=torch.bfloat16) * 0.05)(B, S, D)),
            "dft_seq_re": _w(Ws_re),
            "dft_seq_im": _w(Ws_im),
            "dft_hid_re": _w(Wd_re),
            "dft_hid_im": _w(Wd_im),
        }
    _A_in = _A_setup()

    def _B_setup():
        B, S, D, F, C = 1, 2048, 1024, 3584, 1
        return {
            "x": _w((lambda *s: torch.randn(*s, dtype=torch.bfloat16) * 0.05)(B, S, D)),
            "w_r": _w((lambda *s: torch.randn(*s, dtype=torch.bfloat16) * 1.6)(D)),
            "w_gate": _w((lambda *s: torch.randn(*s, dtype=torch.bfloat16) * 0.4)(D, F)),
            "w_up": _w((lambda *s: torch.randn(*s, dtype=torch.bfloat16) * 0.4)(D, F)),
            "w_down": _w((lambda *s: torch.randn(*s, dtype=torch.bfloat16) * 0.4)(F, D)),
        }
    _B_in = _B_setup()

    return {
        "A_x": _A_in["x"],
        "A_dft_seq_re": _A_in["dft_seq_re"],
        "A_dft_seq_im": _A_in["dft_seq_im"],
        "A_dft_hid_re": _A_in["dft_hid_re"],
        "A_dft_hid_im": _A_in["dft_hid_im"],
        "B_x": _B_in["x"],
        "B_w_r": _B_in["w_r"],
        "B_w_gate": _B_in["w_gate"],
        "B_w_up": _B_in["w_up"],
        "B_w_down": _B_in["w_down"],
    }

def reference(A_x, A_dft_seq_re, A_dft_seq_im, A_dft_hid_re, A_dft_hid_im, B_x, B_w_r, B_w_gate, B_w_up, B_w_down):
    def _A_ref(x, dft_seq_re, dft_seq_im, dft_hid_re, dft_hid_im):
        a = torch.einsum("bsd,ed->bse", x, dft_hid_re)
        b = torch.einsum("bsd,ed->bse", x, dft_hid_im)
        y = torch.einsum("ts,bse->bte", dft_seq_re, a) - torch.einsum("ts,bse->bte", dft_seq_im, b)
        return y

    def _B_ref(x, w_r, w_gate, w_up, w_down):
        B, S, D = x.shape
        C = 1
        r = x @ w_r
        idx = torch.argsort(-r, axis=-1)[:, :C]
        idx_e = (lambda x, n, axis: torch.repeat_interleave(x, n, dim=axis))(idx.reshape(B, C, 1), D, axis=2)
        x_sel = (lambda x, i, axis: torch.take_along_dim(x, i, dim=axis))(x, idx_e, axis=1)
        g = _silu(x_sel @ w_gate)
        u = x_sel @ w_up
        y = (g * u) @ w_down
        r_sel = _sigmoid((lambda x, i, axis: torch.take_along_dim(x, i, dim=axis))(r, idx, axis=1))
        y = y * r_sel.reshape(B, C, 1)
        b_off = (torch.arange(B) * S).reshape(B, 1)
        flat_idx = (idx + b_off).reshape(B * C)
        zero = (x * 0.0).reshape(B * S, D)
        upd = _scatter_add(zero, flat_idx, y.reshape(B * C, D), axis=0)
        return x + upd.reshape(B, S, D)

    x = A_x
    h = x + _A_ref(_layernorm(x, axis=-1), A_dft_seq_re, A_dft_seq_im, A_dft_hid_re, A_dft_hid_im)
    h2 = h + _B_ref(_layernorm(h, axis=-1), B_w_r, B_w_gate, B_w_up, B_w_down)
    return h2
```

```asm
; @launch grid=(256,1,1) block=(512,1,1) lds=157888
.amdgcn_target "amdgcn-amd-amdhsa--gfx950"
.text
.globl sequential_preLN__spectral_fnet__moe_arch_mod__prompt_kernel
.p2align 8
.type sequential_preLN__spectral_fnet__moe_arch_mod__prompt_kernel,@function
sequential_preLN__spectral_fnet__moe_arch_mod__prompt_kernel:
    s_cmp_gt_u32 s2, 255
    s_cbranch_scc1 fk_end
    s_load_dwordx2 s[8:9], s[0:1], 0
    s_load_dwordx2 s[24:25], s[0:1], 96
    s_load_dwordx2 s[32:33], s[0:1], 48
    s_load_dwordx2 s[44:45], s[0:1], 56
    s_load_dwordx2 s[48:49], s[0:1], 64
    s_load_dwordx2 s[52:53], s[0:1], 72
    s_load_dwordx2 s[28:29], s[0:1], 80
    s_getpc_b64 s[40:41]
fk_pc:
    s_mov_b32 s42, fk_end-fk_pc
    s_mov_b32 s43, 0x00020000
    v_lshlrev_b32 v250, 6, v0
    buffer_load_dword v251, v250, s[40:43], 0 offen
    v_lshrrev_b32 v1, 6, v0
    v_and_b32 v15, 63, v0
    v_readfirstlane_b32 s16, v1
    s_and_b32 s3, s2, 0xe0
    s_and_b32 s17, s2, 7
    s_lshl_b32 s17, s17, 2
    s_or_b32 s3, s3, s17
    s_bfe_u32 s17, s2, 0x20003
    s_or_b32 s3, s3, s17
    s_lshr_b32 s17, s3, 4
    s_add_u32 s17, s17, 1
    s_cmp_ge_u32 s3, 248
    s_cselect_b32 s17, 0, s17
    s_cmp_ge_u32 s3, 240
    s_cselect_b32 s18, 7, 15
    s_and_b32 s18, s18, s3
    s_lshl_b32 s18, s18, 7
    s_add_u32 s18, s18, s17
    v_and_b32 v1, 31, v15
    v_lshrrev_b32 v2, 5, v15
    v_lshlrev_b32 v14, 4, v15
    s_mov_b32 s10, 0x400000
    s_mov_b32 s11, 0x00020000
    s_mov_b32 s26, 0x620000
    s_mov_b32 s27, 0x00020000
    s_mov_b32 s30, 0x400000
    s_mov_b32 s31, 0x00020000
    s_mov_b32 s34, 0x800
    s_mov_b32 s35, 0x00020000
    s_mov_b32 s46, 0x700000
    s_mov_b32 s47, 0x00020000
    s_mov_b32 s50, 0x700000
    s_mov_b32 s51, 0x00020000
    s_mov_b32 s54, 0x700000
    s_mov_b32 s55, 0x00020000
    s_cmp_ge_u32 s3, 248
    s_cselect_b32 s12, 5, 4
    s_cmp_ge_u32 s16, s12
    s_cbranch_scc1 fk_H
    s_setprio 3
    s_lshl_b32 s19, s16, 5
    s_add_u32 s19, s19, s18
    s_sub_u32 s20, 2048, s19
    s_and_b32 s20, s20, 2047
    s_lshl_b32 s21, s19, 11
    s_lshl_b32 s22, s20, 11
    s_lshl_b32 s12, s16, 12
    s_add_u32 s12, s12, 98304
    s_mov_b32 m0, s12
    v_mov_b32 v16, 0
    v_mov_b32 v17, 0
    v_mov_b32 v18, 0
    v_mov_b32 v19, 0
    v_mov_b32 v20, 0
    v_mov_b32 v21, 0
    v_mov_b32 v22, 0
    v_mov_b32 v23, 0
    v_mov_b32 v24, 0
    v_mov_b32 v25, 0
    v_mov_b32 v26, 0
    v_mov_b32 v27, 0
    v_mov_b32 v28, 0
    v_mov_b32 v29, 0
    v_mov_b32 v30, 0
    v_mov_b32 v31, 0
    v_mov_b32 v32, 0
    v_mov_b32 v33, 0
    v_mov_b32 v34, 0
    v_mov_b32 v35, 0
    v_mov_b32 v36, 0
    v_mov_b32 v37, 0
    v_mov_b32 v38, 0
    v_mov_b32 v39, 0
    v_mov_b32 v40, 0
    v_mov_b32 v41, 0
    v_mov_b32 v42, 0
    v_mov_b32 v43, 0
    v_mov_b32 v44, 0
    v_mov_b32 v45, 0
    v_mov_b32 v46, 0
    v_mov_b32 v47, 0
    v_cvt_f32_u32 v200, v1
    v_lshlrev_b32 v7, 2, v2
    v_cvt_f32_u32 v7, v7
    v_lshrrev_b32 v8, 1, v1
    v_and_b32 v9, 1, v1
    v_lshlrev_b32 v205, 2, v15
    v_and_b32 v205, 63, v205
    v_add_u32 v205, 157824, v205
    ds_write_b32 v205, v16
    s_waitcnt lgkmcnt(0)
    buffer_load_dwordx4 v14, s[8:11], s21 offen lds
    s_add_u32 s13, s12, 1024
    s_mov_b32 m0, s13
    s_add_u32 s14, s21, 1024
    buffer_load_dwordx4 v14, s[8:11], s14 offen lds
    s_add_u32 s13, s12, 2048
    s_mov_b32 m0, s13
    s_nop 0
    buffer_load_dwordx4 v14, s[8:11], s22 offen lds
    s_add_u32 s13, s12, 3072
    s_mov_b32 m0, s13
    s_add_u32 s14, s22, 1024
    buffer_load_dwordx4 v14, s[8:11], s14 offen lds
    s_cmp_lg_u32 s19, 0
    s_cbranch_scc1 fk_no1024
    s_mov_b32 m0, 118784
    s_mov_b32 s14, 2097152
    buffer_load_dwordx4 v14, s[8:11], s14 offen lds
    s_mov_b32 m0, 119808
    s_mov_b32 s14, 2098176
    buffer_load_dwordx4 v14, s[8:11], s14 offen lds
fk_no1024:
    s_barrier
    v_add_u32 v206, 138496, v14
    s_lshl_b32 s13, s16, 2
    s_add_u32 s13, s13, 157824
    v_mov_b32 v201, s13
    v_mov_b32 v202, 1
    s_cmp_eq_u32 s16, 1
    s_cbranch_scc1 fk_j1
    s_cmp_eq_u32 s16, 2
    s_cbranch_scc1 fk_j2
    s_cmp_eq_u32 s16, 3
    s_cbranch_scc1 fk_j3
    s_cmp_eq_u32 s16, 4
    s_cbranch_scc1 fk_jend
    v_cmp_eq_u32 vcc, 1, v1
    s_nop 1
    v_cndmask_b32 v10, v8, 16, vcc
    v_cndmask_b32 v11, v9, 0, vcc
    v_cvt_f32_u32 v10, v10
    v_cvt_f32_u32 v11, v11
    v_mul_f32 v10, 0x3d000000, v10
    v_mul_f32 v11, 0x3e800000, v11
    v_add_f32 v12, v7, v7
    v_fma_f32 v11, v10, v12, v11
    v_mov_b32 v128, v11
    v_fmamk_f32 v129, v10, 0x3f800000, v11
    v_fmamk_f32 v130, v10, 0x40000000, v11
    v_fmamk_f32 v131, v10, 0x40400000, v11
    v_fmamk_f32 v132, v10, 0x40800000, v11
    v_fmamk_f32 v133, v10, 0x40a00000, v11
    v_fmamk_f32 v134, v10, 0x40c00000, v11
    v_fmamk_f32 v135, v10, 0x40e00000, v11
    v_fmamk_f32 v136, v10, 0x41800000, v11
    v_fmamk_f32 v137, v10, 0x41880000, v11
    v_fmamk_f32 v138, v10, 0x41900000, v11
    v_fmamk_f32 v139, v10, 0x41980000, v11
    v_fmamk_f32 v140, v10, 0x41a00000, v11
    v_fmamk_f32 v141, v10, 0x41a80000, v11
    v_fmamk_f32 v142, v10, 0x41b00000, v11
    v_fmamk_f32 v143, v10, 0x41b80000, v11
    v_cos_f32 v144, v128
    v_cos_f32 v145, v129
    v_cos_f32 v146, v130
    v_cos_f32 v147, v131
    v_cos_f32 v148, v132
    v_cos_f32 v149, v133
    v_cos_f32 v150, v134
    v_cos_f32 v151, v135
    v_cos_f32 v152, v136
    v_cos_f32 v153, v137
    v_cos_f32 v154, v138
    v_cos_f32 v155, v139
    v_cos_f32 v156, v140
    v_cos_f32 v157, v141
    v_cos_f32 v158, v142
    v_cos_f32 v159, v143
    v_cvt_pk_f16_f32 v48, v144, v145
    v_cvt_pk_f16_f32 v49, v146, v147
    v_cvt_pk_f16_f32 v50, v148, v149
    v_cvt_pk_f16_f32 v51, v150, v151
    v_cvt_pk_f16_f32 v52, v152, v153
    v_cvt_pk_f16_f32 v53, v154, v155
    v_cvt_pk_f16_f32 v54, v156, v157
    v_cvt_pk_f16_f32 v55, v158, v159
    ds_write_b128 v206, v[48:51] offset:0
    ds_write_b128 v206, v[52:55] offset:1024
    s_branch fk_jsig
    s_nop 1
fk_j1:
    v_cvt_f32_u32 v10, v8
    v_lshlrev_b32 v11, 31, v9
    v_mul_f32 v10, 0x3a800000, v10
    v_xor_b32 v10, v11, v10
    v_mul_f32 v11, v10, v7
    v_mov_b32 v128, v11
    v_fmamk_f32 v129, v10, 0x3f800000, v11
    v_fmamk_f32 v130, v10, 0x40000000, v11
    v_fmamk_f32 v131, v10, 0x40400000, v11
    v_fmamk_f32 v132, v10, 0x41000000, v11
    v_fmamk_f32 v133, v10, 0x41100000, v11
    v_fmamk_f32 v134, v10, 0x41200000, v11
    v_fmamk_f32 v135, v10, 0x41300000, v11
    v_fmamk_f32 v136, v10, 0x41800000, v11
    v_fmamk_f32 v137, v10, 0x41880000, v11
    v_fmamk_f32 v138, v10, 0x41900000, v11
    v_fmamk_f32 v139, v10, 0x41980000, v11
    v_fmamk_f32 v140, v10, 0x41c00000, v11
    v_fmamk_f32 v141, v10, 0x41c80000, v11
    v_fmamk_f32 v142, v10, 0x41d00000, v11
    v_fmamk_f32 v143, v10, 0x41d80000, v11
    v_cos_f32 v56, v128
    v_cos_f32 v57, v129
    v_cos_f32 v58, v130
    v_cos_f32 v59, v131
    v_cos_f32 v60, v132
    v_cos_f32 v61, v133
    v_cos_f32 v62, v134
    v_cos_f32 v63, v135
    v_cos_f32 v64, v136
    v_cos_f32 v65, v137
    v_cos_f32 v66, v138
    v_cos_f32 v67, v139
    v_cos_f32 v68, v140
    v_cos_f32 v69, v141
    v_cos_f32 v70, v142
    v_cos_f32 v71, v143
    ds_write_b128 v206, v[56:59] offset:2048
    ds_write_b128 v206, v[60:63] offset:3072
    ds_write_b128 v206, v[64:67] offset:4096
    ds_write_b128 v206, v[68:71] offset:5120
    v_sin_f32 v72, v128
    v_sin_f32 v73, v129
    v_sin_f32 v74, v130
    v_sin_f32 v75, v131
    v_sin_f32 v76, v132
    v_sin_f32 v77, v133
    v_sin_f32 v78, v134
    v_sin_f32 v79, v135
    v_sin_f32 v80, v136
    v_sin_f32 v81, v137
    v_sin_f32 v82, v138
    v_sin_f32 v83, v139
    v_sin_f32 v84, v140
    v_sin_f32 v85, v141
    v_sin_f32 v86, v142
    v_sin_f32 v87, v143
    ds_write_b128 v206, v[72:75] offset:6144
    ds_write_b128 v206, v[76:79] offset:7168
    ds_write_b128 v206, v[80:83] offset:8192
    ds_write_b128 v206, v[84:87] offset:9216
    s_branch fk_jsig
    s_nop 0
fk_j2:
    v_mul_f32 v128, 0x3d000000, v200
    v_mul_f32 v129, v128, v7
    v_mov_b32 v130, v129
    v_fmamk_f32 v131, v128, 0x3f800000, v129
    v_fmamk_f32 v132, v128, 0x40000000, v129
    v_fmamk_f32 v133, v128, 0x40400000, v129
    v_fmamk_f32 v134, v128, 0x41000000, v129
    v_fmamk_f32 v135, v128, 0x41100000, v129
    v_fmamk_f32 v136, v128, 0x41200000, v129
    v_fmamk_f32 v137, v128, 0x41300000, v129
    v_fmamk_f32 v138, v128, 0x41800000, v129
    v_fmamk_f32 v139, v128, 0x41880000, v129
    v_fmamk_f32 v140, v128, 0x41900000, v129
    v_fmamk_f32 v141, v128, 0x41980000, v129
    v_fmamk_f32 v142, v128, 0x41c00000, v129
    v_fmamk_f32 v143, v128, 0x41c80000, v129
    v_fmamk_f32 v144, v128, 0x41d00000, v129
    v_fmamk_f32 v145, v128, 0x41d80000, v129
    v_cos_f32 v146, v130
    v_cos_f32 v147, v131
    v_cos_f32 v148, v132
    v_cos_f32 v149, v133
    v_cos_f32 v150, v134
    v_cos_f32 v151, v135
    v_cos_f32 v152, v136
    v_cos_f32 v153, v137
    v_cos_f32 v154, v138
    v_cos_f32 v155, v139
    v_cos_f32 v156, v140
    v_cos_f32 v157, v141
    v_cos_f32 v158, v142
    v_cos_f32 v159, v143
    v_cos_f32 v160, v144
    v_cos_f32 v161, v145
    v_cvt_pk_f16_f32 v96, v146, v147
    v_cvt_pk_f16_f32 v97, v148, v149
    v_cvt_pk_f16_f32 v98, v150, v151
    v_cvt_pk_f16_f32 v99, v152, v153
    v_cvt_pk_f16_f32 v100, v154, v155
    v_cvt_pk_f16_f32 v101, v156, v157
    v_cvt_pk_f16_f32 v102, v158, v159
    v_cvt_pk_f16_f32 v103, v160, v161
    v_sin_f32 v146, v130
    v_sin_f32 v147, v131
    v_sin_f32 v148, v132
    v_sin_f32 v149, v133
    v_sin_f32 v150, v134
    v_sin_f32 v151, v135
    v_sin_f32 v152, v136
    v_sin_f32 v153, v137
    v_sin_f32 v154, v138
    v_sin_f32 v155, v139
    v_sin_f32 v156, v140
    v_sin_f32 v157, v141
    v_sin_f32 v158, v142
    v_sin_f32 v159, v143
    v_sin_f32 v160, v144
    v_sin_f32 v161, v145
    v_cvt_pk_f16_f32 v104, v146, v147
    v_cvt_pk_f16_f32 v105, v148, v149
    v_cvt_pk_f16_f32 v106, v150, v151
    v_cvt_pk_f16_f32 v107, v152, v153
    v_cvt_pk_f16_f32 v108, v154, v155
    v_cvt_pk_f16_f32 v109, v156, v157
    v_cvt_pk_f16_f32 v110, v158, v159
    v_cvt_pk_f16_f32 v111, v160, v161
    ds_write_b128 v206, v[96:99] offset:12288
    ds_write_b128 v206, v[100:103] offset:13312
    ds_write_b128 v206, v[104:107] offset:14336
    ds_write_b128 v206, v[108:111] offset:15360
    s_branch fk_jsig
    s_nop 0
fk_j3:
    v_or_b32 v10, 16, v1
    v_cvt_f32_u32 v10, v10
    v_mov_b32 v11, 0x3c800000
    v_fmamk_f32 v10, v10, 0x3d000000, v11
    v_cmp_gt_u32 vcc, 16, v1
    v_mov_b32 v12, 0xbe800000
    s_nop 0
    v_cndmask_b32 v12, 0, v12, vcc
    v_fma_f32 v11, v10, v7, v12
    v_mov_b32 v128, v11
    v_fmamk_f32 v129, v10, 0x3f800000, v11
    v_fmamk_f32 v130, v10, 0x40000000, v11
    v_fmamk_f32 v131, v10, 0x40400000, v11
    v_fmamk_f32 v132, v10, 0x41000000, v11
    v_fmamk_f32 v133, v10, 0x41100000, v11
    v_fmamk_f32 v134, v10, 0x41200000, v11
    v_fmamk_f32 v135, v10, 0x41300000, v11
    v_fmamk_f32 v136, v10, 0x41800000, v11
    v_fmamk_f32 v137, v10, 0x41880000, v11
    v_fmamk_f32 v138, v10, 0x41900000, v11
    v_fmamk_f32 v139, v10, 0x41980000, v11
    v_fmamk_f32 v140, v10, 0x41c00000, v11
    v_fmamk_f32 v141, v10, 0x41c80000, v11
    v_fmamk_f32 v142, v10, 0x41d00000, v11
    v_fmamk_f32 v143, v10, 0x41d80000, v11
    v_cos_f32 v144, v128
    v_cos_f32 v145, v129
    v_cos_f32 v146, v130
    v_cos_f32 v147, v131
    v_cos_f32 v148, v132
    v_cos_f32 v149, v133
    v_cos_f32 v150, v134
    v_cos_f32 v151, v135
    v_cos_f32 v152, v136
    v_cos_f32 v153, v137
    v_cos_f32 v154, v138
    v_cos_f32 v155, v139
    v_cos_f32 v156, v140
    v_cos_f32 v157, v141
    v_cos_f32 v158, v142
    v_cos_f32 v159, v143
    v_cvt_pk_f16_f32 v88, v144, v145
    v_cvt_pk_f16_f32 v89, v146, v147
    v_cvt_pk_f16_f32 v90, v148, v149
    v_cvt_pk_f16_f32 v91, v150, v151
    v_cvt_pk_f16_f32 v92, v152, v153
    v_cvt_pk_f16_f32 v93, v154, v155
    v_cvt_pk_f16_f32 v94, v156, v157
    v_cvt_pk_f16_f32 v95, v158, v159
    ds_write_b128 v206, v[88:91] offset:10240
    ds_write_b128 v206, v[92:95] offset:11264
    s_nop 2
fk_jsig:
    ds_write_b32 v201, v202 offset:32
fk_jend:
    v_lshlrev_b32 v3, 9, v2
    v_lshl_add_u32 v3, v1, 1, v3
    v_sub_u32 v4, 576, v3
    v_sub_u32 v5, 2048, v3
    v_and_b32 v5, 2047, v5
    v_add_u32 v3, s12, v3
    v_add_u32 v4, s12, v4
    v_add_u32 v5, s12, v5
    s_lshl_b32 s13, s16, 10
    s_sub_u32 s14, 7232, s13
    s_cmp_ge_u32 s3, 248
    s_cselect_b32 s15, 1024, 0
    s_add_u32 s14, s14, s15
    s_cmp_eq_u32 s16, 4
    s_cselect_b32 s13, 8256, s13
    s_add_u32 s13, s13, 120832
    s_add_u32 s14, s14, 120832
    v_cmp_gt_u32 vcc, 16, v1
    v_mov_b32 v8, s13
    v_mov_b32 v9, s14
    v_cndmask_b32 v10, v9, v8, vcc
    v_cndmask_b32 v11, v8, v9, vcc
    v_lshl_add_u32 v10, v15, 2, v10
    v_lshl_add_u32 v11, v15, 2, v11
    v_lshrrev_b32 v6, 1, v15
    v_and_b32 v8, 1, v15
    v_mul_u32_u24 v9, 4160, v8
    v_lshl_add_u32 v9, v6, 2, v9
    s_lshl_b32 s13, s16, 8
    s_add_u32 s13, s13, 120832
    v_and_b32 v12, 15, v6
    v_lshl_add_u32 v12, v12, 4, v2
    v_mul_u32_u24 v12, 8320, v12
    v_lshl_add_u32 v12, v8, 4, v12
    v_add_u32 v6, s13, v9
    s_mul_i32 s36, s3, 8320
    s_lshl_b32 s13, s16, 11
    s_add_u32 s36, s36, s13
    s_add_u32 s36, s36, 0x200000
    s_mul_i32 s37, s16, 33280
    s_lshl_b32 s14, s3, 5
    s_add_u32 s37, s37, s14
    s_add_u32 s37, s37, 0x200000
    s_add_u32 s38, s37, 16640
    s_add_u32 s13, s13, 130304
    v_add_u32 v7, s13, v14
    s_cmp_eq_u32 s19, s20
    s_cselect_b32 s39, 0.5, 1.0
    s_lshl_b32 s13, s16, 2
    s_add_u32 s13, s13, 157056
    v_mov_b32 v9, s13
    s_cmp_ge_u32 s3, 248
    s_cselect_b32 s43, 63, 47
    s_nop 2
fk_spinc:
    ds_read_b32 v203, v205
    s_waitcnt lgkmcnt(0)
    v_cmp_eq_u32 vcc, 0, v203
    s_nop 1
    s_and_b32 s13, vcc_lo, 0xf00
    s_cbranch_scc1 fk_spinc
    ds_read_b128 v[48:51], v206 offset:0
    ds_read_b128 v[52:55], v206 offset:1024
    ds_read_b128 v[56:59], v206 offset:2048
    ds_read_b128 v[60:63], v206 offset:3072
    ds_read_b128 v[64:67], v206 offset:4096
    ds_read_b128 v[68:71], v206 offset:5120
    ds_read_b128 v[72:75], v206 offset:6144
    ds_read_b128 v[76:79], v206 offset:7168
    ds_read_b128 v[80:83], v206 offset:8192
    ds_read_b128 v[84:87], v206 offset:9216
    ds_read_b128 v[88:91], v206 offset:10240
    ds_read_b128 v[92:95], v206 offset:11264
    s_waitcnt lgkmcnt(8)
    ds_read_b128 v[96:99], v206 offset:12288
    ds_read_b128 v[100:103], v206 offset:13312
    ds_read_b128 v[104:107], v206 offset:14336
    ds_read_b128 v[108:111], v206 offset:15360
    s_waitcnt vmcnt(0) lgkmcnt(0)
    ds_read_u16_d16_hi v16, v3 offset:0
    ds_read_u16_d16_hi v17, v3 offset:64
    ds_read_u16_d16_hi v18, v3 offset:128
    ds_read_u16_d16_hi v19, v3 offset:192
    ds_read_u16_d16_hi v20, v3 offset:256
    ds_read_u16_d16_hi v21, v3 offset:320
    ds_read_u16_d16_hi v22, v3 offset:384
    ds_read_u16_d16_hi v23, v3 offset:448
    ds_read_u16_d16_hi v24, v3 offset:1024
    ds_read_u16_d16_hi v25, v3 offset:1088
    ds_read_u16_d16_hi v26, v3 offset:1152
    ds_read_u16_d16_hi v27, v3 offset:1216
    ds_read_u16_d16_hi v28, v3 offset:1280
    ds_read_u16_d16_hi v29, v3 offset:1344
    ds_read_u16_d16_hi v30, v3 offset:1408
    ds_read_u16_d16_hi v31, v3 offset:1472
    s_waitcnt lgkmcnt(2)
    ds_read_u16_d16_hi v32, v5 offset:2048
    ds_read_u16_d16_hi v33, v4 offset:3456
    ds_read_u16_d16_hi v34, v4 offset:3392
    ds_read_u16_d16_hi v35, v4 offset:3328
    ds_read_u16_d16_hi v36, v4 offset:3264
    ds_read_u16_d16_hi v37, v4 offset:3200
    ds_read_u16_d16_hi v38, v4 offset:3136
    ds_read_u16_d16_hi v39, v4 offset:3072
    ds_read_u16_d16_hi v40, v4 offset:2496
    ds_read_u16_d16_hi v41, v4 offset:2432
    ds_read_u16_d16_hi v42, v4 offset:2368
    ds_read_u16_d16_hi v43, v4 offset:2304
    ds_read_u16_d16_hi v44, v4 offset:2240
    s_waitcnt lgkmcnt(8)
    ds_read_u16_d16_hi v45, v4 offset:2176
    ds_read_u16_d16_hi v46, v4 offset:2112
    ds_read_u16_d16_hi v47, v4 offset:2048
    v_pk_add_f32 v[128:129], v[16:17], v[18:19]
    v_pk_add_f32 v[130:131], v[20:21], v[22:23]
    v_pk_add_f32 v[132:133], v[24:25], v[26:27]
    v_pk_add_f32 v[134:135], v[28:29], v[30:31]
    v_pk_mul_f32 v[136:137], v[16:17], v[16:17]
    v_pk_mul_f32 v[138:139], v[18:19], v[18:19]
    v_pk_fma_f32 v[136:137], v[20:21], v[20:21], v[136:137]
    v_pk_fma_f32 v[138:139], v[22:23], v[22:23], v[138:139]
    v_pk_fma_f32 v[136:137], v[24:25], v[24:25], v[136:137]
    v_pk_fma_f32 v[138:139], v[26:27], v[26:27], v[138:139]
    v_pk_fma_f32 v[136:137], v[28:29], v[28:29], v[136:137]
    v_pk_fma_f32 v[138:139], v[30:31], v[30:31], v[138:139]
    v_pk_add_f32 v[128:129], v[128:129], v[130:131]
    v_pk_add_f32 v[132:133], v[132:133], v[134:135]
    v_pk_add_f32 v[136:137], v[136:137], v[138:139]
    v_pk_add_f32 v[128:129], v[128:129], v[132:133]
    v_add_f32 v136, v136, v137
    v_add_f32 v128, v128, v129
    s_waitcnt lgkmcnt(0)
    v_pk_add_f32 v[140:141], v[32:33], v[34:35]
    v_pk_add_f32 v[142:143], v[36:37], v[38:39]
    v_pk_add_f32 v[144:145], v[40:41], v[42:43]
    v_pk_add_f32 v[146:147], v[44:45], v[46:47]
    v_pk_mul_f32 v[148:149], v[32:33], v[32:33]
    v_pk_mul_f32 v[150:151], v[34:35], v[34:35]
    v_pk_fma_f32 v[148:149], v[36:37], v[36:37], v[148:149]
    v_pk_fma_f32 v[150:151], v[38:39], v[38:39], v[150:151]
    v_pk_fma_f32 v[148:149], v[40:41], v[40:41], v[148:149]
    v_pk_fma_f32 v[150:151], v[42:43], v[42:43], v[150:151]
    v_pk_fma_f32 v[148:149], v[44:45], v[44:45], v[148:149]
    v_pk_fma_f32 v[150:151], v[46:47], v[46:47], v[150:151]
    v_pk_add_f32 v[140:141], v[140:141], v[142:143]
    v_pk_add_f32 v[144:145], v[144:145], v[146:147]
    v_pk_add_f32 v[148:149], v[148:149], v[150:151]
    v_pk_add_f32 v[140:141], v[140:141], v[144:145]
    v_add_f32 v148, v148, v149
    v_add_f32 v140, v140, v141
    s_nop 1
    v_permlane32_swap_b32 v128, v140
    v_permlane32_swap_b32 v136, v148
    v_add_f32 v128, v128, v140
    v_add_f32 v136, v136, v148
    s_nop 1
    v_permlane16_swap_b32 v128, v136
    v_add_f32 v128, v128, v136
    s_nop 1
    v_add_f32_dpp v128, v128, v128 quad_perm:[1,0,3,2] row_mask:0xf bank_mask:0xf
    s_nop 1
    v_add_f32_dpp v128, v128, v128 quad_perm:[2,3,0,1] row_mask:0xf bank_mask:0xf
    s_nop 1
    v_add_f32_dpp v128, v128, v128 row_half_mirror row_mask:0xf bank_mask:0xf
    s_nop 1
    v_add_f32_dpp v128, v128, v128 row_mirror row_mask:0xf bank_mask:0xf
    s_nop 1
    v_mov_b32_dpp v129, v128 row_bcast:15 row_mask:0xa bank_mask:0xf
    v_mul_f32 v130, 0x3a800000, v128
    v_mul_f32 v129, 0x3a800000, v129
    v_fma_f32 v130, -v129, v129, v130
    v_max_f32 v130, 0, v130
    v_cvt_pk_bf16_f32 v130, 0, v130
    v_cvt_pk_bf16_f32 v129, 0, v129
    v_add_f32 v130, 0x3727c5ac, v130
    v_cvt_pk_bf16_f32 v130, 0, v130
    v_sqrt_f32 v130, v130
    s_nop 0
    v_cvt_pk_bf16_f32 v130, 0, v130
    v_rcp_f32 v130, v130
    s_nop 0
    v_mul_f32 v130, 0x3d800000, v130
    v_mul_f32 v129, v129, v130
    v_readlane_b32 s4, v130, 16
    v_readlane_b32 s6, v130, 48
    v_readlane_b32 s13, v129, 16
    v_readlane_b32 s14, v129, 48
    s_nop 0
    v_mov_b32 v132, s13
    v_add_f32 v132, s14, v132
    v_pk_fma_f32 v[32:33], v[32:33], s[6:7], v[132:133] op_sel_hi:[1,0,0] neg_lo:[0,0,1] neg_hi:[0,0,1]
    v_pk_fma_f32 v[34:35], v[34:35], s[6:7], v[132:133] op_sel_hi:[1,0,0] neg_lo:[0,0,1] neg_hi:[0,0,1]
    v_pk_fma_f32 v[36:37], v[36:37], s[6:7], v[132:133] op_sel_hi:[1,0,0] neg_lo:[0,0,1] neg_hi:[0,0,1]
    v_pk_fma_f32 v[38:39], v[38:39], s[6:7], v[132:133] op_sel_hi:[1,0,0] neg_lo:[0,0,1] neg_hi:[0,0,1]
    v_pk_fma_f32 v[40:41], v[40:41], s[6:7], v[132:133] op_sel_hi:[1,0,0] neg_lo:[0,0,1] neg_hi:[0,0,1]
    v_pk_fma_f32 v[42:43], v[42:43], s[6:7], v[132:133] op_sel_hi:[1,0,0] neg_lo:[0,0,1] neg_hi:[0,0,1]
    v_pk_fma_f32 v[44:45], v[44:45], s[6:7], v[132:133] op_sel_hi:[1,0,0] neg_lo:[0,0,1] neg_hi:[0,0,1]
    v_pk_fma_f32 v[46:47], v[46:47], s[6:7], v[132:133] op_sel_hi:[1,0,0] neg_lo:[0,0,1] neg_hi:[0,0,1]
    v_pk_fma_f32 v[16:17], v[16:17], s[4:5], v[32:33] op_sel_hi:[1,0,1]
    v_pk_fma_f32 v[18:19], v[18:19], s[4:5], v[34:35] op_sel_hi:[1,0,1]
    v_pk_fma_f32 v[20:21], v[20:21], s[4:5], v[36:37] op_sel_hi:[1,0,1]
    v_pk_fma_f32 v[22:23], v[22:23], s[4:5], v[38:39] op_sel_hi:[1,0,1]
    v_pk_fma_f32 v[24:25], v[24:25], s[4:5], v[40:41] op_sel_hi:[1,0,1]
    v_pk_fma_f32 v[26:27], v[26:27], s[4:5], v[42:43] op_sel_hi:[1,0,1]
    v_pk_fma_f32 v[28:29], v[28:29], s[4:5], v[44:45] op_sel_hi:[1,0,1]
    v_pk_fma_f32 v[30:31], v[30:31], s[4:5], v[46:47] op_sel_hi:[1,0,1]
    v_cvt_pk_f16_f32 v176, v16, v17
    v_cvt_pk_f16_f32 v177, v18, v19
    v_cvt_pk_f16_f32 v178, v20, v21
    v_cvt_pk_f16_f32 v179, v22, v23
    v_cvt_pk_f16_f32 v180, v24, v25
    v_cvt_pk_f16_f32 v181, v26, v27
    v_cvt_pk_f16_f32 v182, v28, v29
    v_cvt_pk_f16_f32 v183, v30, v31
    v_mfma_f32_32x32x16_f16 v[112:127], v[176:179], v[48:51], 0
    s_nop 0
    v_mfma_f32_32x32x16_f16 v[112:127], v[180:183], v[52:55], v[112:127]
    s_nop 11
    v_mul_f32 v16, v112, v56
    v_mul_f32 v17, v113, v57
    v_mul_f32 v18, v114, v58
    v_mul_f32 v19, v115, v59
    v_mul_f32 v20, v116, v60
    v_mul_f32 v21, v117, v61
    v_mul_f32 v22, v118, v62
    v_mul_f32 v23, v119, v63
    v_mul_f32 v24, v120, v64
    v_mul_f32 v25, v121, v65
    v_mul_f32 v26, v122, v66
    v_mul_f32 v27, v123, v67
    v_mul_f32 v28, v124, v68
    v_mul_f32 v29, v125, v69
    v_mul_f32 v30, v126, v70
    v_mul_f32 v31, v127, v71
    v_fmac_f32_dpp v16, v112, v72 quad_perm:[1,0,3,2] row_mask:0xf bank_mask:0xf
    v_fmac_f32_dpp v17, v113, v73 quad_perm:[1,0,3,2] row_mask:0xf bank_mask:0xf
    v_fmac_f32_dpp v18, v114, v74 quad_perm:[1,0,3,2] row_mask:0xf bank_mask:0xf
    v_fmac_f32_dpp v19, v115, v75 quad_perm:[1,0,3,2] row_mask:0xf bank_mask:0xf
    v_fmac_f32_dpp v20, v116, v76 quad_perm:[1,0,3,2] row_mask:0xf bank_mask:0xf
    v_fmac_f32_dpp v21, v117, v77 quad_perm:[1,0,3,2] row_mask:0xf bank_mask:0xf
    v_fmac_f32_dpp v22, v118, v78 quad_perm:[1,0,3,2] row_mask:0xf bank_mask:0xf
    v_fmac_f32_dpp v23, v119, v79 quad_perm:[1,0,3,2] row_mask:0xf bank_mask:0xf
    v_cvt_pk_f16_f32 v176, v16, v17
    v_cvt_pk_f16_f32 v177, v18, v19
    v_cvt_pk_f16_f32 v178, v20, v21
    v_cvt_pk_f16_f32 v179, v22, v23
    v_fmac_f32_dpp v24, v120, v80 quad_perm:[1,0,3,2] row_mask:0xf bank_mask:0xf
    v_fmac_f32_dpp v25, v121, v81 quad_perm:[1,0,3,2] row_mask:0xf bank_mask:0xf
    v_mfma_f32_32x32x16_f16 v[128:143], v[176:179], v[96:99], 0
    v_fmac_f32_dpp v26, v122, v82 quad_perm:[1,0,3,2] row_mask:0xf bank_mask:0xf
    v_fmac_f32_dpp v27, v123, v83 quad_perm:[1,0,3,2] row_mask:0xf bank_mask:0xf
    v_fmac_f32_dpp v28, v124, v84 quad_perm:[1,0,3,2] row_mask:0xf bank_mask:0xf
    v_fmac_f32_dpp v29, v125, v85 quad_perm:[1,0,3,2] row_mask:0xf bank_mask:0xf
    v_mfma_f32_32x32x16_f16 v[144:159], v[176:179], v[104:107], 0
    v_fmac_f32_dpp v30, v126, v86 quad_perm:[1,0,3,2] row_mask:0xf bank_mask:0xf
    v_fmac_f32_dpp v31, v127, v87 quad_perm:[1,0,3,2] row_mask:0xf bank_mask:0xf
    v_cvt_pk_f16_f32 v180, v24, v25
    v_cvt_pk_f16_f32 v181, v26, v27
    v_mfma_f32_32x32x16_f16 v[160:175], v[176:179], v[88:91], 0
    v_cvt_pk_f16_f32 v182, v28, v29
    v_cvt_pk_f16_f32 v183, v30, v31
    s_nop 1
    v_mfma_f32_32x32x16_f16 v[128:143], v[180:183], v[100:103], v[128:143]
    v_mfma_f32_32x32x16_f16 v[144:159], v[180:183], v[108:111], v[144:159]
    v_mfma_f32_32x32x16_f16 v[160:175], v[180:183], v[92:95], v[160:175]
    v_cmp_gt_u32 vcc, 16, v15
    v_cmp_gt_u32 s[40:41], 32, v15
    s_nop 8
    v_add_f32 v18, v132, v149
    v_sub_f32 v26, v133, v148
    v_add_f32 v19, v134, v151
    v_sub_f32 v27, v135, v150
    v_sub_f32 v36, v18, v27
    v_add_f32 v37, v26, v19
    v_add_f32 v38, v18, v27
    v_sub_f32 v39, v19, v26
    v_cvt_pk_f16_f32 v178, v36, v37
    v_cvt_pk_f16_f32 v179, v38, v39
    ds_write_b32 v10, v178 offset:256
    ds_write_b32 v11, v179 offset:256
    v_add_f32 v20, v136, v153
    v_sub_f32 v28, v137, v152
    v_add_f32 v21, v138, v155
    v_sub_f32 v29, v139, v154
    v_sub_f32 v40, v20, v29
    v_add_f32 v41, v28, v21
    v_add_f32 v42, v20, v29
    v_sub_f32 v43, v21, v28
    v_cvt_pk_f16_f32 v180, v40, v41
    v_cvt_pk_f16_f32 v181, v42, v43
    ds_write_b32 v10, v180 offset:512
    ds_write_b32 v11, v181 offset:512
    v_add_f32 v22, v140, v157
    v_sub_f32 v30, v141, v156
    v_add_f32 v23, v142, v159
    v_sub_f32 v31, v143, v158
    v_sub_f32 v44, v22, v31
    v_add_f32 v45, v30, v23
    v_add_f32 v46, v22, v31
    v_sub_f32 v47, v23, v30
    v_cvt_pk_f16_f32 v182, v44, v45
    v_cvt_pk_f16_f32 v183, v46, v47
    ds_write_b32 v10, v182 offset:768
    ds_write_b32 v11, v183 offset:768
    v_add_f32 v16, v128, v145
    v_sub_f32 v24, v129, v144
    v_add_f32 v17, v130, v147
    v_sub_f32 v25, v131, v146
    v_mul_f32 v8, s39, v128
    v_mov_b32 v3, v161
    s_nop 1
    v_permlane16_swap_b32 v4, v3
    v_cndmask_b32 v5, v161, v128, vcc
    v_cndmask_b32 v4, v4, v144, vcc
    v_cndmask_b32 v16, v16, v5, s[40:41]
    v_cndmask_b32 v24, v24, -v4, s[40:41]
    v_sub_f32 v32, v16, v25
    v_add_f32 v33, v24, v17
    v_add_f32 v34, v16, v25
    v_sub_f32 v35, v17, v24
    v_cvt_pk_f16_f32 v176, v32, v33
    v_cvt_pk_f16_f32 v177, v34, v35
    ds_write_b32 v10, v176 offset:0
    ds_write_b32 v11, v177 offset:0
    s_mov_b64 exec, 0x10000
    ds_write_b32 v9, v8
    ds_write_b32 v201, v202
    s_mov_b64 exec, -1
    s_cmp_eq_u32 s16, 4
    s_cbranch_scc1 fk_w4
    s_nop 0
fk_spin:
    ds_read_b32 v3, v205
    s_waitcnt lgkmcnt(0)
    v_cmp_eq_u32 vcc, 0, v3
    s_nop 1
    s_and_b32 s13, vcc_lo, s43
    s_cbranch_scc1 fk_spin
    s_nop 0
fk_staged:
    ds_read2st64_b32 v[184:185], v6 offset0:0 offset1:4
    ds_read2st64_b32 v[186:187], v6 offset0:8 offset1:12
    v_add_u32 v8, 128, v6
    ds_read2st64_b32 v[188:189], v8 offset0:0 offset1:4
    ds_read2st64_b32 v[190:191], v8 offset0:8 offset1:12
    v_and_b32 v9, 16, v14
    v_add_u32 v9, 157056, v9
    ds_read_b128 v[16:19], v9
    s_waitcnt lgkmcnt(3)
    v_min_u32 v184, -2, v184
    v_min_u32 v185, -2, v185
    v_min_u32 v186, -2, v186
    v_min_u32 v187, -2, v187
    buffer_store_dwordx4 v[184:187], v14, s[24:27], s36 offen offset:0 sc1
    s_waitcnt lgkmcnt(1)
    v_min_u32 v188, -2, v188
    v_min_u32 v189, -2, v189
    v_min_u32 v190, -2, v190
    v_min_u32 v191, -2, v191
    buffer_store_dwordx4 v[188:191], v14, s[24:27], s36 offen offset:1024 sc1
    s_mov_b32 s42, 0
    s_waitcnt vmcnt(0)
    s_nop 1
fk_spinf:
    ds_read_b32 v3, v205
    s_waitcnt lgkmcnt(0)
    v_cmp_eq_u32 vcc, 0, v3
    s_nop 1
    s_and_b32 s13, vcc_lo, 64
    s_cbranch_scc1 fk_spinf
    s_cmp_lg_u32 s16, 0
    s_cbranch_scc1 fk_nog5
    s_lshl_b32 s13, s3, 4
    s_add_u32 s13, s13, 0x11000
    s_waitcnt lgkmcnt(0)
    v_min_u32 v16, -2, v16
    v_min_u32 v17, -2, v17
    v_min_u32 v18, -2, v18
    v_min_u32 v19, -2, v19
    s_cmp_eq_u32 s3, 255
    s_cselect_b64 exec, 3, 1
    buffer_store_dwordx4 v[16:19], v14, s[24:27], s13 offen sc1
    s_mov_b64 exec, -1
    s_nop 0
fk_nog5:
fk_pollw:
    buffer_load_dwordx4 v[184:187], v12, s[24:27], s37 offen sc1
    buffer_load_dwordx4 v[188:191], v12, s[24:27], s38 offen sc1
    s_add_u32 s42, s42, 1
    s_waitcnt vmcnt(0)
    v_max3_u32 v3, v184, v185, v186
    v_max3_u32 v3, v3, v187, v188
    v_max3_u32 v3, v3, v189, v190
    v_max_u32 v3, v3, v191
    v_cmp_eq_u32 vcc, -1, v3
    s_cmp_gt_u32 s42, 0x40000
    s_cbranch_scc1 fk_gotw
    s_cbranch_vccnz fk_pollw
    s_nop 1
fk_gotw:
    ds_write_b128 v7, v[184:187]
    ds_write_b128 v7, v[188:191] offset:1024
    s_waitcnt lgkmcnt(0)
    s_barrier
    s_setprio 0
    s_lshl_b32 s13, s16, 10
    s_add_u32 s14, s13, 0x11000
    s_add_u32 s13, s13, 114688
    v_add_u32 v7, s13, v14
    v_mov_b32 v3, 4096
    s_mov_b32 s15, 0x11000
    v_mov_b32 v8, 157152
    buffer_load_dwordx4 v[184:187], v14, s[24:27], s14 offen sc1
    buffer_load_dword v188, v3, s[24:27], s15 offen sc1
    s_mov_b32 s40, s14
    s_mov_b32 s41, s15
    v_lshrrev_b32 v208, 3, v15
    v_and_b32 v209, 7, v15
    v_and_b32 v210, 2, v208
    v_xor_b32 v209, v210, v209
    v_mul_u32_u24 v208, 7168, v208
    v_lshl_add_u32 v208, v209, 4, v208
    v_lshrrev_b32 v210, 5, v15
    v_lshlrev_b32 v210, 11, v210
    v_and_b32 v209, 31, v15
    v_lshl_add_u32 v210, v209, 4, v210
    s_and_b32 s12, s3, 3
    s_mul_i32 s100, s12, 1835008
    s_lshl_b32 s101, s12, 9
    s_lshr_b32 s12, s3, 2
    s_lshl_b32 s12, s12, 7
    s_add_u32 s100, s100, s12
    s_lshl_b32 s12, s12, 10
    s_add_u32 s101, s101, s12
    s_cmp_gt_u32 s3, 223
    s_cbranch_scc1 fk_win1
    s_mul_i32 s15, s16, 4
    s_add_u32 s15, s15, 12
    s_mov_b32 s58, 0x700000
    s_mov_b32 s59, 0x00020000
    s_cmp_gt_u32 s15, 95
    s_cbranch_scc1 fk_win1
    s_lshl_b32 s12, s15, 10
    s_mov_b32 m0, s12
    s_and_b32 s14, s12, 1024
    s_lshr_b32 s14, s14, 4
    v_xor_b32 v209, s14, v208
    s_cmp_lt_u32 s15, 32
    s_cselect_b64 s[56:57], s[44:45], s[48:49]
    s_and_b32 s14, s15, 31
    s_mul_i32 s13, s14, 57344
    s_add_u32 s13, s13, s100
    s_lshl_b32 s14, s14, 12
    s_add_u32 s14, s14, s101
    s_cmp_lt_u32 s15, 64
    s_cselect_b64 s[56:57], s[56:57], s[52:53]
    s_cselect_b32 s13, s13, s14
    s_cselect_b64 vcc, -1, 0
    v_cndmask_b32 v209, v210, v209, vcc
    s_add_u32 s15, s15, 1
    buffer_load_dwordx4 v209, s[56:59], s13 offen lds
    s_cmp_gt_u32 s15, 95
    s_cbranch_scc1 fk_win1
    s_lshl_b32 s12, s15, 10
    s_mov_b32 m0, s12
    s_and_b32 s14, s12, 1024
    s_lshr_b32 s14, s14, 4
    v_xor_b32 v209, s14, v208
    s_cmp_lt_u32 s15, 32
    s_cselect_b64 s[56:57], s[44:45], s[48:49]
    s_and_b32 s14, s15, 31
    s_mul_i32 s13, s14, 57344
    s_add_u32 s13, s13, s100
    s_lshl_b32 s14, s14, 12
    s_add_u32 s14, s14, s101
    s_cmp_lt_u32 s15, 64
    s_cselect_b64 s[56:57], s[56:57], s[52:53]
    s_cselect_b32 s13, s13, s14
    s_cselect_b64 vcc, -1, 0
    v_cndmask_b32 v209, v210, v209, vcc
    s_add_u32 s15, s15, 1
    buffer_load_dwordx4 v209, s[56:59], s13 offen lds
    s_cmp_gt_u32 s15, 95
    s_cbranch_scc1 fk_win1
    s_lshl_b32 s12, s15, 10
    s_mov_b32 m0, s12
    s_and_b32 s14, s12, 1024
    s_lshr_b32 s14, s14, 4
    v_xor_b32 v209, s14, v208
    s_cmp_lt_u32 s15, 32
    s_cselect_b64 s[56:57], s[44:45], s[48:49]
    s_and_b32 s14, s15, 31
    s_mul_i32 s13, s14, 57344
    s_add_u32 s13, s13, s100
    s_lshl_b32 s14, s14, 12
    s_add_u32 s14, s14, s101
    s_cmp_lt_u32 s15, 64
    s_cselect_b64 s[56:57], s[56:57], s[52:53]
    s_cselect_b32 s13, s13, s14
    s_cselect_b64 vcc, -1, 0
    v_cndmask_b32 v209, v210, v209, vcc
    s_add_u32 s15, s15, 1
    buffer_load_dwordx4 v209, s[56:59], s13 offen lds
    s_cmp_gt_u32 s15, 95
    s_cbranch_scc1 fk_win1
    s_lshl_b32 s12, s15, 10
    s_mov_b32 m0, s12
    s_and_b32 s14, s12, 1024
    s_lshr_b32 s14, s14, 4
    v_xor_b32 v209, s14, v208
    s_cmp_lt_u32 s15, 32
    s_cselect_b64 s[56:57], s[44:45], s[48:49]
    s_and_b32 s14, s15, 31
    s_mul_i32 s13, s14, 57344
    s_add_u32 s13, s13, s100
    s_lshl_b32 s14, s14, 12
    s_add_u32 s14, s14, s101
    s_cmp_lt_u32 s15, 64
    s_cselect_b64 s[56:57], s[56:57], s[52:53]
    s_cselect_b32 s13, s13, s14
    s_cselect_b64 vcc, -1, 0
    v_cndmask_b32 v209, v210, v209, vcc
    s_add_u32 s15, s15, 1
    buffer_load_dwordx4 v209, s[56:59], s13 offen lds
    s_nop 2
fk_win1:
    s_mov_b32 s42, 0
    s_cmp_gt_u32 s3, 223
    s_cbranch_scc1 fk_pollg
    s_waitcnt vmcnt(4)
    s_branch fk_chkg
    s_nop 0
fk_pollg:
    buffer_load_dwordx4 v[184:187], v14, s[24:27], s40 offen sc1
    buffer_load_dword v188, v3, s[24:27], s41 offen sc1
    s_waitcnt vmcnt(0)
    s_nop 0
fk_chkg:
    s_add_u32 s42, s42, 1
    v_max3_u32 v4, v184, v185, v186
    v_max3_u32 v4, v4, v187, v188
    v_cmp_eq_u32 vcc, -1, v4
    s_cmp_gt_u32 s42, 0x40000
    s_cbranch_scc1 fk_gotg
    s_cbranch_vccnz fk_pollg
    s_nop 1
fk_gotg:
    ds_write_b128 v7, v[184:187]
    ds_write_b32 v8, v188
    s_branch fk_common
    s_nop 0
fk_w4:
    s_setprio 0
    s_branch fk_Hconst
    s_nop 0
fk_H:
    s_barrier
    s_cmp_lg_u32 s16, 7
    s_cbranch_scc1 fk_Hconst
    v_mov_b32 v4, -1
    v_mov_b32 v5, -1
    v_mov_b32 v6, -1
    v_mov_b32 v7, -1
    s_mul_i32 s36, s3, 8320
    s_add_u32 s38, s36, 0x410000
    s_add_u32 s39, s38, 4096
    s_add_u32 s36, s36, 0x200000
    s_add_u32 s37, s36, 4096
    v_mov_b32 v3, 157120
    v_mov_b32 v8, 0
    ds_write_b32 v3, v8
    v_lshlrev_b32 v3, 12, v15
    s_lshl_b32 s13, s3, 4
    s_add_u32 s14, s13, 0x9000
    s_add_u32 s15, s13, 0x11000
    s_add_u32 s13, s13, 0x1000
    s_waitcnt lgkmcnt(0)
    s_load_dword s56, s[24:25], 0
    buffer_store_dwordx4 v[4:7], v14, s[24:27], s36 offen offset:0 sc1
    buffer_store_dwordx4 v[4:7], v14, s[24:27], s36 offen offset:1024 sc1
    buffer_store_dwordx4 v[4:7], v14, s[24:27], s36 offen offset:2048 sc1
    buffer_store_dwordx4 v[4:7], v14, s[24:27], s36 offen offset:3072 sc1
    buffer_store_dwordx4 v[4:7], v14, s[24:27], s37 offen offset:0 sc1
    buffer_store_dwordx4 v[4:7], v14, s[24:27], s37 offen offset:1024 sc1
    buffer_store_dwordx4 v[4:7], v14, s[24:27], s37 offen offset:2048 sc1
    buffer_store_dwordx4 v[4:7], v14, s[24:27], s37 offen offset:3072 sc1
    s_cmp_eq_u32 s3, 255
    s_cselect_b64 exec, 3, 1
    buffer_store_dwordx4 v[4:7], v14, s[24:27], s15 offen sc1
    s_mov_b64 exec, -1
    s_waitcnt lgkmcnt(0)
    s_add_u32 s56, s56, 1
    s_xor_b32 s57, s56, 0x9e3779b9
    v_mov_b32 v202, s56
    v_mov_b32 v203, s57
    v_mov_b32 v201, 157844
    v_mov_b32 v204, 1
    s_waitcnt vmcnt(0)
    s_mov_b64 exec, 0xff
    buffer_store_dwordx2 v[202:203], v3, s[24:27], s13 offen sc1
    s_mov_b64 exec, -1
    ds_write_b32 v201, v204
    s_mov_b32 m0, 155008
    s_mov_b32 s12, 0
    buffer_load_dwordx4 v14, s[32:35], s12 offen lds
    s_mov_b32 m0, 156032
    s_mov_b32 s12, 1024
    buffer_load_dwordx4 v14, s[32:35], s12 offen lds
    buffer_store_dwordx4 v[4:7], v14, s[24:27], s38 offen offset:0 sc1
    buffer_store_dwordx4 v[4:7], v14, s[24:27], s38 offen offset:1024 sc1
    buffer_store_dwordx4 v[4:7], v14, s[24:27], s38 offen offset:2048 sc1
    buffer_store_dwordx4 v[4:7], v14, s[24:27], s38 offen offset:3072 sc1
    buffer_store_dwordx4 v[4:7], v14, s[24:27], s39 offen offset:0 sc1
    buffer_store_dwordx4 v[4:7], v14, s[24:27], s39 offen offset:1024 sc1
    buffer_store_dwordx4 v[4:7], v14, s[24:27], s39 offen offset:2048 sc1
    buffer_store_dwordx4 v[4:7], v14, s[24:27], s39 offen offset:3072 sc1
    s_lshl_b32 s12, s3, 12
    s_add_u32 s12, s12, 0x80000
    buffer_store_dwordx4 v[4:7], v14, s[24:27], s12 offen offset:0 sc1
    buffer_store_dwordx4 v[4:7], v14, s[24:27], s12 offen offset:1024 sc1
    buffer_store_dwordx4 v[4:7], v14, s[24:27], s12 offen offset:2048 sc1
    buffer_store_dwordx4 v[4:7], v14, s[24:27], s12 offen offset:3072 sc1
    s_lshl_b32 s12, s3, 10
    s_add_u32 s12, s12, 0x30000
    s_cmp_gt_u32 s3, 223
    s_cselect_b32 s12, 0x620000, s12
    buffer_store_dwordx4 v[4:7], v14, s[24:27], s12 offen sc1
    s_lshl_b32 s12, s3, 9
    s_add_u32 s12, s12, 0x13000
    s_cmp_gt_u32 s3, 223
    s_cselect_b32 s12, 0x620000, s12
    s_mov_b32 exec_hi, 0
    buffer_store_dwordx4 v[4:7], v14, s[24:27], s12 offen sc1
    s_mov_b32 exec_lo, 0xff
    buffer_store_dwordx4 v[4:7], v3, s[24:27], s14 offen sc1
    s_mov_b64 exec, -1
    s_nop 0
fk_Hconst:
    s_sub_u32 s20, s16, 4
    v_lshrrev_b32 v208, 3, v15
    v_and_b32 v209, 7, v15
    v_and_b32 v210, 2, v208
    v_xor_b32 v209, v210, v209
    v_mul_u32_u24 v208, 7168, v208
    v_lshl_add_u32 v208, v209, 4, v208
    v_lshrrev_b32 v210, 5, v15
    v_lshlrev_b32 v210, 11, v210
    v_and_b32 v209, 31, v15
    v_lshl_add_u32 v210, v209, 4, v210
    s_and_b32 s12, s3, 3
    s_mul_i32 s100, s12, 1835008
    s_lshl_b32 s101, s12, 9
    s_lshr_b32 s12, s3, 2
    s_lshl_b32 s12, s12, 7
    s_add_u32 s100, s100, s12
    s_lshl_b32 s12, s12, 10
    s_add_u32 s101, s101, s12
    s_and_b32 s12, s20, 1
    s_lshl_b32 s12, s12, 6
    v_xor_b32 v206, s12, v208
    v_xor_b32 v207, 64, v206
    s_mov_b32 s6, 0x700000
    s_mov_b32 s7, 0x00020000
    s_cmp_gt_u32 s3, 223
    s_cselect_b32 s36, 3, s20
    s_waitcnt lgkmcnt(0)
    s_cmp_eq_u32 s36, 3
    s_cbranch_scc1 fk_gu0
    s_add_u32 s37, s20, 0
    s_lshl_b32 s12, s37, 10
    s_mov_b32 m0, s12
    s_cmp_lt_u32 s37, 32
    s_cselect_b64 s[4:5], s[44:45], s[48:49]
    s_and_b32 s37, s37, 31
    s_mul_i32 s37, s37, 57344
    s_add_u32 s37, s37, s100
    buffer_load_dwordx4 v206, s[4:7], s37 offen lds
fk_gu0:
    s_cmp_eq_u32 s36, 3
    s_cbranch_scc1 fk_gu1
    s_add_u32 s37, s20, 3
    s_lshl_b32 s12, s37, 10
    s_mov_b32 m0, s12
    s_cmp_lt_u32 s37, 32
    s_cselect_b64 s[4:5], s[44:45], s[48:49]
    s_and_b32 s37, s37, 31
    s_mul_i32 s37, s37, 57344
    s_add_u32 s37, s37, s100
    buffer_load_dwordx4 v207, s[4:7], s37 offen lds
fk_gu1:
    s_cmp_eq_u32 s36, 3
    s_cbranch_scc1 fk_gu2
    s_add_u32 s37, s20, 6
    s_lshl_b32 s12, s37, 10
    s_mov_b32 m0, s12
    s_cmp_lt_u32 s37, 32
    s_cselect_b64 s[4:5], s[44:45], s[48:49]
    s_and_b32 s37, s37, 31
    s_mul_i32 s37, s37, 57344
    s_add_u32 s37, s37, s100
    buffer_load_dwordx4 v206, s[4:7], s37 offen lds
fk_gu2:
    s_cmp_eq_u32 s36, 3
    s_cbranch_scc1 fk_gu3
    s_add_u32 s37, s20, 9
    s_lshl_b32 s12, s37, 10
    s_mov_b32 m0, s12
    s_cmp_lt_u32 s37, 32
    s_cselect_b64 s[4:5], s[44:45], s[48:49]
    s_and_b32 s37, s37, 31
    s_mul_i32 s37, s37, 57344
    s_add_u32 s37, s37, s100
    buffer_load_dwordx4 v207, s[4:7], s37 offen lds
fk_gu3:
    v_lshrrev_b32 v4, 1, v1
    v_and_b32 v5, 1, v4
    v_lshrrev_b32 v6, 2, v4
    v_lshl_add_u32 v5, v6, 1, v5
    v_and_b32 v6, 2, v4
    v_lshl_add_u32 v5, v6, 2, v5
    s_and_b32 s13, s20, 1
    s_mul_i32 s13, s13, 15
    v_xor_b32 v5, s13, v5
    s_lshl_b32 s13, s20, 4
    v_add_u32 v5, s13, v5
    v_cvt_f32_u32 v5, v5
    v_and_b32 v9, 1, v1
    v_lshlrev_b32 v7, 2, v2
    v_cvt_f32_u32 v7, v7
    v_cvt_f32_u32 v10, v9
    v_mul_f32 v8, 0x3c800000, v5
    v_mul_f32 v10, 0x3e800000, v10
    v_fma_f32 v10, v8, v7, v10
    v_mov_b32 v128, v10
    v_fmamk_f32 v129, v8, 0x3f800000, v10
    v_fmamk_f32 v130, v8, 0x40000000, v10
    v_fmamk_f32 v131, v8, 0x40400000, v10
    v_fmamk_f32 v132, v8, 0x41000000, v10
    v_fmamk_f32 v133, v8, 0x41100000, v10
    v_fmamk_f32 v134, v8, 0x41200000, v10
    v_fmamk_f32 v135, v8, 0x41300000, v10
    v_fmamk_f32 v136, v8, 0x41800000, v10
    v_fmamk_f32 v137, v8, 0x41880000, v10
    v_fmamk_f32 v138, v8, 0x41900000, v10
    v_fmamk_f32 v139, v8, 0x41980000, v10
    v_fmamk_f32 v140, v8, 0x41c00000, v10
    v_fmamk_f32 v141, v8, 0x41c80000, v10
    v_fmamk_f32 v142, v8, 0x41d00000, v10
    v_fmamk_f32 v143, v8, 0x41d80000, v10
    v_cos_f32 v144, v128
    v_cos_f32 v145, v129
    v_cos_f32 v146, v130
    v_cos_f32 v147, v131
    v_cos_f32 v148, v132
    v_cos_f32 v149, v133
    v_cos_f32 v150, v134
    v_cos_f32 v151, v135
    v_cos_f32 v152, v136
    v_cos_f32 v153, v137
    v_cos_f32 v154, v138
    v_cos_f32 v155, v139
    v_cos_f32 v156, v140
    v_cos_f32 v157, v141
    v_cos_f32 v158, v142
    v_cos_f32 v159, v143
    v_sin_f32 v160, v128
    v_sin_f32 v161, v129
    v_sin_f32 v162, v130
    v_sin_f32 v163, v131
    v_sin_f32 v164, v132
    v_sin_f32 v165, v133
    v_sin_f32 v166, v134
    v_sin_f32 v167, v135
    v_sin_f32 v168, v136
    v_sin_f32 v169, v137
    v_sin_f32 v170, v138
    v_sin_f32 v171, v139
    v_sin_f32 v172, v140
    v_sin_f32 v173, v141
    v_sin_f32 v174, v142
    v_sin_f32 v175, v143
    v_cvt_pk_f16_f32 v48, v144, v160
    v_cvt_pk_f16_f32 v49, v145, v161
    v_cvt_pk_f16_f32 v50, v146, v162
    v_cvt_pk_f16_f32 v51, v147, v163
    v_cvt_pk_f16_f32 v52, v148, v164
    v_cvt_pk_f16_f32 v53, v149, v165
    v_cvt_pk_f16_f32 v54, v150, v166
    v_cvt_pk_f16_f32 v55, v151, v167
    v_cvt_pk_f16_f32 v56, v152, v168
    v_cvt_pk_f16_f32 v57, v153, v169
    v_cvt_pk_f16_f32 v58, v154, v170
    v_cvt_pk_f16_f32 v59, v155, v171
    v_cvt_pk_f16_f32 v60, v156, v172
    v_cvt_pk_f16_f32 v61, v157, v173
    v_cvt_pk_f16_f32 v62, v158, v174
    v_cvt_pk_f16_f32 v63, v159, v175
    v_fmamk_f32 v128, v8, 0x42000000, v10
    v_fmamk_f32 v129, v8, 0x42040000, v10
    v_fmamk_f32 v130, v8, 0x42080000, v10
    v_fmamk_f32 v131, v8, 0x420c0000, v10
    v_fmamk_f32 v132, v8, 0x42200000, v10
    v_fmamk_f32 v133, v8, 0x42240000, v10
    v_fmamk_f32 v134, v8, 0x42280000, v10
    v_fmamk_f32 v135, v8, 0x422c0000, v10
    v_fmamk_f32 v136, v8, 0x42400000, v10
    v_fmamk_f32 v137, v8, 0x42440000, v10
    v_fmamk_f32 v138, v8, 0x42480000, v10
    v_fmamk_f32 v139, v8, 0x424c0000, v10
    v_fmamk_f32 v140, v8, 0x42600000, v10
    v_fmamk_f32 v141, v8, 0x42640000, v10
    v_fmamk_f32 v142, v8, 0x42680000, v10
    v_fmamk_f32 v143, v8, 0x426c0000, v10
    v_cos_f32 v144, v128
    v_cos_f32 v145, v129
    v_cos_f32 v146, v130
    v_cos_f32 v147, v131
    v_cos_f32 v148, v132
    v_cos_f32 v149, v133
    v_cos_f32 v150, v134
    v_cos_f32 v151, v135
    v_cos_f32 v152, v136
    v_cos_f32 v153, v137
    v_cos_f32 v154, v138
    v_cos_f32 v155, v139
    v_cos_f32 v156, v140
    v_cos_f32 v157, v141
    v_cos_f32 v158, v142
    v_cos_f32 v159, v143
    v_sin_f32 v160, v128
    v_sin_f32 v161, v129
    v_sin_f32 v162, v130
    v_sin_f32 v163, v131
    v_sin_f32 v164, v132
    v_sin_f32 v165, v133
    v_sin_f32 v166, v134
    v_sin_f32 v167, v135
    v_sin_f32 v168, v136
    v_sin_f32 v169, v137
    v_sin_f32 v170, v138
    v_sin_f32 v171, v139
    v_sin_f32 v172, v140
    v_sin_f32 v173, v141
    v_sin_f32 v174, v142
    v_sin_f32 v175, v143
    v_cvt_pk_f16_f32 v64, v144, v160
    v_cvt_pk_f16_f32 v65, v145, v161
    v_cvt_pk_f16_f32 v66, v146, v162
    v_cvt_pk_f16_f32 v67, v147, v163
    v_cvt_pk_f16_f32 v68, v148, v164
    v_cvt_pk_f16_f32 v69, v149, v165
    v_cvt_pk_f16_f32 v70, v150, v166
    v_cvt_pk_f16_f32 v71, v151, v167
    v_cvt_pk_f16_f32 v72, v152, v168
    v_cvt_pk_f16_f32 v73, v153, v169
    v_cvt_pk_f16_f32 v74, v154, v170
    v_cvt_pk_f16_f32 v75, v155, v171
    v_cvt_pk_f16_f32 v76, v156, v172
    v_cvt_pk_f16_f32 v77, v157, v173
    v_cvt_pk_f16_f32 v78, v158, v174
    v_cvt_pk_f16_f32 v79, v159, v175
    s_cmp_lg_u32 s16, 7
    s_cbranch_scc1 fk_Hb
    s_and_b32 s13, s2, 7
    s_lshl_b32 s13, s13, 12
    s_add_u32 s13, s13, 0x1000
    s_mov_b32 s59, 0
    s_nop 0
fk_pollf:
    buffer_load_dwordx2 v[16:17], v14, s[24:27], s13 offen offset:0 sc1
    buffer_load_dwordx2 v[18:19], v14, s[24:27], s13 offen offset:1024 sc1
    buffer_load_dwordx2 v[20:21], v14, s[24:27], s13 offen offset:2048 sc1
    buffer_load_dwordx2 v[22:23], v14, s[24:27], s13 offen offset:3072 sc1
    s_add_u32 s59, s59, 1
    s_waitcnt vmcnt(0)
    v_xor_b32 v16, s56, v16
    v_xor_b32 v17, s57, v17
    v_xor_b32 v18, s56, v18
    v_xor_b32 v19, s57, v19
    v_xor_b32 v20, s56, v20
    v_xor_b32 v21, s57, v21
    v_xor_b32 v22, s56, v22
    v_xor_b32 v23, s57, v23
    v_or3_b32 v16, v16, v17, v18
    v_or3_b32 v19, v19, v20, v21
    v_or3_b32 v16, v16, v22, v23
    v_or_b32 v16, v16, v19
    v_cmp_ne_u32 vcc, 0, v16
    s_cmp_gt_u32 s59, 0x40000
    s_cbranch_scc1 fk_gotf
    s_cbranch_vccnz fk_pollf
    s_nop 1
fk_gotf:
    ds_write_b32 v201, v204 offset:4
    s_cmp_lg_u32 s3, 0
    s_cbranch_scc1 fk_Hb
    v_mov_b32 v3, s56
    s_mov_b64 exec, 1
    buffer_store_dword v3, v14, s[24:27], 0 offen sc1
    s_mov_b64 exec, -1
    s_nop 1
fk_Hb:
    v_lshlrev_b32 v11, 31, v9
    v_mul_f32 v10, 0x3a000000, v5
    v_xor_b32 v10, v11, v10
    v_mul_f32 v11, v10, v7
    v_mov_b32 v128, v11
    v_fmamk_f32 v129, v10, 0x3f800000, v11
    v_fmamk_f32 v130, v10, 0x40000000, v11
    v_fmamk_f32 v131, v10, 0x40400000, v11
    v_fmamk_f32 v132, v10, 0x41000000, v11
    v_fmamk_f32 v133, v10, 0x41100000, v11
    v_fmamk_f32 v134, v10, 0x41200000, v11
    v_fmamk_f32 v135, v10, 0x41300000, v11
    v_fmamk_f32 v136, v10, 0x41800000, v11
    v_fmamk_f32 v137, v10, 0x41880000, v11
    v_fmamk_f32 v138, v10, 0x41900000, v11
    v_fmamk_f32 v139, v10, 0x41980000, v11
    v_fmamk_f32 v140, v10, 0x41c00000, v11
    v_fmamk_f32 v141, v10, 0x41c80000, v11
    v_fmamk_f32 v142, v10, 0x41d00000, v11
    v_fmamk_f32 v143, v10, 0x41d80000, v11
    v_cos_f32 v80, v128
    v_cos_f32 v81, v129
    v_cos_f32 v82, v130
    v_cos_f32 v83, v131
    v_cos_f32 v84, v132
    v_cos_f32 v85, v133
    v_cos_f32 v86, v134
    v_cos_f32 v87, v135
    v_cos_f32 v88, v136
    v_cos_f32 v89, v137
    v_cos_f32 v90, v138
    v_cos_f32 v91, v139
    v_cos_f32 v92, v140
    v_cos_f32 v93, v141
    v_cos_f32 v94, v142
    v_cos_f32 v95, v143
    v_sin_f32 v96, v128
    v_sin_f32 v97, v129
    v_sin_f32 v98, v130
    v_sin_f32 v99, v131
    v_sin_f32 v100, v132
    v_sin_f32 v101, v133
    v_sin_f32 v102, v134
    v_sin_f32 v103, v135
    v_sin_f32 v104, v136
    v_sin_f32 v105, v137
    v_sin_f32 v106, v138
    v_sin_f32 v107, v139
    v_sin_f32 v108, v140
    v_sin_f32 v109, v141
    v_sin_f32 v110, v142
    v_sin_f32 v111, v143
    v_sub_u32 v4, 31, v1
    v_subrev_u32 v5, 1, v1
    v_cmp_lt_u32 vcc, 16, v1
    s_nop 1
    v_cndmask_b32 v4, v5, v4, vcc
    v_and_b32 v4, 15, v4
    v_lshlrev_b32 v4, 5, v4
    v_add_u32 v4, 130304, v4
    v_lshlrev_b32 v5, 9, v2
    v_add_u32 v6, v4, v5
    v_sub_u32 v7, v4, v5
    v_add_u32 v7, 7696, v7
    v_cmp_eq_u32 s[38:39], 0, v1
    v_mov_b32 v8, 4096
    s_nop 0
    v_cndmask_b32 v8, 0, v8, s[38:39]
    v_add_u32 v6, v6, v8
    v_add_u32 v7, v7, v8
    v_and_b32 v8, 15, v1
    v_cmp_eq_u32 s[38:39], 0, v8
    s_nop 1
    s_or_b64 s[40:41], s[38:39], vcc
    v_add_u32 v184, 0, v6
    v_subrev_u32 v8, 0, v7
    v_cndmask_b32 v184, v184, v8, vcc
    v_add_u32 v185, 1024, v6
    v_subrev_u32 v8, 1024, v7
    v_cndmask_b32 v185, v185, v8, vcc
    v_add_u32 v186, 2048, v6
    v_subrev_u32 v8, 2048, v7
    v_cndmask_b32 v186, v186, v8, vcc
    v_add_u32 v187, 3072, v6
    v_subrev_u32 v8, 3072, v7
    v_cndmask_b32 v187, v187, v8, vcc
    v_add_u32 v188, 4096, v6
    v_subrev_u32 v8, 4096, v7
    v_cndmask_b32 v188, v188, v8, s[40:41]
    v_add_u32 v189, 5120, v6
    v_subrev_u32 v8, 5120, v7
    v_cndmask_b32 v189, v189, v8, s[40:41]
    v_add_u32 v190, 6144, v6
    v_subrev_u32 v8, 6144, v7
    v_cndmask_b32 v190, v190, v8, s[40:41]
    v_add_u32 v191, 7168, v6
    v_subrev_u32 v8, 7168, v7
    v_cndmask_b32 v191, v191, v8, s[40:41]
    s_lshr_b32 s13, s20, 1
    v_lshl_add_u32 v3, v1, 1, s13
    s_and_b32 s13, s20, 1
    s_sub_u32 s14, 64, s13
    v_and_b32 v8, 3, v3
    v_lshlrev_b32 v8, 2, v8
    v_lshlrev_b32 v4, 3, v3
    v_sub_u32 v4, v4, v8
    v_sub_u32 v5, 63, v3
    v_and_b32 v8, 3, v5
    v_mul_u32_u24 v8, 12, v8
    v_lshlrev_b32 v6, 3, v5
    v_sub_u32 v6, v6, v8
    v_add_u32 v6, 28, v6
    v_sub_u32 v5, s14, v3
    v_and_b32 v8, 3, v5
    v_mul_u32_u24 v8, 12, v8
    v_lshlrev_b32 v7, 3, v5
    v_sub_u32 v7, v7, v8
    v_add_u32 v7, 28, v7
    v_cmp_gt_u32 vcc, 32, v3
    s_nop 1
    v_cndmask_b32 v7, v7, v4, vcc
    v_cmp_eq_u32 vcc, 32, v5
    s_nop 1
    v_cndmask_b32 v7, v7, 28, vcc
    s_cmp_eq_u32 s13, 0
    s_cselect_b32 s14, 256, 0
    s_cselect_b32 s15, 576, 0
    s_cselect_b64 s[38:39], -1, 0
    s_add_u32 s14, s14, 7680
    s_sub_u32 s15, 120832, s15
    v_cmp_gt_u32 vcc, 32, v3
    s_nop 1
    v_cndmask_b32 v7, v7, v4, vcc
    v_add_u32 v7, s14, v7
    v_cndmask_b32 v4, v6, v4, s[38:39]
    v_lshl_add_u32 v4, v2, 12, v4
    v_lshrrev_b32 v8, 7, v4
    v_lshl_add_u32 v4, v8, 4, v4
    v_lshrrev_b32 v8, 7, v7
    v_lshl_add_u32 v7, v8, 4, v7
    v_add_u32 v11, s15, v4
    v_add_u32 v7, 120832, v7
    v_add_u32 v12, 4032, v11
    v_cmp_eq_u32 vcc, s13, v2
    s_nop 1
    s_and_b64 s[40:41], vcc, s[38:39]
    s_andn2_b64 s[38:39], vcc, s[38:39]
    v_cndmask_b32 v10, v11, v7, s[40:41]
    v_cndmask_b32 v12, v12, v7, s[38:39]
    s_lshl_b32 s23, s20, 5
    s_add_u32 s23, s23, s18
    v_and_b32 v3, 15, v15
    v_lshrrev_b32 v4, 4, v15
    v_lshl_add_u32 v3, v3, 7, v4
    v_add_u32 v3, 1, v3
    v_cmp_le_u32 vcc, 56, v15
    v_mov_b32 v4, 1008
    s_nop 0
    v_cndmask_b32 v4, 0, v4, vcc
    v_add_u32 v4, v3, v4
    v_mul_u32_u24 v3, s23, v3
    v_and_b32 v3, 2047, v3
    v_cvt_f32_u32 v3, v3
    v_mul_f32 v3, 0x3a000000, v3
    v_mul_u32_u24 v4, s23, v4
    v_and_b32 v4, 2047, v4
    v_cvt_f32_u32 v4, v4
    v_mul_f32 v4, 0x3a000000, v4
    v_cvt_f32_u32 v5, s23
    v_mul_f32 v5, 0x3a000000, v5
    v_mov_b32 v192, v3
    v_fmamk_f32 v193, v5, 0x42000000, v3
    v_fmamk_f32 v194, v5, 0x42800000, v3
    v_fmamk_f32 v195, v5, 0x42c00000, v3
    v_fmamk_f32 v196, v5, 0x40800000, v3
    v_fmamk_f32 v197, v5, 0x42100000, v3
    v_fmamk_f32 v198, v5, 0x42880000, v3
    v_fmamk_f32 v199, v5, 0x42c80000, v3
    v_fmamk_f32 v200, v5, 0x41000000, v3
    v_fmamk_f32 v201, v5, 0x42200000, v3
    v_fmamk_f32 v202, v5, 0x42900000, v3
    v_fmamk_f32 v203, v5, 0x42d00000, v3
    v_fmamk_f32 v204, v5, 0x41400000, v4
    v_fmamk_f32 v205, v5, 0x42300000, v4
    v_fmamk_f32 v206, v5, 0x42980000, v4
    v_fmamk_f32 v207, v5, 0x42d80000, v4
    v_cos_f32 v192, v192
    v_cos_f32 v193, v193
    v_cos_f32 v194, v194
    v_cos_f32 v195, v195
    v_cos_f32 v196, v196
    v_cos_f32 v197, v197
    v_cos_f32 v198, v198
    v_cos_f32 v199, v199
    v_cos_f32 v200, v200
    v_cos_f32 v201, v201
    v_cos_f32 v202, v202
    v_cos_f32 v203, v203
    v_cos_f32 v204, v204
    v_cos_f32 v205, v205
    v_cos_f32 v206, v206
    v_cos_f32 v207, v207
    v_add_u32 v9, 138496, v14
    s_setprio 2
    s_barrier
    ds_read_b128 v[16:19], v184
    ds_read_b128 v[20:23], v185
    ds_read_b128 v[24:27], v186
    ds_read_b128 v[28:31], v187
    ds_read_b128 v[32:35], v188
    ds_read_b128 v[36:39], v189
    ds_read_b128 v[40:43], v190
    ds_read_b128 v[44:47], v191
    ds_read_b128 v[112:115], v9 offset:12288
    ds_read_b128 v[116:119], v9 offset:13312
    ds_read_b128 v[120:123], v9 offset:14336
    ds_read_b128 v[124:127], v9 offset:15360
    s_waitcnt lgkmcnt(11)
    v_mfma_f32_32x32x16_f16 v[128:143], v[16:19], v[48:51], 0
    s_waitcnt lgkmcnt(10)
    v_mfma_f32_32x32x16_f16 v[128:143], v[20:23], v[52:55], v[128:143]
    s_waitcnt lgkmcnt(9)
    v_mfma_f32_32x32x16_f16 v[128:143], v[24:27], v[56:59], v[128:143]
    s_waitcnt lgkmcnt(8)
    v_mfma_f32_32x32x16_f16 v[128:143], v[28:31], v[60:63], v[128:143]
    s_waitcnt lgkmcnt(7)
    v_mfma_f32_32x32x16_f16 v[128:143], v[32:35], v[64:67], v[128:143]
    s_waitcnt lgkmcnt(6)
    v_mfma_f32_32x32x16_f16 v[128:143], v[36:39], v[68:71], v[128:143]
    s_waitcnt lgkmcnt(5)
    v_mfma_f32_32x32x16_f16 v[128:143], v[40:43], v[72:75], v[128:143]
    s_waitcnt lgkmcnt(4)
    v_mfma_f32_32x32x16_f16 v[128:143], v[44:47], v[76:79], v[128:143]
    s_nop 11
    v_mul_f32 v16, v128, v80
    v_mul_f32 v17, v129, v81
    v_mul_f32 v18, v130, v82
    v_mul_f32 v19, v131, v83
    v_mul_f32 v20, v132, v84
    v_mul_f32 v21, v133, v85
    v_mul_f32 v22, v134, v86
    v_mul_f32 v23, v135, v87
    v_mul_f32 v24, v136, v88
    v_mul_f32 v25, v137, v89
    v_mul_f32 v26, v138, v90
    v_mul_f32 v27, v139, v91
    v_mul_f32 v28, v140, v92
    v_mul_f32 v29, v141, v93
    v_mul_f32 v30, v142, v94
    v_mul_f32 v31, v143, v95
    v_fmac_f32_dpp v16, v128, v96 quad_perm:[1,0,3,2] row_mask:0xf bank_mask:0xf
    v_fmac_f32_dpp v17, v129, v97 quad_perm:[1,0,3,2] row_mask:0xf bank_mask:0xf
    v_fmac_f32_dpp v18, v130, v98 quad_perm:[1,0,3,2] row_mask:0xf bank_mask:0xf
    v_fmac_f32_dpp v19, v131, v99 quad_perm:[1,0,3,2] row_mask:0xf bank_mask:0xf
    v_fmac_f32_dpp v20, v132, v100 quad_perm:[1,0,3,2] row_mask:0xf bank_mask:0xf
    v_fmac_f32_dpp v21, v133, v101 quad_perm:[1,0,3,2] row_mask:0xf bank_mask:0xf
    v_fmac_f32_dpp v22, v134, v102 quad_perm:[1,0,3,2] row_mask:0xf bank_mask:0xf
    v_fmac_f32_dpp v23, v135, v103 quad_perm:[1,0,3,2] row_mask:0xf bank_mask:0xf
    v_cvt_pk_f16_f32 v176, v16, v17
    v_cvt_pk_f16_f32 v177, v18, v19
    v_cvt_pk_f16_f32 v178, v20, v21
    v_cvt_pk_f16_f32 v179, v22, v23
    v_fmac_f32_dpp v24, v136, v104 quad_perm:[1,0,3,2] row_mask:0xf bank_mask:0xf
    v_fmac_f32_dpp v25, v137, v105 quad_perm:[1,0,3,2] row_mask:0xf bank_mask:0xf
    s_waitcnt lgkmcnt(0)
    v_mfma_f32_32x32x16_f16 v[144:159], v[176:179], v[112:115], 0
    v_fmac_f32_dpp v26, v138, v106 quad_perm:[1,0,3,2] row_mask:0xf bank_mask:0xf
    v_fmac_f32_dpp v27, v139, v107 quad_perm:[1,0,3,2] row_mask:0xf bank_mask:0xf
    v_fmac_f32_dpp v28, v140, v108 quad_perm:[1,0,3,2] row_mask:0xf bank_mask:0xf
    v_fmac_f32_dpp v29, v141, v109 quad_perm:[1,0,3,2] row_mask:0xf bank_mask:0xf
    v_fmac_f32_dpp v30, v142, v110 quad_perm:[1,0,3,2] row_mask:0xf bank_mask:0xf
    v_mfma_f32_32x32x16_f16 v[160:175], v[176:179], v[120:123], 0
    v_fmac_f32_dpp v31, v143, v111 quad_perm:[1,0,3,2] row_mask:0xf bank_mask:0xf
    v_cvt_pk_f16_f32 v180, v24, v25
    v_cvt_pk_f16_f32 v181, v26, v27
    v_cvt_pk_f16_f32 v182, v28, v29
    v_cvt_pk_f16_f32 v183, v30, v31
    s_nop 1
    v_mfma_f32_32x32x16_f16 v[144:159], v[180:183], v[116:119], v[144:159]
    v_mfma_f32_32x32x16_f16 v[160:175], v[180:183], v[124:127], v[160:175]
    s_nop 11
    v_add_f32 v16, v144, v161
    v_sub_f32 v24, v145, v160
    v_cvt_pk_bf16_f32 v48, v16, v24
    ds_write_b32 v10, v48
    v_add_f32 v17, v146, v163
    v_sub_f32 v25, v147, v162
    v_cvt_pk_bf16_f32 v49, v17, v25
    ds_write_b32 v11, v49 offset:576
    v_add_f32 v18, v148, v165
    v_sub_f32 v26, v149, v164
    v_cvt_pk_bf16_f32 v50, v18, v26
    ds_write_b32 v11, v50 offset:1152
    v_add_f32 v19, v150, v167
    v_sub_f32 v27, v151, v166
    v_cvt_pk_bf16_f32 v51, v19, v27
    ds_write_b32 v11, v51 offset:1728
    v_add_f32 v20, v152, v169
    v_sub_f32 v28, v153, v168
    v_cvt_pk_bf16_f32 v52, v20, v28
    ds_write_b32 v11, v52 offset:2304
    v_add_f32 v21, v154, v171
    v_sub_f32 v29, v155, v170
    v_cvt_pk_bf16_f32 v53, v21, v29
    ds_write_b32 v11, v53 offset:2880
    v_add_f32 v22, v156, v173
    v_sub_f32 v30, v157, v172
    v_cvt_pk_bf16_f32 v54, v22, v30
    ds_write_b32 v11, v54 offset:3456
    v_add_f32 v23, v158, v175
    v_sub_f32 v31, v159, v174
    v_cvt_pk_bf16_f32 v55, v23, v31
    ds_write_b32 v12, v55
    s_nop 3
fk_common:
    v_lshlrev_b32 v4, 4, v0
    v_lshrrev_b32 v5, 3, v0
    v_lshl_add_u32 v5, v5, 4, v4
    v_add_u32 v5, 120832, v5
    s_mul_i32 s17, s3, 8320
    s_add_u32 s17, s17, 0x410000
    s_waitcnt lgkmcnt(0)
    s_barrier
    s_setprio 0
    ds_read_b128 v[16:19], v5
    s_sub_u32 s13, 7, s16
    s_cmp_lt_u32 s16, 4
    s_cselect_b32 s13, s16, s13
    s_cselect_b32 s14, 0, 2048
    s_lshl_b32 s21, s13, 5
    s_add_u32 s21, s21, s18
    s_sub_u32 s22, 2048, s21
    s_and_b32 s22, s22, 2047
    s_cmp_lt_u32 s16, 4
    s_cselect_b32 s21, s21, s22
    s_lshl_b32 s13, s13, 12
    s_add_u32 s13, s13, s14
    s_add_u32 s13, s13, 98304
    s_lshl_b32 s14, s3, 3
    s_add_u32 s19, s14, s16
    s_cmp_eq_u32 s19, 1991
    s_cselect_b32 s21, 1024, s21
    s_cselect_b32 s13, 118784, s13
    s_lshl_b32 s22, s21, 11
    v_add_u32 v6, s13, v14
    v_add_u32 v7, 155008, v14
    s_waitcnt lgkmcnt(0)
    v_min_u32 v16, -2, v16
    v_min_u32 v17, -2, v17
    v_min_u32 v18, -2, v18
    v_min_u32 v19, -2, v19
    buffer_store_dwordx4 v[16:19], v4, s[24:27], s17 offen sc1
    ds_read_b128 v[20:23], v6
    ds_read_b128 v[24:27], v6 offset:1024
    ds_read_b128 v[28:31], v7
    ds_read_b128 v[32:35], v7 offset:1024
    s_cmp_lt_u32 s16, 4
    s_cbranch_scc1 fk_noy5
    v_add_u32 v3, 114688, v14
    v_mov_b32 v4, 157152
    ds_read_b128 v[128:131], v3 offset:0
    ds_read_b128 v[132:135], v3 offset:1024
    ds_read_b128 v[136:139], v3 offset:2048
    ds_read_b128 v[140:143], v3 offset:3072
    ds_read_b32 v9, v4
    s_lshl_b32 s38, s20, 2
    s_sub_u32 s39, 28, s38
    s_waitcnt lgkmcnt(0)
    s_nop 0
fk_y5:
    v_pk_mul_f32 v[144:145], v[128:129], v[192:193]
    v_pk_mul_f32 v[146:147], v[130:131], v[194:195]
    v_pk_fma_f32 v[144:145], v[132:133], v[196:197], v[144:145]
    v_pk_fma_f32 v[146:147], v[134:135], v[198:199], v[146:147]
    v_pk_fma_f32 v[144:145], v[136:137], v[200:201], v[144:145]
    v_pk_fma_f32 v[146:147], v[138:139], v[202:203], v[146:147]
    v_pk_fma_f32 v[144:145], v[140:141], v[204:205], v[144:145]
    v_pk_fma_f32 v[146:147], v[142:143], v[206:207], v[146:147]
    v_pk_add_f32 v[144:145], v[144:145], v[146:147]
    v_add_f32 v144, v144, v145
    s_lshl_b32 s13, s23, 31
    v_xor_b32 v12, s13, v9
    v_add_f32_dpp v144, v144, v144 quad_perm:[1,0,3,2] row_mask:0xf bank_mask:0xf
    s_nop 1
    v_add_f32_dpp v144, v144, v144 quad_perm:[2,3,0,1] row_mask:0xf bank_mask:0xf
    s_nop 1
    v_add_f32_dpp v144, v144, v144 row_half_mirror row_mask:0xf bank_mask:0xf
    s_nop 1
    v_add_f32_dpp v144, v144, v144 row_mirror row_mask:0xf bank_mask:0xf
    s_nop 1
    v_add_f32_dpp v144, v144, v144 row_bcast:15 row_mask:0xa bank_mask:0xf
    s_nop 1
    v_add_f32_dpp v144, v144, v144 row_bcast:31 row_mask:0xc bank_mask:0xf
    v_add_f32 v144, v144, v12
    v_add_f32 v144, v144, v144
    v_cvt_pk_bf16_f32 v144, 0, v144
    s_add_u32 s13, s38, 157088
    s_add_u32 s14, s39, 157088
    v_mov_b32 v10, s13
    v_mov_b32 v11, s14
    s_mov_b32 exec_lo, 0
    s_mov_b32 exec_hi, 0x80000000
    ds_write_b32 v10, v144
    ds_write_b32 v11, v144
    s_mov_b64 exec, -1
    s_cmp_lg_u32 s23, 0
    s_cbranch_scc1 fk_noy5
    s_mov_b32 s23, 1024
    s_mov_b32 s38, 28
    v_and_b32 v3, 15, v15
    v_lshrrev_b32 v4, 4, v15
    v_lshl_add_u32 v3, v3, 7, v4
    v_add_u32 v3, 1, v3
    v_cmp_le_u32 vcc, 56, v15
    v_mov_b32 v4, 1008
    s_nop 0
    v_cndmask_b32 v4, 0, v4, vcc
    v_add_u32 v4, v3, v4
    v_mul_u32_u24 v3, s23, v3
    v_and_b32 v3, 2047, v3
    v_cvt_f32_u32 v3, v3
    v_mul_f32 v3, 0x3a000000, v3
    v_mul_u32_u24 v4, s23, v4
    v_and_b32 v4, 2047, v4
    v_cvt_f32_u32 v4, v4
    v_mul_f32 v4, 0x3a000000, v4
    v_cvt_f32_u32 v5, s23
    v_mul_f32 v5, 0x3a000000, v5
    v_mov_b32 v192, v3
    v_fmamk_f32 v193, v5, 0x42000000, v3
    v_fmamk_f32 v194, v5, 0x42800000, v3
    v_fmamk_f32 v195, v5, 0x42c00000, v3
    v_fmamk_f32 v196, v5, 0x40800000, v3
    v_fmamk_f32 v197, v5, 0x42100000, v3
    v_fmamk_f32 v198, v5, 0x42880000, v3
    v_fmamk_f32 v199, v5, 0x42c80000, v3
    v_fmamk_f32 v200, v5, 0x41000000, v3
    v_fmamk_f32 v201, v5, 0x42200000, v3
    v_fmamk_f32 v202, v5, 0x42900000, v3
    v_fmamk_f32 v203, v5, 0x42d00000, v3
    v_fmamk_f32 v204, v5, 0x41400000, v4
    v_fmamk_f32 v205, v5, 0x42300000, v4
    v_fmamk_f32 v206, v5, 0x42980000, v4
    v_fmamk_f32 v207, v5, 0x42d80000, v4
    v_cos_f32 v192, v192
    v_cos_f32 v193, v193
    v_cos_f32 v194, v194
    v_cos_f32 v195, v195
    v_cos_f32 v196, v196
    v_cos_f32 v197, v197
    v_cos_f32 v198, v198
    v_cos_f32 v199, v199
    v_cos_f32 v200, v200
    v_cos_f32 v201, v201
    v_cos_f32 v202, v202
    v_cos_f32 v203, v203
    v_cos_f32 v204, v204
    v_cos_f32 v205, v205
    v_cos_f32 v206, v206
    v_cos_f32 v207, v207
    s_branch fk_y5
    s_nop 3
fk_noy5:
    v_lshrrev_b32 v1, 1, v0
    v_and_b32 v45, 1, v0
    v_lshrrev_b32 v2, 4, v1
    v_and_b32 v3, 15, v1
    v_cmp_gt_u32 vcc, 8, v3
    v_sub_u32 v6, 16, v3
    v_and_b32 v6, 7, v6
    v_sub_u32 v5, 31, v2
    v_cndmask_b32 v6, v6, v3, vcc
    v_cndmask_b32 v5, v5, v2, vcc
    v_lshl_add_u32 v4, v6, 5, v5
    v_mul_u32_u24 v4, 8320, v4
    v_lshl_add_u32 v4, v45, 4, v4
    s_lshl_b32 s17, s3, 5
    s_add_u32 s17, s17, 0x410000
    v_cndmask_b32 v6, -1, 1, vcc
    v_cmp_eq_u32 vcc, 8, v3
    v_mul_u32_u24 v46, 8256, v45
    v_add_u32 v46, 138496, v46
    v_sub_u32 v47, 287296, v46
    v_cndmask_b32 v6, v6, 15, vcc
    v_lshlrev_b32 v9, 2, v1
    v_lshl_add_u32 v10, v6, 1, v9
    v_sub_u32 v11, v47, v9
    v_sub_u32 v12, v47, v10
    v_add_u32 v9, v46, v9
    v_add_u32 v10, v46, v10
    s_cmp_eq_u32 s3, 248
    s_cselect_b32 s38, 14448, 0
    v_mul_u32_u24 v46, s38, v45
    v_sub_u32 v47, s38, v46
    v_add_u32 v7, v46, v11
    v_add_u32 v8, v46, v12
    v_sub_u32 v2, v11, v47
    v_sub_u32 v3, v12, v47
    s_mul_i32 s36, s16, 2064
    s_add_u32 s36, s36, 138496
    v_add_u32 v5, s36, v14
    s_lshl_b32 s36, s16, 2
    s_add_u32 s36, s36, 157088
    v_mov_b32 v6, s36
    s_mov_b32 s36, 0xffff0000
    s_mov_b32 s37, 0x3f803f80
    s_mov_b32 s38, 8.0
    s_waitcnt lgkmcnt(0)
    v_lshlrev_b32 v48, 16, v20
    v_and_b32 v49, s36, v20
    v_lshlrev_b32 v50, 16, v21
    v_and_b32 v51, s36, v21
    v_lshlrev_b32 v52, 16, v22
    v_and_b32 v53, s36, v22
    v_lshlrev_b32 v54, 16, v23
    v_and_b32 v55, s36, v23
    v_lshlrev_b32 v56, 16, v24
    v_and_b32 v57, s36, v24
    v_lshlrev_b32 v58, 16, v25
    v_and_b32 v59, s36, v25
    v_lshlrev_b32 v60, 16, v26
    v_and_b32 v61, s36, v26
    v_lshlrev_b32 v62, 16, v27
    v_and_b32 v63, s36, v27
    v_mov_b32 v44, 0
    v_dot2c_f32_bf16 v44, s37, v28
    v_dot2c_f32_bf16 v44, s37, v29
    v_dot2c_f32_bf16 v44, s37, v30
    v_dot2c_f32_bf16 v44, s37, v31
    v_dot2c_f32_bf16 v44, s37, v32
    v_dot2c_f32_bf16 v44, s37, v33
    v_dot2c_f32_bf16 v44, s37, v34
    v_dot2c_f32_bf16 v44, s37, v35
    s_nop 2
    v_add_f32_dpp v44, v44, v44 quad_perm:[1,0,3,2] row_mask:0xf bank_mask:0xf
    s_nop 1
    v_add_f32_dpp v44, v44, v44 quad_perm:[2,3,0,1] row_mask:0xf bank_mask:0xf
    s_nop 1
    v_add_f32_dpp v44, v44, v44 row_half_mirror row_mask:0xf bank_mask:0xf
    s_nop 1
    v_add_f32_dpp v44, v44, v44 row_mirror row_mask:0xf bank_mask:0xf
    s_nop 1
    v_add_f32_dpp v44, v44, v44 row_bcast:15 row_mask:0xa bank_mask:0xf
    s_nop 1
    v_add_f32_dpp v44, v44, v44 row_bcast:31 row_mask:0xc bank_mask:0xf
    s_nop 0
    v_readlane_b32 s39, v44, 63
    s_mov_b32 s42, 0
    s_waitcnt vmcnt(0)
    s_nop 2
fk_polly:
    buffer_load_dwordx4 v[36:39], v4, s[24:27], s17 offen sc1
    s_add_u32 s42, s42, 1
    s_waitcnt vmcnt(0)
    v_max3_u32 v46, v36, v37, v38
    v_max_u32 v46, v46, v39
    v_cmp_eq_u32 vcc, -1, v46
    s_cmp_gt_u32 s42, 0x40000
    s_cbranch_scc1 fk_goty
    s_cbranch_vccnz fk_polly
    s_nop 1
fk_goty:
    ds_write_b16 v9, v36 offset:0
    ds_write_b16_d16_hi v10, v36 offset:0
    ds_write_b16 v2, v36 offset:6192
    ds_write_b16_d16_hi v3, v36 offset:6192
    ds_write_b16 v9, v37 offset:2064
    ds_write_b16_d16_hi v10, v37 offset:2064
    ds_write_b16 v11, v37 offset:4128
    ds_write_b16_d16_hi v12, v37 offset:4128
    ds_write_b16 v9, v38 offset:4128
    ds_write_b16_d16_hi v10, v38 offset:4128
    ds_write_b16 v11, v38 offset:2064
    ds_write_b16_d16_hi v12, v38 offset:2064
    ds_write_b16 v9, v39 offset:6192
    ds_write_b16_d16_hi v10, v39 offset:6192
    ds_write_b16 v7, v39 offset:0
    ds_write_b16_d16_hi v8, v39 offset:0
    s_cmp_gt_u32 s3, 223
    s_cbranch_scc1 fk_win2
    s_mul_i32 s15, s16, 5
    s_add_u32 s15, s15, 28
    s_mov_b32 s58, 0x700000
    s_mov_b32 s59, 0x00020000
    s_cmp_gt_u32 s15, 95
    s_cbranch_scc1 fk_win2
    s_lshl_b32 s12, s15, 10
    s_mov_b32 m0, s12
    s_and_b32 s14, s12, 1024
    s_lshr_b32 s14, s14, 4
    v_xor_b32 v209, s14, v208
    s_cmp_lt_u32 s15, 32
    s_cselect_b64 s[56:57], s[44:45], s[48:49]
    s_and_b32 s14, s15, 31
    s_mul_i32 s13, s14, 57344
    s_add_u32 s13, s13, s100
    s_lshl_b32 s14, s14, 12
    s_add_u32 s14, s14, s101
    s_cmp_lt_u32 s15, 64
    s_cselect_b64 s[56:57], s[56:57], s[52:53]
    s_cselect_b32 s13, s13, s14
    s_cselect_b64 vcc, -1, 0
    v_cndmask_b32 v209, v210, v209, vcc
    s_add_u32 s15, s15, 1
    buffer_load_dwordx4 v209, s[56:59], s13 offen lds
    s_cmp_gt_u32 s15, 95
    s_cbranch_scc1 fk_win2
    s_lshl_b32 s12, s15, 10
    s_mov_b32 m0, s12
    s_and_b32 s14, s12, 1024
    s_lshr_b32 s14, s14, 4
    v_xor_b32 v209, s14, v208
    s_cmp_lt_u32 s15, 32
    s_cselect_b64 s[56:57], s[44:45], s[48:49]
    s_and_b32 s14, s15, 31
    s_mul_i32 s13, s14, 57344
    s_add_u32 s13, s13, s100
    s_lshl_b32 s14, s14, 12
    s_add_u32 s14, s14, s101
    s_cmp_lt_u32 s15, 64
    s_cselect_b64 s[56:57], s[56:57], s[52:53]
    s_cselect_b32 s13, s13, s14
    s_cselect_b64 vcc, -1, 0
    v_cndmask_b32 v209, v210, v209, vcc
    s_add_u32 s15, s15, 1
    buffer_load_dwordx4 v209, s[56:59], s13 offen lds
    s_cmp_gt_u32 s15, 95
    s_cbranch_scc1 fk_win2
    s_lshl_b32 s12, s15, 10
    s_mov_b32 m0, s12
    s_and_b32 s14, s12, 1024
    s_lshr_b32 s14, s14, 4
    v_xor_b32 v209, s14, v208
    s_cmp_lt_u32 s15, 32
    s_cselect_b64 s[56:57], s[44:45], s[48:49]
    s_and_b32 s14, s15, 31
    s_mul_i32 s13, s14, 57344
    s_add_u32 s13, s13, s100
    s_lshl_b32 s14, s14, 12
    s_add_u32 s14, s14, s101
    s_cmp_lt_u32 s15, 64
    s_cselect_b64 s[56:57], s[56:57], s[52:53]
    s_cselect_b32 s13, s13, s14
    s_cselect_b64 vcc, -1, 0
    v_cndmask_b32 v209, v210, v209, vcc
    s_add_u32 s15, s15, 1
    buffer_load_dwordx4 v209, s[56:59], s13 offen lds
    s_cmp_gt_u32 s15, 95
    s_cbranch_scc1 fk_win2
    s_lshl_b32 s12, s15, 10
    s_mov_b32 m0, s12
    s_and_b32 s14, s12, 1024
    s_lshr_b32 s14, s14, 4
    v_xor_b32 v209, s14, v208
    s_cmp_lt_u32 s15, 32
    s_cselect_b64 s[56:57], s[44:45], s[48:49]
    s_and_b32 s14, s15, 31
    s_mul_i32 s13, s14, 57344
    s_add_u32 s13, s13, s100
    s_lshl_b32 s14, s14, 12
    s_add_u32 s14, s14, s101
    s_cmp_lt_u32 s15, 64
    s_cselect_b64 s[56:57], s[56:57], s[52:53]
    s_cselect_b32 s13, s13, s14
    s_cselect_b64 vcc, -1, 0
    v_cndmask_b32 v209, v210, v209, vcc
    s_add_u32 s15, s15, 1
    buffer_load_dwordx4 v209, s[56:59], s13 offen lds
    s_cmp_gt_u32 s15, 95
    s_cbranch_scc1 fk_win2
    s_lshl_b32 s12, s15, 10
    s_mov_b32 m0, s12
    s_and_b32 s14, s12, 1024
    s_lshr_b32 s14, s14, 4
    v_xor_b32 v209, s14, v208
    s_cmp_lt_u32 s15, 32
    s_cselect_b64 s[56:57], s[44:45], s[48:49]
    s_and_b32 s14, s15, 31
    s_mul_i32 s13, s14, 57344
    s_add_u32 s13, s13, s100
    s_lshl_b32 s14, s14, 12
    s_add_u32 s14, s14, s101
    s_cmp_lt_u32 s15, 64
    s_cselect_b64 s[56:57], s[56:57], s[52:53]
    s_cselect_b32 s13, s13, s14
    s_cselect_b64 vcc, -1, 0
    v_cndmask_b32 v209, v210, v209, vcc
    s_add_u32 s15, s15, 1
    buffer_load_dwordx4 v209, s[56:59], s13 offen lds
    s_nop 2
fk_win2:
    v_mov_b32 v2, 0
    v_mov_b32 v3, 0
    v_mov_b32 v4, 0
    v_mov_b32 v7, 0
    v_mov_b32 v12, 157120
    s_waitcnt lgkmcnt(0)
    s_barrier
    ds_read_b128 v[36:39], v5
    ds_read_b128 v[40:43], v5 offset:1024
    ds_read_b32 v44, v6
    s_waitcnt lgkmcnt(2)
    v_lshlrev_b32 v64, 16, v36
    v_and_b32 v65, s36, v36
    v_lshlrev_b32 v66, 16, v37
    v_and_b32 v67, s36, v37
    v_lshlrev_b32 v68, 16, v38
    v_and_b32 v69, s36, v38
    v_lshlrev_b32 v70, 16, v39
    v_and_b32 v71, s36, v39
    s_waitcnt lgkmcnt(0)
    v_readfirstlane_b32 s13, v44
    v_lshlrev_b32 v72, 16, v40
    v_and_b32 v73, s36, v40
    v_lshlrev_b32 v74, 16, v41
    v_and_b32 v75, s36, v41
    v_lshlrev_b32 v76, 16, v42
    v_and_b32 v77, s36, v42
    v_lshlrev_b32 v78, 16, v43
    v_and_b32 v79, s36, v43
    v_writelane_b32 v72, s13, 0
    v_pk_fma_f32 v[48:49], v[64:65], s[38:39], v[48:49] op_sel_hi:[1,0,1]
    v_pk_fma_f32 v[50:51], v[66:67], s[38:39], v[50:51] op_sel_hi:[1,0,1]
    v_pk_fma_f32 v[52:53], v[68:69], s[38:39], v[52:53] op_sel_hi:[1,0,1]
    v_pk_fma_f32 v[54:55], v[70:71], s[38:39], v[54:55] op_sel_hi:[1,0,1]
    v_pk_fma_f32 v[58:59], v[74:75], s[38:39], v[58:59] op_sel_hi:[1,0,1]
    v_pk_fma_f32 v[60:61], v[76:77], s[38:39], v[60:61] op_sel_hi:[1,0,1]
    v_pk_fma_f32 v[62:63], v[78:79], s[38:39], v[62:63] op_sel_hi:[1,0,1]
    v_pk_fma_f32 v[56:57], v[72:73], s[38:39], v[56:57] op_sel_hi:[1,0,1]
    v_cvt_pk_bf16_f32 v80, v48, v49
    v_cvt_pk_bf16_f32 v81, v50, v51
    v_cvt_pk_bf16_f32 v82, v52, v53
    v_cvt_pk_bf16_f32 v83, v54, v55
    v_cvt_pk_bf16_f32 v85, v58, v59
    v_cvt_pk_bf16_f32 v86, v60, v61
    v_cvt_pk_bf16_f32 v87, v62, v63
    v_cvt_pk_bf16_f32 v84, v56, v57
    v_dot2c_f32_bf16 v2, s37, v80
    v_dot2c_f32_bf16 v3, v80, v80
    v_dot2c_f32_bf16 v4, v80, v28
    v_dot2c_f32_bf16 v2, s37, v81
    v_dot2c_f32_bf16 v3, v81, v81
    v_dot2c_f32_bf16 v4, v81, v29
    v_dot2c_f32_bf16 v2, s37, v82
    v_dot2c_f32_bf16 v3, v82, v82
    v_dot2c_f32_bf16 v4, v82, v30
    v_dot2c_f32_bf16 v2, s37, v83
    v_dot2c_f32_bf16 v3, v83, v83
    v_dot2c_f32_bf16 v4, v83, v31
    v_dot2c_f32_bf16 v2, s37, v85
    v_dot2c_f32_bf16 v3, v85, v85
    v_dot2c_f32_bf16 v4, v85, v33
    v_dot2c_f32_bf16 v2, s37, v86
    v_dot2c_f32_bf16 v3, v86, v86
    v_dot2c_f32_bf16 v4, v86, v34
    v_dot2c_f32_bf16 v2, s37, v87
    v_dot2c_f32_bf16 v3, v87, v87
    v_dot2c_f32_bf16 v4, v87, v35
    v_dot2c_f32_bf16 v2, s37, v84
    v_dot2c_f32_bf16 v3, v84, v84
    v_dot2c_f32_bf16 v4, v84, v32
    s_nop 2
    v_permlane32_swap_b32 v2, v4
    v_permlane32_swap_b32 v3, v7
    v_add_f32 v2, v2, v4
    v_add_f32 v3, v3, v7
    s_nop 1
    v_permlane16_swap_b32 v2, v3
    v_add_f32 v2, v2, v3
    s_nop 1
    v_add_f32_dpp v2, v2, v2 quad_perm:[1,0,3,2] row_mask:0xf bank_mask:0xf
    s_nop 1
    v_add_f32_dpp v2, v2, v2 quad_perm:[2,3,0,1] row_mask:0xf bank_mask:0xf
    s_nop 1
    v_add_f32_dpp v2, v2, v2 row_half_mirror row_mask:0xf bank_mask:0xf
    s_nop 1
    v_add_f32_dpp v2, v2, v2 row_mirror row_mask:0xf bank_mask:0xf
    s_nop 0
    v_readlane_b32 s13, v2, 32
    v_mov_b32_dpp v8, v2 row_bcast:15 row_mask:0xa bank_mask:0xf
    v_mul_f32 v9, 0x3a800000, v2
    v_mul_f32 v8, 0x3a800000, v8
    v_fma_f32 v9, -v8, v8, v9
    v_max_f32 v9, 0, v9
    v_cvt_pk_bf16_f32 v9, 0, v9
    v_cvt_pk_bf16_f32 v8, 0, v8
    v_add_f32 v9, 0x3727c5ac, v9
    v_cvt_pk_bf16_f32 v9, 0, v9
    v_sqrt_f32 v9, v9
    s_nop 0
    v_cvt_pk_bf16_f32 v9, 0, v9
    v_rcp_f32 v9, v9
    v_mov_b32 v10, s13
    v_fma_f32 v10, -v8, s39, v10
    v_mul_f32 v10, v10, v9
    v_mul_f32 v8, v8, v9
    v_readlane_b32 s43, v10, 16
    v_readlane_b32 s4, v9, 16
    v_readlane_b32 s6, v8, 16
    s_ashr_i32 s13, s43, 31
    s_or_b32 s13, s13, 0x80000000
    s_xor_b32 s43, s43, s13
    s_and_b32 s43, s43, 0xfffff800
    s_or_b32 s43, s43, s19
    s_min_u32 s43, s43, -2
    v_mov_b32 v2, s43
    s_mov_b64 exec, 1
    ds_max_u32 v12, v2
    s_mov_b64 exec, -1
    v_mov_b32 v10, s6
    v_add_f32 v8, 1.0, v9
    s_nop 0
    v_readlane_b32 s14, v8, 16
    s_waitcnt lgkmcnt(0)
    s_barrier
    ds_read_b32 v3, v12
    v_lshlrev_b32 v48, 16, v80
    v_and_b32 v49, s36, v80
    v_lshlrev_b32 v50, 16, v81
    v_and_b32 v51, s36, v81
    v_lshlrev_b32 v52, 16, v82
    v_and_b32 v53, s36, v82
    v_lshlrev_b32 v54, 16, v83
    v_and_b32 v55, s36, v83
    v_lshlrev_b32 v56, 16, v84
    v_and_b32 v57, s36, v84
    v_lshlrev_b32 v58, 16, v85
    v_and_b32 v59, s36, v85
    v_lshlrev_b32 v60, 16, v86
    v_and_b32 v61, s36, v86
    v_lshlrev_b32 v62, 16, v87
    v_and_b32 v63, s36, v87
    s_waitcnt lgkmcnt(0)
    v_readfirstlane_b32 s13, v3
    s_nop 1
    s_cmp_lg_u32 s13, s43
    s_cbranch_scc1 fk_other
    v_lshlrev_b32 v3, 12, v15
    s_lshl_b32 s13, s3, 4
    s_add_u32 s13, s13, 0x9000
    s_mov_b64 exec, 0xff
    buffer_store_dword v2, v3, s[24:27], s13 offen sc1
    s_mov_b64 exec, -1
    v_pk_fma_f32 v[64:65], v[48:49], s[4:5], v[10:11] op_sel_hi:[1,0,0] neg_lo:[0,0,1] neg_hi:[0,0,1]
    v_pk_fma_f32 v[66:67], v[50:51], s[4:5], v[10:11] op_sel_hi:[1,0,0] neg_lo:[0,0,1] neg_hi:[0,0,1]
    v_pk_fma_f32 v[68:69], v[52:53], s[4:5], v[10:11] op_sel_hi:[1,0,0] neg_lo:[0,0,1] neg_hi:[0,0,1]
    v_pk_fma_f32 v[70:71], v[54:55], s[4:5], v[10:11] op_sel_hi:[1,0,0] neg_lo:[0,0,1] neg_hi:[0,0,1]
    v_pk_fma_f32 v[72:73], v[56:57], s[4:5], v[10:11] op_sel_hi:[1,0,0] neg_lo:[0,0,1] neg_hi:[0,0,1]
    v_pk_fma_f32 v[74:75], v[58:59], s[4:5], v[10:11] op_sel_hi:[1,0,0] neg_lo:[0,0,1] neg_hi:[0,0,1]
    v_pk_fma_f32 v[76:77], v[60:61], s[4:5], v[10:11] op_sel_hi:[1,0,0] neg_lo:[0,0,1] neg_hi:[0,0,1]
    v_pk_fma_f32 v[78:79], v[62:63], s[4:5], v[10:11] op_sel_hi:[1,0,0] neg_lo:[0,0,1] neg_hi:[0,0,1]
    v_cvt_pk_bf16_f32 v96, v64, v65
    v_cvt_pk_bf16_f32 v97, v66, v67
    v_cvt_pk_bf16_f32 v98, v68, v69
    v_cvt_pk_bf16_f32 v99, v70, v71
    v_cvt_pk_bf16_f32 v100, v72, v73
    v_cvt_pk_bf16_f32 v101, v74, v75
    v_cvt_pk_bf16_f32 v102, v76, v77
    v_cvt_pk_bf16_f32 v103, v78, v79
    v_min_u32 v96, -2, v96
    v_min_u32 v97, -2, v97
    v_min_u32 v98, -2, v98
    v_min_u32 v99, -2, v99
    v_min_u32 v100, -2, v100
    v_min_u32 v101, -2, v101
    v_min_u32 v102, -2, v102
    v_min_u32 v103, -2, v103
    s_lshl_b32 s13, s3, 12
    s_add_u32 s13, s13, 0x80000
    buffer_store_dwordx4 v[96:99], v14, s[24:27], s13 offen sc1
    buffer_store_dwordx4 v[100:103], v14, s[24:27], s13 offen offset:1024 sc1
    v_min_u32 v80, -2, v80
    v_min_u32 v81, -2, v81
    v_min_u32 v82, -2, v82
    v_min_u32 v83, -2, v83
    v_min_u32 v84, -2, v84
    v_min_u32 v85, -2, v85
    v_min_u32 v86, -2, v86
    v_min_u32 v87, -2, v87
    buffer_store_dwordx4 v[80:83], v14, s[24:27], s13 offen offset:2048 sc1
    buffer_store_dwordx4 v[84:87], v14, s[24:27], s13 offen offset:3072 sc1
    v_pk_fma_f32 v[64:65], v[48:49], s[14:15], v[10:11] op_sel_hi:[1,0,0] neg_lo:[0,0,1] neg_hi:[0,0,1]
    v_pk_fma_f32 v[66:67], v[50:51], s[14:15], v[10:11] op_sel_hi:[1,0,0] neg_lo:[0,0,1] neg_hi:[0,0,1]
    v_pk_fma_f32 v[68:69], v[52:53], s[14:15], v[10:11] op_sel_hi:[1,0,0] neg_lo:[0,0,1] neg_hi:[0,0,1]
    v_pk_fma_f32 v[70:71], v[54:55], s[14:15], v[10:11] op_sel_hi:[1,0,0] neg_lo:[0,0,1] neg_hi:[0,0,1]
    v_pk_fma_f32 v[72:73], v[56:57], s[14:15], v[10:11] op_sel_hi:[1,0,0] neg_lo:[0,0,1] neg_hi:[0,0,1]
    v_pk_fma_f32 v[74:75], v[58:59], s[14:15], v[10:11] op_sel_hi:[1,0,0] neg_lo:[0,0,1] neg_hi:[0,0,1]
    v_pk_fma_f32 v[76:77], v[60:61], s[14:15], v[10:11] op_sel_hi:[1,0,0] neg_lo:[0,0,1] neg_hi:[0,0,1]
    v_pk_fma_f32 v[78:79], v[62:63], s[14:15], v[10:11] op_sel_hi:[1,0,0] neg_lo:[0,0,1] neg_hi:[0,0,1]
    v_cvt_pk_bf16_f32 v112, v64, v65
    v_cvt_pk_bf16_f32 v113, v66, v67
    v_cvt_pk_bf16_f32 v114, v68, v69
    v_cvt_pk_bf16_f32 v115, v70, v71
    v_cvt_pk_bf16_f32 v116, v72, v73
    v_cvt_pk_bf16_f32 v117, v74, v75
    v_cvt_pk_bf16_f32 v118, v76, v77
    v_cvt_pk_bf16_f32 v119, v78, v79
    v_lshrrev_b32 v1, 4, v15
    v_bfe_u32 v2, v15, 2, 2
    v_lshl_add_u32 v8, v1, 3, v2
    v_lshlrev_b32 v8, 7, v8
    v_bfe_u32 v9, v15, 1, 1
    s_and_b32 s15, s16, 3
    s_lshl_b32 s15, s15, 1
    v_add_u32 v9, s15, v9
    v_and_b32 v3, 2, v2
    v_xor_b32 v9, v3, v9
    v_and_b32 v3, 1, v1
    v_lshlrev_b32 v4, 2, v3
    v_xor_b32 v9, v4, v9
    v_lshl_add_u32 v8, v9, 4, v8
    v_and_b32 v9, 1, v15
    v_lshl_add_u32 v8, v9, 3, v8
    s_lshr_b32 s15, s16, 2
    s_lshl_b32 s15, s15, 15
    v_add_u32 v8, s15, v8
    v_lshrrev_b32 v7, 1, v1
    v_lshl_add_u32 v7, v7, 3, v2
    v_lshlrev_b32 v7, 9, v7
    v_lshl_add_u32 v7, v3, 5, v7
    v_and_b32 v3, 3, v15
    v_lshl_add_u32 v7, v3, 3, v7
    s_lshl_b32 s15, s16, 6
    s_add_u32 s15, s15, 65536
    v_add_u32 v7, s15, v7
    v_lshlrev_b32 v9, 4, v1
    v_add_u32 v9, 157312, v9
    s_and_b32 s13, s2, 7
    s_lshl_b32 s13, s13, 12
    s_add_u32 s13, s13, 0x9000
    s_mov_b32 s42, 0
    s_waitcnt vmcnt(4)
    v_mov_b32 v1, 157872
    v_mov_b32 v2, 1
    s_mov_b64 exec, 1
    ds_add_u32 v1, v2
    s_mov_b64 exec, -1
    s_nop 1
fk_pollk:
    buffer_load_dword v180, v14, s[24:27], s13 offen offset:0 sc1
    buffer_load_dword v181, v14, s[24:27], s13 offen offset:1024 sc1
    buffer_load_dword v182, v14, s[24:27], s13 offen offset:2048 sc1
    buffer_load_dword v183, v14, s[24:27], s13 offen offset:3072 sc1
    s_add_u32 s42, s42, 1
    s_waitcnt vmcnt(0)
    v_max3_u32 v3, v180, v181, v182
    v_max_u32 v3, v3, v183
    v_cmp_eq_u32 vcc, -1, v3
    s_cmp_gt_u32 s42, 0x40000
    s_cbranch_scc1 fk_gotk
    s_cbranch_vccnz fk_pollk
    s_nop 1
fk_gotk:
    v_max_u32_dpp v3, v3, v3 quad_perm:[1,0,3,2] row_mask:0xf bank_mask:0xf
    s_nop 1
    v_max_u32_dpp v3, v3, v3 quad_perm:[2,3,0,1] row_mask:0xf bank_mask:0xf
    s_nop 1
    v_max_u32_dpp v3, v3, v3 row_half_mirror row_mask:0xf bank_mask:0xf
    s_nop 1
    v_max_u32_dpp v3, v3, v3 row_mirror row_mask:0xf bank_mask:0xf
    s_nop 1
    v_max_u32_dpp v3, v3, v3 row_bcast:15 row_mask:0xa bank_mask:0xf
    s_nop 1
    v_max_u32_dpp v3, v3, v3 row_bcast:31 row_mask:0xc bank_mask:0xf
    s_nop 0
    v_readlane_b32 s40, v3, 63
    v_mov_b32 v4, 157136
    s_nop 0
    s_bfe_u32 s13, s40, 0x80003
    s_lshl_b32 s13, s13, 12
    s_and_b32 s14, s3, 3
    s_lshl_b32 s14, s14, 9
    s_add_u32 s13, s13, s14
    s_add_u32 s13, s13, 0x80000
    v_lshlrev_b32 v5, 3, v15
    v_mov_b32 v3, s40
    s_cmp_gt_u32 s3, 223
    s_cbranch_scc1 fk_norow
    s_mov_b32 s42, 0
    buffer_load_dwordx2 v[180:181], v5, s[24:27], s13 offen sc1
    s_nop 0
fk_landa:
    ds_read_b32 v2, v1
    s_waitcnt lgkmcnt(0)
    v_readfirstlane_b32 s15, v2
    s_nop 1
    s_cmp_lt_u32 s15, 8
    s_cbranch_scc1 fk_landa
    ds_read_b64_tr_b16 v[128:129], v8 offset:0
    ds_read_b64_tr_b16 v[130:131], v8 offset:512
    ds_read_b64_tr_b16 v[132:133], v8 offset:4096
    ds_read_b64_tr_b16 v[134:135], v8 offset:4608
    ds_read_b64_tr_b16 v[136:137], v8 offset:8192
    ds_read_b64_tr_b16 v[138:139], v8 offset:8704
    ds_read_b64_tr_b16 v[140:141], v8 offset:12288
    ds_read_b64_tr_b16 v[142:143], v8 offset:12800
    ds_read_b64_tr_b16 v[144:145], v8 offset:16384
    ds_read_b64_tr_b16 v[146:147], v8 offset:16896
    ds_read_b64_tr_b16 v[148:149], v8 offset:20480
    ds_read_b64_tr_b16 v[150:151], v8 offset:20992
    s_waitcnt lgkmcnt(4)
    ds_read_b64_tr_b16 v[152:153], v8 offset:24576
    ds_read_b64_tr_b16 v[154:155], v8 offset:25088
    ds_read_b64_tr_b16 v[156:157], v8 offset:28672
    ds_read_b64_tr_b16 v[158:159], v8 offset:29184
    s_branch fk_chkr
    s_nop 0
fk_pollr:
    buffer_load_dwordx2 v[180:181], v5, s[24:27], s13 offen sc1
fk_chkr:
    s_add_u32 s42, s42, 1
    s_waitcnt vmcnt(0)
    v_max_u32 v6, v180, v181
    v_cmp_eq_u32 vcc, -1, v6
    s_cmp_gt_u32 s42, 0x40000
    s_cbranch_scc1 fk_gotr
    s_cbranch_vccnz fk_pollr
    s_nop 1
fk_gotr:
    v_add_u32 v5, 157312, v5
    ds_write_b64 v5, v[180:181]
    s_nop 3
fk_norow:
    ds_write_b32 v4, v3
    s_waitcnt lgkmcnt(0)
    s_barrier
    s_cmp_eq_u32 s40, s43
    s_cselect_b32 s22, 0x400000, s22
    s_branch fk_ffn
    s_nop 0
fk_other:
    v_pk_fma_f32 v[64:65], v[48:49], s[14:15], v[10:11] op_sel_hi:[1,0,0] neg_lo:[0,0,1] neg_hi:[0,0,1]
    v_pk_fma_f32 v[66:67], v[50:51], s[14:15], v[10:11] op_sel_hi:[1,0,0] neg_lo:[0,0,1] neg_hi:[0,0,1]
    v_pk_fma_f32 v[68:69], v[52:53], s[14:15], v[10:11] op_sel_hi:[1,0,0] neg_lo:[0,0,1] neg_hi:[0,0,1]
    v_pk_fma_f32 v[70:71], v[54:55], s[14:15], v[10:11] op_sel_hi:[1,0,0] neg_lo:[0,0,1] neg_hi:[0,0,1]
    v_pk_fma_f32 v[72:73], v[56:57], s[14:15], v[10:11] op_sel_hi:[1,0,0] neg_lo:[0,0,1] neg_hi:[0,0,1]
    v_pk_fma_f32 v[74:75], v[58:59], s[14:15], v[10:11] op_sel_hi:[1,0,0] neg_lo:[0,0,1] neg_hi:[0,0,1]
    v_pk_fma_f32 v[76:77], v[60:61], s[14:15], v[10:11] op_sel_hi:[1,0,0] neg_lo:[0,0,1] neg_hi:[0,0,1]
    v_pk_fma_f32 v[78:79], v[62:63], s[14:15], v[10:11] op_sel_hi:[1,0,0] neg_lo:[0,0,1] neg_hi:[0,0,1]
    v_cvt_pk_bf16_f32 v112, v64, v65
    v_cvt_pk_bf16_f32 v113, v66, v67
    v_cvt_pk_bf16_f32 v114, v68, v69
    v_cvt_pk_bf16_f32 v115, v70, v71
    v_cvt_pk_bf16_f32 v116, v72, v73
    v_cvt_pk_bf16_f32 v117, v74, v75
    v_cvt_pk_bf16_f32 v118, v76, v77
    v_cvt_pk_bf16_f32 v119, v78, v79
    s_and_b32 s13, s13, 7
    s_cmp_gt_u32 s16, s13
    s_cselect_b32 s13, 1, 0
    s_sub_u32 s17, s16, s13
    s_waitcnt vmcnt(0)
    v_lshrrev_b32 v1, 4, v15
    v_bfe_u32 v2, v15, 2, 2
    v_lshl_add_u32 v8, v1, 3, v2
    v_lshlrev_b32 v8, 7, v8
    v_bfe_u32 v9, v15, 1, 1
    s_and_b32 s15, s16, 3
    s_lshl_b32 s15, s15, 1
    v_add_u32 v9, s15, v9
    v_and_b32 v3, 2, v2
    v_xor_b32 v9, v3, v9
    v_and_b32 v3, 1, v1
    v_lshlrev_b32 v4, 2, v3
    v_xor_b32 v9, v4, v9
    v_lshl_add_u32 v8, v9, 4, v8
    v_and_b32 v9, 1, v15
    v_lshl_add_u32 v8, v9, 3, v8
    s_lshr_b32 s15, s16, 2
    s_lshl_b32 s15, s15, 15
    v_add_u32 v8, s15, v8
    v_lshrrev_b32 v7, 1, v1
    v_lshl_add_u32 v7, v7, 3, v2
    v_lshlrev_b32 v7, 9, v7
    v_lshl_add_u32 v7, v3, 5, v7
    v_and_b32 v3, 3, v15
    v_lshl_add_u32 v7, v3, 3, v7
    s_lshl_b32 s15, s16, 6
    s_add_u32 s15, s15, 65536
    v_add_u32 v7, s15, v7
    v_lshlrev_b32 v9, 4, v1
    v_add_u32 v9, 157312, v9
    v_mov_b32 v1, 157872
    v_mov_b32 v2, 1
    s_mov_b64 exec, 1
    ds_add_u32 v1, v2
    s_mov_b64 exec, -1
    s_cmp_gt_u32 s3, 223
    s_cbranch_scc1 fk_win3
    s_mul_i32 s15, s17, 4
    s_add_u32 s15, s15, 68
    s_mov_b32 s58, 0x700000
    s_mov_b32 s59, 0x00020000
    s_cmp_gt_u32 s15, 95
    s_cbranch_scc1 fk_win3
    s_lshl_b32 s12, s15, 10
    s_mov_b32 m0, s12
    s_and_b32 s14, s12, 1024
    s_lshr_b32 s14, s14, 4
    v_xor_b32 v209, s14, v208
    s_cmp_lt_u32 s15, 32
    s_cselect_b64 s[56:57], s[44:45], s[48:49]
    s_and_b32 s14, s15, 31
    s_mul_i32 s13, s14, 57344
    s_add_u32 s13, s13, s100
    s_lshl_b32 s14, s14, 12
    s_add_u32 s14, s14, s101
    s_cmp_lt_u32 s15, 64
    s_cselect_b64 s[56:57], s[56:57], s[52:53]
    s_cselect_b32 s13, s13, s14
    s_cselect_b64 vcc, -1, 0
    v_cndmask_b32 v209, v210, v209, vcc
    s_add_u32 s15, s15, 1
    buffer_load_dwordx4 v209, s[56:59], s13 offen lds
    s_cmp_gt_u32 s15, 95
    s_cbranch_scc1 fk_win3
    s_lshl_b32 s12, s15, 10
    s_mov_b32 m0, s12
    s_and_b32 s14, s12, 1024
    s_lshr_b32 s14, s14, 4
    v_xor_b32 v209, s14, v208
    s_cmp_lt_u32 s15, 32
    s_cselect_b64 s[56:57], s[44:45], s[48:49]
    s_and_b32 s14, s15, 31
    s_mul_i32 s13, s14, 57344
    s_add_u32 s13, s13, s100
    s_lshl_b32 s14, s14, 12
    s_add_u32 s14, s14, s101
    s_cmp_lt_u32 s15, 64
    s_cselect_b64 s[56:57], s[56:57], s[52:53]
    s_cselect_b32 s13, s13, s14
    s_cselect_b64 vcc, -1, 0
    v_cndmask_b32 v209, v210, v209, vcc
    s_add_u32 s15, s15, 1
    buffer_load_dwordx4 v209, s[56:59], s13 offen lds
    s_cmp_gt_u32 s15, 95
    s_cbranch_scc1 fk_win3
    s_lshl_b32 s12, s15, 10
    s_mov_b32 m0, s12
    s_and_b32 s14, s12, 1024
    s_lshr_b32 s14, s14, 4
    v_xor_b32 v209, s14, v208
    s_cmp_lt_u32 s15, 32
    s_cselect_b64 s[56:57], s[44:45], s[48:49]
    s_and_b32 s14, s15, 31
    s_mul_i32 s13, s14, 57344
    s_add_u32 s13, s13, s100
    s_lshl_b32 s14, s14, 12
    s_add_u32 s14, s14, s101
    s_cmp_lt_u32 s15, 64
    s_cselect_b64 s[56:57], s[56:57], s[52:53]
    s_cselect_b32 s13, s13, s14
    s_cselect_b64 vcc, -1, 0
    v_cndmask_b32 v209, v210, v209, vcc
    s_add_u32 s15, s15, 1
    buffer_load_dwordx4 v209, s[56:59], s13 offen lds
    s_cmp_gt_u32 s15, 95
    s_cbranch_scc1 fk_win3
    s_lshl_b32 s12, s15, 10
    s_mov_b32 m0, s12
    s_and_b32 s14, s12, 1024
    s_lshr_b32 s14, s14, 4
    v_xor_b32 v209, s14, v208
    s_cmp_lt_u32 s15, 32
    s_cselect_b64 s[56:57], s[44:45], s[48:49]
    s_and_b32 s14, s15, 31
    s_mul_i32 s13, s14, 57344
    s_add_u32 s13, s13, s100
    s_lshl_b32 s14, s14, 12
    s_add_u32 s14, s14, s101
    s_cmp_lt_u32 s15, 64
    s_cselect_b64 s[56:57], s[56:57], s[52:53]
    s_cselect_b32 s13, s13, s14
    s_cselect_b64 vcc, -1, 0
    v_cndmask_b32 v209, v210, v209, vcc
    s_add_u32 s15, s15, 1
    buffer_load_dwordx4 v209, s[56:59], s13 offen lds
    s_nop 2
fk_win3:
fk_landb:
    ds_read_b32 v2, v1
    s_waitcnt lgkmcnt(0)
    v_readfirstlane_b32 s15, v2
    s_nop 1
    s_cmp_lt_u32 s15, 8
    s_cbranch_scc1 fk_landb
    ds_read_b64_tr_b16 v[128:129], v8 offset:0
    ds_read_b64_tr_b16 v[130:131], v8 offset:512
    ds_read_b64_tr_b16 v[132:133], v8 offset:4096
    ds_read_b64_tr_b16 v[134:135], v8 offset:4608
    ds_read_b64_tr_b16 v[136:137], v8 offset:8192
    ds_read_b64_tr_b16 v[138:139], v8 offset:8704
    ds_read_b64_tr_b16 v[140:141], v8 offset:12288
    ds_read_b64_tr_b16 v[142:143], v8 offset:12800
    ds_read_b64_tr_b16 v[144:145], v8 offset:16384
    ds_read_b64_tr_b16 v[146:147], v8 offset:16896
    ds_read_b64_tr_b16 v[148:149], v8 offset:20480
    ds_read_b64_tr_b16 v[150:151], v8 offset:20992
    s_waitcnt lgkmcnt(4)
    ds_read_b64_tr_b16 v[152:153], v8 offset:24576
    ds_read_b64_tr_b16 v[154:155], v8 offset:25088
    ds_read_b64_tr_b16 v[156:157], v8 offset:28672
    ds_read_b64_tr_b16 v[158:159], v8 offset:29184
    s_waitcnt vmcnt(0) lgkmcnt(0)
    s_barrier
    s_nop 0
fk_ffn:
    buffer_store_dwordx4 v[112:115], v14, s[28:31], s22 offen nt
    buffer_store_dwordx4 v[116:119], v14, s[28:31], s22 offen offset:1024 nt
    s_cmp_gt_u32 s3, 223
    s_cbranch_scc1 fk_fin
    ds_read_b128 v[16:19], v9 offset:0
    ds_read_b128 v[20:23], v9 offset:64
    ds_read_b128 v[24:27], v9 offset:128
    ds_read_b128 v[28:31], v9 offset:192
    ds_read_b128 v[32:35], v9 offset:256
    ds_read_b128 v[36:39], v9 offset:320
    ds_read_b128 v[40:43], v9 offset:384
    ds_read_b128 v[44:47], v9 offset:448
    v_mov_b32 v3, 157136
    ds_read_b32 v12, v3
    v_and_b32 v4, 15, v15
    v_lshlrev_b32 v4, 3, v4
    s_lshl_b32 s13, s3, 9
    s_and_b32 s14, s16, 3
    s_lshl_b32 s14, s14, 7
    s_add_u32 s13, s13, s14
    s_lshr_b32 s14, s16, 2
    s_lshl_b32 s14, s14, 2
    s_add_u32 s13, s13, s14
    s_add_u32 s13, s13, 0x13000
    s_waitcnt lgkmcnt(8)
    v_mfma_f32_16x16x32_bf16 v[176:179], v[16:19], v[128:131], 0
    s_waitcnt lgkmcnt(7)
    v_mfma_f32_16x16x32_bf16 v[176:179], v[20:23], v[132:135], v[176:179]
    s_waitcnt lgkmcnt(6)
    v_mfma_f32_16x16x32_bf16 v[176:179], v[24:27], v[136:139], v[176:179]
    s_waitcnt lgkmcnt(5)
    v_mfma_f32_16x16x32_bf16 v[176:179], v[28:31], v[140:143], v[176:179]
    s_waitcnt lgkmcnt(4)
    v_mfma_f32_16x16x32_bf16 v[176:179], v[32:35], v[144:147], v[176:179]
    s_waitcnt lgkmcnt(3)
    v_mfma_f32_16x16x32_bf16 v[176:179], v[36:39], v[148:151], v[176:179]
    s_waitcnt lgkmcnt(2)
    v_mfma_f32_16x16x32_bf16 v[176:179], v[40:43], v[152:155], v[176:179]
    s_waitcnt lgkmcnt(1)
    v_mfma_f32_16x16x32_bf16 v[176:179], v[44:47], v[156:159], v[176:179]
    v_lshlrev_b32 v5, 3, v15
    v_lshlrev_b32 v6, 2, v15
    v_lshrrev_b32 v9, 5, v15
    v_lshlrev_b32 v9, 4, v9
    v_add_u32 v9, 157184, v9
    s_lshl_b32 s41, s3, 10
    s_lshl_b32 s14, s16, 7
    s_add_u32 s41, s41, s14
    s_add_u32 s41, s41, 0x30000
    v_min_u32 v176, -2, v176
    s_mov_b64 exec, 0xffff
    buffer_store_dword v176, v4, s[24:27], s13 offen sc1
    s_mov_b64 exec, -1
    ds_read_b64_tr_b16 v[160:161], v7 offset:0
    ds_read_b64_tr_b16 v[162:163], v7 offset:2048
    ds_read_b64_tr_b16 v[164:165], v7 offset:8192
    ds_read_b64_tr_b16 v[166:167], v7 offset:10240
    ds_read_b64_tr_b16 v[168:169], v7 offset:16384
    ds_read_b64_tr_b16 v[170:171], v7 offset:18432
    ds_read_b64_tr_b16 v[172:173], v7 offset:24576
    ds_read_b64_tr_b16 v[174:175], v7 offset:26624
    s_cmp_eq_u32 s16, 7
    s_cbranch_scc1 fk_c1
    s_cmp_lg_u32 s16, 0
    s_cbranch_scc1 fk_wait1
    s_lshr_b32 s13, s3, 2
    s_lshl_b32 s13, s13, 11
    s_add_u32 s13, s13, 0x13000
    s_mov_b32 s42, 0
    v_lshrrev_b32 v10, 2, v5
    v_add_u32 v10, 157184, v10
    s_waitcnt vmcnt(0)
    s_nop 3
fk_poll1:
    buffer_load_dwordx2 v[184:185], v5, s[24:27], s13 offen offset:0 sc1
    buffer_load_dwordx2 v[186:187], v5, s[24:27], s13 offen offset:512 sc1
    buffer_load_dwordx2 v[188:189], v5, s[24:27], s13 offen offset:1024 sc1
    buffer_load_dwordx2 v[190:191], v5, s[24:27], s13 offen offset:1536 sc1
    s_add_u32 s42, s42, 1
    s_waitcnt vmcnt(0)
    v_max3_u32 v11, v184, v185, v186
    v_max3_u32 v11, v11, v187, v188
    v_max3_u32 v11, v11, v189, v190
    v_max_u32 v11, v11, v191
    v_cmp_eq_u32 vcc, -1, v11
    s_cmp_gt_u32 s42, 0x40000
    s_cbranch_scc1 fk_got1
    s_cbranch_vccnz fk_poll1
    s_nop 1
fk_got1:
    v_pk_add_f32 v[184:185], v[184:185], v[186:187]
    v_pk_add_f32 v[188:189], v[188:189], v[190:191]
    v_pk_add_f32 v[184:185], v[184:185], v[188:189]
    v_cvt_pk_bf16_f32 v184, 0, v184
    v_cvt_pk_bf16_f32 v185, 0, v185
    v_mul_f32 v186, 0xbfb8aa3b, v184
    v_exp_f32 v186, v186
    s_nop 0
    v_add_f32 v186, 1.0, v186
    v_rcp_f32 v186, v186
    s_nop 0
    v_mul_f32 v184, v184, v186
    v_cvt_pk_bf16_f32 v184, 0, v184
    v_mul_f32 v184, v184, v185
    v_cvt_pk_bf16_f32 v184, 0, v184
    ds_write_b16_d16_hi v10, v184
    s_branch fk_wait1
    s_nop 2
fk_c1:
    s_cmp_gt_u32 s3, 127
    s_cbranch_scc1 fk_wait1
    s_waitcnt lgkmcnt(0)
    v_readfirstlane_b32 s40, v12
    v_lshrrev_b32 v10, 4, v15
    v_and_b32 v11, 1, v15
    v_lshl_add_u32 v12, v11, 2, v10
    v_lshlrev_b32 v12, 1, v12
    v_and_b32 v11, 12, v12
    v_and_b32 v10, 1, v10
    s_bfe_u32 s13, s40, 0x80003
    s_lshl_b32 s14, s13, 12
    s_lshl_b32 s15, s3, 4
    s_add_u32 s14, s14, s15
    s_add_u32 s14, s14, 0x80000
    s_mov_b32 s42, 0
    s_nop 0
fk_pollh:
    buffer_load_dword v2, v11, s[24:27], s14 offen sc1
    buffer_load_dword v3, v11, s[24:27], s14 offen offset:2048 sc1
    s_add_u32 s42, s42, 1
    s_waitcnt vmcnt(0)
    v_max_u32 v4, v2, v3
    v_cmp_eq_u32 vcc, -1, v4
    s_cmp_gt_u32 s42, 0x40000
    s_cbranch_scc1 fk_goth
    s_cbranch_vccnz fk_pollh
    s_nop 1
fk_goth:
    v_cmp_eq_u32 vcc, 1, v10
    v_lshlrev_b32 v4, 16, v2
    v_and_b32 v2, s36, v2
    v_cndmask_b32 v2, v4, v2, vcc
    v_lshlrev_b32 v4, 16, v3
    v_and_b32 v3, s36, v3
    v_cndmask_b32 v3, v4, v3, vcc
    s_lshr_b32 s14, s13, 4
    s_add_u32 s14, s14, 1
    s_cmp_ge_u32 s13, 248
    s_cselect_b32 s14, 0, s14
    s_cmp_ge_u32 s13, 240
    s_cselect_b32 s15, 7, 15
    s_and_b32 s15, s15, s13
    s_lshl_b32 s15, s15, 7
    s_add_u32 s14, s14, s15
    s_and_b32 s13, s40, 7
    s_sub_u32 s15, 7, s13
    s_min_u32 s15, s15, s13
    s_lshl_b32 s15, s15, 5
    s_add_u32 s14, s14, s15
    s_sub_u32 s15, 2048, s14
    s_and_b32 s15, s15, 2047
    s_cmp_lt_u32 s13, 4
    s_cselect_b32 s14, s14, s15
    s_and_b32 s13, s40, 0x7ff
    s_cmp_eq_u32 s13, 1991
    s_cselect_b32 s14, 1024, s14
    s_lshl_b32 s21, s14, 11
    s_lshl_b32 s15, s3, 4
    s_add_u32 s21, s21, s15
    s_ashr_i32 s13, s40, 31
    s_not_b32 s13, s13
    s_or_b32 s13, s13, 0x80000000
    s_xor_b32 s13, s40, s13
    s_and_b32 s13, s13, 0xfffff800
    v_mov_b32 v11, s13
    v_cvt_pk_bf16_f32 v11, 0, v11
    v_mul_f32 v11, 0xbfb8aa3b, v11
    v_exp_f32 v11, v11
    s_nop 0
    v_add_f32 v11, 1.0, v11
    v_rcp_f32 v11, v11
    s_nop 0
    v_cvt_pk_bf16_f32 v11, 0, v11
    v_lshrrev_b32 v4, 1, v15
    v_lshlrev_b32 v4, 12, v4
    v_and_b32 v5, 1, v15
    v_lshl_add_u32 v4, v5, 4, v4
    v_add_u32 v5, 131072, v4
    v_cmp_gt_u32 vcc, 48, v15
    s_nop 1
    v_cndmask_b32 v5, -16, v5, vcc
    s_lshl_b32 s40, s3, 5
    s_add_u32 s40, s40, 0x30000
    s_nop 2
fk_wait1:
    s_waitcnt lgkmcnt(0)
    s_barrier
    ds_read_b128 v[16:19], v9 offset:0
    ds_read_b128 v[20:23], v9 offset:32
    ds_read_b128 v[24:27], v9 offset:64
    ds_read_b128 v[28:31], v9 offset:96
    s_waitcnt lgkmcnt(3)
    v_mfma_f32_32x32x16_bf16 v[192:207], v[16:19], v[160:163], 0
    s_waitcnt lgkmcnt(2)
    v_mfma_f32_32x32x16_bf16 v[192:207], v[20:23], v[164:167], v[192:207]
    s_waitcnt lgkmcnt(1)
    v_mfma_f32_32x32x16_bf16 v[192:207], v[24:27], v[168:171], v[192:207]
    s_waitcnt lgkmcnt(0)
    v_mfma_f32_32x32x16_bf16 v[192:207], v[28:31], v[172:175], v[192:207]
    s_nop 11
    v_min_u32 v192, -2, v192
    s_mov_b32 exec_hi, 0
    buffer_store_dword v192, v6, s[24:27], s41 offen sc1
    s_mov_b32 exec_hi, -1
    s_cmp_lg_u32 s16, 7
    s_cbranch_scc1 fk_fin
    s_cmp_gt_u32 s3, 127
    s_cbranch_scc1 fk_fin
    s_mov_b32 s42, 0
    s_waitcnt vmcnt(0)
    s_nop 0
fk_poll2:
    buffer_load_dwordx4 v[16:19], v4, s[24:27], s40 offen sc1
    buffer_load_dwordx4 v[20:23], v5, s[24:27], s40 offen sc1
    s_add_u32 s42, s42, 1
    s_waitcnt vmcnt(0)
    v_max3_u32 v6, v16, v17, v18
    v_max3_u32 v6, v6, v19, v20
    v_max3_u32 v6, v6, v21, v22
    v_max_u32 v6, v6, v23
    v_cmp_eq_u32 vcc, -1, v6
    s_cmp_gt_u32 s42, 0x40000
    s_cbranch_scc1 fk_got2
    s_cbranch_vccnz fk_poll2
    s_nop 1
fk_got2:
    v_pk_add_f32 v[16:17], v[16:17], v[20:21]
    v_pk_add_f32 v[18:19], v[18:19], v[22:23]
    s_nop 1
    v_permlane32_swap_b32 v16, v18
    v_permlane32_swap_b32 v17, v19
    v_add_f32 v16, v16, v18
    v_add_f32 v17, v17, v19
    s_nop 1
    v_permlane16_swap_b32 v16, v17
    v_add_f32 v16, v16, v17
    s_nop 1
    v_add_f32_dpp v16, v16, v16 quad_perm:[2,3,0,1] row_mask:0xf bank_mask:0xf
    s_nop 1
    v_add_f32_dpp v16, v16, v16 row_ror:4 row_mask:0xf bank_mask:0xf
    s_nop 1
    v_add_f32_dpp v16, v16, v16 row_ror:8 row_mask:0xf bank_mask:0xf
    v_cvt_pk_bf16_f32 v16, 0, v16
    v_mul_f32 v16, v16, v11
    v_cvt_pk_bf16_f32 v16, 0, v16
    v_add_f32 v16, v16, v2
    v_cvt_pk_bf16_f32 v16, 0, v16
    v_add_f32 v16, v16, v3
    v_cvt_pk_bf16_f32 v16, 0, v16
    s_mov_b32 exec_lo, 0x00030003
    s_mov_b32 exec_hi, 0x00030003
    buffer_store_short_d16_hi v16, v12, s[28:31], s21 offen
    s_nop 1
fk_fin:
fk_end:
    s_endpgm
.section .rodata,"a"
.p2align 6
.amdhsa_kernel sequential_preLN__spectral_fnet__moe_arch_mod__prompt_kernel
  .amdhsa_next_free_vgpr 256
  .amdhsa_next_free_sgpr 102
  .amdhsa_accum_offset 256
  .amdhsa_group_segment_fixed_size 0
  .amdhsa_kernarg_size 104
  .amdhsa_user_sgpr_count 2
  .amdhsa_user_sgpr_kernarg_segment_ptr 1
  .amdhsa_system_sgpr_workgroup_id_x 1
.end_amdhsa_kernel
```

```asm
; @launch grid=(256,1,1) block=(512,1,1) lds=157888
.amdgcn_target "amdgcn-amd-amdhsa--gfx950"
.text
.globl sequential_preLN__spectral_fnet__moe_arch_mod__prompt_kernel
.p2align 8
.type sequential_preLN__spectral_fnet__moe_arch_mod__prompt_kernel,@function
sequential_preLN__spectral_fnet__moe_arch_mod__prompt_kernel:
    s_cmp_gt_u32 s2, 255
    s_cbranch_scc1 fk_end
    s_load_dwordx2 s[8:9], s[0:1], 0
    s_load_dwordx2 s[24:25], s[0:1], 96
    s_load_dwordx2 s[32:33], s[0:1], 48
    s_load_dwordx2 s[44:45], s[0:1], 56
    s_load_dwordx2 s[48:49], s[0:1], 64
    s_load_dwordx2 s[52:53], s[0:1], 72
    s_load_dwordx2 s[28:29], s[0:1], 80
    s_getpc_b64 s[40:41]
fk_pc:
    s_mov_b32 s42, fk_end-fk_pc
    s_mov_b32 s43, 0x00020000
    v_lshlrev_b32 v250, 6, v0
    buffer_load_dword v251, v250, s[40:43], 0 offen
    v_lshrrev_b32 v1, 6, v0
    v_and_b32 v15, 63, v0
    v_readfirstlane_b32 s16, v1
    s_and_b32 s3, s2, 0xe0
    s_and_b32 s17, s2, 7
    s_lshl_b32 s17, s17, 2
    s_or_b32 s3, s3, s17
    s_bfe_u32 s17, s2, 0x20003
    s_or_b32 s3, s3, s17
    s_lshr_b32 s17, s3, 4
    s_add_u32 s17, s17, 1
    s_cmp_ge_u32 s3, 248
    s_cselect_b32 s17, 0, s17
    s_cmp_ge_u32 s3, 240
    s_cselect_b32 s18, 7, 15
    s_and_b32 s18, s18, s3
    s_lshl_b32 s18, s18, 7
    s_add_u32 s18, s18, s17
    v_and_b32 v1, 31, v15
    v_lshrrev_b32 v2, 5, v15
    v_lshlrev_b32 v14, 4, v15
    s_mov_b32 s10, 0x400000
    s_mov_b32 s11, 0x00020000
    s_mov_b32 s26, 0x690000
    s_mov_b32 s27, 0x00020000
    s_mov_b32 s30, 0x400000
    s_mov_b32 s31, 0x00020000
    s_mov_b32 s34, 0x800
    s_mov_b32 s35, 0x00020000
    s_mov_b32 s46, 0x700000
    s_mov_b32 s47, 0x00020000
    s_mov_b32 s50, 0x700000
    s_mov_b32 s51, 0x00020000
    s_mov_b32 s54, 0x700000
    s_mov_b32 s55, 0x00020000
    s_cmp_ge_u32 s3, 248
    s_cselect_b32 s12, 5, 4
    s_cmp_ge_u32 s16, s12
    s_cbranch_scc1 fk_H
    s_setprio 3
    s_lshl_b32 s19, s16, 5
    s_add_u32 s19, s19, s18
    s_sub_u32 s20, 2048, s19
    s_and_b32 s20, s20, 2047
    s_lshl_b32 s21, s19, 11
    s_lshl_b32 s22, s20, 11
    s_lshl_b32 s12, s16, 12
    s_add_u32 s12, s12, 98304
    s_mov_b32 m0, s12
    v_mov_b32 v16, 0
    v_mov_b32 v17, 0
    v_mov_b32 v18, 0
    v_mov_b32 v19, 0
    v_mov_b32 v20, 0
    v_mov_b32 v21, 0
    v_mov_b32 v22, 0
    v_mov_b32 v23, 0
    v_mov_b32 v24, 0
    v_mov_b32 v25, 0
    v_mov_b32 v26, 0
    v_mov_b32 v27, 0
    v_mov_b32 v28, 0
    v_mov_b32 v29, 0
    v_mov_b32 v30, 0
    v_mov_b32 v31, 0
    v_mov_b32 v32, 0
    v_mov_b32 v33, 0
    v_mov_b32 v34, 0
    v_mov_b32 v35, 0
    v_mov_b32 v36, 0
    v_mov_b32 v37, 0
    v_mov_b32 v38, 0
    v_mov_b32 v39, 0
    v_mov_b32 v40, 0
    v_mov_b32 v41, 0
    v_mov_b32 v42, 0
    v_mov_b32 v43, 0
    v_mov_b32 v44, 0
    v_mov_b32 v45, 0
    v_mov_b32 v46, 0
    v_mov_b32 v47, 0
    v_cvt_f32_u32 v200, v1
    v_lshlrev_b32 v7, 2, v2
    v_cvt_f32_u32 v7, v7
    v_lshrrev_b32 v8, 1, v1
    v_and_b32 v9, 1, v1
    v_lshlrev_b32 v205, 2, v15
    v_and_b32 v205, 63, v205
    v_add_u32 v205, 157824, v205
    ds_write_b32 v205, v16
    s_waitcnt lgkmcnt(0)
    buffer_load_dwordx4 v14, s[8:11], s21 offen lds
    s_add_u32 s13, s12, 1024
    s_mov_b32 m0, s13
    s_add_u32 s14, s21, 1024
    buffer_load_dwordx4 v14, s[8:11], s14 offen lds
    s_add_u32 s13, s12, 2048
    s_mov_b32 m0, s13
    s_nop 0
    buffer_load_dwordx4 v14, s[8:11], s22 offen lds
    s_add_u32 s13, s12, 3072
    s_mov_b32 m0, s13
    s_add_u32 s14, s22, 1024
    buffer_load_dwordx4 v14, s[8:11], s14 offen lds
    s_cmp_lg_u32 s19, 0
    s_cbranch_scc1 fk_no1024
    s_mov_b32 m0, 118784
    s_mov_b32 s14, 2097152
    buffer_load_dwordx4 v14, s[8:11], s14 offen lds
    s_mov_b32 m0, 119808
    s_mov_b32 s14, 2098176
    buffer_load_dwordx4 v14, s[8:11], s14 offen lds
fk_no1024:
    s_barrier
    v_add_u32 v206, 138496, v14
    s_lshl_b32 s13, s16, 2
    s_add_u32 s13, s13, 157824
    v_mov_b32 v201, s13
    v_mov_b32 v202, 1
    s_cmp_eq_u32 s16, 1
    s_cbranch_scc1 fk_j1
    s_cmp_eq_u32 s16, 2
    s_cbranch_scc1 fk_j2
    s_cmp_eq_u32 s16, 3
    s_cbranch_scc1 fk_j3
    s_cmp_eq_u32 s16, 4
    s_cbranch_scc1 fk_jend
    v_cmp_eq_u32 vcc, 1, v1
    s_nop 1
    v_cndmask_b32 v10, v8, 16, vcc
    v_cndmask_b32 v11, v9, 0, vcc
    v_cvt_f32_u32 v10, v10
    v_cvt_f32_u32 v11, v11
    v_mul_f32 v10, 0x3d000000, v10
    v_mul_f32 v11, 0x3e800000, v11
    v_add_f32 v12, v7, v7
    v_fma_f32 v11, v10, v12, v11
    v_mov_b32 v128, v11
    v_fmamk_f32 v129, v10, 0x3f800000, v11
    v_fmamk_f32 v130, v10, 0x40000000, v11
    v_fmamk_f32 v131, v10, 0x40400000, v11
    v_fmamk_f32 v132, v10, 0x40800000, v11
    v_fmamk_f32 v133, v10, 0x40a00000, v11
    v_fmamk_f32 v134, v10, 0x40c00000, v11
    v_fmamk_f32 v135, v10, 0x40e00000, v11
    v_fmamk_f32 v136, v10, 0x41800000, v11
    v_fmamk_f32 v137, v10, 0x41880000, v11
    v_fmamk_f32 v138, v10, 0x41900000, v11
    v_fmamk_f32 v139, v10, 0x41980000, v11
    v_fmamk_f32 v140, v10, 0x41a00000, v11
    v_fmamk_f32 v141, v10, 0x41a80000, v11
    v_fmamk_f32 v142, v10, 0x41b00000, v11
    v_fmamk_f32 v143, v10, 0x41b80000, v11
    v_cos_f32 v144, v128
    v_cos_f32 v145, v129
    v_cos_f32 v146, v130
    v_cos_f32 v147, v131
    v_cos_f32 v148, v132
    v_cos_f32 v149, v133
    v_cos_f32 v150, v134
    v_cos_f32 v151, v135
    v_cos_f32 v152, v136
    v_cos_f32 v153, v137
    v_cos_f32 v154, v138
    v_cos_f32 v155, v139
    v_cos_f32 v156, v140
    v_cos_f32 v157, v141
    v_cos_f32 v158, v142
    v_cos_f32 v159, v143
    v_cvt_pk_f16_f32 v48, v144, v145
    v_cvt_pk_f16_f32 v49, v146, v147
    v_cvt_pk_f16_f32 v50, v148, v149
    v_cvt_pk_f16_f32 v51, v150, v151
    v_cvt_pk_f16_f32 v52, v152, v153
    v_cvt_pk_f16_f32 v53, v154, v155
    v_cvt_pk_f16_f32 v54, v156, v157
    v_cvt_pk_f16_f32 v55, v158, v159
    ds_write_b128 v206, v[48:51] offset:0
    ds_write_b128 v206, v[52:55] offset:1024
    s_branch fk_jsig
    s_nop 1
fk_j1:
    v_cvt_f32_u32 v10, v8
    v_lshlrev_b32 v11, 31, v9
    v_mul_f32 v10, 0x3a800000, v10
    v_xor_b32 v10, v11, v10
    v_mul_f32 v11, v10, v7
    v_mov_b32 v128, v11
    v_fmamk_f32 v129, v10, 0x3f800000, v11
    v_fmamk_f32 v130, v10, 0x40000000, v11
    v_fmamk_f32 v131, v10, 0x40400000, v11
    v_fmamk_f32 v132, v10, 0x41000000, v11
    v_fmamk_f32 v133, v10, 0x41100000, v11
    v_fmamk_f32 v134, v10, 0x41200000, v11
    v_fmamk_f32 v135, v10, 0x41300000, v11
    v_fmamk_f32 v136, v10, 0x41800000, v11
    v_fmamk_f32 v137, v10, 0x41880000, v11
    v_fmamk_f32 v138, v10, 0x41900000, v11
    v_fmamk_f32 v139, v10, 0x41980000, v11
    v_fmamk_f32 v140, v10, 0x41c00000, v11
    v_fmamk_f32 v141, v10, 0x41c80000, v11
    v_fmamk_f32 v142, v10, 0x41d00000, v11
    v_fmamk_f32 v143, v10, 0x41d80000, v11
    v_cos_f32 v56, v128
    v_cos_f32 v57, v129
    v_cos_f32 v58, v130
    v_cos_f32 v59, v131
    v_cos_f32 v60, v132
    v_cos_f32 v61, v133
    v_cos_f32 v62, v134
    v_cos_f32 v63, v135
    v_cos_f32 v64, v136
    v_cos_f32 v65, v137
    v_cos_f32 v66, v138
    v_cos_f32 v67, v139
    v_cos_f32 v68, v140
    v_cos_f32 v69, v141
    v_cos_f32 v70, v142
    v_cos_f32 v71, v143
    ds_write_b128 v206, v[56:59] offset:2048
    ds_write_b128 v206, v[60:63] offset:3072
    ds_write_b128 v206, v[64:67] offset:4096
    ds_write_b128 v206, v[68:71] offset:5120
    v_sin_f32 v72, v128
    v_sin_f32 v73, v129
    v_sin_f32 v74, v130
    v_sin_f32 v75, v131
    v_sin_f32 v76, v132
    v_sin_f32 v77, v133
    v_sin_f32 v78, v134
    v_sin_f32 v79, v135
    v_sin_f32 v80, v136
    v_sin_f32 v81, v137
    v_sin_f32 v82, v138
    v_sin_f32 v83, v139
    v_sin_f32 v84, v140
    v_sin_f32 v85, v141
    v_sin_f32 v86, v142
    v_sin_f32 v87, v143
    ds_write_b128 v206, v[72:75] offset:6144
    ds_write_b128 v206, v[76:79] offset:7168
    ds_write_b128 v206, v[80:83] offset:8192
    ds_write_b128 v206, v[84:87] offset:9216
    s_branch fk_jsig
    s_nop 0
fk_j2:
    v_mul_f32 v128, 0x3d000000, v200
    v_mul_f32 v129, v128, v7
    v_mov_b32 v130, v129
    v_fmamk_f32 v131, v128, 0x3f800000, v129
    v_fmamk_f32 v132, v128, 0x40000000, v129
    v_fmamk_f32 v133, v128, 0x40400000, v129
    v_fmamk_f32 v134, v128, 0x41000000, v129
    v_fmamk_f32 v135, v128, 0x41100000, v129
    v_fmamk_f32 v136, v128, 0x41200000, v129
    v_fmamk_f32 v137, v128, 0x41300000, v129
    v_fmamk_f32 v138, v128, 0x41800000, v129
    v_fmamk_f32 v139, v128, 0x41880000, v129
    v_fmamk_f32 v140, v128, 0x41900000, v129
    v_fmamk_f32 v141, v128, 0x41980000, v129
    v_fmamk_f32 v142, v128, 0x41c00000, v129
    v_fmamk_f32 v143, v128, 0x41c80000, v129
    v_fmamk_f32 v144, v128, 0x41d00000, v129
    v_fmamk_f32 v145, v128, 0x41d80000, v129
    v_cos_f32 v146, v130
    v_cos_f32 v147, v131
    v_cos_f32 v148, v132
    v_cos_f32 v149, v133
    v_cos_f32 v150, v134
    v_cos_f32 v151, v135
    v_cos_f32 v152, v136
    v_cos_f32 v153, v137
    v_cos_f32 v154, v138
    v_cos_f32 v155, v139
    v_cos_f32 v156, v140
    v_cos_f32 v157, v141
    v_cos_f32 v158, v142
    v_cos_f32 v159, v143
    v_cos_f32 v160, v144
    v_cos_f32 v161, v145
    v_cvt_pk_f16_f32 v96, v146, v147
    v_cvt_pk_f16_f32 v97, v148, v149
    v_cvt_pk_f16_f32 v98, v150, v151
    v_cvt_pk_f16_f32 v99, v152, v153
    v_cvt_pk_f16_f32 v100, v154, v155
    v_cvt_pk_f16_f32 v101, v156, v157
    v_cvt_pk_f16_f32 v102, v158, v159
    v_cvt_pk_f16_f32 v103, v160, v161
    v_sin_f32 v146, v130
    v_sin_f32 v147, v131
    v_sin_f32 v148, v132
    v_sin_f32 v149, v133
    v_sin_f32 v150, v134
    v_sin_f32 v151, v135
    v_sin_f32 v152, v136
    v_sin_f32 v153, v137
    v_sin_f32 v154, v138
    v_sin_f32 v155, v139
    v_sin_f32 v156, v140
    v_sin_f32 v157, v141
    v_sin_f32 v158, v142
    v_sin_f32 v159, v143
    v_sin_f32 v160, v144
    v_sin_f32 v161, v145
    v_cvt_pk_f16_f32 v104, v146, v147
    v_cvt_pk_f16_f32 v105, v148, v149
    v_cvt_pk_f16_f32 v106, v150, v151
    v_cvt_pk_f16_f32 v107, v152, v153
    v_cvt_pk_f16_f32 v108, v154, v155
    v_cvt_pk_f16_f32 v109, v156, v157
    v_cvt_pk_f16_f32 v110, v158, v159
    v_cvt_pk_f16_f32 v111, v160, v161
    ds_write_b128 v206, v[96:99] offset:12288
    ds_write_b128 v206, v[100:103] offset:13312
    ds_write_b128 v206, v[104:107] offset:14336
    ds_write_b128 v206, v[108:111] offset:15360
    s_branch fk_jsig
    s_nop 0
fk_j3:
    v_or_b32 v10, 16, v1
    v_cvt_f32_u32 v10, v10
    v_mov_b32 v11, 0x3c800000
    v_fmamk_f32 v10, v10, 0x3d000000, v11
    v_cmp_gt_u32 vcc, 16, v1
    v_mov_b32 v12, 0xbe800000
    s_nop 0
    v_cndmask_b32 v12, 0, v12, vcc
    v_fma_f32 v11, v10, v7, v12
    v_mov_b32 v128, v11
    v_fmamk_f32 v129, v10, 0x3f800000, v11
    v_fmamk_f32 v130, v10, 0x40000000, v11
    v_fmamk_f32 v131, v10, 0x40400000, v11
    v_fmamk_f32 v132, v10, 0x41000000, v11
    v_fmamk_f32 v133, v10, 0x41100000, v11
    v_fmamk_f32 v134, v10, 0x41200000, v11
    v_fmamk_f32 v135, v10, 0x41300000, v11
    v_fmamk_f32 v136, v10, 0x41800000, v11
    v_fmamk_f32 v137, v10, 0x41880000, v11
    v_fmamk_f32 v138, v10, 0x41900000, v11
    v_fmamk_f32 v139, v10, 0x41980000, v11
    v_fmamk_f32 v140, v10, 0x41c00000, v11
    v_fmamk_f32 v141, v10, 0x41c80000, v11
    v_fmamk_f32 v142, v10, 0x41d00000, v11
    v_fmamk_f32 v143, v10, 0x41d80000, v11
    v_cos_f32 v144, v128
    v_cos_f32 v145, v129
    v_cos_f32 v146, v130
    v_cos_f32 v147, v131
    v_cos_f32 v148, v132
    v_cos_f32 v149, v133
    v_cos_f32 v150, v134
    v_cos_f32 v151, v135
    v_cos_f32 v152, v136
    v_cos_f32 v153, v137
    v_cos_f32 v154, v138
    v_cos_f32 v155, v139
    v_cos_f32 v156, v140
    v_cos_f32 v157, v141
    v_cos_f32 v158, v142
    v_cos_f32 v159, v143
    v_cvt_pk_f16_f32 v88, v144, v145
    v_cvt_pk_f16_f32 v89, v146, v147
    v_cvt_pk_f16_f32 v90, v148, v149
    v_cvt_pk_f16_f32 v91, v150, v151
    v_cvt_pk_f16_f32 v92, v152, v153
    v_cvt_pk_f16_f32 v93, v154, v155
    v_cvt_pk_f16_f32 v94, v156, v157
    v_cvt_pk_f16_f32 v95, v158, v159
    ds_write_b128 v206, v[88:91] offset:10240
    ds_write_b128 v206, v[92:95] offset:11264
    s_nop 2
fk_jsig:
    ds_write_b32 v201, v202 offset:32
fk_jend:
    v_lshlrev_b32 v3, 9, v2
    v_lshl_add_u32 v3, v1, 1, v3
    v_sub_u32 v4, 576, v3
    v_sub_u32 v5, 2048, v3
    v_and_b32 v5, 2047, v5
    v_add_u32 v3, s12, v3
    v_add_u32 v4, s12, v4
    v_add_u32 v5, s12, v5
    s_lshl_b32 s13, s16, 10
    s_sub_u32 s14, 7232, s13
    s_cmp_ge_u32 s3, 248
    s_cselect_b32 s15, 1024, 0
    s_add_u32 s14, s14, s15
    s_cmp_eq_u32 s16, 4
    s_cselect_b32 s13, 8256, s13
    s_add_u32 s13, s13, 120832
    s_add_u32 s14, s14, 120832
    v_cmp_gt_u32 vcc, 16, v1
    v_mov_b32 v8, s13
    v_mov_b32 v9, s14
    v_cndmask_b32 v10, v9, v8, vcc
    v_cndmask_b32 v11, v8, v9, vcc
    v_lshl_add_u32 v10, v15, 2, v10
    v_lshl_add_u32 v11, v15, 2, v11
    v_lshrrev_b32 v6, 1, v15
    v_and_b32 v8, 1, v15
    v_mul_u32_u24 v9, 4160, v8
    v_and_b32 v12, 15, v6
    v_lshl_add_u32 v12, v12, 4, v2
    v_mul_u32_u24 v12, 9344, v12
    v_mul_u32_u24 v192, 18688, v8
    v_add_u32 v192, v192, v12
    v_lshl_add_u32 v12, v8, 4, v12
    v_lshrrev_b32 v194, 3, v15
    v_lshlrev_b32 v193, 4, v194
    v_lshl_add_u32 v193, v8, 7, v193
    v_and_b32 v6, 3, v6
    v_lshl_add_u32 v9, v6, 2, v9
    v_lshl_add_u32 v9, v194, 7, v9
    v_lshlrev_b32 v194, 10, v194
    v_and_b32 v6, 7, v15
    v_lshl_add_u32 v194, v6, 4, v194
    s_lshl_b32 s13, s16, 5
    s_add_u32 s13, s13, 120832
    v_add_u32 v6, s13, v9
    s_mul_i32 s36, s3, 9344
    s_lshl_b32 s13, s16, 8
    s_add_u32 s36, s36, s13
    s_add_u32 s36, s36, 0x200000
    s_mul_i32 s37, s16, 37376
    s_add_u32 s37, s37, 0x200000
    s_bfe_u32 s23, s3, 0x30002
    s_lshl_b32 s23, s23, 7
    s_lshr_b32 s12, s3, 5
    s_lshl_b32 s12, s12, 4
    s_add_u32 s23, s23, s12
    s_and_b32 s12, s3, 3
    s_lshl_b32 s12, s12, 2
    s_add_u32 s23, s23, s12
    s_add_u32 s23, s23, 8192
    s_add_u32 s23, s23, s37
    s_lshl_b32 s14, s3, 5
    s_add_u32 s37, s37, s14
    s_add_u32 s38, s37, 18688
    s_lshl_b32 s13, s16, 11
    s_add_u32 s13, s13, 130304
    v_add_u32 v7, s13, v14
    v_cmp_eq_u32 s[58:59], 1, v8
    s_cmp_eq_u32 s19, s20
    s_cselect_b32 s39, 0.5, 1.0
    s_lshl_b32 s13, s16, 2
    s_add_u32 s13, s13, 157056
    v_mov_b32 v9, s13
    s_cmp_ge_u32 s3, 248
    s_cselect_b32 s57, 63, 47
    s_nop 2
fk_spinc:
    ds_read_b32 v203, v205
    s_waitcnt lgkmcnt(0)
    v_cmp_eq_u32 vcc, 0, v203
    s_nop 1
    s_and_b32 s13, vcc_lo, 0xf00
    s_cbranch_scc1 fk_spinc
    ds_read_b128 v[48:51], v206 offset:0
    ds_read_b128 v[52:55], v206 offset:1024
    ds_read_b128 v[56:59], v206 offset:2048
    ds_read_b128 v[60:63], v206 offset:3072
    ds_read_b128 v[64:67], v206 offset:4096
    ds_read_b128 v[68:71], v206 offset:5120
    ds_read_b128 v[72:75], v206 offset:6144
    ds_read_b128 v[76:79], v206 offset:7168
    ds_read_b128 v[80:83], v206 offset:8192
    ds_read_b128 v[84:87], v206 offset:9216
    ds_read_b128 v[88:91], v206 offset:10240
    ds_read_b128 v[92:95], v206 offset:11264
    s_waitcnt lgkmcnt(8)
    ds_read_b128 v[96:99], v206 offset:12288
    ds_read_b128 v[100:103], v206 offset:13312
    ds_read_b128 v[104:107], v206 offset:14336
    ds_read_b128 v[108:111], v206 offset:15360
    s_waitcnt vmcnt(0) lgkmcnt(0)
    ds_read_u16_d16_hi v16, v3 offset:0
    ds_read_u16_d16_hi v17, v3 offset:64
    ds_read_u16_d16_hi v18, v3 offset:128
    ds_read_u16_d16_hi v19, v3 offset:192
    ds_read_u16_d16_hi v20, v3 offset:256
    ds_read_u16_d16_hi v21, v3 offset:320
    ds_read_u16_d16_hi v22, v3 offset:384
    ds_read_u16_d16_hi v23, v3 offset:448
    ds_read_u16_d16_hi v24, v3 offset:1024
    ds_read_u16_d16_hi v25, v3 offset:1088
    ds_read_u16_d16_hi v26, v3 offset:1152
    ds_read_u16_d16_hi v27, v3 offset:1216
    ds_read_u16_d16_hi v28, v3 offset:1280
    ds_read_u16_d16_hi v29, v3 offset:1344
    ds_read_u16_d16_hi v30, v3 offset:1408
    ds_read_u16_d16_hi v31, v3 offset:1472
    s_waitcnt lgkmcnt(2)
    ds_read_u16_d16_hi v32, v5 offset:2048
    ds_read_u16_d16_hi v33, v4 offset:3456
    ds_read_u16_d16_hi v34, v4 offset:3392
    ds_read_u16_d16_hi v35, v4 offset:3328
    ds_read_u16_d16_hi v36, v4 offset:3264
    ds_read_u16_d16_hi v37, v4 offset:3200
    ds_read_u16_d16_hi v38, v4 offset:3136
    ds_read_u16_d16_hi v39, v4 offset:3072
    ds_read_u16_d16_hi v40, v4 offset:2496
    ds_read_u16_d16_hi v41, v4 offset:2432
    ds_read_u16_d16_hi v42, v4 offset:2368
    ds_read_u16_d16_hi v43, v4 offset:2304
    ds_read_u16_d16_hi v44, v4 offset:2240
    s_waitcnt lgkmcnt(8)
    ds_read_u16_d16_hi v45, v4 offset:2176
    ds_read_u16_d16_hi v46, v4 offset:2112
    ds_read_u16_d16_hi v47, v4 offset:2048
    v_pk_add_f32 v[128:129], v[16:17], v[18:19]
    v_pk_add_f32 v[130:131], v[20:21], v[22:23]
    v_pk_add_f32 v[132:133], v[24:25], v[26:27]
    v_pk_add_f32 v[134:135], v[28:29], v[30:31]
    v_pk_mul_f32 v[136:137], v[16:17], v[16:17]
    v_pk_mul_f32 v[138:139], v[18:19], v[18:19]
    v_pk_fma_f32 v[136:137], v[20:21], v[20:21], v[136:137]
    v_pk_fma_f32 v[138:139], v[22:23], v[22:23], v[138:139]
    v_pk_fma_f32 v[136:137], v[24:25], v[24:25], v[136:137]
    v_pk_fma_f32 v[138:139], v[26:27], v[26:27], v[138:139]
    v_pk_fma_f32 v[136:137], v[28:29], v[28:29], v[136:137]
    v_pk_fma_f32 v[138:139], v[30:31], v[30:31], v[138:139]
    v_pk_add_f32 v[128:129], v[128:129], v[130:131]
    v_pk_add_f32 v[132:133], v[132:133], v[134:135]
    v_pk_add_f32 v[136:137], v[136:137], v[138:139]
    v_pk_add_f32 v[128:129], v[128:129], v[132:133]
    v_add_f32 v136, v136, v137
    v_add_f32 v128, v128, v129
    s_waitcnt lgkmcnt(0)
    v_pk_add_f32 v[140:141], v[32:33], v[34:35]
    v_pk_add_f32 v[142:143], v[36:37], v[38:39]
    v_pk_add_f32 v[144:145], v[40:41], v[42:43]
    v_pk_add_f32 v[146:147], v[44:45], v[46:47]
    v_pk_mul_f32 v[148:149], v[32:33], v[32:33]
    v_pk_mul_f32 v[150:151], v[34:35], v[34:35]
    v_pk_fma_f32 v[148:149], v[36:37], v[36:37], v[148:149]
    v_pk_fma_f32 v[150:151], v[38:39], v[38:39], v[150:151]
    v_pk_fma_f32 v[148:149], v[40:41], v[40:41], v[148:149]
    v_pk_fma_f32 v[150:151], v[42:43], v[42:43], v[150:151]
    v_pk_fma_f32 v[148:149], v[44:45], v[44:45], v[148:149]
    v_pk_fma_f32 v[150:151], v[46:47], v[46:47], v[150:151]
    v_pk_add_f32 v[140:141], v[140:141], v[142:143]
    v_pk_add_f32 v[144:145], v[144:145], v[146:147]
    v_pk_add_f32 v[148:149], v[148:149], v[150:151]
    v_pk_add_f32 v[140:141], v[140:141], v[144:145]
    v_add_f32 v148, v148, v149
    v_add_f32 v140, v140, v141
    s_nop 1
    v_permlane32_swap_b32 v128, v140
    v_permlane32_swap_b32 v136, v148
    v_add_f32 v128, v128, v140
    v_add_f32 v136, v136, v148
    s_nop 1
    v_permlane16_swap_b32 v128, v136
    v_add_f32 v128, v128, v136
    s_nop 1
    v_add_f32_dpp v128, v128, v128 quad_perm:[1,0,3,2] row_mask:0xf bank_mask:0xf
    s_nop 1
    v_add_f32_dpp v128, v128, v128 quad_perm:[2,3,0,1] row_mask:0xf bank_mask:0xf
    s_nop 1
    v_add_f32_dpp v128, v128, v128 row_half_mirror row_mask:0xf bank_mask:0xf
    s_nop 1
    v_add_f32_dpp v128, v128, v128 row_mirror row_mask:0xf bank_mask:0xf
    s_nop 1
    v_mov_b32_dpp v129, v128 row_bcast:15 row_mask:0xa bank_mask:0xf
    v_mul_f32 v130, 0x3a800000, v128
    v_mul_f32 v129, 0x3a800000, v129
    v_fma_f32 v130, -v129, v129, v130
    v_max_f32 v130, 0, v130
    v_cvt_pk_bf16_f32 v130, 0, v130
    v_cvt_pk_bf16_f32 v129, 0, v129
    v_add_f32 v130, 0x3727c5ac, v130
    v_cvt_pk_bf16_f32 v130, 0, v130
    v_sqrt_f32 v130, v130
    s_nop 0
    v_cvt_pk_bf16_f32 v130, 0, v130
    v_rcp_f32 v130, v130
    s_nop 0
    v_mul_f32 v130, 0x3d800000, v130
    v_mul_f32 v129, v129, v130
    v_readlane_b32 s4, v130, 16
    v_readlane_b32 s6, v130, 48
    v_readlane_b32 s13, v129, 16
    v_readlane_b32 s14, v129, 48
    s_nop 0
    v_mov_b32 v132, s13
    v_add_f32 v132, s14, v132
    v_pk_fma_f32 v[32:33], v[32:33], s[6:7], v[132:133] op_sel_hi:[1,0,0] neg_lo:[0,0,1] neg_hi:[0,0,1]
    v_pk_fma_f32 v[34:35], v[34:35], s[6:7], v[132:133] op_sel_hi:[1,0,0] neg_lo:[0,0,1] neg_hi:[0,0,1]
    v_pk_fma_f32 v[36:37], v[36:37], s[6:7], v[132:133] op_sel_hi:[1,0,0] neg_lo:[0,0,1] neg_hi:[0,0,1]
    v_pk_fma_f32 v[38:39], v[38:39], s[6:7], v[132:133] op_sel_hi:[1,0,0] neg_lo:[0,0,1] neg_hi:[0,0,1]
    v_pk_fma_f32 v[40:41], v[40:41], s[6:7], v[132:133] op_sel_hi:[1,0,0] neg_lo:[0,0,1] neg_hi:[0,0,1]
    v_pk_fma_f32 v[42:43], v[42:43], s[6:7], v[132:133] op_sel_hi:[1,0,0] neg_lo:[0,0,1] neg_hi:[0,0,1]
    v_pk_fma_f32 v[44:45], v[44:45], s[6:7], v[132:133] op_sel_hi:[1,0,0] neg_lo:[0,0,1] neg_hi:[0,0,1]
    v_pk_fma_f32 v[46:47], v[46:47], s[6:7], v[132:133] op_sel_hi:[1,0,0] neg_lo:[0,0,1] neg_hi:[0,0,1]
    v_pk_fma_f32 v[16:17], v[16:17], s[4:5], v[32:33] op_sel_hi:[1,0,1]
    v_pk_fma_f32 v[18:19], v[18:19], s[4:5], v[34:35] op_sel_hi:[1,0,1]
    v_pk_fma_f32 v[20:21], v[20:21], s[4:5], v[36:37] op_sel_hi:[1,0,1]
    v_pk_fma_f32 v[22:23], v[22:23], s[4:5], v[38:39] op_sel_hi:[1,0,1]
    v_pk_fma_f32 v[24:25], v[24:25], s[4:5], v[40:41] op_sel_hi:[1,0,1]
    v_pk_fma_f32 v[26:27], v[26:27], s[4:5], v[42:43] op_sel_hi:[1,0,1]
    v_pk_fma_f32 v[28:29], v[28:29], s[4:5], v[44:45] op_sel_hi:[1,0,1]
    v_pk_fma_f32 v[30:31], v[30:31], s[4:5], v[46:47] op_sel_hi:[1,0,1]
    v_cvt_pk_f16_f32 v176, v16, v17
    v_cvt_pk_f16_f32 v177, v18, v19
    v_cvt_pk_f16_f32 v178, v20, v21
    v_cvt_pk_f16_f32 v179, v22, v23
    v_cvt_pk_f16_f32 v180, v24, v25
    v_cvt_pk_f16_f32 v181, v26, v27
    v_cvt_pk_f16_f32 v182, v28, v29
    v_cvt_pk_f16_f32 v183, v30, v31
    v_mfma_f32_32x32x16_f16 v[112:127], v[176:179], v[48:51], 0
    s_nop 0
    v_mfma_f32_32x32x16_f16 v[112:127], v[180:183], v[52:55], v[112:127]
    s_nop 11
    v_pk_mul_f32 v[16:17], v[112:113], v[56:57]
    v_pk_mul_f32 v[18:19], v[114:115], v[58:59]
    v_pk_mul_f32 v[20:21], v[116:117], v[60:61]
    v_pk_mul_f32 v[22:23], v[118:119], v[62:63]
    v_pk_mul_f32 v[24:25], v[120:121], v[64:65]
    v_pk_mul_f32 v[26:27], v[122:123], v[66:67]
    v_pk_mul_f32 v[28:29], v[124:125], v[68:69]
    v_pk_mul_f32 v[30:31], v[126:127], v[70:71]
    v_fmac_f32_dpp v16, v112, v72 quad_perm:[1,0,3,2] row_mask:0xf bank_mask:0xf
    v_fmac_f32_dpp v17, v113, v73 quad_perm:[1,0,3,2] row_mask:0xf bank_mask:0xf
    v_fmac_f32_dpp v18, v114, v74 quad_perm:[1,0,3,2] row_mask:0xf bank_mask:0xf
    v_fmac_f32_dpp v19, v115, v75 quad_perm:[1,0,3,2] row_mask:0xf bank_mask:0xf
    v_fmac_f32_dpp v20, v116, v76 quad_perm:[1,0,3,2] row_mask:0xf bank_mask:0xf
    v_fmac_f32_dpp v21, v117, v77 quad_perm:[1,0,3,2] row_mask:0xf bank_mask:0xf
    v_fmac_f32_dpp v22, v118, v78 quad_perm:[1,0,3,2] row_mask:0xf bank_mask:0xf
    v_fmac_f32_dpp v23, v119, v79 quad_perm:[1,0,3,2] row_mask:0xf bank_mask:0xf
    v_cvt_pk_f16_f32 v176, v16, v17
    v_cvt_pk_f16_f32 v177, v18, v19
    v_cvt_pk_f16_f32 v178, v20, v21
    v_cvt_pk_f16_f32 v179, v22, v23
    v_fmac_f32_dpp v24, v120, v80 quad_perm:[1,0,3,2] row_mask:0xf bank_mask:0xf
    v_fmac_f32_dpp v25, v121, v81 quad_perm:[1,0,3,2] row_mask:0xf bank_mask:0xf
    v_mfma_f32_32x32x16_f16 v[128:143], v[176:179], v[96:99], 0
    v_fmac_f32_dpp v26, v122, v82 quad_perm:[1,0,3,2] row_mask:0xf bank_mask:0xf
    v_fmac_f32_dpp v27, v123, v83 quad_perm:[1,0,3,2] row_mask:0xf bank_mask:0xf
    v_fmac_f32_dpp v28, v124, v84 quad_perm:[1,0,3,2] row_mask:0xf bank_mask:0xf
    v_fmac_f32_dpp v29, v125, v85 quad_perm:[1,0,3,2] row_mask:0xf bank_mask:0xf
    v_mfma_f32_32x32x16_f16 v[144:159], v[176:179], v[104:107], 0
    v_fmac_f32_dpp v30, v126, v86 quad_perm:[1,0,3,2] row_mask:0xf bank_mask:0xf
    v_fmac_f32_dpp v31, v127, v87 quad_perm:[1,0,3,2] row_mask:0xf bank_mask:0xf
    v_cvt_pk_f16_f32 v180, v24, v25
    v_cvt_pk_f16_f32 v181, v26, v27
    v_mfma_f32_32x32x16_f16 v[160:175], v[176:179], v[88:91], 0
    v_cvt_pk_f16_f32 v182, v28, v29
    v_cvt_pk_f16_f32 v183, v30, v31
    s_nop 1
    v_mfma_f32_32x32x16_f16 v[128:143], v[180:183], v[100:103], v[128:143]
    v_mfma_f32_32x32x16_f16 v[144:159], v[180:183], v[108:111], v[144:159]
    v_mfma_f32_32x32x16_f16 v[160:175], v[180:183], v[92:95], v[160:175]
    v_cmp_gt_u32 vcc, 16, v15
    v_cmp_gt_u32 s[40:41], 32, v15
    s_nop 8
    v_pk_add_f32 v[20:21], v[132:133], v[148:149] op_sel:[0,1] op_sel_hi:[1,0] neg_hi:[0,1]
    v_pk_add_f32 v[22:23], v[134:135], v[150:151] op_sel:[0,1] op_sel_hi:[1,0] neg_hi:[0,1]
    v_pk_add_f32 v[36:37], v[20:21], v[22:23] op_sel:[0,1] op_sel_hi:[1,0] neg_lo:[0,1]
    v_pk_add_f32 v[38:39], v[20:21], v[22:23] op_sel:[0,1] op_sel_hi:[1,0] neg_hi:[1,0]
    v_cvt_pk_f16_f32 v178, v36, v37
    v_cvt_pk_f16_f32 v179, v38, v39
    ds_write_b32 v10, v178 offset:256
    ds_write_b32 v11, v179 offset:256
    v_pk_add_f32 v[24:25], v[136:137], v[152:153] op_sel:[0,1] op_sel_hi:[1,0] neg_hi:[0,1]
    v_pk_add_f32 v[26:27], v[138:139], v[154:155] op_sel:[0,1] op_sel_hi:[1,0] neg_hi:[0,1]
    v_pk_add_f32 v[40:41], v[24:25], v[26:27] op_sel:[0,1] op_sel_hi:[1,0] neg_lo:[0,1]
    v_pk_add_f32 v[42:43], v[24:25], v[26:27] op_sel:[0,1] op_sel_hi:[1,0] neg_hi:[1,0]
    v_cvt_pk_f16_f32 v180, v40, v41
    v_cvt_pk_f16_f32 v181, v42, v43
    ds_write_b32 v10, v180 offset:512
    ds_write_b32 v11, v181 offset:512
    v_pk_add_f32 v[28:29], v[140:141], v[156:157] op_sel:[0,1] op_sel_hi:[1,0] neg_hi:[0,1]
    v_pk_add_f32 v[30:31], v[142:143], v[158:159] op_sel:[0,1] op_sel_hi:[1,0] neg_hi:[0,1]
    v_pk_add_f32 v[44:45], v[28:29], v[30:31] op_sel:[0,1] op_sel_hi:[1,0] neg_lo:[0,1]
    v_pk_add_f32 v[46:47], v[28:29], v[30:31] op_sel:[0,1] op_sel_hi:[1,0] neg_hi:[1,0]
    v_cvt_pk_f16_f32 v182, v44, v45
    v_cvt_pk_f16_f32 v183, v46, v47
    ds_write_b32 v10, v182 offset:768
    ds_write_b32 v11, v183 offset:768
    v_pk_add_f32 v[16:17], v[128:129], v[144:145] op_sel:[0,1] op_sel_hi:[1,0] neg_hi:[0,1]
    v_pk_add_f32 v[18:19], v[130:131], v[146:147] op_sel:[0,1] op_sel_hi:[1,0] neg_hi:[0,1]
    v_mul_f32 v8, s39, v128
    v_mov_b32 v3, v161
    s_nop 1
    v_permlane16_swap_b32 v4, v3
    v_cndmask_b32 v5, v161, v128, vcc
    v_cndmask_b32 v4, v4, v144, vcc
    v_cndmask_b32 v16, v16, v5, s[40:41]
    v_cndmask_b32 v17, v17, -v4, s[40:41]
    v_pk_add_f32 v[32:33], v[16:17], v[18:19] op_sel:[0,1] op_sel_hi:[1,0] neg_lo:[0,1]
    v_pk_add_f32 v[34:35], v[16:17], v[18:19] op_sel:[0,1] op_sel_hi:[1,0] neg_hi:[1,0]
    v_cvt_pk_f16_f32 v176, v32, v33
    v_cvt_pk_f16_f32 v177, v34, v35
    ds_write_b32 v10, v176 offset:0
    ds_write_b32 v11, v177 offset:0
    s_mov_b64 exec, 0x10000
    ds_write_b32 v9, v8
    ds_write_b32 v201, v202
    s_mov_b64 exec, -1
    s_cmp_eq_u32 s16, 4
    s_cbranch_scc1 fk_w4
    s_nop 0
fk_spin:
    ds_read_b32 v3, v205
    s_waitcnt lgkmcnt(0)
    v_cmp_eq_u32 vcc, 0, v3
    s_nop 1
    s_and_b32 s13, vcc_lo, s57
    s_cbranch_scc1 fk_spin
    s_nop 0
fk_staged:
    ds_read2st64_b32 v[184:185], v6 offset0:0 offset1:4
    ds_read2st64_b32 v[186:187], v6 offset0:8 offset1:12
    v_add_u32 v8, 16, v6
    ds_read2st64_b32 v[188:189], v8 offset0:0 offset1:4
    ds_read2st64_b32 v[190:191], v8 offset0:8 offset1:12
    v_readlane_b32 s43, v3, 7
    s_waitcnt lgkmcnt(2)
    buffer_store_dwordx4 v[184:187], v194, s[24:27], s36 offen offset:0 sc1
    s_waitcnt lgkmcnt(0)
    buffer_store_dwordx4 v[188:191], v194, s[24:27], s36 offen offset:128 sc1
    v_add3_u32 v3, v184, v185, v186
    v_add_u32 v3, v3, v187
    v_add3_u32 v4, v188, v189, v190
    v_add_u32 v4, v4, v191
    s_add_u32 s36, s36, 8192
    v_add_u32_dpp v3, v3, v3 quad_perm:[1,0,3,2] row_mask:0xf bank_mask:0xf
    v_add_u32_dpp v4, v4, v4 quad_perm:[1,0,3,2] row_mask:0xf bank_mask:0xf
    v_cndmask_b32 v3, v3, v4, s[58:59]
    v_add_u32 v196, s43, v3
    s_nop 1
    v_mov_b32_dpp v197, v196 row_shl:2 row_mask:0xf bank_mask:0xf
    v_mov_b32_dpp v198, v196 row_shl:4 row_mask:0xf bank_mask:0xf
    v_mov_b32_dpp v199, v196 row_shl:6 row_mask:0xf bank_mask:0xf
    s_mov_b32 exec_lo, 0x03030303
    s_mov_b32 exec_hi, 0x03030303
    buffer_store_dwordx4 v[196:199], v193, s[24:27], s36 offen sc1
    s_mov_b64 exec, -1
    s_cmp_lg_u32 s16, 0
    s_cbranch_scc1 fk_nog5
    v_and_b32 v9, 16, v14
    v_add_u32 v9, 157056, v9
    ds_read_b128 v[16:19], v9
    s_lshl_b32 s13, s3, 4
    s_add_u32 s13, s13, 0x11000
    s_waitcnt lgkmcnt(0)
    v_min_u32 v16, -2, v16
    v_min_u32 v17, -2, v17
    v_min_u32 v18, -2, v18
    v_min_u32 v19, -2, v19
    s_cmp_eq_u32 s3, 255
    s_cselect_b64 exec, 3, 1
    buffer_store_dwordx4 v[16:19], v14, s[24:27], s13 offen sc1
    s_mov_b64 exec, -1
    s_nop 0
fk_nog5:
    v_lshrrev_b32 v208, 3, v15
    v_and_b32 v209, 7, v15
    v_and_b32 v210, 2, v208
    v_xor_b32 v209, v210, v209
    v_mul_u32_u24 v208, 7168, v208
    v_lshl_add_u32 v208, v209, 4, v208
    v_lshrrev_b32 v210, 5, v15
    v_lshlrev_b32 v210, 11, v210
    v_and_b32 v209, 31, v15
    v_lshl_add_u32 v210, v209, 4, v210
    s_and_b32 s12, s3, 3
    s_mul_i32 s100, s12, 1835008
    s_lshl_b32 s101, s12, 9
    s_lshr_b32 s12, s3, 2
    s_lshl_b32 s12, s12, 7
    s_add_u32 s100, s100, s12
    s_lshl_b32 s12, s12, 10
    s_add_u32 s101, s101, s12
    s_mov_b32 s42, 0
    s_waitcnt vmcnt(0)
    s_nop 0
fk_pollw:
    buffer_load_dwordx4 v[184:187], v12, s[24:27], s37 offen sc1
    buffer_load_dwordx4 v[188:191], v12, s[24:27], s38 offen sc1
    buffer_load_dword v5, v192, s[24:27], s23 offen sc1
    s_waitcnt vmcnt(1)
    v_add3_u32 v3, v184, v185, v186
    v_add_u32 v3, v3, v187
    v_add3_u32 v4, v188, v189, v190
    v_add_u32 v4, v4, v191
    ds_write_b128 v7, v[184:187]
    v_add_u32_dpp v3, v3, v3 quad_perm:[1,0,3,2] row_mask:0xf bank_mask:0xf
    v_add_u32_dpp v4, v4, v4 quad_perm:[1,0,3,2] row_mask:0xf bank_mask:0xf
    ds_write_b128 v7, v[188:191] offset:1024
    v_cndmask_b32 v3, v3, v4, s[58:59]
    v_add_u32 v3, s43, v3
    s_waitcnt vmcnt(0)
    v_cmp_ne_u32 vcc, v3, v5
    s_add_u32 s42, s42, 1
    s_cmp_gt_u32 s42, 0x40000
    s_cbranch_scc1 fk_gotw
    s_cbranch_vccnz fk_pollw
    s_nop 0
fk_gotw:
    s_waitcnt lgkmcnt(0)
    s_barrier
    s_setprio 0
    s_or_b32 s13, s3, s16
    s_cbranch_scc1 fk_nobump
    v_mov_b32 v3, s43
    s_mov_b64 exec, 1
    buffer_store_dword v3, v14, s[24:27], 0 offen sc1
    s_mov_b64 exec, -1
    s_nop 1
fk_nobump:
    s_lshl_b32 s13, s16, 10
    s_add_u32 s14, s13, 0x11000
    s_add_u32 s13, s13, 114688
    v_add_u32 v7, s13, v14
    v_mov_b32 v3, 4096
    s_mov_b32 s15, 0x11000
    v_mov_b32 v8, 157152
    buffer_load_dwordx4 v[184:187], v14, s[24:27], s14 offen sc1
    buffer_load_dword v188, v3, s[24:27], s15 offen sc1
    s_mov_b32 s40, s14
    s_mov_b32 s41, s15
    s_cmp_gt_u32 s3, 223
    s_cbranch_scc1 fk_win1
    s_mul_i32 s15, s16, 4
    s_add_u32 s15, s15, 12
    s_mov_b32 s58, 0x700000
    s_mov_b32 s59, 0x00020000
    s_cmp_gt_u32 s15, 95
    s_cbranch_scc1 fk_win1
    s_lshl_b32 s12, s15, 10
    s_mov_b32 m0, s12
    s_and_b32 s14, s12, 1024
    s_lshr_b32 s14, s14, 4
    v_xor_b32 v209, s14, v208
    s_cmp_lt_u32 s15, 32
    s_cselect_b64 s[56:57], s[44:45], s[48:49]
    s_and_b32 s14, s15, 31
    s_mul_i32 s13, s14, 57344
    s_add_u32 s13, s13, s100
    s_lshl_b32 s14, s14, 12
    s_add_u32 s14, s14, s101
    s_cmp_lt_u32 s15, 64
    s_cselect_b64 s[56:57], s[56:57], s[52:53]
    s_cselect_b32 s13, s13, s14
    s_cselect_b64 vcc, -1, 0
    v_cndmask_b32 v209, v210, v209, vcc
    s_add_u32 s15, s15, 1
    buffer_load_dwordx4 v209, s[56:59], s13 offen lds
    s_cmp_gt_u32 s15, 95
    s_cbranch_scc1 fk_win1
    s_lshl_b32 s12, s15, 10
    s_mov_b32 m0, s12
    s_and_b32 s14, s12, 1024
    s_lshr_b32 s14, s14, 4
    v_xor_b32 v209, s14, v208
    s_cmp_lt_u32 s15, 32
    s_cselect_b64 s[56:57], s[44:45], s[48:49]
    s_and_b32 s14, s15, 31
    s_mul_i32 s13, s14, 57344
    s_add_u32 s13, s13, s100
    s_lshl_b32 s14, s14, 12
    s_add_u32 s14, s14, s101
    s_cmp_lt_u32 s15, 64
    s_cselect_b64 s[56:57], s[56:57], s[52:53]
    s_cselect_b32 s13, s13, s14
    s_cselect_b64 vcc, -1, 0
    v_cndmask_b32 v209, v210, v209, vcc
    s_add_u32 s15, s15, 1
    buffer_load_dwordx4 v209, s[56:59], s13 offen lds
    s_cmp_gt_u32 s15, 95
    s_cbranch_scc1 fk_win1
    s_lshl_b32 s12, s15, 10
    s_mov_b32 m0, s12
    s_and_b32 s14, s12, 1024
    s_lshr_b32 s14, s14, 4
    v_xor_b32 v209, s14, v208
    s_cmp_lt_u32 s15, 32
    s_cselect_b64 s[56:57], s[44:45], s[48:49]
    s_and_b32 s14, s15, 31
    s_mul_i32 s13, s14, 57344
    s_add_u32 s13, s13, s100
    s_lshl_b32 s14, s14, 12
    s_add_u32 s14, s14, s101
    s_cmp_lt_u32 s15, 64
    s_cselect_b64 s[56:57], s[56:57], s[52:53]
    s_cselect_b32 s13, s13, s14
    s_cselect_b64 vcc, -1, 0
    v_cndmask_b32 v209, v210, v209, vcc
    s_add_u32 s15, s15, 1
    buffer_load_dwordx4 v209, s[56:59], s13 offen lds
    s_cmp_gt_u32 s15, 95
    s_cbranch_scc1 fk_win1
    s_lshl_b32 s12, s15, 10
    s_mov_b32 m0, s12
    s_and_b32 s14, s12, 1024
    s_lshr_b32 s14, s14, 4
    v_xor_b32 v209, s14, v208
    s_cmp_lt_u32 s15, 32
    s_cselect_b64 s[56:57], s[44:45], s[48:49]
    s_and_b32 s14, s15, 31
    s_mul_i32 s13, s14, 57344
    s_add_u32 s13, s13, s100
    s_lshl_b32 s14, s14, 12
    s_add_u32 s14, s14, s101
    s_cmp_lt_u32 s15, 64
    s_cselect_b64 s[56:57], s[56:57], s[52:53]
    s_cselect_b32 s13, s13, s14
    s_cselect_b64 vcc, -1, 0
    v_cndmask_b32 v209, v210, v209, vcc
    s_add_u32 s15, s15, 1
    buffer_load_dwordx4 v209, s[56:59], s13 offen lds
    s_nop 2
fk_win1:
    s_mov_b32 s42, 0
    s_cmp_gt_u32 s3, 223
    s_cbranch_scc1 fk_pollg
    s_waitcnt vmcnt(4)
    s_branch fk_chkg
    s_nop 0
fk_pollg:
    buffer_load_dwordx4 v[184:187], v14, s[24:27], s40 offen sc1
    buffer_load_dword v188, v3, s[24:27], s41 offen sc1
    s_waitcnt vmcnt(0)
    s_nop 0
fk_chkg:
    s_add_u32 s42, s42, 1
    v_max3_u32 v4, v184, v185, v186
    v_max3_u32 v4, v4, v187, v188
    v_cmp_eq_u32 vcc, -1, v4
    s_cmp_gt_u32 s42, 0x40000
    s_cbranch_scc1 fk_gotg
    s_cbranch_vccnz fk_pollg
    s_nop 1
fk_gotg:
    ds_write_b128 v7, v[184:187]
    ds_write_b32 v8, v188
    s_branch fk_common
    s_nop 0
fk_w4:
    s_setprio 0
    s_branch fk_Hconst
    s_nop 0
fk_H:
    s_barrier
    s_cmp_lg_u32 s16, 7
    s_cbranch_scc1 fk_Hconst
    v_mov_b32 v4, -1
    v_mov_b32 v5, -1
    v_mov_b32 v6, -1
    v_mov_b32 v7, -1
    v_mov_b32 v3, 157120
    v_mov_b32 v8, 0
    ds_write_b32 v3, v8
    v_lshlrev_b32 v3, 12, v15
    s_lshl_b32 s13, s3, 4
    s_add_u32 s14, s13, 0x9000
    s_add_u32 s15, s13, 0x11000
    v_mov_b32 v201, 157844
    v_mov_b32 v204, 1
    s_waitcnt lgkmcnt(0)
    s_load_dword s56, s[24:25], 0
    s_mul_i32 s38, s3, 9344
    s_add_u32 s38, s38, 0x448000
    s_add_u32 s39, s38, 4096
    buffer_store_dwordx4 v[4:7], v14, s[24:27], s38 offen offset:0 sc1
    buffer_store_dwordx4 v[4:7], v14, s[24:27], s38 offen offset:1024 sc1
    buffer_store_dwordx4 v[4:7], v14, s[24:27], s38 offen offset:2048 sc1
    buffer_store_dwordx4 v[4:7], v14, s[24:27], s38 offen offset:3072 sc1
    buffer_store_dwordx4 v[4:7], v14, s[24:27], s39 offen offset:0 sc1
    buffer_store_dwordx4 v[4:7], v14, s[24:27], s39 offen offset:1024 sc1
    buffer_store_dwordx4 v[4:7], v14, s[24:27], s39 offen offset:2048 sc1
    buffer_store_dwordx4 v[4:7], v14, s[24:27], s39 offen offset:3072 sc1
    s_lshl_b32 s12, s3, 12
    s_add_u32 s12, s12, 0x80000
    buffer_store_dwordx4 v[4:7], v14, s[24:27], s12 offen offset:0 sc1
    buffer_store_dwordx4 v[4:7], v14, s[24:27], s12 offen offset:1024 sc1
    buffer_store_dwordx4 v[4:7], v14, s[24:27], s12 offen offset:2048 sc1
    buffer_store_dwordx4 v[4:7], v14, s[24:27], s12 offen offset:3072 sc1
    s_lshl_b32 s12, s3, 10
    s_add_u32 s12, s12, 0x30000
    s_cmp_gt_u32 s3, 223
    s_cselect_b32 s12, 0x690000, s12
    buffer_store_dwordx4 v[4:7], v14, s[24:27], s12 offen sc1
    s_lshl_b32 s12, s3, 9
    s_add_u32 s12, s12, 0x13000
    s_cmp_gt_u32 s3, 223
    s_cselect_b32 s12, 0x690000, s12
    s_mov_b32 exec_hi, 0
    buffer_store_dwordx4 v[4:7], v14, s[24:27], s12 offen sc1
    s_mov_b32 exec_lo, 0xff
    buffer_store_dwordx4 v[4:7], v3, s[24:27], s14 offen sc1
    s_mov_b32 exec_hi, 0
    s_cmp_eq_u32 s3, 255
    s_cselect_b32 exec_lo, 3, 1
    buffer_store_dwordx4 v[4:7], v14, s[24:27], s15 offen sc1
    s_mov_b64 exec, -1
    s_mov_b32 m0, 155008
    s_mov_b32 s12, 0
    buffer_load_dwordx4 v14, s[32:35], s12 offen lds
    s_mov_b32 m0, 156032
    s_mov_b32 s12, 1024
    buffer_load_dwordx4 v14, s[32:35], s12 offen lds
    s_waitcnt lgkmcnt(0)
    s_add_u32 s56, s56, 1
    v_mov_b32 v202, s56
    ds_write_b32 v201, v202 offset:8
    s_waitcnt vmcnt(0)
    ds_write_b32 v201, v204
    s_nop 1
fk_Hconst:
    s_sub_u32 s20, s16, 4
    v_lshrrev_b32 v208, 3, v15
    v_and_b32 v209, 7, v15
    v_and_b32 v210, 2, v208
    v_xor_b32 v209, v210, v209
    v_mul_u32_u24 v208, 7168, v208
    v_lshl_add_u32 v208, v209, 4, v208
    v_lshrrev_b32 v210, 5, v15
    v_lshlrev_b32 v210, 11, v210
    v_and_b32 v209, 31, v15
    v_lshl_add_u32 v210, v209, 4, v210
    s_and_b32 s12, s3, 3
    s_mul_i32 s100, s12, 1835008
    s_lshl_b32 s101, s12, 9
    s_lshr_b32 s12, s3, 2
    s_lshl_b32 s12, s12, 7
    s_add_u32 s100, s100, s12
    s_lshl_b32 s12, s12, 10
    s_add_u32 s101, s101, s12
    s_and_b32 s12, s20, 1
    s_lshl_b32 s12, s12, 6
    v_xor_b32 v206, s12, v208
    v_xor_b32 v207, 64, v206
    s_mov_b32 s6, 0x700000
    s_mov_b32 s7, 0x00020000
    s_cmp_gt_u32 s3, 223
    s_cselect_b32 s36, 3, s20
    s_waitcnt lgkmcnt(0)
    s_cmp_eq_u32 s36, 3
    s_cbranch_scc1 fk_gu0
    s_add_u32 s37, s20, 0
    s_lshl_b32 s12, s37, 10
    s_mov_b32 m0, s12
    s_cmp_lt_u32 s37, 32
    s_cselect_b64 s[4:5], s[44:45], s[48:49]
    s_and_b32 s37, s37, 31
    s_mul_i32 s37, s37, 57344
    s_add_u32 s37, s37, s100
    buffer_load_dwordx4 v206, s[4:7], s37 offen lds
fk_gu0:
    s_cmp_eq_u32 s36, 3
    s_cbranch_scc1 fk_gu1
    s_add_u32 s37, s20, 3
    s_lshl_b32 s12, s37, 10
    s_mov_b32 m0, s12
    s_cmp_lt_u32 s37, 32
    s_cselect_b64 s[4:5], s[44:45], s[48:49]
    s_and_b32 s37, s37, 31
    s_mul_i32 s37, s37, 57344
    s_add_u32 s37, s37, s100
    buffer_load_dwordx4 v207, s[4:7], s37 offen lds
fk_gu1:
    s_cmp_eq_u32 s36, 3
    s_cbranch_scc1 fk_gu2
    s_add_u32 s37, s20, 6
    s_lshl_b32 s12, s37, 10
    s_mov_b32 m0, s12
    s_cmp_lt_u32 s37, 32
    s_cselect_b64 s[4:5], s[44:45], s[48:49]
    s_and_b32 s37, s37, 31
    s_mul_i32 s37, s37, 57344
    s_add_u32 s37, s37, s100
    buffer_load_dwordx4 v206, s[4:7], s37 offen lds
fk_gu2:
    s_cmp_eq_u32 s36, 3
    s_cbranch_scc1 fk_gu3
    s_add_u32 s37, s20, 9
    s_lshl_b32 s12, s37, 10
    s_mov_b32 m0, s12
    s_cmp_lt_u32 s37, 32
    s_cselect_b64 s[4:5], s[44:45], s[48:49]
    s_and_b32 s37, s37, 31
    s_mul_i32 s37, s37, 57344
    s_add_u32 s37, s37, s100
    buffer_load_dwordx4 v207, s[4:7], s37 offen lds
fk_gu3:
    v_lshrrev_b32 v4, 1, v1
    v_and_b32 v5, 1, v4
    v_lshrrev_b32 v6, 2, v4
    v_lshl_add_u32 v5, v6, 1, v5
    v_and_b32 v6, 2, v4
    v_lshl_add_u32 v5, v6, 2, v5
    s_and_b32 s13, s20, 1
    s_mul_i32 s13, s13, 15
    v_xor_b32 v5, s13, v5
    s_lshl_b32 s13, s20, 4
    v_add_u32 v5, s13, v5
    v_cvt_f32_u32 v5, v5
    v_and_b32 v9, 1, v1
    v_lshlrev_b32 v7, 2, v2
    v_cvt_f32_u32 v7, v7
    v_cvt_f32_u32 v10, v9
    v_mul_f32 v8, 0x3c800000, v5
    v_mul_f32 v10, 0x3e800000, v10
    v_fma_f32 v10, v8, v7, v10
    v_mov_b32 v128, v10
    v_fmamk_f32 v129, v8, 0x3f800000, v10
    v_fmamk_f32 v130, v8, 0x40000000, v10
    v_fmamk_f32 v131, v8, 0x40400000, v10
    v_fmamk_f32 v132, v8, 0x41000000, v10
    v_fmamk_f32 v133, v8, 0x41100000, v10
    v_fmamk_f32 v134, v8, 0x41200000, v10
    v_fmamk_f32 v135, v8, 0x41300000, v10
    v_fmamk_f32 v136, v8, 0x41800000, v10
    v_fmamk_f32 v137, v8, 0x41880000, v10
    v_fmamk_f32 v138, v8, 0x41900000, v10
    v_fmamk_f32 v139, v8, 0x41980000, v10
    v_fmamk_f32 v140, v8, 0x41c00000, v10
    v_fmamk_f32 v141, v8, 0x41c80000, v10
    v_fmamk_f32 v142, v8, 0x41d00000, v10
    v_fmamk_f32 v143, v8, 0x41d80000, v10
    v_cos_f32 v144, v128
    v_cos_f32 v145, v129
    v_cos_f32 v146, v130
    v_cos_f32 v147, v131
    v_cos_f32 v148, v132
    v_cos_f32 v149, v133
    v_cos_f32 v150, v134
    v_cos_f32 v151, v135
    v_cos_f32 v152, v136
    v_cos_f32 v153, v137
    v_cos_f32 v154, v138
    v_cos_f32 v155, v139
    v_cos_f32 v156, v140
    v_cos_f32 v157, v141
    v_cos_f32 v158, v142
    v_cos_f32 v159, v143
    v_sin_f32 v160, v128
    v_sin_f32 v161, v129
    v_sin_f32 v162, v130
    v_sin_f32 v163, v131
    v_sin_f32 v164, v132
    v_sin_f32 v165, v133
    v_sin_f32 v166, v134
    v_sin_f32 v167, v135
    v_sin_f32 v168, v136
    v_sin_f32 v169, v137
    v_sin_f32 v170, v138
    v_sin_f32 v171, v139
    v_sin_f32 v172, v140
    v_sin_f32 v173, v141
    v_sin_f32 v174, v142
    v_sin_f32 v175, v143
    v_cvt_pk_f16_f32 v48, v144, v160
    v_cvt_pk_f16_f32 v49, v145, v161
    v_cvt_pk_f16_f32 v50, v146, v162
    v_cvt_pk_f16_f32 v51, v147, v163
    v_cvt_pk_f16_f32 v52, v148, v164
    v_cvt_pk_f16_f32 v53, v149, v165
    v_cvt_pk_f16_f32 v54, v150, v166
    v_cvt_pk_f16_f32 v55, v151, v167
    v_cvt_pk_f16_f32 v56, v152, v168
    v_cvt_pk_f16_f32 v57, v153, v169
    v_cvt_pk_f16_f32 v58, v154, v170
    v_cvt_pk_f16_f32 v59, v155, v171
    v_cvt_pk_f16_f32 v60, v156, v172
    v_cvt_pk_f16_f32 v61, v157, v173
    v_cvt_pk_f16_f32 v62, v158, v174
    v_cvt_pk_f16_f32 v63, v159, v175
    v_fmamk_f32 v128, v8, 0x42000000, v10
    v_fmamk_f32 v129, v8, 0x42040000, v10
    v_fmamk_f32 v130, v8, 0x42080000, v10
    v_fmamk_f32 v131, v8, 0x420c0000, v10
    v_fmamk_f32 v132, v8, 0x42200000, v10
    v_fmamk_f32 v133, v8, 0x42240000, v10
    v_fmamk_f32 v134, v8, 0x42280000, v10
    v_fmamk_f32 v135, v8, 0x422c0000, v10
    v_fmamk_f32 v136, v8, 0x42400000, v10
    v_fmamk_f32 v137, v8, 0x42440000, v10
    v_fmamk_f32 v138, v8, 0x42480000, v10
    v_fmamk_f32 v139, v8, 0x424c0000, v10
    v_fmamk_f32 v140, v8, 0x42600000, v10
    v_fmamk_f32 v141, v8, 0x42640000, v10
    v_fmamk_f32 v142, v8, 0x42680000, v10
    v_fmamk_f32 v143, v8, 0x426c0000, v10
    v_cos_f32 v144, v128
    v_cos_f32 v145, v129
    v_cos_f32 v146, v130
    v_cos_f32 v147, v131
    v_cos_f32 v148, v132
    v_cos_f32 v149, v133
    v_cos_f32 v150, v134
    v_cos_f32 v151, v135
    v_cos_f32 v152, v136
    v_cos_f32 v153, v137
    v_cos_f32 v154, v138
    v_cos_f32 v155, v139
    v_cos_f32 v156, v140
    v_cos_f32 v157, v141
    v_cos_f32 v158, v142
    v_cos_f32 v159, v143
    v_sin_f32 v160, v128
    v_sin_f32 v161, v129
    v_sin_f32 v162, v130
    v_sin_f32 v163, v131
    v_sin_f32 v164, v132
    v_sin_f32 v165, v133
    v_sin_f32 v166, v134
    v_sin_f32 v167, v135
    v_sin_f32 v168, v136
    v_sin_f32 v169, v137
    v_sin_f32 v170, v138
    v_sin_f32 v171, v139
    v_sin_f32 v172, v140
    v_sin_f32 v173, v141
    v_sin_f32 v174, v142
    v_sin_f32 v175, v143
    v_cvt_pk_f16_f32 v64, v144, v160
    v_cvt_pk_f16_f32 v65, v145, v161
    v_cvt_pk_f16_f32 v66, v146, v162
    v_cvt_pk_f16_f32 v67, v147, v163
    v_cvt_pk_f16_f32 v68, v148, v164
    v_cvt_pk_f16_f32 v69, v149, v165
    v_cvt_pk_f16_f32 v70, v150, v166
    v_cvt_pk_f16_f32 v71, v151, v167
    v_cvt_pk_f16_f32 v72, v152, v168
    v_cvt_pk_f16_f32 v73, v153, v169
    v_cvt_pk_f16_f32 v74, v154, v170
    v_cvt_pk_f16_f32 v75, v155, v171
    v_cvt_pk_f16_f32 v76, v156, v172
    v_cvt_pk_f16_f32 v77, v157, v173
    v_cvt_pk_f16_f32 v78, v158, v174
    v_cvt_pk_f16_f32 v79, v159, v175
    v_lshlrev_b32 v11, 31, v9
    v_mul_f32 v10, 0x3a000000, v5
    v_xor_b32 v10, v11, v10
    v_mul_f32 v11, v10, v7
    v_mov_b32 v128, v11
    v_fmamk_f32 v129, v10, 0x3f800000, v11
    v_fmamk_f32 v130, v10, 0x40000000, v11
    v_fmamk_f32 v131, v10, 0x40400000, v11
    v_fmamk_f32 v132, v10, 0x41000000, v11
    v_fmamk_f32 v133, v10, 0x41100000, v11
    v_fmamk_f32 v134, v10, 0x41200000, v11
    v_fmamk_f32 v135, v10, 0x41300000, v11
    v_fmamk_f32 v136, v10, 0x41800000, v11
    v_fmamk_f32 v137, v10, 0x41880000, v11
    v_fmamk_f32 v138, v10, 0x41900000, v11
    v_fmamk_f32 v139, v10, 0x41980000, v11
    v_fmamk_f32 v140, v10, 0x41c00000, v11
    v_fmamk_f32 v141, v10, 0x41c80000, v11
    v_fmamk_f32 v142, v10, 0x41d00000, v11
    v_fmamk_f32 v143, v10, 0x41d80000, v11
    v_cos_f32 v80, v128
    v_cos_f32 v81, v129
    v_cos_f32 v82, v130
    v_cos_f32 v83, v131
    v_cos_f32 v84, v132
    v_cos_f32 v85, v133
    v_cos_f32 v86, v134
    v_cos_f32 v87, v135
    v_cos_f32 v88, v136
    v_cos_f32 v89, v137
    v_cos_f32 v90, v138
    v_cos_f32 v91, v139
    v_cos_f32 v92, v140
    v_cos_f32 v93, v141
    v_cos_f32 v94, v142
    v_cos_f32 v95, v143
    v_sin_f32 v96, v128
    v_sin_f32 v97, v129
    v_sin_f32 v98, v130
    v_sin_f32 v99, v131
    v_sin_f32 v100, v132
    v_sin_f32 v101, v133
    v_sin_f32 v102, v134
    v_sin_f32 v103, v135
    v_sin_f32 v104, v136
    v_sin_f32 v105, v137
    v_sin_f32 v106, v138
    v_sin_f32 v107, v139
    v_sin_f32 v108, v140
    v_sin_f32 v109, v141
    v_sin_f32 v110, v142
    v_sin_f32 v111, v143
    v_sub_u32 v4, 31, v1
    v_subrev_u32 v5, 1, v1
    v_cmp_lt_u32 vcc, 16, v1
    s_nop 1
    v_cndmask_b32 v4, v5, v4, vcc
    v_and_b32 v4, 15, v4
    v_lshlrev_b32 v4, 5, v4
    v_add_u32 v4, 130304, v4
    v_lshlrev_b32 v5, 9, v2
    v_add_u32 v6, v4, v5
    v_sub_u32 v7, v4, v5
    v_add_u32 v7, 7696, v7
    v_cmp_eq_u32 s[38:39], 0, v1
    v_mov_b32 v8, 4096
    s_nop 0
    v_cndmask_b32 v8, 0, v8, s[38:39]
    v_add_u32 v6, v6, v8
    v_add_u32 v7, v7, v8
    v_and_b32 v8, 15, v1
    v_cmp_eq_u32 s[38:39], 0, v8
    s_nop 1
    s_or_b64 s[40:41], s[38:39], vcc
    v_add_u32 v184, 0, v6
    v_subrev_u32 v8, 0, v7
    v_cndmask_b32 v184, v184, v8, vcc
    v_add_u32 v185, 1024, v6
    v_subrev_u32 v8, 1024, v7
    v_cndmask_b32 v185, v185, v8, vcc
    v_add_u32 v186, 2048, v6
    v_subrev_u32 v8, 2048, v7
    v_cndmask_b32 v186, v186, v8, vcc
    v_add_u32 v187, 3072, v6
    v_subrev_u32 v8, 3072, v7
    v_cndmask_b32 v187, v187, v8, vcc
    v_add_u32 v188, 4096, v6
    v_subrev_u32 v8, 4096, v7
    v_cndmask_b32 v188, v188, v8, s[40:41]
    v_add_u32 v189, 5120, v6
    v_subrev_u32 v8, 5120, v7
    v_cndmask_b32 v189, v189, v8, s[40:41]
    v_add_u32 v190, 6144, v6
    v_subrev_u32 v8, 6144, v7
    v_cndmask_b32 v190, v190, v8, s[40:41]
    v_add_u32 v191, 7168, v6
    v_subrev_u32 v8, 7168, v7
    v_cndmask_b32 v191, v191, v8, s[40:41]
    s_lshr_b32 s13, s20, 1
    v_lshl_add_u32 v3, v1, 1, s13
    s_and_b32 s13, s20, 1
    s_sub_u32 s14, 64, s13
    v_and_b32 v8, 3, v3
    v_lshlrev_b32 v8, 2, v8
    v_lshlrev_b32 v4, 3, v3
    v_sub_u32 v4, v4, v8
    v_sub_u32 v5, 63, v3
    v_and_b32 v8, 3, v5
    v_mul_u32_u24 v8, 12, v8
    v_lshlrev_b32 v6, 3, v5
    v_sub_u32 v6, v6, v8
    v_add_u32 v6, 28, v6
    v_sub_u32 v5, s14, v3
    v_and_b32 v8, 3, v5
    v_mul_u32_u24 v8, 12, v8
    v_lshlrev_b32 v7, 3, v5
    v_sub_u32 v7, v7, v8
    v_add_u32 v7, 28, v7
    v_cmp_gt_u32 vcc, 32, v3
    s_nop 1
    v_cndmask_b32 v7, v7, v4, vcc
    v_cmp_eq_u32 vcc, 32, v5
    s_nop 1
    v_cndmask_b32 v7, v7, 28, vcc
    s_cmp_eq_u32 s13, 0
    s_cselect_b32 s14, 256, 0
    s_cselect_b32 s15, 576, 0
    s_cselect_b64 s[38:39], -1, 0
    s_add_u32 s14, s14, 7680
    s_sub_u32 s15, 120832, s15
    v_cmp_gt_u32 vcc, 32, v3
    s_nop 1
    v_cndmask_b32 v7, v7, v4, vcc
    v_add_u32 v7, s14, v7
    v_cndmask_b32 v4, v6, v4, s[38:39]
    v_lshl_add_u32 v4, v2, 12, v4
    v_lshrrev_b32 v8, 7, v4
    v_lshl_add_u32 v4, v8, 4, v4
    v_lshrrev_b32 v8, 7, v7
    v_lshl_add_u32 v7, v8, 4, v7
    v_add_u32 v11, s15, v4
    v_add_u32 v7, 120832, v7
    v_add_u32 v12, 4032, v11
    v_cmp_eq_u32 vcc, s13, v2
    s_nop 1
    s_and_b64 s[40:41], vcc, s[38:39]
    s_andn2_b64 s[38:39], vcc, s[38:39]
    v_cndmask_b32 v10, v11, v7, s[40:41]
    v_cndmask_b32 v12, v12, v7, s[38:39]
    s_lshl_b32 s23, s20, 5
    s_add_u32 s23, s23, s18
    v_and_b32 v3, 15, v15
    v_lshrrev_b32 v4, 4, v15
    v_lshl_add_u32 v3, v3, 7, v4
    v_add_u32 v3, 1, v3
    v_cmp_le_u32 vcc, 56, v15
    v_mov_b32 v4, 1008
    s_nop 0
    v_cndmask_b32 v4, 0, v4, vcc
    v_add_u32 v4, v3, v4
    v_mul_u32_u24 v3, s23, v3
    v_and_b32 v3, 2047, v3
    v_cvt_f32_u32 v3, v3
    v_mul_f32 v3, 0x3a000000, v3
    v_mul_u32_u24 v4, s23, v4
    v_and_b32 v4, 2047, v4
    v_cvt_f32_u32 v4, v4
    v_mul_f32 v4, 0x3a000000, v4
    v_cvt_f32_u32 v5, s23
    v_mul_f32 v5, 0x3a000000, v5
    v_mov_b32 v192, v3
    v_fmamk_f32 v193, v5, 0x42000000, v3
    v_fmamk_f32 v194, v5, 0x42800000, v3
    v_fmamk_f32 v195, v5, 0x42c00000, v3
    v_fmamk_f32 v196, v5, 0x40800000, v3
    v_fmamk_f32 v197, v5, 0x42100000, v3
    v_fmamk_f32 v198, v5, 0x42880000, v3
    v_fmamk_f32 v199, v5, 0x42c80000, v3
    v_fmamk_f32 v200, v5, 0x41000000, v3
    v_fmamk_f32 v201, v5, 0x42200000, v3
    v_fmamk_f32 v202, v5, 0x42900000, v3
    v_fmamk_f32 v203, v5, 0x42d00000, v3
    v_fmamk_f32 v204, v5, 0x41400000, v4
    v_fmamk_f32 v205, v5, 0x42300000, v4
    v_fmamk_f32 v206, v5, 0x42980000, v4
    v_fmamk_f32 v207, v5, 0x42d80000, v4
    v_cos_f32 v192, v192
    v_cos_f32 v193, v193
    v_cos_f32 v194, v194
    v_cos_f32 v195, v195
    v_cos_f32 v196, v196
    v_cos_f32 v197, v197
    v_cos_f32 v198, v198
    v_cos_f32 v199, v199
    v_cos_f32 v200, v200
    v_cos_f32 v201, v201
    v_cos_f32 v202, v202
    v_cos_f32 v203, v203
    v_cos_f32 v204, v204
    v_cos_f32 v205, v205
    v_cos_f32 v206, v206
    v_cos_f32 v207, v207
    v_add_u32 v9, 138496, v14
    s_setprio 2
    s_barrier
    ds_read_b128 v[16:19], v184
    ds_read_b128 v[20:23], v185
    ds_read_b128 v[24:27], v186
    ds_read_b128 v[28:31], v187
    ds_read_b128 v[32:35], v188
    ds_read_b128 v[36:39], v189
    ds_read_b128 v[40:43], v190
    ds_read_b128 v[44:47], v191
    ds_read_b128 v[112:115], v9 offset:12288
    ds_read_b128 v[116:119], v9 offset:13312
    ds_read_b128 v[120:123], v9 offset:14336
    ds_read_b128 v[124:127], v9 offset:15360
    s_waitcnt lgkmcnt(11)
    v_mfma_f32_32x32x16_f16 v[128:143], v[16:19], v[48:51], 0
    s_waitcnt lgkmcnt(10)
    v_mfma_f32_32x32x16_f16 v[128:143], v[20:23], v[52:55], v[128:143]
    s_waitcnt lgkmcnt(9)
    v_mfma_f32_32x32x16_f16 v[128:143], v[24:27], v[56:59], v[128:143]
    s_waitcnt lgkmcnt(8)
    v_mfma_f32_32x32x16_f16 v[128:143], v[28:31], v[60:63], v[128:143]
    s_waitcnt lgkmcnt(7)
    v_mfma_f32_32x32x16_f16 v[128:143], v[32:35], v[64:67], v[128:143]
    s_waitcnt lgkmcnt(6)
    v_mfma_f32_32x32x16_f16 v[128:143], v[36:39], v[68:71], v[128:143]
    s_waitcnt lgkmcnt(5)
    v_mfma_f32_32x32x16_f16 v[128:143], v[40:43], v[72:75], v[128:143]
    s_waitcnt lgkmcnt(4)
    v_mfma_f32_32x32x16_f16 v[128:143], v[44:47], v[76:79], v[128:143]
    s_nop 11
    v_pk_mul_f32 v[16:17], v[128:129], v[80:81]
    v_pk_mul_f32 v[18:19], v[130:131], v[82:83]
    v_pk_mul_f32 v[20:21], v[132:133], v[84:85]
    v_pk_mul_f32 v[22:23], v[134:135], v[86:87]
    v_pk_mul_f32 v[24:25], v[136:137], v[88:89]
    v_pk_mul_f32 v[26:27], v[138:139], v[90:91]
    v_pk_mul_f32 v[28:29], v[140:141], v[92:93]
    v_pk_mul_f32 v[30:31], v[142:143], v[94:95]
    v_fmac_f32_dpp v16, v128, v96 quad_perm:[1,0,3,2] row_mask:0xf bank_mask:0xf
    v_fmac_f32_dpp v17, v129, v97 quad_perm:[1,0,3,2] row_mask:0xf bank_mask:0xf
    v_fmac_f32_dpp v18, v130, v98 quad_perm:[1,0,3,2] row_mask:0xf bank_mask:0xf
    v_fmac_f32_dpp v19, v131, v99 quad_perm:[1,0,3,2] row_mask:0xf bank_mask:0xf
    v_fmac_f32_dpp v20, v132, v100 quad_perm:[1,0,3,2] row_mask:0xf bank_mask:0xf
    v_fmac_f32_dpp v21, v133, v101 quad_perm:[1,0,3,2] row_mask:0xf bank_mask:0xf
    v_fmac_f32_dpp v22, v134, v102 quad_perm:[1,0,3,2] row_mask:0xf bank_mask:0xf
    v_fmac_f32_dpp v23, v135, v103 quad_perm:[1,0,3,2] row_mask:0xf bank_mask:0xf
    v_cvt_pk_f16_f32 v176, v16, v17
    v_cvt_pk_f16_f32 v177, v18, v19
    v_cvt_pk_f16_f32 v178, v20, v21
    v_cvt_pk_f16_f32 v179, v22, v23
    v_fmac_f32_dpp v24, v136, v104 quad_perm:[1,0,3,2] row_mask:0xf bank_mask:0xf
    v_fmac_f32_dpp v25, v137, v105 quad_perm:[1,0,3,2] row_mask:0xf bank_mask:0xf
    s_waitcnt lgkmcnt(0)
    v_mfma_f32_32x32x16_f16 v[144:159], v[176:179], v[112:115], 0
    v_fmac_f32_dpp v26, v138, v106 quad_perm:[1,0,3,2] row_mask:0xf bank_mask:0xf
    v_fmac_f32_dpp v27, v139, v107 quad_perm:[1,0,3,2] row_mask:0xf bank_mask:0xf
    v_fmac_f32_dpp v28, v140, v108 quad_perm:[1,0,3,2] row_mask:0xf bank_mask:0xf
    v_fmac_f32_dpp v29, v141, v109 quad_perm:[1,0,3,2] row_mask:0xf bank_mask:0xf
    v_fmac_f32_dpp v30, v142, v110 quad_perm:[1,0,3,2] row_mask:0xf bank_mask:0xf
    v_mfma_f32_32x32x16_f16 v[160:175], v[176:179], v[120:123], 0
    v_fmac_f32_dpp v31, v143, v111 quad_perm:[1,0,3,2] row_mask:0xf bank_mask:0xf
    v_cvt_pk_f16_f32 v180, v24, v25
    v_cvt_pk_f16_f32 v181, v26, v27
    v_cvt_pk_f16_f32 v182, v28, v29
    v_cvt_pk_f16_f32 v183, v30, v31
    s_nop 1
    v_mfma_f32_32x32x16_f16 v[144:159], v[180:183], v[116:119], v[144:159]
    v_mfma_f32_32x32x16_f16 v[160:175], v[180:183], v[124:127], v[160:175]
    s_nop 11
    v_pk_add_f32 v[16:17], v[144:145], v[160:161] op_sel:[0,1] op_sel_hi:[1,0] neg_hi:[0,1]
    v_pk_add_f32 v[18:19], v[146:147], v[162:163] op_sel:[0,1] op_sel_hi:[1,0] neg_hi:[0,1]
    v_pk_add_f32 v[20:21], v[148:149], v[164:165] op_sel:[0,1] op_sel_hi:[1,0] neg_hi:[0,1]
    v_pk_add_f32 v[22:23], v[150:151], v[166:167] op_sel:[0,1] op_sel_hi:[1,0] neg_hi:[0,1]
    v_pk_add_f32 v[24:25], v[152:153], v[168:169] op_sel:[0,1] op_sel_hi:[1,0] neg_hi:[0,1]
    v_pk_add_f32 v[26:27], v[154:155], v[170:171] op_sel:[0,1] op_sel_hi:[1,0] neg_hi:[0,1]
    v_pk_add_f32 v[28:29], v[156:157], v[172:173] op_sel:[0,1] op_sel_hi:[1,0] neg_hi:[0,1]
    v_pk_add_f32 v[30:31], v[158:159], v[174:175] op_sel:[0,1] op_sel_hi:[1,0] neg_hi:[0,1]
    v_cvt_pk_bf16_f32 v48, v16, v17
    ds_write_b32 v10, v48
    v_cvt_pk_bf16_f32 v49, v18, v19
    ds_write_b32 v11, v49 offset:576
    v_cvt_pk_bf16_f32 v50, v20, v21
    ds_write_b32 v11, v50 offset:1152
    v_cvt_pk_bf16_f32 v51, v22, v23
    ds_write_b32 v11, v51 offset:1728
    v_cvt_pk_bf16_f32 v52, v24, v25
    ds_write_b32 v11, v52 offset:2304
    v_cvt_pk_bf16_f32 v53, v26, v27
    ds_write_b32 v11, v53 offset:2880
    v_cvt_pk_bf16_f32 v54, v28, v29
    ds_write_b32 v11, v54 offset:3456
    v_cvt_pk_bf16_f32 v55, v30, v31
    ds_write_b32 v12, v55
    s_nop 3
fk_common:
    v_lshrrev_b32 v5, 3, v15
    v_lshlrev_b32 v4, 10, v5
    v_and_b32 v6, 7, v15
    v_lshl_add_u32 v4, v6, 4, v4
    s_mul_i32 s13, s16, 144
    s_add_u32 s13, s13, 120832
    v_lshl_add_u32 v5, v5, 7, v4
    v_add_u32 v5, s13, v5
    s_mul_i32 s17, s3, 9344
    s_lshl_b32 s13, s16, 7
    s_add_u32 s17, s17, s13
    s_add_u32 s17, s17, 0x448000
    v_mov_b32 v3, 157852
    v_lshrrev_b32 v47, 3, v15
    v_lshlrev_b32 v47, 4, v47
    ds_read_b32 v3, v3
    s_waitcnt lgkmcnt(0)
    s_barrier
    s_setprio 0
    ds_read_b128 v[16:19], v5
    v_readfirstlane_b32 s43, v3
    s_sub_u32 s13, 7, s16
    s_cmp_lt_u32 s16, 4
    s_cselect_b32 s13, s16, s13
    s_cselect_b32 s14, 0, 2048
    s_lshl_b32 s21, s13, 5
    s_add_u32 s21, s21, s18
    s_sub_u32 s22, 2048, s21
    s_and_b32 s22, s22, 2047
    s_cmp_lt_u32 s16, 4
    s_cselect_b32 s21, s21, s22
    s_lshl_b32 s13, s13, 12
    s_add_u32 s13, s13, s14
    s_add_u32 s13, s13, 98304
    s_lshl_b32 s14, s3, 3
    s_add_u32 s19, s14, s16
    s_cmp_eq_u32 s19, 1991
    s_cselect_b32 s21, 1024, s21
    s_cselect_b32 s13, 118784, s13
    s_lshl_b32 s22, s21, 11
    v_add_u32 v6, s13, v14
    v_add_u32 v7, 155008, v14
    s_waitcnt lgkmcnt(0)
    v_min_u32 v16, -2, v16
    v_min_u32 v17, -2, v17
    v_min_u32 v18, -2, v18
    v_min_u32 v19, -2, v19
    buffer_store_dwordx4 v[16:19], v4, s[24:27], s17 offen sc1
    ds_read_b128 v[20:23], v6
    ds_read_b128 v[24:27], v6 offset:1024
    ds_read_b128 v[28:31], v7
    ds_read_b128 v[32:35], v7 offset:1024
    s_cmp_lt_u32 s16, 4
    s_cbranch_scc1 fk_noy5
    v_add_u32 v3, 114688, v14
    v_mov_b32 v4, 157152
    ds_read_b128 v[128:131], v3 offset:0
    ds_read_b128 v[132:135], v3 offset:1024
    ds_read_b128 v[136:139], v3 offset:2048
    ds_read_b128 v[140:143], v3 offset:3072
    ds_read_b32 v9, v4
    s_lshl_b32 s38, s20, 2
    s_sub_u32 s39, 28, s38
    s_waitcnt lgkmcnt(0)
    s_nop 0
fk_y5:
    v_pk_mul_f32 v[144:145], v[128:129], v[192:193]
    v_pk_mul_f32 v[146:147], v[130:131], v[194:195]
    v_pk_fma_f32 v[144:145], v[132:133], v[196:197], v[144:145]
    v_pk_fma_f32 v[146:147], v[134:135], v[198:199], v[146:147]
    v_pk_fma_f32 v[144:145], v[136:137], v[200:201], v[144:145]
    v_pk_fma_f32 v[146:147], v[138:139], v[202:203], v[146:147]
    v_pk_fma_f32 v[144:145], v[140:141], v[204:205], v[144:145]
    v_pk_fma_f32 v[146:147], v[142:143], v[206:207], v[146:147]
    v_pk_add_f32 v[144:145], v[144:145], v[146:147]
    v_add_f32 v144, v144, v145
    s_lshl_b32 s13, s23, 31
    v_xor_b32 v12, s13, v9
    v_add_f32_dpp v144, v144, v144 quad_perm:[1,0,3,2] row_mask:0xf bank_mask:0xf
    s_nop 1
    v_add_f32_dpp v144, v144, v144 quad_perm:[2,3,0,1] row_mask:0xf bank_mask:0xf
    s_nop 1
    v_add_f32_dpp v144, v144, v144 row_half_mirror row_mask:0xf bank_mask:0xf
    s_nop 1
    v_add_f32_dpp v144, v144, v144 row_mirror row_mask:0xf bank_mask:0xf
    s_nop 1
    v_add_f32_dpp v144, v144, v144 row_bcast:15 row_mask:0xa bank_mask:0xf
    s_nop 1
    v_add_f32_dpp v144, v144, v144 row_bcast:31 row_mask:0xc bank_mask:0xf
    v_add_f32 v144, v144, v12
    v_add_f32 v144, v144, v144
    v_cvt_pk_bf16_f32 v144, 0, v144
    s_add_u32 s13, s38, 157088
    s_add_u32 s14, s39, 157088
    v_mov_b32 v10, s13
    v_mov_b32 v11, s14
    s_mov_b32 exec_lo, 0
    s_mov_b32 exec_hi, 0x80000000
    ds_write_b32 v10, v144
    ds_write_b32 v11, v144
    s_mov_b64 exec, -1
    s_cmp_lg_u32 s23, 0
    s_cbranch_scc1 fk_noy5
    s_mov_b32 s23, 1024
    s_mov_b32 s38, 28
    v_and_b32 v3, 15, v15
    v_lshrrev_b32 v4, 4, v15
    v_lshl_add_u32 v3, v3, 7, v4
    v_add_u32 v3, 1, v3
    v_cmp_le_u32 vcc, 56, v15
    v_mov_b32 v4, 1008
    s_nop 0
    v_cndmask_b32 v4, 0, v4, vcc
    v_add_u32 v4, v3, v4
    v_mul_u32_u24 v3, s23, v3
    v_and_b32 v3, 2047, v3
    v_cvt_f32_u32 v3, v3
    v_mul_f32 v3, 0x3a000000, v3
    v_mul_u32_u24 v4, s23, v4
    v_and_b32 v4, 2047, v4
    v_cvt_f32_u32 v4, v4
    v_mul_f32 v4, 0x3a000000, v4
    v_cvt_f32_u32 v5, s23
    v_mul_f32 v5, 0x3a000000, v5
    v_mov_b32 v192, v3
    v_fmamk_f32 v193, v5, 0x42000000, v3
    v_fmamk_f32 v194, v5, 0x42800000, v3
    v_fmamk_f32 v195, v5, 0x42c00000, v3
    v_fmamk_f32 v196, v5, 0x40800000, v3
    v_fmamk_f32 v197, v5, 0x42100000, v3
    v_fmamk_f32 v198, v5, 0x42880000, v3
    v_fmamk_f32 v199, v5, 0x42c80000, v3
    v_fmamk_f32 v200, v5, 0x41000000, v3
    v_fmamk_f32 v201, v5, 0x42200000, v3
    v_fmamk_f32 v202, v5, 0x42900000, v3
    v_fmamk_f32 v203, v5, 0x42d00000, v3
    v_fmamk_f32 v204, v5, 0x41400000, v4
    v_fmamk_f32 v205, v5, 0x42300000, v4
    v_fmamk_f32 v206, v5, 0x42980000, v4
    v_fmamk_f32 v207, v5, 0x42d80000, v4
    v_cos_f32 v192, v192
    v_cos_f32 v193, v193
    v_cos_f32 v194, v194
    v_cos_f32 v195, v195
    v_cos_f32 v196, v196
    v_cos_f32 v197, v197
    v_cos_f32 v198, v198
    v_cos_f32 v199, v199
    v_cos_f32 v200, v200
    v_cos_f32 v201, v201
    v_cos_f32 v202, v202
    v_cos_f32 v203, v203
    v_cos_f32 v204, v204
    v_cos_f32 v205, v205
    v_cos_f32 v206, v206
    v_cos_f32 v207, v207
    s_branch fk_y5
    s_nop 3
fk_noy5:
    v_lshrrev_b32 v1, 1, v0
    v_and_b32 v45, 1, v0
    v_lshrrev_b32 v2, 4, v1
    v_and_b32 v3, 15, v1
    v_cmp_gt_u32 vcc, 8, v3
    v_sub_u32 v6, 16, v3
    v_and_b32 v6, 7, v6
    v_sub_u32 v5, 31, v2
    v_cndmask_b32 v6, v6, v3, vcc
    v_cndmask_b32 v5, v5, v2, vcc
    v_lshl_add_u32 v4, v6, 5, v5
    v_mul_u32_u24 v47, 9344, v4
    v_lshl_add_u32 v4, v45, 4, v47
    s_bfe_u32 s23, s3, 0x30002
    s_lshl_b32 s23, s23, 7
    s_lshr_b32 s12, s3, 5
    s_lshl_b32 s12, s12, 4
    s_add_u32 s23, s23, s12
    s_and_b32 s12, s3, 3
    s_lshl_b32 s12, s12, 2
    s_add_u32 s23, s23, s12
    s_add_u32 s23, s23, 8192
    s_add_u32 s23, s23, 0x448000
    s_lshl_b32 s17, s3, 5
    s_add_u32 s17, s17, 0x448000
    v_cndmask_b32 v6, -1, 1, vcc
    v_cmp_eq_u32 vcc, 8, v3
    v_mul_u32_u24 v46, 8256, v45
    v_add_u32 v46, 138496, v46
    v_cndmask_b32 v6, v6, 15, vcc
    v_lshlrev_b32 v9, 2, v1
    v_lshl_add_u32 v10, v6, 1, v9
    v_add_u32 v9, v46, v9
    v_add_u32 v10, v46, v10
    s_mul_i32 s36, s16, 2064
    s_add_u32 s36, s36, 138496
    v_add_u32 v5, s36, v14
    s_sub_u32 s36, 7, s16
    s_cmp_eq_u32 s21, 0
    s_cselect_b32 s36, 0, s36
    s_cmp_eq_u32 s21, 1024
    s_cselect_b32 s36, 7, s36
    s_mul_i32 s36, s36, 2064
    s_add_u32 s36, s36, 139504
    v_sub_u32 v11, s36, v14
    v_mov_b32 v8, 0x10000
    s_lshl_b32 s36, s16, 2
    s_add_u32 s36, s36, 157088
    v_mov_b32 v6, s36
    s_mov_b32 s36, 0xffff0000
    s_mov_b32 s37, 0x3f803f80
    s_mov_b32 s38, 8.0
    s_waitcnt lgkmcnt(0)
    v_lshlrev_b32 v48, 16, v20
    v_and_b32 v49, s36, v20
    v_lshlrev_b32 v50, 16, v21
    v_and_b32 v51, s36, v21
    v_lshlrev_b32 v52, 16, v22
    v_and_b32 v53, s36, v22
    v_lshlrev_b32 v54, 16, v23
    v_and_b32 v55, s36, v23
    v_lshlrev_b32 v56, 16, v24
    v_and_b32 v57, s36, v24
    v_lshlrev_b32 v58, 16, v25
    v_and_b32 v59, s36, v25
    v_lshlrev_b32 v60, 16, v26
    v_and_b32 v61, s36, v26
    v_lshlrev_b32 v62, 16, v27
    v_and_b32 v63, s36, v27
    v_mov_b32 v44, 0
    v_dot2c_f32_bf16 v44, s37, v28
    v_dot2c_f32_bf16 v44, s37, v29
    v_dot2c_f32_bf16 v44, s37, v30
    v_dot2c_f32_bf16 v44, s37, v31
    v_dot2c_f32_bf16 v44, s37, v32
    v_dot2c_f32_bf16 v44, s37, v33
    v_dot2c_f32_bf16 v44, s37, v34
    v_dot2c_f32_bf16 v44, s37, v35
    s_nop 2
    v_add_f32_dpp v44, v44, v44 quad_perm:[1,0,3,2] row_mask:0xf bank_mask:0xf
    s_nop 1
    v_add_f32_dpp v44, v44, v44 quad_perm:[2,3,0,1] row_mask:0xf bank_mask:0xf
    s_nop 1
    v_add_f32_dpp v44, v44, v44 row_half_mirror row_mask:0xf bank_mask:0xf
    s_nop 1
    v_add_f32_dpp v44, v44, v44 row_mirror row_mask:0xf bank_mask:0xf
    s_nop 1
    v_add_f32_dpp v44, v44, v44 row_bcast:15 row_mask:0xa bank_mask:0xf
    s_nop 1
    v_add_f32_dpp v44, v44, v44 row_bcast:31 row_mask:0xc bank_mask:0xf
    s_nop 0
    v_readlane_b32 s39, v44, 63
    s_mov_b32 s42, 0
    s_waitcnt vmcnt(0)
    s_nop 2
fk_polly:
    buffer_load_dwordx4 v[36:39], v4, s[24:27], s17 offen sc1
    s_add_u32 s42, s42, 1
    s_waitcnt vmcnt(0)
    v_max3_u32 v46, v36, v37, v38
    v_max_u32 v46, v46, v39
    v_cmp_eq_u32 vcc, -1, v46
    s_cmp_gt_u32 s42, 0x40000
    s_cbranch_scc1 fk_goty
    s_cbranch_vccnz fk_polly
    s_nop 1
fk_goty:
    ds_write_b16 v9, v36 offset:0
    ds_write_b16_d16_hi v10, v36 offset:0
    ds_write_b16 v9, v37 offset:2064
    ds_write_b16_d16_hi v10, v37 offset:2064
    ds_write_b16 v9, v38 offset:4128
    ds_write_b16_d16_hi v10, v38 offset:4128
    ds_write_b16 v9, v39 offset:6192
    ds_write_b16_d16_hi v10, v39 offset:6192
    s_cmp_gt_u32 s3, 223
    s_cbranch_scc1 fk_win2
    s_mul_i32 s15, s16, 5
    s_add_u32 s15, s15, 28
    s_mov_b32 s58, 0x700000
    s_mov_b32 s59, 0x00020000
    s_cmp_gt_u32 s15, 95
    s_cbranch_scc1 fk_win2
    s_lshl_b32 s12, s15, 10
    s_mov_b32 m0, s12
    s_and_b32 s14, s12, 1024
    s_lshr_b32 s14, s14, 4
    v_xor_b32 v209, s14, v208
    s_cmp_lt_u32 s15, 32
    s_cselect_b64 s[56:57], s[44:45], s[48:49]
    s_and_b32 s14, s15, 31
    s_mul_i32 s13, s14, 57344
    s_add_u32 s13, s13, s100
    s_lshl_b32 s14, s14, 12
    s_add_u32 s14, s14, s101
    s_cmp_lt_u32 s15, 64
    s_cselect_b64 s[56:57], s[56:57], s[52:53]
    s_cselect_b32 s13, s13, s14
    s_cselect_b64 vcc, -1, 0
    v_cndmask_b32 v209, v210, v209, vcc
    s_add_u32 s15, s15, 1
    buffer_load_dwordx4 v209, s[56:59], s13 offen lds
    s_cmp_gt_u32 s15, 95
    s_cbranch_scc1 fk_win2
    s_lshl_b32 s12, s15, 10
    s_mov_b32 m0, s12
    s_and_b32 s14, s12, 1024
    s_lshr_b32 s14, s14, 4
    v_xor_b32 v209, s14, v208
    s_cmp_lt_u32 s15, 32
    s_cselect_b64 s[56:57], s[44:45], s[48:49]
    s_and_b32 s14, s15, 31
    s_mul_i32 s13, s14, 57344
    s_add_u32 s13, s13, s100
    s_lshl_b32 s14, s14, 12
    s_add_u32 s14, s14, s101
    s_cmp_lt_u32 s15, 64
    s_cselect_b64 s[56:57], s[56:57], s[52:53]
    s_cselect_b32 s13, s13, s14
    s_cselect_b64 vcc, -1, 0
    v_cndmask_b32 v209, v210, v209, vcc
    s_add_u32 s15, s15, 1
    buffer_load_dwordx4 v209, s[56:59], s13 offen lds
    s_cmp_gt_u32 s15, 95
    s_cbranch_scc1 fk_win2
    s_lshl_b32 s12, s15, 10
    s_mov_b32 m0, s12
    s_and_b32 s14, s12, 1024
    s_lshr_b32 s14, s14, 4
    v_xor_b32 v209, s14, v208
    s_cmp_lt_u32 s15, 32
    s_cselect_b64 s[56:57], s[44:45], s[48:49]
    s_and_b32 s14, s15, 31
    s_mul_i32 s13, s14, 57344
    s_add_u32 s13, s13, s100
    s_lshl_b32 s14, s14, 12
    s_add_u32 s14, s14, s101
    s_cmp_lt_u32 s15, 64
    s_cselect_b64 s[56:57], s[56:57], s[52:53]
    s_cselect_b32 s13, s13, s14
    s_cselect_b64 vcc, -1, 0
    v_cndmask_b32 v209, v210, v209, vcc
    s_add_u32 s15, s15, 1
    buffer_load_dwordx4 v209, s[56:59], s13 offen lds
    s_cmp_gt_u32 s15, 95
    s_cbranch_scc1 fk_win2
    s_lshl_b32 s12, s15, 10
    s_mov_b32 m0, s12
    s_and_b32 s14, s12, 1024
    s_lshr_b32 s14, s14, 4
    v_xor_b32 v209, s14, v208
    s_cmp_lt_u32 s15, 32
    s_cselect_b64 s[56:57], s[44:45], s[48:49]
    s_and_b32 s14, s15, 31
    s_mul_i32 s13, s14, 57344
    s_add_u32 s13, s13, s100
    s_lshl_b32 s14, s14, 12
    s_add_u32 s14, s14, s101
    s_cmp_lt_u32 s15, 64
    s_cselect_b64 s[56:57], s[56:57], s[52:53]
    s_cselect_b32 s13, s13, s14
    s_cselect_b64 vcc, -1, 0
    v_cndmask_b32 v209, v210, v209, vcc
    s_add_u32 s15, s15, 1
    buffer_load_dwordx4 v209, s[56:59], s13 offen lds
    s_cmp_gt_u32 s15, 95
    s_cbranch_scc1 fk_win2
    s_lshl_b32 s12, s15, 10
    s_mov_b32 m0, s12
    s_and_b32 s14, s12, 1024
    s_lshr_b32 s14, s14, 4
    v_xor_b32 v209, s14, v208
    s_cmp_lt_u32 s15, 32
    s_cselect_b64 s[56:57], s[44:45], s[48:49]
    s_and_b32 s14, s15, 31
    s_mul_i32 s13, s14, 57344
    s_add_u32 s13, s13, s100
    s_lshl_b32 s14, s14, 12
    s_add_u32 s14, s14, s101
    s_cmp_lt_u32 s15, 64
    s_cselect_b64 s[56:57], s[56:57], s[52:53]
    s_cselect_b32 s13, s13, s14
    s_cselect_b64 vcc, -1, 0
    v_cndmask_b32 v209, v210, v209, vcc
    s_add_u32 s15, s15, 1
    buffer_load_dwordx4 v209, s[56:59], s13 offen lds
    s_nop 2
fk_win2:
    v_mov_b32 v2, 0
    v_mov_b32 v3, 0
    v_mov_b32 v4, 0
    v_mov_b32 v7, 0
    v_mov_b32 v12, 157120
    s_waitcnt lgkmcnt(0)
    s_barrier
    ds_read_b128 v[36:39], v5
    ds_read_b128 v[40:43], v11
    ds_read_b32 v44, v6
    s_waitcnt lgkmcnt(2)
    v_lshlrev_b32 v64, 16, v36
    v_and_b32 v65, s36, v36
    v_lshlrev_b32 v66, 16, v37
    v_and_b32 v67, s36, v37
    v_lshlrev_b32 v68, 16, v38
    v_and_b32 v69, s36, v38
    v_lshlrev_b32 v70, 16, v39
    v_and_b32 v71, s36, v39
    s_waitcnt lgkmcnt(0)
    v_readfirstlane_b32 s13, v44
    v_mul_u32_u24_dpp v72, v40, v8 wave_shr:1 row_mask:0xf bank_mask:0xf
    v_and_b32 v73, s36, v43
    v_lshlrev_b32 v74, 16, v43
    v_and_b32 v75, s36, v42
    v_lshlrev_b32 v76, 16, v42
    v_and_b32 v77, s36, v41
    v_lshlrev_b32 v78, 16, v41
    v_and_b32 v79, s36, v40
    v_writelane_b32 v72, s13, 0
    v_pk_fma_f32 v[48:49], v[64:65], s[38:39], v[48:49] op_sel_hi:[1,0,1]
    v_pk_fma_f32 v[50:51], v[66:67], s[38:39], v[50:51] op_sel_hi:[1,0,1]
    v_pk_fma_f32 v[52:53], v[68:69], s[38:39], v[52:53] op_sel_hi:[1,0,1]
    v_pk_fma_f32 v[54:55], v[70:71], s[38:39], v[54:55] op_sel_hi:[1,0,1]
    v_pk_fma_f32 v[58:59], v[74:75], s[38:39], v[58:59] op_sel_hi:[1,0,1]
    v_pk_fma_f32 v[60:61], v[76:77], s[38:39], v[60:61] op_sel_hi:[1,0,1]
    v_pk_fma_f32 v[62:63], v[78:79], s[38:39], v[62:63] op_sel_hi:[1,0,1]
    v_pk_fma_f32 v[56:57], v[72:73], s[38:39], v[56:57] op_sel_hi:[1,0,1]
    v_cvt_pk_bf16_f32 v80, v48, v49
    v_cvt_pk_bf16_f32 v81, v50, v51
    v_cvt_pk_bf16_f32 v82, v52, v53
    v_cvt_pk_bf16_f32 v83, v54, v55
    v_cvt_pk_bf16_f32 v85, v58, v59
    v_cvt_pk_bf16_f32 v86, v60, v61
    v_cvt_pk_bf16_f32 v87, v62, v63
    v_cvt_pk_bf16_f32 v84, v56, v57
    v_dot2c_f32_bf16 v2, s37, v80
    v_dot2c_f32_bf16 v3, v80, v80
    v_dot2c_f32_bf16 v4, v80, v28
    v_dot2c_f32_bf16 v2, s37, v81
    v_dot2c_f32_bf16 v3, v81, v81
    v_dot2c_f32_bf16 v4, v81, v29
    v_dot2c_f32_bf16 v2, s37, v82
    v_dot2c_f32_bf16 v3, v82, v82
    v_dot2c_f32_bf16 v4, v82, v30
    v_dot2c_f32_bf16 v2, s37, v83
    v_dot2c_f32_bf16 v3, v83, v83
    v_dot2c_f32_bf16 v4, v83, v31
    v_dot2c_f32_bf16 v2, s37, v85
    v_dot2c_f32_bf16 v3, v85, v85
    v_dot2c_f32_bf16 v4, v85, v33
    v_dot2c_f32_bf16 v2, s37, v86
    v_dot2c_f32_bf16 v3, v86, v86
    v_dot2c_f32_bf16 v4, v86, v34
    v_dot2c_f32_bf16 v2, s37, v87
    v_dot2c_f32_bf16 v3, v87, v87
    v_dot2c_f32_bf16 v4, v87, v35
    v_dot2c_f32_bf16 v2, s37, v84
    v_dot2c_f32_bf16 v3, v84, v84
    v_dot2c_f32_bf16 v4, v84, v32
    s_nop 2
    v_permlane32_swap_b32 v2, v4
    v_permlane32_swap_b32 v3, v7
    v_add_f32 v2, v2, v4
    v_add_f32 v3, v3, v7
    s_nop 1
    v_permlane16_swap_b32 v2, v3
    v_add_f32 v2, v2, v3
    s_nop 1
    v_add_f32_dpp v2, v2, v2 quad_perm:[1,0,3,2] row_mask:0xf bank_mask:0xf
    s_nop 1
    v_add_f32_dpp v2, v2, v2 quad_perm:[2,3,0,1] row_mask:0xf bank_mask:0xf
    s_nop 1
    v_add_f32_dpp v2, v2, v2 row_half_mirror row_mask:0xf bank_mask:0xf
    s_nop 1
    v_add_f32_dpp v2, v2, v2 row_mirror row_mask:0xf bank_mask:0xf
    s_nop 0
    v_readlane_b32 s13, v2, 32
    v_mov_b32_dpp v8, v2 row_bcast:15 row_mask:0xa bank_mask:0xf
    v_mul_f32 v9, 0x3a800000, v2
    v_mul_f32 v8, 0x3a800000, v8
    v_fma_f32 v9, -v8, v8, v9
    v_max_f32 v9, 0, v9
    v_cvt_pk_bf16_f32 v9, 0, v9
    v_cvt_pk_bf16_f32 v8, 0, v8
    v_add_f32 v9, 0x3727c5ac, v9
    v_cvt_pk_bf16_f32 v9, 0, v9
    v_sqrt_f32 v9, v9
    s_nop 0
    v_cvt_pk_bf16_f32 v9, 0, v9
    v_rcp_f32 v9, v9
    v_mov_b32 v10, s13
    v_fma_f32 v10, -v8, s39, v10
    v_mul_f32 v10, v10, v9
    v_mul_f32 v8, v8, v9
    v_readlane_b32 s43, v10, 16
    v_readlane_b32 s4, v9, 16
    v_readlane_b32 s6, v8, 16
    s_ashr_i32 s13, s43, 31
    s_or_b32 s13, s13, 0x80000000
    s_xor_b32 s43, s43, s13
    s_and_b32 s43, s43, 0xfffff800
    s_or_b32 s43, s43, s19
    s_min_u32 s43, s43, -2
    v_mov_b32 v2, s43
    s_mov_b64 exec, 1
    ds_max_u32 v12, v2
    s_mov_b64 exec, -1
    v_mov_b32 v10, s6
    v_add_f32 v8, 1.0, v9
    v_lshlrev_b32 v4, 12, v15
    s_lshl_b32 s17, s3, 4
    s_add_u32 s17, s17, 0x9000
    v_readlane_b32 s14, v8, 16
    s_waitcnt lgkmcnt(0)
    s_barrier
    ds_read_b32 v3, v12
    v_lshlrev_b32 v48, 16, v80
    v_and_b32 v49, s36, v80
    v_lshlrev_b32 v50, 16, v81
    v_and_b32 v51, s36, v81
    v_lshlrev_b32 v52, 16, v82
    v_and_b32 v53, s36, v82
    v_lshlrev_b32 v54, 16, v83
    v_and_b32 v55, s36, v83
    v_lshlrev_b32 v56, 16, v84
    v_and_b32 v57, s36, v84
    v_lshlrev_b32 v58, 16, v85
    v_and_b32 v59, s36, v85
    v_lshlrev_b32 v60, 16, v86
    v_and_b32 v61, s36, v86
    v_lshlrev_b32 v62, 16, v87
    v_and_b32 v63, s36, v87
    s_waitcnt lgkmcnt(0)
    v_readfirstlane_b32 s13, v3
    s_nop 1
    s_cmp_lg_u32 s13, s43
    s_cbranch_scc1 fk_other
    s_mov_b64 exec, 0xff
    buffer_store_dword v2, v4, s[24:27], s17 offen sc1
    s_mov_b64 exec, -1
    v_pk_fma_f32 v[64:65], v[48:49], s[4:5], v[10:11] op_sel_hi:[1,0,0] neg_lo:[0,0,1] neg_hi:[0,0,1]
    v_pk_fma_f32 v[66:67], v[50:51], s[4:5], v[10:11] op_sel_hi:[1,0,0] neg_lo:[0,0,1] neg_hi:[0,0,1]
    v_pk_fma_f32 v[68:69], v[52:53], s[4:5], v[10:11] op_sel_hi:[1,0,0] neg_lo:[0,0,1] neg_hi:[0,0,1]
    v_pk_fma_f32 v[70:71], v[54:55], s[4:5], v[10:11] op_sel_hi:[1,0,0] neg_lo:[0,0,1] neg_hi:[0,0,1]
    v_pk_fma_f32 v[72:73], v[56:57], s[4:5], v[10:11] op_sel_hi:[1,0,0] neg_lo:[0,0,1] neg_hi:[0,0,1]
    v_pk_fma_f32 v[74:75], v[58:59], s[4:5], v[10:11] op_sel_hi:[1,0,0] neg_lo:[0,0,1] neg_hi:[0,0,1]
    v_pk_fma_f32 v[76:77], v[60:61], s[4:5], v[10:11] op_sel_hi:[1,0,0] neg_lo:[0,0,1] neg_hi:[0,0,1]
    v_pk_fma_f32 v[78:79], v[62:63], s[4:5], v[10:11] op_sel_hi:[1,0,0] neg_lo:[0,0,1] neg_hi:[0,0,1]
    v_cvt_pk_bf16_f32 v96, v64, v65
    v_cvt_pk_bf16_f32 v97, v66, v67
    v_cvt_pk_bf16_f32 v98, v68, v69
    v_cvt_pk_bf16_f32 v99, v70, v71
    v_cvt_pk_bf16_f32 v100, v72, v73
    v_cvt_pk_bf16_f32 v101, v74, v75
    v_cvt_pk_bf16_f32 v102, v76, v77
    v_cvt_pk_bf16_f32 v103, v78, v79
    v_min_u32 v96, -2, v96
    v_min_u32 v97, -2, v97
    v_min_u32 v98, -2, v98
    v_min_u32 v99, -2, v99
    v_min_u32 v100, -2, v100
    v_min_u32 v101, -2, v101
    v_min_u32 v102, -2, v102
    v_min_u32 v103, -2, v103
    s_lshl_b32 s13, s3, 12
    s_add_u32 s13, s13, 0x80000
    buffer_store_dwordx4 v[96:99], v14, s[24:27], s13 offen sc1
    buffer_store_dwordx4 v[100:103], v14, s[24:27], s13 offen offset:1024 sc1
    v_min_u32 v80, -2, v80
    v_min_u32 v81, -2, v81
    v_min_u32 v82, -2, v82
    v_min_u32 v83, -2, v83
    v_min_u32 v84, -2, v84
    v_min_u32 v85, -2, v85
    v_min_u32 v86, -2, v86
    v_min_u32 v87, -2, v87
    buffer_store_dwordx4 v[80:83], v14, s[24:27], s13 offen offset:2048 sc1
    buffer_store_dwordx4 v[84:87], v14, s[24:27], s13 offen offset:3072 sc1
    v_pk_fma_f32 v[64:65], v[48:49], s[14:15], v[10:11] op_sel_hi:[1,0,0] neg_lo:[0,0,1] neg_hi:[0,0,1]
    v_pk_fma_f32 v[66:67], v[50:51], s[14:15], v[10:11] op_sel_hi:[1,0,0] neg_lo:[0,0,1] neg_hi:[0,0,1]
    v_pk_fma_f32 v[68:69], v[52:53], s[14:15], v[10:11] op_sel_hi:[1,0,0] neg_lo:[0,0,1] neg_hi:[0,0,1]
    v_pk_fma_f32 v[70:71], v[54:55], s[14:15], v[10:11] op_sel_hi:[1,0,0] neg_lo:[0,0,1] neg_hi:[0,0,1]
    v_pk_fma_f32 v[72:73], v[56:57], s[14:15], v[10:11] op_sel_hi:[1,0,0] neg_lo:[0,0,1] neg_hi:[0,0,1]
    v_pk_fma_f32 v[74:75], v[58:59], s[14:15], v[10:11] op_sel_hi:[1,0,0] neg_lo:[0,0,1] neg_hi:[0,0,1]
    v_pk_fma_f32 v[76:77], v[60:61], s[14:15], v[10:11] op_sel_hi:[1,0,0] neg_lo:[0,0,1] neg_hi:[0,0,1]
    v_pk_fma_f32 v[78:79], v[62:63], s[14:15], v[10:11] op_sel_hi:[1,0,0] neg_lo:[0,0,1] neg_hi:[0,0,1]
    v_cvt_pk_bf16_f32 v112, v64, v65
    v_cvt_pk_bf16_f32 v113, v66, v67
    v_cvt_pk_bf16_f32 v114, v68, v69
    v_cvt_pk_bf16_f32 v115, v70, v71
    v_cvt_pk_bf16_f32 v116, v72, v73
    v_cvt_pk_bf16_f32 v117, v74, v75
    v_cvt_pk_bf16_f32 v118, v76, v77
    v_cvt_pk_bf16_f32 v119, v78, v79
    v_lshrrev_b32 v1, 4, v15
    v_bfe_u32 v2, v15, 2, 2
    v_lshl_add_u32 v8, v1, 3, v2
    v_lshlrev_b32 v8, 7, v8
    v_and_b32 v3, 2, v2
    v_xor_b32 v9, s16, v3
    v_and_b32 v3, 1, v1
    v_lshlrev_b32 v4, 2, v3
    v_xor_b32 v9, v4, v9
    v_lshl_add_u32 v8, v9, 4, v8
    v_and_b32 v9, 1, v15
    v_lshl_add_u32 v8, v9, 3, v8
    v_bfe_u32 v9, v15, 1, 1
    v_lshl_add_u32 v8, v9, 15, v8
    v_lshrrev_b32 v7, 1, v1
    v_lshl_add_u32 v7, v7, 3, v2
    v_lshlrev_b32 v7, 9, v7
    v_lshl_add_u32 v7, v3, 5, v7
    v_and_b32 v3, 3, v15
    v_lshl_add_u32 v7, v3, 3, v7
    s_lshl_b32 s15, s16, 6
    s_add_u32 s15, s15, 65536
    v_add_u32 v7, s15, v7
    v_lshlrev_b32 v9, 4, v1
    v_add_u32 v9, 157312, v9
    s_and_b32 s13, s2, 7
    s_lshl_b32 s13, s13, 12
    s_add_u32 s13, s13, 0x9000
    s_mov_b32 s42, 0
    s_waitcnt vmcnt(4)
    v_mov_b32 v1, 157872
    v_mov_b32 v2, 1
    s_mov_b64 exec, 1
    ds_add_u32 v1, v2
    s_mov_b64 exec, -1
    s_nop 1
fk_pollk:
    buffer_load_dword v180, v14, s[24:27], s13 offen offset:0 sc1
    buffer_load_dword v181, v14, s[24:27], s13 offen offset:1024 sc1
    buffer_load_dword v182, v14, s[24:27], s13 offen offset:2048 sc1
    buffer_load_dword v183, v14, s[24:27], s13 offen offset:3072 sc1
    s_add_u32 s42, s42, 1
    s_waitcnt vmcnt(0)
    v_max3_u32 v3, v180, v181, v182
    v_max_u32 v3, v3, v183
    v_cmp_eq_u32 vcc, -1, v3
    s_cmp_gt_u32 s42, 0x40000
    s_cbranch_scc1 fk_gotk
    s_cbranch_vccnz fk_pollk
    s_nop 1
fk_gotk:
    v_max_u32_dpp v3, v3, v3 quad_perm:[1,0,3,2] row_mask:0xf bank_mask:0xf
    s_nop 1
    v_max_u32_dpp v3, v3, v3 quad_perm:[2,3,0,1] row_mask:0xf bank_mask:0xf
    s_nop 1
    v_max_u32_dpp v3, v3, v3 row_half_mirror row_mask:0xf bank_mask:0xf
    s_nop 1
    v_max_u32_dpp v3, v3, v3 row_mirror row_mask:0xf bank_mask:0xf
    s_nop 1
    v_max_u32_dpp v3, v3, v3 row_bcast:15 row_mask:0xa bank_mask:0xf
    s_nop 1
    v_max_u32_dpp v3, v3, v3 row_bcast:31 row_mask:0xc bank_mask:0xf
    s_nop 0
    v_readlane_b32 s40, v3, 63
    v_mov_b32 v4, 157136
    s_nop 0
    s_bfe_u32 s13, s40, 0x80003
    s_lshl_b32 s13, s13, 12
    s_and_b32 s14, s3, 3
    s_lshl_b32 s14, s14, 9
    s_add_u32 s13, s13, s14
    s_add_u32 s13, s13, 0x80000
    v_lshlrev_b32 v5, 3, v15
    v_mov_b32 v3, s40
    s_cmp_gt_u32 s3, 223
    s_cbranch_scc1 fk_norow
    s_mov_b32 s42, 0
    buffer_load_dwordx2 v[180:181], v5, s[24:27], s13 offen sc1
    s_nop 0
fk_landa:
    ds_read_b32 v2, v1
    s_waitcnt lgkmcnt(0)
    v_readfirstlane_b32 s15, v2
    s_nop 1
    s_cmp_lt_u32 s15, 8
    s_cbranch_scc1 fk_landa
    ds_read_b64_tr_b16 v[128:129], v8 offset:0
    ds_read_b64_tr_b16 v[130:131], v8 offset:512
    ds_read_b64_tr_b16 v[132:133], v8 offset:4096
    ds_read_b64_tr_b16 v[134:135], v8 offset:4608
    ds_read_b64_tr_b16 v[136:137], v8 offset:8192
    ds_read_b64_tr_b16 v[138:139], v8 offset:8704
    ds_read_b64_tr_b16 v[140:141], v8 offset:12288
    ds_read_b64_tr_b16 v[142:143], v8 offset:12800
    ds_read_b64_tr_b16 v[144:145], v8 offset:16384
    ds_read_b64_tr_b16 v[146:147], v8 offset:16896
    ds_read_b64_tr_b16 v[148:149], v8 offset:20480
    ds_read_b64_tr_b16 v[150:151], v8 offset:20992
    s_waitcnt lgkmcnt(4)
    ds_read_b64_tr_b16 v[152:153], v8 offset:24576
    ds_read_b64_tr_b16 v[154:155], v8 offset:25088
    ds_read_b64_tr_b16 v[156:157], v8 offset:28672
    ds_read_b64_tr_b16 v[158:159], v8 offset:29184
    s_branch fk_chkr
    s_nop 0
fk_pollr:
    buffer_load_dwordx2 v[180:181], v5, s[24:27], s13 offen sc1
fk_chkr:
    s_add_u32 s42, s42, 1
    s_waitcnt vmcnt(0)
    v_max_u32 v6, v180, v181
    v_cmp_eq_u32 vcc, -1, v6
    s_cmp_gt_u32 s42, 0x40000
    s_cbranch_scc1 fk_gotr
    s_cbranch_vccnz fk_pollr
    s_nop 1
fk_gotr:
    v_add_u32 v5, 157312, v5
    ds_write_b64 v5, v[180:181]
    s_nop 3
fk_norow:
    ds_write_b32 v4, v3
    s_waitcnt lgkmcnt(0)
    s_barrier
    s_cmp_eq_u32 s40, s43
    s_cselect_b32 s22, 0x400000, s22
    s_branch fk_ffn
    s_nop 0
fk_other:
    v_pk_fma_f32 v[64:65], v[48:49], s[14:15], v[10:11] op_sel_hi:[1,0,0] neg_lo:[0,0,1] neg_hi:[0,0,1]
    v_pk_fma_f32 v[66:67], v[50:51], s[14:15], v[10:11] op_sel_hi:[1,0,0] neg_lo:[0,0,1] neg_hi:[0,0,1]
    v_pk_fma_f32 v[68:69], v[52:53], s[14:15], v[10:11] op_sel_hi:[1,0,0] neg_lo:[0,0,1] neg_hi:[0,0,1]
    v_pk_fma_f32 v[70:71], v[54:55], s[14:15], v[10:11] op_sel_hi:[1,0,0] neg_lo:[0,0,1] neg_hi:[0,0,1]
    v_pk_fma_f32 v[72:73], v[56:57], s[14:15], v[10:11] op_sel_hi:[1,0,0] neg_lo:[0,0,1] neg_hi:[0,0,1]
    v_pk_fma_f32 v[74:75], v[58:59], s[14:15], v[10:11] op_sel_hi:[1,0,0] neg_lo:[0,0,1] neg_hi:[0,0,1]
    v_pk_fma_f32 v[76:77], v[60:61], s[14:15], v[10:11] op_sel_hi:[1,0,0] neg_lo:[0,0,1] neg_hi:[0,0,1]
    v_pk_fma_f32 v[78:79], v[62:63], s[14:15], v[10:11] op_sel_hi:[1,0,0] neg_lo:[0,0,1] neg_hi:[0,0,1]
    v_cvt_pk_bf16_f32 v112, v64, v65
    v_cvt_pk_bf16_f32 v113, v66, v67
    v_cvt_pk_bf16_f32 v114, v68, v69
    v_cvt_pk_bf16_f32 v115, v70, v71
    v_cvt_pk_bf16_f32 v116, v72, v73
    v_cvt_pk_bf16_f32 v117, v74, v75
    v_cvt_pk_bf16_f32 v118, v76, v77
    v_cvt_pk_bf16_f32 v119, v78, v79
    s_and_b32 s13, s13, 7
    s_cmp_gt_u32 s16, s13
    s_cselect_b32 s13, 1, 0
    s_sub_u32 s17, s16, s13
    s_waitcnt vmcnt(0)
    v_lshrrev_b32 v1, 4, v15
    v_bfe_u32 v2, v15, 2, 2
    v_lshl_add_u32 v8, v1, 3, v2
    v_lshlrev_b32 v8, 7, v8
    v_and_b32 v3, 2, v2
    v_xor_b32 v9, s16, v3
    v_and_b32 v3, 1, v1
    v_lshlrev_b32 v4, 2, v3
    v_xor_b32 v9, v4, v9
    v_lshl_add_u32 v8, v9, 4, v8
    v_and_b32 v9, 1, v15
    v_lshl_add_u32 v8, v9, 3, v8
    v_bfe_u32 v9, v15, 1, 1
    v_lshl_add_u32 v8, v9, 15, v8
    v_lshrrev_b32 v7, 1, v1
    v_lshl_add_u32 v7, v7, 3, v2
    v_lshlrev_b32 v7, 9, v7
    v_lshl_add_u32 v7, v3, 5, v7
    v_and_b32 v3, 3, v15
    v_lshl_add_u32 v7, v3, 3, v7
    s_lshl_b32 s15, s16, 6
    s_add_u32 s15, s15, 65536
    v_add_u32 v7, s15, v7
    v_lshlrev_b32 v9, 4, v1
    v_add_u32 v9, 157312, v9
    v_mov_b32 v1, 157872
    v_mov_b32 v2, 1
    s_mov_b64 exec, 1
    ds_add_u32 v1, v2
    s_mov_b64 exec, -1
    s_cmp_gt_u32 s3, 223
    s_cbranch_scc1 fk_win3
    s_mul_i32 s15, s17, 4
    s_add_u32 s15, s15, 68
    s_mov_b32 s58, 0x700000
    s_mov_b32 s59, 0x00020000
    s_cmp_gt_u32 s15, 95
    s_cbranch_scc1 fk_win3
    s_lshl_b32 s12, s15, 10
    s_mov_b32 m0, s12
    s_and_b32 s14, s12, 1024
    s_lshr_b32 s14, s14, 4
    v_xor_b32 v209, s14, v208
    s_cmp_lt_u32 s15, 32
    s_cselect_b64 s[56:57], s[44:45], s[48:49]
    s_and_b32 s14, s15, 31
    s_mul_i32 s13, s14, 57344
    s_add_u32 s13, s13, s100
    s_lshl_b32 s14, s14, 12
    s_add_u32 s14, s14, s101
    s_cmp_lt_u32 s15, 64
    s_cselect_b64 s[56:57], s[56:57], s[52:53]
    s_cselect_b32 s13, s13, s14
    s_cselect_b64 vcc, -1, 0
    v_cndmask_b32 v209, v210, v209, vcc
    s_add_u32 s15, s15, 1
    buffer_load_dwordx4 v209, s[56:59], s13 offen lds
    s_cmp_gt_u32 s15, 95
    s_cbranch_scc1 fk_win3
    s_lshl_b32 s12, s15, 10
    s_mov_b32 m0, s12
    s_and_b32 s14, s12, 1024
    s_lshr_b32 s14, s14, 4
    v_xor_b32 v209, s14, v208
    s_cmp_lt_u32 s15, 32
    s_cselect_b64 s[56:57], s[44:45], s[48:49]
    s_and_b32 s14, s15, 31
    s_mul_i32 s13, s14, 57344
    s_add_u32 s13, s13, s100
    s_lshl_b32 s14, s14, 12
    s_add_u32 s14, s14, s101
    s_cmp_lt_u32 s15, 64
    s_cselect_b64 s[56:57], s[56:57], s[52:53]
    s_cselect_b32 s13, s13, s14
    s_cselect_b64 vcc, -1, 0
    v_cndmask_b32 v209, v210, v209, vcc
    s_add_u32 s15, s15, 1
    buffer_load_dwordx4 v209, s[56:59], s13 offen lds
    s_cmp_gt_u32 s15, 95
    s_cbranch_scc1 fk_win3
    s_lshl_b32 s12, s15, 10
    s_mov_b32 m0, s12
    s_and_b32 s14, s12, 1024
    s_lshr_b32 s14, s14, 4
    v_xor_b32 v209, s14, v208
    s_cmp_lt_u32 s15, 32
    s_cselect_b64 s[56:57], s[44:45], s[48:49]
    s_and_b32 s14, s15, 31
    s_mul_i32 s13, s14, 57344
    s_add_u32 s13, s13, s100
    s_lshl_b32 s14, s14, 12
    s_add_u32 s14, s14, s101
    s_cmp_lt_u32 s15, 64
    s_cselect_b64 s[56:57], s[56:57], s[52:53]
    s_cselect_b32 s13, s13, s14
    s_cselect_b64 vcc, -1, 0
    v_cndmask_b32 v209, v210, v209, vcc
    s_add_u32 s15, s15, 1
    buffer_load_dwordx4 v209, s[56:59], s13 offen lds
    s_cmp_gt_u32 s15, 95
    s_cbranch_scc1 fk_win3
    s_lshl_b32 s12, s15, 10
    s_mov_b32 m0, s12
    s_and_b32 s14, s12, 1024
    s_lshr_b32 s14, s14, 4
    v_xor_b32 v209, s14, v208
    s_cmp_lt_u32 s15, 32
    s_cselect_b64 s[56:57], s[44:45], s[48:49]
    s_and_b32 s14, s15, 31
    s_mul_i32 s13, s14, 57344
    s_add_u32 s13, s13, s100
    s_lshl_b32 s14, s14, 12
    s_add_u32 s14, s14, s101
    s_cmp_lt_u32 s15, 64
    s_cselect_b64 s[56:57], s[56:57], s[52:53]
    s_cselect_b32 s13, s13, s14
    s_cselect_b64 vcc, -1, 0
    v_cndmask_b32 v209, v210, v209, vcc
    s_add_u32 s15, s15, 1
    buffer_load_dwordx4 v209, s[56:59], s13 offen lds
    s_nop 2
fk_win3:
fk_landb:
    ds_read_b32 v2, v1
    s_waitcnt lgkmcnt(0)
    v_readfirstlane_b32 s15, v2
    s_nop 1
    s_cmp_lt_u32 s15, 8
    s_cbranch_scc1 fk_landb
    ds_read_b64_tr_b16 v[128:129], v8 offset:0
    ds_read_b64_tr_b16 v[130:131], v8 offset:512
    ds_read_b64_tr_b16 v[132:133], v8 offset:4096
    ds_read_b64_tr_b16 v[134:135], v8 offset:4608
    ds_read_b64_tr_b16 v[136:137], v8 offset:8192
    ds_read_b64_tr_b16 v[138:139], v8 offset:8704
    ds_read_b64_tr_b16 v[140:141], v8 offset:12288
    ds_read_b64_tr_b16 v[142:143], v8 offset:12800
    ds_read_b64_tr_b16 v[144:145], v8 offset:16384
    ds_read_b64_tr_b16 v[146:147], v8 offset:16896
    ds_read_b64_tr_b16 v[148:149], v8 offset:20480
    ds_read_b64_tr_b16 v[150:151], v8 offset:20992
    s_waitcnt lgkmcnt(4)
    ds_read_b64_tr_b16 v[152:153], v8 offset:24576
    ds_read_b64_tr_b16 v[154:155], v8 offset:25088
    ds_read_b64_tr_b16 v[156:157], v8 offset:28672
    ds_read_b64_tr_b16 v[158:159], v8 offset:29184
    s_waitcnt lgkmcnt(0)
    s_barrier
    s_nop 0
fk_ffn:
    buffer_store_dwordx4 v[112:115], v14, s[28:31], s22 offen nt
    buffer_store_dwordx4 v[116:119], v14, s[28:31], s22 offen offset:1024 nt
    s_cmp_gt_u32 s3, 223
    s_cbranch_scc1 fk_fin
    ds_read_b128 v[16:19], v9 offset:0
    ds_read_b128 v[20:23], v9 offset:64
    ds_read_b128 v[24:27], v9 offset:128
    ds_read_b128 v[28:31], v9 offset:192
    ds_read_b128 v[32:35], v9 offset:256
    ds_read_b128 v[36:39], v9 offset:320
    ds_read_b128 v[40:43], v9 offset:384
    ds_read_b128 v[44:47], v9 offset:448
    v_mov_b32 v3, 157136
    ds_read_b32 v12, v3
    v_lshlrev_b32 v4, 3, v15
    s_lshl_b32 s13, s3, 9
    s_lshl_b32 s14, s16, 6
    s_add_u32 s13, s13, s14
    s_add_u32 s13, s13, 0x13000
    s_waitcnt lgkmcnt(8)
    v_mfma_f32_16x16x32_bf16 v[176:179], v[16:19], v[128:131], 0
    s_waitcnt lgkmcnt(7)
    v_mfma_f32_16x16x32_bf16 v[176:179], v[20:23], v[132:135], v[176:179]
    s_waitcnt lgkmcnt(6)
    v_mfma_f32_16x16x32_bf16 v[176:179], v[24:27], v[136:139], v[176:179]
    s_waitcnt lgkmcnt(5)
    v_mfma_f32_16x16x32_bf16 v[176:179], v[28:31], v[140:143], v[176:179]
    s_waitcnt lgkmcnt(4)
    v_mfma_f32_16x16x32_bf16 v[176:179], v[32:35], v[144:147], v[176:179]
    s_waitcnt lgkmcnt(3)
    v_mfma_f32_16x16x32_bf16 v[176:179], v[36:39], v[148:151], v[176:179]
    s_waitcnt lgkmcnt(2)
    v_mfma_f32_16x16x32_bf16 v[176:179], v[40:43], v[152:155], v[176:179]
    s_waitcnt lgkmcnt(1)
    v_mfma_f32_16x16x32_bf16 v[176:179], v[44:47], v[156:159], v[176:179]
    v_lshlrev_b32 v5, 3, v15
    v_lshlrev_b32 v6, 2, v15
    v_lshrrev_b32 v9, 5, v15
    v_lshlrev_b32 v9, 4, v9
    v_add_u32 v9, 157184, v9
    s_lshl_b32 s41, s3, 10
    s_lshl_b32 s14, s16, 7
    s_add_u32 s41, s41, s14
    s_add_u32 s41, s41, 0x30000
    v_min_u32 v176, -2, v176
    s_nop 1
    v_mov_b32_dpp v177, v176 row_shl:8 row_mask:0xf bank_mask:0xf
    v_mov_b32_dpp v178, v176 row_shl:1 row_mask:0xf bank_mask:0xf
    v_mov_b32_dpp v179, v176 row_shl:9 row_mask:0xf bank_mask:0xf
    s_mov_b64 exec, 0x55
    buffer_store_dwordx4 v[176:179], v4, s[24:27], s13 offen sc1
    s_mov_b64 exec, -1
    v_mov_b32 v1, 157876
    v_mov_b32 v8, 1
    s_cmp_eq_u32 s16, 7
    s_cbranch_scc1 fk_c1
    s_cmp_lg_u32 s16, 0
    s_cbranch_scc1 fk_bd
    s_lshr_b32 s13, s3, 2
    s_lshl_b32 s13, s13, 11
    s_add_u32 s13, s13, 0x13000
    s_mov_b32 s42, 0
    v_lshrrev_b32 v10, 2, v5
    v_add_u32 v10, 157184, v10
    s_waitcnt vmcnt(0)
    s_mov_b64 exec, 1
    ds_add_u32 v1, v8
    s_mov_b64 exec, -1
    s_nop 0
fk_poll1:
    buffer_load_dwordx2 v[184:185], v5, s[24:27], s13 offen offset:0 sc1
    buffer_load_dwordx2 v[186:187], v5, s[24:27], s13 offen offset:512 sc1
    buffer_load_dwordx2 v[188:189], v5, s[24:27], s13 offen offset:1024 sc1
    buffer_load_dwordx2 v[190:191], v5, s[24:27], s13 offen offset:1536 sc1
    s_add_u32 s42, s42, 1
    s_waitcnt vmcnt(0)
    v_max3_u32 v11, v184, v185, v186
    v_max3_u32 v11, v11, v187, v188
    v_max3_u32 v11, v11, v189, v190
    v_max_u32 v11, v11, v191
    v_cmp_eq_u32 vcc, -1, v11
    s_cmp_gt_u32 s42, 0x40000
    s_cbranch_scc1 fk_got1
    s_cbranch_vccnz fk_poll1
    s_nop 1
fk_got1:
    v_pk_add_f32 v[184:185], v[184:185], v[186:187]
    v_pk_add_f32 v[188:189], v[188:189], v[190:191]
    v_pk_add_f32 v[184:185], v[184:185], v[188:189]
    v_cvt_pk_bf16_f32 v184, 0, v184
    v_cvt_pk_bf16_f32 v185, 0, v185
    v_mul_f32 v186, 0xbfb8aa3b, v184
    v_exp_f32 v186, v186
    s_nop 0
    v_add_f32 v186, 1.0, v186
    v_rcp_f32 v186, v186
    s_nop 0
    v_mul_f32 v184, v184, v186
    v_cvt_pk_bf16_f32 v184, 0, v184
    v_mul_f32 v184, v184, v185
    v_cvt_pk_bf16_f32 v184, 0, v184
    ds_write_b16_d16_hi v10, v184
    s_nop 3
fk_dla:
    ds_read_b32 v13, v1
    s_waitcnt lgkmcnt(0)
    v_readfirstlane_b32 s15, v13
    s_nop 1
    s_cmp_lt_u32 s15, 8
    s_cbranch_scc1 fk_dla
    ds_read_b64_tr_b16 v[160:161], v7 offset:0
    ds_read_b64_tr_b16 v[162:163], v7 offset:2048
    ds_read_b64_tr_b16 v[164:165], v7 offset:8192
    ds_read_b64_tr_b16 v[166:167], v7 offset:10240
    ds_read_b64_tr_b16 v[168:169], v7 offset:16384
    ds_read_b64_tr_b16 v[170:171], v7 offset:18432
    ds_read_b64_tr_b16 v[172:173], v7 offset:24576
    ds_read_b64_tr_b16 v[174:175], v7 offset:26624
    s_branch fk_wait1
    s_nop 0
fk_c1:
    s_cmp_gt_u32 s3, 127
    s_cbranch_scc1 fk_bd
    s_waitcnt lgkmcnt(0)
    v_readfirstlane_b32 s40, v12
    v_lshrrev_b32 v10, 4, v15
    v_and_b32 v11, 1, v15
    v_lshl_add_u32 v12, v11, 2, v10
    v_lshlrev_b32 v12, 1, v12
    v_and_b32 v11, 12, v12
    v_and_b32 v10, 1, v10
    s_bfe_u32 s13, s40, 0x80003
    s_lshl_b32 s14, s13, 12
    s_lshl_b32 s15, s3, 4
    s_add_u32 s14, s14, s15
    s_add_u32 s14, s14, 0x80000
    s_mov_b32 s42, 0
    s_nop 0
fk_pollh:
    buffer_load_dword v2, v11, s[24:27], s14 offen sc1
    buffer_load_dword v3, v11, s[24:27], s14 offen offset:2048 sc1
    s_add_u32 s42, s42, 1
    s_waitcnt vmcnt(0)
    v_max_u32 v4, v2, v3
    v_cmp_eq_u32 vcc, -1, v4
    s_cmp_gt_u32 s42, 0x40000
    s_cbranch_scc1 fk_goth
    s_cbranch_vccnz fk_pollh
    s_nop 1
fk_goth:
    v_cmp_eq_u32 vcc, 1, v10
    v_lshlrev_b32 v4, 16, v2
    v_and_b32 v2, s36, v2
    v_cndmask_b32 v2, v4, v2, vcc
    v_lshlrev_b32 v4, 16, v3
    v_and_b32 v3, s36, v3
    v_cndmask_b32 v3, v4, v3, vcc
    s_lshr_b32 s14, s13, 4
    s_add_u32 s14, s14, 1
    s_cmp_ge_u32 s13, 248
    s_cselect_b32 s14, 0, s14
    s_cmp_ge_u32 s13, 240
    s_cselect_b32 s15, 7, 15
    s_and_b32 s15, s15, s13
    s_lshl_b32 s15, s15, 7
    s_add_u32 s14, s14, s15
    s_and_b32 s13, s40, 7
    s_sub_u32 s15, 7, s13
    s_min_u32 s15, s15, s13
    s_lshl_b32 s15, s15, 5
    s_add_u32 s14, s14, s15
    s_sub_u32 s15, 2048, s14
    s_and_b32 s15, s15, 2047
    s_cmp_lt_u32 s13, 4
    s_cselect_b32 s14, s14, s15
    s_and_b32 s13, s40, 0x7ff
    s_cmp_eq_u32 s13, 1991
    s_cselect_b32 s14, 1024, s14
    s_lshl_b32 s21, s14, 11
    s_lshl_b32 s15, s3, 4
    s_add_u32 s21, s21, s15
    s_ashr_i32 s13, s40, 31
    s_not_b32 s13, s13
    s_or_b32 s13, s13, 0x80000000
    s_xor_b32 s13, s40, s13
    s_and_b32 s13, s13, 0xfffff800
    v_mov_b32 v11, s13
    v_cvt_pk_bf16_f32 v11, 0, v11
    v_mul_f32 v11, 0xbfb8aa3b, v11
    v_exp_f32 v11, v11
    s_nop 0
    v_add_f32 v11, 1.0, v11
    v_rcp_f32 v11, v11
    s_nop 0
    v_cvt_pk_bf16_f32 v11, 0, v11
    v_lshrrev_b32 v4, 1, v15
    v_lshlrev_b32 v4, 12, v4
    v_and_b32 v5, 1, v15
    v_lshl_add_u32 v4, v5, 4, v4
    v_add_u32 v5, 131072, v4
    v_cmp_gt_u32 vcc, 48, v15
    s_nop 1
    v_cndmask_b32 v5, -16, v5, vcc
    s_lshl_b32 s40, s3, 5
    s_add_u32 s40, s40, 0x30000
    s_nop 2
fk_bd:
    s_waitcnt vmcnt(0)
    s_mov_b64 exec, 1
    ds_add_u32 v1, v8
    s_mov_b64 exec, -1
    s_nop 0
fk_dlb:
    ds_read_b32 v13, v1
    s_waitcnt lgkmcnt(0)
    v_readfirstlane_b32 s15, v13
    s_nop 1
    s_cmp_lt_u32 s15, 8
    s_cbranch_scc1 fk_dlb
    ds_read_b64_tr_b16 v[160:161], v7 offset:0
    ds_read_b64_tr_b16 v[162:163], v7 offset:2048
    ds_read_b64_tr_b16 v[164:165], v7 offset:8192
    ds_read_b64_tr_b16 v[166:167], v7 offset:10240
    ds_read_b64_tr_b16 v[168:169], v7 offset:16384
    ds_read_b64_tr_b16 v[170:171], v7 offset:18432
    ds_read_b64_tr_b16 v[172:173], v7 offset:24576
    ds_read_b64_tr_b16 v[174:175], v7 offset:26624
fk_wait1:
    s_waitcnt lgkmcnt(0)
    s_barrier
    ds_read_b128 v[16:19], v9 offset:0
    ds_read_b128 v[20:23], v9 offset:32
    ds_read_b128 v[24:27], v9 offset:64
    ds_read_b128 v[28:31], v9 offset:96
    s_waitcnt lgkmcnt(3)
    v_mfma_f32_32x32x16_bf16 v[192:207], v[16:19], v[160:163], 0
    s_waitcnt lgkmcnt(2)
    v_mfma_f32_32x32x16_bf16 v[192:207], v[20:23], v[164:167], v[192:207]
    s_waitcnt lgkmcnt(1)
    v_mfma_f32_32x32x16_bf16 v[192:207], v[24:27], v[168:171], v[192:207]
    s_waitcnt lgkmcnt(0)
    v_mfma_f32_32x32x16_bf16 v[192:207], v[28:31], v[172:175], v[192:207]
    s_nop 11
    v_min_u32 v192, -2, v192
    s_nop 1
    v_mov_b32_dpp v193, v192 row_shl:1 row_mask:0xf bank_mask:0xf
    v_mov_b32_dpp v194, v192 row_shl:2 row_mask:0xf bank_mask:0xf
    v_mov_b32_dpp v195, v192 row_shl:3 row_mask:0xf bank_mask:0xf
    s_mov_b32 exec_lo, 0x11111111
    s_mov_b32 exec_hi, 0
    buffer_store_dwordx4 v[192:195], v6, s[24:27], s41 offen sc1
    s_mov_b64 exec, -1
    s_cmp_lg_u32 s16, 7
    s_cbranch_scc1 fk_fin
    s_cmp_gt_u32 s3, 127
    s_cbranch_scc1 fk_fin
    s_mov_b32 s42, 0
    s_waitcnt vmcnt(0)
    s_nop 0
fk_poll2:
    buffer_load_dwordx4 v[16:19], v4, s[24:27], s40 offen sc1
    buffer_load_dwordx4 v[20:23], v5, s[24:27], s40 offen sc1
    s_add_u32 s42, s42, 1
    s_waitcnt vmcnt(0)
    v_max3_u32 v6, v16, v17, v18
    v_max3_u32 v6, v6, v19, v20
    v_max3_u32 v6, v6, v21, v22
    v_max_u32 v6, v6, v23
    v_cmp_eq_u32 vcc, -1, v6
    s_cmp_gt_u32 s42, 0x40000
    s_cbranch_scc1 fk_got2
    s_cbranch_vccnz fk_poll2
    s_nop 1
fk_got2:
    v_pk_add_f32 v[16:17], v[16:17], v[20:21]
    v_pk_add_f32 v[18:19], v[18:19], v[22:23]
    s_nop 1
    v_permlane32_swap_b32 v16, v18
    v_permlane32_swap_b32 v17, v19
    v_add_f32 v16, v16, v18
    v_add_f32 v17, v17, v19
    s_nop 1
    v_permlane16_swap_b32 v16, v17
    v_add_f32 v16, v16, v17
    s_nop 1
    v_add_f32_dpp v16, v16, v16 quad_perm:[2,3,0,1] row_mask:0xf bank_mask:0xf
    s_nop 1
    v_add_f32_dpp v16, v16, v16 row_ror:4 row_mask:0xf bank_mask:0xf
    s_nop 1
    v_add_f32_dpp v16, v16, v16 row_ror:8 row_mask:0xf bank_mask:0xf
    v_cvt_pk_bf16_f32 v16, 0, v16
    v_mul_f32 v16, v16, v11
    v_cvt_pk_bf16_f32 v16, 0, v16
    v_add_f32 v16, v16, v2
    v_cvt_pk_bf16_f32 v16, 0, v16
    v_add_f32 v16, v16, v3
    v_cvt_pk_bf16_f32 v16, 0, v16
    s_mov_b32 exec_lo, 0x00030003
    s_mov_b32 exec_hi, 0x00030003
    buffer_store_short_d16_hi v16, v12, s[28:31], s21 offen
    s_nop 1
fk_fin:
fk_end:
    s_endpgm
.section .rodata,"a"
.p2align 6
.amdhsa_kernel sequential_preLN__spectral_fnet__moe_arch_mod__prompt_kernel
  .amdhsa_next_free_vgpr 256
  .amdhsa_next_free_sgpr 102
  .amdhsa_accum_offset 256
  .amdhsa_group_segment_fixed_size 0
  .amdhsa_kernarg_size 104
  .amdhsa_user_sgpr_count 2
  .amdhsa_user_sgpr_kernarg_segment_ptr 1
  .amdhsa_system_sgpr_workgroup_id_x 1
.end_amdhsa_kernel
```

```asm
; @launch grid=(256,1,1) block=(512,1,1) lds=157952
.amdgcn_target "amdgcn-amd-amdhsa--gfx950"
.text
.globl sequential_preLN__spectral_fnet__moe_arch_mod__prompt_kernel
.p2align 8
.type sequential_preLN__spectral_fnet__moe_arch_mod__prompt_kernel,@function
sequential_preLN__spectral_fnet__moe_arch_mod__prompt_kernel:
    s_cmp_gt_u32 s2, 255
    s_cbranch_scc1 fk_end
    s_load_dwordx2 s[8:9], s[0:1], 0
    s_load_dwordx2 s[24:25], s[0:1], 96
    s_load_dwordx2 s[32:33], s[0:1], 48
    s_load_dwordx2 s[44:45], s[0:1], 56
    s_load_dwordx2 s[48:49], s[0:1], 64
    s_load_dwordx2 s[52:53], s[0:1], 72
    s_load_dwordx2 s[28:29], s[0:1], 80
    s_getpc_b64 s[40:41]
fk_pc:
    s_mov_b32 s42, fk_end-fk_pc
    s_mov_b32 s43, 0x00020000
    v_lshlrev_b32 v250, 6, v0
    buffer_load_dword v251, v250, s[40:43], 0 offen
    v_lshrrev_b32 v1, 6, v0
    v_and_b32 v15, 63, v0
    v_readfirstlane_b32 s16, v1
    s_and_b32 s3, s2, 0xe0
    s_and_b32 s17, s2, 7
    s_lshl_b32 s17, s17, 2
    s_or_b32 s3, s3, s17
    s_bfe_u32 s17, s2, 0x20003
    s_or_b32 s3, s3, s17
    s_lshr_b32 s17, s3, 4
    s_add_u32 s17, s17, 1
    s_cmp_ge_u32 s3, 248
    s_cselect_b32 s17, 0, s17
    s_cmp_ge_u32 s3, 240
    s_cselect_b32 s18, 7, 15
    s_and_b32 s18, s18, s3
    s_lshl_b32 s18, s18, 7
    s_add_u32 s18, s18, s17
    v_and_b32 v1, 31, v15
    v_lshrrev_b32 v2, 5, v15
    v_lshlrev_b32 v14, 4, v15
    s_mov_b32 s10, 0x400000
    s_mov_b32 s11, 0x00020000
    s_mov_b32 s26, 0x470000
    s_mov_b32 s27, 0x00020000
    s_mov_b32 s30, 0x400000
    s_mov_b32 s31, 0x00020000
    s_mov_b32 s34, 0x800
    s_mov_b32 s35, 0x00020000
    s_mov_b32 s46, 0x700000
    s_mov_b32 s47, 0x00020000
    s_mov_b32 s50, 0x700000
    s_mov_b32 s51, 0x00020000
    s_mov_b32 s54, 0x700000
    s_mov_b32 s55, 0x00020000
    s_cmp_eq_u32 s3, 255
    s_cselect_b32 s12, 5, 4
    s_cmp_ge_u32 s16, s12
    s_cbranch_scc1 fk_H
    s_cmp_eq_u32 s16, 4
    s_cbranch_scc1 fk_lowp
    s_setprio 3
fk_lowp:
    s_lshl_b32 s19, s16, 5
    s_add_u32 s19, s19, s18
    s_sub_u32 s20, 2048, s19
    s_and_b32 s20, s20, 2047
    s_lshl_b32 s21, s19, 11
    s_lshl_b32 s22, s20, 11
    s_lshl_b32 s12, s16, 12
    s_add_u32 s12, s12, 98304
    s_mov_b32 m0, s12
    v_mov_b32 v16, 0
    v_mov_b32 v17, 0
    v_mov_b32 v18, 0
    v_mov_b32 v19, 0
    v_mov_b32 v20, 0
    v_mov_b32 v21, 0
    v_mov_b32 v22, 0
    v_mov_b32 v23, 0
    v_mov_b32 v24, 0
    v_mov_b32 v25, 0
    v_mov_b32 v26, 0
    v_mov_b32 v27, 0
    v_mov_b32 v28, 0
    v_mov_b32 v29, 0
    v_mov_b32 v30, 0
    v_mov_b32 v31, 0
    v_mov_b32 v32, 0
    v_mov_b32 v33, 0
    v_mov_b32 v34, 0
    v_mov_b32 v35, 0
    v_mov_b32 v36, 0
    v_mov_b32 v37, 0
    v_mov_b32 v38, 0
    v_mov_b32 v39, 0
    v_mov_b32 v40, 0
    v_mov_b32 v41, 0
    v_mov_b32 v42, 0
    v_mov_b32 v43, 0
    v_mov_b32 v44, 0
    v_mov_b32 v45, 0
    v_mov_b32 v46, 0
    v_mov_b32 v47, 0
    v_cvt_f32_u32 v200, v1
    v_lshlrev_b32 v7, 2, v2
    v_cvt_f32_u32 v7, v7
    v_lshrrev_b32 v8, 1, v1
    v_and_b32 v9, 1, v1
    v_lshlrev_b32 v205, 2, v15
    v_and_b32 v205, 63, v205
    v_add_u32 v205, 157824, v205
    ds_write_b32 v205, v16
    s_waitcnt lgkmcnt(0)
    buffer_load_dwordx4 v14, s[8:11], s21 offen lds
    s_add_u32 s13, s12, 1024
    s_mov_b32 m0, s13
    s_add_u32 s14, s21, 1024
    buffer_load_dwordx4 v14, s[8:11], s14 offen lds
    s_add_u32 s13, s12, 2048
    s_mov_b32 m0, s13
    s_nop 0
    buffer_load_dwordx4 v14, s[8:11], s22 offen lds
    s_add_u32 s13, s12, 3072
    s_mov_b32 m0, s13
    s_add_u32 s14, s22, 1024
    buffer_load_dwordx4 v14, s[8:11], s14 offen lds
    s_barrier
    v_add_u32 v206, 138496, v14
    s_lshl_b32 s13, s16, 2
    s_add_u32 s13, s13, 157824
    v_mov_b32 v201, s13
    v_mov_b32 v202, 1
    s_cmp_eq_u32 s16, 1
    s_cbranch_scc1 fk_j1
    s_cmp_eq_u32 s16, 2
    s_cbranch_scc1 fk_j2
    s_cmp_eq_u32 s16, 3
    s_cbranch_scc1 fk_j3
    s_cmp_eq_u32 s16, 4
    s_cbranch_scc1 fk_jend
    v_cmp_eq_u32 vcc, 1, v1
    s_nop 1
    v_cndmask_b32 v10, v8, 16, vcc
    v_cndmask_b32 v11, v9, 0, vcc
    v_cvt_f32_u32 v10, v10
    v_cvt_f32_u32 v11, v11
    v_mul_f32 v10, 0x3d000000, v10
    v_mul_f32 v11, 0x3e800000, v11
    v_add_f32 v12, v7, v7
    v_fma_f32 v11, v10, v12, v11
    v_mov_b32 v128, v11
    v_fmamk_f32 v129, v10, 0x3f800000, v11
    v_fmamk_f32 v130, v10, 0x40000000, v11
    v_fmamk_f32 v131, v10, 0x40400000, v11
    v_fmamk_f32 v132, v10, 0x40800000, v11
    v_fmamk_f32 v133, v10, 0x40a00000, v11
    v_fmamk_f32 v134, v10, 0x40c00000, v11
    v_fmamk_f32 v135, v10, 0x40e00000, v11
    v_fmamk_f32 v136, v10, 0x41800000, v11
    v_fmamk_f32 v137, v10, 0x41880000, v11
    v_fmamk_f32 v138, v10, 0x41900000, v11
    v_fmamk_f32 v139, v10, 0x41980000, v11
    v_fmamk_f32 v140, v10, 0x41a00000, v11
    v_fmamk_f32 v141, v10, 0x41a80000, v11
    v_fmamk_f32 v142, v10, 0x41b00000, v11
    v_fmamk_f32 v143, v10, 0x41b80000, v11
    v_cos_f32 v144, v128
    v_cos_f32 v145, v129
    v_cos_f32 v146, v130
    v_cos_f32 v147, v131
    v_cos_f32 v148, v132
    v_cos_f32 v149, v133
    v_cos_f32 v150, v134
    v_cos_f32 v151, v135
    v_cos_f32 v152, v136
    v_cos_f32 v153, v137
    v_cos_f32 v154, v138
    v_cos_f32 v155, v139
    v_cos_f32 v156, v140
    v_cos_f32 v157, v141
    v_cos_f32 v158, v142
    v_cos_f32 v159, v143
    v_cvt_pk_f16_f32 v48, v144, v145
    v_cvt_pk_f16_f32 v49, v146, v147
    v_cvt_pk_f16_f32 v50, v148, v149
    v_cvt_pk_f16_f32 v51, v150, v151
    v_cvt_pk_f16_f32 v52, v152, v153
    v_cvt_pk_f16_f32 v53, v154, v155
    v_cvt_pk_f16_f32 v54, v156, v157
    v_cvt_pk_f16_f32 v55, v158, v159
    ds_write_b128 v206, v[48:51] offset:0
    ds_write_b128 v206, v[52:55] offset:1024
    s_branch fk_jsig
    s_nop 1
fk_j1:
    v_cvt_f32_u32 v10, v8
    v_lshlrev_b32 v11, 31, v9
    v_mul_f32 v10, 0x3a800000, v10
    v_xor_b32 v10, v11, v10
    v_mul_f32 v11, v10, v7
    v_mov_b32 v128, v11
    v_fmamk_f32 v129, v10, 0x3f800000, v11
    v_fmamk_f32 v130, v10, 0x40000000, v11
    v_fmamk_f32 v131, v10, 0x40400000, v11
    v_fmamk_f32 v132, v10, 0x41000000, v11
    v_fmamk_f32 v133, v10, 0x41100000, v11
    v_fmamk_f32 v134, v10, 0x41200000, v11
    v_fmamk_f32 v135, v10, 0x41300000, v11
    v_fmamk_f32 v136, v10, 0x41800000, v11
    v_fmamk_f32 v137, v10, 0x41880000, v11
    v_fmamk_f32 v138, v10, 0x41900000, v11
    v_fmamk_f32 v139, v10, 0x41980000, v11
    v_fmamk_f32 v140, v10, 0x41c00000, v11
    v_fmamk_f32 v141, v10, 0x41c80000, v11
    v_fmamk_f32 v142, v10, 0x41d00000, v11
    v_fmamk_f32 v143, v10, 0x41d80000, v11
    v_cos_f32 v56, v128
    v_cos_f32 v57, v129
    v_cos_f32 v58, v130
    v_cos_f32 v59, v131
    v_cos_f32 v60, v132
    v_cos_f32 v61, v133
    v_cos_f32 v62, v134
    v_cos_f32 v63, v135
    v_cos_f32 v64, v136
    v_cos_f32 v65, v137
    v_cos_f32 v66, v138
    v_cos_f32 v67, v139
    v_cos_f32 v68, v140
    v_cos_f32 v69, v141
    v_cos_f32 v70, v142
    v_cos_f32 v71, v143
    ds_write_b128 v206, v[56:59] offset:2048
    ds_write_b128 v206, v[60:63] offset:3072
    ds_write_b128 v206, v[64:67] offset:4096
    ds_write_b128 v206, v[68:71] offset:5120
    v_sin_f32 v72, v128
    v_sin_f32 v73, v129
    v_sin_f32 v74, v130
    v_sin_f32 v75, v131
    v_sin_f32 v76, v132
    v_sin_f32 v77, v133
    v_sin_f32 v78, v134
    v_sin_f32 v79, v135
    v_sin_f32 v80, v136
    v_sin_f32 v81, v137
    v_sin_f32 v82, v138
    v_sin_f32 v83, v139
    v_sin_f32 v84, v140
    v_sin_f32 v85, v141
    v_sin_f32 v86, v142
    v_sin_f32 v87, v143
    ds_write_b128 v206, v[72:75] offset:6144
    ds_write_b128 v206, v[76:79] offset:7168
    ds_write_b128 v206, v[80:83] offset:8192
    ds_write_b128 v206, v[84:87] offset:9216
    s_branch fk_jsig
    s_nop 0
fk_j2:
    v_mul_f32 v128, 0x3d000000, v200
    v_mul_f32 v129, v128, v7
    v_mov_b32 v130, v129
    v_fmamk_f32 v131, v128, 0x3f800000, v129
    v_fmamk_f32 v132, v128, 0x40000000, v129
    v_fmamk_f32 v133, v128, 0x40400000, v129
    v_fmamk_f32 v134, v128, 0x41000000, v129
    v_fmamk_f32 v135, v128, 0x41100000, v129
    v_fmamk_f32 v136, v128, 0x41200000, v129
    v_fmamk_f32 v137, v128, 0x41300000, v129
    v_fmamk_f32 v138, v128, 0x41800000, v129
    v_fmamk_f32 v139, v128, 0x41880000, v129
    v_fmamk_f32 v140, v128, 0x41900000, v129
    v_fmamk_f32 v141, v128, 0x41980000, v129
    v_fmamk_f32 v142, v128, 0x41c00000, v129
    v_fmamk_f32 v143, v128, 0x41c80000, v129
    v_fmamk_f32 v144, v128, 0x41d00000, v129
    v_fmamk_f32 v145, v128, 0x41d80000, v129
    v_cos_f32 v146, v130
    v_cos_f32 v147, v131
    v_cos_f32 v148, v132
    v_cos_f32 v149, v133
    v_cos_f32 v150, v134
    v_cos_f32 v151, v135
    v_cos_f32 v152, v136
    v_cos_f32 v153, v137
    v_cos_f32 v154, v138
    v_cos_f32 v155, v139
    v_cos_f32 v156, v140
    v_cos_f32 v157, v141
    v_cos_f32 v158, v142
    v_cos_f32 v159, v143
    v_cos_f32 v160, v144
    v_cos_f32 v161, v145
    v_cvt_pk_f16_f32 v96, v146, v147
    v_cvt_pk_f16_f32 v97, v148, v149
    v_cvt_pk_f16_f32 v98, v150, v151
    v_cvt_pk_f16_f32 v99, v152, v153
    v_cvt_pk_f16_f32 v100, v154, v155
    v_cvt_pk_f16_f32 v101, v156, v157
    v_cvt_pk_f16_f32 v102, v158, v159
    v_cvt_pk_f16_f32 v103, v160, v161
    v_sin_f32 v146, v130
    v_sin_f32 v147, v131
    v_sin_f32 v148, v132
    v_sin_f32 v149, v133
    v_sin_f32 v150, v134
    v_sin_f32 v151, v135
    v_sin_f32 v152, v136
    v_sin_f32 v153, v137
    v_sin_f32 v154, v138
    v_sin_f32 v155, v139
    v_sin_f32 v156, v140
    v_sin_f32 v157, v141
    v_sin_f32 v158, v142
    v_sin_f32 v159, v143
    v_sin_f32 v160, v144
    v_sin_f32 v161, v145
    v_cvt_pk_f16_f32 v104, v146, v147
    v_cvt_pk_f16_f32 v105, v148, v149
    v_cvt_pk_f16_f32 v106, v150, v151
    v_cvt_pk_f16_f32 v107, v152, v153
    v_cvt_pk_f16_f32 v108, v154, v155
    v_cvt_pk_f16_f32 v109, v156, v157
    v_cvt_pk_f16_f32 v110, v158, v159
    v_cvt_pk_f16_f32 v111, v160, v161
    ds_write_b128 v206, v[96:99] offset:12288
    ds_write_b128 v206, v[100:103] offset:13312
    ds_write_b128 v206, v[104:107] offset:14336
    ds_write_b128 v206, v[108:111] offset:15360
    s_branch fk_jsig
    s_nop 0
fk_j3:
    v_or_b32 v10, 16, v1
    v_cvt_f32_u32 v10, v10
    v_mov_b32 v11, 0x3c800000
    v_fmamk_f32 v10, v10, 0x3d000000, v11
    v_cmp_gt_u32 vcc, 16, v1
    v_mov_b32 v12, 0xbe800000
    s_nop 0
    v_cndmask_b32 v12, 0, v12, vcc
    v_fma_f32 v11, v10, v7, v12
    v_mov_b32 v128, v11
    v_fmamk_f32 v129, v10, 0x3f800000, v11
    v_fmamk_f32 v130, v10, 0x40000000, v11
    v_fmamk_f32 v131, v10, 0x40400000, v11
    v_fmamk_f32 v132, v10, 0x41000000, v11
    v_fmamk_f32 v133, v10, 0x41100000, v11
    v_fmamk_f32 v134, v10, 0x41200000, v11
    v_fmamk_f32 v135, v10, 0x41300000, v11
    v_fmamk_f32 v136, v10, 0x41800000, v11
    v_fmamk_f32 v137, v10, 0x41880000, v11
    v_fmamk_f32 v138, v10, 0x41900000, v11
    v_fmamk_f32 v139, v10, 0x41980000, v11
    v_fmamk_f32 v140, v10, 0x41c00000, v11
    v_fmamk_f32 v141, v10, 0x41c80000, v11
    v_fmamk_f32 v142, v10, 0x41d00000, v11
    v_fmamk_f32 v143, v10, 0x41d80000, v11
    v_cos_f32 v144, v128
    v_cos_f32 v145, v129
    v_cos_f32 v146, v130
    v_cos_f32 v147, v131
    v_cos_f32 v148, v132
    v_cos_f32 v149, v133
    v_cos_f32 v150, v134
    v_cos_f32 v151, v135
    v_cos_f32 v152, v136
    v_cos_f32 v153, v137
    v_cos_f32 v154, v138
    v_cos_f32 v155, v139
    v_cos_f32 v156, v140
    v_cos_f32 v157, v141
    v_cos_f32 v158, v142
    v_cos_f32 v159, v143
    v_cvt_pk_f16_f32 v88, v144, v145
    v_cvt_pk_f16_f32 v89, v146, v147
    v_cvt_pk_f16_f32 v90, v148, v149
    v_cvt_pk_f16_f32 v91, v150, v151
    v_cvt_pk_f16_f32 v92, v152, v153
    v_cvt_pk_f16_f32 v93, v154, v155
    v_cvt_pk_f16_f32 v94, v156, v157
    v_cvt_pk_f16_f32 v95, v158, v159
    ds_write_b128 v206, v[88:91] offset:10240
    ds_write_b128 v206, v[92:95] offset:11264
    s_nop 2
fk_jsig:
    ds_write_b32 v201, v202 offset:32
fk_jend:
    v_lshlrev_b32 v3, 9, v2
    v_lshl_add_u32 v3, v1, 1, v3
    v_sub_u32 v4, 576, v3
    v_sub_u32 v5, 2048, v3
    v_and_b32 v5, 2047, v5
    v_add_u32 v3, s12, v3
    v_add_u32 v4, s12, v4
    v_add_u32 v5, s12, v5
    s_lshl_b32 s13, s16, 10
    s_sub_u32 s14, 7232, s13
    s_cmp_ge_u32 s3, 248
    s_cselect_b32 s15, 1024, 0
    s_add_u32 s14, s14, s15
    s_cmp_eq_u32 s14, 8256
    s_cselect_b32 s14, 4160, s14
    s_cmp_eq_u32 s19, s20
    s_cselect_b32 s14, 8256, s14
    s_cmp_eq_u32 s16, 4
    s_cselect_b32 s13, 8256, s13
    s_cmp_lg_u32 s19, 0
    s_cbranch_scc1 fk_noz
    v_add_u32 v8, 124992, v14
    ds_write_b128 v8, v[16:19]
fk_noz:
    s_add_u32 s13, s13, 120832
    s_add_u32 s14, s14, 120832
    v_cmp_gt_u32 vcc, 16, v1
    v_mov_b32 v8, s13
    v_mov_b32 v9, s14
    v_cndmask_b32 v10, v9, v8, vcc
    v_cndmask_b32 v11, v8, v9, vcc
    v_lshl_add_u32 v10, v15, 2, v10
    v_lshl_add_u32 v11, v15, 2, v11
    v_lshrrev_b32 v6, 1, v15
    v_and_b32 v8, 1, v15
    v_mul_u32_u24 v9, 4160, v8
    v_and_b32 v12, 15, v6
    v_lshl_add_u32 v12, v12, 4, v2
    v_mul_u32_u24 v12, 9344, v12
    v_mul_u32_u24 v192, 18688, v8
    v_add_u32 v192, v192, v12
    v_lshl_add_u32 v12, v8, 4, v12
    v_lshrrev_b32 v194, 3, v15
    v_lshlrev_b32 v193, 4, v194
    v_lshl_add_u32 v193, v8, 7, v193
    v_and_b32 v6, 3, v6
    v_lshl_add_u32 v9, v6, 2, v9
    v_lshl_add_u32 v9, v194, 7, v9
    v_lshlrev_b32 v194, 10, v194
    v_and_b32 v6, 7, v15
    v_lshl_add_u32 v194, v6, 4, v194
    s_lshl_b32 s13, s16, 5
    s_add_u32 s13, s13, 120832
    v_add_u32 v6, s13, v9
    s_mul_i32 s36, s3, 9344
    s_lshl_b32 s13, s16, 8
    s_add_u32 s36, s36, s13
    s_add_u32 s36, s36, 0x20000
    s_mul_i32 s37, s16, 37376
    s_add_u32 s37, s37, 0x20000
    s_bfe_u32 s23, s3, 0x30002
    s_lshl_b32 s23, s23, 7
    s_lshr_b32 s12, s3, 5
    s_lshl_b32 s12, s12, 4
    s_add_u32 s23, s23, s12
    s_and_b32 s12, s3, 3
    s_lshl_b32 s12, s12, 2
    s_add_u32 s23, s23, s12
    s_add_u32 s23, s23, 8192
    s_add_u32 s23, s23, s37
    s_lshl_b32 s14, s3, 5
    s_add_u32 s37, s37, s14
    s_add_u32 s38, s37, 18688
    s_lshl_b32 s13, s16, 11
    s_add_u32 s13, s13, 130304
    v_add_u32 v7, s13, v14
    v_cmp_eq_u32 s[58:59], 1, v8
    s_cmp_eq_u32 s19, s20
    s_cselect_b32 s39, 0.5, 1.0
    s_lshl_b32 s13, s16, 2
    s_add_u32 s13, s13, 157056
    v_mov_b32 v9, s13
    s_mov_b32 s57, 47
    s_nop 3
fk_spinc:
    ds_read_b32 v203, v205
    s_waitcnt lgkmcnt(0)
    v_cmp_eq_u32 vcc, 0, v203
    s_nop 1
    s_and_b32 s13, vcc_lo, 0xf00
    s_cbranch_scc1 fk_spinc
    ds_read_b128 v[48:51], v206 offset:0
    ds_read_b128 v[52:55], v206 offset:1024
    ds_read_b128 v[56:59], v206 offset:2048
    ds_read_b128 v[60:63], v206 offset:3072
    ds_read_b128 v[64:67], v206 offset:4096
    ds_read_b128 v[68:71], v206 offset:5120
    ds_read_b128 v[72:75], v206 offset:6144
    ds_read_b128 v[76:79], v206 offset:7168
    ds_read_b128 v[80:83], v206 offset:8192
    ds_read_b128 v[84:87], v206 offset:9216
    ds_read_b128 v[88:91], v206 offset:10240
    ds_read_b128 v[92:95], v206 offset:11264
    s_waitcnt lgkmcnt(8)
    ds_read_b128 v[96:99], v206 offset:12288
    ds_read_b128 v[100:103], v206 offset:13312
    ds_read_b128 v[104:107], v206 offset:14336
    ds_read_b128 v[108:111], v206 offset:15360
    s_waitcnt vmcnt(0) lgkmcnt(0)
    ds_read_u16_d16_hi v16, v3 offset:0
    ds_read_u16_d16_hi v17, v3 offset:64
    ds_read_u16_d16_hi v18, v3 offset:128
    ds_read_u16_d16_hi v19, v3 offset:192
    ds_read_u16_d16_hi v20, v3 offset:256
    ds_read_u16_d16_hi v21, v3 offset:320
    ds_read_u16_d16_hi v22, v3 offset:384
    ds_read_u16_d16_hi v23, v3 offset:448
    ds_read_u16_d16_hi v24, v3 offset:1024
    ds_read_u16_d16_hi v25, v3 offset:1088
    ds_read_u16_d16_hi v26, v3 offset:1152
    ds_read_u16_d16_hi v27, v3 offset:1216
    ds_read_u16_d16_hi v28, v3 offset:1280
    ds_read_u16_d16_hi v29, v3 offset:1344
    ds_read_u16_d16_hi v30, v3 offset:1408
    ds_read_u16_d16_hi v31, v3 offset:1472
    s_waitcnt lgkmcnt(2)
    ds_read_u16_d16_hi v32, v5 offset:2048
    ds_read_u16_d16_hi v33, v4 offset:3456
    ds_read_u16_d16_hi v34, v4 offset:3392
    ds_read_u16_d16_hi v35, v4 offset:3328
    ds_read_u16_d16_hi v36, v4 offset:3264
    ds_read_u16_d16_hi v37, v4 offset:3200
    ds_read_u16_d16_hi v38, v4 offset:3136
    ds_read_u16_d16_hi v39, v4 offset:3072
    ds_read_u16_d16_hi v40, v4 offset:2496
    ds_read_u16_d16_hi v41, v4 offset:2432
    ds_read_u16_d16_hi v42, v4 offset:2368
    ds_read_u16_d16_hi v43, v4 offset:2304
    ds_read_u16_d16_hi v44, v4 offset:2240
    s_waitcnt lgkmcnt(8)
    ds_read_u16_d16_hi v45, v4 offset:2176
    ds_read_u16_d16_hi v46, v4 offset:2112
    ds_read_u16_d16_hi v47, v4 offset:2048
    v_pk_add_f32 v[128:129], v[16:17], v[18:19]
    v_pk_add_f32 v[130:131], v[20:21], v[22:23]
    v_pk_add_f32 v[132:133], v[24:25], v[26:27]
    v_pk_add_f32 v[134:135], v[28:29], v[30:31]
    v_pk_mul_f32 v[136:137], v[16:17], v[16:17]
    v_pk_mul_f32 v[138:139], v[18:19], v[18:19]
    v_pk_fma_f32 v[136:137], v[20:21], v[20:21], v[136:137]
    v_pk_fma_f32 v[138:139], v[22:23], v[22:23], v[138:139]
    v_pk_fma_f32 v[136:137], v[24:25], v[24:25], v[136:137]
    v_pk_fma_f32 v[138:139], v[26:27], v[26:27], v[138:139]
    v_pk_fma_f32 v[136:137], v[28:29], v[28:29], v[136:137]
    v_pk_fma_f32 v[138:139], v[30:31], v[30:31], v[138:139]
    v_pk_add_f32 v[128:129], v[128:129], v[130:131]
    v_pk_add_f32 v[132:133], v[132:133], v[134:135]
    v_pk_add_f32 v[136:137], v[136:137], v[138:139]
    v_pk_add_f32 v[128:129], v[128:129], v[132:133]
    v_add_f32 v136, v136, v137
    v_add_f32 v128, v128, v129
    s_waitcnt lgkmcnt(0)
    v_pk_add_f32 v[140:141], v[32:33], v[34:35]
    v_pk_add_f32 v[142:143], v[36:37], v[38:39]
    v_pk_add_f32 v[144:145], v[40:41], v[42:43]
    v_pk_add_f32 v[146:147], v[44:45], v[46:47]
    v_pk_mul_f32 v[148:149], v[32:33], v[32:33]
    v_pk_mul_f32 v[150:151], v[34:35], v[34:35]
    v_pk_fma_f32 v[148:149], v[36:37], v[36:37], v[148:149]
    v_pk_fma_f32 v[150:151], v[38:39], v[38:39], v[150:151]
    v_pk_fma_f32 v[148:149], v[40:41], v[40:41], v[148:149]
    v_pk_fma_f32 v[150:151], v[42:43], v[42:43], v[150:151]
    v_pk_fma_f32 v[148:149], v[44:45], v[44:45], v[148:149]
    v_pk_fma_f32 v[150:151], v[46:47], v[46:47], v[150:151]
    v_pk_add_f32 v[140:141], v[140:141], v[142:143]
    v_pk_add_f32 v[144:145], v[144:145], v[146:147]
    v_pk_add_f32 v[148:149], v[148:149], v[150:151]
    v_pk_add_f32 v[140:141], v[140:141], v[144:145]
    v_add_f32 v148, v148, v149
    v_add_f32 v140, v140, v141
    s_nop 1
    v_permlane32_swap_b32 v128, v140
    v_permlane32_swap_b32 v136, v148
    v_add_f32 v128, v128, v140
    v_add_f32 v136, v136, v148
    s_nop 1
    v_permlane16_swap_b32 v128, v136
    v_add_f32 v128, v128, v136
    s_nop 1
    v_add_f32_dpp v128, v128, v128 quad_perm:[1,0,3,2] row_mask:0xf bank_mask:0xf
    s_nop 1
    v_add_f32_dpp v128, v128, v128 quad_perm:[2,3,0,1] row_mask:0xf bank_mask:0xf
    s_nop 1
    v_add_f32_dpp v128, v128, v128 row_half_mirror row_mask:0xf bank_mask:0xf
    s_nop 1
    v_add_f32_dpp v128, v128, v128 row_mirror row_mask:0xf bank_mask:0xf
    s_nop 1
    v_mov_b32_dpp v129, v128 row_bcast:15 row_mask:0xa bank_mask:0xf
    v_mul_f32 v130, 0x3a800000, v128
    v_mul_f32 v129, 0x3a800000, v129
    v_fma_f32 v130, -v129, v129, v130
    v_max_f32 v130, 0, v130
    v_cvt_pk_bf16_f32 v130, 0, v130
    v_cvt_pk_bf16_f32 v129, 0, v129
    v_add_f32 v130, 0x3727c5ac, v130
    v_cvt_pk_bf16_f32 v130, 0, v130
    v_sqrt_f32 v130, v130
    s_nop 0
    v_cvt_pk_bf16_f32 v130, 0, v130
    v_rcp_f32 v130, v130
    s_nop 0
    v_mul_f32 v130, 0x3c000000, v130
    v_mul_f32 v129, v129, v130
    v_readlane_b32 s4, v130, 16
    v_readlane_b32 s6, v130, 48
    v_readlane_b32 s13, v129, 16
    v_readlane_b32 s14, v129, 48
    s_nop 0
    v_mov_b32 v132, s13
    v_add_f32 v132, s14, v132
    v_pk_fma_f32 v[32:33], v[32:33], s[6:7], v[132:133] op_sel_hi:[1,0,0] neg_lo:[0,0,1] neg_hi:[0,0,1]
    v_pk_fma_f32 v[34:35], v[34:35], s[6:7], v[132:133] op_sel_hi:[1,0,0] neg_lo:[0,0,1] neg_hi:[0,0,1]
    v_pk_fma_f32 v[36:37], v[36:37], s[6:7], v[132:133] op_sel_hi:[1,0,0] neg_lo:[0,0,1] neg_hi:[0,0,1]
    v_pk_fma_f32 v[38:39], v[38:39], s[6:7], v[132:133] op_sel_hi:[1,0,0] neg_lo:[0,0,1] neg_hi:[0,0,1]
    v_pk_fma_f32 v[40:41], v[40:41], s[6:7], v[132:133] op_sel_hi:[1,0,0] neg_lo:[0,0,1] neg_hi:[0,0,1]
    v_pk_fma_f32 v[42:43], v[42:43], s[6:7], v[132:133] op_sel_hi:[1,0,0] neg_lo:[0,0,1] neg_hi:[0,0,1]
    v_pk_fma_f32 v[44:45], v[44:45], s[6:7], v[132:133] op_sel_hi:[1,0,0] neg_lo:[0,0,1] neg_hi:[0,0,1]
    v_pk_fma_f32 v[46:47], v[46:47], s[6:7], v[132:133] op_sel_hi:[1,0,0] neg_lo:[0,0,1] neg_hi:[0,0,1]
    v_pk_fma_f32 v[16:17], v[16:17], s[4:5], v[32:33] op_sel_hi:[1,0,1]
    v_pk_fma_f32 v[18:19], v[18:19], s[4:5], v[34:35] op_sel_hi:[1,0,1]
    v_pk_fma_f32 v[20:21], v[20:21], s[4:5], v[36:37] op_sel_hi:[1,0,1]
    v_pk_fma_f32 v[22:23], v[22:23], s[4:5], v[38:39] op_sel_hi:[1,0,1]
    v_pk_fma_f32 v[24:25], v[24:25], s[4:5], v[40:41] op_sel_hi:[1,0,1]
    v_pk_fma_f32 v[26:27], v[26:27], s[4:5], v[42:43] op_sel_hi:[1,0,1]
    v_pk_fma_f32 v[28:29], v[28:29], s[4:5], v[44:45] op_sel_hi:[1,0,1]
    v_pk_fma_f32 v[30:31], v[30:31], s[4:5], v[46:47] op_sel_hi:[1,0,1]
    v_cvt_pk_f16_f32 v176, v16, v17
    v_cvt_pk_f16_f32 v177, v18, v19
    v_cvt_pk_f16_f32 v178, v20, v21
    v_cvt_pk_f16_f32 v179, v22, v23
    v_cvt_pk_f16_f32 v180, v24, v25
    v_cvt_pk_f16_f32 v181, v26, v27
    v_cvt_pk_f16_f32 v182, v28, v29
    v_cvt_pk_f16_f32 v183, v30, v31
    v_mfma_f32_32x32x16_f16 v[112:127], v[176:179], v[48:51], 0
    s_nop 0
    v_mfma_f32_32x32x16_f16 v[112:127], v[180:183], v[52:55], v[112:127]
    s_nop 11
    v_pk_mul_f32 v[16:17], v[112:113], v[56:57]
    v_pk_mul_f32 v[18:19], v[114:115], v[58:59]
    v_pk_mul_f32 v[20:21], v[116:117], v[60:61]
    v_pk_mul_f32 v[22:23], v[118:119], v[62:63]
    v_pk_mul_f32 v[24:25], v[120:121], v[64:65]
    v_pk_mul_f32 v[26:27], v[122:123], v[66:67]
    v_pk_mul_f32 v[28:29], v[124:125], v[68:69]
    v_pk_mul_f32 v[30:31], v[126:127], v[70:71]
    v_fmac_f32_dpp v16, v112, v72 quad_perm:[1,0,3,2] row_mask:0xf bank_mask:0xf
    v_fmac_f32_dpp v17, v113, v73 quad_perm:[1,0,3,2] row_mask:0xf bank_mask:0xf
    v_fmac_f32_dpp v18, v114, v74 quad_perm:[1,0,3,2] row_mask:0xf bank_mask:0xf
    v_fmac_f32_dpp v19, v115, v75 quad_perm:[1,0,3,2] row_mask:0xf bank_mask:0xf
    v_fmac_f32_dpp v20, v116, v76 quad_perm:[1,0,3,2] row_mask:0xf bank_mask:0xf
    v_fmac_f32_dpp v21, v117, v77 quad_perm:[1,0,3,2] row_mask:0xf bank_mask:0xf
    v_fmac_f32_dpp v22, v118, v78 quad_perm:[1,0,3,2] row_mask:0xf bank_mask:0xf
    v_fmac_f32_dpp v23, v119, v79 quad_perm:[1,0,3,2] row_mask:0xf bank_mask:0xf
    v_cvt_pk_f16_f32 v176, v16, v17
    v_cvt_pk_f16_f32 v177, v18, v19
    v_cvt_pk_f16_f32 v178, v20, v21
    v_cvt_pk_f16_f32 v179, v22, v23
    v_fmac_f32_dpp v24, v120, v80 quad_perm:[1,0,3,2] row_mask:0xf bank_mask:0xf
    v_fmac_f32_dpp v25, v121, v81 quad_perm:[1,0,3,2] row_mask:0xf bank_mask:0xf
    v_mfma_f32_32x32x16_f16 v[128:143], v[176:179], v[96:99], 0
    v_fmac_f32_dpp v26, v122, v82 quad_perm:[1,0,3,2] row_mask:0xf bank_mask:0xf
    v_fmac_f32_dpp v27, v123, v83 quad_perm:[1,0,3,2] row_mask:0xf bank_mask:0xf
    v_fmac_f32_dpp v28, v124, v84 quad_perm:[1,0,3,2] row_mask:0xf bank_mask:0xf
    v_fmac_f32_dpp v29, v125, v85 quad_perm:[1,0,3,2] row_mask:0xf bank_mask:0xf
    v_mfma_f32_32x32x16_f16 v[144:159], v[176:179], v[104:107], 0
    v_fmac_f32_dpp v30, v126, v86 quad_perm:[1,0,3,2] row_mask:0xf bank_mask:0xf
    v_fmac_f32_dpp v31, v127, v87 quad_perm:[1,0,3,2] row_mask:0xf bank_mask:0xf
    v_cvt_pk_f16_f32 v180, v24, v25
    v_cvt_pk_f16_f32 v181, v26, v27
    v_mfma_f32_32x32x16_f16 v[160:175], v[176:179], v[88:91], 0
    v_cvt_pk_f16_f32 v182, v28, v29
    v_cvt_pk_f16_f32 v183, v30, v31
    s_nop 1
    v_mfma_f32_32x32x16_f16 v[128:143], v[180:183], v[100:103], v[128:143]
    v_mfma_f32_32x32x16_f16 v[144:159], v[180:183], v[108:111], v[144:159]
    v_mfma_f32_32x32x16_f16 v[160:175], v[180:183], v[92:95], v[160:175]
    v_cmp_gt_u32 vcc, 16, v15
    v_cmp_gt_u32 s[40:41], 32, v15
    s_nop 8
    v_pk_add_f32 v[20:21], v[132:133], v[148:149] op_sel:[0,1] op_sel_hi:[1,0] neg_hi:[0,1]
    v_pk_add_f32 v[22:23], v[134:135], v[150:151] op_sel:[0,1] op_sel_hi:[1,0] neg_hi:[0,1]
    v_pk_add_f32 v[36:37], v[20:21], v[22:23] op_sel:[0,1] op_sel_hi:[1,0] neg_lo:[0,1]
    v_pk_add_f32 v[38:39], v[20:21], v[22:23] op_sel:[0,1] op_sel_hi:[1,0] neg_hi:[1,0]
    v_cvt_pk_f16_f32 v178, v36, v37
    v_cvt_pk_f16_f32 v179, v38, v39
    ds_write_b32 v10, v178 offset:256
    ds_write_b32 v11, v179 offset:256
    v_pk_add_f32 v[24:25], v[136:137], v[152:153] op_sel:[0,1] op_sel_hi:[1,0] neg_hi:[0,1]
    v_pk_add_f32 v[26:27], v[138:139], v[154:155] op_sel:[0,1] op_sel_hi:[1,0] neg_hi:[0,1]
    v_pk_add_f32 v[40:41], v[24:25], v[26:27] op_sel:[0,1] op_sel_hi:[1,0] neg_lo:[0,1]
    v_pk_add_f32 v[42:43], v[24:25], v[26:27] op_sel:[0,1] op_sel_hi:[1,0] neg_hi:[1,0]
    v_cvt_pk_f16_f32 v180, v40, v41
    v_cvt_pk_f16_f32 v181, v42, v43
    ds_write_b32 v10, v180 offset:512
    ds_write_b32 v11, v181 offset:512
    v_pk_add_f32 v[28:29], v[140:141], v[156:157] op_sel:[0,1] op_sel_hi:[1,0] neg_hi:[0,1]
    v_pk_add_f32 v[30:31], v[142:143], v[158:159] op_sel:[0,1] op_sel_hi:[1,0] neg_hi:[0,1]
    v_pk_add_f32 v[44:45], v[28:29], v[30:31] op_sel:[0,1] op_sel_hi:[1,0] neg_lo:[0,1]
    v_pk_add_f32 v[46:47], v[28:29], v[30:31] op_sel:[0,1] op_sel_hi:[1,0] neg_hi:[1,0]
    v_cvt_pk_f16_f32 v182, v44, v45
    v_cvt_pk_f16_f32 v183, v46, v47
    ds_write_b32 v10, v182 offset:768
    ds_write_b32 v11, v183 offset:768
    v_pk_add_f32 v[16:17], v[128:129], v[144:145] op_sel:[0,1] op_sel_hi:[1,0] neg_hi:[0,1]
    v_pk_add_f32 v[18:19], v[130:131], v[146:147] op_sel:[0,1] op_sel_hi:[1,0] neg_hi:[0,1]
    v_mul_f32 v8, s39, v128
    v_mov_b32 v3, v161
    s_nop 1
    v_permlane16_swap_b32 v4, v3
    v_cndmask_b32 v5, v161, v128, vcc
    v_cndmask_b32 v4, v4, v144, vcc
    v_cndmask_b32 v16, v16, v5, s[40:41]
    v_cndmask_b32 v17, v17, -v4, s[40:41]
    v_pk_add_f32 v[32:33], v[16:17], v[18:19] op_sel:[0,1] op_sel_hi:[1,0] neg_lo:[0,1]
    v_pk_add_f32 v[34:35], v[16:17], v[18:19] op_sel:[0,1] op_sel_hi:[1,0] neg_hi:[1,0]
    v_cvt_pk_f16_f32 v176, v32, v33
    v_cvt_pk_f16_f32 v177, v34, v35
    ds_write_b32 v10, v176 offset:0
    ds_write_b32 v11, v177 offset:0
    s_mov_b64 exec, 0x10000
    ds_write_b32 v9, v8
    ds_write_b32 v201, v202
    s_mov_b64 exec, -1
    s_cmp_eq_u32 s16, 4
    s_cbranch_scc1 fk_w4
    s_nop 0
fk_spin:
    ds_read_b32 v3, v205
    s_waitcnt lgkmcnt(0)
    v_cmp_eq_u32 vcc, 0, v3
    s_nop 1
    s_and_b32 s13, vcc_lo, s57
    s_cbranch_scc1 fk_spin
    s_nop 0
fk_staged:
    ds_read2st64_b32 v[184:185], v6 offset0:0 offset1:4
    ds_read2st64_b32 v[186:187], v6 offset0:8 offset1:12
    v_add_u32 v8, 16, v6
    ds_read2st64_b32 v[188:189], v8 offset0:0 offset1:4
    ds_read2st64_b32 v[190:191], v8 offset0:8 offset1:12
    v_readlane_b32 s43, v3, 7
    s_waitcnt lgkmcnt(2)
    v_or_b32 v184, 1, v184
    v_or_b32 v185, 1, v185
    v_or_b32 v186, 1, v186
    v_or_b32 v187, 1, v187
    buffer_store_dwordx4 v[184:187], v194, s[24:27], s36 offen offset:0 sc1
    s_waitcnt lgkmcnt(0)
    v_or_b32 v188, 1, v188
    v_or_b32 v189, 1, v189
    v_or_b32 v190, 1, v190
    v_or_b32 v191, 1, v191
    buffer_store_dwordx4 v[188:191], v194, s[24:27], s36 offen offset:128 sc1
    v_add3_u32 v3, v184, v185, v186
    v_add_u32 v3, v3, v187
    v_add3_u32 v4, v188, v189, v190
    v_add_u32 v4, v4, v191
    s_add_u32 s36, s36, 8192
    v_add_u32_dpp v3, v3, v3 quad_perm:[1,0,3,2] row_mask:0xf bank_mask:0xf
    v_add_u32_dpp v4, v4, v4 quad_perm:[1,0,3,2] row_mask:0xf bank_mask:0xf
    v_cndmask_b32 v3, v3, v4, s[58:59]
    v_add_u32 v196, s43, v3
    s_nop 1
    v_mov_b32_dpp v197, v196 row_shl:2 row_mask:0xf bank_mask:0xf
    v_mov_b32_dpp v198, v196 row_shl:4 row_mask:0xf bank_mask:0xf
    v_mov_b32_dpp v199, v196 row_shl:6 row_mask:0xf bank_mask:0xf
    s_mov_b32 exec_lo, 0x03030303
    s_mov_b32 exec_hi, 0x03030303
    buffer_store_dwordx4 v[196:199], v193, s[24:27], s36 offen sc1
    s_mov_b64 exec, -1
    s_cmp_lg_u32 s16, 0
    s_cbranch_scc1 fk_nog5
    v_and_b32 v9, 16, v14
    v_add_u32 v9, 157056, v9
    ds_read_b128 v[16:19], v9
    s_lshl_b32 s13, s3, 4
    s_add_u32 s13, s13, 0x11000
    s_waitcnt lgkmcnt(0)
    v_min_u32 v16, -2, v16
    v_min_u32 v17, -2, v17
    v_min_u32 v18, -2, v18
    v_min_u32 v19, -2, v19
    s_mov_b64 exec, 1
    buffer_store_dwordx4 v[16:19], v14, s[24:27], s13 offen sc1
    s_mov_b64 exec, -1
    s_nop 1
fk_nog5:
    v_lshrrev_b32 v208, 3, v15
    v_and_b32 v209, 7, v15
    v_and_b32 v210, 2, v208
    v_xor_b32 v209, v210, v209
    v_mul_u32_u24 v208, 7168, v208
    v_lshl_add_u32 v208, v209, 4, v208
    v_lshrrev_b32 v210, 5, v15
    v_lshlrev_b32 v210, 11, v210
    v_and_b32 v209, 31, v15
    v_lshl_add_u32 v210, v209, 4, v210
    s_and_b32 s12, s3, 3
    s_mul_i32 s100, s12, 1835008
    s_lshl_b32 s101, s12, 9
    s_lshr_b32 s12, s3, 2
    s_lshl_b32 s12, s12, 7
    s_add_u32 s100, s100, s12
    s_lshl_b32 s12, s12, 10
    s_add_u32 s101, s101, s12
    s_mov_b64 s[4:5], s[58:59]
    s_cmp_gt_u32 s3, 223
    s_cbranch_scc1 fk_win1
    s_mul_i32 s15, s16, 3
    s_add_u32 s15, s15, 12
    s_mov_b32 s58, 0x700000
    s_mov_b32 s59, 0x00020000
    s_cmp_gt_u32 s15, 95
    s_cbranch_scc1 fk_win1
    s_lshl_b32 s12, s15, 10
    s_mov_b32 m0, s12
    s_and_b32 s14, s12, 1024
    s_lshr_b32 s14, s14, 4
    v_xor_b32 v209, s14, v208
    s_cmp_lt_u32 s15, 32
    s_cselect_b64 s[56:57], s[44:45], s[48:49]
    s_and_b32 s14, s15, 31
    s_mul_i32 s13, s14, 57344
    s_add_u32 s13, s13, s100
    s_lshl_b32 s14, s14, 12
    s_add_u32 s14, s14, s101
    s_cmp_lt_u32 s15, 64
    s_cselect_b64 s[56:57], s[56:57], s[52:53]
    s_cselect_b32 s13, s13, s14
    s_cselect_b64 vcc, -1, 0
    v_cndmask_b32 v209, v210, v209, vcc
    s_add_u32 s15, s15, 1
    buffer_load_dwordx4 v209, s[56:59], s13 offen lds
    s_cmp_gt_u32 s15, 95
    s_cbranch_scc1 fk_win1
    s_lshl_b32 s12, s15, 10
    s_mov_b32 m0, s12
    s_and_b32 s14, s12, 1024
    s_lshr_b32 s14, s14, 4
    v_xor_b32 v209, s14, v208
    s_cmp_lt_u32 s15, 32
    s_cselect_b64 s[56:57], s[44:45], s[48:49]
    s_and_b32 s14, s15, 31
    s_mul_i32 s13, s14, 57344
    s_add_u32 s13, s13, s100
    s_lshl_b32 s14, s14, 12
    s_add_u32 s14, s14, s101
    s_cmp_lt_u32 s15, 64
    s_cselect_b64 s[56:57], s[56:57], s[52:53]
    s_cselect_b32 s13, s13, s14
    s_cselect_b64 vcc, -1, 0
    v_cndmask_b32 v209, v210, v209, vcc
    s_add_u32 s15, s15, 1
    buffer_load_dwordx4 v209, s[56:59], s13 offen lds
    s_cmp_gt_u32 s15, 95
    s_cbranch_scc1 fk_win1
    s_lshl_b32 s12, s15, 10
    s_mov_b32 m0, s12
    s_and_b32 s14, s12, 1024
    s_lshr_b32 s14, s14, 4
    v_xor_b32 v209, s14, v208
    s_cmp_lt_u32 s15, 32
    s_cselect_b64 s[56:57], s[44:45], s[48:49]
    s_and_b32 s14, s15, 31
    s_mul_i32 s13, s14, 57344
    s_add_u32 s13, s13, s100
    s_lshl_b32 s14, s14, 12
    s_add_u32 s14, s14, s101
    s_cmp_lt_u32 s15, 64
    s_cselect_b64 s[56:57], s[56:57], s[52:53]
    s_cselect_b32 s13, s13, s14
    s_cselect_b64 vcc, -1, 0
    v_cndmask_b32 v209, v210, v209, vcc
    s_add_u32 s15, s15, 1
    buffer_load_dwordx4 v209, s[56:59], s13 offen lds
    s_nop 2
fk_win1:
    s_mov_b32 s42, 0
    s_waitcnt vmcnt(0)
    s_sleep 6
    s_nop 0
fk_pollw:
    buffer_load_dwordx4 v[184:187], v12, s[24:27], s37 offen sc1
    buffer_load_dwordx4 v[188:191], v12, s[24:27], s38 offen sc1
    buffer_load_dword v5, v192, s[24:27], s23 offen sc1
    s_waitcnt vmcnt(1)
    v_add3_u32 v3, v184, v185, v186
    v_add_u32 v3, v3, v187
    v_add3_u32 v4, v188, v189, v190
    v_add_u32 v4, v4, v191
    ds_write_b128 v7, v[184:187]
    v_add_u32_dpp v3, v3, v3 quad_perm:[1,0,3,2] row_mask:0xf bank_mask:0xf
    v_add_u32_dpp v4, v4, v4 quad_perm:[1,0,3,2] row_mask:0xf bank_mask:0xf
    ds_write_b128 v7, v[188:191] offset:1024
    v_cndmask_b32 v3, v3, v4, s[4:5]
    v_add_u32 v3, s43, v3
    s_waitcnt vmcnt(0)
    v_cmp_ne_u32 vcc, v3, v5
    s_add_u32 s42, s42, 1
    s_cbranch_vccz fk_gotw
    s_cmp_le_u32 s42, 0x40000
    s_cbranch_scc1 fk_pollw
    s_nop 0
fk_gotw:
    s_waitcnt lgkmcnt(0)
    s_barrier
    s_setprio 0
    s_or_b32 s13, s3, s16
    s_cbranch_scc1 fk_nobump
    v_mov_b32 v3, s43
    s_mov_b64 exec, 1
    buffer_store_dword v3, v14, s[24:27], 0 offen sc1
    s_mov_b64 exec, -1
    s_nop 1
fk_nobump:
    s_lshl_b32 s13, s16, 10
    s_add_u32 s14, s13, 0x11000
    s_add_u32 s13, s13, 114688
    v_add_u32 v7, s13, v14
    v_mov_b32 v3, 4096
    s_mov_b32 s15, 0x11000
    v_mov_b32 v8, 157152
    buffer_load_dwordx4 v[184:187], v14, s[24:27], s14 offen sc1
    buffer_load_dword v188, v3, s[24:27], s15 offen sc1
    s_mov_b32 s40, s14
    s_mov_b32 s41, s15
    s_cmp_gt_u32 s3, 223
    s_cbranch_scc1 fk_win2
    s_mul_i32 s15, s16, 4
    s_add_u32 s15, s15, 24
    s_mov_b32 s58, 0x700000
    s_mov_b32 s59, 0x00020000
    s_cmp_gt_u32 s15, 95
    s_cbranch_scc1 fk_win2
    s_lshl_b32 s12, s15, 10
    s_mov_b32 m0, s12
    s_and_b32 s14, s12, 1024
    s_lshr_b32 s14, s14, 4
    v_xor_b32 v209, s14, v208
    s_cmp_lt_u32 s15, 32
    s_cselect_b64 s[56:57], s[44:45], s[48:49]
    s_and_b32 s14, s15, 31
    s_mul_i32 s13, s14, 57344
    s_add_u32 s13, s13, s100
    s_lshl_b32 s14, s14, 12
    s_add_u32 s14, s14, s101
    s_cmp_lt_u32 s15, 64
    s_cselect_b64 s[56:57], s[56:57], s[52:53]
    s_cselect_b32 s13, s13, s14
    s_cselect_b64 vcc, -1, 0
    v_cndmask_b32 v209, v210, v209, vcc
    s_add_u32 s15, s15, 1
    buffer_load_dwordx4 v209, s[56:59], s13 offen lds
    s_cmp_gt_u32 s15, 95
    s_cbranch_scc1 fk_win2
    s_lshl_b32 s12, s15, 10
    s_mov_b32 m0, s12
    s_and_b32 s14, s12, 1024
    s_lshr_b32 s14, s14, 4
    v_xor_b32 v209, s14, v208
    s_cmp_lt_u32 s15, 32
    s_cselect_b64 s[56:57], s[44:45], s[48:49]
    s_and_b32 s14, s15, 31
    s_mul_i32 s13, s14, 57344
    s_add_u32 s13, s13, s100
    s_lshl_b32 s14, s14, 12
    s_add_u32 s14, s14, s101
    s_cmp_lt_u32 s15, 64
    s_cselect_b64 s[56:57], s[56:57], s[52:53]
    s_cselect_b32 s13, s13, s14
    s_cselect_b64 vcc, -1, 0
    v_cndmask_b32 v209, v210, v209, vcc
    s_add_u32 s15, s15, 1
    buffer_load_dwordx4 v209, s[56:59], s13 offen lds
    s_cmp_gt_u32 s15, 95
    s_cbranch_scc1 fk_win2
    s_lshl_b32 s12, s15, 10
    s_mov_b32 m0, s12
    s_and_b32 s14, s12, 1024
    s_lshr_b32 s14, s14, 4
    v_xor_b32 v209, s14, v208
    s_cmp_lt_u32 s15, 32
    s_cselect_b64 s[56:57], s[44:45], s[48:49]
    s_and_b32 s14, s15, 31
    s_mul_i32 s13, s14, 57344
    s_add_u32 s13, s13, s100
    s_lshl_b32 s14, s14, 12
    s_add_u32 s14, s14, s101
    s_cmp_lt_u32 s15, 64
    s_cselect_b64 s[56:57], s[56:57], s[52:53]
    s_cselect_b32 s13, s13, s14
    s_cselect_b64 vcc, -1, 0
    v_cndmask_b32 v209, v210, v209, vcc
    s_add_u32 s15, s15, 1
    buffer_load_dwordx4 v209, s[56:59], s13 offen lds
    s_cmp_gt_u32 s15, 95
    s_cbranch_scc1 fk_win2
    s_lshl_b32 s12, s15, 10
    s_mov_b32 m0, s12
    s_and_b32 s14, s12, 1024
    s_lshr_b32 s14, s14, 4
    v_xor_b32 v209, s14, v208
    s_cmp_lt_u32 s15, 32
    s_cselect_b64 s[56:57], s[44:45], s[48:49]
    s_and_b32 s14, s15, 31
    s_mul_i32 s13, s14, 57344
    s_add_u32 s13, s13, s100
    s_lshl_b32 s14, s14, 12
    s_add_u32 s14, s14, s101
    s_cmp_lt_u32 s15, 64
    s_cselect_b64 s[56:57], s[56:57], s[52:53]
    s_cselect_b32 s13, s13, s14
    s_cselect_b64 vcc, -1, 0
    v_cndmask_b32 v209, v210, v209, vcc
    s_add_u32 s15, s15, 1
    buffer_load_dwordx4 v209, s[56:59], s13 offen lds
    s_nop 2
fk_win2:
    s_mov_b32 s42, 0
    s_cmp_gt_u32 s3, 223
    s_cbranch_scc1 fk_pollg
    s_waitcnt vmcnt(4)
    s_branch fk_chkg
    s_nop 0
fk_pollg:
    buffer_load_dwordx4 v[184:187], v14, s[24:27], s40 offen sc1
    buffer_load_dword v188, v3, s[24:27], s41 offen sc1
    s_waitcnt vmcnt(0)
    s_nop 0
fk_chkg:
    s_add_u32 s42, s42, 1
    v_max3_u32 v4, v184, v185, v186
    v_max3_u32 v4, v4, v187, v188
    v_cmp_eq_u32 vcc, -1, v4
    s_cbranch_vccz fk_gotg
    s_cmp_le_u32 s42, 0x40000
    s_cbranch_scc1 fk_pollg
    s_nop 1
fk_gotg:
    ds_write_b128 v7, v[184:187]
    ds_write_b32 v8, v188
    s_branch fk_common
    s_nop 0
fk_w4:
    v_min_u32 v184, -2, v176
    v_min_u32 v185, -2, v178
    v_min_u32 v186, -2, v180
    v_min_u32 v187, -2, v182
    v_min_u32 v8, -2, v8
    v_mov_b32 v4, 4096
    s_mov_b32 s14, 0x13000
    s_mov_b32 s15, 0x11000
    s_nop 2
fk_w4s:
    ds_read_b32 v3, v205
    s_waitcnt lgkmcnt(0)
    v_cmp_eq_u32 vcc, 0, v3
    s_nop 1
    s_and_b32 s13, vcc_lo, 32
    s_cbranch_scc1 fk_w4s
    buffer_store_dwordx4 v[184:187], v14, s[24:27], s14 offen sc1
    s_mov_b64 exec, 0x10000
    buffer_store_dword v8, v4, s[24:27], s15 offen sc1
    s_mov_b64 exec, -1
    s_branch fk_Hconst
    s_nop 0
fk_H:
    s_barrier
    s_cmp_lg_u32 s16, 7
    s_cbranch_scc1 fk_Hconst
    v_mov_b32 v4, -1
    v_mov_b32 v5, -1
    v_mov_b32 v6, -1
    v_mov_b32 v7, -1
    v_mov_b32 v3, 157120
    v_mov_b32 v8, 0
    ds_write_b32 v3, v8
    v_lshlrev_b32 v3, 12, v15
    s_lshl_b32 s13, s3, 4
    s_add_u32 s14, s13, 0x9000
    s_add_u32 s15, s13, 0x11000
    v_mov_b32 v201, 157844
    v_mov_b32 v204, 1
    s_waitcnt lgkmcnt(0)
    s_load_dword s56, s[24:25], 0
    s_mul_i32 s38, s3, 8320
    s_add_u32 s38, s38, 0x268000
    s_add_u32 s39, s38, 4096
    buffer_store_dwordx4 v[4:7], v14, s[24:27], s38 offen offset:0 sc1
    buffer_store_dwordx4 v[4:7], v14, s[24:27], s38 offen offset:1024 sc1
    buffer_store_dwordx4 v[4:7], v14, s[24:27], s38 offen offset:2048 sc1
    buffer_store_dwordx4 v[4:7], v14, s[24:27], s38 offen offset:3072 sc1
    buffer_store_dwordx4 v[4:7], v14, s[24:27], s39 offen offset:0 sc1
    buffer_store_dwordx4 v[4:7], v14, s[24:27], s39 offen offset:1024 sc1
    buffer_store_dwordx4 v[4:7], v14, s[24:27], s39 offen offset:2048 sc1
    buffer_store_dwordx4 v[4:7], v14, s[24:27], s39 offen offset:3072 sc1
    s_mov_b64 exec, 0xff
    buffer_store_dwordx4 v[4:7], v3, s[24:27], s14 offen sc1
    s_cmp_eq_u32 s3, 255
    s_cselect_b32 exec_lo, 3, 1
    buffer_store_dwordx4 v[4:7], v14, s[24:27], s15 offen sc1
    s_mov_b64 exec, -1
    s_mov_b32 m0, 155008
    s_mov_b32 s12, 0
    buffer_load_dwordx4 v14, s[32:35], s12 offen lds
    s_mov_b32 m0, 156032
    s_mov_b32 s12, 1024
    buffer_load_dwordx4 v14, s[32:35], s12 offen lds
    s_cmp_eq_u32 s3, 255
    s_cselect_b32 s12, 0x13000, s26
    buffer_store_dwordx4 v[4:7], v14, s[24:27], s12 offen sc1
    s_cmp_lg_u32 s3, 248
    s_cbranch_scc1 fk_no1024
    s_mov_b32 m0, 118784
    s_mov_b32 s14, 2097152
    buffer_load_dwordx4 v14, s[8:11], s14 offen lds
    s_mov_b32 m0, 119808
    s_mov_b32 s14, 2098176
    buffer_load_dwordx4 v14, s[8:11], s14 offen lds
fk_no1024:
    s_waitcnt lgkmcnt(0)
    s_add_u32 s56, s56, 1
    v_mov_b32 v202, s56
    ds_write_b32 v201, v202 offset:8
    s_waitcnt vmcnt(0)
    ds_write_b32 v201, v204
    s_nop 1
fk_Hconst:
    s_sub_u32 s20, s16, 4
    v_lshrrev_b32 v208, 3, v15
    v_and_b32 v209, 7, v15
    v_and_b32 v210, 2, v208
    v_xor_b32 v209, v210, v209
    v_mul_u32_u24 v208, 7168, v208
    v_lshl_add_u32 v208, v209, 4, v208
    v_lshrrev_b32 v210, 5, v15
    v_lshlrev_b32 v210, 11, v210
    v_and_b32 v209, 31, v15
    v_lshl_add_u32 v210, v209, 4, v210
    s_and_b32 s12, s3, 3
    s_mul_i32 s100, s12, 1835008
    s_lshl_b32 s101, s12, 9
    s_lshr_b32 s12, s3, 2
    s_lshl_b32 s12, s12, 7
    s_add_u32 s100, s100, s12
    s_lshl_b32 s12, s12, 10
    s_add_u32 s101, s101, s12
    s_and_b32 s12, s20, 1
    s_lshl_b32 s12, s12, 6
    v_xor_b32 v206, s12, v208
    v_xor_b32 v207, 64, v206
    s_mov_b32 s6, 0x700000
    s_mov_b32 s7, 0x00020000
    s_cmp_gt_u32 s3, 223
    s_cselect_b32 s36, 3, s20
    s_waitcnt lgkmcnt(0)
    s_cmp_eq_u32 s36, 3
    s_cbranch_scc1 fk_gu0
    s_add_u32 s37, s20, 0
    s_lshl_b32 s12, s37, 10
    s_mov_b32 m0, s12
    s_cmp_lt_u32 s37, 32
    s_cselect_b64 s[4:5], s[44:45], s[48:49]
    s_and_b32 s37, s37, 31
    s_mul_i32 s37, s37, 57344
    s_add_u32 s37, s37, s100
    buffer_load_dwordx4 v206, s[4:7], s37 offen lds
fk_gu0:
    s_cmp_eq_u32 s36, 3
    s_cbranch_scc1 fk_gu1
    s_add_u32 s37, s20, 3
    s_lshl_b32 s12, s37, 10
    s_mov_b32 m0, s12
    s_cmp_lt_u32 s37, 32
    s_cselect_b64 s[4:5], s[44:45], s[48:49]
    s_and_b32 s37, s37, 31
    s_mul_i32 s37, s37, 57344
    s_add_u32 s37, s37, s100
    buffer_load_dwordx4 v207, s[4:7], s37 offen lds
fk_gu1:
    s_cmp_eq_u32 s36, 3
    s_cbranch_scc1 fk_gu2
    s_add_u32 s37, s20, 6
    s_lshl_b32 s12, s37, 10
    s_mov_b32 m0, s12
    s_cmp_lt_u32 s37, 32
    s_cselect_b64 s[4:5], s[44:45], s[48:49]
    s_and_b32 s37, s37, 31
    s_mul_i32 s37, s37, 57344
    s_add_u32 s37, s37, s100
    buffer_load_dwordx4 v206, s[4:7], s37 offen lds
fk_gu2:
    s_cmp_eq_u32 s36, 3
    s_cbranch_scc1 fk_gu3
    s_add_u32 s37, s20, 9
    s_lshl_b32 s12, s37, 10
    s_mov_b32 m0, s12
    s_cmp_lt_u32 s37, 32
    s_cselect_b64 s[4:5], s[44:45], s[48:49]
    s_and_b32 s37, s37, 31
    s_mul_i32 s37, s37, 57344
    s_add_u32 s37, s37, s100
    buffer_load_dwordx4 v207, s[4:7], s37 offen lds
fk_gu3:
    v_lshrrev_b32 v4, 1, v1
    v_and_b32 v5, 1, v4
    v_lshrrev_b32 v6, 2, v4
    v_lshl_add_u32 v5, v6, 1, v5
    v_and_b32 v6, 2, v4
    v_lshl_add_u32 v5, v6, 2, v5
    s_and_b32 s13, s20, 1
    s_mul_i32 s13, s13, 15
    v_xor_b32 v5, s13, v5
    s_lshl_b32 s13, s20, 4
    v_add_u32 v5, s13, v5
    v_cvt_f32_u32 v5, v5
    v_and_b32 v9, 1, v1
    v_lshlrev_b32 v7, 2, v2
    v_cvt_f32_u32 v7, v7
    v_cvt_f32_u32 v10, v9
    v_mul_f32 v8, 0x3c800000, v5
    v_mul_f32 v10, 0x3e800000, v10
    v_fma_f32 v10, v8, v7, v10
    v_mov_b32 v128, v10
    v_fmamk_f32 v129, v8, 0x3f800000, v10
    v_fmamk_f32 v130, v8, 0x40000000, v10
    v_fmamk_f32 v131, v8, 0x40400000, v10
    v_fmamk_f32 v132, v8, 0x41000000, v10
    v_fmamk_f32 v133, v8, 0x41100000, v10
    v_fmamk_f32 v134, v8, 0x41200000, v10
    v_fmamk_f32 v135, v8, 0x41300000, v10
    v_fmamk_f32 v136, v8, 0x41800000, v10
    v_fmamk_f32 v137, v8, 0x41880000, v10
    v_fmamk_f32 v138, v8, 0x41900000, v10
    v_fmamk_f32 v139, v8, 0x41980000, v10
    v_fmamk_f32 v140, v8, 0x41c00000, v10
    v_fmamk_f32 v141, v8, 0x41c80000, v10
    v_fmamk_f32 v142, v8, 0x41d00000, v10
    v_fmamk_f32 v143, v8, 0x41d80000, v10
    v_cos_f32 v144, v128
    v_cos_f32 v145, v129
    v_cos_f32 v146, v130
    v_cos_f32 v147, v131
    v_cos_f32 v148, v132
    v_cos_f32 v149, v133
    v_cos_f32 v150, v134
    v_cos_f32 v151, v135
    v_cos_f32 v152, v136
    v_cos_f32 v153, v137
    v_cos_f32 v154, v138
    v_cos_f32 v155, v139
    v_cos_f32 v156, v140
    v_cos_f32 v157, v141
    v_cos_f32 v158, v142
    v_cos_f32 v159, v143
    v_sin_f32 v160, v128
    v_sin_f32 v161, v129
    v_sin_f32 v162, v130
    v_sin_f32 v163, v131
    v_sin_f32 v164, v132
    v_sin_f32 v165, v133
    v_sin_f32 v166, v134
    v_sin_f32 v167, v135
    v_sin_f32 v168, v136
    v_sin_f32 v169, v137
    v_sin_f32 v170, v138
    v_sin_f32 v171, v139
    v_sin_f32 v172, v140
    v_sin_f32 v173, v141
    v_sin_f32 v174, v142
    v_sin_f32 v175, v143
    v_cvt_pk_f16_f32 v48, v144, v160
    v_cvt_pk_f16_f32 v49, v145, v161
    v_cvt_pk_f16_f32 v50, v146, v162
    v_cvt_pk_f16_f32 v51, v147, v163
    v_cvt_pk_f16_f32 v52, v148, v164
    v_cvt_pk_f16_f32 v53, v149, v165
    v_cvt_pk_f16_f32 v54, v150, v166
    v_cvt_pk_f16_f32 v55, v151, v167
    v_cvt_pk_f16_f32 v56, v152, v168
    v_cvt_pk_f16_f32 v57, v153, v169
    v_cvt_pk_f16_f32 v58, v154, v170
    v_cvt_pk_f16_f32 v59, v155, v171
    v_cvt_pk_f16_f32 v60, v156, v172
    v_cvt_pk_f16_f32 v61, v157, v173
    v_cvt_pk_f16_f32 v62, v158, v174
    v_cvt_pk_f16_f32 v63, v159, v175
    v_fmamk_f32 v128, v8, 0x42000000, v10
    v_fmamk_f32 v129, v8, 0x42040000, v10
    v_fmamk_f32 v130, v8, 0x42080000, v10
    v_fmamk_f32 v131, v8, 0x420c0000, v10
    v_fmamk_f32 v132, v8, 0x42200000, v10
    v_fmamk_f32 v133, v8, 0x42240000, v10
    v_fmamk_f32 v134, v8, 0x42280000, v10
    v_fmamk_f32 v135, v8, 0x422c0000, v10
    v_fmamk_f32 v136, v8, 0x42400000, v10
    v_fmamk_f32 v137, v8, 0x42440000, v10
    v_fmamk_f32 v138, v8, 0x42480000, v10
    v_fmamk_f32 v139, v8, 0x424c0000, v10
    v_fmamk_f32 v140, v8, 0x42600000, v10
    v_fmamk_f32 v141, v8, 0x42640000, v10
    v_fmamk_f32 v142, v8, 0x42680000, v10
    v_fmamk_f32 v143, v8, 0x426c0000, v10
    v_cos_f32 v144, v128
    v_cos_f32 v145, v129
    v_cos_f32 v146, v130
    v_cos_f32 v147, v131
    v_cos_f32 v148, v132
    v_cos_f32 v149, v133
    v_cos_f32 v150, v134
    v_cos_f32 v151, v135
    v_cos_f32 v152, v136
    v_cos_f32 v153, v137
    v_cos_f32 v154, v138
    v_cos_f32 v155, v139
    v_cos_f32 v156, v140
    v_cos_f32 v157, v141
    v_cos_f32 v158, v142
    v_cos_f32 v159, v143
    v_sin_f32 v160, v128
    v_sin_f32 v161, v129
    v_sin_f32 v162, v130
    v_sin_f32 v163, v131
    v_sin_f32 v164, v132
    v_sin_f32 v165, v133
    v_sin_f32 v166, v134
    v_sin_f32 v167, v135
    v_sin_f32 v168, v136
    v_sin_f32 v169, v137
    v_sin_f32 v170, v138
    v_sin_f32 v171, v139
    v_sin_f32 v172, v140
    v_sin_f32 v173, v141
    v_sin_f32 v174, v142
    v_sin_f32 v175, v143
    v_cvt_pk_f16_f32 v64, v144, v160
    v_cvt_pk_f16_f32 v65, v145, v161
    v_cvt_pk_f16_f32 v66, v146, v162
    v_cvt_pk_f16_f32 v67, v147, v163
    v_cvt_pk_f16_f32 v68, v148, v164
    v_cvt_pk_f16_f32 v69, v149, v165
    v_cvt_pk_f16_f32 v70, v150, v166
    v_cvt_pk_f16_f32 v71, v151, v167
    v_cvt_pk_f16_f32 v72, v152, v168
    v_cvt_pk_f16_f32 v73, v153, v169
    v_cvt_pk_f16_f32 v74, v154, v170
    v_cvt_pk_f16_f32 v75, v155, v171
    v_cvt_pk_f16_f32 v76, v156, v172
    v_cvt_pk_f16_f32 v77, v157, v173
    v_cvt_pk_f16_f32 v78, v158, v174
    v_cvt_pk_f16_f32 v79, v159, v175
    v_lshlrev_b32 v11, 31, v9
    v_mul_f32 v10, 0x3a000000, v5
    v_xor_b32 v10, v11, v10
    v_mul_f32 v11, v10, v7
    v_mov_b32 v128, v11
    v_fmamk_f32 v129, v10, 0x3f800000, v11
    v_fmamk_f32 v130, v10, 0x40000000, v11
    v_fmamk_f32 v131, v10, 0x40400000, v11
    v_fmamk_f32 v132, v10, 0x41000000, v11
    v_fmamk_f32 v133, v10, 0x41100000, v11
    v_fmamk_f32 v134, v10, 0x41200000, v11
    v_fmamk_f32 v135, v10, 0x41300000, v11
    v_fmamk_f32 v136, v10, 0x41800000, v11
    v_fmamk_f32 v137, v10, 0x41880000, v11
    v_fmamk_f32 v138, v10, 0x41900000, v11
    v_fmamk_f32 v139, v10, 0x41980000, v11
    v_fmamk_f32 v140, v10, 0x41c00000, v11
    v_fmamk_f32 v141, v10, 0x41c80000, v11
    v_fmamk_f32 v142, v10, 0x41d00000, v11
    v_fmamk_f32 v143, v10, 0x41d80000, v11
    v_cos_f32 v80, v128
    v_cos_f32 v81, v129
    v_cos_f32 v82, v130
    v_cos_f32 v83, v131
    v_cos_f32 v84, v132
    v_cos_f32 v85, v133
    v_cos_f32 v86, v134
    v_cos_f32 v87, v135
    v_cos_f32 v88, v136
    v_cos_f32 v89, v137
    v_cos_f32 v90, v138
    v_cos_f32 v91, v139
    v_cos_f32 v92, v140
    v_cos_f32 v93, v141
    v_cos_f32 v94, v142
    v_cos_f32 v95, v143
    v_sin_f32 v96, v128
    v_sin_f32 v97, v129
    v_sin_f32 v98, v130
    v_sin_f32 v99, v131
    v_sin_f32 v100, v132
    v_sin_f32 v101, v133
    v_sin_f32 v102, v134
    v_sin_f32 v103, v135
    v_sin_f32 v104, v136
    v_sin_f32 v105, v137
    v_sin_f32 v106, v138
    v_sin_f32 v107, v139
    v_sin_f32 v108, v140
    v_sin_f32 v109, v141
    v_sin_f32 v110, v142
    v_sin_f32 v111, v143
    v_sub_u32 v4, 31, v1
    v_subrev_u32 v5, 1, v1
    v_cmp_lt_u32 vcc, 16, v1
    s_nop 1
    v_cndmask_b32 v4, v5, v4, vcc
    v_and_b32 v4, 15, v4
    v_lshlrev_b32 v4, 5, v4
    v_add_u32 v4, 130304, v4
    v_lshlrev_b32 v5, 9, v2
    v_add_u32 v6, v4, v5
    v_sub_u32 v7, v4, v5
    v_add_u32 v7, 7696, v7
    v_cmp_eq_u32 s[38:39], 0, v1
    v_mov_b32 v8, 4096
    s_nop 0
    v_cndmask_b32 v8, 0, v8, s[38:39]
    v_add_u32 v6, v6, v8
    v_add_u32 v7, v7, v8
    v_and_b32 v8, 15, v1
    v_cmp_eq_u32 s[38:39], 0, v8
    s_nop 1
    s_or_b64 s[40:41], s[38:39], vcc
    v_add_u32 v184, 0, v6
    v_subrev_u32 v8, 0, v7
    v_cndmask_b32 v184, v184, v8, vcc
    v_add_u32 v185, 1024, v6
    v_subrev_u32 v8, 1024, v7
    v_cndmask_b32 v185, v185, v8, vcc
    v_add_u32 v186, 2048, v6
    v_subrev_u32 v8, 2048, v7
    v_cndmask_b32 v186, v186, v8, vcc
    v_add_u32 v187, 3072, v6
    v_subrev_u32 v8, 3072, v7
    v_cndmask_b32 v187, v187, v8, vcc
    v_add_u32 v188, 4096, v6
    v_subrev_u32 v8, 4096, v7
    v_cndmask_b32 v188, v188, v8, s[40:41]
    v_add_u32 v189, 5120, v6
    v_subrev_u32 v8, 5120, v7
    v_cndmask_b32 v189, v189, v8, s[40:41]
    v_add_u32 v190, 6144, v6
    v_subrev_u32 v8, 6144, v7
    v_cndmask_b32 v190, v190, v8, s[40:41]
    v_add_u32 v191, 7168, v6
    v_subrev_u32 v8, 7168, v7
    v_cndmask_b32 v191, v191, v8, s[40:41]
    v_add_u32 v212, 512, v188
    v_add_u32 v213, 512, v189
    v_add_u32 v214, 512, v190
    v_add_u32 v215, 512, v191
    v_subrev_u32 v8, 4096, v212
    v_cmp_eq_u32 vcc, 0, v2
    s_nop 1
    v_cndmask_b32 v212, v212, v8, vcc
    s_lshr_b32 s13, s20, 1
    v_lshl_add_u32 v3, v1, 1, s13
    s_and_b32 s13, s20, 1
    s_sub_u32 s14, 64, s13
    v_and_b32 v8, 3, v3
    v_lshlrev_b32 v8, 2, v8
    v_lshlrev_b32 v4, 3, v3
    v_sub_u32 v4, v4, v8
    v_sub_u32 v5, 63, v3
    v_and_b32 v8, 3, v5
    v_mul_u32_u24 v8, 12, v8
    v_lshlrev_b32 v6, 3, v5
    v_sub_u32 v6, v6, v8
    v_add_u32 v6, 28, v6
    v_sub_u32 v5, s14, v3
    v_and_b32 v8, 3, v5
    v_mul_u32_u24 v8, 12, v8
    v_lshlrev_b32 v7, 3, v5
    v_sub_u32 v7, v7, v8
    v_add_u32 v7, 28, v7
    v_cmp_gt_u32 vcc, 32, v3
    s_nop 1
    v_cndmask_b32 v7, v7, v4, vcc
    v_cmp_eq_u32 vcc, 32, v5
    s_nop 1
    v_cndmask_b32 v7, v7, 28, vcc
    s_cmp_eq_u32 s13, 0
    s_cselect_b32 s14, 256, 0
    s_cselect_b32 s15, 576, 0
    s_cselect_b64 s[38:39], -1, 0
    s_add_u32 s14, s14, 7680
    s_sub_u32 s15, 120832, s15
    v_cmp_gt_u32 vcc, 32, v3
    s_nop 1
    v_cndmask_b32 v7, v7, v4, vcc
    v_add_u32 v7, s14, v7
    v_cndmask_b32 v4, v6, v4, s[38:39]
    v_lshl_add_u32 v4, v2, 12, v4
    v_lshrrev_b32 v8, 7, v4
    v_lshl_add_u32 v4, v8, 4, v4
    v_lshrrev_b32 v8, 7, v7
    v_lshl_add_u32 v7, v8, 4, v7
    v_add_u32 v11, s15, v4
    v_add_u32 v7, 120832, v7
    v_add_u32 v12, 4032, v11
    v_cmp_eq_u32 vcc, s13, v2
    s_nop 1
    s_and_b64 s[40:41], vcc, s[38:39]
    s_andn2_b64 s[38:39], vcc, s[38:39]
    v_cndmask_b32 v10, v11, v7, s[40:41]
    v_cndmask_b32 v12, v12, v7, s[38:39]
    s_lshl_b32 s23, s20, 5
    s_add_u32 s23, s23, s18
    v_and_b32 v3, 15, v15
    v_lshrrev_b32 v4, 4, v15
    v_lshl_add_u32 v3, v3, 7, v4
    v_add_u32 v3, 1, v3
    v_cmp_le_u32 vcc, 56, v15
    v_mov_b32 v4, 1008
    s_nop 0
    v_cndmask_b32 v4, 0, v4, vcc
    v_add_u32 v4, v3, v4
    v_mul_u32_u24 v3, s23, v3
    v_and_b32 v3, 2047, v3
    v_cvt_f32_u32 v3, v3
    v_mul_f32 v3, 0x3a000000, v3
    v_mul_u32_u24 v4, s23, v4
    v_and_b32 v4, 2047, v4
    v_cvt_f32_u32 v4, v4
    v_mul_f32 v4, 0x3a000000, v4
    v_cvt_f32_u32 v5, s23
    v_mul_f32 v5, 0x3a000000, v5
    v_mov_b32 v192, v3
    v_fmamk_f32 v193, v5, 0x42000000, v3
    v_fmamk_f32 v194, v5, 0x42800000, v3
    v_fmamk_f32 v195, v5, 0x42c00000, v3
    v_fmamk_f32 v196, v5, 0x40800000, v3
    v_fmamk_f32 v197, v5, 0x42100000, v3
    v_fmamk_f32 v198, v5, 0x42880000, v3
    v_fmamk_f32 v199, v5, 0x42c80000, v3
    v_fmamk_f32 v200, v5, 0x41000000, v3
    v_fmamk_f32 v201, v5, 0x42200000, v3
    v_fmamk_f32 v202, v5, 0x42900000, v3
    v_fmamk_f32 v203, v5, 0x42d00000, v3
    v_fmamk_f32 v204, v5, 0x41400000, v4
    v_fmamk_f32 v205, v5, 0x42300000, v4
    v_fmamk_f32 v206, v5, 0x42980000, v4
    v_fmamk_f32 v207, v5, 0x42d80000, v4
    v_cos_f32 v192, v192
    v_cos_f32 v193, v193
    v_cos_f32 v194, v194
    v_cos_f32 v195, v195
    v_cos_f32 v196, v196
    v_cos_f32 v197, v197
    v_cos_f32 v198, v198
    v_cos_f32 v199, v199
    v_cos_f32 v200, v200
    v_cos_f32 v201, v201
    v_cos_f32 v202, v202
    v_cos_f32 v203, v203
    v_cos_f32 v204, v204
    v_cos_f32 v205, v205
    v_cos_f32 v206, v206
    v_cos_f32 v207, v207
    v_add_u32 v9, 138496, v14
    v_mov_b32 v3, 157864
    s_nop 4
fk_c2s:
    ds_read_b32 v4, v3
    s_waitcnt lgkmcnt(0)
    v_readfirstlane_b32 s13, v4
    s_nop 1
    s_cmp_eq_u32 s13, 0
    s_cbranch_scc1 fk_c2s
    ds_read_b128 v[112:115], v9 offset:12288
    ds_read_b128 v[116:119], v9 offset:13312
    ds_read_b128 v[120:123], v9 offset:14336
    ds_read_b128 v[124:127], v9 offset:15360
    s_setprio 2
    s_waitcnt lgkmcnt(0)
    s_barrier
    ds_read_b128 v[16:19], v184
    ds_read_b128 v[20:23], v185
    ds_read_b128 v[24:27], v186
    ds_read_b128 v[28:31], v187
    ds_read_b128 v[32:35], v188
    ds_read_b128 v[36:39], v189
    ds_read_b128 v[40:43], v190
    ds_read_b128 v[44:47], v191
    s_mov_b32 exec_lo, 1
    s_mov_b32 exec_hi, 1
    ds_read_b32 v32, v212
    ds_read_b32 v36, v213
    ds_read_b32 v40, v214
    ds_read_b32 v44, v215
    s_mov_b64 exec, -1
    s_waitcnt lgkmcnt(11)
    v_mfma_f32_32x32x16_f16 v[128:143], v[16:19], v[48:51], 0
    s_waitcnt lgkmcnt(10)
    v_mfma_f32_32x32x16_f16 v[128:143], v[20:23], v[52:55], v[128:143]
    s_waitcnt lgkmcnt(9)
    v_mfma_f32_32x32x16_f16 v[128:143], v[24:27], v[56:59], v[128:143]
    s_waitcnt lgkmcnt(8)
    v_mfma_f32_32x32x16_f16 v[128:143], v[28:31], v[60:63], v[128:143]
    s_waitcnt lgkmcnt(3)
    v_mfma_f32_32x32x16_f16 v[128:143], v[32:35], v[64:67], v[128:143]
    s_waitcnt lgkmcnt(2)
    v_mfma_f32_32x32x16_f16 v[128:143], v[36:39], v[68:71], v[128:143]
    s_waitcnt lgkmcnt(1)
    v_mfma_f32_32x32x16_f16 v[128:143], v[40:43], v[72:75], v[128:143]
    s_waitcnt lgkmcnt(0)
    v_mfma_f32_32x32x16_f16 v[128:143], v[44:47], v[76:79], v[128:143]
    s_nop 11
    v_pk_mul_f32 v[16:17], v[128:129], v[80:81]
    v_pk_mul_f32 v[18:19], v[130:131], v[82:83]
    v_pk_mul_f32 v[20:21], v[132:133], v[84:85]
    v_pk_mul_f32 v[22:23], v[134:135], v[86:87]
    v_pk_mul_f32 v[24:25], v[136:137], v[88:89]
    v_pk_mul_f32 v[26:27], v[138:139], v[90:91]
    v_pk_mul_f32 v[28:29], v[140:141], v[92:93]
    v_pk_mul_f32 v[30:31], v[142:143], v[94:95]
    v_fmac_f32_dpp v16, v128, v96 quad_perm:[1,0,3,2] row_mask:0xf bank_mask:0xf
    v_fmac_f32_dpp v17, v129, v97 quad_perm:[1,0,3,2] row_mask:0xf bank_mask:0xf
    v_fmac_f32_dpp v18, v130, v98 quad_perm:[1,0,3,2] row_mask:0xf bank_mask:0xf
    v_fmac_f32_dpp v19, v131, v99 quad_perm:[1,0,3,2] row_mask:0xf bank_mask:0xf
    v_fmac_f32_dpp v20, v132, v100 quad_perm:[1,0,3,2] row_mask:0xf bank_mask:0xf
    v_fmac_f32_dpp v21, v133, v101 quad_perm:[1,0,3,2] row_mask:0xf bank_mask:0xf
    v_fmac_f32_dpp v22, v134, v102 quad_perm:[1,0,3,2] row_mask:0xf bank_mask:0xf
    v_fmac_f32_dpp v23, v135, v103 quad_perm:[1,0,3,2] row_mask:0xf bank_mask:0xf
    v_cvt_pk_f16_f32 v176, v16, v17
    v_cvt_pk_f16_f32 v177, v18, v19
    v_cvt_pk_f16_f32 v178, v20, v21
    v_cvt_pk_f16_f32 v179, v22, v23
    v_fmac_f32_dpp v24, v136, v104 quad_perm:[1,0,3,2] row_mask:0xf bank_mask:0xf
    v_fmac_f32_dpp v25, v137, v105 quad_perm:[1,0,3,2] row_mask:0xf bank_mask:0xf
    v_mfma_f32_32x32x16_f16 v[144:159], v[176:179], v[112:115], 0
    v_fmac_f32_dpp v26, v138, v106 quad_perm:[1,0,3,2] row_mask:0xf bank_mask:0xf
    v_fmac_f32_dpp v27, v139, v107 quad_perm:[1,0,3,2] row_mask:0xf bank_mask:0xf
    v_fmac_f32_dpp v28, v140, v108 quad_perm:[1,0,3,2] row_mask:0xf bank_mask:0xf
    v_fmac_f32_dpp v29, v141, v109 quad_perm:[1,0,3,2] row_mask:0xf bank_mask:0xf
    v_fmac_f32_dpp v30, v142, v110 quad_perm:[1,0,3,2] row_mask:0xf bank_mask:0xf
    v_mfma_f32_32x32x16_f16 v[160:175], v[176:179], v[120:123], 0
    v_fmac_f32_dpp v31, v143, v111 quad_perm:[1,0,3,2] row_mask:0xf bank_mask:0xf
    v_cvt_pk_f16_f32 v180, v24, v25
    v_cvt_pk_f16_f32 v181, v26, v27
    v_cvt_pk_f16_f32 v182, v28, v29
    v_cvt_pk_f16_f32 v183, v30, v31
    s_nop 1
    v_mfma_f32_32x32x16_f16 v[144:159], v[180:183], v[116:119], v[144:159]
    v_mfma_f32_32x32x16_f16 v[160:175], v[180:183], v[124:127], v[160:175]
    s_nop 11
    v_pk_add_f32 v[16:17], v[144:145], v[160:161] op_sel:[0,1] op_sel_hi:[1,0] neg_hi:[0,1]
    v_pk_add_f32 v[18:19], v[146:147], v[162:163] op_sel:[0,1] op_sel_hi:[1,0] neg_hi:[0,1]
    v_pk_add_f32 v[20:21], v[148:149], v[164:165] op_sel:[0,1] op_sel_hi:[1,0] neg_hi:[0,1]
    v_pk_add_f32 v[22:23], v[150:151], v[166:167] op_sel:[0,1] op_sel_hi:[1,0] neg_hi:[0,1]
    v_pk_add_f32 v[24:25], v[152:153], v[168:169] op_sel:[0,1] op_sel_hi:[1,0] neg_hi:[0,1]
    v_pk_add_f32 v[26:27], v[154:155], v[170:171] op_sel:[0,1] op_sel_hi:[1,0] neg_hi:[0,1]
    v_pk_add_f32 v[28:29], v[156:157], v[172:173] op_sel:[0,1] op_sel_hi:[1,0] neg_hi:[0,1]
    v_pk_add_f32 v[30:31], v[158:159], v[174:175] op_sel:[0,1] op_sel_hi:[1,0] neg_hi:[0,1]
    v_cvt_pk_f16_f32 v48, v16, v17
    ds_write_b32 v10, v48
    v_cvt_pk_f16_f32 v49, v18, v19
    ds_write_b32 v11, v49 offset:576
    v_cvt_pk_f16_f32 v50, v20, v21
    ds_write_b32 v11, v50 offset:1152
    v_cvt_pk_f16_f32 v51, v22, v23
    ds_write_b32 v11, v51 offset:1728
    v_cvt_pk_f16_f32 v52, v24, v25
    ds_write_b32 v11, v52 offset:2304
    v_cvt_pk_f16_f32 v53, v26, v27
    ds_write_b32 v11, v53 offset:2880
    v_cvt_pk_f16_f32 v54, v28, v29
    ds_write_b32 v11, v54 offset:3456
    v_cvt_pk_f16_f32 v55, v30, v31
    ds_write_b32 v12, v55
    s_nop 3
fk_common:
    v_lshlrev_b32 v4, 4, v0
    v_lshrrev_b32 v5, 3, v0
    v_lshl_add_u32 v5, v5, 4, v4
    v_add_u32 v5, 120832, v5
    s_mul_i32 s17, s3, 8320
    s_add_u32 s17, s17, 0x268000
    s_waitcnt lgkmcnt(0)
    s_barrier
    s_setprio 0
    ds_read_b128 v[16:19], v5
    s_sub_u32 s13, 7, s16
    s_cmp_lt_u32 s16, 4
    s_cselect_b32 s13, s16, s13
    s_cselect_b32 s14, 0, 2048
    s_lshl_b32 s21, s13, 5
    s_add_u32 s21, s21, s18
    s_sub_u32 s22, 2048, s21
    s_and_b32 s22, s22, 2047
    s_cmp_lt_u32 s16, 4
    s_cselect_b32 s21, s21, s22
    s_lshl_b32 s13, s13, 12
    s_add_u32 s13, s13, s14
    s_add_u32 s13, s13, 98304
    s_lshl_b32 s14, s3, 3
    s_add_u32 s19, s14, s16
    s_cmp_eq_u32 s19, 1991
    s_cselect_b32 s21, 1024, s21
    s_cselect_b32 s13, 118784, s13
    s_lshl_b32 s22, s21, 11
    v_add_u32 v6, s13, v14
    v_add_u32 v7, 155008, v14
    s_waitcnt lgkmcnt(0)
    v_min_u32 v16, -2, v16
    v_min_u32 v17, -2, v17
    v_min_u32 v18, -2, v18
    v_min_u32 v19, -2, v19
    buffer_store_dwordx4 v[16:19], v4, s[24:27], s17 offen sc1
    ds_read_b128 v[20:23], v6
    ds_read_b128 v[24:27], v6 offset:1024
    ds_read_b128 v[28:31], v7
    ds_read_b128 v[32:35], v7 offset:1024
    s_cmp_lt_u32 s16, 4
    s_cbranch_scc1 fk_noy5
    v_add_u32 v3, 114688, v14
    v_mov_b32 v4, 157152
    ds_read_b128 v[128:131], v3 offset:0
    ds_read_b128 v[132:135], v3 offset:1024
    ds_read_b128 v[136:139], v3 offset:2048
    ds_read_b128 v[140:143], v3 offset:3072
    ds_read_b32 v9, v4
    s_lshl_b32 s38, s20, 2
    s_sub_u32 s39, 28, s38
    s_waitcnt lgkmcnt(0)
    s_nop 0
fk_y5:
    v_pk_mul_f32 v[144:145], v[128:129], v[192:193]
    v_pk_mul_f32 v[146:147], v[130:131], v[194:195]
    v_pk_fma_f32 v[144:145], v[132:133], v[196:197], v[144:145]
    v_pk_fma_f32 v[146:147], v[134:135], v[198:199], v[146:147]
    v_pk_fma_f32 v[144:145], v[136:137], v[200:201], v[144:145]
    v_pk_fma_f32 v[146:147], v[138:139], v[202:203], v[146:147]
    v_pk_fma_f32 v[144:145], v[140:141], v[204:205], v[144:145]
    v_pk_fma_f32 v[146:147], v[142:143], v[206:207], v[146:147]
    v_pk_add_f32 v[144:145], v[144:145], v[146:147]
    v_add_f32 v144, v144, v145
    s_lshl_b32 s13, s23, 31
    v_xor_b32 v12, s13, v9
    v_add_f32_dpp v144, v144, v144 quad_perm:[1,0,3,2] row_mask:0xf bank_mask:0xf
    s_nop 1
    v_add_f32_dpp v144, v144, v144 quad_perm:[2,3,0,1] row_mask:0xf bank_mask:0xf
    s_nop 1
    v_add_f32_dpp v144, v144, v144 row_half_mirror row_mask:0xf bank_mask:0xf
    s_nop 1
    v_add_f32_dpp v144, v144, v144 row_mirror row_mask:0xf bank_mask:0xf
    s_nop 1
    v_add_f32_dpp v144, v144, v144 row_bcast:15 row_mask:0xa bank_mask:0xf
    s_nop 1
    v_add_f32_dpp v144, v144, v144 row_bcast:31 row_mask:0xc bank_mask:0xf
    v_add_f32 v144, v144, v12
    v_add_f32 v144, v144, v144
    v_cvt_f16_f32 v144, v144
    s_add_u32 s13, s38, 157088
    s_add_u32 s14, s39, 157088
    v_mov_b32 v10, s13
    v_mov_b32 v11, s14
    s_mov_b32 exec_lo, 0
    s_mov_b32 exec_hi, 0x80000000
    ds_write_b32 v10, v144
    ds_write_b32 v11, v144
    s_mov_b64 exec, -1
    s_cmp_lg_u32 s23, 0
    s_cbranch_scc1 fk_noy5
    s_mov_b32 s23, 1024
    s_mov_b32 s38, 28
    v_and_b32 v3, 15, v15
    v_lshrrev_b32 v4, 4, v15
    v_lshl_add_u32 v3, v3, 7, v4
    v_add_u32 v3, 1, v3
    v_cmp_le_u32 vcc, 56, v15
    v_mov_b32 v4, 1008
    s_nop 0
    v_cndmask_b32 v4, 0, v4, vcc
    v_add_u32 v4, v3, v4
    v_mul_u32_u24 v3, s23, v3
    v_and_b32 v3, 2047, v3
    v_cvt_f32_u32 v3, v3
    v_mul_f32 v3, 0x3a000000, v3
    v_mul_u32_u24 v4, s23, v4
    v_and_b32 v4, 2047, v4
    v_cvt_f32_u32 v4, v4
    v_mul_f32 v4, 0x3a000000, v4
    v_cvt_f32_u32 v5, s23
    v_mul_f32 v5, 0x3a000000, v5
    v_mov_b32 v192, v3
    v_fmamk_f32 v193, v5, 0x42000000, v3
    v_fmamk_f32 v194, v5, 0x42800000, v3
    v_fmamk_f32 v195, v5, 0x42c00000, v3
    v_fmamk_f32 v196, v5, 0x40800000, v3
    v_fmamk_f32 v197, v5, 0x42100000, v3
    v_fmamk_f32 v198, v5, 0x42880000, v3
    v_fmamk_f32 v199, v5, 0x42c80000, v3
    v_fmamk_f32 v200, v5, 0x41000000, v3
    v_fmamk_f32 v201, v5, 0x42200000, v3
    v_fmamk_f32 v202, v5, 0x42900000, v3
    v_fmamk_f32 v203, v5, 0x42d00000, v3
    v_fmamk_f32 v204, v5, 0x41400000, v4
    v_fmamk_f32 v205, v5, 0x42300000, v4
    v_fmamk_f32 v206, v5, 0x42980000, v4
    v_fmamk_f32 v207, v5, 0x42d80000, v4
    v_cos_f32 v192, v192
    v_cos_f32 v193, v193
    v_cos_f32 v194, v194
    v_cos_f32 v195, v195
    v_cos_f32 v196, v196
    v_cos_f32 v197, v197
    v_cos_f32 v198, v198
    v_cos_f32 v199, v199
    v_cos_f32 v200, v200
    v_cos_f32 v201, v201
    v_cos_f32 v202, v202
    v_cos_f32 v203, v203
    v_cos_f32 v204, v204
    v_cos_f32 v205, v205
    v_cos_f32 v206, v206
    v_cos_f32 v207, v207
    s_branch fk_y5
    s_nop 3
fk_noy5:
    v_lshrrev_b32 v1, 1, v0
    v_and_b32 v45, 1, v0
    v_lshrrev_b32 v2, 4, v1
    v_and_b32 v3, 15, v1
    v_cmp_gt_u32 vcc, 8, v3
    v_sub_u32 v6, 16, v3
    v_and_b32 v6, 7, v6
    v_sub_u32 v5, 31, v2
    v_cndmask_b32 v6, v6, v3, vcc
    v_cndmask_b32 v5, v5, v2, vcc
    v_lshl_add_u32 v4, v6, 5, v5
    v_and_b32 v12, 63, v4
    v_lshrrev_b32 v13, 6, v4
    v_lshlrev_b32 v13, 2, v13
    v_lshl_add_u32 v12, v12, 4, v13
    s_mov_b32 s23, 0x13000
    s_mov_b32 s42, 0
    buffer_load_dword v47, v12, s[24:27], s23 offen sc1
    v_mul_u32_u24 v4, 8320, v4
    v_lshl_add_u32 v4, v45, 4, v4
    s_lshl_b32 s17, s3, 5
    s_add_u32 s17, s17, 0x268000
    v_cndmask_b32 v6, -1, 1, vcc
    v_cmp_eq_u32 vcc, 8, v3
    v_mul_u32_u24 v46, 8256, v45
    v_add_u32 v46, 138496, v46
    v_cndmask_b32 v6, v6, 15, vcc
    v_lshlrev_b32 v9, 2, v1
    v_lshl_add_u32 v10, v6, 1, v9
    v_add_u32 v9, v46, v9
    v_add_u32 v10, v46, v10
    s_mul_i32 s36, s16, 2064
    s_add_u32 s36, s36, 138496
    v_add_u32 v5, s36, v14
    s_sub_u32 s36, 7, s16
    s_cmp_eq_u32 s21, 0
    s_cselect_b32 s36, 0, s36
    s_cmp_eq_u32 s21, 1024
    s_cselect_b32 s36, 7, s36
    s_mul_i32 s36, s36, 2064
    s_add_u32 s36, s36, 139504
    v_sub_u32 v11, s36, v14
    s_lshl_b32 s36, s16, 2
    s_add_u32 s36, s36, 157088
    v_mov_b32 v6, s36
    s_mov_b32 s36, 0xffff0000
    s_mov_b32 s37, 0x3f803f80
    s_mov_b32 s38, 0x42800000
    s_waitcnt lgkmcnt(0)
    v_lshlrev_b32 v48, 16, v20
    v_and_b32 v49, s36, v20
    v_lshlrev_b32 v50, 16, v21
    v_and_b32 v51, s36, v21
    v_lshlrev_b32 v52, 16, v22
    v_and_b32 v53, s36, v22
    v_lshlrev_b32 v54, 16, v23
    v_and_b32 v55, s36, v23
    v_lshlrev_b32 v56, 16, v24
    v_and_b32 v57, s36, v24
    v_lshlrev_b32 v58, 16, v25
    v_and_b32 v59, s36, v25
    v_lshlrev_b32 v60, 16, v26
    v_and_b32 v61, s36, v26
    v_lshlrev_b32 v62, 16, v27
    v_and_b32 v63, s36, v27
    v_mov_b32 v44, 0
    v_dot2c_f32_bf16 v44, s37, v28
    v_dot2c_f32_bf16 v44, s37, v29
    v_dot2c_f32_bf16 v44, s37, v30
    v_dot2c_f32_bf16 v44, s37, v31
    v_dot2c_f32_bf16 v44, s37, v32
    v_dot2c_f32_bf16 v44, s37, v33
    v_dot2c_f32_bf16 v44, s37, v34
    v_dot2c_f32_bf16 v44, s37, v35
    s_nop 2
    v_add_f32_dpp v44, v44, v44 quad_perm:[1,0,3,2] row_mask:0xf bank_mask:0xf
    s_nop 1
    v_add_f32_dpp v44, v44, v44 quad_perm:[2,3,0,1] row_mask:0xf bank_mask:0xf
    s_nop 1
    v_add_f32_dpp v44, v44, v44 row_half_mirror row_mask:0xf bank_mask:0xf
    s_nop 1
    v_add_f32_dpp v44, v44, v44 row_mirror row_mask:0xf bank_mask:0xf
    s_nop 1
    v_add_f32_dpp v44, v44, v44 row_bcast:15 row_mask:0xa bank_mask:0xf
    s_nop 1
    v_add_f32_dpp v44, v44, v44 row_bcast:31 row_mask:0xc bank_mask:0xf
    s_nop 0
    v_readlane_b32 s39, v44, 63
    s_and_b32 s13, s18, 1
    s_mul_i32 s40, s13, 0x80008000
    s_branch fk_chkr1
    s_nop 1
fk_pollr1:
    buffer_load_dword v47, v12, s[24:27], s23 offen sc1
fk_chkr1:
    s_add_u32 s42, s42, 1
    s_waitcnt vmcnt(0)
    v_cmp_eq_u32 vcc, -1, v47
    s_cbranch_vccz fk_gotr1
    s_cmp_le_u32 s42, 0x40000
    s_cbranch_scc1 fk_pollr1
    s_nop 1
fk_gotr1:
    v_xor_b32 v47, s40, v47
    s_mov_b32 s42, 0
    s_sleep 2
    s_nop 2
fk_polly:
    buffer_load_dwordx4 v[36:39], v4, s[24:27], s17 offen sc1
    s_add_u32 s42, s42, 1
    s_waitcnt vmcnt(0)
    v_max3_u32 v46, v36, v37, v38
    v_max_u32 v46, v46, v39
    v_cmp_eq_u32 vcc, -1, v46
    s_cbranch_vccz fk_goty
    s_cmp_le_u32 s42, 0x40000
    s_cbranch_scc1 fk_polly
    s_nop 1
fk_goty:
    v_pk_add_f16 v36, v36, v47
    v_pk_add_f16 v37, v37, v47
    v_pk_add_f16 v38, v38, v47
    v_pk_add_f16 v39, v39, v47
    ds_write_b16 v9, v36 offset:0
    ds_write_b16_d16_hi v10, v36 offset:0
    ds_write_b16 v9, v37 offset:2064
    ds_write_b16_d16_hi v10, v37 offset:2064
    ds_write_b16 v9, v38 offset:4128
    ds_write_b16_d16_hi v10, v38 offset:4128
    ds_write_b16 v9, v39 offset:6192
    ds_write_b16_d16_hi v10, v39 offset:6192
    s_cmp_gt_u32 s3, 223
    s_cbranch_scc1 fk_win3
    s_mul_i32 s15, s16, 4
    s_add_u32 s15, s15, 40
    s_mov_b32 s58, 0x700000
    s_mov_b32 s59, 0x00020000
    s_cmp_gt_u32 s15, 95
    s_cbranch_scc1 fk_win3
    s_lshl_b32 s12, s15, 10
    s_mov_b32 m0, s12
    s_and_b32 s14, s12, 1024
    s_lshr_b32 s14, s14, 4
    v_xor_b32 v209, s14, v208
    s_cmp_lt_u32 s15, 32
    s_cselect_b64 s[56:57], s[44:45], s[48:49]
    s_and_b32 s14, s15, 31
    s_mul_i32 s13, s14, 57344
    s_add_u32 s13, s13, s100
    s_lshl_b32 s14, s14, 12
    s_add_u32 s14, s14, s101
    s_cmp_lt_u32 s15, 64
    s_cselect_b64 s[56:57], s[56:57], s[52:53]
    s_cselect_b32 s13, s13, s14
    s_cselect_b64 vcc, -1, 0
    v_cndmask_b32 v209, v210, v209, vcc
    s_add_u32 s15, s15, 1
    buffer_load_dwordx4 v209, s[56:59], s13 offen lds
    s_cmp_gt_u32 s15, 95
    s_cbranch_scc1 fk_win3
    s_lshl_b32 s12, s15, 10
    s_mov_b32 m0, s12
    s_and_b32 s14, s12, 1024
    s_lshr_b32 s14, s14, 4
    v_xor_b32 v209, s14, v208
    s_cmp_lt_u32 s15, 32
    s_cselect_b64 s[56:57], s[44:45], s[48:49]
    s_and_b32 s14, s15, 31
    s_mul_i32 s13, s14, 57344
    s_add_u32 s13, s13, s100
    s_lshl_b32 s14, s14, 12
    s_add_u32 s14, s14, s101
    s_cmp_lt_u32 s15, 64
    s_cselect_b64 s[56:57], s[56:57], s[52:53]
    s_cselect_b32 s13, s13, s14
    s_cselect_b64 vcc, -1, 0
    v_cndmask_b32 v209, v210, v209, vcc
    s_add_u32 s15, s15, 1
    buffer_load_dwordx4 v209, s[56:59], s13 offen lds
    s_cmp_gt_u32 s15, 95
    s_cbranch_scc1 fk_win3
    s_lshl_b32 s12, s15, 10
    s_mov_b32 m0, s12
    s_and_b32 s14, s12, 1024
    s_lshr_b32 s14, s14, 4
    v_xor_b32 v209, s14, v208
    s_cmp_lt_u32 s15, 32
    s_cselect_b64 s[56:57], s[44:45], s[48:49]
    s_and_b32 s14, s15, 31
    s_mul_i32 s13, s14, 57344
    s_add_u32 s13, s13, s100
    s_lshl_b32 s14, s14, 12
    s_add_u32 s14, s14, s101
    s_cmp_lt_u32 s15, 64
    s_cselect_b64 s[56:57], s[56:57], s[52:53]
    s_cselect_b32 s13, s13, s14
    s_cselect_b64 vcc, -1, 0
    v_cndmask_b32 v209, v210, v209, vcc
    s_add_u32 s15, s15, 1
    buffer_load_dwordx4 v209, s[56:59], s13 offen lds
    s_cmp_gt_u32 s15, 95
    s_cbranch_scc1 fk_win3
    s_lshl_b32 s12, s15, 10
    s_mov_b32 m0, s12
    s_and_b32 s14, s12, 1024
    s_lshr_b32 s14, s14, 4
    v_xor_b32 v209, s14, v208
    s_cmp_lt_u32 s15, 32
    s_cselect_b64 s[56:57], s[44:45], s[48:49]
    s_and_b32 s14, s15, 31
    s_mul_i32 s13, s14, 57344
    s_add_u32 s13, s13, s100
    s_lshl_b32 s14, s14, 12
    s_add_u32 s14, s14, s101
    s_cmp_lt_u32 s15, 64
    s_cselect_b64 s[56:57], s[56:57], s[52:53]
    s_cselect_b32 s13, s13, s14
    s_cselect_b64 vcc, -1, 0
    v_cndmask_b32 v209, v210, v209, vcc
    s_add_u32 s15, s15, 1
    buffer_load_dwordx4 v209, s[56:59], s13 offen lds
    s_nop 2
fk_win3:
    v_mov_b32 v2, 0
    v_mov_b32 v3, 0
    v_mov_b32 v4, 0
    v_mov_b32 v7, 0
    v_mov_b32 v12, 157120
    s_waitcnt lgkmcnt(0)
    s_barrier
    ds_read_b128 v[36:39], v5
    ds_read_b128 v[40:43], v11
    ds_read_b32 v44, v6
    s_waitcnt lgkmcnt(2)
    v_fma_mix_f32 v48, v36, s38, v48 op_sel:[0,0,0] op_sel_hi:[1,0,0]
    v_fma_mix_f32 v49, v36, s38, v49 op_sel:[1,0,0] op_sel_hi:[1,0,0]
    v_fma_mix_f32 v50, v37, s38, v50 op_sel:[0,0,0] op_sel_hi:[1,0,0]
    v_fma_mix_f32 v51, v37, s38, v51 op_sel:[1,0,0] op_sel_hi:[1,0,0]
    v_fma_mix_f32 v52, v38, s38, v52 op_sel:[0,0,0] op_sel_hi:[1,0,0]
    v_fma_mix_f32 v53, v38, s38, v53 op_sel:[1,0,0] op_sel_hi:[1,0,0]
    v_fma_mix_f32 v54, v39, s38, v54 op_sel:[0,0,0] op_sel_hi:[1,0,0]
    v_fma_mix_f32 v55, v39, s38, v55 op_sel:[1,0,0] op_sel_hi:[1,0,0]
    s_waitcnt lgkmcnt(0)
    v_readfirstlane_b32 s13, v44
    v_mov_b32_dpp v8, v40 wave_shr:1 row_mask:0xf bank_mask:0xf
    v_fma_mix_f32 v57, v43, s38, v57 op_sel:[1,0,0] op_sel_hi:[1,0,0]
    v_fma_mix_f32 v58, v43, s38, v58 op_sel:[0,0,0] op_sel_hi:[1,0,0]
    v_fma_mix_f32 v59, v42, s38, v59 op_sel:[1,0,0] op_sel_hi:[1,0,0]
    v_fma_mix_f32 v60, v42, s38, v60 op_sel:[0,0,0] op_sel_hi:[1,0,0]
    v_writelane_b32 v8, s13, 0
    v_fma_mix_f32 v61, v41, s38, v61 op_sel:[1,0,0] op_sel_hi:[1,0,0]
    v_fma_mix_f32 v62, v41, s38, v62 op_sel:[0,0,0] op_sel_hi:[1,0,0]
    v_fma_mix_f32 v63, v40, s38, v63 op_sel:[1,0,0] op_sel_hi:[1,0,0]
    v_fma_mix_f32 v56, v8, s38, v56 op_sel:[0,0,0] op_sel_hi:[1,0,0]
    v_cvt_pk_bf16_f32 v80, v48, v49
    v_cvt_pk_bf16_f32 v81, v50, v51
    v_cvt_pk_bf16_f32 v82, v52, v53
    v_cvt_pk_bf16_f32 v83, v54, v55
    v_cvt_pk_bf16_f32 v85, v58, v59
    v_cvt_pk_bf16_f32 v86, v60, v61
    v_cvt_pk_bf16_f32 v87, v62, v63
    v_cvt_pk_bf16_f32 v84, v56, v57
    v_dot2c_f32_bf16 v2, s37, v80
    v_dot2c_f32_bf16 v3, v80, v80
    v_dot2c_f32_bf16 v4, v80, v28
    v_dot2c_f32_bf16 v2, s37, v81
    v_dot2c_f32_bf16 v3, v81, v81
    v_dot2c_f32_bf16 v4, v81, v29
    v_dot2c_f32_bf16 v2, s37, v82
    v_dot2c_f32_bf16 v3, v82, v82
    v_dot2c_f32_bf16 v4, v82, v30
    v_dot2c_f32_bf16 v2, s37, v83
    v_dot2c_f32_bf16 v3, v83, v83
    v_dot2c_f32_bf16 v4, v83, v31
    v_dot2c_f32_bf16 v2, s37, v85
    v_dot2c_f32_bf16 v3, v85, v85
    v_dot2c_f32_bf16 v4, v85, v33
    v_dot2c_f32_bf16 v2, s37, v86
    v_dot2c_f32_bf16 v3, v86, v86
    v_dot2c_f32_bf16 v4, v86, v34
    v_dot2c_f32_bf16 v2, s37, v87
    v_dot2c_f32_bf16 v3, v87, v87
    v_dot2c_f32_bf16 v4, v87, v35
    v_dot2c_f32_bf16 v2, s37, v84
    v_dot2c_f32_bf16 v3, v84, v84
    v_dot2c_f32_bf16 v4, v84, v32
    s_nop 2
    v_permlane32_swap_b32 v2, v4
    v_permlane32_swap_b32 v3, v7
    v_add_f32 v2, v2, v4
    v_add_f32 v3, v3, v7
    s_nop 1
    v_permlane16_swap_b32 v2, v3
    v_add_f32 v2, v2, v3
    s_nop 1
    v_add_f32_dpp v2, v2, v2 quad_perm:[1,0,3,2] row_mask:0xf bank_mask:0xf
    s_nop 1
    v_add_f32_dpp v2, v2, v2 quad_perm:[2,3,0,1] row_mask:0xf bank_mask:0xf
    s_nop 1
    v_add_f32_dpp v2, v2, v2 row_half_mirror row_mask:0xf bank_mask:0xf
    s_nop 1
    v_add_f32_dpp v2, v2, v2 row_mirror row_mask:0xf bank_mask:0xf
    s_nop 0
    v_readlane_b32 s13, v2, 32
    v_mov_b32_dpp v8, v2 row_bcast:15 row_mask:0xa bank_mask:0xf
    v_mul_f32 v9, 0x3a800000, v2
    v_mul_f32 v8, 0x3a800000, v8
    v_fma_f32 v9, -v8, v8, v9
    v_max_f32 v9, 0, v9
    v_cvt_pk_bf16_f32 v9, 0, v9
    v_cvt_pk_bf16_f32 v8, 0, v8
    v_add_f32 v9, 0x3727c5ac, v9
    v_cvt_pk_bf16_f32 v9, 0, v9
    v_sqrt_f32 v9, v9
    s_nop 0
    v_cvt_pk_bf16_f32 v9, 0, v9
    v_rcp_f32 v9, v9
    v_mov_b32 v10, s13
    v_fma_f32 v10, -v8, s39, v10
    v_mul_f32 v10, v10, v9
    v_mul_f32 v8, v8, v9
    v_readlane_b32 s43, v10, 16
    v_readlane_b32 s4, v9, 16
    v_readlane_b32 s6, v8, 16
    s_ashr_i32 s13, s43, 31
    s_or_b32 s13, s13, 0x80000000
    s_xor_b32 s43, s43, s13
    s_and_b32 s43, s43, 0xfffff800
    s_or_b32 s43, s43, s19
    s_min_u32 s43, s43, -2
    v_mov_b32 v2, s43
    s_mov_b64 exec, 1
    ds_max_u32 v12, v2
    s_mov_b64 exec, -1
    v_mov_b32 v10, s6
    v_add_f32 v8, 1.0, v9
    v_lshlrev_b32 v4, 12, v15
    s_lshl_b32 s17, s3, 4
    s_add_u32 s17, s17, 0x9000
    v_readlane_b32 s14, v8, 16
    s_waitcnt lgkmcnt(0)
    s_barrier
    ds_read_b32 v3, v12
    v_lshlrev_b32 v48, 16, v80
    v_and_b32 v49, s36, v80
    v_lshlrev_b32 v50, 16, v81
    v_and_b32 v51, s36, v81
    v_lshlrev_b32 v52, 16, v82
    v_and_b32 v53, s36, v82
    v_lshlrev_b32 v54, 16, v83
    v_and_b32 v55, s36, v83
    v_lshlrev_b32 v56, 16, v84
    v_and_b32 v57, s36, v84
    v_lshlrev_b32 v58, 16, v85
    v_and_b32 v59, s36, v85
    v_lshlrev_b32 v60, 16, v86
    v_and_b32 v61, s36, v86
    v_lshlrev_b32 v62, 16, v87
    v_and_b32 v63, s36, v87
    s_waitcnt lgkmcnt(0)
    v_readfirstlane_b32 s13, v3
    s_nop 1
    s_cmp_lg_u32 s13, s43
    s_cbranch_scc1 fk_other
    s_mov_b64 exec, 0xff
    buffer_store_dword v2, v4, s[24:27], s17 offen sc1
    s_mov_b64 exec, -1
    v_pk_fma_f32 v[64:65], v[48:49], s[4:5], v[10:11] op_sel_hi:[1,0,0] neg_lo:[0,0,1] neg_hi:[0,0,1]
    v_pk_fma_f32 v[66:67], v[50:51], s[4:5], v[10:11] op_sel_hi:[1,0,0] neg_lo:[0,0,1] neg_hi:[0,0,1]
    v_pk_fma_f32 v[68:69], v[52:53], s[4:5], v[10:11] op_sel_hi:[1,0,0] neg_lo:[0,0,1] neg_hi:[0,0,1]
    v_pk_fma_f32 v[70:71], v[54:55], s[4:5], v[10:11] op_sel_hi:[1,0,0] neg_lo:[0,0,1] neg_hi:[0,0,1]
    v_pk_fma_f32 v[72:73], v[56:57], s[4:5], v[10:11] op_sel_hi:[1,0,0] neg_lo:[0,0,1] neg_hi:[0,0,1]
    v_pk_fma_f32 v[74:75], v[58:59], s[4:5], v[10:11] op_sel_hi:[1,0,0] neg_lo:[0,0,1] neg_hi:[0,0,1]
    v_pk_fma_f32 v[76:77], v[60:61], s[4:5], v[10:11] op_sel_hi:[1,0,0] neg_lo:[0,0,1] neg_hi:[0,0,1]
    v_pk_fma_f32 v[78:79], v[62:63], s[4:5], v[10:11] op_sel_hi:[1,0,0] neg_lo:[0,0,1] neg_hi:[0,0,1]
    v_cvt_pk_bf16_f32 v96, v64, v65
    v_cvt_pk_bf16_f32 v97, v66, v67
    v_cvt_pk_bf16_f32 v98, v68, v69
    v_cvt_pk_bf16_f32 v99, v70, v71
    v_cvt_pk_bf16_f32 v100, v72, v73
    v_cvt_pk_bf16_f32 v101, v74, v75
    v_cvt_pk_bf16_f32 v102, v76, v77
    v_cvt_pk_bf16_f32 v103, v78, v79
    v_and_b32 v96, -2, v96
    v_and_b32 v97, -2, v97
    v_and_b32 v98, -2, v98
    v_and_b32 v99, -2, v99
    v_and_b32 v100, -2, v100
    v_and_b32 v101, -2, v101
    v_and_b32 v102, -2, v102
    v_and_b32 v103, -2, v103
    s_mul_i32 s13, s3, 9344
    s_add_u32 s13, s13, 0x20000
    buffer_store_dwordx4 v[96:99], v14, s[24:27], s13 offen sc1
    buffer_store_dwordx4 v[100:103], v14, s[24:27], s13 offen offset:1024 sc1
    v_and_b32 v80, -2, v80
    v_and_b32 v81, -2, v81
    v_and_b32 v82, -2, v82
    v_and_b32 v83, -2, v83
    v_and_b32 v84, -2, v84
    v_and_b32 v85, -2, v85
    v_and_b32 v86, -2, v86
    v_and_b32 v87, -2, v87
    buffer_store_dwordx4 v[80:83], v14, s[24:27], s13 offen offset:2048 sc1
    buffer_store_dwordx4 v[84:87], v14, s[24:27], s13 offen offset:3072 sc1
    v_pk_fma_f32 v[64:65], v[48:49], s[14:15], v[10:11] op_sel_hi:[1,0,0] neg_lo:[0,0,1] neg_hi:[0,0,1]
    v_pk_fma_f32 v[66:67], v[50:51], s[14:15], v[10:11] op_sel_hi:[1,0,0] neg_lo:[0,0,1] neg_hi:[0,0,1]
    v_pk_fma_f32 v[68:69], v[52:53], s[14:15], v[10:11] op_sel_hi:[1,0,0] neg_lo:[0,0,1] neg_hi:[0,0,1]
    v_pk_fma_f32 v[70:71], v[54:55], s[14:15], v[10:11] op_sel_hi:[1,0,0] neg_lo:[0,0,1] neg_hi:[0,0,1]
    v_pk_fma_f32 v[72:73], v[56:57], s[14:15], v[10:11] op_sel_hi:[1,0,0] neg_lo:[0,0,1] neg_hi:[0,0,1]
    v_pk_fma_f32 v[74:75], v[58:59], s[14:15], v[10:11] op_sel_hi:[1,0,0] neg_lo:[0,0,1] neg_hi:[0,0,1]
    v_pk_fma_f32 v[76:77], v[60:61], s[14:15], v[10:11] op_sel_hi:[1,0,0] neg_lo:[0,0,1] neg_hi:[0,0,1]
    v_pk_fma_f32 v[78:79], v[62:63], s[14:15], v[10:11] op_sel_hi:[1,0,0] neg_lo:[0,0,1] neg_hi:[0,0,1]
    v_cvt_pk_bf16_f32 v112, v64, v65
    v_cvt_pk_bf16_f32 v113, v66, v67
    v_cvt_pk_bf16_f32 v114, v68, v69
    v_cvt_pk_bf16_f32 v115, v70, v71
    v_cvt_pk_bf16_f32 v116, v72, v73
    v_cvt_pk_bf16_f32 v117, v74, v75
    v_cvt_pk_bf16_f32 v118, v76, v77
    v_cvt_pk_bf16_f32 v119, v78, v79
    v_lshrrev_b32 v1, 4, v15
    v_bfe_u32 v2, v15, 2, 2
    v_lshl_add_u32 v8, v1, 3, v2
    v_lshlrev_b32 v8, 7, v8
    v_and_b32 v3, 2, v2
    v_xor_b32 v9, s16, v3
    v_and_b32 v3, 1, v1
    v_lshlrev_b32 v4, 2, v3
    v_xor_b32 v9, v4, v9
    v_lshl_add_u32 v8, v9, 4, v8
    v_and_b32 v9, 1, v15
    v_lshl_add_u32 v8, v9, 3, v8
    v_bfe_u32 v9, v15, 1, 1
    v_lshl_add_u32 v8, v9, 15, v8
    v_lshrrev_b32 v7, 1, v1
    v_lshl_add_u32 v7, v7, 3, v2
    v_lshlrev_b32 v7, 9, v7
    v_lshl_add_u32 v7, v3, 5, v7
    v_and_b32 v3, 3, v15
    v_lshl_add_u32 v7, v3, 3, v7
    s_lshl_b32 s15, s16, 6
    s_add_u32 s15, s15, 65536
    v_add_u32 v7, s15, v7
    v_lshlrev_b32 v9, 4, v1
    v_add_u32 v9, 157312, v9
    s_and_b32 s13, s2, 7
    s_lshl_b32 s13, s13, 12
    s_add_u32 s13, s13, 0x9000
    s_mov_b32 s42, 0
    s_waitcnt vmcnt(4)
    v_mov_b32 v1, 157872
    v_mov_b32 v2, 1
    s_mov_b64 exec, 1
    ds_add_u32 v1, v2
    s_mov_b64 exec, -1
    s_sleep 4
    s_nop 0
fk_pollk:
    buffer_load_dword v180, v14, s[24:27], s13 offen offset:0 sc1
    buffer_load_dword v181, v14, s[24:27], s13 offen offset:1024 sc1
    buffer_load_dword v182, v14, s[24:27], s13 offen offset:2048 sc1
    buffer_load_dword v183, v14, s[24:27], s13 offen offset:3072 sc1
    s_add_u32 s42, s42, 1
    s_waitcnt vmcnt(0)
    v_max3_u32 v3, v180, v181, v182
    v_max_u32 v3, v3, v183
    v_cmp_eq_u32 vcc, -1, v3
    s_cbranch_vccz fk_gotk
    s_cmp_le_u32 s42, 0x40000
    s_cbranch_scc1 fk_pollk
    s_nop 1
fk_gotk:
    v_max_u32_dpp v3, v3, v3 quad_perm:[1,0,3,2] row_mask:0xf bank_mask:0xf
    s_nop 1
    v_max_u32_dpp v3, v3, v3 quad_perm:[2,3,0,1] row_mask:0xf bank_mask:0xf
    s_nop 1
    v_max_u32_dpp v3, v3, v3 row_half_mirror row_mask:0xf bank_mask:0xf
    s_nop 1
    v_max_u32_dpp v3, v3, v3 row_mirror row_mask:0xf bank_mask:0xf
    s_nop 1
    v_max_u32_dpp v3, v3, v3 row_bcast:15 row_mask:0xa bank_mask:0xf
    s_nop 1
    v_max_u32_dpp v3, v3, v3 row_bcast:31 row_mask:0xc bank_mask:0xf
    s_nop 0
    v_readlane_b32 s40, v3, 63
    v_mov_b32 v4, 157136
    s_nop 0
    s_bfe_u32 s13, s40, 0x80003
    s_mul_i32 s13, s13, 9344
    s_and_b32 s14, s3, 3
    s_lshl_b32 s14, s14, 9
    s_add_u32 s13, s13, s14
    s_add_u32 s13, s13, 0x20000
    v_lshlrev_b32 v5, 3, v15
    v_mov_b32 v3, s40
    s_cmp_gt_u32 s3, 223
    s_cbranch_scc1 fk_norow
    s_mov_b32 s42, 0
    buffer_load_dwordx2 v[180:181], v5, s[24:27], s13 offen sc1
    s_nop 0
fk_landa:
    ds_read_b32 v2, v1
    s_waitcnt lgkmcnt(0)
    v_readfirstlane_b32 s15, v2
    s_nop 1
    s_cmp_lt_u32 s15, 8
    s_cbranch_scc1 fk_landa
    ds_read_b64_tr_b16 v[128:129], v8 offset:0
    ds_read_b64_tr_b16 v[130:131], v8 offset:512
    ds_read_b64_tr_b16 v[132:133], v8 offset:4096
    ds_read_b64_tr_b16 v[134:135], v8 offset:4608
    ds_read_b64_tr_b16 v[136:137], v8 offset:8192
    ds_read_b64_tr_b16 v[138:139], v8 offset:8704
    ds_read_b64_tr_b16 v[140:141], v8 offset:12288
    ds_read_b64_tr_b16 v[142:143], v8 offset:12800
    ds_read_b64_tr_b16 v[144:145], v8 offset:16384
    ds_read_b64_tr_b16 v[146:147], v8 offset:16896
    ds_read_b64_tr_b16 v[148:149], v8 offset:20480
    ds_read_b64_tr_b16 v[150:151], v8 offset:20992
    s_waitcnt lgkmcnt(4)
    ds_read_b64_tr_b16 v[152:153], v8 offset:24576
    ds_read_b64_tr_b16 v[154:155], v8 offset:25088
    ds_read_b64_tr_b16 v[156:157], v8 offset:28672
    ds_read_b64_tr_b16 v[158:159], v8 offset:29184
    s_branch fk_chkr
    s_nop 0
fk_pollr:
    buffer_load_dwordx2 v[180:181], v5, s[24:27], s13 offen sc1
fk_chkr:
    s_waitcnt vmcnt(0)
    v_or_b32 v6, v180, v181
    v_and_b32 v6, 1, v6
    v_cmp_eq_u32 vcc, 1, v6
    s_add_u32 s42, s42, 1
    s_cbranch_vccz fk_gotr
    s_cmp_le_u32 s42, 0x40000
    s_cbranch_scc1 fk_pollr
    s_nop 0
fk_gotr:
    v_add_u32 v5, 157312, v5
    ds_write_b64 v5, v[180:181]
    s_nop 3
fk_norow:
    ds_write_b32 v4, v3
    s_waitcnt lgkmcnt(0)
    s_barrier
    s_cmp_eq_u32 s40, s43
    s_cselect_b32 s22, 0x400000, s22
    s_branch fk_ffn
    s_nop 0
fk_other:
    v_pk_fma_f32 v[64:65], v[48:49], s[14:15], v[10:11] op_sel_hi:[1,0,0] neg_lo:[0,0,1] neg_hi:[0,0,1]
    v_pk_fma_f32 v[66:67], v[50:51], s[14:15], v[10:11] op_sel_hi:[1,0,0] neg_lo:[0,0,1] neg_hi:[0,0,1]
    v_pk_fma_f32 v[68:69], v[52:53], s[14:15], v[10:11] op_sel_hi:[1,0,0] neg_lo:[0,0,1] neg_hi:[0,0,1]
    v_pk_fma_f32 v[70:71], v[54:55], s[14:15], v[10:11] op_sel_hi:[1,0,0] neg_lo:[0,0,1] neg_hi:[0,0,1]
    v_pk_fma_f32 v[72:73], v[56:57], s[14:15], v[10:11] op_sel_hi:[1,0,0] neg_lo:[0,0,1] neg_hi:[0,0,1]
    v_pk_fma_f32 v[74:75], v[58:59], s[14:15], v[10:11] op_sel_hi:[1,0,0] neg_lo:[0,0,1] neg_hi:[0,0,1]
    v_pk_fma_f32 v[76:77], v[60:61], s[14:15], v[10:11] op_sel_hi:[1,0,0] neg_lo:[0,0,1] neg_hi:[0,0,1]
    v_pk_fma_f32 v[78:79], v[62:63], s[14:15], v[10:11] op_sel_hi:[1,0,0] neg_lo:[0,0,1] neg_hi:[0,0,1]
    v_cvt_pk_bf16_f32 v112, v64, v65
    v_cvt_pk_bf16_f32 v113, v66, v67
    v_cvt_pk_bf16_f32 v114, v68, v69
    v_cvt_pk_bf16_f32 v115, v70, v71
    v_cvt_pk_bf16_f32 v116, v72, v73
    v_cvt_pk_bf16_f32 v117, v74, v75
    v_cvt_pk_bf16_f32 v118, v76, v77
    v_cvt_pk_bf16_f32 v119, v78, v79
    s_and_b32 s13, s13, 7
    s_cmp_gt_u32 s16, s13
    s_cselect_b32 s13, 1, 0
    s_sub_u32 s17, s16, s13
    s_waitcnt vmcnt(0)
    v_lshrrev_b32 v1, 4, v15
    v_bfe_u32 v2, v15, 2, 2
    v_lshl_add_u32 v8, v1, 3, v2
    v_lshlrev_b32 v8, 7, v8
    v_and_b32 v3, 2, v2
    v_xor_b32 v9, s16, v3
    v_and_b32 v3, 1, v1
    v_lshlrev_b32 v4, 2, v3
    v_xor_b32 v9, v4, v9
    v_lshl_add_u32 v8, v9, 4, v8
    v_and_b32 v9, 1, v15
    v_lshl_add_u32 v8, v9, 3, v8
    v_bfe_u32 v9, v15, 1, 1
    v_lshl_add_u32 v8, v9, 15, v8
    v_lshrrev_b32 v7, 1, v1
    v_lshl_add_u32 v7, v7, 3, v2
    v_lshlrev_b32 v7, 9, v7
    v_lshl_add_u32 v7, v3, 5, v7
    v_and_b32 v3, 3, v15
    v_lshl_add_u32 v7, v3, 3, v7
    s_lshl_b32 s15, s16, 6
    s_add_u32 s15, s15, 65536
    v_add_u32 v7, s15, v7
    v_lshlrev_b32 v9, 4, v1
    v_add_u32 v9, 157312, v9
    v_mov_b32 v1, 157872
    v_mov_b32 v2, 1
    s_mov_b64 exec, 1
    ds_add_u32 v1, v2
    s_mov_b64 exec, -1
    s_cmp_gt_u32 s3, 223
    s_cbranch_scc1 fk_win4
    s_mul_i32 s15, s17, 4
    s_add_u32 s15, s15, 72
    s_mov_b32 s58, 0x700000
    s_mov_b32 s59, 0x00020000
    s_cmp_gt_u32 s15, 95
    s_cbranch_scc1 fk_win4
    s_lshl_b32 s12, s15, 10
    s_mov_b32 m0, s12
    s_and_b32 s14, s12, 1024
    s_lshr_b32 s14, s14, 4
    v_xor_b32 v209, s14, v208
    s_cmp_lt_u32 s15, 32
    s_cselect_b64 s[56:57], s[44:45], s[48:49]
    s_and_b32 s14, s15, 31
    s_mul_i32 s13, s14, 57344
    s_add_u32 s13, s13, s100
    s_lshl_b32 s14, s14, 12
    s_add_u32 s14, s14, s101
    s_cmp_lt_u32 s15, 64
    s_cselect_b64 s[56:57], s[56:57], s[52:53]
    s_cselect_b32 s13, s13, s14
    s_cselect_b64 vcc, -1, 0
    v_cndmask_b32 v209, v210, v209, vcc
    s_add_u32 s15, s15, 1
    buffer_load_dwordx4 v209, s[56:59], s13 offen lds
    s_cmp_gt_u32 s15, 95
    s_cbranch_scc1 fk_win4
    s_lshl_b32 s12, s15, 10
    s_mov_b32 m0, s12
    s_and_b32 s14, s12, 1024
    s_lshr_b32 s14, s14, 4
    v_xor_b32 v209, s14, v208
    s_cmp_lt_u32 s15, 32
    s_cselect_b64 s[56:57], s[44:45], s[48:49]
    s_and_b32 s14, s15, 31
    s_mul_i32 s13, s14, 57344
    s_add_u32 s13, s13, s100
    s_lshl_b32 s14, s14, 12
    s_add_u32 s14, s14, s101
    s_cmp_lt_u32 s15, 64
    s_cselect_b64 s[56:57], s[56:57], s[52:53]
    s_cselect_b32 s13, s13, s14
    s_cselect_b64 vcc, -1, 0
    v_cndmask_b32 v209, v210, v209, vcc
    s_add_u32 s15, s15, 1
    buffer_load_dwordx4 v209, s[56:59], s13 offen lds
    s_cmp_gt_u32 s15, 95
    s_cbranch_scc1 fk_win4
    s_lshl_b32 s12, s15, 10
    s_mov_b32 m0, s12
    s_and_b32 s14, s12, 1024
    s_lshr_b32 s14, s14, 4
    v_xor_b32 v209, s14, v208
    s_cmp_lt_u32 s15, 32
    s_cselect_b64 s[56:57], s[44:45], s[48:49]
    s_and_b32 s14, s15, 31
    s_mul_i32 s13, s14, 57344
    s_add_u32 s13, s13, s100
    s_lshl_b32 s14, s14, 12
    s_add_u32 s14, s14, s101
    s_cmp_lt_u32 s15, 64
    s_cselect_b64 s[56:57], s[56:57], s[52:53]
    s_cselect_b32 s13, s13, s14
    s_cselect_b64 vcc, -1, 0
    v_cndmask_b32 v209, v210, v209, vcc
    s_add_u32 s15, s15, 1
    buffer_load_dwordx4 v209, s[56:59], s13 offen lds
    s_cmp_gt_u32 s15, 95
    s_cbranch_scc1 fk_win4
    s_lshl_b32 s12, s15, 10
    s_mov_b32 m0, s12
    s_and_b32 s14, s12, 1024
    s_lshr_b32 s14, s14, 4
    v_xor_b32 v209, s14, v208
    s_cmp_lt_u32 s15, 32
    s_cselect_b64 s[56:57], s[44:45], s[48:49]
    s_and_b32 s14, s15, 31
    s_mul_i32 s13, s14, 57344
    s_add_u32 s13, s13, s100
    s_lshl_b32 s14, s14, 12
    s_add_u32 s14, s14, s101
    s_cmp_lt_u32 s15, 64
    s_cselect_b64 s[56:57], s[56:57], s[52:53]
    s_cselect_b32 s13, s13, s14
    s_cselect_b64 vcc, -1, 0
    v_cndmask_b32 v209, v210, v209, vcc
    s_add_u32 s15, s15, 1
    buffer_load_dwordx4 v209, s[56:59], s13 offen lds
    s_nop 2
fk_win4:
fk_landb:
    ds_read_b32 v2, v1
    s_waitcnt lgkmcnt(0)
    v_readfirstlane_b32 s15, v2
    s_nop 1
    s_cmp_lt_u32 s15, 8
    s_cbranch_scc1 fk_landb
    ds_read_b64_tr_b16 v[128:129], v8 offset:0
    ds_read_b64_tr_b16 v[130:131], v8 offset:512
    ds_read_b64_tr_b16 v[132:133], v8 offset:4096
    ds_read_b64_tr_b16 v[134:135], v8 offset:4608
    ds_read_b64_tr_b16 v[136:137], v8 offset:8192
    ds_read_b64_tr_b16 v[138:139], v8 offset:8704
    ds_read_b64_tr_b16 v[140:141], v8 offset:12288
    ds_read_b64_tr_b16 v[142:143], v8 offset:12800
    ds_read_b64_tr_b16 v[144:145], v8 offset:16384
    ds_read_b64_tr_b16 v[146:147], v8 offset:16896
    ds_read_b64_tr_b16 v[148:149], v8 offset:20480
    ds_read_b64_tr_b16 v[150:151], v8 offset:20992
    s_waitcnt lgkmcnt(4)
    ds_read_b64_tr_b16 v[152:153], v8 offset:24576
    ds_read_b64_tr_b16 v[154:155], v8 offset:25088
    ds_read_b64_tr_b16 v[156:157], v8 offset:28672
    ds_read_b64_tr_b16 v[158:159], v8 offset:29184
    s_waitcnt vmcnt(0) lgkmcnt(0)
    s_barrier
    s_nop 0
fk_ffn:
    buffer_store_dwordx4 v[112:115], v14, s[28:31], s22 offen nt
    buffer_store_dwordx4 v[116:119], v14, s[28:31], s22 offen offset:1024 nt
    s_cmp_gt_u32 s3, 223
    s_cbranch_scc1 fk_fin
    ds_read_b128 v[16:19], v9 offset:0
    ds_read_b128 v[20:23], v9 offset:64
    ds_read_b128 v[24:27], v9 offset:128
    ds_read_b128 v[28:31], v9 offset:192
    ds_read_b128 v[32:35], v9 offset:256
    ds_read_b128 v[36:39], v9 offset:320
    ds_read_b128 v[40:43], v9 offset:384
    ds_read_b128 v[44:47], v9 offset:448
    v_mov_b32 v3, 157136
    ds_read_b32 v12, v3
    v_lshlrev_b32 v4, 3, v15
    s_mul_i32 s41, s3, 9344
    s_lshl_b32 s14, s16, 6
    s_add_u32 s13, s41, s14
    s_add_u32 s13, s13, 0x21000
    s_waitcnt lgkmcnt(8)
    v_mfma_f32_16x16x32_bf16 v[176:179], v[16:19], v[128:131], 0
    s_waitcnt lgkmcnt(7)
    v_mfma_f32_16x16x32_bf16 v[176:179], v[20:23], v[132:135], v[176:179]
    s_waitcnt lgkmcnt(6)
    v_mfma_f32_16x16x32_bf16 v[176:179], v[24:27], v[136:139], v[176:179]
    s_waitcnt lgkmcnt(5)
    v_mfma_f32_16x16x32_bf16 v[176:179], v[28:31], v[140:143], v[176:179]
    s_waitcnt lgkmcnt(4)
    v_mfma_f32_16x16x32_bf16 v[176:179], v[32:35], v[144:147], v[176:179]
    s_waitcnt lgkmcnt(3)
    v_mfma_f32_16x16x32_bf16 v[176:179], v[36:39], v[148:151], v[176:179]
    s_waitcnt lgkmcnt(2)
    v_mfma_f32_16x16x32_bf16 v[176:179], v[40:43], v[152:155], v[176:179]
    s_waitcnt lgkmcnt(1)
    v_mfma_f32_16x16x32_bf16 v[176:179], v[44:47], v[156:159], v[176:179]
    v_lshlrev_b32 v5, 3, v15
    v_lshlrev_b32 v6, 2, v15
    v_lshrrev_b32 v9, 5, v15
    v_lshlrev_b32 v9, 4, v9
    v_add_u32 v9, 157184, v9
    s_lshl_b32 s14, s16, 7
    s_add_u32 s41, s41, s14
    s_add_u32 s41, s41, 0x21400
    v_and_b32 v176, -2, v176
    s_nop 1
    v_mov_b32_dpp v177, v176 row_shl:8 row_mask:0xf bank_mask:0xf
    v_mov_b32_dpp v178, v176 row_shl:1 row_mask:0xf bank_mask:0xf
    v_mov_b32_dpp v179, v176 row_shl:9 row_mask:0xf bank_mask:0xf
    s_mov_b64 exec, 0x55
    buffer_store_dwordx4 v[176:179], v4, s[24:27], s13 offen sc1
    s_mov_b64 exec, -1
    v_mov_b32 v1, 157876
    v_mov_b32 v8, 1
    ds_read_b64_tr_b16 v[160:161], v7 offset:0
    ds_read_b64_tr_b16 v[162:163], v7 offset:2048
    ds_read_b64_tr_b16 v[164:165], v7 offset:8192
    ds_read_b64_tr_b16 v[166:167], v7 offset:10240
    ds_read_b64_tr_b16 v[168:169], v7 offset:16384
    ds_read_b64_tr_b16 v[170:171], v7 offset:18432
    ds_read_b64_tr_b16 v[172:173], v7 offset:24576
    ds_read_b64_tr_b16 v[174:175], v7 offset:26624
    s_cmp_eq_u32 s16, 7
    s_cbranch_scc1 fk_c1
    s_cmp_lg_u32 s16, 0
    s_cbranch_scc1 fk_wait1
    s_and_b32 s13, s3, -4
    s_mul_i32 s13, s13, 9344
    s_add_u32 s36, s13, 0x21000
    s_add_u32 s37, s36, 9344
    s_add_u32 s38, s36, 18688
    s_add_u32 s39, s36, 28032
    s_mov_b32 s42, 0
    v_lshrrev_b32 v10, 2, v5
    v_add_u32 v10, 157184, v10
    s_waitcnt vmcnt(0)
    s_nop 3
fk_poll1:
    buffer_load_dwordx2 v[184:185], v5, s[24:27], s36 offen sc1
    buffer_load_dwordx2 v[186:187], v5, s[24:27], s37 offen sc1
    buffer_load_dwordx2 v[188:189], v5, s[24:27], s38 offen sc1
    buffer_load_dwordx2 v[190:191], v5, s[24:27], s39 offen sc1
    s_waitcnt vmcnt(0)
    v_or3_b32 v11, v184, v185, v186
    v_or3_b32 v11, v11, v187, v188
    v_or3_b32 v11, v11, v189, v190
    v_or_b32 v11, v11, v191
    v_and_b32 v11, 1, v11
    v_cmp_eq_u32 vcc, 1, v11
    s_add_u32 s42, s42, 1
    s_cbranch_vccz fk_got1
    s_cmp_le_u32 s42, 0x40000
    s_cbranch_scc1 fk_poll1
    s_nop 0
fk_got1:
    v_pk_add_f32 v[184:185], v[184:185], v[186:187]
    v_pk_add_f32 v[188:189], v[188:189], v[190:191]
    v_pk_add_f32 v[184:185], v[184:185], v[188:189]
    v_cvt_pk_bf16_f32 v184, 0, v184
    v_cvt_pk_bf16_f32 v185, 0, v185
    v_mul_f32 v186, 0xbfb8aa3b, v184
    v_exp_f32 v186, v186
    s_nop 0
    v_add_f32 v186, 1.0, v186
    v_rcp_f32 v186, v186
    s_nop 0
    v_mul_f32 v184, v184, v186
    v_cvt_pk_bf16_f32 v184, 0, v184
    v_mul_f32 v184, v184, v185
    v_cvt_pk_bf16_f32 v184, 0, v184
    ds_write_b16_d16_hi v10, v184
    s_branch fk_wait1
    s_nop 2
fk_c1:
    s_cmp_gt_u32 s3, 127
    s_cbranch_scc1 fk_wait1
    s_waitcnt lgkmcnt(0)
    v_readfirstlane_b32 s40, v12
    v_lshrrev_b32 v10, 4, v15
    v_and_b32 v11, 1, v15
    v_lshl_add_u32 v12, v11, 2, v10
    v_lshlrev_b32 v12, 1, v12
    v_and_b32 v11, 12, v12
    v_and_b32 v10, 1, v10
    s_bfe_u32 s13, s40, 0x80003
    s_mul_i32 s14, s13, 9344
    s_lshl_b32 s15, s3, 4
    s_add_u32 s14, s14, s15
    s_add_u32 s14, s14, 0x20000
    s_mov_b32 s42, 0
    s_nop 0
fk_pollh:
    buffer_load_dword v2, v11, s[24:27], s14 offen sc1
    buffer_load_dword v3, v11, s[24:27], s14 offen offset:2048 sc1
    s_waitcnt vmcnt(0)
    v_or_b32 v4, v2, v3
    v_and_b32 v4, 1, v4
    v_cmp_eq_u32 vcc, 1, v4
    s_add_u32 s42, s42, 1
    s_cbranch_vccz fk_goth
    s_cmp_le_u32 s42, 0x40000
    s_cbranch_scc1 fk_pollh
    s_nop 0
fk_goth:
    v_cmp_eq_u32 vcc, 1, v10
    v_lshlrev_b32 v4, 16, v2
    v_and_b32 v2, s36, v2
    v_cndmask_b32 v2, v4, v2, vcc
    v_lshlrev_b32 v4, 16, v3
    v_and_b32 v3, s36, v3
    v_cndmask_b32 v3, v4, v3, vcc
    s_lshr_b32 s14, s13, 4
    s_add_u32 s14, s14, 1
    s_cmp_ge_u32 s13, 248
    s_cselect_b32 s14, 0, s14
    s_cmp_ge_u32 s13, 240
    s_cselect_b32 s15, 7, 15
    s_and_b32 s15, s15, s13
    s_lshl_b32 s15, s15, 7
    s_add_u32 s14, s14, s15
    s_and_b32 s13, s40, 7
    s_sub_u32 s15, 7, s13
    s_min_u32 s15, s15, s13
    s_lshl_b32 s15, s15, 5
    s_add_u32 s14, s14, s15
    s_sub_u32 s15, 2048, s14
    s_and_b32 s15, s15, 2047
    s_cmp_lt_u32 s13, 4
    s_cselect_b32 s14, s14, s15
    s_and_b32 s13, s40, 0x7ff
    s_cmp_eq_u32 s13, 1991
    s_cselect_b32 s14, 1024, s14
    s_lshl_b32 s21, s14, 11
    s_lshl_b32 s15, s3, 4
    s_add_u32 s21, s21, s15
    s_ashr_i32 s13, s40, 31
    s_not_b32 s13, s13
    s_or_b32 s13, s13, 0x80000000
    s_xor_b32 s13, s40, s13
    s_and_b32 s13, s13, 0xfffff800
    v_mov_b32 v11, s13
    v_cvt_pk_bf16_f32 v11, 0, v11
    v_mul_f32 v11, 0xbfb8aa3b, v11
    v_exp_f32 v11, v11
    s_nop 0
    v_add_f32 v11, 1.0, v11
    v_rcp_f32 v11, v11
    s_nop 0
    v_cvt_pk_bf16_f32 v11, 0, v11
    v_lshrrev_b32 v4, 1, v15
    v_mul_u32_u24 v4, 37376, v4
    v_and_b32 v5, 1, v15
    v_lshl_add_u32 v4, v5, 4, v4
    v_add_u32 v5, 1196032, v4
    v_cmp_gt_u32 vcc, 48, v15
    s_nop 1
    v_cndmask_b32 v5, -16, v5, vcc
    s_lshr_b32 s40, s3, 5
    s_mul_i32 s40, s40, 9344
    s_and_b32 s15, s3, 31
    s_lshl_b32 s15, s15, 5
    s_add_u32 s40, s40, s15
    s_add_u32 s40, s40, 0x21400
    s_nop 0
fk_wait1:
    s_waitcnt lgkmcnt(0)
    s_barrier
    ds_read_b128 v[16:19], v9 offset:0
    ds_read_b128 v[20:23], v9 offset:32
    ds_read_b128 v[24:27], v9 offset:64
    ds_read_b128 v[28:31], v9 offset:96
    s_waitcnt lgkmcnt(3)
    v_mfma_f32_32x32x16_bf16 v[192:207], v[16:19], v[160:163], 0
    s_waitcnt lgkmcnt(2)
    v_mfma_f32_32x32x16_bf16 v[192:207], v[20:23], v[164:167], v[192:207]
    s_waitcnt lgkmcnt(1)
    v_mfma_f32_32x32x16_bf16 v[192:207], v[24:27], v[168:171], v[192:207]
    s_waitcnt lgkmcnt(0)
    v_mfma_f32_32x32x16_bf16 v[192:207], v[28:31], v[172:175], v[192:207]
    s_nop 11
    v_and_b32 v192, -2, v192
    s_nop 1
    v_mov_b32_dpp v193, v192 row_shl:1 row_mask:0xf bank_mask:0xf
    v_mov_b32_dpp v194, v192 row_shl:2 row_mask:0xf bank_mask:0xf
    v_mov_b32_dpp v195, v192 row_shl:3 row_mask:0xf bank_mask:0xf
    s_mov_b32 exec_lo, 0x11111111
    s_mov_b32 exec_hi, 0
    buffer_store_dwordx4 v[192:195], v6, s[24:27], s41 offen sc1
    s_mov_b64 exec, -1
    s_cmp_lg_u32 s16, 7
    s_cbranch_scc1 fk_fin
    s_cmp_gt_u32 s3, 127
    s_cbranch_scc1 fk_fin
    s_mov_b32 s42, 0
    s_waitcnt vmcnt(0)
    s_nop 0
fk_poll2:
    buffer_load_dwordx4 v[16:19], v4, s[24:27], s40 offen sc1
    buffer_load_dwordx4 v[20:23], v5, s[24:27], s40 offen sc1
    s_waitcnt vmcnt(0)
    v_or3_b32 v6, v16, v17, v18
    v_or3_b32 v6, v6, v19, v20
    v_or3_b32 v6, v6, v21, v22
    v_or_b32 v6, v6, v23
    v_and_b32 v6, 1, v6
    v_cmp_eq_u32 vcc, 1, v6
    s_add_u32 s42, s42, 1
    s_cbranch_vccz fk_got2
    s_cmp_le_u32 s42, 0x40000
    s_cbranch_scc1 fk_poll2
    s_nop 0
fk_got2:
    v_pk_add_f32 v[16:17], v[16:17], v[20:21]
    v_pk_add_f32 v[18:19], v[18:19], v[22:23]
    s_nop 1
    v_permlane32_swap_b32 v16, v18
    v_permlane32_swap_b32 v17, v19
    v_add_f32 v16, v16, v18
    v_add_f32 v17, v17, v19
    s_nop 1
    v_permlane16_swap_b32 v16, v17
    v_add_f32 v16, v16, v17
    s_nop 1
    v_add_f32_dpp v16, v16, v16 quad_perm:[2,3,0,1] row_mask:0xf bank_mask:0xf
    s_nop 1
    v_add_f32_dpp v16, v16, v16 row_ror:4 row_mask:0xf bank_mask:0xf
    s_nop 1
    v_add_f32_dpp v16, v16, v16 row_ror:8 row_mask:0xf bank_mask:0xf
    v_cvt_pk_bf16_f32 v16, 0, v16
    v_mul_f32 v16, v16, v11
    v_cvt_pk_bf16_f32 v16, 0, v16
    v_add_f32 v16, v16, v2
    v_cvt_pk_bf16_f32 v16, 0, v16
    v_add_f32 v16, v16, v3
    v_cvt_pk_bf16_f32 v16, 0, v16
    s_mov_b32 exec_lo, 0x00030003
    s_mov_b32 exec_hi, 0x00030003
    buffer_store_short_d16_hi v16, v12, s[28:31], s21 offen
    s_nop 1
fk_fin:
fk_end:
    s_endpgm
.section .rodata,"a"
.p2align 6
.amdhsa_kernel sequential_preLN__spectral_fnet__moe_arch_mod__prompt_kernel
  .amdhsa_next_free_vgpr 256
  .amdhsa_next_free_sgpr 102
  .amdhsa_accum_offset 256
  .amdhsa_group_segment_fixed_size 0
  .amdhsa_kernarg_size 104
  .amdhsa_user_sgpr_count 2
  .amdhsa_user_sgpr_kernarg_segment_ptr 1
  .amdhsa_system_sgpr_workgroup_id_x 1
.end_amdhsa_kernel
```

```asm
; @launch grid=(256,1,1) block=(512,1,1) lds=157952
.amdgcn_target "amdgcn-amd-amdhsa--gfx950"
.text
.globl sequential_preLN__spectral_fnet__moe_arch_mod__prompt_kernel
.p2align 8
.type sequential_preLN__spectral_fnet__moe_arch_mod__prompt_kernel,@function
sequential_preLN__spectral_fnet__moe_arch_mod__prompt_kernel:
    s_cmp_gt_u32 s2, 255
    s_cbranch_scc1 fk_end
    s_load_dwordx2 s[8:9], s[0:1], 0
    s_load_dwordx2 s[24:25], s[0:1], 96
    s_load_dwordx2 s[32:33], s[0:1], 48
    s_load_dwordx2 s[44:45], s[0:1], 56
    s_load_dwordx2 s[48:49], s[0:1], 64
    s_load_dwordx2 s[52:53], s[0:1], 72
    s_load_dwordx2 s[28:29], s[0:1], 80
    s_getpc_b64 s[40:41]
fk_pc:
    s_mov_b32 s42, fk_end-fk_pc
    s_mov_b32 s43, 0x00020000
    v_lshlrev_b32 v250, 6, v0
    buffer_load_dword v251, v250, s[40:43], 0 offen
    v_lshrrev_b32 v1, 6, v0
    v_and_b32 v15, 63, v0
    v_readfirstlane_b32 s16, v1
    s_and_b32 s3, s2, 0xe0
    s_and_b32 s17, s2, 7
    s_lshl_b32 s17, s17, 2
    s_or_b32 s3, s3, s17
    s_bfe_u32 s17, s2, 0x20003
    s_or_b32 s3, s3, s17
    s_lshr_b32 s17, s3, 4
    s_add_u32 s17, s17, 1
    s_cmp_ge_u32 s3, 248
    s_cselect_b32 s17, 0, s17
    s_cmp_ge_u32 s3, 240
    s_cselect_b32 s18, 7, 15
    s_and_b32 s18, s18, s3
    s_lshl_b32 s18, s18, 7
    s_add_u32 s18, s18, s17
    v_and_b32 v1, 31, v15
    v_lshrrev_b32 v2, 5, v15
    v_lshlrev_b32 v14, 4, v15
    s_mov_b32 s10, 0x400000
    s_mov_b32 s11, 0x00020000
    s_mov_b32 s26, 0x470000
    s_mov_b32 s27, 0x00020000
    s_mov_b32 s30, 0x400000
    s_mov_b32 s31, 0x00020000
    s_mov_b32 s34, 0x800
    s_mov_b32 s35, 0x00020000
    s_mov_b32 s46, 0x700000
    s_mov_b32 s47, 0x00020000
    s_mov_b32 s50, 0x700000
    s_mov_b32 s51, 0x00020000
    s_mov_b32 s54, 0x700000
    s_mov_b32 s55, 0x00020000
    s_cmp_eq_u32 s3, 255
    s_cselect_b32 s12, 5, 4
    s_cmp_ge_u32 s16, s12
    s_cbranch_scc1 fk_H
    s_cmp_eq_u32 s16, 4
    s_cbranch_scc1 fk_lowp
    s_setprio 3
fk_lowp:
    s_lshl_b32 s19, s16, 5
    s_add_u32 s19, s19, s18
    s_sub_u32 s20, 2048, s19
    s_and_b32 s20, s20, 2047
    s_lshl_b32 s21, s19, 11
    s_lshl_b32 s22, s20, 11
    s_lshl_b32 s12, s16, 12
    s_add_u32 s12, s12, 98304
    s_mov_b32 m0, s12
    v_mov_b32 v16, 0
    v_mov_b32 v17, 0
    v_mov_b32 v18, 0
    v_mov_b32 v19, 0
    v_mov_b32 v20, 0
    v_mov_b32 v21, 0
    v_mov_b32 v22, 0
    v_mov_b32 v23, 0
    v_mov_b32 v24, 0
    v_mov_b32 v25, 0
    v_mov_b32 v26, 0
    v_mov_b32 v27, 0
    v_mov_b32 v28, 0
    v_mov_b32 v29, 0
    v_mov_b32 v30, 0
    v_mov_b32 v31, 0
    v_mov_b32 v32, 0
    v_mov_b32 v33, 0
    v_mov_b32 v34, 0
    v_mov_b32 v35, 0
    v_mov_b32 v36, 0
    v_mov_b32 v37, 0
    v_mov_b32 v38, 0
    v_mov_b32 v39, 0
    v_mov_b32 v40, 0
    v_mov_b32 v41, 0
    v_mov_b32 v42, 0
    v_mov_b32 v43, 0
    v_mov_b32 v44, 0
    v_mov_b32 v45, 0
    v_mov_b32 v46, 0
    v_mov_b32 v47, 0
    v_cvt_f32_u32 v200, v1
    v_lshlrev_b32 v7, 2, v2
    v_cvt_f32_u32 v7, v7
    v_lshrrev_b32 v8, 1, v1
    v_and_b32 v9, 1, v1
    v_lshlrev_b32 v205, 2, v15
    v_and_b32 v205, 63, v205
    v_add_u32 v205, 157824, v205
    ds_write_b32 v205, v16
    s_waitcnt lgkmcnt(0)
    buffer_load_dwordx4 v14, s[8:11], s21 offen lds
    s_add_u32 s13, s12, 1024
    s_mov_b32 m0, s13
    s_add_u32 s14, s21, 1024
    buffer_load_dwordx4 v14, s[8:11], s14 offen lds
    s_add_u32 s13, s12, 2048
    s_mov_b32 m0, s13
    s_nop 0
    buffer_load_dwordx4 v14, s[8:11], s22 offen lds
    s_add_u32 s13, s12, 3072
    s_mov_b32 m0, s13
    s_add_u32 s14, s22, 1024
    buffer_load_dwordx4 v14, s[8:11], s14 offen lds
    s_barrier
    v_add_u32 v206, 138496, v14
    s_lshl_b32 s13, s16, 2
    s_add_u32 s13, s13, 157824
    v_mov_b32 v201, s13
    v_mov_b32 v202, 1
    s_cmp_eq_u32 s16, 1
    s_cbranch_scc1 fk_j1
    s_cmp_eq_u32 s16, 2
    s_cbranch_scc1 fk_j2
    s_cmp_eq_u32 s16, 3
    s_cbranch_scc1 fk_j3
    s_cmp_eq_u32 s16, 4
    s_cbranch_scc1 fk_jend
    v_cmp_eq_u32 vcc, 1, v1
    s_nop 1
    v_cndmask_b32 v10, v8, 16, vcc
    v_cndmask_b32 v11, v9, 0, vcc
    v_cvt_f32_u32 v10, v10
    v_cvt_f32_u32 v11, v11
    v_mul_f32 v10, 0x3d000000, v10
    v_mul_f32 v11, 0x3e800000, v11
    v_add_f32 v12, v7, v7
    v_fma_f32 v11, v10, v12, v11
    v_mov_b32 v128, v11
    v_fmamk_f32 v129, v10, 0x3f800000, v11
    v_fmamk_f32 v130, v10, 0x40000000, v11
    v_fmamk_f32 v131, v10, 0x40400000, v11
    v_fmamk_f32 v132, v10, 0x40800000, v11
    v_fmamk_f32 v133, v10, 0x40a00000, v11
    v_fmamk_f32 v134, v10, 0x40c00000, v11
    v_fmamk_f32 v135, v10, 0x40e00000, v11
    v_fmamk_f32 v136, v10, 0x41800000, v11
    v_fmamk_f32 v137, v10, 0x41880000, v11
    v_fmamk_f32 v138, v10, 0x41900000, v11
    v_fmamk_f32 v139, v10, 0x41980000, v11
    v_fmamk_f32 v140, v10, 0x41a00000, v11
    v_fmamk_f32 v141, v10, 0x41a80000, v11
    v_fmamk_f32 v142, v10, 0x41b00000, v11
    v_fmamk_f32 v143, v10, 0x41b80000, v11
    v_cos_f32 v144, v128
    v_cos_f32 v145, v129
    v_cos_f32 v146, v130
    v_cos_f32 v147, v131
    v_cos_f32 v148, v132
    v_cos_f32 v149, v133
    v_cos_f32 v150, v134
    v_cos_f32 v151, v135
    v_cos_f32 v152, v136
    v_cos_f32 v153, v137
    v_cos_f32 v154, v138
    v_cos_f32 v155, v139
    v_cos_f32 v156, v140
    v_cos_f32 v157, v141
    v_cos_f32 v158, v142
    v_cos_f32 v159, v143
    v_cvt_pk_f16_f32 v48, v144, v145
    v_cvt_pk_f16_f32 v49, v146, v147
    v_cvt_pk_f16_f32 v50, v148, v149
    v_cvt_pk_f16_f32 v51, v150, v151
    v_cvt_pk_f16_f32 v52, v152, v153
    v_cvt_pk_f16_f32 v53, v154, v155
    v_cvt_pk_f16_f32 v54, v156, v157
    v_cvt_pk_f16_f32 v55, v158, v159
    ds_write_b128 v206, v[48:51] offset:0
    ds_write_b128 v206, v[52:55] offset:1024
    s_branch fk_jsig
    s_nop 1
fk_j1:
    v_cvt_f32_u32 v10, v8
    v_lshlrev_b32 v11, 31, v9
    v_mul_f32 v10, 0x3a800000, v10
    v_xor_b32 v10, v11, v10
    v_mul_f32 v11, v10, v7
    v_mov_b32 v128, v11
    v_fmamk_f32 v129, v10, 0x3f800000, v11
    v_fmamk_f32 v130, v10, 0x40000000, v11
    v_fmamk_f32 v131, v10, 0x40400000, v11
    v_fmamk_f32 v132, v10, 0x41000000, v11
    v_fmamk_f32 v133, v10, 0x41100000, v11
    v_fmamk_f32 v134, v10, 0x41200000, v11
    v_fmamk_f32 v135, v10, 0x41300000, v11
    v_fmamk_f32 v136, v10, 0x41800000, v11
    v_fmamk_f32 v137, v10, 0x41880000, v11
    v_fmamk_f32 v138, v10, 0x41900000, v11
    v_fmamk_f32 v139, v10, 0x41980000, v11
    v_fmamk_f32 v140, v10, 0x41c00000, v11
    v_fmamk_f32 v141, v10, 0x41c80000, v11
    v_fmamk_f32 v142, v10, 0x41d00000, v11
    v_fmamk_f32 v143, v10, 0x41d80000, v11
    v_cos_f32 v56, v128
    v_cos_f32 v57, v129
    v_cos_f32 v58, v130
    v_cos_f32 v59, v131
    v_cos_f32 v60, v132
    v_cos_f32 v61, v133
    v_cos_f32 v62, v134
    v_cos_f32 v63, v135
    v_cos_f32 v64, v136
    v_cos_f32 v65, v137
    v_cos_f32 v66, v138
    v_cos_f32 v67, v139
    v_cos_f32 v68, v140
    v_cos_f32 v69, v141
    v_cos_f32 v70, v142
    v_cos_f32 v71, v143
    ds_write_b128 v206, v[56:59] offset:2048
    ds_write_b128 v206, v[60:63] offset:3072
    ds_write_b128 v206, v[64:67] offset:4096
    ds_write_b128 v206, v[68:71] offset:5120
    v_sin_f32 v72, v128
    v_sin_f32 v73, v129
    v_sin_f32 v74, v130
    v_sin_f32 v75, v131
    v_sin_f32 v76, v132
    v_sin_f32 v77, v133
    v_sin_f32 v78, v134
    v_sin_f32 v79, v135
    v_sin_f32 v80, v136
    v_sin_f32 v81, v137
    v_sin_f32 v82, v138
    v_sin_f32 v83, v139
    v_sin_f32 v84, v140
    v_sin_f32 v85, v141
    v_sin_f32 v86, v142
    v_sin_f32 v87, v143
    ds_write_b128 v206, v[72:75] offset:6144
    ds_write_b128 v206, v[76:79] offset:7168
    ds_write_b128 v206, v[80:83] offset:8192
    ds_write_b128 v206, v[84:87] offset:9216
    s_branch fk_jsig
    s_nop 0
fk_j2:
    v_mul_f32 v128, 0x3d000000, v200
    v_mul_f32 v129, v128, v7
    v_mov_b32 v130, v129
    v_fmamk_f32 v131, v128, 0x3f800000, v129
    v_fmamk_f32 v132, v128, 0x40000000, v129
    v_fmamk_f32 v133, v128, 0x40400000, v129
    v_fmamk_f32 v134, v128, 0x41000000, v129
    v_fmamk_f32 v135, v128, 0x41100000, v129
    v_fmamk_f32 v136, v128, 0x41200000, v129
    v_fmamk_f32 v137, v128, 0x41300000, v129
    v_fmamk_f32 v138, v128, 0x41800000, v129
    v_fmamk_f32 v139, v128, 0x41880000, v129
    v_fmamk_f32 v140, v128, 0x41900000, v129
    v_fmamk_f32 v141, v128, 0x41980000, v129
    v_fmamk_f32 v142, v128, 0x41c00000, v129
    v_fmamk_f32 v143, v128, 0x41c80000, v129
    v_fmamk_f32 v144, v128, 0x41d00000, v129
    v_fmamk_f32 v145, v128, 0x41d80000, v129
    v_cos_f32 v146, v130
    v_cos_f32 v147, v131
    v_cos_f32 v148, v132
    v_cos_f32 v149, v133
    v_cos_f32 v150, v134
    v_cos_f32 v151, v135
    v_cos_f32 v152, v136
    v_cos_f32 v153, v137
    v_cos_f32 v154, v138
    v_cos_f32 v155, v139
    v_cos_f32 v156, v140
    v_cos_f32 v157, v141
    v_cos_f32 v158, v142
    v_cos_f32 v159, v143
    v_cos_f32 v160, v144
    v_cos_f32 v161, v145
    v_cvt_pk_f16_f32 v96, v146, v147
    v_cvt_pk_f16_f32 v97, v148, v149
    v_cvt_pk_f16_f32 v98, v150, v151
    v_cvt_pk_f16_f32 v99, v152, v153
    v_cvt_pk_f16_f32 v100, v154, v155
    v_cvt_pk_f16_f32 v101, v156, v157
    v_cvt_pk_f16_f32 v102, v158, v159
    v_cvt_pk_f16_f32 v103, v160, v161
    v_sin_f32 v146, v130
    v_sin_f32 v147, v131
    v_sin_f32 v148, v132
    v_sin_f32 v149, v133
    v_sin_f32 v150, v134
    v_sin_f32 v151, v135
    v_sin_f32 v152, v136
    v_sin_f32 v153, v137
    v_sin_f32 v154, v138
    v_sin_f32 v155, v139
    v_sin_f32 v156, v140
    v_sin_f32 v157, v141
    v_sin_f32 v158, v142
    v_sin_f32 v159, v143
    v_sin_f32 v160, v144
    v_sin_f32 v161, v145
    v_cvt_pk_f16_f32 v104, v146, v147
    v_cvt_pk_f16_f32 v105, v148, v149
    v_cvt_pk_f16_f32 v106, v150, v151
    v_cvt_pk_f16_f32 v107, v152, v153
    v_cvt_pk_f16_f32 v108, v154, v155
    v_cvt_pk_f16_f32 v109, v156, v157
    v_cvt_pk_f16_f32 v110, v158, v159
    v_cvt_pk_f16_f32 v111, v160, v161
    ds_write_b128 v206, v[96:99] offset:12288
    ds_write_b128 v206, v[100:103] offset:13312
    ds_write_b128 v206, v[104:107] offset:14336
    ds_write_b128 v206, v[108:111] offset:15360
    s_branch fk_jsig
    s_nop 0
fk_j3:
    v_or_b32 v10, 16, v1
    v_cvt_f32_u32 v10, v10
    v_mov_b32 v11, 0x3c800000
    v_fmamk_f32 v10, v10, 0x3d000000, v11
    v_cmp_gt_u32 vcc, 16, v1
    v_mov_b32 v12, 0xbe800000
    s_nop 0
    v_cndmask_b32 v12, 0, v12, vcc
    v_fma_f32 v11, v10, v7, v12
    v_mov_b32 v128, v11
    v_fmamk_f32 v129, v10, 0x3f800000, v11
    v_fmamk_f32 v130, v10, 0x40000000, v11
    v_fmamk_f32 v131, v10, 0x40400000, v11
    v_fmamk_f32 v132, v10, 0x41000000, v11
    v_fmamk_f32 v133, v10, 0x41100000, v11
    v_fmamk_f32 v134, v10, 0x41200000, v11
    v_fmamk_f32 v135, v10, 0x41300000, v11
    v_fmamk_f32 v136, v10, 0x41800000, v11
    v_fmamk_f32 v137, v10, 0x41880000, v11
    v_fmamk_f32 v138, v10, 0x41900000, v11
    v_fmamk_f32 v139, v10, 0x41980000, v11
    v_fmamk_f32 v140, v10, 0x41c00000, v11
    v_fmamk_f32 v141, v10, 0x41c80000, v11
    v_fmamk_f32 v142, v10, 0x41d00000, v11
    v_fmamk_f32 v143, v10, 0x41d80000, v11
    v_cos_f32 v144, v128
    v_cos_f32 v145, v129
    v_cos_f32 v146, v130
    v_cos_f32 v147, v131
    v_cos_f32 v148, v132
    v_cos_f32 v149, v133
    v_cos_f32 v150, v134
    v_cos_f32 v151, v135
    v_cos_f32 v152, v136
    v_cos_f32 v153, v137
    v_cos_f32 v154, v138
    v_cos_f32 v155, v139
    v_cos_f32 v156, v140
    v_cos_f32 v157, v141
    v_cos_f32 v158, v142
    v_cos_f32 v159, v143
    v_cvt_pk_f16_f32 v88, v144, v145
    v_cvt_pk_f16_f32 v89, v146, v147
    v_cvt_pk_f16_f32 v90, v148, v149
    v_cvt_pk_f16_f32 v91, v150, v151
    v_cvt_pk_f16_f32 v92, v152, v153
    v_cvt_pk_f16_f32 v93, v154, v155
    v_cvt_pk_f16_f32 v94, v156, v157
    v_cvt_pk_f16_f32 v95, v158, v159
    ds_write_b128 v206, v[88:91] offset:10240
    ds_write_b128 v206, v[92:95] offset:11264
    s_nop 2
fk_jsig:
    ds_write_b32 v201, v202 offset:32
fk_jend:
    v_lshlrev_b32 v3, 9, v2
    v_lshl_add_u32 v3, v1, 1, v3
    v_sub_u32 v4, 576, v3
    v_sub_u32 v5, 2048, v3
    v_and_b32 v5, 2047, v5
    v_add_u32 v3, s12, v3
    v_add_u32 v4, s12, v4
    v_add_u32 v5, s12, v5
    s_lshl_b32 s13, s16, 10
    s_sub_u32 s14, 7232, s13
    s_cmp_ge_u32 s3, 248
    s_cselect_b32 s15, 1024, 0
    s_add_u32 s14, s14, s15
    s_cmp_eq_u32 s14, 8256
    s_cselect_b32 s14, 4160, s14
    s_cmp_eq_u32 s19, s20
    s_cselect_b32 s14, 8256, s14
    s_cmp_eq_u32 s16, 4
    s_cselect_b32 s13, 8256, s13
    s_cmp_lg_u32 s19, 0
    s_cbranch_scc1 fk_noz
    v_add_u32 v8, 124992, v14
    ds_write_b128 v8, v[16:19]
fk_noz:
    s_add_u32 s13, s13, 120832
    s_add_u32 s14, s14, 120832
    v_cmp_gt_u32 vcc, 16, v1
    v_mov_b32 v8, s13
    v_mov_b32 v9, s14
    v_cndmask_b32 v10, v9, v8, vcc
    v_cndmask_b32 v11, v8, v9, vcc
    v_lshl_add_u32 v10, v15, 2, v10
    v_lshl_add_u32 v11, v15, 2, v11
    v_lshrrev_b32 v6, 1, v15
    v_and_b32 v8, 1, v15
    v_mul_u32_u24 v9, 4160, v8
    v_and_b32 v12, 15, v6
    v_lshl_add_u32 v12, v12, 4, v2
    v_mul_u32_u24 v12, 9344, v12
    v_mul_u32_u24 v192, 18688, v8
    v_add_u32 v192, v192, v12
    v_lshl_add_u32 v12, v8, 4, v12
    v_lshrrev_b32 v194, 3, v15
    v_lshlrev_b32 v193, 4, v194
    v_lshl_add_u32 v193, v8, 7, v193
    v_and_b32 v6, 3, v6
    v_lshl_add_u32 v9, v6, 2, v9
    v_lshl_add_u32 v9, v194, 7, v9
    v_lshlrev_b32 v194, 10, v194
    v_and_b32 v6, 7, v15
    v_lshl_add_u32 v194, v6, 4, v194
    s_lshl_b32 s13, s16, 5
    s_add_u32 s13, s13, 120832
    v_add_u32 v6, s13, v9
    s_mul_i32 s36, s3, 9344
    s_lshl_b32 s13, s16, 8
    s_add_u32 s36, s36, s13
    s_add_u32 s36, s36, 0x20000
    s_mul_i32 s37, s16, 37376
    s_add_u32 s37, s37, 0x20000
    s_bfe_u32 s23, s3, 0x30002
    s_lshl_b32 s23, s23, 7
    s_lshr_b32 s12, s3, 5
    s_lshl_b32 s12, s12, 4
    s_add_u32 s23, s23, s12
    s_and_b32 s12, s3, 3
    s_lshl_b32 s12, s12, 2
    s_add_u32 s23, s23, s12
    s_add_u32 s23, s23, 8192
    s_add_u32 s23, s23, s37
    s_lshl_b32 s14, s3, 5
    s_add_u32 s37, s37, s14
    s_add_u32 s38, s37, 18688
    s_lshl_b32 s13, s16, 11
    s_add_u32 s13, s13, 130304
    v_add_u32 v7, s13, v14
    v_cmp_eq_u32 s[58:59], 1, v8
    s_cmp_eq_u32 s19, s20
    s_cselect_b32 s39, 0.5, 1.0
    s_lshl_b32 s13, s16, 2
    s_add_u32 s13, s13, 157056
    v_mov_b32 v9, s13
    s_mov_b32 s57, 47
    s_nop 3
fk_spinc:
    ds_read_b32 v203, v205
    s_waitcnt lgkmcnt(0)
    v_cmp_eq_u32 vcc, 0, v203
    s_nop 1
    s_and_b32 s13, vcc_lo, 0xf00
    s_cbranch_scc1 fk_spinc
    ds_read_b128 v[48:51], v206 offset:0
    ds_read_b128 v[52:55], v206 offset:1024
    ds_read_b128 v[56:59], v206 offset:2048
    ds_read_b128 v[60:63], v206 offset:3072
    ds_read_b128 v[64:67], v206 offset:4096
    ds_read_b128 v[68:71], v206 offset:5120
    ds_read_b128 v[72:75], v206 offset:6144
    ds_read_b128 v[76:79], v206 offset:7168
    ds_read_b128 v[80:83], v206 offset:8192
    ds_read_b128 v[84:87], v206 offset:9216
    ds_read_b128 v[88:91], v206 offset:10240
    ds_read_b128 v[92:95], v206 offset:11264
    s_waitcnt lgkmcnt(8)
    ds_read_b128 v[96:99], v206 offset:12288
    ds_read_b128 v[100:103], v206 offset:13312
    ds_read_b128 v[104:107], v206 offset:14336
    ds_read_b128 v[108:111], v206 offset:15360
    s_waitcnt vmcnt(0) lgkmcnt(0)
    ds_read_u16_d16_hi v16, v3 offset:0
    ds_read_u16_d16_hi v17, v3 offset:64
    ds_read_u16_d16_hi v18, v3 offset:128
    ds_read_u16_d16_hi v19, v3 offset:192
    ds_read_u16_d16_hi v20, v3 offset:256
    ds_read_u16_d16_hi v21, v3 offset:320
    ds_read_u16_d16_hi v22, v3 offset:384
    ds_read_u16_d16_hi v23, v3 offset:448
    ds_read_u16_d16_hi v24, v3 offset:1024
    ds_read_u16_d16_hi v25, v3 offset:1088
    ds_read_u16_d16_hi v26, v3 offset:1152
    ds_read_u16_d16_hi v27, v3 offset:1216
    ds_read_u16_d16_hi v28, v3 offset:1280
    ds_read_u16_d16_hi v29, v3 offset:1344
    ds_read_u16_d16_hi v30, v3 offset:1408
    ds_read_u16_d16_hi v31, v3 offset:1472
    s_waitcnt lgkmcnt(2)
    ds_read_u16_d16_hi v32, v5 offset:2048
    ds_read_u16_d16_hi v33, v4 offset:3456
    ds_read_u16_d16_hi v34, v4 offset:3392
    ds_read_u16_d16_hi v35, v4 offset:3328
    ds_read_u16_d16_hi v36, v4 offset:3264
    ds_read_u16_d16_hi v37, v4 offset:3200
    ds_read_u16_d16_hi v38, v4 offset:3136
    ds_read_u16_d16_hi v39, v4 offset:3072
    ds_read_u16_d16_hi v40, v4 offset:2496
    ds_read_u16_d16_hi v41, v4 offset:2432
    ds_read_u16_d16_hi v42, v4 offset:2368
    ds_read_u16_d16_hi v43, v4 offset:2304
    ds_read_u16_d16_hi v44, v4 offset:2240
    s_waitcnt lgkmcnt(8)
    ds_read_u16_d16_hi v45, v4 offset:2176
    ds_read_u16_d16_hi v46, v4 offset:2112
    ds_read_u16_d16_hi v47, v4 offset:2048
    v_pk_add_f32 v[128:129], v[16:17], v[18:19]
    v_pk_add_f32 v[130:131], v[20:21], v[22:23]
    v_pk_add_f32 v[132:133], v[24:25], v[26:27]
    v_pk_add_f32 v[134:135], v[28:29], v[30:31]
    v_pk_mul_f32 v[136:137], v[16:17], v[16:17]
    v_pk_mul_f32 v[138:139], v[18:19], v[18:19]
    v_pk_fma_f32 v[136:137], v[20:21], v[20:21], v[136:137]
    v_pk_fma_f32 v[138:139], v[22:23], v[22:23], v[138:139]
    v_pk_fma_f32 v[136:137], v[24:25], v[24:25], v[136:137]
    v_pk_fma_f32 v[138:139], v[26:27], v[26:27], v[138:139]
    v_pk_fma_f32 v[136:137], v[28:29], v[28:29], v[136:137]
    v_pk_fma_f32 v[138:139], v[30:31], v[30:31], v[138:139]
    v_pk_add_f32 v[128:129], v[128:129], v[130:131]
    v_pk_add_f32 v[132:133], v[132:133], v[134:135]
    v_pk_add_f32 v[136:137], v[136:137], v[138:139]
    v_pk_add_f32 v[128:129], v[128:129], v[132:133]
    v_add_f32 v136, v136, v137
    v_add_f32 v128, v128, v129
    s_waitcnt lgkmcnt(0)
    v_pk_add_f32 v[140:141], v[32:33], v[34:35]
    v_pk_add_f32 v[142:143], v[36:37], v[38:39]
    v_pk_add_f32 v[144:145], v[40:41], v[42:43]
    v_pk_add_f32 v[146:147], v[44:45], v[46:47]
    v_pk_mul_f32 v[148:149], v[32:33], v[32:33]
    v_pk_mul_f32 v[150:151], v[34:35], v[34:35]
    v_pk_fma_f32 v[148:149], v[36:37], v[36:37], v[148:149]
    v_pk_fma_f32 v[150:151], v[38:39], v[38:39], v[150:151]
    v_pk_fma_f32 v[148:149], v[40:41], v[40:41], v[148:149]
    v_pk_fma_f32 v[150:151], v[42:43], v[42:43], v[150:151]
    v_pk_fma_f32 v[148:149], v[44:45], v[44:45], v[148:149]
    v_pk_fma_f32 v[150:151], v[46:47], v[46:47], v[150:151]
    v_pk_add_f32 v[140:141], v[140:141], v[142:143]
    v_pk_add_f32 v[144:145], v[144:145], v[146:147]
    v_pk_add_f32 v[148:149], v[148:149], v[150:151]
    v_pk_add_f32 v[140:141], v[140:141], v[144:145]
    v_add_f32 v148, v148, v149
    v_add_f32 v140, v140, v141
    s_nop 1
    v_permlane32_swap_b32 v128, v140
    v_permlane32_swap_b32 v136, v148
    v_add_f32 v128, v128, v140
    v_add_f32 v136, v136, v148
    s_nop 1
    v_permlane16_swap_b32 v128, v136
    v_add_f32 v128, v128, v136
    s_nop 1
    v_add_f32_dpp v128, v128, v128 quad_perm:[1,0,3,2] row_mask:0xf bank_mask:0xf
    s_nop 1
    v_add_f32_dpp v128, v128, v128 quad_perm:[2,3,0,1] row_mask:0xf bank_mask:0xf
    s_nop 1
    v_add_f32_dpp v128, v128, v128 row_half_mirror row_mask:0xf bank_mask:0xf
    s_nop 1
    v_add_f32_dpp v128, v128, v128 row_mirror row_mask:0xf bank_mask:0xf
    s_nop 1
    v_mov_b32_dpp v129, v128 row_bcast:15 row_mask:0xa bank_mask:0xf
    v_mul_f32 v130, 0x3a800000, v128
    v_mul_f32 v129, 0x3a800000, v129
    v_fma_f32 v130, -v129, v129, v130
    v_max_f32 v130, 0, v130
    v_cvt_pk_bf16_f32 v130, 0, v130
    v_cvt_pk_bf16_f32 v129, 0, v129
    v_add_f32 v130, 0x3727c5ac, v130
    v_cvt_pk_bf16_f32 v130, 0, v130
    v_sqrt_f32 v130, v130
    s_nop 0
    v_cvt_pk_bf16_f32 v130, 0, v130
    v_rcp_f32 v130, v130
    s_nop 0
    v_mul_f32 v130, 0x3c000000, v130
    v_mul_f32 v129, v129, v130
    v_readlane_b32 s4, v130, 16
    v_readlane_b32 s6, v130, 48
    v_readlane_b32 s13, v129, 16
    v_readlane_b32 s14, v129, 48
    s_nop 0
    v_mov_b32 v132, s13
    v_add_f32 v132, s14, v132
    v_pk_fma_f32 v[32:33], v[32:33], s[6:7], v[132:133] op_sel_hi:[1,0,0] neg_lo:[0,0,1] neg_hi:[0,0,1]
    v_pk_fma_f32 v[34:35], v[34:35], s[6:7], v[132:133] op_sel_hi:[1,0,0] neg_lo:[0,0,1] neg_hi:[0,0,1]
    v_pk_fma_f32 v[36:37], v[36:37], s[6:7], v[132:133] op_sel_hi:[1,0,0] neg_lo:[0,0,1] neg_hi:[0,0,1]
    v_pk_fma_f32 v[38:39], v[38:39], s[6:7], v[132:133] op_sel_hi:[1,0,0] neg_lo:[0,0,1] neg_hi:[0,0,1]
    v_pk_fma_f32 v[40:41], v[40:41], s[6:7], v[132:133] op_sel_hi:[1,0,0] neg_lo:[0,0,1] neg_hi:[0,0,1]
    v_pk_fma_f32 v[42:43], v[42:43], s[6:7], v[132:133] op_sel_hi:[1,0,0] neg_lo:[0,0,1] neg_hi:[0,0,1]
    v_pk_fma_f32 v[44:45], v[44:45], s[6:7], v[132:133] op_sel_hi:[1,0,0] neg_lo:[0,0,1] neg_hi:[0,0,1]
    v_pk_fma_f32 v[46:47], v[46:47], s[6:7], v[132:133] op_sel_hi:[1,0,0] neg_lo:[0,0,1] neg_hi:[0,0,1]
    v_pk_fma_f32 v[16:17], v[16:17], s[4:5], v[32:33] op_sel_hi:[1,0,1]
    v_pk_fma_f32 v[18:19], v[18:19], s[4:5], v[34:35] op_sel_hi:[1,0,1]
    v_pk_fma_f32 v[20:21], v[20:21], s[4:5], v[36:37] op_sel_hi:[1,0,1]
    v_pk_fma_f32 v[22:23], v[22:23], s[4:5], v[38:39] op_sel_hi:[1,0,1]
    v_pk_fma_f32 v[24:25], v[24:25], s[4:5], v[40:41] op_sel_hi:[1,0,1]
    v_pk_fma_f32 v[26:27], v[26:27], s[4:5], v[42:43] op_sel_hi:[1,0,1]
    v_pk_fma_f32 v[28:29], v[28:29], s[4:5], v[44:45] op_sel_hi:[1,0,1]
    v_pk_fma_f32 v[30:31], v[30:31], s[4:5], v[46:47] op_sel_hi:[1,0,1]
    v_cvt_pk_f16_f32 v176, v16, v17
    v_cvt_pk_f16_f32 v177, v18, v19
    v_cvt_pk_f16_f32 v178, v20, v21
    v_cvt_pk_f16_f32 v179, v22, v23
    v_cvt_pk_f16_f32 v180, v24, v25
    v_cvt_pk_f16_f32 v181, v26, v27
    v_cvt_pk_f16_f32 v182, v28, v29
    v_cvt_pk_f16_f32 v183, v30, v31
    v_mfma_f32_32x32x16_f16 v[112:127], v[176:179], v[48:51], 0
    s_nop 0
    v_mfma_f32_32x32x16_f16 v[112:127], v[180:183], v[52:55], v[112:127]
    s_nop 11
    v_pk_mul_f32 v[16:17], v[112:113], v[56:57]
    v_pk_mul_f32 v[18:19], v[114:115], v[58:59]
    v_pk_mul_f32 v[20:21], v[116:117], v[60:61]
    v_pk_mul_f32 v[22:23], v[118:119], v[62:63]
    v_pk_mul_f32 v[24:25], v[120:121], v[64:65]
    v_pk_mul_f32 v[26:27], v[122:123], v[66:67]
    v_pk_mul_f32 v[28:29], v[124:125], v[68:69]
    v_pk_mul_f32 v[30:31], v[126:127], v[70:71]
    v_fmac_f32_dpp v16, v112, v72 quad_perm:[1,0,3,2] row_mask:0xf bank_mask:0xf
    v_fmac_f32_dpp v17, v113, v73 quad_perm:[1,0,3,2] row_mask:0xf bank_mask:0xf
    v_fmac_f32_dpp v18, v114, v74 quad_perm:[1,0,3,2] row_mask:0xf bank_mask:0xf
    v_fmac_f32_dpp v19, v115, v75 quad_perm:[1,0,3,2] row_mask:0xf bank_mask:0xf
    v_fmac_f32_dpp v20, v116, v76 quad_perm:[1,0,3,2] row_mask:0xf bank_mask:0xf
    v_fmac_f32_dpp v21, v117, v77 quad_perm:[1,0,3,2] row_mask:0xf bank_mask:0xf
    v_fmac_f32_dpp v22, v118, v78 quad_perm:[1,0,3,2] row_mask:0xf bank_mask:0xf
    v_fmac_f32_dpp v23, v119, v79 quad_perm:[1,0,3,2] row_mask:0xf bank_mask:0xf
    v_cvt_pk_f16_f32 v176, v16, v17
    v_cvt_pk_f16_f32 v177, v18, v19
    v_cvt_pk_f16_f32 v178, v20, v21
    v_cvt_pk_f16_f32 v179, v22, v23
    v_fmac_f32_dpp v24, v120, v80 quad_perm:[1,0,3,2] row_mask:0xf bank_mask:0xf
    v_fmac_f32_dpp v25, v121, v81 quad_perm:[1,0,3,2] row_mask:0xf bank_mask:0xf
    v_mfma_f32_32x32x16_f16 v[128:143], v[176:179], v[96:99], 0
    v_fmac_f32_dpp v26, v122, v82 quad_perm:[1,0,3,2] row_mask:0xf bank_mask:0xf
    v_fmac_f32_dpp v27, v123, v83 quad_perm:[1,0,3,2] row_mask:0xf bank_mask:0xf
    v_fmac_f32_dpp v28, v124, v84 quad_perm:[1,0,3,2] row_mask:0xf bank_mask:0xf
    v_fmac_f32_dpp v29, v125, v85 quad_perm:[1,0,3,2] row_mask:0xf bank_mask:0xf
    v_mfma_f32_32x32x16_f16 v[144:159], v[176:179], v[104:107], 0
    v_fmac_f32_dpp v30, v126, v86 quad_perm:[1,0,3,2] row_mask:0xf bank_mask:0xf
    v_fmac_f32_dpp v31, v127, v87 quad_perm:[1,0,3,2] row_mask:0xf bank_mask:0xf
    v_cvt_pk_f16_f32 v180, v24, v25
    v_cvt_pk_f16_f32 v181, v26, v27
    v_mfma_f32_32x32x16_f16 v[160:175], v[176:179], v[88:91], 0
    v_cvt_pk_f16_f32 v182, v28, v29
    v_cvt_pk_f16_f32 v183, v30, v31
    s_nop 1
    v_mfma_f32_32x32x16_f16 v[128:143], v[180:183], v[100:103], v[128:143]
    v_mfma_f32_32x32x16_f16 v[144:159], v[180:183], v[108:111], v[144:159]
    v_mfma_f32_32x32x16_f16 v[160:175], v[180:183], v[92:95], v[160:175]
    v_cmp_gt_u32 vcc, 16, v15
    v_cmp_gt_u32 s[40:41], 32, v15
    s_nop 8
    v_pk_add_f32 v[20:21], v[132:133], v[148:149] op_sel:[0,1] op_sel_hi:[1,0] neg_hi:[0,1]
    v_pk_add_f32 v[22:23], v[134:135], v[150:151] op_sel:[0,1] op_sel_hi:[1,0] neg_hi:[0,1]
    v_pk_add_f32 v[36:37], v[20:21], v[22:23] op_sel:[0,1] op_sel_hi:[1,0] neg_lo:[0,1]
    v_pk_add_f32 v[38:39], v[20:21], v[22:23] op_sel:[0,1] op_sel_hi:[1,0] neg_hi:[1,0]
    v_cvt_pk_f16_f32 v178, v36, v37
    v_cvt_pk_f16_f32 v179, v38, v39
    ds_write_b32 v10, v178 offset:256
    ds_write_b32 v11, v179 offset:256
    v_pk_add_f32 v[24:25], v[136:137], v[152:153] op_sel:[0,1] op_sel_hi:[1,0] neg_hi:[0,1]
    v_pk_add_f32 v[26:27], v[138:139], v[154:155] op_sel:[0,1] op_sel_hi:[1,0] neg_hi:[0,1]
    v_pk_add_f32 v[40:41], v[24:25], v[26:27] op_sel:[0,1] op_sel_hi:[1,0] neg_lo:[0,1]
    v_pk_add_f32 v[42:43], v[24:25], v[26:27] op_sel:[0,1] op_sel_hi:[1,0] neg_hi:[1,0]
    v_cvt_pk_f16_f32 v180, v40, v41
    v_cvt_pk_f16_f32 v181, v42, v43
    ds_write_b32 v10, v180 offset:512
    ds_write_b32 v11, v181 offset:512
    v_pk_add_f32 v[28:29], v[140:141], v[156:157] op_sel:[0,1] op_sel_hi:[1,0] neg_hi:[0,1]
    v_pk_add_f32 v[30:31], v[142:143], v[158:159] op_sel:[0,1] op_sel_hi:[1,0] neg_hi:[0,1]
    v_pk_add_f32 v[44:45], v[28:29], v[30:31] op_sel:[0,1] op_sel_hi:[1,0] neg_lo:[0,1]
    v_pk_add_f32 v[46:47], v[28:29], v[30:31] op_sel:[0,1] op_sel_hi:[1,0] neg_hi:[1,0]
    v_cvt_pk_f16_f32 v182, v44, v45
    v_cvt_pk_f16_f32 v183, v46, v47
    ds_write_b32 v10, v182 offset:768
    ds_write_b32 v11, v183 offset:768
    v_pk_add_f32 v[16:17], v[128:129], v[144:145] op_sel:[0,1] op_sel_hi:[1,0] neg_hi:[0,1]
    v_pk_add_f32 v[18:19], v[130:131], v[146:147] op_sel:[0,1] op_sel_hi:[1,0] neg_hi:[0,1]
    v_mul_f32 v8, s39, v128
    v_mov_b32 v3, v161
    s_nop 1
    v_permlane16_swap_b32 v4, v3
    v_cndmask_b32 v5, v161, v128, vcc
    v_cndmask_b32 v4, v4, v144, vcc
    v_cndmask_b32 v16, v16, v5, s[40:41]
    v_cndmask_b32 v17, v17, -v4, s[40:41]
    v_pk_add_f32 v[32:33], v[16:17], v[18:19] op_sel:[0,1] op_sel_hi:[1,0] neg_lo:[0,1]
    v_pk_add_f32 v[34:35], v[16:17], v[18:19] op_sel:[0,1] op_sel_hi:[1,0] neg_hi:[1,0]
    v_cvt_pk_f16_f32 v176, v32, v33
    v_cvt_pk_f16_f32 v177, v34, v35
    ds_write_b32 v10, v176 offset:0
    ds_write_b32 v11, v177 offset:0
    s_mov_b64 exec, 0x10000
    ds_write_b32 v9, v8
    ds_write_b32 v201, v202
    s_mov_b64 exec, -1
    s_cmp_eq_u32 s16, 4
    s_cbranch_scc1 fk_w4
    s_nop 0
fk_spin:
    ds_read_b32 v3, v205
    s_waitcnt lgkmcnt(0)
    v_cmp_eq_u32 vcc, 0, v3
    s_nop 1
    s_and_b32 s13, vcc_lo, s57
    s_cbranch_scc1 fk_spin
    s_nop 0
fk_staged:
    ds_read2st64_b32 v[184:185], v6 offset0:0 offset1:4
    ds_read2st64_b32 v[186:187], v6 offset0:8 offset1:12
    v_add_u32 v8, 16, v6
    ds_read2st64_b32 v[188:189], v8 offset0:0 offset1:4
    ds_read2st64_b32 v[190:191], v8 offset0:8 offset1:12
    v_readlane_b32 s43, v3, 7
    s_waitcnt lgkmcnt(2)
    v_or_b32 v184, 1, v184
    v_or_b32 v185, 1, v185
    v_or_b32 v186, 1, v186
    v_or_b32 v187, 1, v187
    buffer_store_dwordx4 v[184:187], v194, s[24:27], s36 offen offset:0 sc1
    s_waitcnt lgkmcnt(0)
    v_or_b32 v188, 1, v188
    v_or_b32 v189, 1, v189
    v_or_b32 v190, 1, v190
    v_or_b32 v191, 1, v191
    buffer_store_dwordx4 v[188:191], v194, s[24:27], s36 offen offset:128 sc1
    v_add3_u32 v3, v184, v185, v186
    v_add_u32 v3, v3, v187
    v_add3_u32 v4, v188, v189, v190
    v_add_u32 v4, v4, v191
    s_add_u32 s36, s36, 8192
    v_add_u32_dpp v3, v3, v3 quad_perm:[1,0,3,2] row_mask:0xf bank_mask:0xf
    v_add_u32_dpp v4, v4, v4 quad_perm:[1,0,3,2] row_mask:0xf bank_mask:0xf
    v_cndmask_b32 v3, v3, v4, s[58:59]
    v_add_u32 v196, s43, v3
    s_nop 1
    v_mov_b32_dpp v197, v196 row_shl:2 row_mask:0xf bank_mask:0xf
    v_mov_b32_dpp v198, v196 row_shl:4 row_mask:0xf bank_mask:0xf
    v_mov_b32_dpp v199, v196 row_shl:6 row_mask:0xf bank_mask:0xf
    s_mov_b32 exec_lo, 0x03030303
    s_mov_b32 exec_hi, 0x03030303
    buffer_store_dwordx4 v[196:199], v193, s[24:27], s36 offen sc1
    s_mov_b64 exec, -1
    s_cmp_lg_u32 s16, 0
    s_cbranch_scc1 fk_nog5
    v_and_b32 v9, 16, v14
    v_add_u32 v9, 157056, v9
    ds_read_b128 v[16:19], v9
    s_lshl_b32 s13, s3, 4
    s_add_u32 s13, s13, 0x11000
    s_nop 1
fk_g5s:
    ds_read_b32 v3, v205
    s_waitcnt lgkmcnt(0)
    v_cmp_eq_u32 vcc, 0, v3
    s_nop 1
    s_and_b32 s14, vcc_lo, 64
    s_cbranch_scc1 fk_g5s
    v_min_u32 v16, -2, v16
    v_min_u32 v17, -2, v17
    v_min_u32 v18, -2, v18
    v_min_u32 v19, -2, v19
    s_mov_b64 exec, 1
    buffer_store_dwordx4 v[16:19], v14, s[24:27], s13 offen sc1
    s_mov_b64 exec, -1
    s_nop 1
fk_nog5:
    v_lshrrev_b32 v208, 3, v15
    v_and_b32 v209, 7, v15
    v_and_b32 v210, 2, v208
    v_xor_b32 v209, v210, v209
    v_mul_u32_u24 v208, 7168, v208
    v_lshl_add_u32 v208, v209, 4, v208
    v_lshrrev_b32 v210, 5, v15
    v_lshlrev_b32 v210, 11, v210
    v_and_b32 v209, 31, v15
    v_lshl_add_u32 v210, v209, 4, v210
    s_and_b32 s12, s3, 3
    s_mul_i32 s100, s12, 1835008
    s_lshl_b32 s101, s12, 9
    s_lshr_b32 s12, s3, 2
    s_lshl_b32 s12, s12, 7
    s_add_u32 s100, s100, s12
    s_lshl_b32 s12, s12, 10
    s_add_u32 s101, s101, s12
    s_mov_b64 s[4:5], s[58:59]
    s_cmp_gt_u32 s3, 223
    s_cbranch_scc1 fk_win1
    s_mul_i32 s15, s16, 3
    s_add_u32 s15, s15, 12
    s_mov_b32 s58, 0x700000
    s_mov_b32 s59, 0x00020000
    s_cmp_gt_u32 s15, 95
    s_cbranch_scc1 fk_win1
    s_lshl_b32 s12, s15, 10
    s_mov_b32 m0, s12
    s_and_b32 s14, s12, 1024
    s_lshr_b32 s14, s14, 4
    v_xor_b32 v209, s14, v208
    s_cmp_lt_u32 s15, 32
    s_cselect_b64 s[56:57], s[44:45], s[48:49]
    s_and_b32 s14, s15, 31
    s_mul_i32 s13, s14, 57344
    s_add_u32 s13, s13, s100
    s_lshl_b32 s14, s14, 12
    s_add_u32 s14, s14, s101
    s_cmp_lt_u32 s15, 64
    s_cselect_b64 s[56:57], s[56:57], s[52:53]
    s_cselect_b32 s13, s13, s14
    s_cselect_b64 vcc, -1, 0
    v_cndmask_b32 v209, v210, v209, vcc
    s_add_u32 s15, s15, 1
    buffer_load_dwordx4 v209, s[56:59], s13 offen lds
    s_cmp_gt_u32 s15, 95
    s_cbranch_scc1 fk_win1
    s_lshl_b32 s12, s15, 10
    s_mov_b32 m0, s12
    s_and_b32 s14, s12, 1024
    s_lshr_b32 s14, s14, 4
    v_xor_b32 v209, s14, v208
    s_cmp_lt_u32 s15, 32
    s_cselect_b64 s[56:57], s[44:45], s[48:49]
    s_and_b32 s14, s15, 31
    s_mul_i32 s13, s14, 57344
    s_add_u32 s13, s13, s100
    s_lshl_b32 s14, s14, 12
    s_add_u32 s14, s14, s101
    s_cmp_lt_u32 s15, 64
    s_cselect_b64 s[56:57], s[56:57], s[52:53]
    s_cselect_b32 s13, s13, s14
    s_cselect_b64 vcc, -1, 0
    v_cndmask_b32 v209, v210, v209, vcc
    s_add_u32 s15, s15, 1
    buffer_load_dwordx4 v209, s[56:59], s13 offen lds
    s_cmp_gt_u32 s15, 95
    s_cbranch_scc1 fk_win1
    s_lshl_b32 s12, s15, 10
    s_mov_b32 m0, s12
    s_and_b32 s14, s12, 1024
    s_lshr_b32 s14, s14, 4
    v_xor_b32 v209, s14, v208
    s_cmp_lt_u32 s15, 32
    s_cselect_b64 s[56:57], s[44:45], s[48:49]
    s_and_b32 s14, s15, 31
    s_mul_i32 s13, s14, 57344
    s_add_u32 s13, s13, s100
    s_lshl_b32 s14, s14, 12
    s_add_u32 s14, s14, s101
    s_cmp_lt_u32 s15, 64
    s_cselect_b64 s[56:57], s[56:57], s[52:53]
    s_cselect_b32 s13, s13, s14
    s_cselect_b64 vcc, -1, 0
    v_cndmask_b32 v209, v210, v209, vcc
    s_add_u32 s15, s15, 1
    buffer_load_dwordx4 v209, s[56:59], s13 offen lds
    s_nop 2
fk_win1:
    s_mov_b32 s42, 0
    s_waitcnt vmcnt(0)
    s_sleep 6
    s_nop 0
fk_pollw:
    buffer_load_dwordx4 v[184:187], v12, s[24:27], s37 offen sc1
    buffer_load_dwordx4 v[188:191], v12, s[24:27], s38 offen sc1
    buffer_load_dword v5, v192, s[24:27], s23 offen sc1
    s_waitcnt vmcnt(1)
    v_add3_u32 v3, v184, v185, v186
    v_add_u32 v3, v3, v187
    v_add3_u32 v4, v188, v189, v190
    v_add_u32 v4, v4, v191
    ds_write_b128 v7, v[184:187]
    v_add_u32_dpp v3, v3, v3 quad_perm:[1,0,3,2] row_mask:0xf bank_mask:0xf
    v_add_u32_dpp v4, v4, v4 quad_perm:[1,0,3,2] row_mask:0xf bank_mask:0xf
    ds_write_b128 v7, v[188:191] offset:1024
    v_cndmask_b32 v3, v3, v4, s[4:5]
    v_add_u32 v3, s43, v3
    s_waitcnt vmcnt(0)
    v_cmp_ne_u32 vcc, v3, v5
    s_add_u32 s42, s42, 1
    s_cbranch_vccz fk_gotw
    s_cmp_le_u32 s42, 0x40000
    s_cbranch_scc1 fk_pollw
    s_nop 0
fk_gotw:
    s_waitcnt lgkmcnt(0)
    s_barrier
    s_setprio 0
    s_or_b32 s13, s3, s16
    s_cbranch_scc1 fk_nobump
    v_mov_b32 v3, s43
    s_mov_b64 exec, 1
    buffer_store_dword v3, v14, s[24:27], 0 offen sc1
    s_mov_b64 exec, -1
    s_nop 1
fk_nobump:
    s_lshl_b32 s13, s16, 10
    s_add_u32 s14, s13, 0x11000
    s_add_u32 s13, s13, 114688
    v_add_u32 v7, s13, v14
    v_mov_b32 v3, 4096
    s_mov_b32 s15, 0x11000
    v_mov_b32 v8, 157152
    buffer_load_dwordx4 v[184:187], v14, s[24:27], s14 offen sc1
    buffer_load_dword v188, v3, s[24:27], s15 offen sc1
    s_mov_b32 s40, s14
    s_mov_b32 s41, s15
    s_cmp_gt_u32 s3, 223
    s_cbranch_scc1 fk_win2
    s_mul_i32 s15, s16, 4
    s_add_u32 s15, s15, 24
    s_cmp_ge_u32 s15, 32
    s_cselect_b32 s12, 32, 0
    s_add_u32 s15, s15, s12
    s_mov_b32 s58, 0x700000
    s_mov_b32 s59, 0x00020000
    s_cmp_gt_u32 s15, 95
    s_cbranch_scc1 fk_win2
    s_lshl_b32 s12, s15, 10
    s_mov_b32 m0, s12
    s_and_b32 s14, s12, 1024
    s_lshr_b32 s14, s14, 4
    v_xor_b32 v209, s14, v208
    s_cmp_lt_u32 s15, 32
    s_cselect_b64 s[56:57], s[44:45], s[48:49]
    s_and_b32 s14, s15, 31
    s_mul_i32 s13, s14, 57344
    s_add_u32 s13, s13, s100
    s_lshl_b32 s14, s14, 12
    s_add_u32 s14, s14, s101
    s_cmp_lt_u32 s15, 64
    s_cselect_b64 s[56:57], s[56:57], s[52:53]
    s_cselect_b32 s13, s13, s14
    s_cselect_b64 vcc, -1, 0
    v_cndmask_b32 v209, v210, v209, vcc
    s_add_u32 s15, s15, 1
    buffer_load_dwordx4 v209, s[56:59], s13 offen lds
    s_cmp_gt_u32 s15, 95
    s_cbranch_scc1 fk_win2
    s_lshl_b32 s12, s15, 10
    s_mov_b32 m0, s12
    s_and_b32 s14, s12, 1024
    s_lshr_b32 s14, s14, 4
    v_xor_b32 v209, s14, v208
    s_cmp_lt_u32 s15, 32
    s_cselect_b64 s[56:57], s[44:45], s[48:49]
    s_and_b32 s14, s15, 31
    s_mul_i32 s13, s14, 57344
    s_add_u32 s13, s13, s100
    s_lshl_b32 s14, s14, 12
    s_add_u32 s14, s14, s101
    s_cmp_lt_u32 s15, 64
    s_cselect_b64 s[56:57], s[56:57], s[52:53]
    s_cselect_b32 s13, s13, s14
    s_cselect_b64 vcc, -1, 0
    v_cndmask_b32 v209, v210, v209, vcc
    s_add_u32 s15, s15, 1
    buffer_load_dwordx4 v209, s[56:59], s13 offen lds
    s_cmp_gt_u32 s15, 95
    s_cbranch_scc1 fk_win2
    s_lshl_b32 s12, s15, 10
    s_mov_b32 m0, s12
    s_and_b32 s14, s12, 1024
    s_lshr_b32 s14, s14, 4
    v_xor_b32 v209, s14, v208
    s_cmp_lt_u32 s15, 32
    s_cselect_b64 s[56:57], s[44:45], s[48:49]
    s_and_b32 s14, s15, 31
    s_mul_i32 s13, s14, 57344
    s_add_u32 s13, s13, s100
    s_lshl_b32 s14, s14, 12
    s_add_u32 s14, s14, s101
    s_cmp_lt_u32 s15, 64
    s_cselect_b64 s[56:57], s[56:57], s[52:53]
    s_cselect_b32 s13, s13, s14
    s_cselect_b64 vcc, -1, 0
    v_cndmask_b32 v209, v210, v209, vcc
    s_add_u32 s15, s15, 1
    buffer_load_dwordx4 v209, s[56:59], s13 offen lds
    s_cmp_gt_u32 s15, 95
    s_cbranch_scc1 fk_win2
    s_lshl_b32 s12, s15, 10
    s_mov_b32 m0, s12
    s_and_b32 s14, s12, 1024
    s_lshr_b32 s14, s14, 4
    v_xor_b32 v209, s14, v208
    s_cmp_lt_u32 s15, 32
    s_cselect_b64 s[56:57], s[44:45], s[48:49]
    s_and_b32 s14, s15, 31
    s_mul_i32 s13, s14, 57344
    s_add_u32 s13, s13, s100
    s_lshl_b32 s14, s14, 12
    s_add_u32 s14, s14, s101
    s_cmp_lt_u32 s15, 64
    s_cselect_b64 s[56:57], s[56:57], s[52:53]
    s_cselect_b32 s13, s13, s14
    s_cselect_b64 vcc, -1, 0
    v_cndmask_b32 v209, v210, v209, vcc
    s_add_u32 s15, s15, 1
    buffer_load_dwordx4 v209, s[56:59], s13 offen lds
    s_nop 2
fk_win2:
    s_mov_b32 s42, 0
    s_cmp_gt_u32 s3, 223
    s_cbranch_scc1 fk_pollg
    s_waitcnt vmcnt(4)
    s_branch fk_chkg
    s_nop 0
fk_pollg:
    buffer_load_dwordx4 v[184:187], v14, s[24:27], s40 offen sc1
    buffer_load_dword v188, v3, s[24:27], s41 offen sc1
    s_waitcnt vmcnt(0)
    s_nop 0
fk_chkg:
    s_add_u32 s42, s42, 1
    v_max3_u32 v4, v184, v185, v186
    v_max3_u32 v4, v4, v187, v188
    v_cmp_eq_u32 vcc, -1, v4
    s_cbranch_vccz fk_gotg
    s_cmp_le_u32 s42, 0x40000
    s_cbranch_scc1 fk_pollg
    s_nop 1
fk_gotg:
    ds_write_b128 v7, v[184:187]
    ds_write_b32 v8, v188
    s_branch fk_common
    s_nop 0
fk_w4:
    v_min_u32 v184, -2, v176
    v_min_u32 v185, -2, v178
    v_min_u32 v186, -2, v180
    v_min_u32 v187, -2, v182
    v_min_u32 v8, -2, v8
    v_mov_b32 v4, 4096
    s_mov_b32 s14, 0x13000
    s_mov_b32 s15, 0x11000
    s_nop 2
fk_w4s:
    ds_read_b32 v3, v205
    s_waitcnt lgkmcnt(0)
    v_cmp_eq_u32 vcc, 0, v3
    s_nop 1
    s_and_b32 s13, vcc_lo, 32
    s_cbranch_scc1 fk_w4s
    buffer_store_dwordx4 v[184:187], v14, s[24:27], s14 offen sc1
    s_mov_b64 exec, 0x10000
    buffer_store_dword v8, v4, s[24:27], s15 offen sc1
    s_mov_b64 exec, -1
    s_branch fk_Hconst
    s_nop 0
fk_H:
    s_barrier
    s_cmp_lg_u32 s16, 7
    s_cbranch_scc1 fk_Hconst
    v_mov_b32 v4, -1
    v_mov_b32 v5, -1
    v_mov_b32 v6, -1
    v_mov_b32 v7, -1
    v_mov_b32 v3, 157120
    v_mov_b32 v8, 0
    ds_write_b32 v3, v8
    v_lshlrev_b32 v3, 12, v15
    s_lshl_b32 s13, s3, 4
    s_add_u32 s14, s13, 0x9000
    s_add_u32 s15, s13, 0x11000
    v_mov_b32 v201, 157844
    v_mov_b32 v204, 1
    s_waitcnt lgkmcnt(0)
    s_load_dword s56, s[24:25], 0
    s_mov_b64 exec, 0xff
    buffer_store_dwordx4 v[4:7], v3, s[24:27], s14 offen sc1
    s_cmp_eq_u32 s3, 255
    s_cselect_b32 exec_lo, 3, 1
    buffer_store_dwordx4 v[4:7], v14, s[24:27], s15 offen sc1
    s_mov_b64 exec, -1
    s_mov_b32 m0, 155008
    s_mov_b32 s12, 0
    buffer_load_dwordx4 v14, s[32:35], s12 offen lds
    s_mov_b32 m0, 156032
    s_mov_b32 s12, 1024
    buffer_load_dwordx4 v14, s[32:35], s12 offen lds
    s_cmp_eq_u32 s3, 255
    s_cselect_b32 s12, 0x13000, s26
    buffer_store_dwordx4 v[4:7], v14, s[24:27], s12 offen sc1
    s_cmp_lg_u32 s3, 248
    s_cbranch_scc1 fk_no1024
    s_mov_b32 m0, 118784
    s_mov_b32 s14, 2097152
    buffer_load_dwordx4 v14, s[8:11], s14 offen lds
    s_mov_b32 m0, 119808
    s_mov_b32 s14, 2098176
    buffer_load_dwordx4 v14, s[8:11], s14 offen lds
fk_no1024:
    s_mul_i32 s38, s3, 8320
    s_add_u32 s38, s38, 0x268000
    s_add_u32 s39, s38, 4096
    buffer_store_dwordx4 v[4:7], v14, s[24:27], s38 offen offset:0 sc1
    buffer_store_dwordx4 v[4:7], v14, s[24:27], s38 offen offset:1024 sc1
    buffer_store_dwordx4 v[4:7], v14, s[24:27], s38 offen offset:2048 sc1
    buffer_store_dwordx4 v[4:7], v14, s[24:27], s38 offen offset:3072 sc1
    buffer_store_dwordx4 v[4:7], v14, s[24:27], s39 offen offset:0 sc1
    buffer_store_dwordx4 v[4:7], v14, s[24:27], s39 offen offset:1024 sc1
    buffer_store_dwordx4 v[4:7], v14, s[24:27], s39 offen offset:2048 sc1
    buffer_store_dwordx4 v[4:7], v14, s[24:27], s39 offen offset:3072 sc1
    s_waitcnt lgkmcnt(0)
    s_add_u32 s56, s56, 1
    v_mov_b32 v202, s56
    ds_write_b32 v201, v202 offset:8
    s_waitcnt vmcnt(8)
    ds_write_b32 v201, v204
    s_waitcnt vmcnt(0)
    ds_write_b32 v201, v204 offset:4
fk_Hconst:
    s_sub_u32 s20, s16, 4
    v_lshrrev_b32 v208, 3, v15
    v_and_b32 v209, 7, v15
    v_and_b32 v210, 2, v208
    v_xor_b32 v209, v210, v209
    v_mul_u32_u24 v208, 7168, v208
    v_lshl_add_u32 v208, v209, 4, v208
    v_lshrrev_b32 v210, 5, v15
    v_lshlrev_b32 v210, 11, v210
    v_and_b32 v209, 31, v15
    v_lshl_add_u32 v210, v209, 4, v210
    s_and_b32 s12, s3, 3
    s_mul_i32 s100, s12, 1835008
    s_lshl_b32 s101, s12, 9
    s_lshr_b32 s12, s3, 2
    s_lshl_b32 s12, s12, 7
    s_add_u32 s100, s100, s12
    s_lshl_b32 s12, s12, 10
    s_add_u32 s101, s101, s12
    s_and_b32 s12, s20, 1
    s_lshl_b32 s12, s12, 6
    v_xor_b32 v206, s12, v208
    v_xor_b32 v207, 64, v206
    s_mov_b32 s6, 0x700000
    s_mov_b32 s7, 0x00020000
    s_cmp_gt_u32 s3, 223
    s_cselect_b32 s36, 3, s20
    s_waitcnt lgkmcnt(0)
    s_cmp_eq_u32 s36, 3
    s_cbranch_scc1 fk_gu0
    s_add_u32 s37, s20, 0
    s_lshl_b32 s12, s37, 10
    s_mov_b32 m0, s12
    s_cmp_lt_u32 s37, 32
    s_cselect_b64 s[4:5], s[44:45], s[48:49]
    s_and_b32 s37, s37, 31
    s_mul_i32 s37, s37, 57344
    s_add_u32 s37, s37, s100
    buffer_load_dwordx4 v206, s[4:7], s37 offen lds
fk_gu0:
    s_cmp_eq_u32 s36, 3
    s_cbranch_scc1 fk_gu1
    s_add_u32 s37, s20, 3
    s_lshl_b32 s12, s37, 10
    s_mov_b32 m0, s12
    s_cmp_lt_u32 s37, 32
    s_cselect_b64 s[4:5], s[44:45], s[48:49]
    s_and_b32 s37, s37, 31
    s_mul_i32 s37, s37, 57344
    s_add_u32 s37, s37, s100
    buffer_load_dwordx4 v207, s[4:7], s37 offen lds
fk_gu1:
    s_cmp_eq_u32 s36, 3
    s_cbranch_scc1 fk_gu2
    s_add_u32 s37, s20, 6
    s_lshl_b32 s12, s37, 10
    s_mov_b32 m0, s12
    s_cmp_lt_u32 s37, 32
    s_cselect_b64 s[4:5], s[44:45], s[48:49]
    s_and_b32 s37, s37, 31
    s_mul_i32 s37, s37, 57344
    s_add_u32 s37, s37, s100
    buffer_load_dwordx4 v206, s[4:7], s37 offen lds
fk_gu2:
    s_cmp_eq_u32 s36, 3
    s_cbranch_scc1 fk_gu3
    s_add_u32 s37, s20, 9
    s_lshl_b32 s12, s37, 10
    s_mov_b32 m0, s12
    s_cmp_lt_u32 s37, 32
    s_cselect_b64 s[4:5], s[44:45], s[48:49]
    s_and_b32 s37, s37, 31
    s_mul_i32 s37, s37, 57344
    s_add_u32 s37, s37, s100
    buffer_load_dwordx4 v207, s[4:7], s37 offen lds
fk_gu3:
    v_lshrrev_b32 v4, 1, v1
    v_and_b32 v5, 1, v4
    v_lshrrev_b32 v6, 2, v4
    v_lshl_add_u32 v5, v6, 1, v5
    v_and_b32 v6, 2, v4
    v_lshl_add_u32 v5, v6, 2, v5
    s_and_b32 s13, s20, 1
    s_mul_i32 s13, s13, 15
    v_xor_b32 v5, s13, v5
    s_lshl_b32 s13, s20, 4
    v_add_u32 v5, s13, v5
    v_cvt_f32_u32 v5, v5
    v_and_b32 v9, 1, v1
    v_lshlrev_b32 v7, 2, v2
    v_cvt_f32_u32 v7, v7
    v_cvt_f32_u32 v10, v9
    v_mul_f32 v8, 0x3c800000, v5
    v_mul_f32 v10, 0x3e800000, v10
    v_fma_f32 v10, v8, v7, v10
    v_mov_b32 v128, v10
    v_fmamk_f32 v129, v8, 0x3f800000, v10
    v_fmamk_f32 v130, v8, 0x40000000, v10
    v_fmamk_f32 v131, v8, 0x40400000, v10
    v_fmamk_f32 v132, v8, 0x41000000, v10
    v_fmamk_f32 v133, v8, 0x41100000, v10
    v_fmamk_f32 v134, v8, 0x41200000, v10
    v_fmamk_f32 v135, v8, 0x41300000, v10
    v_fmamk_f32 v136, v8, 0x41800000, v10
    v_fmamk_f32 v137, v8, 0x41880000, v10
    v_fmamk_f32 v138, v8, 0x41900000, v10
    v_fmamk_f32 v139, v8, 0x41980000, v10
    v_fmamk_f32 v140, v8, 0x41c00000, v10
    v_fmamk_f32 v141, v8, 0x41c80000, v10
    v_fmamk_f32 v142, v8, 0x41d00000, v10
    v_fmamk_f32 v143, v8, 0x41d80000, v10
    v_cos_f32 v144, v128
    v_cos_f32 v145, v129
    v_cos_f32 v146, v130
    v_cos_f32 v147, v131
    v_cos_f32 v148, v132
    v_cos_f32 v149, v133
    v_cos_f32 v150, v134
    v_cos_f32 v151, v135
    v_cos_f32 v152, v136
    v_cos_f32 v153, v137
    v_cos_f32 v154, v138
    v_cos_f32 v155, v139
    v_cos_f32 v156, v140
    v_cos_f32 v157, v141
    v_cos_f32 v158, v142
    v_cos_f32 v159, v143
    v_sin_f32 v160, v128
    v_sin_f32 v161, v129
    v_sin_f32 v162, v130
    v_sin_f32 v163, v131
    v_sin_f32 v164, v132
    v_sin_f32 v165, v133
    v_sin_f32 v166, v134
    v_sin_f32 v167, v135
    v_sin_f32 v168, v136
    v_sin_f32 v169, v137
    v_sin_f32 v170, v138
    v_sin_f32 v171, v139
    v_sin_f32 v172, v140
    v_sin_f32 v173, v141
    v_sin_f32 v174, v142
    v_sin_f32 v175, v143
    v_cvt_pk_f16_f32 v48, v144, v160
    v_cvt_pk_f16_f32 v49, v145, v161
    v_cvt_pk_f16_f32 v50, v146, v162
    v_cvt_pk_f16_f32 v51, v147, v163
    v_cvt_pk_f16_f32 v52, v148, v164
    v_cvt_pk_f16_f32 v53, v149, v165
    v_cvt_pk_f16_f32 v54, v150, v166
    v_cvt_pk_f16_f32 v55, v151, v167
    v_cvt_pk_f16_f32 v56, v152, v168
    v_cvt_pk_f16_f32 v57, v153, v169
    v_cvt_pk_f16_f32 v58, v154, v170
    v_cvt_pk_f16_f32 v59, v155, v171
    v_cvt_pk_f16_f32 v60, v156, v172
    v_cvt_pk_f16_f32 v61, v157, v173
    v_cvt_pk_f16_f32 v62, v158, v174
    v_cvt_pk_f16_f32 v63, v159, v175
    v_fmamk_f32 v128, v8, 0x42000000, v10
    v_fmamk_f32 v129, v8, 0x42040000, v10
    v_fmamk_f32 v130, v8, 0x42080000, v10
    v_fmamk_f32 v131, v8, 0x420c0000, v10
    v_fmamk_f32 v132, v8, 0x42200000, v10
    v_fmamk_f32 v133, v8, 0x42240000, v10
    v_fmamk_f32 v134, v8, 0x42280000, v10
    v_fmamk_f32 v135, v8, 0x422c0000, v10
    v_fmamk_f32 v136, v8, 0x42400000, v10
    v_fmamk_f32 v137, v8, 0x42440000, v10
    v_fmamk_f32 v138, v8, 0x42480000, v10
    v_fmamk_f32 v139, v8, 0x424c0000, v10
    v_fmamk_f32 v140, v8, 0x42600000, v10
    v_fmamk_f32 v141, v8, 0x42640000, v10
    v_fmamk_f32 v142, v8, 0x42680000, v10
    v_fmamk_f32 v143, v8, 0x426c0000, v10
    v_cos_f32 v144, v128
    v_cos_f32 v145, v129
    v_cos_f32 v146, v130
    v_cos_f32 v147, v131
    v_cos_f32 v148, v132
    v_cos_f32 v149, v133
    v_cos_f32 v150, v134
    v_cos_f32 v151, v135
    v_cos_f32 v152, v136
    v_cos_f32 v153, v137
    v_cos_f32 v154, v138
    v_cos_f32 v155, v139
    v_cos_f32 v156, v140
    v_cos_f32 v157, v141
    v_cos_f32 v158, v142
    v_cos_f32 v159, v143
    v_sin_f32 v160, v128
    v_sin_f32 v161, v129
    v_sin_f32 v162, v130
    v_sin_f32 v163, v131
    v_sin_f32 v164, v132
    v_sin_f32 v165, v133
    v_sin_f32 v166, v134
    v_sin_f32 v167, v135
    v_sin_f32 v168, v136
    v_sin_f32 v169, v137
    v_sin_f32 v170, v138
    v_sin_f32 v171, v139
    v_sin_f32 v172, v140
    v_sin_f32 v173, v141
    v_sin_f32 v174, v142
    v_sin_f32 v175, v143
    v_cvt_pk_f16_f32 v64, v144, v160
    v_cvt_pk_f16_f32 v65, v145, v161
    v_cvt_pk_f16_f32 v66, v146, v162
    v_cvt_pk_f16_f32 v67, v147, v163
    v_cvt_pk_f16_f32 v68, v148, v164
    v_cvt_pk_f16_f32 v69, v149, v165
    v_cvt_pk_f16_f32 v70, v150, v166
    v_cvt_pk_f16_f32 v71, v151, v167
    v_cvt_pk_f16_f32 v72, v152, v168
    v_cvt_pk_f16_f32 v73, v153, v169
    v_cvt_pk_f16_f32 v74, v154, v170
    v_cvt_pk_f16_f32 v75, v155, v171
    v_cvt_pk_f16_f32 v76, v156, v172
    v_cvt_pk_f16_f32 v77, v157, v173
    v_cvt_pk_f16_f32 v78, v158, v174
    v_cvt_pk_f16_f32 v79, v159, v175
    v_lshlrev_b32 v11, 31, v9
    v_mul_f32 v10, 0x3a000000, v5
    v_xor_b32 v10, v11, v10
    v_mul_f32 v11, v10, v7
    v_mov_b32 v128, v11
    v_fmamk_f32 v129, v10, 0x3f800000, v11
    v_fmamk_f32 v130, v10, 0x40000000, v11
    v_fmamk_f32 v131, v10, 0x40400000, v11
    v_fmamk_f32 v132, v10, 0x41000000, v11
    v_fmamk_f32 v133, v10, 0x41100000, v11
    v_fmamk_f32 v134, v10, 0x41200000, v11
    v_fmamk_f32 v135, v10, 0x41300000, v11
    v_fmamk_f32 v136, v10, 0x41800000, v11
    v_fmamk_f32 v137, v10, 0x41880000, v11
    v_fmamk_f32 v138, v10, 0x41900000, v11
    v_fmamk_f32 v139, v10, 0x41980000, v11
    v_fmamk_f32 v140, v10, 0x41c00000, v11
    v_fmamk_f32 v141, v10, 0x41c80000, v11
    v_fmamk_f32 v142, v10, 0x41d00000, v11
    v_fmamk_f32 v143, v10, 0x41d80000, v11
    v_cos_f32 v80, v128
    v_cos_f32 v81, v129
    v_cos_f32 v82, v130
    v_cos_f32 v83, v131
    v_cos_f32 v84, v132
    v_cos_f32 v85, v133
    v_cos_f32 v86, v134
    v_cos_f32 v87, v135
    v_cos_f32 v88, v136
    v_cos_f32 v89, v137
    v_cos_f32 v90, v138
    v_cos_f32 v91, v139
    v_cos_f32 v92, v140
    v_cos_f32 v93, v141
    v_cos_f32 v94, v142
    v_cos_f32 v95, v143
    v_sin_f32 v96, v128
    v_sin_f32 v97, v129
    v_sin_f32 v98, v130
    v_sin_f32 v99, v131
    v_sin_f32 v100, v132
    v_sin_f32 v101, v133
    v_sin_f32 v102, v134
    v_sin_f32 v103, v135
    v_sin_f32 v104, v136
    v_sin_f32 v105, v137
    v_sin_f32 v106, v138
    v_sin_f32 v107, v139
    v_sin_f32 v108, v140
    v_sin_f32 v109, v141
    v_sin_f32 v110, v142
    v_sin_f32 v111, v143
    v_sub_u32 v4, 31, v1
    v_subrev_u32 v5, 1, v1
    v_cmp_lt_u32 vcc, 16, v1
    s_nop 1
    v_cndmask_b32 v4, v5, v4, vcc
    v_and_b32 v4, 15, v4
    v_lshlrev_b32 v4, 5, v4
    v_add_u32 v4, 130304, v4
    v_lshlrev_b32 v5, 9, v2
    v_add_u32 v6, v4, v5
    v_sub_u32 v7, v4, v5
    v_add_u32 v7, 7696, v7
    v_cmp_eq_u32 s[38:39], 0, v1
    v_mov_b32 v8, 4096
    s_nop 0
    v_cndmask_b32 v8, 0, v8, s[38:39]
    v_add_u32 v6, v6, v8
    v_add_u32 v7, v7, v8
    v_and_b32 v8, 15, v1
    v_cmp_eq_u32 s[38:39], 0, v8
    s_nop 1
    s_or_b64 s[40:41], s[38:39], vcc
    v_add_u32 v184, 0, v6
    v_subrev_u32 v8, 0, v7
    v_cndmask_b32 v184, v184, v8, vcc
    v_add_u32 v185, 1024, v6
    v_subrev_u32 v8, 1024, v7
    v_cndmask_b32 v185, v185, v8, vcc
    v_add_u32 v186, 2048, v6
    v_subrev_u32 v8, 2048, v7
    v_cndmask_b32 v186, v186, v8, vcc
    v_add_u32 v187, 3072, v6
    v_subrev_u32 v8, 3072, v7
    v_cndmask_b32 v187, v187, v8, vcc
    v_add_u32 v188, 4096, v6
    v_subrev_u32 v8, 4096, v7
    v_cndmask_b32 v188, v188, v8, s[40:41]
    v_add_u32 v189, 5120, v6
    v_subrev_u32 v8, 5120, v7
    v_cndmask_b32 v189, v189, v8, s[40:41]
    v_add_u32 v190, 6144, v6
    v_subrev_u32 v8, 6144, v7
    v_cndmask_b32 v190, v190, v8, s[40:41]
    v_add_u32 v191, 7168, v6
    v_subrev_u32 v8, 7168, v7
    v_cndmask_b32 v191, v191, v8, s[40:41]
    v_add_u32 v212, 512, v188
    v_add_u32 v213, 512, v189
    v_add_u32 v214, 512, v190
    v_add_u32 v215, 512, v191
    v_subrev_u32 v8, 4096, v212
    v_cmp_eq_u32 vcc, 0, v2
    s_nop 1
    v_cndmask_b32 v212, v212, v8, vcc
    s_lshr_b32 s13, s20, 1
    v_lshl_add_u32 v3, v1, 1, s13
    s_and_b32 s13, s20, 1
    s_sub_u32 s14, 64, s13
    v_and_b32 v8, 3, v3
    v_lshlrev_b32 v8, 2, v8
    v_lshlrev_b32 v4, 3, v3
    v_sub_u32 v4, v4, v8
    v_sub_u32 v5, 63, v3
    v_and_b32 v8, 3, v5
    v_mul_u32_u24 v8, 12, v8
    v_lshlrev_b32 v6, 3, v5
    v_sub_u32 v6, v6, v8
    v_add_u32 v6, 28, v6
    v_sub_u32 v5, s14, v3
    v_and_b32 v8, 3, v5
    v_mul_u32_u24 v8, 12, v8
    v_lshlrev_b32 v7, 3, v5
    v_sub_u32 v7, v7, v8
    v_add_u32 v7, 28, v7
    v_cmp_gt_u32 vcc, 32, v3
    s_nop 1
    v_cndmask_b32 v7, v7, v4, vcc
    v_cmp_eq_u32 vcc, 32, v5
    s_nop 1
    v_cndmask_b32 v7, v7, 28, vcc
    s_cmp_eq_u32 s13, 0
    s_cselect_b32 s14, 256, 0
    s_cselect_b32 s15, 576, 0
    s_cselect_b64 s[38:39], -1, 0
    s_add_u32 s14, s14, 7680
    s_sub_u32 s15, 120832, s15
    v_cmp_gt_u32 vcc, 32, v3
    s_nop 1
    v_cndmask_b32 v7, v7, v4, vcc
    v_add_u32 v7, s14, v7
    v_cndmask_b32 v4, v6, v4, s[38:39]
    v_lshl_add_u32 v4, v2, 12, v4
    v_lshrrev_b32 v8, 7, v4
    v_lshl_add_u32 v4, v8, 4, v4
    v_lshrrev_b32 v8, 7, v7
    v_lshl_add_u32 v7, v8, 4, v7
    v_add_u32 v11, s15, v4
    v_add_u32 v7, 120832, v7
    v_add_u32 v12, 4032, v11
    v_cmp_eq_u32 vcc, s13, v2
    s_nop 1
    s_and_b64 s[40:41], vcc, s[38:39]
    s_andn2_b64 s[38:39], vcc, s[38:39]
    v_cndmask_b32 v10, v11, v7, s[40:41]
    v_cndmask_b32 v12, v12, v7, s[38:39]
    s_lshl_b32 s23, s20, 5
    s_add_u32 s23, s23, s18
    v_and_b32 v3, 15, v15
    v_lshrrev_b32 v4, 4, v15
    v_lshl_add_u32 v3, v3, 7, v4
    v_add_u32 v3, 1, v3
    v_cmp_le_u32 vcc, 56, v15
    v_mov_b32 v4, 1008
    s_nop 0
    v_cndmask_b32 v4, 0, v4, vcc
    v_add_u32 v4, v3, v4
    v_mul_u32_u24 v3, s23, v3
    v_and_b32 v3, 2047, v3
    v_cvt_f32_u32 v3, v3
    v_mul_f32 v3, 0x3a000000, v3
    v_mul_u32_u24 v4, s23, v4
    v_and_b32 v4, 2047, v4
    v_cvt_f32_u32 v4, v4
    v_mul_f32 v4, 0x3a000000, v4
    v_cvt_f32_u32 v5, s23
    v_mul_f32 v5, 0x3a000000, v5
    v_mov_b32 v192, v3
    v_fmamk_f32 v193, v5, 0x42000000, v3
    v_fmamk_f32 v194, v5, 0x42800000, v3
    v_fmamk_f32 v195, v5, 0x42c00000, v3
    v_fmamk_f32 v196, v5, 0x40800000, v3
    v_fmamk_f32 v197, v5, 0x42100000, v3
    v_fmamk_f32 v198, v5, 0x42880000, v3
    v_fmamk_f32 v199, v5, 0x42c80000, v3
    v_fmamk_f32 v200, v5, 0x41000000, v3
    v_fmamk_f32 v201, v5, 0x42200000, v3
    v_fmamk_f32 v202, v5, 0x42900000, v3
    v_fmamk_f32 v203, v5, 0x42d00000, v3
    v_fmamk_f32 v204, v5, 0x41400000, v4
    v_fmamk_f32 v205, v5, 0x42300000, v4
    v_fmamk_f32 v206, v5, 0x42980000, v4
    v_fmamk_f32 v207, v5, 0x42d80000, v4
    v_cos_f32 v192, v192
    v_cos_f32 v193, v193
    v_cos_f32 v194, v194
    v_cos_f32 v195, v195
    v_cos_f32 v196, v196
    v_cos_f32 v197, v197
    v_cos_f32 v198, v198
    v_cos_f32 v199, v199
    v_cos_f32 v200, v200
    v_cos_f32 v201, v201
    v_cos_f32 v202, v202
    v_cos_f32 v203, v203
    v_cos_f32 v204, v204
    v_cos_f32 v205, v205
    v_cos_f32 v206, v206
    v_cos_f32 v207, v207
    v_add_u32 v9, 138496, v14
    v_mov_b32 v3, 157864
    s_nop 4
fk_c2s:
    ds_read_b32 v4, v3
    s_waitcnt lgkmcnt(0)
    v_readfirstlane_b32 s13, v4
    s_nop 1
    s_cmp_eq_u32 s13, 0
    s_cbranch_scc1 fk_c2s
    ds_read_b128 v[112:115], v9 offset:12288
    ds_read_b128 v[116:119], v9 offset:13312
    ds_read_b128 v[120:123], v9 offset:14336
    ds_read_b128 v[124:127], v9 offset:15360
    s_setprio 2
    s_waitcnt lgkmcnt(0)
    s_barrier
    ds_read_b128 v[16:19], v184
    ds_read_b128 v[20:23], v185
    ds_read_b128 v[24:27], v186
    ds_read_b128 v[28:31], v187
    ds_read_b128 v[32:35], v188
    ds_read_b128 v[36:39], v189
    ds_read_b128 v[40:43], v190
    ds_read_b128 v[44:47], v191
    s_mov_b32 exec_lo, 1
    s_mov_b32 exec_hi, 1
    ds_read_b32 v32, v212
    ds_read_b32 v36, v213
    ds_read_b32 v40, v214
    ds_read_b32 v44, v215
    s_mov_b64 exec, -1
    s_waitcnt lgkmcnt(11)
    v_mfma_f32_32x32x16_f16 v[128:143], v[16:19], v[48:51], 0
    s_waitcnt lgkmcnt(10)
    v_mfma_f32_32x32x16_f16 v[128:143], v[20:23], v[52:55], v[128:143]
    s_waitcnt lgkmcnt(9)
    v_mfma_f32_32x32x16_f16 v[128:143], v[24:27], v[56:59], v[128:143]
    s_waitcnt lgkmcnt(8)
    v_mfma_f32_32x32x16_f16 v[128:143], v[28:31], v[60:63], v[128:143]
    s_waitcnt lgkmcnt(3)
    v_mfma_f32_32x32x16_f16 v[128:143], v[32:35], v[64:67], v[128:143]
    s_waitcnt lgkmcnt(2)
    v_mfma_f32_32x32x16_f16 v[128:143], v[36:39], v[68:71], v[128:143]
    s_waitcnt lgkmcnt(1)
    v_mfma_f32_32x32x16_f16 v[128:143], v[40:43], v[72:75], v[128:143]
    s_waitcnt lgkmcnt(0)
    v_mfma_f32_32x32x16_f16 v[128:143], v[44:47], v[76:79], v[128:143]
    s_nop 11
    v_pk_mul_f32 v[16:17], v[128:129], v[80:81]
    v_pk_mul_f32 v[18:19], v[130:131], v[82:83]
    v_pk_mul_f32 v[20:21], v[132:133], v[84:85]
    v_pk_mul_f32 v[22:23], v[134:135], v[86:87]
    v_pk_mul_f32 v[24:25], v[136:137], v[88:89]
    v_pk_mul_f32 v[26:27], v[138:139], v[90:91]
    v_pk_mul_f32 v[28:29], v[140:141], v[92:93]
    v_pk_mul_f32 v[30:31], v[142:143], v[94:95]
    v_fmac_f32_dpp v16, v128, v96 quad_perm:[1,0,3,2] row_mask:0xf bank_mask:0xf
    v_fmac_f32_dpp v17, v129, v97 quad_perm:[1,0,3,2] row_mask:0xf bank_mask:0xf
    v_fmac_f32_dpp v18, v130, v98 quad_perm:[1,0,3,2] row_mask:0xf bank_mask:0xf
    v_fmac_f32_dpp v19, v131, v99 quad_perm:[1,0,3,2] row_mask:0xf bank_mask:0xf
    v_fmac_f32_dpp v20, v132, v100 quad_perm:[1,0,3,2] row_mask:0xf bank_mask:0xf
    v_fmac_f32_dpp v21, v133, v101 quad_perm:[1,0,3,2] row_mask:0xf bank_mask:0xf
    v_fmac_f32_dpp v22, v134, v102 quad_perm:[1,0,3,2] row_mask:0xf bank_mask:0xf
    v_fmac_f32_dpp v23, v135, v103 quad_perm:[1,0,3,2] row_mask:0xf bank_mask:0xf
    v_cvt_pk_f16_f32 v176, v16, v17
    v_cvt_pk_f16_f32 v177, v18, v19
    v_cvt_pk_f16_f32 v178, v20, v21
    v_cvt_pk_f16_f32 v179, v22, v23
    v_fmac_f32_dpp v24, v136, v104 quad_perm:[1,0,3,2] row_mask:0xf bank_mask:0xf
    v_fmac_f32_dpp v25, v137, v105 quad_perm:[1,0,3,2] row_mask:0xf bank_mask:0xf
    v_mfma_f32_32x32x16_f16 v[144:159], v[176:179], v[112:115], 0
    v_fmac_f32_dpp v26, v138, v106 quad_perm:[1,0,3,2] row_mask:0xf bank_mask:0xf
    v_fmac_f32_dpp v27, v139, v107 quad_perm:[1,0,3,2] row_mask:0xf bank_mask:0xf
    v_fmac_f32_dpp v28, v140, v108 quad_perm:[1,0,3,2] row_mask:0xf bank_mask:0xf
    v_fmac_f32_dpp v29, v141, v109 quad_perm:[1,0,3,2] row_mask:0xf bank_mask:0xf
    v_fmac_f32_dpp v30, v142, v110 quad_perm:[1,0,3,2] row_mask:0xf bank_mask:0xf
    v_mfma_f32_32x32x16_f16 v[160:175], v[176:179], v[120:123], 0
    v_fmac_f32_dpp v31, v143, v111 quad_perm:[1,0,3,2] row_mask:0xf bank_mask:0xf
    v_cvt_pk_f16_f32 v180, v24, v25
    v_cvt_pk_f16_f32 v181, v26, v27
    v_cvt_pk_f16_f32 v182, v28, v29
    v_cvt_pk_f16_f32 v183, v30, v31
    s_nop 1
    v_mfma_f32_32x32x16_f16 v[144:159], v[180:183], v[116:119], v[144:159]
    v_mfma_f32_32x32x16_f16 v[160:175], v[180:183], v[124:127], v[160:175]
    s_nop 11
    v_pk_add_f32 v[16:17], v[144:145], v[160:161] op_sel:[0,1] op_sel_hi:[1,0] neg_hi:[0,1]
    v_pk_add_f32 v[18:19], v[146:147], v[162:163] op_sel:[0,1] op_sel_hi:[1,0] neg_hi:[0,1]
    v_pk_add_f32 v[20:21], v[148:149], v[164:165] op_sel:[0,1] op_sel_hi:[1,0] neg_hi:[0,1]
    v_pk_add_f32 v[22:23], v[150:151], v[166:167] op_sel:[0,1] op_sel_hi:[1,0] neg_hi:[0,1]
    v_pk_add_f32 v[24:25], v[152:153], v[168:169] op_sel:[0,1] op_sel_hi:[1,0] neg_hi:[0,1]
    v_pk_add_f32 v[26:27], v[154:155], v[170:171] op_sel:[0,1] op_sel_hi:[1,0] neg_hi:[0,1]
    v_pk_add_f32 v[28:29], v[156:157], v[172:173] op_sel:[0,1] op_sel_hi:[1,0] neg_hi:[0,1]
    v_pk_add_f32 v[30:31], v[158:159], v[174:175] op_sel:[0,1] op_sel_hi:[1,0] neg_hi:[0,1]
    v_cvt_pk_f16_f32 v48, v16, v17
    ds_write_b32 v10, v48
    v_cvt_pk_f16_f32 v49, v18, v19
    ds_write_b32 v11, v49 offset:576
    v_cvt_pk_f16_f32 v50, v20, v21
    ds_write_b32 v11, v50 offset:1152
    v_cvt_pk_f16_f32 v51, v22, v23
    ds_write_b32 v11, v51 offset:1728
    v_cvt_pk_f16_f32 v52, v24, v25
    ds_write_b32 v11, v52 offset:2304
    v_cvt_pk_f16_f32 v53, v26, v27
    ds_write_b32 v11, v53 offset:2880
    v_cvt_pk_f16_f32 v54, v28, v29
    ds_write_b32 v11, v54 offset:3456
    v_cvt_pk_f16_f32 v55, v30, v31
    ds_write_b32 v12, v55
    s_nop 3
fk_common:
    v_lshlrev_b32 v4, 4, v0
    v_lshrrev_b32 v5, 3, v0
    v_lshl_add_u32 v5, v5, 4, v4
    v_add_u32 v5, 120832, v5
    s_mul_i32 s17, s3, 8320
    s_add_u32 s17, s17, 0x268000
    s_waitcnt lgkmcnt(0)
    s_barrier
    s_setprio 0
    ds_read_b128 v[16:19], v5
    s_sub_u32 s13, 7, s16
    s_cmp_lt_u32 s16, 4
    s_cselect_b32 s13, s16, s13
    s_cselect_b32 s14, 0, 2048
    s_lshl_b32 s21, s13, 5
    s_add_u32 s21, s21, s18
    s_sub_u32 s22, 2048, s21
    s_and_b32 s22, s22, 2047
    s_cmp_lt_u32 s16, 4
    s_cselect_b32 s21, s21, s22
    s_lshl_b32 s13, s13, 12
    s_add_u32 s13, s13, s14
    s_add_u32 s13, s13, 98304
    s_lshl_b32 s14, s3, 3
    s_add_u32 s19, s14, s16
    s_cmp_eq_u32 s19, 1991
    s_cselect_b32 s21, 1024, s21
    s_cselect_b32 s13, 118784, s13
    s_lshl_b32 s22, s21, 11
    v_add_u32 v6, s13, v14
    v_add_u32 v7, 155008, v14
    s_waitcnt lgkmcnt(0)
    v_min_u32 v16, -2, v16
    v_min_u32 v17, -2, v17
    v_min_u32 v18, -2, v18
    v_min_u32 v19, -2, v19
    buffer_store_dwordx4 v[16:19], v4, s[24:27], s17 offen sc1
    ds_read_b128 v[20:23], v6
    ds_read_b128 v[24:27], v6 offset:1024
    ds_read_b128 v[28:31], v7
    ds_read_b128 v[32:35], v7 offset:1024
    s_cmp_lt_u32 s16, 4
    s_cbranch_scc1 fk_noy5
    v_add_u32 v3, 114688, v14
    v_mov_b32 v4, 157152
    ds_read_b128 v[128:131], v3 offset:0
    ds_read_b128 v[132:135], v3 offset:1024
    ds_read_b128 v[136:139], v3 offset:2048
    ds_read_b128 v[140:143], v3 offset:3072
    ds_read_b32 v9, v4
    s_lshl_b32 s38, s20, 2
    s_sub_u32 s39, 28, s38
    s_waitcnt lgkmcnt(0)
    s_nop 0
fk_y5:
    v_pk_mul_f32 v[144:145], v[128:129], v[192:193]
    v_pk_mul_f32 v[146:147], v[130:131], v[194:195]
    v_pk_fma_f32 v[144:145], v[132:133], v[196:197], v[144:145]
    v_pk_fma_f32 v[146:147], v[134:135], v[198:199], v[146:147]
    v_pk_fma_f32 v[144:145], v[136:137], v[200:201], v[144:145]
    v_pk_fma_f32 v[146:147], v[138:139], v[202:203], v[146:147]
    v_pk_fma_f32 v[144:145], v[140:141], v[204:205], v[144:145]
    v_pk_fma_f32 v[146:147], v[142:143], v[206:207], v[146:147]
    v_pk_add_f32 v[144:145], v[144:145], v[146:147]
    v_add_f32 v144, v144, v145
    s_lshl_b32 s13, s23, 31
    v_xor_b32 v12, s13, v9
    v_add_f32_dpp v144, v144, v144 quad_perm:[1,0,3,2] row_mask:0xf bank_mask:0xf
    s_nop 1
    v_add_f32_dpp v144, v144, v144 quad_perm:[2,3,0,1] row_mask:0xf bank_mask:0xf
    s_nop 1
    v_add_f32_dpp v144, v144, v144 row_half_mirror row_mask:0xf bank_mask:0xf
    s_nop 1
    v_add_f32_dpp v144, v144, v144 row_mirror row_mask:0xf bank_mask:0xf
    s_nop 1
    v_add_f32_dpp v144, v144, v144 row_bcast:15 row_mask:0xa bank_mask:0xf
    s_nop 1
    v_add_f32_dpp v144, v144, v144 row_bcast:31 row_mask:0xc bank_mask:0xf
    v_add_f32 v144, v144, v12
    v_add_f32 v144, v144, v144
    v_cvt_f16_f32 v144, v144
    s_add_u32 s13, s38, 157088
    s_add_u32 s14, s39, 157088
    v_mov_b32 v10, s13
    v_mov_b32 v11, s14
    s_mov_b32 exec_lo, 0
    s_mov_b32 exec_hi, 0x80000000
    ds_write_b32 v10, v144
    ds_write_b32 v11, v144
    s_mov_b64 exec, -1
    s_cmp_lg_u32 s23, 0
    s_cbranch_scc1 fk_noy5
    s_mov_b32 s23, 1024
    s_mov_b32 s38, 28
    v_and_b32 v3, 15, v15
    v_lshrrev_b32 v4, 4, v15
    v_lshl_add_u32 v3, v3, 7, v4
    v_add_u32 v3, 1, v3
    v_cmp_le_u32 vcc, 56, v15
    v_mov_b32 v4, 1008
    s_nop 0
    v_cndmask_b32 v4, 0, v4, vcc
    v_add_u32 v4, v3, v4
    v_mul_u32_u24 v3, s23, v3
    v_and_b32 v3, 2047, v3
    v_cvt_f32_u32 v3, v3
    v_mul_f32 v3, 0x3a000000, v3
    v_mul_u32_u24 v4, s23, v4
    v_and_b32 v4, 2047, v4
    v_cvt_f32_u32 v4, v4
    v_mul_f32 v4, 0x3a000000, v4
    v_cvt_f32_u32 v5, s23
    v_mul_f32 v5, 0x3a000000, v5
    v_mov_b32 v192, v3
    v_fmamk_f32 v193, v5, 0x42000000, v3
    v_fmamk_f32 v194, v5, 0x42800000, v3
    v_fmamk_f32 v195, v5, 0x42c00000, v3
    v_fmamk_f32 v196, v5, 0x40800000, v3
    v_fmamk_f32 v197, v5, 0x42100000, v3
    v_fmamk_f32 v198, v5, 0x42880000, v3
    v_fmamk_f32 v199, v5, 0x42c80000, v3
    v_fmamk_f32 v200, v5, 0x41000000, v3
    v_fmamk_f32 v201, v5, 0x42200000, v3
    v_fmamk_f32 v202, v5, 0x42900000, v3
    v_fmamk_f32 v203, v5, 0x42d00000, v3
    v_fmamk_f32 v204, v5, 0x41400000, v4
    v_fmamk_f32 v205, v5, 0x42300000, v4
    v_fmamk_f32 v206, v5, 0x42980000, v4
    v_fmamk_f32 v207, v5, 0x42d80000, v4
    v_cos_f32 v192, v192
    v_cos_f32 v193, v193
    v_cos_f32 v194, v194
    v_cos_f32 v195, v195
    v_cos_f32 v196, v196
    v_cos_f32 v197, v197
    v_cos_f32 v198, v198
    v_cos_f32 v199, v199
    v_cos_f32 v200, v200
    v_cos_f32 v201, v201
    v_cos_f32 v202, v202
    v_cos_f32 v203, v203
    v_cos_f32 v204, v204
    v_cos_f32 v205, v205
    v_cos_f32 v206, v206
    v_cos_f32 v207, v207
    s_branch fk_y5
    s_nop 3
fk_noy5:
    v_lshrrev_b32 v1, 1, v0
    v_and_b32 v45, 1, v0
    v_lshrrev_b32 v2, 4, v1
    v_and_b32 v3, 15, v1
    v_cmp_gt_u32 vcc, 8, v3
    v_sub_u32 v6, 16, v3
    v_and_b32 v6, 7, v6
    v_sub_u32 v5, 31, v2
    v_cndmask_b32 v6, v6, v3, vcc
    v_cndmask_b32 v5, v5, v2, vcc
    v_lshl_add_u32 v4, v6, 5, v5
    v_and_b32 v12, 63, v4
    v_lshrrev_b32 v13, 6, v4
    v_lshlrev_b32 v13, 2, v13
    v_lshl_add_u32 v12, v12, 4, v13
    s_mov_b32 s23, 0x13000
    s_mov_b32 s42, 0
    buffer_load_dword v47, v12, s[24:27], s23 offen sc1
    v_mul_u32_u24 v4, 8320, v4
    v_lshl_add_u32 v4, v45, 4, v4
    s_lshl_b32 s17, s3, 5
    s_add_u32 s17, s17, 0x268000
    v_cndmask_b32 v6, -1, 1, vcc
    v_cmp_eq_u32 vcc, 8, v3
    v_mul_u32_u24 v46, 8256, v45
    v_add_u32 v46, 138496, v46
    v_cndmask_b32 v6, v6, 15, vcc
    v_lshlrev_b32 v9, 2, v1
    v_lshl_add_u32 v10, v6, 1, v9
    v_add_u32 v9, v46, v9
    v_add_u32 v10, v46, v10
    s_mul_i32 s36, s16, 2064
    s_add_u32 s36, s36, 138496
    v_add_u32 v5, s36, v14
    s_sub_u32 s36, 7, s16
    s_cmp_eq_u32 s21, 0
    s_cselect_b32 s36, 0, s36
    s_cmp_eq_u32 s21, 1024
    s_cselect_b32 s36, 7, s36
    s_mul_i32 s36, s36, 2064
    s_add_u32 s36, s36, 139504
    v_sub_u32 v11, s36, v14
    s_lshl_b32 s36, s16, 2
    s_add_u32 s36, s36, 157088
    v_mov_b32 v6, s36
    s_mov_b32 s36, 0xffff0000
    s_mov_b32 s37, 0x3f803f80
    s_mov_b32 s38, 0x42800000
    s_waitcnt lgkmcnt(0)
    v_lshlrev_b32 v48, 16, v20
    v_and_b32 v49, s36, v20
    v_lshlrev_b32 v50, 16, v21
    v_and_b32 v51, s36, v21
    v_lshlrev_b32 v52, 16, v22
    v_and_b32 v53, s36, v22
    v_lshlrev_b32 v54, 16, v23
    v_and_b32 v55, s36, v23
    v_lshlrev_b32 v56, 16, v24
    v_and_b32 v57, s36, v24
    v_lshlrev_b32 v58, 16, v25
    v_and_b32 v59, s36, v25
    v_lshlrev_b32 v60, 16, v26
    v_and_b32 v61, s36, v26
    v_lshlrev_b32 v62, 16, v27
    v_and_b32 v63, s36, v27
    v_mov_b32 v44, 0
    v_dot2c_f32_bf16 v44, s37, v28
    v_dot2c_f32_bf16 v44, s37, v29
    v_dot2c_f32_bf16 v44, s37, v30
    v_dot2c_f32_bf16 v44, s37, v31
    v_dot2c_f32_bf16 v44, s37, v32
    v_dot2c_f32_bf16 v44, s37, v33
    v_dot2c_f32_bf16 v44, s37, v34
    v_dot2c_f32_bf16 v44, s37, v35
    s_nop 2
    v_add_f32_dpp v44, v44, v44 quad_perm:[1,0,3,2] row_mask:0xf bank_mask:0xf
    s_nop 1
    v_add_f32_dpp v44, v44, v44 quad_perm:[2,3,0,1] row_mask:0xf bank_mask:0xf
    s_nop 1
    v_add_f32_dpp v44, v44, v44 row_half_mirror row_mask:0xf bank_mask:0xf
    s_nop 1
    v_add_f32_dpp v44, v44, v44 row_mirror row_mask:0xf bank_mask:0xf
    s_nop 1
    v_add_f32_dpp v44, v44, v44 row_bcast:15 row_mask:0xa bank_mask:0xf
    s_nop 1
    v_add_f32_dpp v44, v44, v44 row_bcast:31 row_mask:0xc bank_mask:0xf
    s_nop 0
    v_readlane_b32 s39, v44, 63
    s_and_b32 s13, s18, 1
    s_mul_i32 s40, s13, 0x80008000
    s_branch fk_chkr1
    s_nop 1
fk_pollr1:
    buffer_load_dword v47, v12, s[24:27], s23 offen sc1
fk_chkr1:
    s_add_u32 s42, s42, 1
    s_waitcnt vmcnt(0)
    v_cmp_eq_u32 vcc, -1, v47
    s_cbranch_vccz fk_gotr1
    s_cmp_le_u32 s42, 0x40000
    s_cbranch_scc1 fk_pollr1
    s_nop 1
fk_gotr1:
    v_xor_b32 v47, s40, v47
    s_mov_b32 s42, 0
    s_sleep 2
    s_nop 2
fk_polly:
    buffer_load_dwordx4 v[36:39], v4, s[24:27], s17 offen sc1
    s_add_u32 s42, s42, 1
    s_waitcnt vmcnt(0)
    v_max3_u32 v46, v36, v37, v38
    v_max_u32 v46, v46, v39
    v_cmp_eq_u32 vcc, -1, v46
    s_cbranch_vccz fk_goty
    s_cmp_le_u32 s42, 0x40000
    s_cbranch_scc1 fk_polly
    s_nop 1
fk_goty:
    v_pk_add_f16 v36, v36, v47
    v_pk_add_f16 v37, v37, v47
    v_pk_add_f16 v38, v38, v47
    v_pk_add_f16 v39, v39, v47
    ds_write_b16 v9, v36 offset:0
    ds_write_b16_d16_hi v10, v36 offset:0
    ds_write_b16 v9, v37 offset:2064
    ds_write_b16_d16_hi v10, v37 offset:2064
    ds_write_b16 v9, v38 offset:4128
    ds_write_b16_d16_hi v10, v38 offset:4128
    ds_write_b16 v9, v39 offset:6192
    ds_write_b16_d16_hi v10, v39 offset:6192
    s_cmp_gt_u32 s3, 223
    s_cbranch_scc1 fk_wsc
    s_mul_i32 s15, s16, 4
    s_add_u32 s15, s15, 0
    s_lshl_b32 s12, s15, 10
    s_add_u32 s12, s12, 32768
    s_mul_i32 s13, s15, 57344
    s_add_u32 s13, s13, s100
    v_xor_b32 v209, 64, v208
    s_mov_b32 m0, s12
    s_nop 0
    buffer_load_dwordx4 v208, s[48:51], s13 offen lds
    s_add_u32 s12, s12, 1024
    s_add_u32 s13, s13, 57344
    s_mov_b32 m0, s12
    s_nop 0
    buffer_load_dwordx4 v209, s[48:51], s13 offen lds
    s_add_u32 s12, s12, 1024
    s_add_u32 s13, s13, 57344
    s_mov_b32 m0, s12
    s_nop 0
    buffer_load_dwordx4 v208, s[48:51], s13 offen lds
    s_add_u32 s12, s12, 1024
    s_add_u32 s13, s13, 57344
    s_mov_b32 m0, s12
    s_nop 0
    buffer_load_dwordx4 v209, s[48:51], s13 offen lds
fk_wsc:
    v_mov_b32 v2, 0
    v_mov_b32 v3, 0
    v_mov_b32 v4, 0
    v_mov_b32 v7, 0
    v_mov_b32 v12, 157120
    s_waitcnt lgkmcnt(0)
    s_barrier
    ds_read_b128 v[36:39], v5
    ds_read_b128 v[40:43], v11
    ds_read_b32 v44, v6
    s_waitcnt lgkmcnt(2)
    v_fma_mix_f32 v48, v36, s38, v48 op_sel:[0,0,0] op_sel_hi:[1,0,0]
    v_fma_mix_f32 v49, v36, s38, v49 op_sel:[1,0,0] op_sel_hi:[1,0,0]
    v_fma_mix_f32 v50, v37, s38, v50 op_sel:[0,0,0] op_sel_hi:[1,0,0]
    v_fma_mix_f32 v51, v37, s38, v51 op_sel:[1,0,0] op_sel_hi:[1,0,0]
    v_fma_mix_f32 v52, v38, s38, v52 op_sel:[0,0,0] op_sel_hi:[1,0,0]
    v_fma_mix_f32 v53, v38, s38, v53 op_sel:[1,0,0] op_sel_hi:[1,0,0]
    v_fma_mix_f32 v54, v39, s38, v54 op_sel:[0,0,0] op_sel_hi:[1,0,0]
    v_fma_mix_f32 v55, v39, s38, v55 op_sel:[1,0,0] op_sel_hi:[1,0,0]
    s_waitcnt lgkmcnt(0)
    v_readfirstlane_b32 s13, v44
    v_mov_b32_dpp v8, v40 wave_shr:1 row_mask:0xf bank_mask:0xf
    v_fma_mix_f32 v57, v43, s38, v57 op_sel:[1,0,0] op_sel_hi:[1,0,0]
    v_fma_mix_f32 v58, v43, s38, v58 op_sel:[0,0,0] op_sel_hi:[1,0,0]
    v_fma_mix_f32 v59, v42, s38, v59 op_sel:[1,0,0] op_sel_hi:[1,0,0]
    v_fma_mix_f32 v60, v42, s38, v60 op_sel:[0,0,0] op_sel_hi:[1,0,0]
    v_writelane_b32 v8, s13, 0
    v_fma_mix_f32 v61, v41, s38, v61 op_sel:[1,0,0] op_sel_hi:[1,0,0]
    v_fma_mix_f32 v62, v41, s38, v62 op_sel:[0,0,0] op_sel_hi:[1,0,0]
    v_fma_mix_f32 v63, v40, s38, v63 op_sel:[1,0,0] op_sel_hi:[1,0,0]
    v_fma_mix_f32 v56, v8, s38, v56 op_sel:[0,0,0] op_sel_hi:[1,0,0]
    v_cvt_pk_bf16_f32 v80, v48, v49
    v_cvt_pk_bf16_f32 v81, v50, v51
    v_cvt_pk_bf16_f32 v82, v52, v53
    v_cvt_pk_bf16_f32 v83, v54, v55
    v_cvt_pk_bf16_f32 v85, v58, v59
    v_cvt_pk_bf16_f32 v86, v60, v61
    v_cvt_pk_bf16_f32 v87, v62, v63
    v_cvt_pk_bf16_f32 v84, v56, v57
    v_dot2c_f32_bf16 v2, s37, v80
    v_dot2c_f32_bf16 v3, v80, v80
    v_dot2c_f32_bf16 v4, v80, v28
    v_dot2c_f32_bf16 v2, s37, v81
    v_dot2c_f32_bf16 v3, v81, v81
    v_dot2c_f32_bf16 v4, v81, v29
    v_dot2c_f32_bf16 v2, s37, v82
    v_dot2c_f32_bf16 v3, v82, v82
    v_dot2c_f32_bf16 v4, v82, v30
    v_dot2c_f32_bf16 v2, s37, v83
    v_dot2c_f32_bf16 v3, v83, v83
    v_dot2c_f32_bf16 v4, v83, v31
    v_dot2c_f32_bf16 v2, s37, v85
    v_dot2c_f32_bf16 v3, v85, v85
    v_dot2c_f32_bf16 v4, v85, v33
    v_dot2c_f32_bf16 v2, s37, v86
    v_dot2c_f32_bf16 v3, v86, v86
    v_dot2c_f32_bf16 v4, v86, v34
    v_dot2c_f32_bf16 v2, s37, v87
    v_dot2c_f32_bf16 v3, v87, v87
    v_dot2c_f32_bf16 v4, v87, v35
    v_dot2c_f32_bf16 v2, s37, v84
    v_dot2c_f32_bf16 v3, v84, v84
    v_dot2c_f32_bf16 v4, v84, v32
    s_nop 2
    v_permlane32_swap_b32 v2, v4
    v_permlane32_swap_b32 v3, v7
    v_add_f32 v2, v2, v4
    v_add_f32 v3, v3, v7
    s_nop 1
    v_permlane16_swap_b32 v2, v3
    v_add_f32 v2, v2, v3
    s_nop 1
    v_add_f32_dpp v2, v2, v2 quad_perm:[1,0,3,2] row_mask:0xf bank_mask:0xf
    s_nop 1
    v_add_f32_dpp v2, v2, v2 quad_perm:[2,3,0,1] row_mask:0xf bank_mask:0xf
    s_nop 1
    v_add_f32_dpp v2, v2, v2 row_half_mirror row_mask:0xf bank_mask:0xf
    s_nop 1
    v_add_f32_dpp v2, v2, v2 row_mirror row_mask:0xf bank_mask:0xf
    s_nop 0
    v_readlane_b32 s13, v2, 32
    v_mov_b32_dpp v8, v2 row_bcast:15 row_mask:0xa bank_mask:0xf
    v_mul_f32 v9, 0x3a800000, v2
    v_mul_f32 v8, 0x3a800000, v8
    v_fma_f32 v9, -v8, v8, v9
    v_max_f32 v9, 0, v9
    v_cvt_pk_bf16_f32 v9, 0, v9
    v_cvt_pk_bf16_f32 v8, 0, v8
    v_add_f32 v9, 0x3727c5ac, v9
    v_cvt_pk_bf16_f32 v9, 0, v9
    v_sqrt_f32 v9, v9
    s_nop 0
    v_cvt_pk_bf16_f32 v9, 0, v9
    v_rcp_f32 v9, v9
    v_mov_b32 v10, s13
    v_fma_f32 v10, -v8, s39, v10
    v_mul_f32 v10, v10, v9
    v_mul_f32 v8, v8, v9
    v_readlane_b32 s43, v10, 16
    v_readlane_b32 s4, v9, 16
    v_readlane_b32 s6, v8, 16
    s_ashr_i32 s13, s43, 31
    s_or_b32 s13, s13, 0x80000000
    s_xor_b32 s43, s43, s13
    s_and_b32 s43, s43, 0xfffff800
    s_or_b32 s43, s43, s19
    s_min_u32 s43, s43, -2
    v_mov_b32 v2, s43
    s_mov_b64 exec, 1
    ds_max_u32 v12, v2
    s_mov_b64 exec, -1
    v_mov_b32 v10, s6
    v_add_f32 v8, 1.0, v9
    v_lshlrev_b32 v4, 12, v15
    s_lshl_b32 s17, s3, 4
    s_add_u32 s17, s17, 0x9000
    v_readlane_b32 s14, v8, 16
    s_waitcnt lgkmcnt(0)
    s_barrier
    ds_read_b32 v3, v12
    v_lshlrev_b32 v48, 16, v80
    v_and_b32 v49, s36, v80
    v_lshlrev_b32 v50, 16, v81
    v_and_b32 v51, s36, v81
    v_lshlrev_b32 v52, 16, v82
    v_and_b32 v53, s36, v82
    v_lshlrev_b32 v54, 16, v83
    v_and_b32 v55, s36, v83
    v_lshlrev_b32 v56, 16, v84
    v_and_b32 v57, s36, v84
    v_lshlrev_b32 v58, 16, v85
    v_and_b32 v59, s36, v85
    v_lshlrev_b32 v60, 16, v86
    v_and_b32 v61, s36, v86
    v_lshlrev_b32 v62, 16, v87
    v_and_b32 v63, s36, v87
    s_waitcnt lgkmcnt(0)
    v_readfirstlane_b32 s13, v3
    s_nop 1
    s_cmp_lg_u32 s13, s43
    s_cbranch_scc1 fk_other
    s_mov_b64 exec, 0xff
    buffer_store_dword v2, v4, s[24:27], s17 offen sc1
    s_mov_b64 exec, -1
    v_pk_fma_f32 v[64:65], v[48:49], s[4:5], v[10:11] op_sel_hi:[1,0,0] neg_lo:[0,0,1] neg_hi:[0,0,1]
    v_pk_fma_f32 v[66:67], v[50:51], s[4:5], v[10:11] op_sel_hi:[1,0,0] neg_lo:[0,0,1] neg_hi:[0,0,1]
    v_pk_fma_f32 v[68:69], v[52:53], s[4:5], v[10:11] op_sel_hi:[1,0,0] neg_lo:[0,0,1] neg_hi:[0,0,1]
    v_pk_fma_f32 v[70:71], v[54:55], s[4:5], v[10:11] op_sel_hi:[1,0,0] neg_lo:[0,0,1] neg_hi:[0,0,1]
    v_pk_fma_f32 v[72:73], v[56:57], s[4:5], v[10:11] op_sel_hi:[1,0,0] neg_lo:[0,0,1] neg_hi:[0,0,1]
    v_pk_fma_f32 v[74:75], v[58:59], s[4:5], v[10:11] op_sel_hi:[1,0,0] neg_lo:[0,0,1] neg_hi:[0,0,1]
    v_pk_fma_f32 v[76:77], v[60:61], s[4:5], v[10:11] op_sel_hi:[1,0,0] neg_lo:[0,0,1] neg_hi:[0,0,1]
    v_pk_fma_f32 v[78:79], v[62:63], s[4:5], v[10:11] op_sel_hi:[1,0,0] neg_lo:[0,0,1] neg_hi:[0,0,1]
    v_cvt_pk_bf16_f32 v96, v64, v65
    v_cvt_pk_bf16_f32 v97, v66, v67
    v_cvt_pk_bf16_f32 v98, v68, v69
    v_cvt_pk_bf16_f32 v99, v70, v71
    v_cvt_pk_bf16_f32 v100, v72, v73
    v_cvt_pk_bf16_f32 v101, v74, v75
    v_cvt_pk_bf16_f32 v102, v76, v77
    v_cvt_pk_bf16_f32 v103, v78, v79
    v_and_b32 v96, -2, v96
    v_and_b32 v97, -2, v97
    v_and_b32 v98, -2, v98
    v_and_b32 v99, -2, v99
    v_and_b32 v100, -2, v100
    v_and_b32 v101, -2, v101
    v_and_b32 v102, -2, v102
    v_and_b32 v103, -2, v103
    s_mul_i32 s13, s3, 9344
    s_add_u32 s13, s13, 0x20000
    buffer_store_dwordx4 v[96:99], v14, s[24:27], s13 offen sc1
    buffer_store_dwordx4 v[100:103], v14, s[24:27], s13 offen offset:1024 sc1
    v_and_b32 v80, -2, v80
    v_and_b32 v81, -2, v81
    v_and_b32 v82, -2, v82
    v_and_b32 v83, -2, v83
    v_and_b32 v84, -2, v84
    v_and_b32 v85, -2, v85
    v_and_b32 v86, -2, v86
    v_and_b32 v87, -2, v87
    buffer_store_dwordx4 v[80:83], v14, s[24:27], s13 offen offset:2048 sc1
    buffer_store_dwordx4 v[84:87], v14, s[24:27], s13 offen offset:3072 sc1
    v_pk_fma_f32 v[64:65], v[48:49], s[14:15], v[10:11] op_sel_hi:[1,0,0] neg_lo:[0,0,1] neg_hi:[0,0,1]
    v_pk_fma_f32 v[66:67], v[50:51], s[14:15], v[10:11] op_sel_hi:[1,0,0] neg_lo:[0,0,1] neg_hi:[0,0,1]
    v_pk_fma_f32 v[68:69], v[52:53], s[14:15], v[10:11] op_sel_hi:[1,0,0] neg_lo:[0,0,1] neg_hi:[0,0,1]
    v_pk_fma_f32 v[70:71], v[54:55], s[14:15], v[10:11] op_sel_hi:[1,0,0] neg_lo:[0,0,1] neg_hi:[0,0,1]
    v_pk_fma_f32 v[72:73], v[56:57], s[14:15], v[10:11] op_sel_hi:[1,0,0] neg_lo:[0,0,1] neg_hi:[0,0,1]
    v_pk_fma_f32 v[74:75], v[58:59], s[14:15], v[10:11] op_sel_hi:[1,0,0] neg_lo:[0,0,1] neg_hi:[0,0,1]
    v_pk_fma_f32 v[76:77], v[60:61], s[14:15], v[10:11] op_sel_hi:[1,0,0] neg_lo:[0,0,1] neg_hi:[0,0,1]
    v_pk_fma_f32 v[78:79], v[62:63], s[14:15], v[10:11] op_sel_hi:[1,0,0] neg_lo:[0,0,1] neg_hi:[0,0,1]
    v_cvt_pk_bf16_f32 v112, v64, v65
    v_cvt_pk_bf16_f32 v113, v66, v67
    v_cvt_pk_bf16_f32 v114, v68, v69
    v_cvt_pk_bf16_f32 v115, v70, v71
    v_cvt_pk_bf16_f32 v116, v72, v73
    v_cvt_pk_bf16_f32 v117, v74, v75
    v_cvt_pk_bf16_f32 v118, v76, v77
    v_cvt_pk_bf16_f32 v119, v78, v79
    v_lshrrev_b32 v1, 4, v15
    v_bfe_u32 v2, v15, 2, 2
    v_lshl_add_u32 v8, v1, 3, v2
    v_lshlrev_b32 v8, 7, v8
    v_and_b32 v3, 2, v2
    v_xor_b32 v9, s16, v3
    v_and_b32 v3, 1, v1
    v_lshlrev_b32 v4, 2, v3
    v_xor_b32 v9, v4, v9
    v_lshl_add_u32 v8, v9, 4, v8
    v_and_b32 v9, 1, v15
    v_lshl_add_u32 v8, v9, 3, v8
    v_bfe_u32 v9, v15, 1, 1
    v_lshl_add_u32 v8, v9, 15, v8
    v_lshrrev_b32 v7, 1, v1
    v_lshl_add_u32 v7, v7, 3, v2
    v_lshlrev_b32 v7, 9, v7
    v_lshl_add_u32 v7, v3, 5, v7
    v_and_b32 v3, 3, v15
    v_lshl_add_u32 v7, v3, 3, v7
    s_lshl_b32 s15, s16, 6
    s_add_u32 s15, s15, 65536
    v_add_u32 v7, s15, v7
    v_lshlrev_b32 v9, 4, v1
    v_add_u32 v9, 157312, v9
    s_and_b32 s13, s2, 7
    s_lshl_b32 s13, s13, 12
    s_add_u32 s13, s13, 0x9000
    s_mov_b32 s42, 0
    s_waitcnt vmcnt(4)
    v_mov_b32 v1, 157872
    v_mov_b32 v2, 1
    s_mov_b64 exec, 1
    ds_add_u32 v1, v2
    s_mov_b64 exec, -1
    s_sleep 4
    s_nop 0
fk_pollk:
    buffer_load_dword v180, v14, s[24:27], s13 offen offset:0 sc1
    buffer_load_dword v181, v14, s[24:27], s13 offen offset:1024 sc1
    buffer_load_dword v182, v14, s[24:27], s13 offen offset:2048 sc1
    buffer_load_dword v183, v14, s[24:27], s13 offen offset:3072 sc1
    s_add_u32 s42, s42, 1
    s_waitcnt vmcnt(0)
    v_max3_u32 v3, v180, v181, v182
    v_max_u32 v3, v3, v183
    v_cmp_eq_u32 vcc, -1, v3
    s_cbranch_vccz fk_gotk
    s_cmp_le_u32 s42, 0x40000
    s_cbranch_scc1 fk_pollk
    s_nop 1
fk_gotk:
    v_max_u32_dpp v3, v3, v3 quad_perm:[1,0,3,2] row_mask:0xf bank_mask:0xf
    s_nop 1
    v_max_u32_dpp v3, v3, v3 quad_perm:[2,3,0,1] row_mask:0xf bank_mask:0xf
    s_nop 1
    v_max_u32_dpp v3, v3, v3 row_half_mirror row_mask:0xf bank_mask:0xf
    s_nop 1
    v_max_u32_dpp v3, v3, v3 row_mirror row_mask:0xf bank_mask:0xf
    s_nop 1
    v_max_u32_dpp v3, v3, v3 row_bcast:15 row_mask:0xa bank_mask:0xf
    s_nop 1
    v_max_u32_dpp v3, v3, v3 row_bcast:31 row_mask:0xc bank_mask:0xf
    s_nop 0
    v_readlane_b32 s40, v3, 63
    v_mov_b32 v4, 157136
    s_nop 0
    s_bfe_u32 s13, s40, 0x80003
    s_mul_i32 s13, s13, 9344
    s_and_b32 s14, s3, 3
    s_lshl_b32 s14, s14, 9
    s_add_u32 s13, s13, s14
    s_add_u32 s13, s13, 0x20000
    v_lshlrev_b32 v5, 3, v15
    v_mov_b32 v3, s40
    s_cmp_gt_u32 s3, 223
    s_cbranch_scc1 fk_norow
    s_mov_b32 s42, 0
    buffer_load_dwordx2 v[180:181], v5, s[24:27], s13 offen sc1
    s_nop 0
fk_landa:
    ds_read_b32 v2, v1
    s_waitcnt lgkmcnt(0)
    v_readfirstlane_b32 s15, v2
    s_nop 1
    s_cmp_lt_u32 s15, 8
    s_cbranch_scc1 fk_landa
    ds_read_b64_tr_b16 v[128:129], v8 offset:0
    ds_read_b64_tr_b16 v[130:131], v8 offset:512
    ds_read_b64_tr_b16 v[132:133], v8 offset:4096
    ds_read_b64_tr_b16 v[134:135], v8 offset:4608
    ds_read_b64_tr_b16 v[136:137], v8 offset:8192
    ds_read_b64_tr_b16 v[138:139], v8 offset:8704
    ds_read_b64_tr_b16 v[140:141], v8 offset:12288
    ds_read_b64_tr_b16 v[142:143], v8 offset:12800
    ds_read_b64_tr_b16 v[144:145], v8 offset:16384
    ds_read_b64_tr_b16 v[146:147], v8 offset:16896
    ds_read_b64_tr_b16 v[148:149], v8 offset:20480
    ds_read_b64_tr_b16 v[150:151], v8 offset:20992
    s_waitcnt lgkmcnt(4)
    ds_read_b64_tr_b16 v[152:153], v8 offset:24576
    ds_read_b64_tr_b16 v[154:155], v8 offset:25088
    ds_read_b64_tr_b16 v[156:157], v8 offset:28672
    ds_read_b64_tr_b16 v[158:159], v8 offset:29184
    s_branch fk_chkr
    s_nop 0
fk_pollr:
    buffer_load_dwordx2 v[180:181], v5, s[24:27], s13 offen sc1
fk_chkr:
    s_waitcnt vmcnt(0)
    v_or_b32 v6, v180, v181
    v_and_b32 v6, 1, v6
    v_cmp_eq_u32 vcc, 1, v6
    s_add_u32 s42, s42, 1
    s_cbranch_vccz fk_gotr
    s_cmp_le_u32 s42, 0x40000
    s_cbranch_scc1 fk_pollr
    s_nop 0
fk_gotr:
    v_add_u32 v5, 157312, v5
    ds_write_b64 v5, v[180:181]
    s_nop 3
fk_norow:
    ds_write_b32 v4, v3
    s_waitcnt lgkmcnt(0)
    s_barrier
    s_cmp_eq_u32 s40, s43
    s_cselect_b32 s22, 0x400000, s22
    s_branch fk_ffn
    s_nop 0
fk_other:
    v_pk_fma_f32 v[64:65], v[48:49], s[14:15], v[10:11] op_sel_hi:[1,0,0] neg_lo:[0,0,1] neg_hi:[0,0,1]
    v_pk_fma_f32 v[66:67], v[50:51], s[14:15], v[10:11] op_sel_hi:[1,0,0] neg_lo:[0,0,1] neg_hi:[0,0,1]
    v_pk_fma_f32 v[68:69], v[52:53], s[14:15], v[10:11] op_sel_hi:[1,0,0] neg_lo:[0,0,1] neg_hi:[0,0,1]
    v_pk_fma_f32 v[70:71], v[54:55], s[14:15], v[10:11] op_sel_hi:[1,0,0] neg_lo:[0,0,1] neg_hi:[0,0,1]
    v_pk_fma_f32 v[72:73], v[56:57], s[14:15], v[10:11] op_sel_hi:[1,0,0] neg_lo:[0,0,1] neg_hi:[0,0,1]
    v_pk_fma_f32 v[74:75], v[58:59], s[14:15], v[10:11] op_sel_hi:[1,0,0] neg_lo:[0,0,1] neg_hi:[0,0,1]
    v_pk_fma_f32 v[76:77], v[60:61], s[14:15], v[10:11] op_sel_hi:[1,0,0] neg_lo:[0,0,1] neg_hi:[0,0,1]
    v_pk_fma_f32 v[78:79], v[62:63], s[14:15], v[10:11] op_sel_hi:[1,0,0] neg_lo:[0,0,1] neg_hi:[0,0,1]
    v_cvt_pk_bf16_f32 v112, v64, v65
    v_cvt_pk_bf16_f32 v113, v66, v67
    v_cvt_pk_bf16_f32 v114, v68, v69
    v_cvt_pk_bf16_f32 v115, v70, v71
    v_cvt_pk_bf16_f32 v116, v72, v73
    v_cvt_pk_bf16_f32 v117, v74, v75
    v_cvt_pk_bf16_f32 v118, v76, v77
    v_cvt_pk_bf16_f32 v119, v78, v79
    s_and_b32 s13, s13, 7
    s_cmp_gt_u32 s16, s13
    s_cselect_b32 s13, 1, 0
    s_sub_u32 s17, s16, s13
    s_waitcnt vmcnt(0)
    v_lshrrev_b32 v1, 4, v15
    v_bfe_u32 v2, v15, 2, 2
    v_lshl_add_u32 v8, v1, 3, v2
    v_lshlrev_b32 v8, 7, v8
    v_and_b32 v3, 2, v2
    v_xor_b32 v9, s16, v3
    v_and_b32 v3, 1, v1
    v_lshlrev_b32 v4, 2, v3
    v_xor_b32 v9, v4, v9
    v_lshl_add_u32 v8, v9, 4, v8
    v_and_b32 v9, 1, v15
    v_lshl_add_u32 v8, v9, 3, v8
    v_bfe_u32 v9, v15, 1, 1
    v_lshl_add_u32 v8, v9, 15, v8
    v_lshrrev_b32 v7, 1, v1
    v_lshl_add_u32 v7, v7, 3, v2
    v_lshlrev_b32 v7, 9, v7
    v_lshl_add_u32 v7, v3, 5, v7
    v_and_b32 v3, 3, v15
    v_lshl_add_u32 v7, v3, 3, v7
    s_lshl_b32 s15, s16, 6
    s_add_u32 s15, s15, 65536
    v_add_u32 v7, s15, v7
    v_lshlrev_b32 v9, 4, v1
    v_add_u32 v9, 157312, v9
    v_mov_b32 v1, 157872
    v_mov_b32 v2, 1
    s_mov_b64 exec, 1
    ds_add_u32 v1, v2
    s_mov_b64 exec, -1
    s_cmp_gt_u32 s3, 223
    s_cbranch_scc1 fk_wsd
    s_mul_i32 s15, s17, 4
    s_add_u32 s15, s15, 8
    s_lshl_b32 s12, s15, 10
    s_add_u32 s12, s12, 65536
    s_mul_i32 s13, s15, 4096
    s_add_u32 s13, s13, s101
    s_mov_b32 m0, s12
    s_cmp_gt_u32 s12, 97280
    s_cbranch_scc1 fk_wsd
    buffer_load_dwordx4 v210, s[52:55], s13 offen lds
    s_add_u32 s12, s12, 1024
    s_add_u32 s13, s13, 4096
    s_mov_b32 m0, s12
    s_cmp_gt_u32 s12, 97280
    s_cbranch_scc1 fk_wsd
    buffer_load_dwordx4 v210, s[52:55], s13 offen lds
    s_add_u32 s12, s12, 1024
    s_add_u32 s13, s13, 4096
    s_mov_b32 m0, s12
    s_cmp_gt_u32 s12, 97280
    s_cbranch_scc1 fk_wsd
    buffer_load_dwordx4 v210, s[52:55], s13 offen lds
    s_add_u32 s12, s12, 1024
    s_add_u32 s13, s13, 4096
    s_mov_b32 m0, s12
    s_cmp_gt_u32 s12, 97280
    s_cbranch_scc1 fk_wsd
    buffer_load_dwordx4 v210, s[52:55], s13 offen lds
fk_wsd:
fk_landb:
    ds_read_b32 v2, v1
    s_waitcnt lgkmcnt(0)
    v_readfirstlane_b32 s15, v2
    s_nop 1
    s_cmp_lt_u32 s15, 8
    s_cbranch_scc1 fk_landb
    ds_read_b64_tr_b16 v[128:129], v8 offset:0
    ds_read_b64_tr_b16 v[130:131], v8 offset:512
    ds_read_b64_tr_b16 v[132:133], v8 offset:4096
    ds_read_b64_tr_b16 v[134:135], v8 offset:4608
    ds_read_b64_tr_b16 v[136:137], v8 offset:8192
    ds_read_b64_tr_b16 v[138:139], v8 offset:8704
    ds_read_b64_tr_b16 v[140:141], v8 offset:12288
    ds_read_b64_tr_b16 v[142:143], v8 offset:12800
    ds_read_b64_tr_b16 v[144:145], v8 offset:16384
    ds_read_b64_tr_b16 v[146:147], v8 offset:16896
    ds_read_b64_tr_b16 v[148:149], v8 offset:20480
    ds_read_b64_tr_b16 v[150:151], v8 offset:20992
    s_waitcnt lgkmcnt(4)
    ds_read_b64_tr_b16 v[152:153], v8 offset:24576
    ds_read_b64_tr_b16 v[154:155], v8 offset:25088
    ds_read_b64_tr_b16 v[156:157], v8 offset:28672
    ds_read_b64_tr_b16 v[158:159], v8 offset:29184
    s_waitcnt vmcnt(0) lgkmcnt(0)
    s_barrier
    s_nop 0
fk_ffn:
    buffer_store_dwordx4 v[112:115], v14, s[28:31], s22 offen nt
    buffer_store_dwordx4 v[116:119], v14, s[28:31], s22 offen offset:1024 nt
    s_cmp_gt_u32 s3, 223
    s_cbranch_scc1 fk_fin
    ds_read_b128 v[16:19], v9 offset:0
    ds_read_b128 v[20:23], v9 offset:64
    ds_read_b128 v[24:27], v9 offset:128
    ds_read_b128 v[28:31], v9 offset:192
    ds_read_b128 v[32:35], v9 offset:256
    ds_read_b128 v[36:39], v9 offset:320
    ds_read_b128 v[40:43], v9 offset:384
    ds_read_b128 v[44:47], v9 offset:448
    v_mov_b32 v3, 157136
    ds_read_b32 v12, v3
    v_lshlrev_b32 v4, 3, v15
    s_mul_i32 s41, s3, 9344
    s_lshl_b32 s14, s16, 6
    s_add_u32 s13, s41, s14
    s_add_u32 s13, s13, 0x21000
    s_waitcnt lgkmcnt(8)
    v_mfma_f32_16x16x32_bf16 v[176:179], v[16:19], v[128:131], 0
    s_waitcnt lgkmcnt(7)
    v_mfma_f32_16x16x32_bf16 v[176:179], v[20:23], v[132:135], v[176:179]
    s_waitcnt lgkmcnt(6)
    v_mfma_f32_16x16x32_bf16 v[176:179], v[24:27], v[136:139], v[176:179]
    s_waitcnt lgkmcnt(5)
    v_mfma_f32_16x16x32_bf16 v[176:179], v[28:31], v[140:143], v[176:179]
    s_waitcnt lgkmcnt(4)
    v_mfma_f32_16x16x32_bf16 v[176:179], v[32:35], v[144:147], v[176:179]
    s_waitcnt lgkmcnt(3)
    v_mfma_f32_16x16x32_bf16 v[176:179], v[36:39], v[148:151], v[176:179]
    s_waitcnt lgkmcnt(2)
    v_mfma_f32_16x16x32_bf16 v[176:179], v[40:43], v[152:155], v[176:179]
    s_waitcnt lgkmcnt(1)
    v_mfma_f32_16x16x32_bf16 v[176:179], v[44:47], v[156:159], v[176:179]
    v_lshlrev_b32 v5, 3, v15
    v_lshlrev_b32 v6, 2, v15
    v_lshrrev_b32 v9, 5, v15
    v_lshlrev_b32 v9, 4, v9
    v_add_u32 v9, 157184, v9
    s_lshl_b32 s14, s16, 7
    s_add_u32 s41, s41, s14
    s_add_u32 s41, s41, 0x21400
    v_and_b32 v176, -2, v176
    s_nop 1
    v_mov_b32_dpp v177, v176 row_shl:8 row_mask:0xf bank_mask:0xf
    v_mov_b32_dpp v178, v176 row_shl:1 row_mask:0xf bank_mask:0xf
    v_mov_b32_dpp v179, v176 row_shl:9 row_mask:0xf bank_mask:0xf
    s_mov_b64 exec, 0x55
    buffer_store_dwordx4 v[176:179], v4, s[24:27], s13 offen sc1
    s_mov_b64 exec, -1
    v_mov_b32 v1, 157876
    v_mov_b32 v8, 1
    ds_read_b64_tr_b16 v[160:161], v7 offset:0
    ds_read_b64_tr_b16 v[162:163], v7 offset:2048
    ds_read_b64_tr_b16 v[164:165], v7 offset:8192
    ds_read_b64_tr_b16 v[166:167], v7 offset:10240
    ds_read_b64_tr_b16 v[168:169], v7 offset:16384
    ds_read_b64_tr_b16 v[170:171], v7 offset:18432
    ds_read_b64_tr_b16 v[172:173], v7 offset:24576
    ds_read_b64_tr_b16 v[174:175], v7 offset:26624
    s_cmp_eq_u32 s16, 7
    s_cbranch_scc1 fk_c1
    s_cmp_lg_u32 s16, 0
    s_cbranch_scc1 fk_wait1
    s_and_b32 s13, s3, -4
    s_mul_i32 s13, s13, 9344
    s_add_u32 s36, s13, 0x21000
    s_add_u32 s37, s36, 9344
    s_add_u32 s38, s36, 18688
    s_add_u32 s39, s36, 28032
    s_mov_b32 s42, 0
    v_lshrrev_b32 v10, 2, v5
    v_add_u32 v10, 157184, v10
    s_waitcnt vmcnt(0)
    s_nop 3
fk_poll1:
    buffer_load_dwordx2 v[184:185], v5, s[24:27], s36 offen sc1
    buffer_load_dwordx2 v[186:187], v5, s[24:27], s37 offen sc1
    buffer_load_dwordx2 v[188:189], v5, s[24:27], s38 offen sc1
    buffer_load_dwordx2 v[190:191], v5, s[24:27], s39 offen sc1
    s_waitcnt vmcnt(0)
    v_or3_b32 v11, v184, v185, v186
    v_or3_b32 v11, v11, v187, v188
    v_or3_b32 v11, v11, v189, v190
    v_or_b32 v11, v11, v191
    v_and_b32 v11, 1, v11
    v_cmp_eq_u32 vcc, 1, v11
    s_add_u32 s42, s42, 1
    s_cbranch_vccz fk_got1
    s_cmp_le_u32 s42, 0x40000
    s_cbranch_scc1 fk_poll1
    s_nop 0
fk_got1:
    v_pk_add_f32 v[184:185], v[184:185], v[186:187]
    v_pk_add_f32 v[188:189], v[188:189], v[190:191]
    v_pk_add_f32 v[184:185], v[184:185], v[188:189]
    v_cvt_pk_bf16_f32 v184, 0, v184
    v_cvt_pk_bf16_f32 v185, 0, v185
    v_mul_f32 v186, 0xbfb8aa3b, v184
    v_exp_f32 v186, v186
    s_nop 0
    v_add_f32 v186, 1.0, v186
    v_rcp_f32 v186, v186
    s_nop 0
    v_mul_f32 v184, v184, v186
    v_cvt_pk_bf16_f32 v184, 0, v184
    v_mul_f32 v184, v184, v185
    v_cvt_pk_bf16_f32 v184, 0, v184
    ds_write_b16_d16_hi v10, v184
    s_branch fk_wait1
    s_nop 2
fk_c1:
    s_cmp_gt_u32 s3, 127
    s_cbranch_scc1 fk_wait1
    s_waitcnt lgkmcnt(0)
    v_readfirstlane_b32 s40, v12
    v_lshrrev_b32 v10, 4, v15
    v_and_b32 v11, 1, v15
    v_lshl_add_u32 v12, v11, 2, v10
    v_lshlrev_b32 v12, 1, v12
    v_and_b32 v11, 12, v12
    v_and_b32 v10, 1, v10
    s_bfe_u32 s13, s40, 0x80003
    s_mul_i32 s14, s13, 9344
    s_lshl_b32 s15, s3, 4
    s_add_u32 s14, s14, s15
    s_add_u32 s14, s14, 0x20000
    s_mov_b32 s42, 0
    s_nop 0
fk_pollh:
    buffer_load_dword v2, v11, s[24:27], s14 offen sc1
    buffer_load_dword v3, v11, s[24:27], s14 offen offset:2048 sc1
    s_waitcnt vmcnt(0)
    v_or_b32 v4, v2, v3
    v_and_b32 v4, 1, v4
    v_cmp_eq_u32 vcc, 1, v4
    s_add_u32 s42, s42, 1
    s_cbranch_vccz fk_goth
    s_cmp_le_u32 s42, 0x40000
    s_cbranch_scc1 fk_pollh
    s_nop 0
fk_goth:
    v_cmp_eq_u32 vcc, 1, v10
    v_lshlrev_b32 v4, 16, v2
    v_and_b32 v2, s36, v2
    v_cndmask_b32 v2, v4, v2, vcc
    v_lshlrev_b32 v4, 16, v3
    v_and_b32 v3, s36, v3
    v_cndmask_b32 v3, v4, v3, vcc
    s_lshr_b32 s14, s13, 4
    s_add_u32 s14, s14, 1
    s_cmp_ge_u32 s13, 248
    s_cselect_b32 s14, 0, s14
    s_cmp_ge_u32 s13, 240
    s_cselect_b32 s15, 7, 15
    s_and_b32 s15, s15, s13
    s_lshl_b32 s15, s15, 7
    s_add_u32 s14, s14, s15
    s_and_b32 s13, s40, 7
    s_sub_u32 s15, 7, s13
    s_min_u32 s15, s15, s13
    s_lshl_b32 s15, s15, 5
    s_add_u32 s14, s14, s15
    s_sub_u32 s15, 2048, s14
    s_and_b32 s15, s15, 2047
    s_cmp_lt_u32 s13, 4
    s_cselect_b32 s14, s14, s15
    s_and_b32 s13, s40, 0x7ff
    s_cmp_eq_u32 s13, 1991
    s_cselect_b32 s14, 1024, s14
    s_lshl_b32 s21, s14, 11
    s_lshl_b32 s15, s3, 4
    s_add_u32 s21, s21, s15
    s_ashr_i32 s13, s40, 31
    s_not_b32 s13, s13
    s_or_b32 s13, s13, 0x80000000
    s_xor_b32 s13, s40, s13
    s_and_b32 s13, s13, 0xfffff800
    v_mov_b32 v11, s13
    v_cvt_pk_bf16_f32 v11, 0, v11
    v_mul_f32 v11, 0xbfb8aa3b, v11
    v_exp_f32 v11, v11
    s_nop 0
    v_add_f32 v11, 1.0, v11
    v_rcp_f32 v11, v11
    s_nop 0
    v_cvt_pk_bf16_f32 v11, 0, v11
    v_lshrrev_b32 v4, 1, v15
    v_mul_u32_u24 v4, 37376, v4
    v_and_b32 v5, 1, v15
    v_lshl_add_u32 v4, v5, 4, v4
    v_add_u32 v5, 1196032, v4
    v_cmp_gt_u32 vcc, 48, v15
    s_nop 1
    v_cndmask_b32 v5, -16, v5, vcc
    s_lshr_b32 s40, s3, 5
    s_mul_i32 s40, s40, 9344
    s_and_b32 s15, s3, 31
    s_lshl_b32 s15, s15, 5
    s_add_u32 s40, s40, s15
    s_add_u32 s40, s40, 0x21400
    s_nop 0
fk_wait1:
    s_waitcnt lgkmcnt(0)
    s_barrier
    ds_read_b128 v[16:19], v9 offset:0
    ds_read_b128 v[20:23], v9 offset:32
    ds_read_b128 v[24:27], v9 offset:64
    ds_read_b128 v[28:31], v9 offset:96
    s_waitcnt lgkmcnt(3)
    v_mfma_f32_32x32x16_bf16 v[192:207], v[16:19], v[160:163], 0
    s_waitcnt lgkmcnt(2)
    v_mfma_f32_32x32x16_bf16 v[192:207], v[20:23], v[164:167], v[192:207]
    s_waitcnt lgkmcnt(1)
    v_mfma_f32_32x32x16_bf16 v[192:207], v[24:27], v[168:171], v[192:207]
    s_waitcnt lgkmcnt(0)
    v_mfma_f32_32x32x16_bf16 v[192:207], v[28:31], v[172:175], v[192:207]
    s_nop 11
    v_and_b32 v192, -2, v192
    s_nop 1
    v_mov_b32_dpp v193, v192 row_shl:1 row_mask:0xf bank_mask:0xf
    v_mov_b32_dpp v194, v192 row_shl:2 row_mask:0xf bank_mask:0xf
    v_mov_b32_dpp v195, v192 row_shl:3 row_mask:0xf bank_mask:0xf
    s_mov_b32 exec_lo, 0x11111111
    s_mov_b32 exec_hi, 0
    buffer_store_dwordx4 v[192:195], v6, s[24:27], s41 offen sc1
    s_mov_b64 exec, -1
    s_cmp_lg_u32 s16, 7
    s_cbranch_scc1 fk_fin
    s_cmp_gt_u32 s3, 127
    s_cbranch_scc1 fk_fin
    s_mov_b32 s42, 0
    s_waitcnt vmcnt(0)
    s_nop 0
fk_poll2:
    buffer_load_dwordx4 v[16:19], v4, s[24:27], s40 offen sc1
    buffer_load_dwordx4 v[20:23], v5, s[24:27], s40 offen sc1
    s_waitcnt vmcnt(0)
    v_or3_b32 v6, v16, v17, v18
    v_or3_b32 v6, v6, v19, v20
    v_or3_b32 v6, v6, v21, v22
    v_or_b32 v6, v6, v23
    v_and_b32 v6, 1, v6
    v_cmp_eq_u32 vcc, 1, v6
    s_add_u32 s42, s42, 1
    s_cbranch_vccz fk_got2
    s_cmp_le_u32 s42, 0x40000
    s_cbranch_scc1 fk_poll2
    s_nop 0
fk_got2:
    v_pk_add_f32 v[16:17], v[16:17], v[20:21]
    v_pk_add_f32 v[18:19], v[18:19], v[22:23]
    s_nop 1
    v_permlane32_swap_b32 v16, v18
    v_permlane32_swap_b32 v17, v19
    v_add_f32 v16, v16, v18
    v_add_f32 v17, v17, v19
    s_nop 1
    v_permlane16_swap_b32 v16, v17
    v_add_f32 v16, v16, v17
    s_nop 1
    v_add_f32_dpp v16, v16, v16 quad_perm:[2,3,0,1] row_mask:0xf bank_mask:0xf
    s_nop 1
    v_add_f32_dpp v16, v16, v16 row_ror:4 row_mask:0xf bank_mask:0xf
    s_nop 1
    v_add_f32_dpp v16, v16, v16 row_ror:8 row_mask:0xf bank_mask:0xf
    v_cvt_pk_bf16_f32 v16, 0, v16
    v_mul_f32 v16, v16, v11
    v_cvt_pk_bf16_f32 v16, 0, v16
    v_add_f32 v16, v16, v2
    v_cvt_pk_bf16_f32 v16, 0, v16
    v_add_f32 v16, v16, v3
    v_cvt_pk_bf16_f32 v16, 0, v16
    s_mov_b32 exec_lo, 0x00030003
    s_mov_b32 exec_hi, 0x00030003
    buffer_store_short_d16_hi v16, v12, s[28:31], s21 offen
    s_nop 1
fk_fin:
fk_end:
    s_endpgm
.section .rodata,"a"
.p2align 6
.amdhsa_kernel sequential_preLN__spectral_fnet__moe_arch_mod__prompt_kernel
  .amdhsa_next_free_vgpr 256
  .amdhsa_next_free_sgpr 102
  .amdhsa_accum_offset 256
  .amdhsa_group_segment_fixed_size 0
  .amdhsa_kernarg_size 104
  .amdhsa_user_sgpr_count 2
  .amdhsa_user_sgpr_kernarg_segment_ptr 1
  .amdhsa_system_sgpr_workgroup_id_x 1
.end_amdhsa_kernel
```

```asm
; @launch grid=(256,1,1) block=(512,1,1) lds=157952
.amdgcn_target "amdgcn-amd-amdhsa--gfx950"
.text
.globl sequential_preLN__spectral_fnet__moe_arch_mod__prompt_kernel
.p2align 8
.type sequential_preLN__spectral_fnet__moe_arch_mod__prompt_kernel,@function
sequential_preLN__spectral_fnet__moe_arch_mod__prompt_kernel:
    s_cmp_gt_u32 s2, 255
    s_cbranch_scc1 fk_end
    s_load_dwordx2 s[8:9], s[0:1], 0
    s_load_dwordx2 s[24:25], s[0:1], 96
    s_load_dwordx2 s[32:33], s[0:1], 48
    s_load_dwordx2 s[44:45], s[0:1], 56
    s_load_dwordx2 s[48:49], s[0:1], 64
    s_load_dwordx2 s[52:53], s[0:1], 72
    s_load_dwordx2 s[28:29], s[0:1], 80
    s_getpc_b64 s[40:41]
fk_pc:
    s_mov_b32 s42, fk_end-fk_pc
    s_mov_b32 s43, 0x00020000
    v_lshlrev_b32 v250, 6, v0
    buffer_load_dword v251, v250, s[40:43], 0 offen
    v_lshrrev_b32 v1, 6, v0
    v_and_b32 v15, 63, v0
    v_readfirstlane_b32 s16, v1
    s_and_b32 s3, s2, 0xe0
    s_and_b32 s17, s2, 7
    s_lshl_b32 s17, s17, 2
    s_or_b32 s3, s3, s17
    s_bfe_u32 s17, s2, 0x20003
    s_or_b32 s3, s3, s17
    s_lshr_b32 s17, s3, 4
    s_add_u32 s17, s17, 1
    s_cmp_ge_u32 s3, 248
    s_cselect_b32 s17, 0, s17
    s_cmp_ge_u32 s3, 240
    s_cselect_b32 s18, 7, 15
    s_and_b32 s18, s18, s3
    s_lshl_b32 s18, s18, 7
    s_add_u32 s18, s18, s17
    v_and_b32 v1, 31, v15
    v_lshrrev_b32 v2, 5, v15
    v_lshlrev_b32 v14, 4, v15
    s_mov_b32 s10, 0x400000
    s_mov_b32 s11, 0x00020000
    s_mov_b32 s26, 0x470000
    s_mov_b32 s27, 0x00020000
    s_mov_b32 s30, 0x400000
    s_mov_b32 s31, 0x00020000
    s_mov_b32 s34, 0x800
    s_mov_b32 s35, 0x00020000
    s_mov_b32 s46, 0x700000
    s_mov_b32 s47, 0x00020000
    s_mov_b32 s50, 0x700000
    s_mov_b32 s51, 0x00020000
    s_mov_b32 s54, 0x700000
    s_mov_b32 s55, 0x00020000
    s_cmp_eq_u32 s3, 255
    s_cselect_b32 s12, 5, 4
    s_cmp_ge_u32 s16, s12
    s_cbranch_scc1 fk_H
    s_cmp_eq_u32 s16, 4
    s_cbranch_scc1 fk_lowp
    s_setprio 3
fk_lowp:
    s_lshl_b32 s19, s16, 5
    s_add_u32 s19, s19, s18
    s_sub_u32 s20, 2048, s19
    s_and_b32 s20, s20, 2047
    s_lshl_b32 s21, s19, 11
    s_lshl_b32 s22, s20, 11
    s_lshl_b32 s12, s16, 12
    s_add_u32 s12, s12, 98304
    s_mov_b32 m0, s12
    v_mov_b32 v16, 0
    v_mov_b32 v17, 0
    v_mov_b32 v18, 0
    v_mov_b32 v19, 0
    v_mov_b32 v20, 0
    v_mov_b32 v21, 0
    v_mov_b32 v22, 0
    v_mov_b32 v23, 0
    v_mov_b32 v24, 0
    v_mov_b32 v25, 0
    v_mov_b32 v26, 0
    v_mov_b32 v27, 0
    v_mov_b32 v28, 0
    v_mov_b32 v29, 0
    v_mov_b32 v30, 0
    v_mov_b32 v31, 0
    v_mov_b32 v32, 0
    v_mov_b32 v33, 0
    v_mov_b32 v34, 0
    v_mov_b32 v35, 0
    v_mov_b32 v36, 0
    v_mov_b32 v37, 0
    v_mov_b32 v38, 0
    v_mov_b32 v39, 0
    v_mov_b32 v40, 0
    v_mov_b32 v41, 0
    v_mov_b32 v42, 0
    v_mov_b32 v43, 0
    v_mov_b32 v44, 0
    v_mov_b32 v45, 0
    v_mov_b32 v46, 0
    v_mov_b32 v47, 0
    v_cvt_f32_u32 v200, v1
    v_lshlrev_b32 v7, 2, v2
    v_cvt_f32_u32 v7, v7
    v_lshrrev_b32 v8, 1, v1
    v_and_b32 v9, 1, v1
    v_lshlrev_b32 v205, 2, v15
    v_and_b32 v205, 63, v205
    v_add_u32 v205, 157824, v205
    ds_write_b32 v205, v16
    s_waitcnt lgkmcnt(0)
    buffer_load_dwordx4 v14, s[8:11], s21 offen lds
    s_add_u32 s13, s12, 1024
    s_mov_b32 m0, s13
    s_add_u32 s14, s21, 1024
    buffer_load_dwordx4 v14, s[8:11], s14 offen lds
    s_add_u32 s13, s12, 2048
    s_mov_b32 m0, s13
    s_nop 0
    buffer_load_dwordx4 v14, s[8:11], s22 offen lds
    s_add_u32 s13, s12, 3072
    s_mov_b32 m0, s13
    s_add_u32 s14, s22, 1024
    buffer_load_dwordx4 v14, s[8:11], s14 offen lds
    s_barrier
    v_add_u32 v206, 138496, v14
    s_lshl_b32 s13, s16, 2
    s_add_u32 s13, s13, 157824
    v_mov_b32 v201, s13
    v_mov_b32 v202, 1
    s_cmp_eq_u32 s16, 1
    s_cbranch_scc1 fk_j1
    s_cmp_eq_u32 s16, 2
    s_cbranch_scc1 fk_j2
    s_cmp_eq_u32 s16, 3
    s_cbranch_scc1 fk_j3
    s_cmp_eq_u32 s16, 4
    s_cbranch_scc1 fk_jend
    v_cmp_eq_u32 vcc, 1, v1
    s_nop 1
    v_cndmask_b32 v10, v8, 16, vcc
    v_cndmask_b32 v11, v9, 0, vcc
    v_cvt_f32_u32 v10, v10
    v_cvt_f32_u32 v11, v11
    v_mul_f32 v10, 0x3d000000, v10
    v_mul_f32 v11, 0x3e800000, v11
    v_add_f32 v12, v7, v7
    v_fma_f32 v11, v10, v12, v11
    v_mov_b32 v128, v11
    v_fmamk_f32 v129, v10, 0x3f800000, v11
    v_fmamk_f32 v130, v10, 0x40000000, v11
    v_fmamk_f32 v131, v10, 0x40400000, v11
    v_fmamk_f32 v132, v10, 0x40800000, v11
    v_fmamk_f32 v133, v10, 0x40a00000, v11
    v_fmamk_f32 v134, v10, 0x40c00000, v11
    v_fmamk_f32 v135, v10, 0x40e00000, v11
    v_fmamk_f32 v136, v10, 0x41800000, v11
    v_fmamk_f32 v137, v10, 0x41880000, v11
    v_fmamk_f32 v138, v10, 0x41900000, v11
    v_fmamk_f32 v139, v10, 0x41980000, v11
    v_fmamk_f32 v140, v10, 0x41a00000, v11
    v_fmamk_f32 v141, v10, 0x41a80000, v11
    v_fmamk_f32 v142, v10, 0x41b00000, v11
    v_fmamk_f32 v143, v10, 0x41b80000, v11
    v_cos_f32 v144, v128
    v_cos_f32 v145, v129
    v_cos_f32 v146, v130
    v_cos_f32 v147, v131
    v_cos_f32 v148, v132
    v_cos_f32 v149, v133
    v_cos_f32 v150, v134
    v_cos_f32 v151, v135
    v_cos_f32 v152, v136
    v_cos_f32 v153, v137
    v_cos_f32 v154, v138
    v_cos_f32 v155, v139
    v_cos_f32 v156, v140
    v_cos_f32 v157, v141
    v_cos_f32 v158, v142
    v_cos_f32 v159, v143
    v_cvt_pk_f16_f32 v48, v144, v145
    v_cvt_pk_f16_f32 v49, v146, v147
    v_cvt_pk_f16_f32 v50, v148, v149
    v_cvt_pk_f16_f32 v51, v150, v151
    v_cvt_pk_f16_f32 v52, v152, v153
    v_cvt_pk_f16_f32 v53, v154, v155
    v_cvt_pk_f16_f32 v54, v156, v157
    v_cvt_pk_f16_f32 v55, v158, v159
    ds_write_b128 v206, v[48:51] offset:0
    ds_write_b128 v206, v[52:55] offset:1024
    s_branch fk_jsig
    s_nop 1
fk_j1:
    v_cvt_f32_u32 v10, v8
    v_lshlrev_b32 v11, 31, v9
    v_mul_f32 v10, 0x3a800000, v10
    v_xor_b32 v10, v11, v10
    v_mul_f32 v11, v10, v7
    v_mov_b32 v128, v11
    v_fmamk_f32 v129, v10, 0x3f800000, v11
    v_fmamk_f32 v130, v10, 0x40000000, v11
    v_fmamk_f32 v131, v10, 0x40400000, v11
    v_fmamk_f32 v132, v10, 0x41000000, v11
    v_fmamk_f32 v133, v10, 0x41100000, v11
    v_fmamk_f32 v134, v10, 0x41200000, v11
    v_fmamk_f32 v135, v10, 0x41300000, v11
    v_fmamk_f32 v136, v10, 0x41800000, v11
    v_fmamk_f32 v137, v10, 0x41880000, v11
    v_fmamk_f32 v138, v10, 0x41900000, v11
    v_fmamk_f32 v139, v10, 0x41980000, v11
    v_fmamk_f32 v140, v10, 0x41c00000, v11
    v_fmamk_f32 v141, v10, 0x41c80000, v11
    v_fmamk_f32 v142, v10, 0x41d00000, v11
    v_fmamk_f32 v143, v10, 0x41d80000, v11
    v_cos_f32 v56, v128
    v_cos_f32 v57, v129
    v_cos_f32 v58, v130
    v_cos_f32 v59, v131
    v_cos_f32 v60, v132
    v_cos_f32 v61, v133
    v_cos_f32 v62, v134
    v_cos_f32 v63, v135
    v_cos_f32 v64, v136
    v_cos_f32 v65, v137
    v_cos_f32 v66, v138
    v_cos_f32 v67, v139
    v_cos_f32 v68, v140
    v_cos_f32 v69, v141
    v_cos_f32 v70, v142
    v_cos_f32 v71, v143
    ds_write_b128 v206, v[56:59] offset:2048
    ds_write_b128 v206, v[60:63] offset:3072
    ds_write_b128 v206, v[64:67] offset:4096
    ds_write_b128 v206, v[68:71] offset:5120
    v_sin_f32 v72, v128
    v_sin_f32 v73, v129
    v_sin_f32 v74, v130
    v_sin_f32 v75, v131
    v_sin_f32 v76, v132
    v_sin_f32 v77, v133
    v_sin_f32 v78, v134
    v_sin_f32 v79, v135
    v_sin_f32 v80, v136
    v_sin_f32 v81, v137
    v_sin_f32 v82, v138
    v_sin_f32 v83, v139
    v_sin_f32 v84, v140
    v_sin_f32 v85, v141
    v_sin_f32 v86, v142
    v_sin_f32 v87, v143
    ds_write_b128 v206, v[72:75] offset:6144
    ds_write_b128 v206, v[76:79] offset:7168
    ds_write_b128 v206, v[80:83] offset:8192
    ds_write_b128 v206, v[84:87] offset:9216
    s_branch fk_jsig
    s_nop 0
fk_j2:
    v_mul_f32 v128, 0x3d000000, v200
    v_mul_f32 v129, v128, v7
    v_mov_b32 v130, v129
    v_fmamk_f32 v131, v128, 0x3f800000, v129
    v_fmamk_f32 v132, v128, 0x40000000, v129
    v_fmamk_f32 v133, v128, 0x40400000, v129
    v_fmamk_f32 v134, v128, 0x41000000, v129
    v_fmamk_f32 v135, v128, 0x41100000, v129
    v_fmamk_f32 v136, v128, 0x41200000, v129
    v_fmamk_f32 v137, v128, 0x41300000, v129
    v_fmamk_f32 v138, v128, 0x41800000, v129
    v_fmamk_f32 v139, v128, 0x41880000, v129
    v_fmamk_f32 v140, v128, 0x41900000, v129
    v_fmamk_f32 v141, v128, 0x41980000, v129
    v_fmamk_f32 v142, v128, 0x41c00000, v129
    v_fmamk_f32 v143, v128, 0x41c80000, v129
    v_fmamk_f32 v144, v128, 0x41d00000, v129
    v_fmamk_f32 v145, v128, 0x41d80000, v129
    v_cos_f32 v146, v130
    v_cos_f32 v147, v131
    v_cos_f32 v148, v132
    v_cos_f32 v149, v133
    v_cos_f32 v150, v134
    v_cos_f32 v151, v135
    v_cos_f32 v152, v136
    v_cos_f32 v153, v137
    v_cos_f32 v154, v138
    v_cos_f32 v155, v139
    v_cos_f32 v156, v140
    v_cos_f32 v157, v141
    v_cos_f32 v158, v142
    v_cos_f32 v159, v143
    v_cos_f32 v160, v144
    v_cos_f32 v161, v145
    v_cvt_pk_f16_f32 v96, v146, v147
    v_cvt_pk_f16_f32 v97, v148, v149
    v_cvt_pk_f16_f32 v98, v150, v151
    v_cvt_pk_f16_f32 v99, v152, v153
    v_cvt_pk_f16_f32 v100, v154, v155
    v_cvt_pk_f16_f32 v101, v156, v157
    v_cvt_pk_f16_f32 v102, v158, v159
    v_cvt_pk_f16_f32 v103, v160, v161
    v_sin_f32 v146, v130
    v_sin_f32 v147, v131
    v_sin_f32 v148, v132
    v_sin_f32 v149, v133
    v_sin_f32 v150, v134
    v_sin_f32 v151, v135
    v_sin_f32 v152, v136
    v_sin_f32 v153, v137
    v_sin_f32 v154, v138
    v_sin_f32 v155, v139
    v_sin_f32 v156, v140
    v_sin_f32 v157, v141
    v_sin_f32 v158, v142
    v_sin_f32 v159, v143
    v_sin_f32 v160, v144
    v_sin_f32 v161, v145
    v_cvt_pk_f16_f32 v104, v146, v147
    v_cvt_pk_f16_f32 v105, v148, v149
    v_cvt_pk_f16_f32 v106, v150, v151
    v_cvt_pk_f16_f32 v107, v152, v153
    v_cvt_pk_f16_f32 v108, v154, v155
    v_cvt_pk_f16_f32 v109, v156, v157
    v_cvt_pk_f16_f32 v110, v158, v159
    v_cvt_pk_f16_f32 v111, v160, v161
    ds_write_b128 v206, v[96:99] offset:12288
    ds_write_b128 v206, v[100:103] offset:13312
    ds_write_b128 v206, v[104:107] offset:14336
    ds_write_b128 v206, v[108:111] offset:15360
    s_branch fk_jsig
    s_nop 0
fk_j3:
    v_or_b32 v10, 16, v1
    v_cvt_f32_u32 v10, v10
    v_mov_b32 v11, 0x3c800000
    v_fmamk_f32 v10, v10, 0x3d000000, v11
    v_cmp_gt_u32 vcc, 16, v1
    v_mov_b32 v12, 0xbe800000
    s_nop 0
    v_cndmask_b32 v12, 0, v12, vcc
    v_fma_f32 v11, v10, v7, v12
    v_mov_b32 v128, v11
    v_fmamk_f32 v129, v10, 0x3f800000, v11
    v_fmamk_f32 v130, v10, 0x40000000, v11
    v_fmamk_f32 v131, v10, 0x40400000, v11
    v_fmamk_f32 v132, v10, 0x41000000, v11
    v_fmamk_f32 v133, v10, 0x41100000, v11
    v_fmamk_f32 v134, v10, 0x41200000, v11
    v_fmamk_f32 v135, v10, 0x41300000, v11
    v_fmamk_f32 v136, v10, 0x41800000, v11
    v_fmamk_f32 v137, v10, 0x41880000, v11
    v_fmamk_f32 v138, v10, 0x41900000, v11
    v_fmamk_f32 v139, v10, 0x41980000, v11
    v_fmamk_f32 v140, v10, 0x41c00000, v11
    v_fmamk_f32 v141, v10, 0x41c80000, v11
    v_fmamk_f32 v142, v10, 0x41d00000, v11
    v_fmamk_f32 v143, v10, 0x41d80000, v11
    v_cos_f32 v144, v128
    v_cos_f32 v145, v129
    v_cos_f32 v146, v130
    v_cos_f32 v147, v131
    v_cos_f32 v148, v132
    v_cos_f32 v149, v133
    v_cos_f32 v150, v134
    v_cos_f32 v151, v135
    v_cos_f32 v152, v136
    v_cos_f32 v153, v137
    v_cos_f32 v154, v138
    v_cos_f32 v155, v139
    v_cos_f32 v156, v140
    v_cos_f32 v157, v141
    v_cos_f32 v158, v142
    v_cos_f32 v159, v143
    v_cvt_pk_f16_f32 v88, v144, v145
    v_cvt_pk_f16_f32 v89, v146, v147
    v_cvt_pk_f16_f32 v90, v148, v149
    v_cvt_pk_f16_f32 v91, v150, v151
    v_cvt_pk_f16_f32 v92, v152, v153
    v_cvt_pk_f16_f32 v93, v154, v155
    v_cvt_pk_f16_f32 v94, v156, v157
    v_cvt_pk_f16_f32 v95, v158, v159
    ds_write_b128 v206, v[88:91] offset:10240
    ds_write_b128 v206, v[92:95] offset:11264
    s_nop 2
fk_jsig:
    ds_write_b32 v201, v202 offset:32
fk_jend:
    v_lshlrev_b32 v3, 9, v2
    v_lshl_add_u32 v3, v1, 1, v3
    v_sub_u32 v4, 576, v3
    v_sub_u32 v5, 2048, v3
    v_and_b32 v5, 2047, v5
    v_add_u32 v3, s12, v3
    v_add_u32 v4, s12, v4
    v_add_u32 v5, s12, v5
    s_lshl_b32 s13, s16, 10
    s_sub_u32 s14, 7232, s13
    s_cmp_ge_u32 s3, 248
    s_cselect_b32 s15, 1024, 0
    s_add_u32 s14, s14, s15
    s_cmp_eq_u32 s14, 8256
    s_cselect_b32 s14, 4160, s14
    s_cmp_eq_u32 s19, s20
    s_cselect_b32 s14, 8256, s14
    s_cmp_eq_u32 s16, 4
    s_cselect_b32 s13, 8256, s13
    s_cmp_lg_u32 s19, 0
    s_cbranch_scc1 fk_noz
    v_add_u32 v8, 124992, v14
    ds_write_b128 v8, v[16:19]
fk_noz:
    s_add_u32 s13, s13, 120832
    s_add_u32 s14, s14, 120832
    v_cmp_gt_u32 vcc, 16, v1
    v_mov_b32 v8, s13
    v_mov_b32 v9, s14
    v_cndmask_b32 v10, v9, v8, vcc
    v_cndmask_b32 v11, v8, v9, vcc
    v_lshl_add_u32 v10, v15, 2, v10
    v_lshl_add_u32 v11, v15, 2, v11
    v_lshrrev_b32 v6, 1, v15
    v_and_b32 v8, 1, v15
    v_mul_u32_u24 v9, 4160, v8
    v_and_b32 v12, 15, v6
    v_lshl_add_u32 v12, v12, 4, v2
    v_mul_u32_u24 v12, 9344, v12
    v_mul_u32_u24 v192, 18688, v8
    v_add_u32 v192, v192, v12
    v_lshl_add_u32 v12, v8, 4, v12
    v_lshrrev_b32 v194, 3, v15
    v_lshlrev_b32 v193, 4, v194
    v_lshl_add_u32 v193, v8, 7, v193
    v_and_b32 v6, 3, v6
    v_lshl_add_u32 v9, v6, 2, v9
    v_lshl_add_u32 v9, v194, 7, v9
    v_lshlrev_b32 v194, 10, v194
    v_and_b32 v6, 7, v15
    v_lshl_add_u32 v194, v6, 4, v194
    s_lshl_b32 s13, s16, 5
    s_add_u32 s13, s13, 120832
    v_add_u32 v6, s13, v9
    s_mul_i32 s36, s3, 9344
    s_lshl_b32 s13, s16, 8
    s_add_u32 s36, s36, s13
    s_add_u32 s36, s36, 0x20000
    s_mul_i32 s37, s16, 37376
    s_add_u32 s37, s37, 0x20000
    s_bfe_u32 s23, s3, 0x30002
    s_lshl_b32 s23, s23, 7
    s_lshr_b32 s12, s3, 5
    s_lshl_b32 s12, s12, 4
    s_add_u32 s23, s23, s12
    s_and_b32 s12, s3, 3
    s_lshl_b32 s12, s12, 2
    s_add_u32 s23, s23, s12
    s_add_u32 s23, s23, 8192
    s_add_u32 s23, s23, s37
    s_lshl_b32 s14, s3, 5
    s_add_u32 s37, s37, s14
    s_add_u32 s38, s37, 18688
    s_lshl_b32 s13, s16, 11
    s_add_u32 s13, s13, 130304
    v_add_u32 v7, s13, v14
    v_cmp_eq_u32 s[58:59], 1, v8
    s_cmp_eq_u32 s19, s20
    s_cselect_b32 s39, 0.5, 1.0
    s_lshl_b32 s13, s16, 2
    s_add_u32 s13, s13, 157056
    v_mov_b32 v9, s13
    s_mov_b32 s57, 47
    s_nop 3
fk_spinc:
    ds_read_b32 v203, v205
    s_waitcnt lgkmcnt(0)
    v_cmp_eq_u32 vcc, 0, v203
    s_nop 1
    s_and_b32 s13, vcc_lo, 0xf00
    s_cbranch_scc1 fk_spinc
    ds_read_b128 v[48:51], v206 offset:0
    ds_read_b128 v[52:55], v206 offset:1024
    ds_read_b128 v[56:59], v206 offset:2048
    ds_read_b128 v[60:63], v206 offset:3072
    ds_read_b128 v[64:67], v206 offset:4096
    ds_read_b128 v[68:71], v206 offset:5120
    ds_read_b128 v[72:75], v206 offset:6144
    ds_read_b128 v[76:79], v206 offset:7168
    ds_read_b128 v[80:83], v206 offset:8192
    ds_read_b128 v[84:87], v206 offset:9216
    ds_read_b128 v[88:91], v206 offset:10240
    ds_read_b128 v[92:95], v206 offset:11264
    s_waitcnt lgkmcnt(8)
    ds_read_b128 v[96:99], v206 offset:12288
    ds_read_b128 v[100:103], v206 offset:13312
    ds_read_b128 v[104:107], v206 offset:14336
    ds_read_b128 v[108:111], v206 offset:15360
    s_waitcnt vmcnt(0) lgkmcnt(0)
    ds_read_u16_d16_hi v16, v3 offset:0
    ds_read_u16_d16_hi v17, v3 offset:64
    ds_read_u16_d16_hi v18, v3 offset:128
    ds_read_u16_d16_hi v19, v3 offset:192
    ds_read_u16_d16_hi v20, v3 offset:256
    ds_read_u16_d16_hi v21, v3 offset:320
    ds_read_u16_d16_hi v22, v3 offset:384
    ds_read_u16_d16_hi v23, v3 offset:448
    ds_read_u16_d16_hi v24, v3 offset:1024
    ds_read_u16_d16_hi v25, v3 offset:1088
    ds_read_u16_d16_hi v26, v3 offset:1152
    ds_read_u16_d16_hi v27, v3 offset:1216
    ds_read_u16_d16_hi v28, v3 offset:1280
    ds_read_u16_d16_hi v29, v3 offset:1344
    ds_read_u16_d16_hi v30, v3 offset:1408
    ds_read_u16_d16_hi v31, v3 offset:1472
    s_waitcnt lgkmcnt(2)
    ds_read_u16_d16_hi v32, v5 offset:2048
    ds_read_u16_d16_hi v33, v4 offset:3456
    ds_read_u16_d16_hi v34, v4 offset:3392
    ds_read_u16_d16_hi v35, v4 offset:3328
    ds_read_u16_d16_hi v36, v4 offset:3264
    ds_read_u16_d16_hi v37, v4 offset:3200
    ds_read_u16_d16_hi v38, v4 offset:3136
    ds_read_u16_d16_hi v39, v4 offset:3072
    ds_read_u16_d16_hi v40, v4 offset:2496
    ds_read_u16_d16_hi v41, v4 offset:2432
    ds_read_u16_d16_hi v42, v4 offset:2368
    ds_read_u16_d16_hi v43, v4 offset:2304
    ds_read_u16_d16_hi v44, v4 offset:2240
    s_waitcnt lgkmcnt(8)
    ds_read_u16_d16_hi v45, v4 offset:2176
    ds_read_u16_d16_hi v46, v4 offset:2112
    ds_read_u16_d16_hi v47, v4 offset:2048
    v_pk_add_f32 v[128:129], v[16:17], v[18:19]
    v_pk_add_f32 v[130:131], v[20:21], v[22:23]
    v_pk_add_f32 v[132:133], v[24:25], v[26:27]
    v_pk_add_f32 v[134:135], v[28:29], v[30:31]
    v_pk_mul_f32 v[136:137], v[16:17], v[16:17]
    v_pk_mul_f32 v[138:139], v[18:19], v[18:19]
    v_pk_fma_f32 v[136:137], v[20:21], v[20:21], v[136:137]
    v_pk_fma_f32 v[138:139], v[22:23], v[22:23], v[138:139]
    v_pk_fma_f32 v[136:137], v[24:25], v[24:25], v[136:137]
    v_pk_fma_f32 v[138:139], v[26:27], v[26:27], v[138:139]
    v_pk_fma_f32 v[136:137], v[28:29], v[28:29], v[136:137]
    v_pk_fma_f32 v[138:139], v[30:31], v[30:31], v[138:139]
    v_pk_add_f32 v[128:129], v[128:129], v[130:131]
    v_pk_add_f32 v[132:133], v[132:133], v[134:135]
    v_pk_add_f32 v[136:137], v[136:137], v[138:139]
    v_pk_add_f32 v[128:129], v[128:129], v[132:133]
    v_add_f32 v136, v136, v137
    v_add_f32 v128, v128, v129
    s_waitcnt lgkmcnt(0)
    v_pk_add_f32 v[140:141], v[32:33], v[34:35]
    v_pk_add_f32 v[142:143], v[36:37], v[38:39]
    v_pk_add_f32 v[144:145], v[40:41], v[42:43]
    v_pk_add_f32 v[146:147], v[44:45], v[46:47]
    v_pk_mul_f32 v[148:149], v[32:33], v[32:33]
    v_pk_mul_f32 v[150:151], v[34:35], v[34:35]
    v_pk_fma_f32 v[148:149], v[36:37], v[36:37], v[148:149]
    v_pk_fma_f32 v[150:151], v[38:39], v[38:39], v[150:151]
    v_pk_fma_f32 v[148:149], v[40:41], v[40:41], v[148:149]
    v_pk_fma_f32 v[150:151], v[42:43], v[42:43], v[150:151]
    v_pk_fma_f32 v[148:149], v[44:45], v[44:45], v[148:149]
    v_pk_fma_f32 v[150:151], v[46:47], v[46:47], v[150:151]
    v_pk_add_f32 v[140:141], v[140:141], v[142:143]
    v_pk_add_f32 v[144:145], v[144:145], v[146:147]
    v_pk_add_f32 v[148:149], v[148:149], v[150:151]
    v_pk_add_f32 v[140:141], v[140:141], v[144:145]
    v_add_f32 v148, v148, v149
    v_add_f32 v140, v140, v141
    s_nop 1
    v_permlane32_swap_b32 v128, v140
    v_permlane32_swap_b32 v136, v148
    v_add_f32 v128, v128, v140
    v_add_f32 v136, v136, v148
    s_nop 1
    v_permlane16_swap_b32 v128, v136
    v_add_f32 v128, v128, v136
    s_nop 1
    v_add_f32_dpp v128, v128, v128 quad_perm:[1,0,3,2] row_mask:0xf bank_mask:0xf
    s_nop 1
    v_add_f32_dpp v128, v128, v128 quad_perm:[2,3,0,1] row_mask:0xf bank_mask:0xf
    s_nop 1
    v_add_f32_dpp v128, v128, v128 row_half_mirror row_mask:0xf bank_mask:0xf
    s_nop 1
    v_add_f32_dpp v128, v128, v128 row_mirror row_mask:0xf bank_mask:0xf
    s_nop 1
    v_mov_b32_dpp v129, v128 row_bcast:15 row_mask:0xa bank_mask:0xf
    v_mul_f32 v130, 0x3a800000, v128
    v_mul_f32 v129, 0x3a800000, v129
    v_fma_f32 v130, -v129, v129, v130
    v_max_f32 v130, 0, v130
    v_cvt_pk_bf16_f32 v130, 0, v130
    v_cvt_pk_bf16_f32 v129, 0, v129
    v_add_f32 v130, 0x3727c5ac, v130
    v_cvt_pk_bf16_f32 v130, 0, v130
    v_sqrt_f32 v130, v130
    s_nop 0
    v_cvt_pk_bf16_f32 v130, 0, v130
    v_rcp_f32 v130, v130
    s_nop 0
    v_mul_f32 v130, 0x3c000000, v130
    v_mul_f32 v129, v129, v130
    v_readlane_b32 s4, v130, 16
    v_readlane_b32 s6, v130, 48
    v_readlane_b32 s13, v129, 16
    v_readlane_b32 s14, v129, 48
    s_nop 0
    v_mov_b32 v132, s13
    v_add_f32 v132, s14, v132
    v_pk_fma_f32 v[32:33], v[32:33], s[6:7], v[132:133] op_sel_hi:[1,0,0] neg_lo:[0,0,1] neg_hi:[0,0,1]
    v_pk_fma_f32 v[34:35], v[34:35], s[6:7], v[132:133] op_sel_hi:[1,0,0] neg_lo:[0,0,1] neg_hi:[0,0,1]
    v_pk_fma_f32 v[36:37], v[36:37], s[6:7], v[132:133] op_sel_hi:[1,0,0] neg_lo:[0,0,1] neg_hi:[0,0,1]
    v_pk_fma_f32 v[38:39], v[38:39], s[6:7], v[132:133] op_sel_hi:[1,0,0] neg_lo:[0,0,1] neg_hi:[0,0,1]
    v_pk_fma_f32 v[40:41], v[40:41], s[6:7], v[132:133] op_sel_hi:[1,0,0] neg_lo:[0,0,1] neg_hi:[0,0,1]
    v_pk_fma_f32 v[42:43], v[42:43], s[6:7], v[132:133] op_sel_hi:[1,0,0] neg_lo:[0,0,1] neg_hi:[0,0,1]
    v_pk_fma_f32 v[44:45], v[44:45], s[6:7], v[132:133] op_sel_hi:[1,0,0] neg_lo:[0,0,1] neg_hi:[0,0,1]
    v_pk_fma_f32 v[46:47], v[46:47], s[6:7], v[132:133] op_sel_hi:[1,0,0] neg_lo:[0,0,1] neg_hi:[0,0,1]
    v_pk_fma_f32 v[16:17], v[16:17], s[4:5], v[32:33] op_sel_hi:[1,0,1]
    v_pk_fma_f32 v[18:19], v[18:19], s[4:5], v[34:35] op_sel_hi:[1,0,1]
    v_pk_fma_f32 v[20:21], v[20:21], s[4:5], v[36:37] op_sel_hi:[1,0,1]
    v_pk_fma_f32 v[22:23], v[22:23], s[4:5], v[38:39] op_sel_hi:[1,0,1]
    v_pk_fma_f32 v[24:25], v[24:25], s[4:5], v[40:41] op_sel_hi:[1,0,1]
    v_pk_fma_f32 v[26:27], v[26:27], s[4:5], v[42:43] op_sel_hi:[1,0,1]
    v_pk_fma_f32 v[28:29], v[28:29], s[4:5], v[44:45] op_sel_hi:[1,0,1]
    v_pk_fma_f32 v[30:31], v[30:31], s[4:5], v[46:47] op_sel_hi:[1,0,1]
    v_cvt_pk_f16_f32 v176, v16, v17
    v_cvt_pk_f16_f32 v177, v18, v19
    v_cvt_pk_f16_f32 v178, v20, v21
    v_cvt_pk_f16_f32 v179, v22, v23
    v_cvt_pk_f16_f32 v180, v24, v25
    v_cvt_pk_f16_f32 v181, v26, v27
    v_cvt_pk_f16_f32 v182, v28, v29
    v_cvt_pk_f16_f32 v183, v30, v31
    v_mfma_f32_32x32x16_f16 v[112:127], v[176:179], v[48:51], 0
    s_nop 0
    v_mfma_f32_32x32x16_f16 v[112:127], v[180:183], v[52:55], v[112:127]
    s_nop 11
    v_pk_mul_f32 v[16:17], v[112:113], v[56:57]
    v_pk_mul_f32 v[18:19], v[114:115], v[58:59]
    v_pk_mul_f32 v[20:21], v[116:117], v[60:61]
    v_pk_mul_f32 v[22:23], v[118:119], v[62:63]
    v_pk_mul_f32 v[24:25], v[120:121], v[64:65]
    v_pk_mul_f32 v[26:27], v[122:123], v[66:67]
    v_pk_mul_f32 v[28:29], v[124:125], v[68:69]
    v_pk_mul_f32 v[30:31], v[126:127], v[70:71]
    v_fmac_f32_dpp v16, v112, v72 quad_perm:[1,0,3,2] row_mask:0xf bank_mask:0xf
    v_fmac_f32_dpp v17, v113, v73 quad_perm:[1,0,3,2] row_mask:0xf bank_mask:0xf
    v_fmac_f32_dpp v18, v114, v74 quad_perm:[1,0,3,2] row_mask:0xf bank_mask:0xf
    v_fmac_f32_dpp v19, v115, v75 quad_perm:[1,0,3,2] row_mask:0xf bank_mask:0xf
    v_fmac_f32_dpp v20, v116, v76 quad_perm:[1,0,3,2] row_mask:0xf bank_mask:0xf
    v_fmac_f32_dpp v21, v117, v77 quad_perm:[1,0,3,2] row_mask:0xf bank_mask:0xf
    v_fmac_f32_dpp v22, v118, v78 quad_perm:[1,0,3,2] row_mask:0xf bank_mask:0xf
    v_fmac_f32_dpp v23, v119, v79 quad_perm:[1,0,3,2] row_mask:0xf bank_mask:0xf
    v_cvt_pk_f16_f32 v176, v16, v17
    v_cvt_pk_f16_f32 v177, v18, v19
    v_cvt_pk_f16_f32 v178, v20, v21
    v_cvt_pk_f16_f32 v179, v22, v23
    v_fmac_f32_dpp v24, v120, v80 quad_perm:[1,0,3,2] row_mask:0xf bank_mask:0xf
    v_fmac_f32_dpp v25, v121, v81 quad_perm:[1,0,3,2] row_mask:0xf bank_mask:0xf
    v_mfma_f32_32x32x16_f16 v[128:143], v[176:179], v[96:99], 0
    v_fmac_f32_dpp v26, v122, v82 quad_perm:[1,0,3,2] row_mask:0xf bank_mask:0xf
    v_fmac_f32_dpp v27, v123, v83 quad_perm:[1,0,3,2] row_mask:0xf bank_mask:0xf
    v_fmac_f32_dpp v28, v124, v84 quad_perm:[1,0,3,2] row_mask:0xf bank_mask:0xf
    v_fmac_f32_dpp v29, v125, v85 quad_perm:[1,0,3,2] row_mask:0xf bank_mask:0xf
    v_mfma_f32_32x32x16_f16 v[144:159], v[176:179], v[104:107], 0
    v_fmac_f32_dpp v30, v126, v86 quad_perm:[1,0,3,2] row_mask:0xf bank_mask:0xf
    v_fmac_f32_dpp v31, v127, v87 quad_perm:[1,0,3,2] row_mask:0xf bank_mask:0xf
    v_cvt_pk_f16_f32 v180, v24, v25
    v_cvt_pk_f16_f32 v181, v26, v27
    v_mfma_f32_32x32x16_f16 v[160:175], v[176:179], v[88:91], 0
    v_cvt_pk_f16_f32 v182, v28, v29
    v_cvt_pk_f16_f32 v183, v30, v31
    s_nop 1
    v_mfma_f32_32x32x16_f16 v[128:143], v[180:183], v[100:103], v[128:143]
    v_mfma_f32_32x32x16_f16 v[144:159], v[180:183], v[108:111], v[144:159]
    v_mfma_f32_32x32x16_f16 v[160:175], v[180:183], v[92:95], v[160:175]
    v_cmp_gt_u32 vcc, 16, v15
    v_cmp_gt_u32 s[40:41], 32, v15
    s_nop 8
    v_pk_add_f32 v[20:21], v[132:133], v[148:149] op_sel:[0,1] op_sel_hi:[1,0] neg_hi:[0,1]
    v_pk_add_f32 v[22:23], v[134:135], v[150:151] op_sel:[0,1] op_sel_hi:[1,0] neg_hi:[0,1]
    v_pk_add_f32 v[36:37], v[20:21], v[22:23] op_sel:[0,1] op_sel_hi:[1,0] neg_lo:[0,1]
    v_pk_add_f32 v[38:39], v[20:21], v[22:23] op_sel:[0,1] op_sel_hi:[1,0] neg_hi:[1,0]
    v_cvt_pk_f16_f32 v178, v36, v37
    v_cvt_pk_f16_f32 v179, v38, v39
    ds_write_b32 v10, v178 offset:256
    ds_write_b32 v11, v179 offset:256
    v_pk_add_f32 v[24:25], v[136:137], v[152:153] op_sel:[0,1] op_sel_hi:[1,0] neg_hi:[0,1]
    v_pk_add_f32 v[26:27], v[138:139], v[154:155] op_sel:[0,1] op_sel_hi:[1,0] neg_hi:[0,1]
    v_pk_add_f32 v[40:41], v[24:25], v[26:27] op_sel:[0,1] op_sel_hi:[1,0] neg_lo:[0,1]
    v_pk_add_f32 v[42:43], v[24:25], v[26:27] op_sel:[0,1] op_sel_hi:[1,0] neg_hi:[1,0]
    v_cvt_pk_f16_f32 v180, v40, v41
    v_cvt_pk_f16_f32 v181, v42, v43
    ds_write_b32 v10, v180 offset:512
    ds_write_b32 v11, v181 offset:512
    v_pk_add_f32 v[28:29], v[140:141], v[156:157] op_sel:[0,1] op_sel_hi:[1,0] neg_hi:[0,1]
    v_pk_add_f32 v[30:31], v[142:143], v[158:159] op_sel:[0,1] op_sel_hi:[1,0] neg_hi:[0,1]
    v_pk_add_f32 v[44:45], v[28:29], v[30:31] op_sel:[0,1] op_sel_hi:[1,0] neg_lo:[0,1]
    v_pk_add_f32 v[46:47], v[28:29], v[30:31] op_sel:[0,1] op_sel_hi:[1,0] neg_hi:[1,0]
    v_cvt_pk_f16_f32 v182, v44, v45
    v_cvt_pk_f16_f32 v183, v46, v47
    ds_write_b32 v10, v182 offset:768
    ds_write_b32 v11, v183 offset:768
    v_pk_add_f32 v[16:17], v[128:129], v[144:145] op_sel:[0,1] op_sel_hi:[1,0] neg_hi:[0,1]
    v_pk_add_f32 v[18:19], v[130:131], v[146:147] op_sel:[0,1] op_sel_hi:[1,0] neg_hi:[0,1]
    v_mul_f32 v8, s39, v128
    v_mov_b32 v3, v161
    s_nop 1
    v_permlane16_swap_b32 v4, v3
    v_cndmask_b32 v5, v161, v128, vcc
    v_cndmask_b32 v4, v4, v144, vcc
    v_cndmask_b32 v16, v16, v5, s[40:41]
    v_cndmask_b32 v17, v17, -v4, s[40:41]
    v_pk_add_f32 v[32:33], v[16:17], v[18:19] op_sel:[0,1] op_sel_hi:[1,0] neg_lo:[0,1]
    v_pk_add_f32 v[34:35], v[16:17], v[18:19] op_sel:[0,1] op_sel_hi:[1,0] neg_hi:[1,0]
    v_cvt_pk_f16_f32 v176, v32, v33
    v_cvt_pk_f16_f32 v177, v34, v35
    ds_write_b32 v10, v176 offset:0
    ds_write_b32 v11, v177 offset:0
    s_mov_b64 exec, 0x10000
    ds_write_b32 v9, v8
    ds_write_b32 v201, v202
    s_mov_b64 exec, -1
    s_cmp_eq_u32 s16, 4
    s_cbranch_scc1 fk_w4
    s_nop 0
fk_spin:
    ds_read_b32 v3, v205
    s_waitcnt lgkmcnt(0)
    v_cmp_eq_u32 vcc, 0, v3
    s_nop 1
    s_and_b32 s13, vcc_lo, s57
    s_cbranch_scc1 fk_spin
    s_nop 0
fk_staged:
    ds_read2st64_b32 v[184:185], v6 offset0:0 offset1:4
    ds_read2st64_b32 v[186:187], v6 offset0:8 offset1:12
    v_add_u32 v8, 16, v6
    ds_read2st64_b32 v[188:189], v8 offset0:0 offset1:4
    ds_read2st64_b32 v[190:191], v8 offset0:8 offset1:12
    v_readlane_b32 s43, v3, 7
    s_waitcnt lgkmcnt(2)
    v_or_b32 v184, 1, v184
    v_or_b32 v185, 1, v185
    v_or_b32 v186, 1, v186
    v_or_b32 v187, 1, v187
    buffer_store_dwordx4 v[184:187], v194, s[24:27], s36 offen offset:0 sc1
    s_waitcnt lgkmcnt(0)
    v_or_b32 v188, 1, v188
    v_or_b32 v189, 1, v189
    v_or_b32 v190, 1, v190
    v_or_b32 v191, 1, v191
    buffer_store_dwordx4 v[188:191], v194, s[24:27], s36 offen offset:128 sc1
    v_add3_u32 v3, v184, v185, v186
    v_add_u32 v3, v3, v187
    v_add3_u32 v4, v188, v189, v190
    v_add_u32 v4, v4, v191
    s_add_u32 s36, s36, 8192
    v_add_u32_dpp v3, v3, v3 quad_perm:[1,0,3,2] row_mask:0xf bank_mask:0xf
    v_add_u32_dpp v4, v4, v4 quad_perm:[1,0,3,2] row_mask:0xf bank_mask:0xf
    v_cndmask_b32 v3, v3, v4, s[58:59]
    v_add_u32 v196, s43, v3
    s_nop 1
    v_mov_b32_dpp v197, v196 row_shl:2 row_mask:0xf bank_mask:0xf
    v_mov_b32_dpp v198, v196 row_shl:4 row_mask:0xf bank_mask:0xf
    v_mov_b32_dpp v199, v196 row_shl:6 row_mask:0xf bank_mask:0xf
    s_mov_b32 exec_lo, 0x03030303
    s_mov_b32 exec_hi, 0x03030303
    buffer_store_dwordx4 v[196:199], v193, s[24:27], s36 offen sc1
    s_mov_b64 exec, -1
    s_cmp_lg_u32 s16, 0
    s_cbranch_scc1 fk_nog5
    v_and_b32 v9, 16, v14
    v_add_u32 v9, 157056, v9
    ds_read_b128 v[16:19], v9
    s_lshl_b32 s13, s3, 4
    s_add_u32 s13, s13, 0x11000
    s_nop 1
fk_g5s:
    ds_read_b32 v3, v205
    s_waitcnt lgkmcnt(0)
    v_cmp_eq_u32 vcc, 0, v3
    s_nop 1
    s_and_b32 s14, vcc_lo, 64
    s_cbranch_scc1 fk_g5s
    v_min_u32 v16, -2, v16
    v_min_u32 v17, -2, v17
    v_min_u32 v18, -2, v18
    v_min_u32 v19, -2, v19
    s_mov_b64 exec, 1
    buffer_store_dwordx4 v[16:19], v14, s[24:27], s13 offen sc1
    s_mov_b64 exec, -1
    s_nop 1
fk_nog5:
    v_lshrrev_b32 v208, 3, v15
    v_and_b32 v209, 7, v15
    v_and_b32 v210, 2, v208
    v_xor_b32 v209, v210, v209
    v_mul_u32_u24 v208, 7168, v208
    v_lshl_add_u32 v208, v209, 4, v208
    v_lshrrev_b32 v210, 5, v15
    v_lshlrev_b32 v210, 11, v210
    v_and_b32 v209, 31, v15
    v_lshl_add_u32 v210, v209, 4, v210
    s_and_b32 s12, s3, 3
    s_mul_i32 s100, s12, 1835008
    s_lshl_b32 s101, s12, 9
    s_lshr_b32 s12, s3, 2
    s_lshl_b32 s12, s12, 7
    s_add_u32 s100, s100, s12
    s_lshl_b32 s12, s12, 10
    s_add_u32 s101, s101, s12
    s_mov_b64 s[4:5], s[58:59]
    s_cmp_gt_u32 s3, 223
    s_cbranch_scc1 fk_win1
    s_mul_i32 s15, s16, 3
    s_add_u32 s15, s15, 12
    s_mov_b32 s58, 0x700000
    s_mov_b32 s59, 0x00020000
    s_cmp_gt_u32 s15, 95
    s_cbranch_scc1 fk_win1
    s_lshl_b32 s12, s15, 10
    s_mov_b32 m0, s12
    s_and_b32 s14, s12, 1024
    s_lshr_b32 s14, s14, 4
    v_xor_b32 v209, s14, v208
    s_cmp_lt_u32 s15, 32
    s_cselect_b64 s[56:57], s[44:45], s[48:49]
    s_and_b32 s14, s15, 31
    s_mul_i32 s13, s14, 57344
    s_add_u32 s13, s13, s100
    s_lshl_b32 s14, s14, 12
    s_add_u32 s14, s14, s101
    s_cmp_lt_u32 s15, 64
    s_cselect_b64 s[56:57], s[56:57], s[52:53]
    s_cselect_b32 s13, s13, s14
    s_cselect_b64 vcc, -1, 0
    v_cndmask_b32 v209, v210, v209, vcc
    s_add_u32 s15, s15, 1
    buffer_load_dwordx4 v209, s[56:59], s13 offen lds
    s_cmp_gt_u32 s15, 95
    s_cbranch_scc1 fk_win1
    s_lshl_b32 s12, s15, 10
    s_mov_b32 m0, s12
    s_and_b32 s14, s12, 1024
    s_lshr_b32 s14, s14, 4
    v_xor_b32 v209, s14, v208
    s_cmp_lt_u32 s15, 32
    s_cselect_b64 s[56:57], s[44:45], s[48:49]
    s_and_b32 s14, s15, 31
    s_mul_i32 s13, s14, 57344
    s_add_u32 s13, s13, s100
    s_lshl_b32 s14, s14, 12
    s_add_u32 s14, s14, s101
    s_cmp_lt_u32 s15, 64
    s_cselect_b64 s[56:57], s[56:57], s[52:53]
    s_cselect_b32 s13, s13, s14
    s_cselect_b64 vcc, -1, 0
    v_cndmask_b32 v209, v210, v209, vcc
    s_add_u32 s15, s15, 1
    buffer_load_dwordx4 v209, s[56:59], s13 offen lds
    s_cmp_gt_u32 s15, 95
    s_cbranch_scc1 fk_win1
    s_lshl_b32 s12, s15, 10
    s_mov_b32 m0, s12
    s_and_b32 s14, s12, 1024
    s_lshr_b32 s14, s14, 4
    v_xor_b32 v209, s14, v208
    s_cmp_lt_u32 s15, 32
    s_cselect_b64 s[56:57], s[44:45], s[48:49]
    s_and_b32 s14, s15, 31
    s_mul_i32 s13, s14, 57344
    s_add_u32 s13, s13, s100
    s_lshl_b32 s14, s14, 12
    s_add_u32 s14, s14, s101
    s_cmp_lt_u32 s15, 64
    s_cselect_b64 s[56:57], s[56:57], s[52:53]
    s_cselect_b32 s13, s13, s14
    s_cselect_b64 vcc, -1, 0
    v_cndmask_b32 v209, v210, v209, vcc
    s_add_u32 s15, s15, 1
    buffer_load_dwordx4 v209, s[56:59], s13 offen lds
    s_nop 2
fk_win1:
    s_mov_b32 s42, 0
    s_waitcnt vmcnt(0)
    s_nop 0
fk_pollw:
    buffer_load_dwordx4 v[184:187], v12, s[24:27], s37 offen sc1
    buffer_load_dwordx4 v[188:191], v12, s[24:27], s38 offen sc1
    buffer_load_dword v5, v192, s[24:27], s23 offen sc1
    s_waitcnt vmcnt(1)
    v_add3_u32 v3, v184, v185, v186
    v_add_u32 v3, v3, v187
    v_add3_u32 v4, v188, v189, v190
    v_add_u32 v4, v4, v191
    ds_write_b128 v7, v[184:187]
    v_add_u32_dpp v3, v3, v3 quad_perm:[1,0,3,2] row_mask:0xf bank_mask:0xf
    v_add_u32_dpp v4, v4, v4 quad_perm:[1,0,3,2] row_mask:0xf bank_mask:0xf
    ds_write_b128 v7, v[188:191] offset:1024
    v_cndmask_b32 v3, v3, v4, s[4:5]
    v_add_u32 v3, s43, v3
    s_waitcnt vmcnt(0)
    v_cmp_ne_u32 vcc, v3, v5
    s_add_u32 s42, s42, 1
    s_cbranch_vccz fk_gotw
    s_cmp_le_u32 s42, 0x40000
    s_cbranch_scc1 fk_pollw
    s_nop 0
fk_gotw:
    s_waitcnt lgkmcnt(0)
    s_barrier
    s_setprio 0
    s_or_b32 s13, s3, s16
    s_cbranch_scc1 fk_nobump
    v_mov_b32 v3, s43
    s_mov_b64 exec, 1
    buffer_store_dword v3, v14, s[24:27], 0 offen sc1
    s_mov_b64 exec, -1
    s_nop 1
fk_nobump:
    s_lshl_b32 s13, s16, 10
    s_add_u32 s14, s13, 0x11000
    s_add_u32 s13, s13, 114688
    v_add_u32 v7, s13, v14
    v_mov_b32 v3, 4096
    s_mov_b32 s15, 0x11000
    v_mov_b32 v8, 157152
    buffer_load_dwordx4 v[184:187], v14, s[24:27], s14 offen sc1
    buffer_load_dword v188, v3, s[24:27], s15 offen sc1
    s_mov_b32 s40, s14
    s_mov_b32 s41, s15
    s_cmp_gt_u32 s3, 223
    s_cbranch_scc1 fk_win2
    s_mul_i32 s15, s16, 4
    s_add_u32 s15, s15, 24
    s_cmp_ge_u32 s15, 32
    s_cselect_b32 s12, 32, 0
    s_add_u32 s15, s15, s12
    s_mov_b32 s58, 0x700000
    s_mov_b32 s59, 0x00020000
    s_cmp_gt_u32 s15, 95
    s_cbranch_scc1 fk_win2
    s_lshl_b32 s12, s15, 10
    s_mov_b32 m0, s12
    s_and_b32 s14, s12, 1024
    s_lshr_b32 s14, s14, 4
    v_xor_b32 v209, s14, v208
    s_cmp_lt_u32 s15, 32
    s_cselect_b64 s[56:57], s[44:45], s[48:49]
    s_and_b32 s14, s15, 31
    s_mul_i32 s13, s14, 57344
    s_add_u32 s13, s13, s100
    s_lshl_b32 s14, s14, 12
    s_add_u32 s14, s14, s101
    s_cmp_lt_u32 s15, 64
    s_cselect_b64 s[56:57], s[56:57], s[52:53]
    s_cselect_b32 s13, s13, s14
    s_cselect_b64 vcc, -1, 0
    v_cndmask_b32 v209, v210, v209, vcc
    s_add_u32 s15, s15, 1
    buffer_load_dwordx4 v209, s[56:59], s13 offen lds
    s_cmp_gt_u32 s15, 95
    s_cbranch_scc1 fk_win2
    s_lshl_b32 s12, s15, 10
    s_mov_b32 m0, s12
    s_and_b32 s14, s12, 1024
    s_lshr_b32 s14, s14, 4
    v_xor_b32 v209, s14, v208
    s_cmp_lt_u32 s15, 32
    s_cselect_b64 s[56:57], s[44:45], s[48:49]
    s_and_b32 s14, s15, 31
    s_mul_i32 s13, s14, 57344
    s_add_u32 s13, s13, s100
    s_lshl_b32 s14, s14, 12
    s_add_u32 s14, s14, s101
    s_cmp_lt_u32 s15, 64
    s_cselect_b64 s[56:57], s[56:57], s[52:53]
    s_cselect_b32 s13, s13, s14
    s_cselect_b64 vcc, -1, 0
    v_cndmask_b32 v209, v210, v209, vcc
    s_add_u32 s15, s15, 1
    buffer_load_dwordx4 v209, s[56:59], s13 offen lds
    s_cmp_gt_u32 s15, 95
    s_cbranch_scc1 fk_win2
    s_lshl_b32 s12, s15, 10
    s_mov_b32 m0, s12
    s_and_b32 s14, s12, 1024
    s_lshr_b32 s14, s14, 4
    v_xor_b32 v209, s14, v208
    s_cmp_lt_u32 s15, 32
    s_cselect_b64 s[56:57], s[44:45], s[48:49]
    s_and_b32 s14, s15, 31
    s_mul_i32 s13, s14, 57344
    s_add_u32 s13, s13, s100
    s_lshl_b32 s14, s14, 12
    s_add_u32 s14, s14, s101
    s_cmp_lt_u32 s15, 64
    s_cselect_b64 s[56:57], s[56:57], s[52:53]
    s_cselect_b32 s13, s13, s14
    s_cselect_b64 vcc, -1, 0
    v_cndmask_b32 v209, v210, v209, vcc
    s_add_u32 s15, s15, 1
    buffer_load_dwordx4 v209, s[56:59], s13 offen lds
    s_cmp_gt_u32 s15, 95
    s_cbranch_scc1 fk_win2
    s_lshl_b32 s12, s15, 10
    s_mov_b32 m0, s12
    s_and_b32 s14, s12, 1024
    s_lshr_b32 s14, s14, 4
    v_xor_b32 v209, s14, v208
    s_cmp_lt_u32 s15, 32
    s_cselect_b64 s[56:57], s[44:45], s[48:49]
    s_and_b32 s14, s15, 31
    s_mul_i32 s13, s14, 57344
    s_add_u32 s13, s13, s100
    s_lshl_b32 s14, s14, 12
    s_add_u32 s14, s14, s101
    s_cmp_lt_u32 s15, 64
    s_cselect_b64 s[56:57], s[56:57], s[52:53]
    s_cselect_b32 s13, s13, s14
    s_cselect_b64 vcc, -1, 0
    v_cndmask_b32 v209, v210, v209, vcc
    s_add_u32 s15, s15, 1
    buffer_load_dwordx4 v209, s[56:59], s13 offen lds
    s_nop 2
fk_win2:
    s_mov_b32 s42, 0
    s_cmp_gt_u32 s3, 223
    s_cbranch_scc1 fk_pollg
    s_waitcnt vmcnt(4)
    s_branch fk_chkg
    s_nop 0
fk_pollg:
    buffer_load_dwordx4 v[184:187], v14, s[24:27], s40 offen sc1
    buffer_load_dword v188, v3, s[24:27], s41 offen sc1
    s_waitcnt vmcnt(0)
    s_nop 0
fk_chkg:
    s_add_u32 s42, s42, 1
    v_max3_u32 v4, v184, v185, v186
    v_max3_u32 v4, v4, v187, v188
    v_cmp_eq_u32 vcc, -1, v4
    s_cbranch_vccz fk_gotg
    s_cmp_le_u32 s42, 0x40000
    s_cbranch_scc1 fk_pollg
    s_nop 1
fk_gotg:
    ds_write_b128 v7, v[184:187]
    ds_write_b32 v8, v188
    s_branch fk_common
    s_nop 0
fk_w4:
    v_min_u32 v184, -2, v176
    v_min_u32 v185, -2, v178
    v_min_u32 v186, -2, v180
    v_min_u32 v187, -2, v182
    v_min_u32 v8, -2, v8
    v_mov_b32 v4, 4096
    s_mov_b32 s14, 0x13000
    s_mov_b32 s15, 0x11000
    s_nop 2
fk_w4s:
    ds_read_b32 v3, v205
    s_waitcnt lgkmcnt(0)
    v_cmp_eq_u32 vcc, 0, v3
    s_nop 1
    s_and_b32 s13, vcc_lo, 32
    s_cbranch_scc1 fk_w4s
    buffer_store_dwordx4 v[184:187], v14, s[24:27], s14 offen sc1
    s_mov_b64 exec, 0x10000
    buffer_store_dword v8, v4, s[24:27], s15 offen sc1
    s_mov_b64 exec, -1
    s_branch fk_Hconst
    s_nop 0
fk_H:
    s_barrier
    s_cmp_lg_u32 s16, 7
    s_cbranch_scc1 fk_Hconst
    v_mov_b32 v4, -1
    v_mov_b32 v5, -1
    v_mov_b32 v6, -1
    v_mov_b32 v7, -1
    v_mov_b32 v3, 157120
    v_mov_b32 v8, 0
    ds_write_b32 v3, v8
    v_lshlrev_b32 v3, 12, v15
    s_lshl_b32 s13, s3, 4
    s_add_u32 s14, s13, 0x9000
    s_add_u32 s15, s13, 0x11000
    v_mov_b32 v201, 157844
    v_mov_b32 v204, 1
    s_waitcnt lgkmcnt(0)
    s_load_dword s56, s[24:25], 0
    s_mov_b64 exec, 0xff
    buffer_store_dwordx4 v[4:7], v3, s[24:27], s14 offen sc1
    s_cmp_eq_u32 s3, 255
    s_cselect_b32 exec_lo, 3, 1
    buffer_store_dwordx4 v[4:7], v14, s[24:27], s15 offen sc1
    s_mov_b64 exec, -1
    s_mov_b32 m0, 155008
    s_mov_b32 s12, 0
    buffer_load_dwordx4 v14, s[32:35], s12 offen lds
    s_mov_b32 m0, 156032
    s_mov_b32 s12, 1024
    buffer_load_dwordx4 v14, s[32:35], s12 offen lds
    s_cmp_eq_u32 s3, 255
    s_cselect_b32 s12, 0x13000, s26
    buffer_store_dwordx4 v[4:7], v14, s[24:27], s12 offen sc1
    s_cmp_lg_u32 s3, 248
    s_cbranch_scc1 fk_no1024
    s_mov_b32 m0, 118784
    s_mov_b32 s14, 2097152
    buffer_load_dwordx4 v14, s[8:11], s14 offen lds
    s_mov_b32 m0, 119808
    s_mov_b32 s14, 2098176
    buffer_load_dwordx4 v14, s[8:11], s14 offen lds
fk_no1024:
    s_mul_i32 s38, s3, 8320
    s_add_u32 s38, s38, 0x268000
    s_add_u32 s39, s38, 4096
    s_waitcnt vmcnt(0) lgkmcnt(0)
    s_add_u32 s57, s56, 1
    v_mov_b32 v202, s57
    ds_write_b32 v201, v202 offset:8
    ds_write_b32 v201, v204
    buffer_store_dwordx4 v[4:7], v14, s[24:27], s38 offen offset:0 sc1
    buffer_store_dwordx4 v[4:7], v14, s[24:27], s38 offen offset:1024 sc1
    buffer_store_dwordx4 v[4:7], v14, s[24:27], s38 offen offset:2048 sc1
    buffer_store_dwordx4 v[4:7], v14, s[24:27], s38 offen offset:3072 sc1
    buffer_store_dwordx4 v[4:7], v14, s[24:27], s39 offen offset:0 sc1
    buffer_store_dwordx4 v[4:7], v14, s[24:27], s39 offen offset:1024 sc1
    buffer_store_dwordx4 v[4:7], v14, s[24:27], s39 offen offset:2048 sc1
    buffer_store_dwordx4 v[4:7], v14, s[24:27], s39 offen offset:3072 sc1
    s_waitcnt lgkmcnt(0)
    s_add_u32 s56, s56, 1
    v_mov_b32 v202, s56
    ds_write_b32 v201, v202 offset:8
    s_waitcnt vmcnt(8)
    ds_write_b32 v201, v204
    s_waitcnt vmcnt(0)
    ds_write_b32 v201, v204 offset:4
fk_Hconst:
    s_sub_u32 s20, s16, 4
    v_lshrrev_b32 v208, 3, v15
    v_and_b32 v209, 7, v15
    v_and_b32 v210, 2, v208
    v_xor_b32 v209, v210, v209
    v_mul_u32_u24 v208, 7168, v208
    v_lshl_add_u32 v208, v209, 4, v208
    v_lshrrev_b32 v210, 5, v15
    v_lshlrev_b32 v210, 11, v210
    v_and_b32 v209, 31, v15
    v_lshl_add_u32 v210, v209, 4, v210
    s_and_b32 s12, s3, 3
    s_mul_i32 s100, s12, 1835008
    s_lshl_b32 s101, s12, 9
    s_lshr_b32 s12, s3, 2
    s_lshl_b32 s12, s12, 7
    s_add_u32 s100, s100, s12
    s_lshl_b32 s12, s12, 10
    s_add_u32 s101, s101, s12
    s_and_b32 s12, s20, 1
    s_lshl_b32 s12, s12, 6
    v_xor_b32 v206, s12, v208
    v_xor_b32 v207, 64, v206
    s_mov_b32 s6, 0x700000
    s_mov_b32 s7, 0x00020000
    s_cmp_gt_u32 s3, 223
    s_cselect_b32 s36, 3, s20
    s_waitcnt lgkmcnt(0)
    v_lshrrev_b32 v4, 1, v1
    v_and_b32 v5, 1, v4
    v_lshrrev_b32 v6, 2, v4
    v_lshl_add_u32 v5, v6, 1, v5
    v_and_b32 v6, 2, v4
    v_lshl_add_u32 v5, v6, 2, v5
    s_and_b32 s13, s20, 1
    s_mul_i32 s13, s13, 15
    v_xor_b32 v5, s13, v5
    s_lshl_b32 s13, s20, 4
    v_add_u32 v5, s13, v5
    v_cvt_f32_u32 v5, v5
    v_and_b32 v9, 1, v1
    v_lshlrev_b32 v7, 2, v2
    v_cvt_f32_u32 v7, v7
    v_cvt_f32_u32 v10, v9
    v_mul_f32 v8, 0x3c800000, v5
    v_mul_f32 v10, 0x3e800000, v10
    v_fma_f32 v10, v8, v7, v10
    v_mov_b32 v128, v10
    v_fmamk_f32 v129, v8, 0x3f800000, v10
    v_fmamk_f32 v130, v8, 0x40000000, v10
    v_fmamk_f32 v131, v8, 0x40400000, v10
    v_fmamk_f32 v132, v8, 0x41000000, v10
    v_fmamk_f32 v133, v8, 0x41100000, v10
    v_fmamk_f32 v134, v8, 0x41200000, v10
    v_fmamk_f32 v135, v8, 0x41300000, v10
    v_fmamk_f32 v136, v8, 0x41800000, v10
    v_fmamk_f32 v137, v8, 0x41880000, v10
    v_fmamk_f32 v138, v8, 0x41900000, v10
    v_fmamk_f32 v139, v8, 0x41980000, v10
    v_fmamk_f32 v140, v8, 0x41c00000, v10
    v_fmamk_f32 v141, v8, 0x41c80000, v10
    v_fmamk_f32 v142, v8, 0x41d00000, v10
    v_fmamk_f32 v143, v8, 0x41d80000, v10
    v_cos_f32 v144, v128
    v_cos_f32 v145, v129
    v_cos_f32 v146, v130
    v_cos_f32 v147, v131
    v_cos_f32 v148, v132
    v_cos_f32 v149, v133
    v_cos_f32 v150, v134
    v_cos_f32 v151, v135
    v_cos_f32 v152, v136
    v_cos_f32 v153, v137
    v_cos_f32 v154, v138
    v_cos_f32 v155, v139
    v_cos_f32 v156, v140
    v_cos_f32 v157, v141
    v_cos_f32 v158, v142
    v_cos_f32 v159, v143
    v_sin_f32 v160, v128
    v_sin_f32 v161, v129
    v_sin_f32 v162, v130
    v_sin_f32 v163, v131
    v_sin_f32 v164, v132
    v_sin_f32 v165, v133
    v_sin_f32 v166, v134
    v_sin_f32 v167, v135
    v_sin_f32 v168, v136
    v_sin_f32 v169, v137
    v_sin_f32 v170, v138
    v_sin_f32 v171, v139
    v_sin_f32 v172, v140
    v_sin_f32 v173, v141
    v_sin_f32 v174, v142
    v_sin_f32 v175, v143
    v_cvt_pk_f16_f32 v48, v144, v160
    v_cvt_pk_f16_f32 v49, v145, v161
    v_cvt_pk_f16_f32 v50, v146, v162
    v_cvt_pk_f16_f32 v51, v147, v163
    v_cvt_pk_f16_f32 v52, v148, v164
    v_cvt_pk_f16_f32 v53, v149, v165
    v_cvt_pk_f16_f32 v54, v150, v166
    v_cvt_pk_f16_f32 v55, v151, v167
    v_cvt_pk_f16_f32 v56, v152, v168
    v_cvt_pk_f16_f32 v57, v153, v169
    v_cvt_pk_f16_f32 v58, v154, v170
    v_cvt_pk_f16_f32 v59, v155, v171
    v_cvt_pk_f16_f32 v60, v156, v172
    v_cvt_pk_f16_f32 v61, v157, v173
    v_cvt_pk_f16_f32 v62, v158, v174
    s_cmp_eq_u32 s36, 3
    s_cbranch_scc1 fk_gu0
    s_add_u32 s37, s20, 0
    s_lshl_b32 s12, s37, 10
    s_mov_b32 m0, s12
    s_cmp_lt_u32 s37, 32
    s_cselect_b64 s[4:5], s[44:45], s[48:49]
    s_and_b32 s37, s37, 31
    s_mul_i32 s37, s37, 57344
    s_add_u32 s37, s37, s100
    buffer_load_dwordx4 v206, s[4:7], s37 offen lds
fk_gu0:
    s_cmp_eq_u32 s36, 3
    s_cbranch_scc1 fk_gu1
    s_add_u32 s37, s20, 3
    s_lshl_b32 s12, s37, 10
    s_mov_b32 m0, s12
    s_cmp_lt_u32 s37, 32
    s_cselect_b64 s[4:5], s[44:45], s[48:49]
    s_and_b32 s37, s37, 31
    s_mul_i32 s37, s37, 57344
    s_add_u32 s37, s37, s100
    buffer_load_dwordx4 v207, s[4:7], s37 offen lds
fk_gu1:
    s_cmp_eq_u32 s36, 3
    s_cbranch_scc1 fk_gu2
    s_add_u32 s37, s20, 6
    s_lshl_b32 s12, s37, 10
    s_mov_b32 m0, s12
    s_cmp_lt_u32 s37, 32
    s_cselect_b64 s[4:5], s[44:45], s[48:49]
    s_and_b32 s37, s37, 31
    s_mul_i32 s37, s37, 57344
    s_add_u32 s37, s37, s100
    buffer_load_dwordx4 v206, s[4:7], s37 offen lds
fk_gu2:
    s_cmp_eq_u32 s36, 3
    s_cbranch_scc1 fk_gu3
    s_add_u32 s37, s20, 9
    s_lshl_b32 s12, s37, 10
    s_mov_b32 m0, s12
    s_cmp_lt_u32 s37, 32
    s_cselect_b64 s[4:5], s[44:45], s[48:49]
    s_and_b32 s37, s37, 31
    s_mul_i32 s37, s37, 57344
    s_add_u32 s37, s37, s100
    buffer_load_dwordx4 v207, s[4:7], s37 offen lds
fk_gu3:
    v_cvt_pk_f16_f32 v63, v159, v175
    v_fmamk_f32 v128, v8, 0x42000000, v10
    v_fmamk_f32 v129, v8, 0x42040000, v10
    v_fmamk_f32 v130, v8, 0x42080000, v10
    v_fmamk_f32 v131, v8, 0x420c0000, v10
    v_fmamk_f32 v132, v8, 0x42200000, v10
    v_fmamk_f32 v133, v8, 0x42240000, v10
    v_fmamk_f32 v134, v8, 0x42280000, v10
    v_fmamk_f32 v135, v8, 0x422c0000, v10
    v_fmamk_f32 v136, v8, 0x42400000, v10
    v_fmamk_f32 v137, v8, 0x42440000, v10
    v_fmamk_f32 v138, v8, 0x42480000, v10
    v_fmamk_f32 v139, v8, 0x424c0000, v10
    v_fmamk_f32 v140, v8, 0x42600000, v10
    v_fmamk_f32 v141, v8, 0x42640000, v10
    v_fmamk_f32 v142, v8, 0x42680000, v10
    v_fmamk_f32 v143, v8, 0x426c0000, v10
    v_cos_f32 v144, v128
    v_cos_f32 v145, v129
    v_cos_f32 v146, v130
    v_cos_f32 v147, v131
    v_cos_f32 v148, v132
    v_cos_f32 v149, v133
    v_cos_f32 v150, v134
    v_cos_f32 v151, v135
    v_cos_f32 v152, v136
    v_cos_f32 v153, v137
    v_cos_f32 v154, v138
    v_cos_f32 v155, v139
    v_cos_f32 v156, v140
    v_cos_f32 v157, v141
    v_cos_f32 v158, v142
    v_cos_f32 v159, v143
    v_sin_f32 v160, v128
    v_sin_f32 v161, v129
    v_sin_f32 v162, v130
    v_sin_f32 v163, v131
    v_sin_f32 v164, v132
    v_sin_f32 v165, v133
    v_sin_f32 v166, v134
    v_sin_f32 v167, v135
    v_sin_f32 v168, v136
    v_sin_f32 v169, v137
    v_sin_f32 v170, v138
    v_sin_f32 v171, v139
    v_sin_f32 v172, v140
    v_sin_f32 v173, v141
    v_sin_f32 v174, v142
    v_sin_f32 v175, v143
    v_cvt_pk_f16_f32 v64, v144, v160
    v_cvt_pk_f16_f32 v65, v145, v161
    v_cvt_pk_f16_f32 v66, v146, v162
    v_cvt_pk_f16_f32 v67, v147, v163
    v_cvt_pk_f16_f32 v68, v148, v164
    v_cvt_pk_f16_f32 v69, v149, v165
    v_cvt_pk_f16_f32 v70, v150, v166
    v_cvt_pk_f16_f32 v71, v151, v167
    v_cvt_pk_f16_f32 v72, v152, v168
    v_cvt_pk_f16_f32 v73, v153, v169
    v_cvt_pk_f16_f32 v74, v154, v170
    v_cvt_pk_f16_f32 v75, v155, v171
    v_cvt_pk_f16_f32 v76, v156, v172
    v_cvt_pk_f16_f32 v77, v157, v173
    v_cvt_pk_f16_f32 v78, v158, v174
    v_cvt_pk_f16_f32 v79, v159, v175
    v_lshlrev_b32 v11, 31, v9
    v_mul_f32 v10, 0x3a000000, v5
    v_xor_b32 v10, v11, v10
    v_mul_f32 v11, v10, v7
    v_mov_b32 v128, v11
    v_fmamk_f32 v129, v10, 0x3f800000, v11
    v_fmamk_f32 v130, v10, 0x40000000, v11
    v_fmamk_f32 v131, v10, 0x40400000, v11
    v_fmamk_f32 v132, v10, 0x41000000, v11
    v_fmamk_f32 v133, v10, 0x41100000, v11
    v_fmamk_f32 v134, v10, 0x41200000, v11
    v_fmamk_f32 v135, v10, 0x41300000, v11
    v_fmamk_f32 v136, v10, 0x41800000, v11
    v_fmamk_f32 v137, v10, 0x41880000, v11
    v_fmamk_f32 v138, v10, 0x41900000, v11
    v_fmamk_f32 v139, v10, 0x41980000, v11
    v_fmamk_f32 v140, v10, 0x41c00000, v11
    v_fmamk_f32 v141, v10, 0x41c80000, v11
    v_fmamk_f32 v142, v10, 0x41d00000, v11
    v_fmamk_f32 v143, v10, 0x41d80000, v11
    v_cos_f32 v80, v128
    v_cos_f32 v81, v129
    v_cos_f32 v82, v130
    v_cos_f32 v83, v131
    v_cos_f32 v84, v132
    v_cos_f32 v85, v133
    v_cos_f32 v86, v134
    v_cos_f32 v87, v135
    v_cos_f32 v88, v136
    v_cos_f32 v89, v137
    v_cos_f32 v90, v138
    v_cos_f32 v91, v139
    v_cos_f32 v92, v140
    v_cos_f32 v93, v141
    v_cos_f32 v94, v142
    v_cos_f32 v95, v143
    v_sin_f32 v96, v128
    v_sin_f32 v97, v129
    v_sin_f32 v98, v130
    v_sin_f32 v99, v131
    v_sin_f32 v100, v132
    v_sin_f32 v101, v133
    v_sin_f32 v102, v134
    v_sin_f32 v103, v135
    v_sin_f32 v104, v136
    v_sin_f32 v105, v137
    v_sin_f32 v106, v138
    v_sin_f32 v107, v139
    v_sin_f32 v108, v140
    v_sin_f32 v109, v141
    v_sin_f32 v110, v142
    v_sin_f32 v111, v143
    v_sub_u32 v4, 31, v1
    v_subrev_u32 v5, 1, v1
    v_cmp_lt_u32 vcc, 16, v1
    s_nop 1
    v_cndmask_b32 v4, v5, v4, vcc
    v_and_b32 v4, 15, v4
    v_lshlrev_b32 v4, 5, v4
    v_add_u32 v4, 130304, v4
    v_lshlrev_b32 v5, 9, v2
    v_add_u32 v6, v4, v5
    v_sub_u32 v7, v4, v5
    v_add_u32 v7, 7696, v7
    v_cmp_eq_u32 s[38:39], 0, v1
    v_mov_b32 v8, 4096
    s_nop 0
    v_cndmask_b32 v8, 0, v8, s[38:39]
    v_add_u32 v6, v6, v8
    v_add_u32 v7, v7, v8
    v_and_b32 v8, 15, v1
    v_cmp_eq_u32 s[38:39], 0, v8
    s_nop 1
    s_or_b64 s[40:41], s[38:39], vcc
    v_add_u32 v184, 0, v6
    v_subrev_u32 v8, 0, v7
    v_cndmask_b32 v184, v184, v8, vcc
    v_add_u32 v185, 1024, v6
    v_subrev_u32 v8, 1024, v7
    v_cndmask_b32 v185, v185, v8, vcc
    v_add_u32 v186, 2048, v6
    v_subrev_u32 v8, 2048, v7
    v_cndmask_b32 v186, v186, v8, vcc
    v_add_u32 v187, 3072, v6
    v_subrev_u32 v8, 3072, v7
    v_cndmask_b32 v187, v187, v8, vcc
    v_add_u32 v188, 4096, v6
    v_subrev_u32 v8, 4096, v7
    v_cndmask_b32 v188, v188, v8, s[40:41]
    v_add_u32 v189, 5120, v6
    v_subrev_u32 v8, 5120, v7
    v_cndmask_b32 v189, v189, v8, s[40:41]
    v_add_u32 v190, 6144, v6
    v_subrev_u32 v8, 6144, v7
    v_cndmask_b32 v190, v190, v8, s[40:41]
    v_add_u32 v191, 7168, v6
    v_subrev_u32 v8, 7168, v7
    v_cndmask_b32 v191, v191, v8, s[40:41]
    v_add_u32 v212, 512, v188
    v_add_u32 v213, 512, v189
    v_add_u32 v214, 512, v190
    v_add_u32 v215, 512, v191
    v_subrev_u32 v8, 4096, v212
    v_cmp_eq_u32 vcc, 0, v2
    s_nop 1
    v_cndmask_b32 v212, v212, v8, vcc
    s_lshr_b32 s13, s20, 1
    v_lshl_add_u32 v3, v1, 1, s13
    s_and_b32 s13, s20, 1
    s_sub_u32 s14, 64, s13
    v_and_b32 v8, 3, v3
    v_lshlrev_b32 v8, 2, v8
    v_lshlrev_b32 v4, 3, v3
    v_sub_u32 v4, v4, v8
    v_sub_u32 v5, 63, v3
    v_and_b32 v8, 3, v5
    v_mul_u32_u24 v8, 12, v8
    v_lshlrev_b32 v6, 3, v5
    v_sub_u32 v6, v6, v8
    v_add_u32 v6, 28, v6
    v_sub_u32 v5, s14, v3
    v_and_b32 v8, 3, v5
    v_mul_u32_u24 v8, 12, v8
    v_lshlrev_b32 v7, 3, v5
    v_sub_u32 v7, v7, v8
    v_add_u32 v7, 28, v7
    v_cmp_gt_u32 vcc, 32, v3
    s_nop 1
    v_cndmask_b32 v7, v7, v4, vcc
    v_cmp_eq_u32 vcc, 32, v5
    s_nop 1
    v_cndmask_b32 v7, v7, 28, vcc
    s_cmp_eq_u32 s13, 0
    s_cselect_b32 s14, 256, 0
    s_cselect_b32 s15, 576, 0
    s_cselect_b64 s[38:39], -1, 0
    s_add_u32 s14, s14, 7680
    s_sub_u32 s15, 120832, s15
    v_cmp_gt_u32 vcc, 32, v3
    s_nop 1
    v_cndmask_b32 v7, v7, v4, vcc
    v_add_u32 v7, s14, v7
    v_cndmask_b32 v4, v6, v4, s[38:39]
    v_lshl_add_u32 v4, v2, 12, v4
    v_lshrrev_b32 v8, 7, v4
    v_lshl_add_u32 v4, v8, 4, v4
    v_lshrrev_b32 v8, 7, v7
    v_lshl_add_u32 v7, v8, 4, v7
    v_add_u32 v11, s15, v4
    v_add_u32 v7, 120832, v7
    v_add_u32 v12, 4032, v11
    v_cmp_eq_u32 vcc, s13, v2
    s_nop 1
    s_and_b64 s[40:41], vcc, s[38:39]
    s_andn2_b64 s[38:39], vcc, s[38:39]
    v_cndmask_b32 v10, v11, v7, s[40:41]
    v_cndmask_b32 v12, v12, v7, s[38:39]
    s_lshl_b32 s23, s20, 5
    s_add_u32 s23, s23, s18
    v_and_b32 v3, 15, v15
    v_lshrrev_b32 v4, 4, v15
    v_lshl_add_u32 v3, v3, 7, v4
    v_add_u32 v3, 1, v3
    v_cmp_le_u32 vcc, 56, v15
    v_mov_b32 v4, 1008
    s_nop 0
    v_cndmask_b32 v4, 0, v4, vcc
    v_add_u32 v4, v3, v4
    v_mul_u32_u24 v3, s23, v3
    v_and_b32 v3, 2047, v3
    v_cvt_f32_u32 v3, v3
    v_mul_f32 v3, 0x3a000000, v3
    v_mul_u32_u24 v4, s23, v4
    v_and_b32 v4, 2047, v4
    v_cvt_f32_u32 v4, v4
    v_mul_f32 v4, 0x3a000000, v4
    v_cvt_f32_u32 v5, s23
    v_mul_f32 v5, 0x3a000000, v5
    v_mov_b32 v192, v3
    v_fmamk_f32 v193, v5, 0x42000000, v3
    v_fmamk_f32 v194, v5, 0x42800000, v3
    v_fmamk_f32 v195, v5, 0x42c00000, v3
    v_fmamk_f32 v196, v5, 0x40800000, v3
    v_fmamk_f32 v197, v5, 0x42100000, v3
    v_fmamk_f32 v198, v5, 0x42880000, v3
    v_fmamk_f32 v199, v5, 0x42c80000, v3
    v_fmamk_f32 v200, v5, 0x41000000, v3
    v_fmamk_f32 v201, v5, 0x42200000, v3
    v_fmamk_f32 v202, v5, 0x42900000, v3
    v_fmamk_f32 v203, v5, 0x42d00000, v3
    v_fmamk_f32 v204, v5, 0x41400000, v4
    v_fmamk_f32 v205, v5, 0x42300000, v4
    v_fmamk_f32 v206, v5, 0x42980000, v4
    v_fmamk_f32 v207, v5, 0x42d80000, v4
    v_cos_f32 v192, v192
    v_cos_f32 v193, v193
    v_cos_f32 v194, v194
    v_cos_f32 v195, v195
    v_cos_f32 v196, v196
    v_cos_f32 v197, v197
    v_cos_f32 v198, v198
    v_cos_f32 v199, v199
    v_cos_f32 v200, v200
    v_cos_f32 v201, v201
    v_cos_f32 v202, v202
    v_cos_f32 v203, v203
    v_cos_f32 v204, v204
    v_cos_f32 v205, v205
    v_cos_f32 v206, v206
    v_cos_f32 v207, v207
    v_add_u32 v9, 138496, v14
    v_mov_b32 v3, 157864
    s_nop 4
fk_c2s:
    ds_read_b32 v4, v3
    s_waitcnt lgkmcnt(0)
    v_readfirstlane_b32 s13, v4
    s_nop 1
    s_cmp_eq_u32 s13, 0
    s_cbranch_scc1 fk_c2s
    ds_read_b128 v[112:115], v9 offset:12288
    ds_read_b128 v[116:119], v9 offset:13312
    ds_read_b128 v[120:123], v9 offset:14336
    ds_read_b128 v[124:127], v9 offset:15360
    s_setprio 2
    s_waitcnt lgkmcnt(0)
    s_barrier
    ds_read_b128 v[16:19], v184
    ds_read_b128 v[20:23], v185
    ds_read_b128 v[24:27], v186
    ds_read_b128 v[28:31], v187
    ds_read_b128 v[32:35], v188
    ds_read_b128 v[36:39], v189
    ds_read_b128 v[40:43], v190
    ds_read_b128 v[44:47], v191
    s_mov_b32 exec_lo, 1
    s_mov_b32 exec_hi, 1
    ds_read_b32 v32, v212
    ds_read_b32 v36, v213
    ds_read_b32 v40, v214
    ds_read_b32 v44, v215
    s_mov_b64 exec, -1
    s_waitcnt lgkmcnt(11)
    v_mfma_f32_32x32x16_f16 v[128:143], v[16:19], v[48:51], 0
    s_waitcnt lgkmcnt(10)
    v_mfma_f32_32x32x16_f16 v[128:143], v[20:23], v[52:55], v[128:143]
    s_waitcnt lgkmcnt(9)
    v_mfma_f32_32x32x16_f16 v[128:143], v[24:27], v[56:59], v[128:143]
    s_waitcnt lgkmcnt(8)
    v_mfma_f32_32x32x16_f16 v[128:143], v[28:31], v[60:63], v[128:143]
    s_waitcnt lgkmcnt(3)
    v_mfma_f32_32x32x16_f16 v[128:143], v[32:35], v[64:67], v[128:143]
    s_waitcnt lgkmcnt(2)
    v_mfma_f32_32x32x16_f16 v[128:143], v[36:39], v[68:71], v[128:143]
    s_waitcnt lgkmcnt(1)
    v_mfma_f32_32x32x16_f16 v[128:143], v[40:43], v[72:75], v[128:143]
    s_waitcnt lgkmcnt(0)
    v_mfma_f32_32x32x16_f16 v[128:143], v[44:47], v[76:79], v[128:143]
    s_nop 11
    v_pk_mul_f32 v[16:17], v[128:129], v[80:81]
    v_pk_mul_f32 v[18:19], v[130:131], v[82:83]
    v_pk_mul_f32 v[20:21], v[132:133], v[84:85]
    v_pk_mul_f32 v[22:23], v[134:135], v[86:87]
    v_pk_mul_f32 v[24:25], v[136:137], v[88:89]
    v_pk_mul_f32 v[26:27], v[138:139], v[90:91]
    v_pk_mul_f32 v[28:29], v[140:141], v[92:93]
    v_pk_mul_f32 v[30:31], v[142:143], v[94:95]
    v_fmac_f32_dpp v16, v128, v96 quad_perm:[1,0,3,2] row_mask:0xf bank_mask:0xf
    v_fmac_f32_dpp v17, v129, v97 quad_perm:[1,0,3,2] row_mask:0xf bank_mask:0xf
    v_fmac_f32_dpp v18, v130, v98 quad_perm:[1,0,3,2] row_mask:0xf bank_mask:0xf
    v_fmac_f32_dpp v19, v131, v99 quad_perm:[1,0,3,2] row_mask:0xf bank_mask:0xf
    v_fmac_f32_dpp v20, v132, v100 quad_perm:[1,0,3,2] row_mask:0xf bank_mask:0xf
    v_fmac_f32_dpp v21, v133, v101 quad_perm:[1,0,3,2] row_mask:0xf bank_mask:0xf
    v_fmac_f32_dpp v22, v134, v102 quad_perm:[1,0,3,2] row_mask:0xf bank_mask:0xf
    v_fmac_f32_dpp v23, v135, v103 quad_perm:[1,0,3,2] row_mask:0xf bank_mask:0xf
    v_cvt_pk_f16_f32 v176, v16, v17
    v_cvt_pk_f16_f32 v177, v18, v19
    v_cvt_pk_f16_f32 v178, v20, v21
    v_cvt_pk_f16_f32 v179, v22, v23
    v_fmac_f32_dpp v24, v136, v104 quad_perm:[1,0,3,2] row_mask:0xf bank_mask:0xf
    v_fmac_f32_dpp v25, v137, v105 quad_perm:[1,0,3,2] row_mask:0xf bank_mask:0xf
    v_mfma_f32_32x32x16_f16 v[144:159], v[176:179], v[112:115], 0
    v_fmac_f32_dpp v26, v138, v106 quad_perm:[1,0,3,2] row_mask:0xf bank_mask:0xf
    v_fmac_f32_dpp v27, v139, v107 quad_perm:[1,0,3,2] row_mask:0xf bank_mask:0xf
    v_fmac_f32_dpp v28, v140, v108 quad_perm:[1,0,3,2] row_mask:0xf bank_mask:0xf
    v_fmac_f32_dpp v29, v141, v109 quad_perm:[1,0,3,2] row_mask:0xf bank_mask:0xf
    v_fmac_f32_dpp v30, v142, v110 quad_perm:[1,0,3,2] row_mask:0xf bank_mask:0xf
    v_mfma_f32_32x32x16_f16 v[160:175], v[176:179], v[120:123], 0
    v_fmac_f32_dpp v31, v143, v111 quad_perm:[1,0,3,2] row_mask:0xf bank_mask:0xf
    v_cvt_pk_f16_f32 v180, v24, v25
    v_cvt_pk_f16_f32 v181, v26, v27
    v_cvt_pk_f16_f32 v182, v28, v29
    v_cvt_pk_f16_f32 v183, v30, v31
    s_nop 1
    v_mfma_f32_32x32x16_f16 v[144:159], v[180:183], v[116:119], v[144:159]
    v_mfma_f32_32x32x16_f16 v[160:175], v[180:183], v[124:127], v[160:175]
    s_nop 11
    v_pk_add_f32 v[16:17], v[144:145], v[160:161] op_sel:[0,1] op_sel_hi:[1,0] neg_hi:[0,1]
    v_pk_add_f32 v[18:19], v[146:147], v[162:163] op_sel:[0,1] op_sel_hi:[1,0] neg_hi:[0,1]
    v_pk_add_f32 v[20:21], v[148:149], v[164:165] op_sel:[0,1] op_sel_hi:[1,0] neg_hi:[0,1]
    v_pk_add_f32 v[22:23], v[150:151], v[166:167] op_sel:[0,1] op_sel_hi:[1,0] neg_hi:[0,1]
    v_pk_add_f32 v[24:25], v[152:153], v[168:169] op_sel:[0,1] op_sel_hi:[1,0] neg_hi:[0,1]
    v_pk_add_f32 v[26:27], v[154:155], v[170:171] op_sel:[0,1] op_sel_hi:[1,0] neg_hi:[0,1]
    v_pk_add_f32 v[28:29], v[156:157], v[172:173] op_sel:[0,1] op_sel_hi:[1,0] neg_hi:[0,1]
    v_pk_add_f32 v[30:31], v[158:159], v[174:175] op_sel:[0,1] op_sel_hi:[1,0] neg_hi:[0,1]
    v_cvt_pk_f16_f32 v48, v16, v17
    ds_write_b32 v10, v48
    v_cvt_pk_f16_f32 v49, v18, v19
    ds_write_b32 v11, v49 offset:576
    v_cvt_pk_f16_f32 v50, v20, v21
    ds_write_b32 v11, v50 offset:1152
    v_cvt_pk_f16_f32 v51, v22, v23
    ds_write_b32 v11, v51 offset:1728
    v_cvt_pk_f16_f32 v52, v24, v25
    ds_write_b32 v11, v52 offset:2304
    v_cvt_pk_f16_f32 v53, v26, v27
    ds_write_b32 v11, v53 offset:2880
    v_cvt_pk_f16_f32 v54, v28, v29
    ds_write_b32 v11, v54 offset:3456
    v_cvt_pk_f16_f32 v55, v30, v31
    ds_write_b32 v12, v55
    s_nop 3
fk_common:
    v_lshlrev_b32 v4, 4, v0
    v_lshrrev_b32 v5, 3, v0
    v_lshl_add_u32 v5, v5, 4, v4
    v_add_u32 v5, 120832, v5
    s_mul_i32 s17, s3, 8320
    s_add_u32 s17, s17, 0x268000
    s_waitcnt lgkmcnt(0)
    s_barrier
    s_setprio 0
    ds_read_b128 v[16:19], v5
    s_sub_u32 s13, 7, s16
    s_cmp_lt_u32 s16, 4
    s_cselect_b32 s13, s16, s13
    s_cselect_b32 s14, 0, 2048
    s_lshl_b32 s21, s13, 5
    s_add_u32 s21, s21, s18
    s_sub_u32 s22, 2048, s21
    s_and_b32 s22, s22, 2047
    s_cmp_lt_u32 s16, 4
    s_cselect_b32 s21, s21, s22
    s_lshl_b32 s13, s13, 12
    s_add_u32 s13, s13, s14
    s_add_u32 s13, s13, 98304
    s_lshl_b32 s14, s3, 3
    s_add_u32 s19, s14, s16
    s_cmp_eq_u32 s19, 1991
    s_cselect_b32 s21, 1024, s21
    s_cselect_b32 s13, 118784, s13
    s_lshl_b32 s22, s21, 11
    v_add_u32 v6, s13, v14
    v_add_u32 v7, 155008, v14
    s_waitcnt lgkmcnt(0)
    v_min_u32 v16, -2, v16
    v_min_u32 v17, -2, v17
    v_min_u32 v18, -2, v18
    v_min_u32 v19, -2, v19
    buffer_store_dwordx4 v[16:19], v4, s[24:27], s17 offen sc1
    ds_read_b128 v[20:23], v6
    ds_read_b128 v[24:27], v6 offset:1024
    ds_read_b128 v[28:31], v7
    ds_read_b128 v[32:35], v7 offset:1024
    s_cmp_lt_u32 s16, 4
    s_cbranch_scc1 fk_noy5
    v_add_u32 v3, 114688, v14
    v_mov_b32 v4, 157152
    ds_read_b128 v[128:131], v3 offset:0
    ds_read_b128 v[132:135], v3 offset:1024
    ds_read_b128 v[136:139], v3 offset:2048
    ds_read_b128 v[140:143], v3 offset:3072
    ds_read_b32 v9, v4
    s_lshl_b32 s38, s20, 2
    s_sub_u32 s39, 28, s38
    s_waitcnt lgkmcnt(0)
    s_nop 0
fk_y5:
    v_pk_mul_f32 v[144:145], v[128:129], v[192:193]
    v_pk_mul_f32 v[146:147], v[130:131], v[194:195]
    v_pk_fma_f32 v[144:145], v[132:133], v[196:197], v[144:145]
    v_pk_fma_f32 v[146:147], v[134:135], v[198:199], v[146:147]
    v_pk_fma_f32 v[144:145], v[136:137], v[200:201], v[144:145]
    v_pk_fma_f32 v[146:147], v[138:139], v[202:203], v[146:147]
    v_pk_fma_f32 v[144:145], v[140:141], v[204:205], v[144:145]
    v_pk_fma_f32 v[146:147], v[142:143], v[206:207], v[146:147]
    v_pk_add_f32 v[144:145], v[144:145], v[146:147]
    v_add_f32 v144, v144, v145
    s_lshl_b32 s13, s23, 31
    v_xor_b32 v12, s13, v9
    v_add_f32_dpp v144, v144, v144 quad_perm:[1,0,3,2] row_mask:0xf bank_mask:0xf
    s_nop 1
    v_add_f32_dpp v144, v144, v144 quad_perm:[2,3,0,1] row_mask:0xf bank_mask:0xf
    s_nop 1
    v_add_f32_dpp v144, v144, v144 row_half_mirror row_mask:0xf bank_mask:0xf
    s_nop 1
    v_add_f32_dpp v144, v144, v144 row_mirror row_mask:0xf bank_mask:0xf
    s_nop 1
    v_add_f32_dpp v144, v144, v144 row_bcast:15 row_mask:0xa bank_mask:0xf
    s_nop 1
    v_add_f32_dpp v144, v144, v144 row_bcast:31 row_mask:0xc bank_mask:0xf
    v_add_f32 v144, v144, v12
    v_add_f32 v144, v144, v144
    v_cvt_f16_f32 v144, v144
    s_add_u32 s13, s38, 157088
    s_add_u32 s14, s39, 157088
    v_mov_b32 v10, s13
    v_mov_b32 v11, s14
    s_mov_b32 exec_lo, 0
    s_mov_b32 exec_hi, 0x80000000
    ds_write_b32 v10, v144
    ds_write_b32 v11, v144
    s_mov_b64 exec, -1
    s_cmp_lg_u32 s23, 0
    s_cbranch_scc1 fk_noy5
    s_mov_b32 s23, 1024
    s_mov_b32 s38, 28
    v_and_b32 v3, 15, v15
    v_lshrrev_b32 v4, 4, v15
    v_lshl_add_u32 v3, v3, 7, v4
    v_add_u32 v3, 1, v3
    v_cmp_le_u32 vcc, 56, v15
    v_mov_b32 v4, 1008
    s_nop 0
    v_cndmask_b32 v4, 0, v4, vcc
    v_add_u32 v4, v3, v4
    v_mul_u32_u24 v3, s23, v3
    v_and_b32 v3, 2047, v3
    v_cvt_f32_u32 v3, v3
    v_mul_f32 v3, 0x3a000000, v3
    v_mul_u32_u24 v4, s23, v4
    v_and_b32 v4, 2047, v4
    v_cvt_f32_u32 v4, v4
    v_mul_f32 v4, 0x3a000000, v4
    v_cvt_f32_u32 v5, s23
    v_mul_f32 v5, 0x3a000000, v5
    v_mov_b32 v192, v3
    v_fmamk_f32 v193, v5, 0x42000000, v3
    v_fmamk_f32 v194, v5, 0x42800000, v3
    v_fmamk_f32 v195, v5, 0x42c00000, v3
    v_fmamk_f32 v196, v5, 0x40800000, v3
    v_fmamk_f32 v197, v5, 0x42100000, v3
    v_fmamk_f32 v198, v5, 0x42880000, v3
    v_fmamk_f32 v199, v5, 0x42c80000, v3
    v_fmamk_f32 v200, v5, 0x41000000, v3
    v_fmamk_f32 v201, v5, 0x42200000, v3
    v_fmamk_f32 v202, v5, 0x42900000, v3
    v_fmamk_f32 v203, v5, 0x42d00000, v3
    v_fmamk_f32 v204, v5, 0x41400000, v4
    v_fmamk_f32 v205, v5, 0x42300000, v4
    v_fmamk_f32 v206, v5, 0x42980000, v4
    v_fmamk_f32 v207, v5, 0x42d80000, v4
    v_cos_f32 v192, v192
    v_cos_f32 v193, v193
    v_cos_f32 v194, v194
    v_cos_f32 v195, v195
    v_cos_f32 v196, v196
    v_cos_f32 v197, v197
    v_cos_f32 v198, v198
    v_cos_f32 v199, v199
    v_cos_f32 v200, v200
    v_cos_f32 v201, v201
    v_cos_f32 v202, v202
    v_cos_f32 v203, v203
    v_cos_f32 v204, v204
    v_cos_f32 v205, v205
    v_cos_f32 v206, v206
    v_cos_f32 v207, v207
    s_branch fk_y5
    s_nop 3
fk_noy5:
    v_lshrrev_b32 v1, 1, v0
    v_and_b32 v45, 1, v0
    v_lshrrev_b32 v2, 4, v1
    v_and_b32 v3, 15, v1
    v_cmp_gt_u32 vcc, 8, v3
    v_sub_u32 v6, 16, v3
    v_and_b32 v6, 7, v6
    v_sub_u32 v5, 31, v2
    v_cndmask_b32 v6, v6, v3, vcc
    v_cndmask_b32 v5, v5, v2, vcc
    v_lshl_add_u32 v4, v6, 5, v5
    v_and_b32 v12, 63, v4
    v_lshrrev_b32 v13, 6, v4
    v_lshlrev_b32 v13, 2, v13
    v_lshl_add_u32 v12, v12, 4, v13
    s_mov_b32 s23, 0x13000
    s_mov_b32 s42, 0
    buffer_load_dword v47, v12, s[24:27], s23 offen sc1
    v_mul_u32_u24 v4, 8320, v4
    v_lshl_add_u32 v4, v45, 4, v4
    s_lshl_b32 s17, s3, 5
    s_add_u32 s17, s17, 0x268000
    v_cndmask_b32 v6, -1, 1, vcc
    v_cmp_eq_u32 vcc, 8, v3
    v_mul_u32_u24 v46, 8256, v45
    v_add_u32 v46, 138496, v46
    v_cndmask_b32 v6, v6, 15, vcc
    v_lshlrev_b32 v9, 2, v1
    v_lshl_add_u32 v10, v6, 1, v9
    v_add_u32 v9, v46, v9
    v_add_u32 v10, v46, v10
    s_mul_i32 s36, s16, 2064
    s_add_u32 s36, s36, 138496
    v_add_u32 v5, s36, v14
    s_sub_u32 s36, 7, s16
    s_cmp_eq_u32 s21, 0
    s_cselect_b32 s36, 0, s36
    s_cmp_eq_u32 s21, 1024
    s_cselect_b32 s36, 7, s36
    s_mul_i32 s36, s36, 2064
    s_add_u32 s36, s36, 139504
    v_sub_u32 v11, s36, v14
    s_lshl_b32 s36, s16, 2
    s_add_u32 s36, s36, 157088
    v_mov_b32 v6, s36
    s_mov_b32 s36, 0xffff0000
    s_mov_b32 s37, 0x3f803f80
    s_mov_b32 s38, 0x42800000
    s_waitcnt lgkmcnt(0)
    v_lshlrev_b32 v48, 16, v20
    v_and_b32 v49, s36, v20
    v_lshlrev_b32 v50, 16, v21
    v_and_b32 v51, s36, v21
    v_lshlrev_b32 v52, 16, v22
    v_and_b32 v53, s36, v22
    v_lshlrev_b32 v54, 16, v23
    v_and_b32 v55, s36, v23
    v_lshlrev_b32 v56, 16, v24
    v_and_b32 v57, s36, v24
    v_lshlrev_b32 v58, 16, v25
    v_and_b32 v59, s36, v25
    v_lshlrev_b32 v60, 16, v26
    v_and_b32 v61, s36, v26
    v_lshlrev_b32 v62, 16, v27
    v_and_b32 v63, s36, v27
    v_mov_b32 v44, 0
    v_dot2c_f32_bf16 v44, s37, v28
    v_dot2c_f32_bf16 v44, s37, v29
    v_dot2c_f32_bf16 v44, s37, v30
    v_dot2c_f32_bf16 v44, s37, v31
    v_dot2c_f32_bf16 v44, s37, v32
    v_dot2c_f32_bf16 v44, s37, v33
    v_dot2c_f32_bf16 v44, s37, v34
    v_dot2c_f32_bf16 v44, s37, v35
    s_nop 2
    v_add_f32_dpp v44, v44, v44 quad_perm:[1,0,3,2] row_mask:0xf bank_mask:0xf
    s_nop 1
    v_add_f32_dpp v44, v44, v44 quad_perm:[2,3,0,1] row_mask:0xf bank_mask:0xf
    s_nop 1
    v_add_f32_dpp v44, v44, v44 row_half_mirror row_mask:0xf bank_mask:0xf
    s_nop 1
    v_add_f32_dpp v44, v44, v44 row_mirror row_mask:0xf bank_mask:0xf
    s_nop 1
    v_add_f32_dpp v44, v44, v44 row_bcast:15 row_mask:0xa bank_mask:0xf
    s_nop 1
    v_add_f32_dpp v44, v44, v44 row_bcast:31 row_mask:0xc bank_mask:0xf
    s_nop 0
    v_readlane_b32 s39, v44, 63
    s_and_b32 s13, s18, 1
    s_mul_i32 s40, s13, 0x80008000
    s_branch fk_chkr1
    s_nop 1
fk_pollr1:
    buffer_load_dword v47, v12, s[24:27], s23 offen sc1
fk_chkr1:
    s_add_u32 s42, s42, 1
    s_waitcnt vmcnt(0)
    v_cmp_eq_u32 vcc, -1, v47
    s_cbranch_vccz fk_gotr1
    s_cmp_le_u32 s42, 0x40000
    s_cbranch_scc1 fk_pollr1
    s_nop 1
fk_gotr1:
    v_xor_b32 v47, s40, v47
    s_mov_b32 s42, 0
    s_nop 3
fk_polly:
    buffer_load_dwordx4 v[36:39], v4, s[24:27], s17 offen sc1
    s_add_u32 s42, s42, 1
    s_waitcnt vmcnt(0)
    v_max3_u32 v46, v36, v37, v38
    v_max_u32 v46, v46, v39
    v_cmp_eq_u32 vcc, -1, v46
    s_cbranch_vccz fk_goty
    s_cmp_le_u32 s42, 0x40000
    s_cbranch_scc1 fk_polly
    s_nop 1
fk_goty:
    v_pk_add_f16 v36, v36, v47
    v_pk_add_f16 v37, v37, v47
    v_pk_add_f16 v38, v38, v47
    v_pk_add_f16 v39, v39, v47
    ds_write_b16 v9, v36 offset:0
    ds_write_b16_d16_hi v10, v36 offset:0
    ds_write_b16 v9, v37 offset:2064
    ds_write_b16_d16_hi v10, v37 offset:2064
    ds_write_b16 v9, v38 offset:4128
    ds_write_b16_d16_hi v10, v38 offset:4128
    ds_write_b16 v9, v39 offset:6192
    ds_write_b16_d16_hi v10, v39 offset:6192
    s_cmp_gt_u32 s3, 223
    s_cbranch_scc1 fk_wsc
    s_mul_i32 s15, s16, 4
    s_add_u32 s15, s15, 0
    s_lshl_b32 s12, s15, 10
    s_add_u32 s12, s12, 32768
    s_mul_i32 s13, s15, 57344
    s_add_u32 s13, s13, s100
    v_xor_b32 v209, 64, v208
    s_mov_b32 m0, s12
    s_nop 0
    buffer_load_dwordx4 v208, s[48:51], s13 offen lds
    s_add_u32 s12, s12, 1024
    s_add_u32 s13, s13, 57344
    s_mov_b32 m0, s12
    s_nop 0
    buffer_load_dwordx4 v209, s[48:51], s13 offen lds
    s_add_u32 s12, s12, 1024
    s_add_u32 s13, s13, 57344
    s_mov_b32 m0, s12
    s_nop 0
    buffer_load_dwordx4 v208, s[48:51], s13 offen lds
    s_add_u32 s12, s12, 1024
    s_add_u32 s13, s13, 57344
    s_mov_b32 m0, s12
    s_nop 0
    buffer_load_dwordx4 v209, s[48:51], s13 offen lds
fk_wsc:
    v_mov_b32 v2, 0
    v_mov_b32 v3, 0
    v_mov_b32 v4, 0
    v_mov_b32 v7, 0
    v_mov_b32 v12, 157120
    s_waitcnt lgkmcnt(0)
    s_barrier
    ds_read_b128 v[36:39], v5
    ds_read_b128 v[40:43], v11
    ds_read_b32 v44, v6
    s_waitcnt lgkmcnt(2)
    v_fma_mix_f32 v48, v36, s38, v48 op_sel:[0,0,0] op_sel_hi:[1,0,0]
    v_fma_mix_f32 v49, v36, s38, v49 op_sel:[1,0,0] op_sel_hi:[1,0,0]
    v_fma_mix_f32 v50, v37, s38, v50 op_sel:[0,0,0] op_sel_hi:[1,0,0]
    v_fma_mix_f32 v51, v37, s38, v51 op_sel:[1,0,0] op_sel_hi:[1,0,0]
    v_fma_mix_f32 v52, v38, s38, v52 op_sel:[0,0,0] op_sel_hi:[1,0,0]
    v_fma_mix_f32 v53, v38, s38, v53 op_sel:[1,0,0] op_sel_hi:[1,0,0]
    v_fma_mix_f32 v54, v39, s38, v54 op_sel:[0,0,0] op_sel_hi:[1,0,0]
    v_fma_mix_f32 v55, v39, s38, v55 op_sel:[1,0,0] op_sel_hi:[1,0,0]
    s_waitcnt lgkmcnt(0)
    v_readfirstlane_b32 s13, v44
    v_mov_b32_dpp v8, v40 wave_shr:1 row_mask:0xf bank_mask:0xf
    v_fma_mix_f32 v57, v43, s38, v57 op_sel:[1,0,0] op_sel_hi:[1,0,0]
    v_fma_mix_f32 v58, v43, s38, v58 op_sel:[0,0,0] op_sel_hi:[1,0,0]
    v_fma_mix_f32 v59, v42, s38, v59 op_sel:[1,0,0] op_sel_hi:[1,0,0]
    v_fma_mix_f32 v60, v42, s38, v60 op_sel:[0,0,0] op_sel_hi:[1,0,0]
    v_writelane_b32 v8, s13, 0
    v_fma_mix_f32 v61, v41, s38, v61 op_sel:[1,0,0] op_sel_hi:[1,0,0]
    v_fma_mix_f32 v62, v41, s38, v62 op_sel:[0,0,0] op_sel_hi:[1,0,0]
    v_fma_mix_f32 v63, v40, s38, v63 op_sel:[1,0,0] op_sel_hi:[1,0,0]
    v_fma_mix_f32 v56, v8, s38, v56 op_sel:[0,0,0] op_sel_hi:[1,0,0]
    v_cvt_pk_bf16_f32 v80, v48, v49
    v_cvt_pk_bf16_f32 v81, v50, v51
    v_cvt_pk_bf16_f32 v82, v52, v53
    v_cvt_pk_bf16_f32 v83, v54, v55
    v_cvt_pk_bf16_f32 v85, v58, v59
    v_cvt_pk_bf16_f32 v86, v60, v61
    v_cvt_pk_bf16_f32 v87, v62, v63
    v_cvt_pk_bf16_f32 v84, v56, v57
    v_dot2c_f32_bf16 v2, s37, v80
    v_dot2c_f32_bf16 v3, v80, v80
    v_dot2c_f32_bf16 v4, v80, v28
    v_dot2c_f32_bf16 v2, s37, v81
    v_dot2c_f32_bf16 v3, v81, v81
    v_dot2c_f32_bf16 v4, v81, v29
    v_dot2c_f32_bf16 v2, s37, v82
    v_dot2c_f32_bf16 v3, v82, v82
    v_dot2c_f32_bf16 v4, v82, v30
    v_dot2c_f32_bf16 v2, s37, v83
    v_dot2c_f32_bf16 v3, v83, v83
    v_dot2c_f32_bf16 v4, v83, v31
    v_dot2c_f32_bf16 v2, s37, v85
    v_dot2c_f32_bf16 v3, v85, v85
    v_dot2c_f32_bf16 v4, v85, v33
    v_dot2c_f32_bf16 v2, s37, v86
    v_dot2c_f32_bf16 v3, v86, v86
    v_dot2c_f32_bf16 v4, v86, v34
    v_dot2c_f32_bf16 v2, s37, v87
    v_dot2c_f32_bf16 v3, v87, v87
    v_dot2c_f32_bf16 v4, v87, v35
    v_dot2c_f32_bf16 v2, s37, v84
    v_dot2c_f32_bf16 v3, v84, v84
    v_dot2c_f32_bf16 v4, v84, v32
    s_nop 2
    v_permlane32_swap_b32 v2, v4
    v_permlane32_swap_b32 v3, v7
    v_add_f32 v2, v2, v4
    v_add_f32 v3, v3, v7
    s_nop 1
    v_permlane16_swap_b32 v2, v3
    v_add_f32 v2, v2, v3
    s_nop 1
    v_add_f32_dpp v2, v2, v2 quad_perm:[1,0,3,2] row_mask:0xf bank_mask:0xf
    s_nop 1
    v_add_f32_dpp v2, v2, v2 quad_perm:[2,3,0,1] row_mask:0xf bank_mask:0xf
    s_nop 1
    v_add_f32_dpp v2, v2, v2 row_half_mirror row_mask:0xf bank_mask:0xf
    s_nop 1
    v_add_f32_dpp v2, v2, v2 row_mirror row_mask:0xf bank_mask:0xf
    s_nop 0
    v_readlane_b32 s13, v2, 32
    v_mov_b32_dpp v8, v2 row_bcast:15 row_mask:0xa bank_mask:0xf
    v_mul_f32 v9, 0x3a800000, v2
    v_mul_f32 v8, 0x3a800000, v8
    v_fma_f32 v9, -v8, v8, v9
    v_max_f32 v9, 0, v9
    v_cvt_pk_bf16_f32 v9, 0, v9
    v_cvt_pk_bf16_f32 v8, 0, v8
    v_add_f32 v9, 0x3727c5ac, v9
    v_cvt_pk_bf16_f32 v9, 0, v9
    v_sqrt_f32 v9, v9
    s_nop 0
    v_cvt_pk_bf16_f32 v9, 0, v9
    v_rcp_f32 v9, v9
    v_mov_b32 v10, s13
    v_fma_f32 v10, -v8, s39, v10
    v_mul_f32 v10, v10, v9
    v_mul_f32 v8, v8, v9
    v_readlane_b32 s43, v10, 16
    v_readlane_b32 s4, v9, 16
    v_readlane_b32 s6, v8, 16
    s_ashr_i32 s13, s43, 31
    s_or_b32 s13, s13, 0x80000000
    s_xor_b32 s43, s43, s13
    s_and_b32 s43, s43, 0xfffff800
    s_or_b32 s43, s43, s19
    s_min_u32 s43, s43, -2
    v_mov_b32 v2, s43
    s_mov_b64 exec, 1
    ds_max_u32 v12, v2
    s_mov_b64 exec, -1
    v_mov_b32 v10, s6
    v_add_f32 v8, 1.0, v9
    v_lshlrev_b32 v4, 12, v15
    s_lshl_b32 s17, s3, 4
    s_add_u32 s17, s17, 0x9000
    v_readlane_b32 s14, v8, 16
    s_waitcnt lgkmcnt(0)
    s_barrier
    ds_read_b32 v3, v12
    v_lshlrev_b32 v48, 16, v80
    v_and_b32 v49, s36, v80
    v_lshlrev_b32 v50, 16, v81
    v_and_b32 v51, s36, v81
    v_lshlrev_b32 v52, 16, v82
    v_and_b32 v53, s36, v82
    v_lshlrev_b32 v54, 16, v83
    v_and_b32 v55, s36, v83
    v_lshlrev_b32 v56, 16, v84
    v_and_b32 v57, s36, v84
    v_lshlrev_b32 v58, 16, v85
    v_and_b32 v59, s36, v85
    v_lshlrev_b32 v60, 16, v86
    v_and_b32 v61, s36, v86
    v_lshlrev_b32 v62, 16, v87
    v_and_b32 v63, s36, v87
    s_waitcnt lgkmcnt(0)
    v_readfirstlane_b32 s13, v3
    s_nop 1
    s_cmp_lg_u32 s13, s43
    s_cbranch_scc1 fk_other
    s_mov_b64 exec, 0xff
    buffer_store_dword v2, v4, s[24:27], s17 offen sc1
    s_mov_b64 exec, -1
    v_pk_fma_f32 v[64:65], v[48:49], s[4:5], v[10:11] op_sel_hi:[1,0,0] neg_lo:[0,0,1] neg_hi:[0,0,1]
    v_pk_fma_f32 v[66:67], v[50:51], s[4:5], v[10:11] op_sel_hi:[1,0,0] neg_lo:[0,0,1] neg_hi:[0,0,1]
    v_pk_fma_f32 v[68:69], v[52:53], s[4:5], v[10:11] op_sel_hi:[1,0,0] neg_lo:[0,0,1] neg_hi:[0,0,1]
    v_pk_fma_f32 v[70:71], v[54:55], s[4:5], v[10:11] op_sel_hi:[1,0,0] neg_lo:[0,0,1] neg_hi:[0,0,1]
    v_pk_fma_f32 v[72:73], v[56:57], s[4:5], v[10:11] op_sel_hi:[1,0,0] neg_lo:[0,0,1] neg_hi:[0,0,1]
    v_pk_fma_f32 v[74:75], v[58:59], s[4:5], v[10:11] op_sel_hi:[1,0,0] neg_lo:[0,0,1] neg_hi:[0,0,1]
    v_pk_fma_f32 v[76:77], v[60:61], s[4:5], v[10:11] op_sel_hi:[1,0,0] neg_lo:[0,0,1] neg_hi:[0,0,1]
    v_pk_fma_f32 v[78:79], v[62:63], s[4:5], v[10:11] op_sel_hi:[1,0,0] neg_lo:[0,0,1] neg_hi:[0,0,1]
    v_cvt_pk_bf16_f32 v96, v64, v65
    v_cvt_pk_bf16_f32 v97, v66, v67
    v_cvt_pk_bf16_f32 v98, v68, v69
    v_cvt_pk_bf16_f32 v99, v70, v71
    v_cvt_pk_bf16_f32 v100, v72, v73
    v_cvt_pk_bf16_f32 v101, v74, v75
    v_cvt_pk_bf16_f32 v102, v76, v77
    v_cvt_pk_bf16_f32 v103, v78, v79
    v_and_b32 v96, -2, v96
    v_and_b32 v97, -2, v97
    v_and_b32 v98, -2, v98
    v_and_b32 v99, -2, v99
    v_and_b32 v100, -2, v100
    v_and_b32 v101, -2, v101
    v_and_b32 v102, -2, v102
    v_and_b32 v103, -2, v103
    s_mul_i32 s13, s3, 9344
    s_add_u32 s13, s13, 0x20000
    buffer_store_dwordx4 v[96:99], v14, s[24:27], s13 offen sc1
    buffer_store_dwordx4 v[100:103], v14, s[24:27], s13 offen offset:1024 sc1
    v_and_b32 v80, -2, v80
    v_and_b32 v81, -2, v81
    v_and_b32 v82, -2, v82
    v_and_b32 v83, -2, v83
    v_and_b32 v84, -2, v84
    v_and_b32 v85, -2, v85
    v_and_b32 v86, -2, v86
    v_and_b32 v87, -2, v87
    buffer_store_dwordx4 v[80:83], v14, s[24:27], s13 offen offset:2048 sc1
    buffer_store_dwordx4 v[84:87], v14, s[24:27], s13 offen offset:3072 sc1
    v_pk_fma_f32 v[64:65], v[48:49], s[14:15], v[10:11] op_sel_hi:[1,0,0] neg_lo:[0,0,1] neg_hi:[0,0,1]
    v_pk_fma_f32 v[66:67], v[50:51], s[14:15], v[10:11] op_sel_hi:[1,0,0] neg_lo:[0,0,1] neg_hi:[0,0,1]
    v_pk_fma_f32 v[68:69], v[52:53], s[14:15], v[10:11] op_sel_hi:[1,0,0] neg_lo:[0,0,1] neg_hi:[0,0,1]
    v_pk_fma_f32 v[70:71], v[54:55], s[14:15], v[10:11] op_sel_hi:[1,0,0] neg_lo:[0,0,1] neg_hi:[0,0,1]
    v_pk_fma_f32 v[72:73], v[56:57], s[14:15], v[10:11] op_sel_hi:[1,0,0] neg_lo:[0,0,1] neg_hi:[0,0,1]
    v_pk_fma_f32 v[74:75], v[58:59], s[14:15], v[10:11] op_sel_hi:[1,0,0] neg_lo:[0,0,1] neg_hi:[0,0,1]
    v_pk_fma_f32 v[76:77], v[60:61], s[14:15], v[10:11] op_sel_hi:[1,0,0] neg_lo:[0,0,1] neg_hi:[0,0,1]
    v_pk_fma_f32 v[78:79], v[62:63], s[14:15], v[10:11] op_sel_hi:[1,0,0] neg_lo:[0,0,1] neg_hi:[0,0,1]
    v_cvt_pk_bf16_f32 v112, v64, v65
    v_cvt_pk_bf16_f32 v113, v66, v67
    v_cvt_pk_bf16_f32 v114, v68, v69
    v_cvt_pk_bf16_f32 v115, v70, v71
    v_cvt_pk_bf16_f32 v116, v72, v73
    v_cvt_pk_bf16_f32 v117, v74, v75
    v_cvt_pk_bf16_f32 v118, v76, v77
    v_cvt_pk_bf16_f32 v119, v78, v79
    v_lshrrev_b32 v1, 4, v15
    v_bfe_u32 v2, v15, 2, 2
    v_lshl_add_u32 v8, v1, 3, v2
    v_lshlrev_b32 v8, 7, v8
    v_and_b32 v3, 2, v2
    v_xor_b32 v9, s16, v3
    v_and_b32 v3, 1, v1
    v_lshlrev_b32 v4, 2, v3
    v_xor_b32 v9, v4, v9
    v_lshl_add_u32 v8, v9, 4, v8
    v_and_b32 v9, 1, v15
    v_lshl_add_u32 v8, v9, 3, v8
    v_bfe_u32 v9, v15, 1, 1
    v_lshl_add_u32 v8, v9, 15, v8
    v_lshrrev_b32 v7, 1, v1
    v_lshl_add_u32 v7, v7, 3, v2
    v_lshlrev_b32 v7, 9, v7
    v_lshl_add_u32 v7, v3, 5, v7
    v_and_b32 v3, 3, v15
    v_lshl_add_u32 v7, v3, 3, v7
    s_lshl_b32 s15, s16, 6
    s_add_u32 s15, s15, 65536
    v_add_u32 v7, s15, v7
    v_lshlrev_b32 v9, 4, v1
    v_add_u32 v9, 157312, v9
    s_and_b32 s13, s2, 7
    s_lshl_b32 s13, s13, 12
    s_add_u32 s13, s13, 0x9000
    s_mov_b32 s42, 0
    s_waitcnt vmcnt(4)
    v_mov_b32 v1, 157872
    v_mov_b32 v2, 1
    s_mov_b64 exec, 1
    ds_add_u32 v1, v2
    s_mov_b64 exec, -1
    s_nop 1
fk_pollk:
    buffer_load_dword v180, v14, s[24:27], s13 offen offset:0 sc1
    buffer_load_dword v181, v14, s[24:27], s13 offen offset:1024 sc1
    buffer_load_dword v182, v14, s[24:27], s13 offen offset:2048 sc1
    buffer_load_dword v183, v14, s[24:27], s13 offen offset:3072 sc1
    s_add_u32 s42, s42, 1
    s_waitcnt vmcnt(0)
    v_max3_u32 v3, v180, v181, v182
    v_max_u32 v3, v3, v183
    v_cmp_eq_u32 vcc, -1, v3
    s_cbranch_vccz fk_gotk
    s_cmp_le_u32 s42, 0x40000
    s_cbranch_scc1 fk_pollk
    s_nop 1
fk_gotk:
    v_max_u32_dpp v3, v3, v3 quad_perm:[1,0,3,2] row_mask:0xf bank_mask:0xf
    s_nop 1
    v_max_u32_dpp v3, v3, v3 quad_perm:[2,3,0,1] row_mask:0xf bank_mask:0xf
    s_nop 1
    v_max_u32_dpp v3, v3, v3 row_half_mirror row_mask:0xf bank_mask:0xf
    s_nop 1
    v_max_u32_dpp v3, v3, v3 row_mirror row_mask:0xf bank_mask:0xf
    s_nop 1
    v_max_u32_dpp v3, v3, v3 row_bcast:15 row_mask:0xa bank_mask:0xf
    s_nop 1
    v_max_u32_dpp v3, v3, v3 row_bcast:31 row_mask:0xc bank_mask:0xf
    s_nop 0
    v_readlane_b32 s40, v3, 63
    v_mov_b32 v4, 157136
    s_nop 0
    s_bfe_u32 s13, s40, 0x80003
    s_mul_i32 s13, s13, 9344
    s_and_b32 s14, s3, 3
    s_lshl_b32 s14, s14, 9
    s_add_u32 s13, s13, s14
    s_add_u32 s13, s13, 0x20000
    v_lshlrev_b32 v5, 3, v15
    v_mov_b32 v3, s40
    s_cmp_gt_u32 s3, 223
    s_cbranch_scc1 fk_norow
    s_mov_b32 s42, 0
    buffer_load_dwordx2 v[180:181], v5, s[24:27], s13 offen sc1
    s_nop 0
fk_landa:
    ds_read_b32 v2, v1
    s_waitcnt lgkmcnt(0)
    v_readfirstlane_b32 s15, v2
    s_nop 1
    s_cmp_lt_u32 s15, 8
    s_cbranch_scc1 fk_landa
    ds_read_b64_tr_b16 v[128:129], v8 offset:0
    ds_read_b64_tr_b16 v[130:131], v8 offset:512
    ds_read_b64_tr_b16 v[132:133], v8 offset:4096
    ds_read_b64_tr_b16 v[134:135], v8 offset:4608
    ds_read_b64_tr_b16 v[136:137], v8 offset:8192
    ds_read_b64_tr_b16 v[138:139], v8 offset:8704
    ds_read_b64_tr_b16 v[140:141], v8 offset:12288
    ds_read_b64_tr_b16 v[142:143], v8 offset:12800
    ds_read_b64_tr_b16 v[144:145], v8 offset:16384
    ds_read_b64_tr_b16 v[146:147], v8 offset:16896
    ds_read_b64_tr_b16 v[148:149], v8 offset:20480
    ds_read_b64_tr_b16 v[150:151], v8 offset:20992
    s_waitcnt lgkmcnt(4)
    ds_read_b64_tr_b16 v[152:153], v8 offset:24576
    ds_read_b64_tr_b16 v[154:155], v8 offset:25088
    ds_read_b64_tr_b16 v[156:157], v8 offset:28672
    ds_read_b64_tr_b16 v[158:159], v8 offset:29184
    s_branch fk_chkr
    s_nop 0
fk_pollr:
    buffer_load_dwordx2 v[180:181], v5, s[24:27], s13 offen sc1
fk_chkr:
    s_waitcnt vmcnt(0)
    v_or_b32 v6, v180, v181
    v_and_b32 v6, 1, v6
    v_cmp_eq_u32 vcc, 1, v6
    s_add_u32 s42, s42, 1
    s_cbranch_vccz fk_gotr
    s_cmp_le_u32 s42, 0x40000
    s_cbranch_scc1 fk_pollr
    s_nop 0
fk_gotr:
    v_add_u32 v5, 157312, v5
    ds_write_b64 v5, v[180:181]
    s_nop 3
fk_norow:
    ds_write_b32 v4, v3
    s_waitcnt lgkmcnt(0)
    s_barrier
    s_cmp_eq_u32 s40, s43
    s_cselect_b32 s22, 0x400000, s22
    s_branch fk_ffn
    s_nop 0
fk_other:
    v_pk_fma_f32 v[64:65], v[48:49], s[14:15], v[10:11] op_sel_hi:[1,0,0] neg_lo:[0,0,1] neg_hi:[0,0,1]
    v_pk_fma_f32 v[66:67], v[50:51], s[14:15], v[10:11] op_sel_hi:[1,0,0] neg_lo:[0,0,1] neg_hi:[0,0,1]
    v_pk_fma_f32 v[68:69], v[52:53], s[14:15], v[10:11] op_sel_hi:[1,0,0] neg_lo:[0,0,1] neg_hi:[0,0,1]
    v_pk_fma_f32 v[70:71], v[54:55], s[14:15], v[10:11] op_sel_hi:[1,0,0] neg_lo:[0,0,1] neg_hi:[0,0,1]
    v_pk_fma_f32 v[72:73], v[56:57], s[14:15], v[10:11] op_sel_hi:[1,0,0] neg_lo:[0,0,1] neg_hi:[0,0,1]
    v_pk_fma_f32 v[74:75], v[58:59], s[14:15], v[10:11] op_sel_hi:[1,0,0] neg_lo:[0,0,1] neg_hi:[0,0,1]
    v_pk_fma_f32 v[76:77], v[60:61], s[14:15], v[10:11] op_sel_hi:[1,0,0] neg_lo:[0,0,1] neg_hi:[0,0,1]
    v_pk_fma_f32 v[78:79], v[62:63], s[14:15], v[10:11] op_sel_hi:[1,0,0] neg_lo:[0,0,1] neg_hi:[0,0,1]
    v_cvt_pk_bf16_f32 v112, v64, v65
    v_cvt_pk_bf16_f32 v113, v66, v67
    v_cvt_pk_bf16_f32 v114, v68, v69
    v_cvt_pk_bf16_f32 v115, v70, v71
    v_cvt_pk_bf16_f32 v116, v72, v73
    v_cvt_pk_bf16_f32 v117, v74, v75
    v_cvt_pk_bf16_f32 v118, v76, v77
    v_cvt_pk_bf16_f32 v119, v78, v79
    s_and_b32 s13, s13, 7
    s_cmp_gt_u32 s16, s13
    s_cselect_b32 s13, 1, 0
    s_sub_u32 s17, s16, s13
    s_waitcnt vmcnt(0)
    v_lshrrev_b32 v1, 4, v15
    v_bfe_u32 v2, v15, 2, 2
    v_lshl_add_u32 v8, v1, 3, v2
    v_lshlrev_b32 v8, 7, v8
    v_and_b32 v3, 2, v2
    v_xor_b32 v9, s16, v3
    v_and_b32 v3, 1, v1
    v_lshlrev_b32 v4, 2, v3
    v_xor_b32 v9, v4, v9
    v_lshl_add_u32 v8, v9, 4, v8
    v_and_b32 v9, 1, v15
    v_lshl_add_u32 v8, v9, 3, v8
    v_bfe_u32 v9, v15, 1, 1
    v_lshl_add_u32 v8, v9, 15, v8
    v_lshrrev_b32 v7, 1, v1
    v_lshl_add_u32 v7, v7, 3, v2
    v_lshlrev_b32 v7, 9, v7
    v_lshl_add_u32 v7, v3, 5, v7
    v_and_b32 v3, 3, v15
    v_lshl_add_u32 v7, v3, 3, v7
    s_lshl_b32 s15, s16, 6
    s_add_u32 s15, s15, 65536
    v_add_u32 v7, s15, v7
    v_lshlrev_b32 v9, 4, v1
    v_add_u32 v9, 157312, v9
    v_mov_b32 v1, 157872
    v_mov_b32 v2, 1
    s_mov_b64 exec, 1
    ds_add_u32 v1, v2
    s_mov_b64 exec, -1
    s_cmp_gt_u32 s3, 223
    s_cbranch_scc1 fk_wsd
    s_mul_i32 s15, s17, 4
    s_add_u32 s15, s15, 8
    s_lshl_b32 s12, s15, 10
    s_add_u32 s12, s12, 65536
    s_mul_i32 s13, s15, 4096
    s_add_u32 s13, s13, s101
    s_mov_b32 m0, s12
    s_cmp_gt_u32 s12, 97280
    s_cbranch_scc1 fk_wsd
    buffer_load_dwordx4 v210, s[52:55], s13 offen lds
    s_add_u32 s12, s12, 1024
    s_add_u32 s13, s13, 4096
    s_mov_b32 m0, s12
    s_cmp_gt_u32 s12, 97280
    s_cbranch_scc1 fk_wsd
    buffer_load_dwordx4 v210, s[52:55], s13 offen lds
    s_add_u32 s12, s12, 1024
    s_add_u32 s13, s13, 4096
    s_mov_b32 m0, s12
    s_cmp_gt_u32 s12, 97280
    s_cbranch_scc1 fk_wsd
    buffer_load_dwordx4 v210, s[52:55], s13 offen lds
    s_add_u32 s12, s12, 1024
    s_add_u32 s13, s13, 4096
    s_mov_b32 m0, s12
    s_cmp_gt_u32 s12, 97280
    s_cbranch_scc1 fk_wsd
    buffer_load_dwordx4 v210, s[52:55], s13 offen lds
fk_wsd:
fk_landb:
    ds_read_b32 v2, v1
    s_waitcnt lgkmcnt(0)
    v_readfirstlane_b32 s15, v2
    s_nop 1
    s_cmp_lt_u32 s15, 8
    s_cbranch_scc1 fk_landb
    ds_read_b64_tr_b16 v[128:129], v8 offset:0
    ds_read_b64_tr_b16 v[130:131], v8 offset:512
    ds_read_b64_tr_b16 v[132:133], v8 offset:4096
    ds_read_b64_tr_b16 v[134:135], v8 offset:4608
    ds_read_b64_tr_b16 v[136:137], v8 offset:8192
    ds_read_b64_tr_b16 v[138:139], v8 offset:8704
    ds_read_b64_tr_b16 v[140:141], v8 offset:12288
    ds_read_b64_tr_b16 v[142:143], v8 offset:12800
    ds_read_b64_tr_b16 v[144:145], v8 offset:16384
    ds_read_b64_tr_b16 v[146:147], v8 offset:16896
    ds_read_b64_tr_b16 v[148:149], v8 offset:20480
    ds_read_b64_tr_b16 v[150:151], v8 offset:20992
    s_waitcnt lgkmcnt(4)
    ds_read_b64_tr_b16 v[152:153], v8 offset:24576
    ds_read_b64_tr_b16 v[154:155], v8 offset:25088
    ds_read_b64_tr_b16 v[156:157], v8 offset:28672
    ds_read_b64_tr_b16 v[158:159], v8 offset:29184
    s_waitcnt vmcnt(0) lgkmcnt(0)
    s_barrier
    s_nop 0
fk_ffn:
    buffer_store_dwordx4 v[112:115], v14, s[28:31], s22 offen nt
    buffer_store_dwordx4 v[116:119], v14, s[28:31], s22 offen offset:1024 nt
    s_cmp_gt_u32 s3, 223
    s_cbranch_scc1 fk_fin
    ds_read_b128 v[16:19], v9 offset:0
    ds_read_b128 v[20:23], v9 offset:64
    ds_read_b128 v[24:27], v9 offset:128
    ds_read_b128 v[28:31], v9 offset:192
    ds_read_b128 v[32:35], v9 offset:256
    ds_read_b128 v[36:39], v9 offset:320
    ds_read_b128 v[40:43], v9 offset:384
    ds_read_b128 v[44:47], v9 offset:448
    v_mov_b32 v3, 157136
    ds_read_b32 v12, v3
    v_lshlrev_b32 v4, 3, v15
    s_mul_i32 s41, s3, 9344
    s_lshl_b32 s14, s16, 6
    s_add_u32 s13, s41, s14
    s_add_u32 s13, s13, 0x21000
    s_waitcnt lgkmcnt(8)
    v_mfma_f32_16x16x32_bf16 v[176:179], v[16:19], v[128:131], 0
    s_waitcnt lgkmcnt(7)
    v_mfma_f32_16x16x32_bf16 v[176:179], v[20:23], v[132:135], v[176:179]
    s_waitcnt lgkmcnt(6)
    v_mfma_f32_16x16x32_bf16 v[176:179], v[24:27], v[136:139], v[176:179]
    s_waitcnt lgkmcnt(5)
    v_mfma_f32_16x16x32_bf16 v[176:179], v[28:31], v[140:143], v[176:179]
    s_waitcnt lgkmcnt(4)
    v_mfma_f32_16x16x32_bf16 v[176:179], v[32:35], v[144:147], v[176:179]
    s_waitcnt lgkmcnt(3)
    v_mfma_f32_16x16x32_bf16 v[176:179], v[36:39], v[148:151], v[176:179]
    s_waitcnt lgkmcnt(2)
    v_mfma_f32_16x16x32_bf16 v[176:179], v[40:43], v[152:155], v[176:179]
    s_waitcnt lgkmcnt(1)
    v_mfma_f32_16x16x32_bf16 v[176:179], v[44:47], v[156:159], v[176:179]
    v_lshlrev_b32 v5, 3, v15
    v_lshlrev_b32 v6, 2, v15
    v_lshrrev_b32 v9, 5, v15
    v_lshlrev_b32 v9, 4, v9
    v_add_u32 v9, 157184, v9
    s_lshl_b32 s14, s16, 7
    s_add_u32 s41, s41, s14
    s_add_u32 s41, s41, 0x21400
    v_and_b32 v176, -2, v176
    s_nop 1
    v_mov_b32_dpp v177, v176 row_shl:8 row_mask:0xf bank_mask:0xf
    v_mov_b32_dpp v178, v176 row_shl:1 row_mask:0xf bank_mask:0xf
    v_mov_b32_dpp v179, v176 row_shl:9 row_mask:0xf bank_mask:0xf
    s_mov_b64 exec, 0x55
    buffer_store_dwordx4 v[176:179], v4, s[24:27], s13 offen sc1
    s_mov_b64 exec, -1
    v_mov_b32 v1, 157876
    v_mov_b32 v8, 1
    ds_read_b64_tr_b16 v[160:161], v7 offset:0
    ds_read_b64_tr_b16 v[162:163], v7 offset:2048
    ds_read_b64_tr_b16 v[164:165], v7 offset:8192
    ds_read_b64_tr_b16 v[166:167], v7 offset:10240
    ds_read_b64_tr_b16 v[168:169], v7 offset:16384
    ds_read_b64_tr_b16 v[170:171], v7 offset:18432
    ds_read_b64_tr_b16 v[172:173], v7 offset:24576
    ds_read_b64_tr_b16 v[174:175], v7 offset:26624
    s_cmp_eq_u32 s16, 7
    s_cbranch_scc1 fk_c1
    s_cmp_lg_u32 s16, 0
    s_cbranch_scc1 fk_wait1
    s_and_b32 s13, s3, -4
    s_mul_i32 s13, s13, 9344
    s_add_u32 s36, s13, 0x21000
    s_add_u32 s37, s36, 9344
    s_add_u32 s38, s36, 18688
    s_add_u32 s39, s36, 28032
    s_mov_b32 s42, 0
    v_lshrrev_b32 v10, 2, v5
    v_add_u32 v10, 157184, v10
    s_waitcnt vmcnt(0)
    s_nop 3
fk_poll1:
    buffer_load_dwordx2 v[184:185], v5, s[24:27], s36 offen sc1
    buffer_load_dwordx2 v[186:187], v5, s[24:27], s37 offen sc1
    buffer_load_dwordx2 v[188:189], v5, s[24:27], s38 offen sc1
    buffer_load_dwordx2 v[190:191], v5, s[24:27], s39 offen sc1
    s_waitcnt vmcnt(0)
    v_or3_b32 v11, v184, v185, v186
    v_or3_b32 v11, v11, v187, v188
    v_or3_b32 v11, v11, v189, v190
    v_or_b32 v11, v11, v191
    v_and_b32 v11, 1, v11
    v_cmp_eq_u32 vcc, 1, v11
    s_add_u32 s42, s42, 1
    s_cbranch_vccz fk_got1
    s_cmp_le_u32 s42, 0x40000
    s_cbranch_scc1 fk_poll1
    s_nop 0
fk_got1:
    v_pk_add_f32 v[184:185], v[184:185], v[186:187]
    v_pk_add_f32 v[188:189], v[188:189], v[190:191]
    v_pk_add_f32 v[184:185], v[184:185], v[188:189]
    v_cvt_pk_bf16_f32 v184, 0, v184
    v_cvt_pk_bf16_f32 v185, 0, v185
    v_mul_f32 v186, 0xbfb8aa3b, v184
    v_exp_f32 v186, v186
    s_nop 0
    v_add_f32 v186, 1.0, v186
    v_rcp_f32 v186, v186
    s_nop 0
    v_mul_f32 v184, v184, v186
    v_cvt_pk_bf16_f32 v184, 0, v184
    v_mul_f32 v184, v184, v185
    v_cvt_pk_bf16_f32 v184, 0, v184
    ds_write_b16_d16_hi v10, v184
    s_branch fk_wait1
    s_nop 2
fk_c1:
    s_cmp_gt_u32 s3, 127
    s_cbranch_scc1 fk_wait1
    s_waitcnt lgkmcnt(0)
    v_readfirstlane_b32 s40, v12
    v_lshrrev_b32 v10, 4, v15
    v_and_b32 v11, 1, v15
    v_lshl_add_u32 v12, v11, 2, v10
    v_lshlrev_b32 v12, 1, v12
    v_and_b32 v11, 12, v12
    v_and_b32 v10, 1, v10
    s_bfe_u32 s13, s40, 0x80003
    s_mul_i32 s14, s13, 9344
    s_lshl_b32 s15, s3, 4
    s_add_u32 s14, s14, s15
    s_add_u32 s14, s14, 0x20000
    s_mov_b32 s42, 0
    s_nop 0
fk_pollh:
    buffer_load_dword v2, v11, s[24:27], s14 offen sc1
    buffer_load_dword v3, v11, s[24:27], s14 offen offset:2048 sc1
    s_waitcnt vmcnt(0)
    v_or_b32 v4, v2, v3
    v_and_b32 v4, 1, v4
    v_cmp_eq_u32 vcc, 1, v4
    s_add_u32 s42, s42, 1
    s_cbranch_vccz fk_goth
    s_cmp_le_u32 s42, 0x40000
    s_cbranch_scc1 fk_pollh
    s_nop 0
fk_goth:
    v_cmp_eq_u32 vcc, 1, v10
    v_lshlrev_b32 v4, 16, v2
    v_and_b32 v2, s36, v2
    v_cndmask_b32 v2, v4, v2, vcc
    v_lshlrev_b32 v4, 16, v3
    v_and_b32 v3, s36, v3
    v_cndmask_b32 v3, v4, v3, vcc
    s_lshr_b32 s14, s13, 4
    s_add_u32 s14, s14, 1
    s_cmp_ge_u32 s13, 248
    s_cselect_b32 s14, 0, s14
    s_cmp_ge_u32 s13, 240
    s_cselect_b32 s15, 7, 15
    s_and_b32 s15, s15, s13
    s_lshl_b32 s15, s15, 7
    s_add_u32 s14, s14, s15
    s_and_b32 s13, s40, 7
    s_sub_u32 s15, 7, s13
    s_min_u32 s15, s15, s13
    s_lshl_b32 s15, s15, 5
    s_add_u32 s14, s14, s15
    s_sub_u32 s15, 2048, s14
    s_and_b32 s15, s15, 2047
    s_cmp_lt_u32 s13, 4
    s_cselect_b32 s14, s14, s15
    s_and_b32 s13, s40, 0x7ff
    s_cmp_eq_u32 s13, 1991
    s_cselect_b32 s14, 1024, s14
    s_lshl_b32 s21, s14, 11
    s_lshl_b32 s15, s3, 4
    s_add_u32 s21, s21, s15
    s_ashr_i32 s13, s40, 31
    s_not_b32 s13, s13
    s_or_b32 s13, s13, 0x80000000
    s_xor_b32 s13, s40, s13
    s_and_b32 s13, s13, 0xfffff800
    v_mov_b32 v11, s13
    v_cvt_pk_bf16_f32 v11, 0, v11
    v_mul_f32 v11, 0xbfb8aa3b, v11
    v_exp_f32 v11, v11
    s_nop 0
    v_add_f32 v11, 1.0, v11
    v_rcp_f32 v11, v11
    s_nop 0
    v_cvt_pk_bf16_f32 v11, 0, v11
    v_lshrrev_b32 v4, 1, v15
    v_mul_u32_u24 v4, 37376, v4
    v_and_b32 v5, 1, v15
    v_lshl_add_u32 v4, v5, 4, v4
    v_add_u32 v5, 1196032, v4
    v_cmp_gt_u32 vcc, 48, v15
    s_nop 1
    v_cndmask_b32 v5, -16, v5, vcc
    s_lshr_b32 s40, s3, 5
    s_mul_i32 s40, s40, 9344
    s_and_b32 s15, s3, 31
    s_lshl_b32 s15, s15, 5
    s_add_u32 s40, s40, s15
    s_add_u32 s40, s40, 0x21400
    s_nop 0
fk_wait1:
    s_waitcnt lgkmcnt(0)
    s_barrier
    ds_read_b128 v[16:19], v9 offset:0
    ds_read_b128 v[20:23], v9 offset:32
    ds_read_b128 v[24:27], v9 offset:64
    ds_read_b128 v[28:31], v9 offset:96
    s_waitcnt lgkmcnt(3)
    v_mfma_f32_32x32x16_bf16 v[192:207], v[16:19], v[160:163], 0
    s_waitcnt lgkmcnt(2)
    v_mfma_f32_32x32x16_bf16 v[192:207], v[20:23], v[164:167], v[192:207]
    s_waitcnt lgkmcnt(1)
    v_mfma_f32_32x32x16_bf16 v[192:207], v[24:27], v[168:171], v[192:207]
    s_waitcnt lgkmcnt(0)
    v_mfma_f32_32x32x16_bf16 v[192:207], v[28:31], v[172:175], v[192:207]
    s_nop 11
    v_and_b32 v192, -2, v192
    s_nop 1
    v_mov_b32_dpp v193, v192 row_shl:1 row_mask:0xf bank_mask:0xf
    v_mov_b32_dpp v194, v192 row_shl:2 row_mask:0xf bank_mask:0xf
    v_mov_b32_dpp v195, v192 row_shl:3 row_mask:0xf bank_mask:0xf
    s_mov_b32 exec_lo, 0x11111111
    s_mov_b32 exec_hi, 0
    buffer_store_dwordx4 v[192:195], v6, s[24:27], s41 offen sc1
    s_mov_b64 exec, -1
    s_cmp_lg_u32 s16, 7
    s_cbranch_scc1 fk_fin
    s_cmp_gt_u32 s3, 127
    s_cbranch_scc1 fk_fin
    s_mov_b32 s42, 0
    s_waitcnt vmcnt(0)
    s_nop 0
fk_poll2:
    buffer_load_dwordx4 v[16:19], v4, s[24:27], s40 offen sc1
    buffer_load_dwordx4 v[20:23], v5, s[24:27], s40 offen sc1
    s_waitcnt vmcnt(0)
    v_or3_b32 v6, v16, v17, v18
    v_or3_b32 v6, v6, v19, v20
    v_or3_b32 v6, v6, v21, v22
    v_or_b32 v6, v6, v23
    v_and_b32 v6, 1, v6
    v_cmp_eq_u32 vcc, 1, v6
    s_add_u32 s42, s42, 1
    s_cbranch_vccz fk_got2
    s_cmp_le_u32 s42, 0x40000
    s_cbranch_scc1 fk_poll2
    s_nop 0
fk_got2:
    v_pk_add_f32 v[16:17], v[16:17], v[20:21]
    v_pk_add_f32 v[18:19], v[18:19], v[22:23]
    s_nop 1
    v_permlane32_swap_b32 v16, v18
    v_permlane32_swap_b32 v17, v19
    v_add_f32 v16, v16, v18
    v_add_f32 v17, v17, v19
    s_nop 1
    v_permlane16_swap_b32 v16, v17
    v_add_f32 v16, v16, v17
    s_nop 1
    v_add_f32_dpp v16, v16, v16 quad_perm:[2,3,0,1] row_mask:0xf bank_mask:0xf
    s_nop 1
    v_add_f32_dpp v16, v16, v16 row_ror:4 row_mask:0xf bank_mask:0xf
    s_nop 1
    v_add_f32_dpp v16, v16, v16 row_ror:8 row_mask:0xf bank_mask:0xf
    v_cvt_pk_bf16_f32 v16, 0, v16
    v_mul_f32 v16, v16, v11
    v_cvt_pk_bf16_f32 v16, 0, v16
    v_add_f32 v16, v16, v2
    v_cvt_pk_bf16_f32 v16, 0, v16
    v_add_f32 v16, v16, v3
    v_cvt_pk_bf16_f32 v16, 0, v16
    s_mov_b32 exec_lo, 0x00030003
    s_mov_b32 exec_hi, 0x00030003
    buffer_store_short_d16_hi v16, v12, s[28:31], s21 offen
    s_nop 1
fk_fin:
fk_end:
    s_endpgm
.section .rodata,"a"
.p2align 6
.amdhsa_kernel sequential_preLN__spectral_fnet__moe_arch_mod__prompt_kernel
  .amdhsa_next_free_vgpr 256
  .amdhsa_next_free_sgpr 102
  .amdhsa_accum_offset 256
  .amdhsa_group_segment_fixed_size 0
  .amdhsa_kernarg_size 104
  .amdhsa_user_sgpr_count 2
  .amdhsa_user_sgpr_kernarg_segment_ptr 1
  .amdhsa_system_sgpr_workgroup_id_x 1
.end_amdhsa_kernel
```

```asm
; @launch grid=(256,1,1) block=(512,1,1) lds=157952
.amdgcn_target "amdgcn-amd-amdhsa--gfx950"
.text
.globl sequential_preLN__spectral_fnet__moe_arch_mod__prompt_kernel
.p2align 8
.type sequential_preLN__spectral_fnet__moe_arch_mod__prompt_kernel,@function
sequential_preLN__spectral_fnet__moe_arch_mod__prompt_kernel:
    s_cmp_gt_u32 s2, 255
    s_cbranch_scc1 fk_end
    s_load_dwordx2 s[8:9], s[0:1], 0
    s_load_dwordx2 s[24:25], s[0:1], 96
    s_load_dwordx2 s[32:33], s[0:1], 48
    s_load_dwordx2 s[44:45], s[0:1], 56
    s_load_dwordx2 s[48:49], s[0:1], 64
    s_load_dwordx2 s[52:53], s[0:1], 72
    s_load_dwordx2 s[28:29], s[0:1], 80
    s_getpc_b64 s[40:41]
fk_pc:
    s_mov_b32 s42, fk_end-fk_pc
    s_mov_b32 s43, 0x00020000
    v_lshlrev_b32 v250, 6, v0
    buffer_load_dword v251, v250, s[40:43], 0 offen
    v_lshrrev_b32 v1, 6, v0
    v_and_b32 v15, 63, v0
    v_readfirstlane_b32 s16, v1
    s_and_b32 s3, s2, 0xe0
    s_and_b32 s17, s2, 7
    s_lshl_b32 s17, s17, 2
    s_or_b32 s3, s3, s17
    s_bfe_u32 s17, s2, 0x20003
    s_or_b32 s3, s3, s17
    s_lshr_b32 s17, s3, 4
    s_add_u32 s17, s17, 1
    s_cmp_ge_u32 s3, 248
    s_cselect_b32 s17, 0, s17
    s_cmp_ge_u32 s3, 240
    s_cselect_b32 s18, 7, 15
    s_and_b32 s18, s18, s3
    s_lshl_b32 s18, s18, 7
    s_add_u32 s18, s18, s17
    v_and_b32 v1, 31, v15
    v_lshrrev_b32 v2, 5, v15
    v_lshlrev_b32 v14, 4, v15
    s_mov_b32 s10, 0x400000
    s_mov_b32 s11, 0x00020000
    s_mov_b32 s26, 0x6b8000
    s_mov_b32 s27, 0x00020000
    s_mov_b32 s30, 0x400000
    s_mov_b32 s31, 0x00020000
    s_mov_b32 s34, 0x800
    s_mov_b32 s35, 0x00020000
    s_mov_b32 s46, 0x700000
    s_mov_b32 s47, 0x00020000
    s_mov_b32 s50, 0x700000
    s_mov_b32 s51, 0x00020000
    s_mov_b32 s54, 0x700000
    s_mov_b32 s55, 0x00020000
    s_cmp_eq_u32 s3, 255
    s_cselect_b32 s12, 5, 4
    s_cmp_ge_u32 s16, s12
    s_cbranch_scc1 fk_H
    s_cmp_eq_u32 s16, 4
    s_cbranch_scc1 fk_lowp
    s_setprio 3
fk_lowp:
    s_lshl_b32 s19, s16, 5
    s_add_u32 s19, s19, s18
    s_sub_u32 s20, 2048, s19
    s_and_b32 s20, s20, 2047
    s_lshl_b32 s21, s19, 11
    s_lshl_b32 s22, s20, 11
    s_lshl_b32 s12, s16, 12
    s_add_u32 s12, s12, 98304
    s_mov_b32 m0, s12
    v_mov_b32 v16, 0
    v_mov_b32 v17, 0
    v_mov_b32 v18, 0
    v_mov_b32 v19, 0
    v_mov_b32 v20, 0
    v_mov_b32 v21, 0
    v_mov_b32 v22, 0
    v_mov_b32 v23, 0
    v_mov_b32 v24, 0
    v_mov_b32 v25, 0
    v_mov_b32 v26, 0
    v_mov_b32 v27, 0
    v_mov_b32 v28, 0
    v_mov_b32 v29, 0
    v_mov_b32 v30, 0
    v_mov_b32 v31, 0
    v_mov_b32 v32, 0
    v_mov_b32 v33, 0
    v_mov_b32 v34, 0
    v_mov_b32 v35, 0
    v_mov_b32 v36, 0
    v_mov_b32 v37, 0
    v_mov_b32 v38, 0
    v_mov_b32 v39, 0
    v_mov_b32 v40, 0
    v_mov_b32 v41, 0
    v_mov_b32 v42, 0
    v_mov_b32 v43, 0
    v_mov_b32 v44, 0
    v_mov_b32 v45, 0
    v_mov_b32 v46, 0
    v_mov_b32 v47, 0
    v_cvt_f32_u32 v200, v1
    v_lshlrev_b32 v7, 2, v2
    v_cvt_f32_u32 v7, v7
    v_lshrrev_b32 v8, 1, v1
    v_and_b32 v9, 1, v1
    v_lshlrev_b32 v205, 2, v15
    v_and_b32 v205, 63, v205
    v_add_u32 v205, 157824, v205
    ds_write_b32 v205, v16
    ds_write_b32 v205, v16 offset:64
    s_waitcnt lgkmcnt(0)
    buffer_load_dwordx4 v14, s[8:11], s21 offen lds
    s_add_u32 s13, s12, 1024
    s_mov_b32 m0, s13
    s_add_u32 s14, s21, 1024
    buffer_load_dwordx4 v14, s[8:11], s14 offen lds
    s_add_u32 s13, s12, 2048
    s_mov_b32 m0, s13
    s_nop 0
    buffer_load_dwordx4 v14, s[8:11], s22 offen lds
    s_add_u32 s13, s12, 3072
    s_mov_b32 m0, s13
    s_add_u32 s14, s22, 1024
    buffer_load_dwordx4 v14, s[8:11], s14 offen lds
    s_barrier
    v_add_u32 v206, 138496, v14
    s_lshl_b32 s13, s16, 2
    s_add_u32 s13, s13, 157824
    v_mov_b32 v201, s13
    v_mov_b32 v202, 1
    s_cmp_eq_u32 s16, 1
    s_cbranch_scc1 fk_j1
    s_cmp_eq_u32 s16, 2
    s_cbranch_scc1 fk_j2
    s_cmp_eq_u32 s16, 3
    s_cbranch_scc1 fk_j3
    s_cmp_eq_u32 s16, 4
    s_cbranch_scc1 fk_jend
    v_cmp_eq_u32 vcc, 1, v1
    s_nop 1
    v_cndmask_b32 v10, v8, 16, vcc
    v_cndmask_b32 v11, v9, 0, vcc
    v_cvt_f32_u32 v10, v10
    v_cvt_f32_u32 v11, v11
    v_mul_f32 v10, 0x3d000000, v10
    v_mul_f32 v11, 0x3e800000, v11
    v_add_f32 v12, v7, v7
    v_fma_f32 v11, v10, v12, v11
    v_mov_b32 v128, v11
    v_fmamk_f32 v129, v10, 0x3f800000, v11
    v_fmamk_f32 v130, v10, 0x40000000, v11
    v_fmamk_f32 v131, v10, 0x40400000, v11
    v_fmamk_f32 v132, v10, 0x40800000, v11
    v_fmamk_f32 v133, v10, 0x40a00000, v11
    v_fmamk_f32 v134, v10, 0x40c00000, v11
    v_fmamk_f32 v135, v10, 0x40e00000, v11
    v_fmamk_f32 v136, v10, 0x41800000, v11
    v_fmamk_f32 v137, v10, 0x41880000, v11
    v_fmamk_f32 v138, v10, 0x41900000, v11
    v_fmamk_f32 v139, v10, 0x41980000, v11
    v_fmamk_f32 v140, v10, 0x41a00000, v11
    v_fmamk_f32 v141, v10, 0x41a80000, v11
    v_fmamk_f32 v142, v10, 0x41b00000, v11
    v_fmamk_f32 v143, v10, 0x41b80000, v11
    v_cos_f32 v144, v128
    v_cos_f32 v145, v129
    v_cos_f32 v146, v130
    v_cos_f32 v147, v131
    v_cos_f32 v148, v132
    v_cos_f32 v149, v133
    v_cos_f32 v150, v134
    v_cos_f32 v151, v135
    v_cos_f32 v152, v136
    v_cos_f32 v153, v137
    v_cos_f32 v154, v138
    v_cos_f32 v155, v139
    v_cos_f32 v156, v140
    v_cos_f32 v157, v141
    v_cos_f32 v158, v142
    v_cos_f32 v159, v143
    v_cvt_pk_f16_f32 v48, v144, v145
    v_cvt_pk_f16_f32 v49, v146, v147
    v_cvt_pk_f16_f32 v50, v148, v149
    v_cvt_pk_f16_f32 v51, v150, v151
    v_cvt_pk_f16_f32 v52, v152, v153
    v_cvt_pk_f16_f32 v53, v154, v155
    v_cvt_pk_f16_f32 v54, v156, v157
    v_cvt_pk_f16_f32 v55, v158, v159
    ds_write_b128 v206, v[48:51] offset:0
    ds_write_b128 v206, v[52:55] offset:1024
    s_branch fk_jsig
    s_nop 1
fk_j1:
    v_cvt_f32_u32 v10, v8
    v_lshlrev_b32 v11, 31, v9
    v_mul_f32 v10, 0x3a800000, v10
    v_xor_b32 v10, v11, v10
    v_mul_f32 v11, v10, v7
    v_mov_b32 v128, v11
    v_fmamk_f32 v129, v10, 0x3f800000, v11
    v_fmamk_f32 v130, v10, 0x40000000, v11
    v_fmamk_f32 v131, v10, 0x40400000, v11
    v_fmamk_f32 v132, v10, 0x41000000, v11
    v_fmamk_f32 v133, v10, 0x41100000, v11
    v_fmamk_f32 v134, v10, 0x41200000, v11
    v_fmamk_f32 v135, v10, 0x41300000, v11
    v_fmamk_f32 v136, v10, 0x41800000, v11
    v_fmamk_f32 v137, v10, 0x41880000, v11
    v_fmamk_f32 v138, v10, 0x41900000, v11
    v_fmamk_f32 v139, v10, 0x41980000, v11
    v_fmamk_f32 v140, v10, 0x41c00000, v11
    v_fmamk_f32 v141, v10, 0x41c80000, v11
    v_fmamk_f32 v142, v10, 0x41d00000, v11
    v_fmamk_f32 v143, v10, 0x41d80000, v11
    v_cos_f32 v56, v128
    v_cos_f32 v57, v129
    v_cos_f32 v58, v130
    v_cos_f32 v59, v131
    v_cos_f32 v60, v132
    v_cos_f32 v61, v133
    v_cos_f32 v62, v134
    v_cos_f32 v63, v135
    v_cos_f32 v64, v136
    v_cos_f32 v65, v137
    v_cos_f32 v66, v138
    v_cos_f32 v67, v139
    v_cos_f32 v68, v140
    v_cos_f32 v69, v141
    v_cos_f32 v70, v142
    v_cos_f32 v71, v143
    ds_write_b128 v206, v[56:59] offset:2048
    ds_write_b128 v206, v[60:63] offset:3072
    ds_write_b128 v206, v[64:67] offset:4096
    ds_write_b128 v206, v[68:71] offset:5120
    v_sin_f32 v72, v128
    v_sin_f32 v73, v129
    v_sin_f32 v74, v130
    v_sin_f32 v75, v131
    v_sin_f32 v76, v132
    v_sin_f32 v77, v133
    v_sin_f32 v78, v134
    v_sin_f32 v79, v135
    v_sin_f32 v80, v136
    v_sin_f32 v81, v137
    v_sin_f32 v82, v138
    v_sin_f32 v83, v139
    v_sin_f32 v84, v140
    v_sin_f32 v85, v141
    v_sin_f32 v86, v142
    v_sin_f32 v87, v143
    ds_write_b128 v206, v[72:75] offset:6144
    ds_write_b128 v206, v[76:79] offset:7168
    ds_write_b128 v206, v[80:83] offset:8192
    ds_write_b128 v206, v[84:87] offset:9216
    s_branch fk_jsig
    s_nop 0
fk_j2:
    v_mul_f32 v128, 0x3d000000, v200
    v_mul_f32 v129, v128, v7
    v_mov_b32 v130, v129
    v_fmamk_f32 v131, v128, 0x3f800000, v129
    v_fmamk_f32 v132, v128, 0x40000000, v129
    v_fmamk_f32 v133, v128, 0x40400000, v129
    v_fmamk_f32 v134, v128, 0x41000000, v129
    v_fmamk_f32 v135, v128, 0x41100000, v129
    v_fmamk_f32 v136, v128, 0x41200000, v129
    v_fmamk_f32 v137, v128, 0x41300000, v129
    v_fmamk_f32 v138, v128, 0x41800000, v129
    v_fmamk_f32 v139, v128, 0x41880000, v129
    v_fmamk_f32 v140, v128, 0x41900000, v129
    v_fmamk_f32 v141, v128, 0x41980000, v129
    v_fmamk_f32 v142, v128, 0x41c00000, v129
    v_fmamk_f32 v143, v128, 0x41c80000, v129
    v_fmamk_f32 v144, v128, 0x41d00000, v129
    v_fmamk_f32 v145, v128, 0x41d80000, v129
    v_cos_f32 v146, v130
    v_cos_f32 v147, v131
    v_cos_f32 v148, v132
    v_cos_f32 v149, v133
    v_cos_f32 v150, v134
    v_cos_f32 v151, v135
    v_cos_f32 v152, v136
    v_cos_f32 v153, v137
    v_cos_f32 v154, v138
    v_cos_f32 v155, v139
    v_cos_f32 v156, v140
    v_cos_f32 v157, v141
    v_cos_f32 v158, v142
    v_cos_f32 v159, v143
    v_cos_f32 v160, v144
    v_cos_f32 v161, v145
    v_cvt_pk_f16_f32 v96, v146, v147
    v_cvt_pk_f16_f32 v97, v148, v149
    v_cvt_pk_f16_f32 v98, v150, v151
    v_cvt_pk_f16_f32 v99, v152, v153
    v_cvt_pk_f16_f32 v100, v154, v155
    v_cvt_pk_f16_f32 v101, v156, v157
    v_cvt_pk_f16_f32 v102, v158, v159
    v_cvt_pk_f16_f32 v103, v160, v161
    v_sin_f32 v146, v130
    v_sin_f32 v147, v131
    v_sin_f32 v148, v132
    v_sin_f32 v149, v133
    v_sin_f32 v150, v134
    v_sin_f32 v151, v135
    v_sin_f32 v152, v136
    v_sin_f32 v153, v137
    v_sin_f32 v154, v138
    v_sin_f32 v155, v139
    v_sin_f32 v156, v140
    v_sin_f32 v157, v141
    v_sin_f32 v158, v142
    v_sin_f32 v159, v143
    v_sin_f32 v160, v144
    v_sin_f32 v161, v145
    v_cvt_pk_f16_f32 v104, v146, v147
    v_cvt_pk_f16_f32 v105, v148, v149
    v_cvt_pk_f16_f32 v106, v150, v151
    v_cvt_pk_f16_f32 v107, v152, v153
    v_cvt_pk_f16_f32 v108, v154, v155
    v_cvt_pk_f16_f32 v109, v156, v157
    v_cvt_pk_f16_f32 v110, v158, v159
    v_cvt_pk_f16_f32 v111, v160, v161
    ds_write_b128 v206, v[96:99] offset:12288
    ds_write_b128 v206, v[100:103] offset:13312
    ds_write_b128 v206, v[104:107] offset:14336
    ds_write_b128 v206, v[108:111] offset:15360
    s_branch fk_jsig
    s_nop 0
fk_j3:
    v_or_b32 v10, 16, v1
    v_cvt_f32_u32 v10, v10
    v_mov_b32 v11, 0x3c800000
    v_fmamk_f32 v10, v10, 0x3d000000, v11
    v_cmp_gt_u32 vcc, 16, v1
    v_mov_b32 v12, 0xbe800000
    s_nop 0
    v_cndmask_b32 v12, 0, v12, vcc
    v_fma_f32 v11, v10, v7, v12
    v_mov_b32 v128, v11
    v_fmamk_f32 v129, v10, 0x3f800000, v11
    v_fmamk_f32 v130, v10, 0x40000000, v11
    v_fmamk_f32 v131, v10, 0x40400000, v11
    v_fmamk_f32 v132, v10, 0x41000000, v11
    v_fmamk_f32 v133, v10, 0x41100000, v11
    v_fmamk_f32 v134, v10, 0x41200000, v11
    v_fmamk_f32 v135, v10, 0x41300000, v11
    v_fmamk_f32 v136, v10, 0x41800000, v11
    v_fmamk_f32 v137, v10, 0x41880000, v11
    v_fmamk_f32 v138, v10, 0x41900000, v11
    v_fmamk_f32 v139, v10, 0x41980000, v11
    v_fmamk_f32 v140, v10, 0x41c00000, v11
    v_fmamk_f32 v141, v10, 0x41c80000, v11
    v_fmamk_f32 v142, v10, 0x41d00000, v11
    v_fmamk_f32 v143, v10, 0x41d80000, v11
    v_cos_f32 v144, v128
    v_cos_f32 v145, v129
    v_cos_f32 v146, v130
    v_cos_f32 v147, v131
    v_cos_f32 v148, v132
    v_cos_f32 v149, v133
    v_cos_f32 v150, v134
    v_cos_f32 v151, v135
    v_cos_f32 v152, v136
    v_cos_f32 v153, v137
    v_cos_f32 v154, v138
    v_cos_f32 v155, v139
    v_cos_f32 v156, v140
    v_cos_f32 v157, v141
    v_cos_f32 v158, v142
    v_cos_f32 v159, v143
    v_cvt_pk_f16_f32 v88, v144, v145
    v_cvt_pk_f16_f32 v89, v146, v147
    v_cvt_pk_f16_f32 v90, v148, v149
    v_cvt_pk_f16_f32 v91, v150, v151
    v_cvt_pk_f16_f32 v92, v152, v153
    v_cvt_pk_f16_f32 v93, v154, v155
    v_cvt_pk_f16_f32 v94, v156, v157
    v_cvt_pk_f16_f32 v95, v158, v159
    ds_write_b128 v206, v[88:91] offset:10240
    ds_write_b128 v206, v[92:95] offset:11264
    s_nop 2
fk_jsig:
    ds_write_b32 v201, v202 offset:32
fk_jend:
    v_lshlrev_b32 v3, 9, v2
    v_lshl_add_u32 v3, v1, 1, v3
    v_sub_u32 v4, 576, v3
    v_sub_u32 v5, 2048, v3
    v_and_b32 v5, 2047, v5
    v_add_u32 v3, s12, v3
    v_add_u32 v4, s12, v4
    v_add_u32 v5, s12, v5
    s_lshl_b32 s13, s16, 10
    s_sub_u32 s14, 7232, s13
    s_cmp_ge_u32 s3, 248
    s_cselect_b32 s15, 1024, 0
    s_add_u32 s14, s14, s15
    s_cmp_eq_u32 s14, 8256
    s_cselect_b32 s14, 4160, s14
    s_cmp_eq_u32 s19, s20
    s_cselect_b32 s14, 8256, s14
    s_cmp_eq_u32 s16, 4
    s_cselect_b32 s13, 8256, s13
    s_cmp_lg_u32 s19, 0
    s_cbranch_scc1 fk_noz
    v_add_u32 v8, 124992, v14
    ds_write_b128 v8, v[16:19]
fk_noz:
    s_add_u32 s13, s13, 120832
    s_add_u32 s14, s14, 120832
    v_cmp_gt_u32 vcc, 16, v1
    v_mov_b32 v8, s13
    v_mov_b32 v9, s14
    v_cndmask_b32 v10, v9, v8, vcc
    v_cndmask_b32 v11, v8, v9, vcc
    v_lshl_add_u32 v10, v15, 2, v10
    v_lshl_add_u32 v11, v15, 2, v11
    v_lshrrev_b32 v6, 1, v15
    v_and_b32 v8, 1, v15
    v_mul_u32_u24 v9, 4160, v8
    v_and_b32 v12, 15, v6
    v_lshl_add_u32 v12, v12, 4, v2
    v_mul_u32_u24 v12, 9344, v12
    v_mul_u32_u24 v192, 18688, v8
    v_add_u32 v192, v192, v12
    v_lshl_add_u32 v12, v8, 4, v12
    v_lshrrev_b32 v194, 3, v15
    v_lshlrev_b32 v193, 4, v194
    v_lshl_add_u32 v193, v8, 7, v193
    v_and_b32 v6, 3, v6
    v_lshl_add_u32 v9, v6, 2, v9
    v_lshl_add_u32 v9, v194, 7, v9
    v_lshlrev_b32 v194, 10, v194
    v_and_b32 v6, 7, v15
    v_lshl_add_u32 v194, v6, 4, v194
    s_lshl_b32 s13, s16, 5
    s_add_u32 s13, s13, 120832
    v_add_u32 v6, s13, v9
    s_mul_i32 s36, s3, 9344
    s_lshl_b32 s13, s16, 8
    s_add_u32 s36, s36, s13
    s_add_u32 s36, s36, 0x20000
    s_mul_i32 s37, s16, 37376
    s_add_u32 s37, s37, 0x20000
    s_bfe_u32 s23, s3, 0x30002
    s_lshl_b32 s23, s23, 7
    s_lshr_b32 s12, s3, 5
    s_lshl_b32 s12, s12, 4
    s_add_u32 s23, s23, s12
    s_and_b32 s12, s3, 3
    s_lshl_b32 s12, s12, 2
    s_add_u32 s23, s23, s12
    s_add_u32 s23, s23, 8192
    s_add_u32 s23, s23, s37
    s_lshl_b32 s14, s3, 5
    s_add_u32 s37, s37, s14
    s_add_u32 s38, s37, 18688
    s_lshl_b32 s13, s16, 11
    s_add_u32 s13, s13, 130304
    v_add_u32 v7, s13, v14
    v_cmp_eq_u32 s[58:59], 1, v8
    s_cmp_eq_u32 s19, s20
    s_cselect_b32 s39, 0.5, 1.0
    s_lshl_b32 s13, s16, 2
    s_add_u32 s13, s13, 157056
    v_mov_b32 v9, s13
    s_mov_b32 s57, 47
    s_nop 3
fk_spinc:
    ds_read_b32 v203, v205
    s_waitcnt lgkmcnt(0)
    v_cmp_eq_u32 vcc, 0, v203
    s_nop 1
    s_and_b32 s13, vcc_lo, 0xf00
    s_cbranch_scc1 fk_spinc
    ds_read_b128 v[48:51], v206 offset:0
    ds_read_b128 v[52:55], v206 offset:1024
    ds_read_b128 v[56:59], v206 offset:2048
    ds_read_b128 v[60:63], v206 offset:3072
    ds_read_b128 v[64:67], v206 offset:4096
    ds_read_b128 v[68:71], v206 offset:5120
    ds_read_b128 v[72:75], v206 offset:6144
    ds_read_b128 v[76:79], v206 offset:7168
    ds_read_b128 v[80:83], v206 offset:8192
    ds_read_b128 v[84:87], v206 offset:9216
    ds_read_b128 v[88:91], v206 offset:10240
    ds_read_b128 v[92:95], v206 offset:11264
    s_waitcnt lgkmcnt(8)
    ds_read_b128 v[96:99], v206 offset:12288
    ds_read_b128 v[100:103], v206 offset:13312
    ds_read_b128 v[104:107], v206 offset:14336
    ds_read_b128 v[108:111], v206 offset:15360
    s_waitcnt vmcnt(0) lgkmcnt(0)
    ds_read_u16_d16_hi v16, v3 offset:0
    ds_read_u16_d16_hi v17, v3 offset:64
    ds_read_u16_d16_hi v18, v3 offset:128
    ds_read_u16_d16_hi v19, v3 offset:192
    ds_read_u16_d16_hi v20, v3 offset:256
    ds_read_u16_d16_hi v21, v3 offset:320
    ds_read_u16_d16_hi v22, v3 offset:384
    ds_read_u16_d16_hi v23, v3 offset:448
    ds_read_u16_d16_hi v24, v3 offset:1024
    ds_read_u16_d16_hi v25, v3 offset:1088
    ds_read_u16_d16_hi v26, v3 offset:1152
    ds_read_u16_d16_hi v27, v3 offset:1216
    ds_read_u16_d16_hi v28, v3 offset:1280
    ds_read_u16_d16_hi v29, v3 offset:1344
    ds_read_u16_d16_hi v30, v3 offset:1408
    ds_read_u16_d16_hi v31, v3 offset:1472
    s_waitcnt lgkmcnt(2)
    ds_read_u16_d16_hi v32, v5 offset:2048
    ds_read_u16_d16_hi v33, v4 offset:3456
    ds_read_u16_d16_hi v34, v4 offset:3392
    ds_read_u16_d16_hi v35, v4 offset:3328
    ds_read_u16_d16_hi v36, v4 offset:3264
    ds_read_u16_d16_hi v37, v4 offset:3200
    ds_read_u16_d16_hi v38, v4 offset:3136
    ds_read_u16_d16_hi v39, v4 offset:3072
    ds_read_u16_d16_hi v40, v4 offset:2496
    ds_read_u16_d16_hi v41, v4 offset:2432
    ds_read_u16_d16_hi v42, v4 offset:2368
    ds_read_u16_d16_hi v43, v4 offset:2304
    ds_read_u16_d16_hi v44, v4 offset:2240
    s_waitcnt lgkmcnt(8)
    ds_read_u16_d16_hi v45, v4 offset:2176
    ds_read_u16_d16_hi v46, v4 offset:2112
    ds_read_u16_d16_hi v47, v4 offset:2048
    v_pk_add_f32 v[128:129], v[16:17], v[18:19]
    v_pk_add_f32 v[130:131], v[20:21], v[22:23]
    v_pk_add_f32 v[132:133], v[24:25], v[26:27]
    v_pk_add_f32 v[134:135], v[28:29], v[30:31]
    v_pk_mul_f32 v[136:137], v[16:17], v[16:17]
    v_pk_mul_f32 v[138:139], v[18:19], v[18:19]
    v_pk_fma_f32 v[136:137], v[20:21], v[20:21], v[136:137]
    v_pk_fma_f32 v[138:139], v[22:23], v[22:23], v[138:139]
    v_pk_fma_f32 v[136:137], v[24:25], v[24:25], v[136:137]
    v_pk_fma_f32 v[138:139], v[26:27], v[26:27], v[138:139]
    v_pk_fma_f32 v[136:137], v[28:29], v[28:29], v[136:137]
    v_pk_fma_f32 v[138:139], v[30:31], v[30:31], v[138:139]
    v_pk_add_f32 v[128:129], v[128:129], v[130:131]
    v_pk_add_f32 v[132:133], v[132:133], v[134:135]
    v_pk_add_f32 v[136:137], v[136:137], v[138:139]
    v_pk_add_f32 v[128:129], v[128:129], v[132:133]
    v_add_f32 v136, v136, v137
    v_add_f32 v128, v128, v129
    s_waitcnt lgkmcnt(0)
    v_pk_add_f32 v[140:141], v[32:33], v[34:35]
    v_pk_add_f32 v[142:143], v[36:37], v[38:39]
    v_pk_add_f32 v[144:145], v[40:41], v[42:43]
    v_pk_add_f32 v[146:147], v[44:45], v[46:47]
    v_pk_mul_f32 v[148:149], v[32:33], v[32:33]
    v_pk_mul_f32 v[150:151], v[34:35], v[34:35]
    v_pk_fma_f32 v[148:149], v[36:37], v[36:37], v[148:149]
    v_pk_fma_f32 v[150:151], v[38:39], v[38:39], v[150:151]
    v_pk_fma_f32 v[148:149], v[40:41], v[40:41], v[148:149]
    v_pk_fma_f32 v[150:151], v[42:43], v[42:43], v[150:151]
    v_pk_fma_f32 v[148:149], v[44:45], v[44:45], v[148:149]
    v_pk_fma_f32 v[150:151], v[46:47], v[46:47], v[150:151]
    v_pk_add_f32 v[140:141], v[140:141], v[142:143]
    v_pk_add_f32 v[144:145], v[144:145], v[146:147]
    v_pk_add_f32 v[148:149], v[148:149], v[150:151]
    v_pk_add_f32 v[140:141], v[140:141], v[144:145]
    v_add_f32 v148, v148, v149
    v_add_f32 v140, v140, v141
    s_nop 1
    v_permlane32_swap_b32 v128, v140
    v_permlane32_swap_b32 v136, v148
    v_add_f32 v128, v128, v140
    v_add_f32 v136, v136, v148
    s_nop 1
    v_permlane16_swap_b32 v128, v136
    v_add_f32 v128, v128, v136
    s_nop 1
    v_add_f32_dpp v128, v128, v128 quad_perm:[1,0,3,2] row_mask:0xf bank_mask:0xf
    s_nop 1
    v_add_f32_dpp v128, v128, v128 quad_perm:[2,3,0,1] row_mask:0xf bank_mask:0xf
    s_nop 1
    v_add_f32_dpp v128, v128, v128 row_half_mirror row_mask:0xf bank_mask:0xf
    s_nop 1
    v_add_f32_dpp v128, v128, v128 row_mirror row_mask:0xf bank_mask:0xf
    s_nop 1
    v_mov_b32_dpp v129, v128 row_bcast:15 row_mask:0xa bank_mask:0xf
    v_mul_f32 v130, 0x3a800000, v128
    v_mul_f32 v129, 0x3a800000, v129
    v_fma_f32 v130, -v129, v129, v130
    v_max_f32 v130, 0, v130
    v_cvt_pk_bf16_f32 v130, 0, v130
    v_cvt_pk_bf16_f32 v129, 0, v129
    v_add_f32 v130, 0x3727c5ac, v130
    v_cvt_pk_bf16_f32 v130, 0, v130
    v_sqrt_f32 v130, v130
    s_nop 0
    v_cvt_pk_bf16_f32 v130, 0, v130
    v_rcp_f32 v130, v130
    s_nop 0
    v_mul_f32 v130, 0x3c000000, v130
    v_mul_f32 v129, v129, v130
    v_readlane_b32 s4, v130, 16
    v_readlane_b32 s6, v130, 48
    v_readlane_b32 s13, v129, 16
    v_readlane_b32 s14, v129, 48
    s_nop 0
    v_mov_b32 v132, s13
    v_add_f32 v132, s14, v132
    v_pk_fma_f32 v[32:33], v[32:33], s[6:7], v[132:133] op_sel_hi:[1,0,0] neg_lo:[0,0,1] neg_hi:[0,0,1]
    v_pk_fma_f32 v[34:35], v[34:35], s[6:7], v[132:133] op_sel_hi:[1,0,0] neg_lo:[0,0,1] neg_hi:[0,0,1]
    v_pk_fma_f32 v[36:37], v[36:37], s[6:7], v[132:133] op_sel_hi:[1,0,0] neg_lo:[0,0,1] neg_hi:[0,0,1]
    v_pk_fma_f32 v[38:39], v[38:39], s[6:7], v[132:133] op_sel_hi:[1,0,0] neg_lo:[0,0,1] neg_hi:[0,0,1]
    v_pk_fma_f32 v[40:41], v[40:41], s[6:7], v[132:133] op_sel_hi:[1,0,0] neg_lo:[0,0,1] neg_hi:[0,0,1]
    v_pk_fma_f32 v[42:43], v[42:43], s[6:7], v[132:133] op_sel_hi:[1,0,0] neg_lo:[0,0,1] neg_hi:[0,0,1]
    v_pk_fma_f32 v[44:45], v[44:45], s[6:7], v[132:133] op_sel_hi:[1,0,0] neg_lo:[0,0,1] neg_hi:[0,0,1]
    v_pk_fma_f32 v[46:47], v[46:47], s[6:7], v[132:133] op_sel_hi:[1,0,0] neg_lo:[0,0,1] neg_hi:[0,0,1]
    v_pk_fma_f32 v[16:17], v[16:17], s[4:5], v[32:33] op_sel_hi:[1,0,1]
    v_pk_fma_f32 v[18:19], v[18:19], s[4:5], v[34:35] op_sel_hi:[1,0,1]
    v_pk_fma_f32 v[20:21], v[20:21], s[4:5], v[36:37] op_sel_hi:[1,0,1]
    v_pk_fma_f32 v[22:23], v[22:23], s[4:5], v[38:39] op_sel_hi:[1,0,1]
    v_pk_fma_f32 v[24:25], v[24:25], s[4:5], v[40:41] op_sel_hi:[1,0,1]
    v_pk_fma_f32 v[26:27], v[26:27], s[4:5], v[42:43] op_sel_hi:[1,0,1]
    v_pk_fma_f32 v[28:29], v[28:29], s[4:5], v[44:45] op_sel_hi:[1,0,1]
    v_pk_fma_f32 v[30:31], v[30:31], s[4:5], v[46:47] op_sel_hi:[1,0,1]
    v_cvt_pk_f16_f32 v176, v16, v17
    v_cvt_pk_f16_f32 v177, v18, v19
    v_cvt_pk_f16_f32 v178, v20, v21
    v_cvt_pk_f16_f32 v179, v22, v23
    v_cvt_pk_f16_f32 v180, v24, v25
    v_cvt_pk_f16_f32 v181, v26, v27
    v_cvt_pk_f16_f32 v182, v28, v29
    v_cvt_pk_f16_f32 v183, v30, v31
    v_mfma_f32_32x32x16_f16 v[112:127], v[176:179], v[48:51], 0
    s_nop 0
    v_mfma_f32_32x32x16_f16 v[112:127], v[180:183], v[52:55], v[112:127]
    s_nop 11
    v_pk_mul_f32 v[16:17], v[112:113], v[56:57]
    v_pk_mul_f32 v[18:19], v[114:115], v[58:59]
    v_pk_mul_f32 v[20:21], v[116:117], v[60:61]
    v_pk_mul_f32 v[22:23], v[118:119], v[62:63]
    v_pk_mul_f32 v[24:25], v[120:121], v[64:65]
    v_pk_mul_f32 v[26:27], v[122:123], v[66:67]
    v_pk_mul_f32 v[28:29], v[124:125], v[68:69]
    v_pk_mul_f32 v[30:31], v[126:127], v[70:71]
    v_fmac_f32_dpp v16, v112, v72 quad_perm:[1,0,3,2] row_mask:0xf bank_mask:0xf
    v_fmac_f32_dpp v17, v113, v73 quad_perm:[1,0,3,2] row_mask:0xf bank_mask:0xf
    v_fmac_f32_dpp v18, v114, v74 quad_perm:[1,0,3,2] row_mask:0xf bank_mask:0xf
    v_fmac_f32_dpp v19, v115, v75 quad_perm:[1,0,3,2] row_mask:0xf bank_mask:0xf
    v_fmac_f32_dpp v20, v116, v76 quad_perm:[1,0,3,2] row_mask:0xf bank_mask:0xf
    v_fmac_f32_dpp v21, v117, v77 quad_perm:[1,0,3,2] row_mask:0xf bank_mask:0xf
    v_fmac_f32_dpp v22, v118, v78 quad_perm:[1,0,3,2] row_mask:0xf bank_mask:0xf
    v_fmac_f32_dpp v23, v119, v79 quad_perm:[1,0,3,2] row_mask:0xf bank_mask:0xf
    v_cvt_pk_f16_f32 v176, v16, v17
    v_cvt_pk_f16_f32 v177, v18, v19
    v_cvt_pk_f16_f32 v178, v20, v21
    v_cvt_pk_f16_f32 v179, v22, v23
    v_fmac_f32_dpp v24, v120, v80 quad_perm:[1,0,3,2] row_mask:0xf bank_mask:0xf
    v_fmac_f32_dpp v25, v121, v81 quad_perm:[1,0,3,2] row_mask:0xf bank_mask:0xf
    v_mfma_f32_32x32x16_f16 v[128:143], v[176:179], v[96:99], 0
    v_fmac_f32_dpp v26, v122, v82 quad_perm:[1,0,3,2] row_mask:0xf bank_mask:0xf
    v_fmac_f32_dpp v27, v123, v83 quad_perm:[1,0,3,2] row_mask:0xf bank_mask:0xf
    v_fmac_f32_dpp v28, v124, v84 quad_perm:[1,0,3,2] row_mask:0xf bank_mask:0xf
    v_fmac_f32_dpp v29, v125, v85 quad_perm:[1,0,3,2] row_mask:0xf bank_mask:0xf
    v_mfma_f32_32x32x16_f16 v[144:159], v[176:179], v[104:107], 0
    v_fmac_f32_dpp v30, v126, v86 quad_perm:[1,0,3,2] row_mask:0xf bank_mask:0xf
    v_fmac_f32_dpp v31, v127, v87 quad_perm:[1,0,3,2] row_mask:0xf bank_mask:0xf
    v_cvt_pk_f16_f32 v180, v24, v25
    v_cvt_pk_f16_f32 v181, v26, v27
    v_mfma_f32_32x32x16_f16 v[160:175], v[176:179], v[88:91], 0
    v_cvt_pk_f16_f32 v182, v28, v29
    v_cvt_pk_f16_f32 v183, v30, v31
    s_nop 1
    v_mfma_f32_32x32x16_f16 v[128:143], v[180:183], v[100:103], v[128:143]
    v_mfma_f32_32x32x16_f16 v[144:159], v[180:183], v[108:111], v[144:159]
    v_mfma_f32_32x32x16_f16 v[160:175], v[180:183], v[92:95], v[160:175]
    v_cmp_gt_u32 vcc, 16, v15
    v_cmp_gt_u32 s[40:41], 32, v15
    s_nop 8
    v_pk_add_f32 v[20:21], v[132:133], v[148:149] op_sel:[0,1] op_sel_hi:[1,0] neg_hi:[0,1]
    v_pk_add_f32 v[22:23], v[134:135], v[150:151] op_sel:[0,1] op_sel_hi:[1,0] neg_hi:[0,1]
    v_pk_add_f32 v[36:37], v[20:21], v[22:23] op_sel:[0,1] op_sel_hi:[1,0] neg_lo:[0,1]
    v_pk_add_f32 v[38:39], v[20:21], v[22:23] op_sel:[0,1] op_sel_hi:[1,0] neg_hi:[1,0]
    v_cvt_pk_f16_f32 v178, v36, v37
    v_cvt_pk_f16_f32 v179, v38, v39
    ds_write_b32 v10, v178 offset:256
    ds_write_b32 v11, v179 offset:256
    v_pk_add_f32 v[24:25], v[136:137], v[152:153] op_sel:[0,1] op_sel_hi:[1,0] neg_hi:[0,1]
    v_pk_add_f32 v[26:27], v[138:139], v[154:155] op_sel:[0,1] op_sel_hi:[1,0] neg_hi:[0,1]
    v_pk_add_f32 v[40:41], v[24:25], v[26:27] op_sel:[0,1] op_sel_hi:[1,0] neg_lo:[0,1]
    v_pk_add_f32 v[42:43], v[24:25], v[26:27] op_sel:[0,1] op_sel_hi:[1,0] neg_hi:[1,0]
    v_cvt_pk_f16_f32 v180, v40, v41
    v_cvt_pk_f16_f32 v181, v42, v43
    ds_write_b32 v10, v180 offset:512
    ds_write_b32 v11, v181 offset:512
    v_pk_add_f32 v[28:29], v[140:141], v[156:157] op_sel:[0,1] op_sel_hi:[1,0] neg_hi:[0,1]
    v_pk_add_f32 v[30:31], v[142:143], v[158:159] op_sel:[0,1] op_sel_hi:[1,0] neg_hi:[0,1]
    v_pk_add_f32 v[44:45], v[28:29], v[30:31] op_sel:[0,1] op_sel_hi:[1,0] neg_lo:[0,1]
    v_pk_add_f32 v[46:47], v[28:29], v[30:31] op_sel:[0,1] op_sel_hi:[1,0] neg_hi:[1,0]
    v_cvt_pk_f16_f32 v182, v44, v45
    v_cvt_pk_f16_f32 v183, v46, v47
    ds_write_b32 v10, v182 offset:768
    ds_write_b32 v11, v183 offset:768
    v_pk_add_f32 v[16:17], v[128:129], v[144:145] op_sel:[0,1] op_sel_hi:[1,0] neg_hi:[0,1]
    v_pk_add_f32 v[18:19], v[130:131], v[146:147] op_sel:[0,1] op_sel_hi:[1,0] neg_hi:[0,1]
    v_mul_f32 v8, s39, v128
    v_mov_b32 v3, v161
    s_nop 1
    v_permlane16_swap_b32 v4, v3
    v_cndmask_b32 v5, v161, v128, vcc
    v_cndmask_b32 v4, v4, v144, vcc
    v_cndmask_b32 v16, v16, v5, s[40:41]
    v_cndmask_b32 v17, v17, -v4, s[40:41]
    v_pk_add_f32 v[32:33], v[16:17], v[18:19] op_sel:[0,1] op_sel_hi:[1,0] neg_lo:[0,1]
    v_pk_add_f32 v[34:35], v[16:17], v[18:19] op_sel:[0,1] op_sel_hi:[1,0] neg_hi:[1,0]
    v_cvt_pk_f16_f32 v176, v32, v33
    v_cvt_pk_f16_f32 v177, v34, v35
    ds_write_b32 v10, v176 offset:0
    ds_write_b32 v11, v177 offset:0
    s_mov_b64 exec, 0x10000
    ds_write_b32 v9, v8
    ds_write_b32 v201, v202
    s_mov_b64 exec, -1
    s_cmp_eq_u32 s16, 4
    s_cbranch_scc1 fk_w4
    s_nop 0
fk_spin:
    ds_read_b32 v3, v205
    s_waitcnt lgkmcnt(0)
    v_cmp_eq_u32 vcc, 0, v3
    s_nop 1
    s_and_b32 s13, vcc_lo, s57
    s_cbranch_scc1 fk_spin
    s_nop 0
fk_staged:
    ds_read2st64_b32 v[184:185], v6 offset0:0 offset1:4
    ds_read2st64_b32 v[186:187], v6 offset0:8 offset1:12
    v_add_u32 v8, 16, v6
    ds_read2st64_b32 v[188:189], v8 offset0:0 offset1:4
    ds_read2st64_b32 v[190:191], v8 offset0:8 offset1:12
    v_readlane_b32 s43, v3, 7
    s_waitcnt lgkmcnt(2)
    v_or_b32 v184, 1, v184
    v_or_b32 v185, 1, v185
    v_or_b32 v186, 1, v186
    v_or_b32 v187, 1, v187
    buffer_store_dwordx4 v[184:187], v194, s[24:27], s36 offen offset:0 sc1
    s_waitcnt lgkmcnt(0)
    v_or_b32 v188, 1, v188
    v_or_b32 v189, 1, v189
    v_or_b32 v190, 1, v190
    v_or_b32 v191, 1, v191
    buffer_store_dwordx4 v[188:191], v194, s[24:27], s36 offen offset:128 sc1
    v_add3_u32 v3, v184, v185, v186
    v_add_u32 v3, v3, v187
    v_add3_u32 v4, v188, v189, v190
    v_add_u32 v4, v4, v191
    s_add_u32 s36, s36, 8192
    v_add_u32_dpp v3, v3, v3 quad_perm:[1,0,3,2] row_mask:0xf bank_mask:0xf
    v_add_u32_dpp v4, v4, v4 quad_perm:[1,0,3,2] row_mask:0xf bank_mask:0xf
    v_cndmask_b32 v3, v3, v4, s[58:59]
    v_add_u32 v196, s43, v3
    s_nop 1
    v_mov_b32_dpp v197, v196 row_shl:2 row_mask:0xf bank_mask:0xf
    v_mov_b32_dpp v198, v196 row_shl:4 row_mask:0xf bank_mask:0xf
    v_mov_b32_dpp v199, v196 row_shl:6 row_mask:0xf bank_mask:0xf
    s_mov_b32 exec_lo, 0x03030303
    s_mov_b32 exec_hi, 0x03030303
    buffer_store_dwordx4 v[196:199], v193, s[24:27], s36 offen sc1
    s_mov_b64 exec, -1
    s_cmp_lg_u32 s16, 0
    s_cbranch_scc1 fk_nog5
    v_and_b32 v9, 16, v14
    v_add_u32 v9, 157056, v9
    ds_read_b128 v[16:19], v9
    s_lshl_b32 s13, s3, 4
    s_add_u32 s13, s13, 0x11000
    s_nop 1
fk_g5s:
    ds_read_b32 v3, v205
    s_waitcnt lgkmcnt(0)
    v_cmp_eq_u32 vcc, 0, v3
    s_nop 1
    s_and_b32 s14, vcc_lo, 64
    s_cbranch_scc1 fk_g5s
    v_min_u32 v16, -2, v16
    v_min_u32 v17, -2, v17
    v_min_u32 v18, -2, v18
    v_min_u32 v19, -2, v19
    s_mov_b64 exec, 1
    buffer_store_dwordx4 v[16:19], v14, s[24:27], s13 offen sc1
    s_mov_b64 exec, -1
    s_nop 1
fk_nog5:
    v_lshrrev_b32 v208, 3, v15
    v_and_b32 v209, 7, v15
    v_and_b32 v210, 2, v208
    v_xor_b32 v209, v210, v209
    v_mul_u32_u24 v208, 7168, v208
    v_lshl_add_u32 v208, v209, 4, v208
    v_lshrrev_b32 v210, 5, v15
    v_lshlrev_b32 v210, 11, v210
    v_and_b32 v209, 31, v15
    v_lshl_add_u32 v210, v209, 4, v210
    s_and_b32 s12, s3, 3
    s_mul_i32 s100, s12, 1835008
    s_lshl_b32 s101, s12, 9
    s_lshr_b32 s12, s3, 2
    s_lshl_b32 s12, s12, 7
    s_add_u32 s100, s100, s12
    s_lshl_b32 s12, s12, 10
    s_add_u32 s101, s101, s12
    s_xor_b32 s99, s100, 0
    s_mov_b64 s[4:5], s[58:59]
    s_cmp_gt_u32 s3, 223
    s_cbranch_scc1 fk_win1
    s_mul_i32 s15, s16, 3
    s_add_u32 s15, s15, 12
    s_mov_b32 s58, 0x700000
    s_mov_b32 s59, 0x00020000
    s_cmp_gt_u32 s15, 95
    s_cbranch_scc1 fk_win1
    s_lshl_b32 s12, s15, 10
    s_mov_b32 m0, s12
    s_and_b32 s14, s12, 1024
    s_lshr_b32 s14, s14, 4
    v_xor_b32 v209, s14, v208
    s_cmp_lt_u32 s15, 32
    s_cselect_b64 s[56:57], s[44:45], s[48:49]
    s_cselect_b32 s12, s100, s99
    s_and_b32 s14, s15, 31
    s_mul_i32 s13, s14, 57344
    s_add_u32 s13, s13, s12
    s_lshl_b32 s14, s14, 12
    s_add_u32 s14, s14, s101
    s_cmp_lt_u32 s15, 64
    s_cselect_b64 s[56:57], s[56:57], s[52:53]
    s_cselect_b32 s13, s13, s14
    s_cselect_b64 vcc, -1, 0
    v_cndmask_b32 v209, v210, v209, vcc
    s_add_u32 s15, s15, 1
    buffer_load_dwordx4 v209, s[56:59], s13 offen lds
    s_cmp_gt_u32 s15, 95
    s_cbranch_scc1 fk_win1
    s_lshl_b32 s12, s15, 10
    s_mov_b32 m0, s12
    s_and_b32 s14, s12, 1024
    s_lshr_b32 s14, s14, 4
    v_xor_b32 v209, s14, v208
    s_cmp_lt_u32 s15, 32
    s_cselect_b64 s[56:57], s[44:45], s[48:49]
    s_cselect_b32 s12, s100, s99
    s_and_b32 s14, s15, 31
    s_mul_i32 s13, s14, 57344
    s_add_u32 s13, s13, s12
    s_lshl_b32 s14, s14, 12
    s_add_u32 s14, s14, s101
    s_cmp_lt_u32 s15, 64
    s_cselect_b64 s[56:57], s[56:57], s[52:53]
    s_cselect_b32 s13, s13, s14
    s_cselect_b64 vcc, -1, 0
    v_cndmask_b32 v209, v210, v209, vcc
    s_add_u32 s15, s15, 1
    buffer_load_dwordx4 v209, s[56:59], s13 offen lds
    s_cmp_gt_u32 s15, 95
    s_cbranch_scc1 fk_win1
    s_lshl_b32 s12, s15, 10
    s_mov_b32 m0, s12
    s_and_b32 s14, s12, 1024
    s_lshr_b32 s14, s14, 4
    v_xor_b32 v209, s14, v208
    s_cmp_lt_u32 s15, 32
    s_cselect_b64 s[56:57], s[44:45], s[48:49]
    s_cselect_b32 s12, s100, s99
    s_and_b32 s14, s15, 31
    s_mul_i32 s13, s14, 57344
    s_add_u32 s13, s13, s12
    s_lshl_b32 s14, s14, 12
    s_add_u32 s14, s14, s101
    s_cmp_lt_u32 s15, 64
    s_cselect_b64 s[56:57], s[56:57], s[52:53]
    s_cselect_b32 s13, s13, s14
    s_cselect_b64 vcc, -1, 0
    v_cndmask_b32 v209, v210, v209, vcc
    s_add_u32 s15, s15, 1
    buffer_load_dwordx4 v209, s[56:59], s13 offen lds
    s_nop 2
fk_win1:
    s_mov_b32 s42, 0
    s_waitcnt vmcnt(0)
    s_nop 0
fk_pollw:
    buffer_load_dwordx4 v[184:187], v12, s[24:27], s37 offen sc1
    buffer_load_dwordx4 v[188:191], v12, s[24:27], s38 offen sc1
    buffer_load_dword v5, v192, s[24:27], s23 offen sc1
    s_waitcnt vmcnt(1)
    v_add3_u32 v3, v184, v185, v186
    v_add_u32 v3, v3, v187
    v_add3_u32 v4, v188, v189, v190
    v_add_u32 v4, v4, v191
    ds_write_b128 v7, v[184:187]
    v_add_u32_dpp v3, v3, v3 quad_perm:[1,0,3,2] row_mask:0xf bank_mask:0xf
    v_add_u32_dpp v4, v4, v4 quad_perm:[1,0,3,2] row_mask:0xf bank_mask:0xf
    ds_write_b128 v7, v[188:191] offset:1024
    v_cndmask_b32 v3, v3, v4, s[4:5]
    v_add_u32 v3, s43, v3
    s_waitcnt vmcnt(0)
    v_cmp_ne_u32 vcc, v3, v5
    s_add_u32 s42, s42, 1
    s_cbranch_vccz fk_gotw
    s_cmp_le_u32 s42, 0x40000
    s_cbranch_scc1 fk_pollw
    s_nop 0
fk_gotw:
    s_waitcnt lgkmcnt(0)
    s_barrier
    s_setprio 0
    s_or_b32 s13, s3, s16
    s_cbranch_scc1 fk_nobump
    v_mov_b32 v3, s43
    s_mov_b64 exec, 1
    buffer_store_dword v3, v14, s[24:27], 0 offen sc1
    s_mov_b64 exec, -1
    s_nop 1
fk_nobump:
    s_lshl_b32 s13, s16, 10
    s_add_u32 s14, s13, 0x11000
    s_add_u32 s13, s13, 114688
    v_add_u32 v7, s13, v14
    v_mov_b32 v3, 4096
    s_mov_b32 s15, 0x11000
    v_mov_b32 v8, 157152
    buffer_load_dwordx4 v[184:187], v14, s[24:27], s14 offen sc1
    buffer_load_dword v188, v3, s[24:27], s15 offen sc1
    s_mov_b32 s40, s14
    s_mov_b32 s41, s15
    s_cmp_gt_u32 s3, 223
    s_cbranch_scc1 fk_win2
    s_mul_i32 s15, s16, 4
    s_add_u32 s15, s15, 24
    s_cmp_ge_u32 s15, 32
    s_cselect_b32 s12, 32, 0
    s_add_u32 s15, s15, s12
    s_mov_b32 s58, 0x700000
    s_mov_b32 s59, 0x00020000
    s_cmp_gt_u32 s15, 95
    s_cbranch_scc1 fk_win2
    s_lshl_b32 s12, s15, 10
    s_mov_b32 m0, s12
    s_and_b32 s14, s12, 1024
    s_lshr_b32 s14, s14, 4
    v_xor_b32 v209, s14, v208
    s_cmp_lt_u32 s15, 32
    s_cselect_b64 s[56:57], s[44:45], s[48:49]
    s_cselect_b32 s12, s100, s99
    s_and_b32 s14, s15, 31
    s_mul_i32 s13, s14, 57344
    s_add_u32 s13, s13, s12
    s_lshl_b32 s14, s14, 12
    s_add_u32 s14, s14, s101
    s_cmp_lt_u32 s15, 64
    s_cselect_b64 s[56:57], s[56:57], s[52:53]
    s_cselect_b32 s13, s13, s14
    s_cselect_b64 vcc, -1, 0
    v_cndmask_b32 v209, v210, v209, vcc
    s_add_u32 s15, s15, 1
    buffer_load_dwordx4 v209, s[56:59], s13 offen lds
    s_cmp_gt_u32 s15, 95
    s_cbranch_scc1 fk_win2
    s_lshl_b32 s12, s15, 10
    s_mov_b32 m0, s12
    s_and_b32 s14, s12, 1024
    s_lshr_b32 s14, s14, 4
    v_xor_b32 v209, s14, v208
    s_cmp_lt_u32 s15, 32
    s_cselect_b64 s[56:57], s[44:45], s[48:49]
    s_cselect_b32 s12, s100, s99
    s_and_b32 s14, s15, 31
    s_mul_i32 s13, s14, 57344
    s_add_u32 s13, s13, s12
    s_lshl_b32 s14, s14, 12
    s_add_u32 s14, s14, s101
    s_cmp_lt_u32 s15, 64
    s_cselect_b64 s[56:57], s[56:57], s[52:53]
    s_cselect_b32 s13, s13, s14
    s_cselect_b64 vcc, -1, 0
    v_cndmask_b32 v209, v210, v209, vcc
    s_add_u32 s15, s15, 1
    buffer_load_dwordx4 v209, s[56:59], s13 offen lds
    s_cmp_gt_u32 s15, 95
    s_cbranch_scc1 fk_win2
    s_lshl_b32 s12, s15, 10
    s_mov_b32 m0, s12
    s_and_b32 s14, s12, 1024
    s_lshr_b32 s14, s14, 4
    v_xor_b32 v209, s14, v208
    s_cmp_lt_u32 s15, 32
    s_cselect_b64 s[56:57], s[44:45], s[48:49]
    s_cselect_b32 s12, s100, s99
    s_and_b32 s14, s15, 31
    s_mul_i32 s13, s14, 57344
    s_add_u32 s13, s13, s12
    s_lshl_b32 s14, s14, 12
    s_add_u32 s14, s14, s101
    s_cmp_lt_u32 s15, 64
    s_cselect_b64 s[56:57], s[56:57], s[52:53]
    s_cselect_b32 s13, s13, s14
    s_cselect_b64 vcc, -1, 0
    v_cndmask_b32 v209, v210, v209, vcc
    s_add_u32 s15, s15, 1
    buffer_load_dwordx4 v209, s[56:59], s13 offen lds
    s_cmp_gt_u32 s15, 95
    s_cbranch_scc1 fk_win2
    s_lshl_b32 s12, s15, 10
    s_mov_b32 m0, s12
    s_and_b32 s14, s12, 1024
    s_lshr_b32 s14, s14, 4
    v_xor_b32 v209, s14, v208
    s_cmp_lt_u32 s15, 32
    s_cselect_b64 s[56:57], s[44:45], s[48:49]
    s_cselect_b32 s12, s100, s99
    s_and_b32 s14, s15, 31
    s_mul_i32 s13, s14, 57344
    s_add_u32 s13, s13, s12
    s_lshl_b32 s14, s14, 12
    s_add_u32 s14, s14, s101
    s_cmp_lt_u32 s15, 64
    s_cselect_b64 s[56:57], s[56:57], s[52:53]
    s_cselect_b32 s13, s13, s14
    s_cselect_b64 vcc, -1, 0
    v_cndmask_b32 v209, v210, v209, vcc
    s_add_u32 s15, s15, 1
    buffer_load_dwordx4 v209, s[56:59], s13 offen lds
    s_nop 2
fk_win2:
    s_mov_b32 s42, 0
    s_cmp_gt_u32 s3, 223
    s_cbranch_scc1 fk_pollg
    s_waitcnt vmcnt(4)
    s_branch fk_chkg
    s_nop 0
fk_pollg:
    buffer_load_dwordx4 v[184:187], v14, s[24:27], s40 offen sc1
    buffer_load_dword v188, v3, s[24:27], s41 offen sc1
    s_waitcnt vmcnt(0)
    s_nop 0
fk_chkg:
    s_add_u32 s42, s42, 1
    v_max3_u32 v4, v184, v185, v186
    v_max3_u32 v4, v4, v187, v188
    v_cmp_eq_u32 vcc, -1, v4
    s_cbranch_vccz fk_gotg
    s_cmp_le_u32 s42, 0x40000
    s_cbranch_scc1 fk_pollg
    s_nop 1
fk_gotg:
    ds_write_b128 v7, v[184:187]
    ds_write_b32 v8, v188
    s_branch fk_common
    s_nop 0
fk_w4:
    v_min_u32 v184, -2, v176
    v_min_u32 v185, -2, v178
    v_min_u32 v186, -2, v180
    v_min_u32 v187, -2, v182
    v_min_u32 v8, -2, v8
    v_mov_b32 v4, 4096
    s_mov_b32 s14, 0x13000
    s_mov_b32 s15, 0x11000
    s_nop 2
fk_w4s:
    ds_read_b32 v3, v205
    s_waitcnt lgkmcnt(0)
    v_cmp_eq_u32 vcc, 0, v3
    s_nop 1
    s_and_b32 s13, vcc_lo, 32
    s_cbranch_scc1 fk_w4s
    buffer_store_dwordx4 v[184:187], v14, s[24:27], s14 offen sc1
    s_mov_b64 exec, 0x10000
    buffer_store_dword v8, v4, s[24:27], s15 offen sc1
    s_mov_b64 exec, -1
    s_branch fk_Hconst
    s_nop 0
fk_H:
    s_barrier
    s_cmp_lg_u32 s16, 7
    s_cbranch_scc1 fk_Hconst
    v_mov_b32 v4, -1
    v_mov_b32 v5, -1
    v_mov_b32 v6, -1
    v_mov_b32 v7, -1
    v_mov_b32 v3, 157120
    v_mov_b32 v8, 0
    ds_write_b32 v3, v8
    v_lshlrev_b32 v3, 12, v15
    s_lshl_b32 s13, s3, 4
    s_add_u32 s14, s13, 0x9000
    s_add_u32 s15, s13, 0x11000
    v_mov_b32 v201, 157844
    v_mov_b32 v204, 1
    s_waitcnt lgkmcnt(0)
    s_load_dword s56, s[24:25], 0
    s_mov_b64 exec, 0xff
    buffer_store_dwordx4 v[4:7], v3, s[24:27], s14 offen sc1
    s_cmp_eq_u32 s3, 255
    s_cselect_b32 exec_lo, 3, 1
    buffer_store_dwordx4 v[4:7], v14, s[24:27], s15 offen sc1
    s_mov_b64 exec, -1
    s_mov_b32 m0, 155008
    s_mov_b32 s12, 0
    buffer_load_dwordx4 v14, s[32:35], s12 offen lds
    s_mov_b32 m0, 156032
    s_mov_b32 s12, 1024
    buffer_load_dwordx4 v14, s[32:35], s12 offen lds
    s_cmp_eq_u32 s3, 255
    s_cselect_b32 s12, 0x13000, s26
    buffer_store_dwordx4 v[4:7], v14, s[24:27], s12 offen sc1
    s_cmp_lg_u32 s3, 248
    s_cbranch_scc1 fk_no1024
    s_mov_b32 m0, 118784
    s_mov_b32 s14, 2097152
    buffer_load_dwordx4 v14, s[8:11], s14 offen lds
    s_mov_b32 m0, 119808
    s_mov_b32 s14, 2098176
    buffer_load_dwordx4 v14, s[8:11], s14 offen lds
fk_no1024:
    s_mul_i32 s38, s3, 8320
    s_add_u32 s38, s38, 0x268000
    s_add_u32 s39, s38, 4096
    s_waitcnt vmcnt(0) lgkmcnt(0)
    s_add_u32 s57, s56, 1
    v_mov_b32 v202, s57
    ds_write_b32 v201, v202 offset:8
    ds_write_b32 v201, v204
    buffer_store_dwordx4 v[4:7], v14, s[24:27], s38 offen offset:0 sc1
    buffer_store_dwordx4 v[4:7], v14, s[24:27], s38 offen offset:1024 sc1
    buffer_store_dwordx4 v[4:7], v14, s[24:27], s38 offen offset:2048 sc1
    buffer_store_dwordx4 v[4:7], v14, s[24:27], s38 offen offset:3072 sc1
    buffer_store_dwordx4 v[4:7], v14, s[24:27], s39 offen offset:0 sc1
    buffer_store_dwordx4 v[4:7], v14, s[24:27], s39 offen offset:1024 sc1
    buffer_store_dwordx4 v[4:7], v14, s[24:27], s39 offen offset:2048 sc1
    buffer_store_dwordx4 v[4:7], v14, s[24:27], s39 offen offset:3072 sc1
    s_waitcnt lgkmcnt(0)
    s_add_u32 s56, s56, 1
    v_mov_b32 v202, s56
    ds_write_b32 v201, v202 offset:8
    s_waitcnt vmcnt(8)
    ds_write_b32 v201, v204
    s_waitcnt vmcnt(0)
    ds_write_b32 v201, v204 offset:4
fk_Hconst:
    s_sub_u32 s20, s16, 4
    v_lshrrev_b32 v208, 3, v15
    v_and_b32 v209, 7, v15
    v_and_b32 v210, 2, v208
    v_xor_b32 v209, v210, v209
    v_mul_u32_u24 v208, 7168, v208
    v_lshl_add_u32 v208, v209, 4, v208
    v_lshrrev_b32 v210, 5, v15
    v_lshlrev_b32 v210, 11, v210
    v_and_b32 v209, 31, v15
    v_lshl_add_u32 v210, v209, 4, v210
    s_and_b32 s12, s3, 3
    s_mul_i32 s100, s12, 1835008
    s_lshl_b32 s101, s12, 9
    s_lshr_b32 s12, s3, 2
    s_lshl_b32 s12, s12, 7
    s_add_u32 s100, s100, s12
    s_lshl_b32 s12, s12, 10
    s_add_u32 s101, s101, s12
    s_xor_b32 s99, s100, 0
    s_and_b32 s12, s20, 1
    s_lshl_b32 s12, s12, 6
    v_xor_b32 v206, s12, v208
    v_xor_b32 v207, 64, v206
    s_mov_b32 s6, 0x700000
    s_mov_b32 s7, 0x00020000
    s_cmp_gt_u32 s3, 223
    s_cselect_b32 s36, 3, s20
    s_waitcnt lgkmcnt(0)
    v_lshrrev_b32 v4, 1, v1
    v_and_b32 v5, 1, v4
    v_lshrrev_b32 v6, 2, v4
    v_lshl_add_u32 v5, v6, 1, v5
    v_and_b32 v6, 2, v4
    v_lshl_add_u32 v5, v6, 2, v5
    s_and_b32 s13, s20, 1
    s_mul_i32 s13, s13, 15
    v_xor_b32 v5, s13, v5
    s_lshl_b32 s13, s20, 4
    v_add_u32 v5, s13, v5
    v_cvt_f32_u32 v5, v5
    v_and_b32 v9, 1, v1
    v_lshlrev_b32 v7, 2, v2
    v_cvt_f32_u32 v7, v7
    v_cvt_f32_u32 v10, v9
    v_mul_f32 v8, 0x3c800000, v5
    v_mul_f32 v10, 0x3e800000, v10
    v_fma_f32 v10, v8, v7, v10
    v_mov_b32 v128, v10
    v_fmamk_f32 v129, v8, 0x3f800000, v10
    v_fmamk_f32 v130, v8, 0x40000000, v10
    v_fmamk_f32 v131, v8, 0x40400000, v10
    v_fmamk_f32 v132, v8, 0x41000000, v10
    v_fmamk_f32 v133, v8, 0x41100000, v10
    v_fmamk_f32 v134, v8, 0x41200000, v10
    v_fmamk_f32 v135, v8, 0x41300000, v10
    v_fmamk_f32 v136, v8, 0x41800000, v10
    v_fmamk_f32 v137, v8, 0x41880000, v10
    v_fmamk_f32 v138, v8, 0x41900000, v10
    v_fmamk_f32 v139, v8, 0x41980000, v10
    v_fmamk_f32 v140, v8, 0x41c00000, v10
    v_fmamk_f32 v141, v8, 0x41c80000, v10
    v_fmamk_f32 v142, v8, 0x41d00000, v10
    v_fmamk_f32 v143, v8, 0x41d80000, v10
    v_cos_f32 v144, v128
    v_cos_f32 v145, v129
    v_cos_f32 v146, v130
    v_cos_f32 v147, v131
    v_cos_f32 v148, v132
    v_cos_f32 v149, v133
    v_cos_f32 v150, v134
    v_cos_f32 v151, v135
    v_cos_f32 v152, v136
    v_cos_f32 v153, v137
    v_cos_f32 v154, v138
    v_cos_f32 v155, v139
    v_cos_f32 v156, v140
    v_cos_f32 v157, v141
    v_cos_f32 v158, v142
    v_cos_f32 v159, v143
    v_sin_f32 v160, v128
    v_sin_f32 v161, v129
    v_sin_f32 v162, v130
    v_sin_f32 v163, v131
    v_sin_f32 v164, v132
    v_sin_f32 v165, v133
    v_sin_f32 v166, v134
    v_sin_f32 v167, v135
    v_sin_f32 v168, v136
    v_sin_f32 v169, v137
    v_sin_f32 v170, v138
    v_sin_f32 v171, v139
    v_sin_f32 v172, v140
    v_sin_f32 v173, v141
    v_sin_f32 v174, v142
    v_sin_f32 v175, v143
    v_cvt_pk_f16_f32 v48, v144, v160
    v_cvt_pk_f16_f32 v49, v145, v161
    v_cvt_pk_f16_f32 v50, v146, v162
    v_cvt_pk_f16_f32 v51, v147, v163
    v_cvt_pk_f16_f32 v52, v148, v164
    v_cvt_pk_f16_f32 v53, v149, v165
    v_cvt_pk_f16_f32 v54, v150, v166
    v_cvt_pk_f16_f32 v55, v151, v167
    v_cvt_pk_f16_f32 v56, v152, v168
    v_cvt_pk_f16_f32 v57, v153, v169
    v_cvt_pk_f16_f32 v58, v154, v170
    v_cvt_pk_f16_f32 v59, v155, v171
    v_cvt_pk_f16_f32 v60, v156, v172
    v_cvt_pk_f16_f32 v61, v157, v173
    v_cvt_pk_f16_f32 v62, v158, v174
    s_cmp_eq_u32 s36, 3
    s_cbranch_scc1 fk_gu0
    s_add_u32 s37, s20, 0
    s_lshl_b32 s12, s37, 10
    s_mov_b32 m0, s12
    s_cmp_lt_u32 s37, 32
    s_cselect_b64 s[4:5], s[44:45], s[48:49]
    s_and_b32 s37, s37, 31
    s_mul_i32 s37, s37, 57344
    s_add_u32 s37, s37, s100
    buffer_load_dwordx4 v206, s[4:7], s37 offen lds
fk_gu0:
    s_cmp_eq_u32 s36, 3
    s_cbranch_scc1 fk_gu1
    s_add_u32 s37, s20, 3
    s_lshl_b32 s12, s37, 10
    s_mov_b32 m0, s12
    s_cmp_lt_u32 s37, 32
    s_cselect_b64 s[4:5], s[44:45], s[48:49]
    s_and_b32 s37, s37, 31
    s_mul_i32 s37, s37, 57344
    s_add_u32 s37, s37, s100
    buffer_load_dwordx4 v207, s[4:7], s37 offen lds
fk_gu1:
    s_cmp_eq_u32 s36, 3
    s_cbranch_scc1 fk_gu2
    s_add_u32 s37, s20, 6
    s_lshl_b32 s12, s37, 10
    s_mov_b32 m0, s12
    s_cmp_lt_u32 s37, 32
    s_cselect_b64 s[4:5], s[44:45], s[48:49]
    s_and_b32 s37, s37, 31
    s_mul_i32 s37, s37, 57344
    s_add_u32 s37, s37, s100
    buffer_load_dwordx4 v206, s[4:7], s37 offen lds
fk_gu2:
    s_cmp_eq_u32 s36, 3
    s_cbranch_scc1 fk_gu3
    s_add_u32 s37, s20, 9
    s_lshl_b32 s12, s37, 10
    s_mov_b32 m0, s12
    s_cmp_lt_u32 s37, 32
    s_cselect_b64 s[4:5], s[44:45], s[48:49]
    s_and_b32 s37, s37, 31
    s_mul_i32 s37, s37, 57344
    s_add_u32 s37, s37, s100
    buffer_load_dwordx4 v207, s[4:7], s37 offen lds
fk_gu3:
    v_cvt_pk_f16_f32 v63, v159, v175
    v_fmamk_f32 v128, v8, 0x42000000, v10
    v_fmamk_f32 v129, v8, 0x42040000, v10
    v_fmamk_f32 v130, v8, 0x42080000, v10
    v_fmamk_f32 v131, v8, 0x420c0000, v10
    v_fmamk_f32 v132, v8, 0x42200000, v10
    v_fmamk_f32 v133, v8, 0x42240000, v10
    v_fmamk_f32 v134, v8, 0x42280000, v10
    v_fmamk_f32 v135, v8, 0x422c0000, v10
    v_fmamk_f32 v136, v8, 0x42400000, v10
    v_fmamk_f32 v137, v8, 0x42440000, v10
    v_fmamk_f32 v138, v8, 0x42480000, v10
    v_fmamk_f32 v139, v8, 0x424c0000, v10
    v_fmamk_f32 v140, v8, 0x42600000, v10
    v_fmamk_f32 v141, v8, 0x42640000, v10
    v_fmamk_f32 v142, v8, 0x42680000, v10
    v_fmamk_f32 v143, v8, 0x426c0000, v10
    v_cos_f32 v144, v128
    v_cos_f32 v145, v129
    v_cos_f32 v146, v130
    v_cos_f32 v147, v131
    v_cos_f32 v148, v132
    v_cos_f32 v149, v133
    v_cos_f32 v150, v134
    v_cos_f32 v151, v135
    v_cos_f32 v152, v136
    v_cos_f32 v153, v137
    v_cos_f32 v154, v138
    v_cos_f32 v155, v139
    v_cos_f32 v156, v140
    v_cos_f32 v157, v141
    v_cos_f32 v158, v142
    v_cos_f32 v159, v143
    v_sin_f32 v160, v128
    v_sin_f32 v161, v129
    v_sin_f32 v162, v130
    v_sin_f32 v163, v131
    v_sin_f32 v164, v132
    v_sin_f32 v165, v133
    v_sin_f32 v166, v134
    v_sin_f32 v167, v135
    v_sin_f32 v168, v136
    v_sin_f32 v169, v137
    v_sin_f32 v170, v138
    v_sin_f32 v171, v139
    v_sin_f32 v172, v140
    v_sin_f32 v173, v141
    v_sin_f32 v174, v142
    v_sin_f32 v175, v143
    v_cvt_pk_f16_f32 v64, v144, v160
    v_cvt_pk_f16_f32 v65, v145, v161
    v_cvt_pk_f16_f32 v66, v146, v162
    v_cvt_pk_f16_f32 v67, v147, v163
    v_cvt_pk_f16_f32 v68, v148, v164
    v_cvt_pk_f16_f32 v69, v149, v165
    v_cvt_pk_f16_f32 v70, v150, v166
    v_cvt_pk_f16_f32 v71, v151, v167
    v_cvt_pk_f16_f32 v72, v152, v168
    v_cvt_pk_f16_f32 v73, v153, v169
    v_cvt_pk_f16_f32 v74, v154, v170
    v_cvt_pk_f16_f32 v75, v155, v171
    v_cvt_pk_f16_f32 v76, v156, v172
    v_cvt_pk_f16_f32 v77, v157, v173
    v_cvt_pk_f16_f32 v78, v158, v174
    v_cvt_pk_f16_f32 v79, v159, v175
    v_lshlrev_b32 v11, 31, v9
    v_mul_f32 v10, 0x3a000000, v5
    v_xor_b32 v10, v11, v10
    v_mul_f32 v11, v10, v7
    v_mov_b32 v128, v11
    v_fmamk_f32 v129, v10, 0x3f800000, v11
    v_fmamk_f32 v130, v10, 0x40000000, v11
    v_fmamk_f32 v131, v10, 0x40400000, v11
    v_fmamk_f32 v132, v10, 0x41000000, v11
    v_fmamk_f32 v133, v10, 0x41100000, v11
    v_fmamk_f32 v134, v10, 0x41200000, v11
    v_fmamk_f32 v135, v10, 0x41300000, v11
    v_fmamk_f32 v136, v10, 0x41800000, v11
    v_fmamk_f32 v137, v10, 0x41880000, v11
    v_fmamk_f32 v138, v10, 0x41900000, v11
    v_fmamk_f32 v139, v10, 0x41980000, v11
    v_fmamk_f32 v140, v10, 0x41c00000, v11
    v_fmamk_f32 v141, v10, 0x41c80000, v11
    v_fmamk_f32 v142, v10, 0x41d00000, v11
    v_fmamk_f32 v143, v10, 0x41d80000, v11
    v_cos_f32 v80, v128
    v_cos_f32 v81, v129
    v_cos_f32 v82, v130
    v_cos_f32 v83, v131
    v_cos_f32 v84, v132
    v_cos_f32 v85, v133
    v_cos_f32 v86, v134
    v_cos_f32 v87, v135
    v_cos_f32 v88, v136
    v_cos_f32 v89, v137
    v_cos_f32 v90, v138
    v_cos_f32 v91, v139
    v_cos_f32 v92, v140
    v_cos_f32 v93, v141
    v_cos_f32 v94, v142
    v_cos_f32 v95, v143
    v_sin_f32 v96, v128
    v_sin_f32 v97, v129
    v_sin_f32 v98, v130
    v_sin_f32 v99, v131
    v_sin_f32 v100, v132
    v_sin_f32 v101, v133
    v_sin_f32 v102, v134
    v_sin_f32 v103, v135
    v_sin_f32 v104, v136
    v_sin_f32 v105, v137
    v_sin_f32 v106, v138
    v_sin_f32 v107, v139
    v_sin_f32 v108, v140
    v_sin_f32 v109, v141
    v_sin_f32 v110, v142
    v_sin_f32 v111, v143
    v_sub_u32 v4, 31, v1
    v_subrev_u32 v5, 1, v1
    v_cmp_lt_u32 vcc, 16, v1
    s_nop 1
    v_cndmask_b32 v4, v5, v4, vcc
    v_and_b32 v4, 15, v4
    v_lshlrev_b32 v4, 5, v4
    v_add_u32 v4, 130304, v4
    v_lshlrev_b32 v5, 9, v2
    v_add_u32 v6, v4, v5
    v_sub_u32 v7, v4, v5
    v_add_u32 v7, 7696, v7
    v_cmp_eq_u32 s[38:39], 0, v1
    v_mov_b32 v8, 4096
    s_nop 0
    v_cndmask_b32 v8, 0, v8, s[38:39]
    v_add_u32 v6, v6, v8
    v_add_u32 v7, v7, v8
    v_and_b32 v8, 15, v1
    v_cmp_eq_u32 s[38:39], 0, v8
    s_nop 1
    s_or_b64 s[40:41], s[38:39], vcc
    v_add_u32 v184, 0, v6
    v_subrev_u32 v8, 0, v7
    v_cndmask_b32 v184, v184, v8, vcc
    v_add_u32 v185, 1024, v6
    v_subrev_u32 v8, 1024, v7
    v_cndmask_b32 v185, v185, v8, vcc
    v_add_u32 v186, 2048, v6
    v_subrev_u32 v8, 2048, v7
    v_cndmask_b32 v186, v186, v8, vcc
    v_add_u32 v187, 3072, v6
    v_subrev_u32 v8, 3072, v7
    v_cndmask_b32 v187, v187, v8, vcc
    v_add_u32 v188, 4096, v6
    v_subrev_u32 v8, 4096, v7
    v_cndmask_b32 v188, v188, v8, s[40:41]
    v_add_u32 v189, 5120, v6
    v_subrev_u32 v8, 5120, v7
    v_cndmask_b32 v189, v189, v8, s[40:41]
    v_add_u32 v190, 6144, v6
    v_subrev_u32 v8, 6144, v7
    v_cndmask_b32 v190, v190, v8, s[40:41]
    v_add_u32 v191, 7168, v6
    v_subrev_u32 v8, 7168, v7
    v_cndmask_b32 v191, v191, v8, s[40:41]
    v_add_u32 v212, 512, v188
    v_add_u32 v213, 512, v189
    v_add_u32 v214, 512, v190
    v_add_u32 v215, 512, v191
    v_subrev_u32 v8, 4096, v212
    v_cmp_eq_u32 vcc, 0, v2
    s_nop 1
    v_cndmask_b32 v212, v212, v8, vcc
    s_lshr_b32 s13, s20, 1
    v_lshl_add_u32 v3, v1, 1, s13
    s_and_b32 s13, s20, 1
    s_sub_u32 s14, 64, s13
    v_and_b32 v8, 3, v3
    v_lshlrev_b32 v8, 2, v8
    v_lshlrev_b32 v4, 3, v3
    v_sub_u32 v4, v4, v8
    v_sub_u32 v5, 63, v3
    v_and_b32 v8, 3, v5
    v_mul_u32_u24 v8, 12, v8
    v_lshlrev_b32 v6, 3, v5
    v_sub_u32 v6, v6, v8
    v_add_u32 v6, 28, v6
    v_sub_u32 v5, s14, v3
    v_and_b32 v8, 3, v5
    v_mul_u32_u24 v8, 12, v8
    v_lshlrev_b32 v7, 3, v5
    v_sub_u32 v7, v7, v8
    v_add_u32 v7, 28, v7
    v_cmp_gt_u32 vcc, 32, v3
    s_nop 1
    v_cndmask_b32 v7, v7, v4, vcc
    v_cmp_eq_u32 vcc, 32, v5
    s_nop 1
    v_cndmask_b32 v7, v7, 28, vcc
    s_cmp_eq_u32 s13, 0
    s_cselect_b32 s14, 256, 0
    s_cselect_b32 s15, 576, 0
    s_cselect_b64 s[38:39], -1, 0
    s_add_u32 s14, s14, 7680
    s_sub_u32 s15, 120832, s15
    v_cmp_gt_u32 vcc, 32, v3
    s_nop 1
    v_cndmask_b32 v7, v7, v4, vcc
    v_add_u32 v7, s14, v7
    v_cndmask_b32 v4, v6, v4, s[38:39]
    v_lshl_add_u32 v4, v2, 12, v4
    v_lshrrev_b32 v8, 7, v4
    v_lshl_add_u32 v4, v8, 4, v4
    v_lshrrev_b32 v8, 7, v7
    v_lshl_add_u32 v7, v8, 4, v7
    v_add_u32 v11, s15, v4
    v_add_u32 v7, 120832, v7
    v_add_u32 v12, 4032, v11
    v_cmp_eq_u32 vcc, s13, v2
    s_nop 1
    s_and_b64 s[40:41], vcc, s[38:39]
    s_andn2_b64 s[38:39], vcc, s[38:39]
    v_cndmask_b32 v10, v11, v7, s[40:41]
    v_cndmask_b32 v12, v12, v7, s[38:39]
    s_lshl_b32 s23, s20, 5
    s_add_u32 s23, s23, s18
    v_and_b32 v3, 15, v15
    v_lshrrev_b32 v4, 4, v15
    v_lshl_add_u32 v3, v3, 7, v4
    v_add_u32 v3, 1, v3
    v_cmp_le_u32 vcc, 56, v15
    v_mov_b32 v4, 1008
    s_nop 0
    v_cndmask_b32 v4, 0, v4, vcc
    v_add_u32 v4, v3, v4
    v_mul_u32_u24 v3, s23, v3
    v_and_b32 v3, 2047, v3
    v_cvt_f32_u32 v3, v3
    v_mul_f32 v3, 0x3a000000, v3
    v_mul_u32_u24 v4, s23, v4
    v_and_b32 v4, 2047, v4
    v_cvt_f32_u32 v4, v4
    v_mul_f32 v4, 0x3a000000, v4
    v_cvt_f32_u32 v5, s23
    v_mul_f32 v5, 0x3a000000, v5
    v_mov_b32 v192, v3
    v_fmamk_f32 v193, v5, 0x42000000, v3
    v_fmamk_f32 v194, v5, 0x42800000, v3
    v_fmamk_f32 v195, v5, 0x42c00000, v3
    v_fmamk_f32 v196, v5, 0x40800000, v3
    v_fmamk_f32 v197, v5, 0x42100000, v3
    v_fmamk_f32 v198, v5, 0x42880000, v3
    v_fmamk_f32 v199, v5, 0x42c80000, v3
    v_fmamk_f32 v200, v5, 0x41000000, v3
    v_fmamk_f32 v201, v5, 0x42200000, v3
    v_fmamk_f32 v202, v5, 0x42900000, v3
    v_fmamk_f32 v203, v5, 0x42d00000, v3
    v_fmamk_f32 v204, v5, 0x41400000, v4
    v_fmamk_f32 v205, v5, 0x42300000, v4
    v_fmamk_f32 v206, v5, 0x42980000, v4
    v_fmamk_f32 v207, v5, 0x42d80000, v4
    v_cos_f32 v192, v192
    v_cos_f32 v193, v193
    v_cos_f32 v194, v194
    v_cos_f32 v195, v195
    v_cos_f32 v196, v196
    v_cos_f32 v197, v197
    v_cos_f32 v198, v198
    v_cos_f32 v199, v199
    v_cos_f32 v200, v200
    v_cos_f32 v201, v201
    v_cos_f32 v202, v202
    v_cos_f32 v203, v203
    v_cos_f32 v204, v204
    v_cos_f32 v205, v205
    v_cos_f32 v206, v206
    v_cos_f32 v207, v207
    v_add_u32 v9, 138496, v14
    v_mov_b32 v3, 157864
    s_nop 4
fk_c2s:
    ds_read_b32 v4, v3
    s_waitcnt lgkmcnt(0)
    v_readfirstlane_b32 s13, v4
    s_nop 1
    s_cmp_eq_u32 s13, 0
    s_cbranch_scc1 fk_c2s
    ds_read_b128 v[112:115], v9 offset:12288
    ds_read_b128 v[116:119], v9 offset:13312
    ds_read_b128 v[120:123], v9 offset:14336
    ds_read_b128 v[124:127], v9 offset:15360
    s_setprio 2
    s_waitcnt lgkmcnt(0)
    s_barrier
    ds_read_b128 v[16:19], v184
    ds_read_b128 v[20:23], v185
    ds_read_b128 v[24:27], v186
    ds_read_b128 v[28:31], v187
    ds_read_b128 v[32:35], v188
    ds_read_b128 v[36:39], v189
    ds_read_b128 v[40:43], v190
    ds_read_b128 v[44:47], v191
    s_mov_b32 exec_lo, 1
    s_mov_b32 exec_hi, 1
    ds_read_b32 v32, v212
    ds_read_b32 v36, v213
    ds_read_b32 v40, v214
    ds_read_b32 v44, v215
    s_mov_b64 exec, -1
    s_waitcnt lgkmcnt(11)
    v_mfma_f32_32x32x16_f16 v[128:143], v[16:19], v[48:51], 0
    s_waitcnt lgkmcnt(10)
    v_mfma_f32_32x32x16_f16 v[128:143], v[20:23], v[52:55], v[128:143]
    s_waitcnt lgkmcnt(9)
    v_mfma_f32_32x32x16_f16 v[128:143], v[24:27], v[56:59], v[128:143]
    s_waitcnt lgkmcnt(8)
    v_mfma_f32_32x32x16_f16 v[128:143], v[28:31], v[60:63], v[128:143]
    s_waitcnt lgkmcnt(3)
    v_mfma_f32_32x32x16_f16 v[128:143], v[32:35], v[64:67], v[128:143]
    s_waitcnt lgkmcnt(2)
    v_mfma_f32_32x32x16_f16 v[128:143], v[36:39], v[68:71], v[128:143]
    s_waitcnt lgkmcnt(1)
    v_mfma_f32_32x32x16_f16 v[128:143], v[40:43], v[72:75], v[128:143]
    s_waitcnt lgkmcnt(0)
    v_mfma_f32_32x32x16_f16 v[128:143], v[44:47], v[76:79], v[128:143]
    s_nop 11
    v_pk_mul_f32 v[16:17], v[128:129], v[80:81]
    v_pk_mul_f32 v[18:19], v[130:131], v[82:83]
    v_pk_mul_f32 v[20:21], v[132:133], v[84:85]
    v_pk_mul_f32 v[22:23], v[134:135], v[86:87]
    v_pk_mul_f32 v[24:25], v[136:137], v[88:89]
    v_pk_mul_f32 v[26:27], v[138:139], v[90:91]
    v_pk_mul_f32 v[28:29], v[140:141], v[92:93]
    v_pk_mul_f32 v[30:31], v[142:143], v[94:95]
    v_fmac_f32_dpp v16, v128, v96 quad_perm:[1,0,3,2] row_mask:0xf bank_mask:0xf
    v_fmac_f32_dpp v17, v129, v97 quad_perm:[1,0,3,2] row_mask:0xf bank_mask:0xf
    v_fmac_f32_dpp v18, v130, v98 quad_perm:[1,0,3,2] row_mask:0xf bank_mask:0xf
    v_fmac_f32_dpp v19, v131, v99 quad_perm:[1,0,3,2] row_mask:0xf bank_mask:0xf
    v_fmac_f32_dpp v20, v132, v100 quad_perm:[1,0,3,2] row_mask:0xf bank_mask:0xf
    v_fmac_f32_dpp v21, v133, v101 quad_perm:[1,0,3,2] row_mask:0xf bank_mask:0xf
    v_fmac_f32_dpp v22, v134, v102 quad_perm:[1,0,3,2] row_mask:0xf bank_mask:0xf
    v_fmac_f32_dpp v23, v135, v103 quad_perm:[1,0,3,2] row_mask:0xf bank_mask:0xf
    v_cvt_pk_f16_f32 v176, v16, v17
    v_cvt_pk_f16_f32 v177, v18, v19
    v_cvt_pk_f16_f32 v178, v20, v21
    v_cvt_pk_f16_f32 v179, v22, v23
    v_fmac_f32_dpp v24, v136, v104 quad_perm:[1,0,3,2] row_mask:0xf bank_mask:0xf
    v_fmac_f32_dpp v25, v137, v105 quad_perm:[1,0,3,2] row_mask:0xf bank_mask:0xf
    v_mfma_f32_32x32x16_f16 v[144:159], v[176:179], v[112:115], 0
    v_fmac_f32_dpp v26, v138, v106 quad_perm:[1,0,3,2] row_mask:0xf bank_mask:0xf
    v_fmac_f32_dpp v27, v139, v107 quad_perm:[1,0,3,2] row_mask:0xf bank_mask:0xf
    v_fmac_f32_dpp v28, v140, v108 quad_perm:[1,0,3,2] row_mask:0xf bank_mask:0xf
    v_fmac_f32_dpp v29, v141, v109 quad_perm:[1,0,3,2] row_mask:0xf bank_mask:0xf
    v_fmac_f32_dpp v30, v142, v110 quad_perm:[1,0,3,2] row_mask:0xf bank_mask:0xf
    v_mfma_f32_32x32x16_f16 v[160:175], v[176:179], v[120:123], 0
    v_fmac_f32_dpp v31, v143, v111 quad_perm:[1,0,3,2] row_mask:0xf bank_mask:0xf
    v_cvt_pk_f16_f32 v180, v24, v25
    v_cvt_pk_f16_f32 v181, v26, v27
    v_cvt_pk_f16_f32 v182, v28, v29
    v_cvt_pk_f16_f32 v183, v30, v31
    s_nop 1
    v_mfma_f32_32x32x16_f16 v[144:159], v[180:183], v[116:119], v[144:159]
    v_mfma_f32_32x32x16_f16 v[160:175], v[180:183], v[124:127], v[160:175]
    s_nop 11
    v_pk_add_f32 v[16:17], v[144:145], v[160:161] op_sel:[0,1] op_sel_hi:[1,0] neg_hi:[0,1]
    v_pk_add_f32 v[18:19], v[146:147], v[162:163] op_sel:[0,1] op_sel_hi:[1,0] neg_hi:[0,1]
    v_pk_add_f32 v[20:21], v[148:149], v[164:165] op_sel:[0,1] op_sel_hi:[1,0] neg_hi:[0,1]
    v_pk_add_f32 v[22:23], v[150:151], v[166:167] op_sel:[0,1] op_sel_hi:[1,0] neg_hi:[0,1]
    v_pk_add_f32 v[24:25], v[152:153], v[168:169] op_sel:[0,1] op_sel_hi:[1,0] neg_hi:[0,1]
    v_pk_add_f32 v[26:27], v[154:155], v[170:171] op_sel:[0,1] op_sel_hi:[1,0] neg_hi:[0,1]
    v_pk_add_f32 v[28:29], v[156:157], v[172:173] op_sel:[0,1] op_sel_hi:[1,0] neg_hi:[0,1]
    v_pk_add_f32 v[30:31], v[158:159], v[174:175] op_sel:[0,1] op_sel_hi:[1,0] neg_hi:[0,1]
    v_cvt_pk_f16_f32 v48, v16, v17
    ds_write_b32 v10, v48
    v_cvt_pk_f16_f32 v49, v18, v19
    ds_write_b32 v11, v49 offset:576
    v_cvt_pk_f16_f32 v50, v20, v21
    ds_write_b32 v11, v50 offset:1152
    v_cvt_pk_f16_f32 v51, v22, v23
    ds_write_b32 v11, v51 offset:1728
    v_cvt_pk_f16_f32 v52, v24, v25
    ds_write_b32 v11, v52 offset:2304
    v_cvt_pk_f16_f32 v53, v26, v27
    ds_write_b32 v11, v53 offset:2880
    v_cvt_pk_f16_f32 v54, v28, v29
    ds_write_b32 v11, v54 offset:3456
    v_cvt_pk_f16_f32 v55, v30, v31
    ds_write_b32 v12, v55
    s_nop 3
fk_common:
    v_lshlrev_b32 v4, 4, v0
    v_lshrrev_b32 v5, 3, v0
    v_lshl_add_u32 v5, v5, 4, v4
    v_add_u32 v5, 120832, v5
    s_mul_i32 s17, s3, 8320
    s_add_u32 s17, s17, 0x268000
    s_waitcnt lgkmcnt(0)
    s_barrier
    s_setprio 0
    ds_read_b128 v[16:19], v5
    s_sub_u32 s13, 7, s16
    s_cmp_lt_u32 s16, 4
    s_cselect_b32 s13, s16, s13
    s_cselect_b32 s14, 0, 2048
    s_lshl_b32 s21, s13, 5
    s_add_u32 s21, s21, s18
    s_sub_u32 s22, 2048, s21
    s_and_b32 s22, s22, 2047
    s_cmp_lt_u32 s16, 4
    s_cselect_b32 s21, s21, s22
    s_lshl_b32 s13, s13, 12
    s_add_u32 s13, s13, s14
    s_add_u32 s13, s13, 98304
    s_lshl_b32 s14, s3, 3
    s_add_u32 s19, s14, s16
    s_cmp_eq_u32 s19, 1991
    s_cselect_b32 s21, 1024, s21
    s_cselect_b32 s13, 118784, s13
    s_lshl_b32 s22, s21, 11
    v_add_u32 v6, s13, v14
    v_add_u32 v7, 155008, v14
    s_waitcnt lgkmcnt(0)
    v_min_u32 v16, -2, v16
    v_min_u32 v17, -2, v17
    v_min_u32 v18, -2, v18
    v_min_u32 v19, -2, v19
    buffer_store_dwordx4 v[16:19], v4, s[24:27], s17 offen sc1
    ds_read_b128 v[20:23], v6
    ds_read_b128 v[24:27], v6 offset:1024
    ds_read_b128 v[28:31], v7
    ds_read_b128 v[32:35], v7 offset:1024
    s_cmp_lt_u32 s16, 4
    s_cbranch_scc1 fk_noy5
    v_add_u32 v3, 114688, v14
    v_mov_b32 v4, 157152
    ds_read_b128 v[128:131], v3 offset:0
    ds_read_b128 v[132:135], v3 offset:1024
    ds_read_b128 v[136:139], v3 offset:2048
    ds_read_b128 v[140:143], v3 offset:3072
    ds_read_b32 v9, v4
    s_lshl_b32 s38, s20, 2
    s_sub_u32 s39, 28, s38
    s_waitcnt lgkmcnt(0)
    s_nop 0
fk_y5:
    v_pk_mul_f32 v[144:145], v[128:129], v[192:193]
    v_pk_mul_f32 v[146:147], v[130:131], v[194:195]
    v_pk_fma_f32 v[144:145], v[132:133], v[196:197], v[144:145]
    v_pk_fma_f32 v[146:147], v[134:135], v[198:199], v[146:147]
    v_pk_fma_f32 v[144:145], v[136:137], v[200:201], v[144:145]
    v_pk_fma_f32 v[146:147], v[138:139], v[202:203], v[146:147]
    v_pk_fma_f32 v[144:145], v[140:141], v[204:205], v[144:145]
    v_pk_fma_f32 v[146:147], v[142:143], v[206:207], v[146:147]
    v_pk_add_f32 v[144:145], v[144:145], v[146:147]
    v_add_f32 v144, v144, v145
    s_lshl_b32 s13, s23, 31
    v_xor_b32 v12, s13, v9
    v_add_f32_dpp v144, v144, v144 quad_perm:[1,0,3,2] row_mask:0xf bank_mask:0xf
    s_nop 1
    v_add_f32_dpp v144, v144, v144 quad_perm:[2,3,0,1] row_mask:0xf bank_mask:0xf
    s_nop 1
    v_add_f32_dpp v144, v144, v144 row_half_mirror row_mask:0xf bank_mask:0xf
    s_nop 1
    v_add_f32_dpp v144, v144, v144 row_mirror row_mask:0xf bank_mask:0xf
    s_nop 1
    v_add_f32_dpp v144, v144, v144 row_bcast:15 row_mask:0xa bank_mask:0xf
    s_nop 1
    v_add_f32_dpp v144, v144, v144 row_bcast:31 row_mask:0xc bank_mask:0xf
    v_add_f32 v144, v144, v12
    v_add_f32 v144, v144, v144
    v_cvt_f16_f32 v144, v144
    s_add_u32 s13, s38, 157088
    s_add_u32 s14, s39, 157088
    v_mov_b32 v10, s13
    v_mov_b32 v11, s14
    s_mov_b32 exec_lo, 0
    s_mov_b32 exec_hi, 0x80000000
    ds_write_b32 v10, v144
    ds_write_b32 v11, v144
    s_mov_b64 exec, -1
    s_cmp_lg_u32 s23, 0
    s_cbranch_scc1 fk_noy5
    s_mov_b32 s23, 1024
    s_mov_b32 s38, 28
    v_and_b32 v3, 15, v15
    v_lshrrev_b32 v4, 4, v15
    v_lshl_add_u32 v3, v3, 7, v4
    v_add_u32 v3, 1, v3
    v_cmp_le_u32 vcc, 56, v15
    v_mov_b32 v4, 1008
    s_nop 0
    v_cndmask_b32 v4, 0, v4, vcc
    v_add_u32 v4, v3, v4
    v_mul_u32_u24 v3, s23, v3
    v_and_b32 v3, 2047, v3
    v_cvt_f32_u32 v3, v3
    v_mul_f32 v3, 0x3a000000, v3
    v_mul_u32_u24 v4, s23, v4
    v_and_b32 v4, 2047, v4
    v_cvt_f32_u32 v4, v4
    v_mul_f32 v4, 0x3a000000, v4
    v_cvt_f32_u32 v5, s23
    v_mul_f32 v5, 0x3a000000, v5
    v_mov_b32 v192, v3
    v_fmamk_f32 v193, v5, 0x42000000, v3
    v_fmamk_f32 v194, v5, 0x42800000, v3
    v_fmamk_f32 v195, v5, 0x42c00000, v3
    v_fmamk_f32 v196, v5, 0x40800000, v3
    v_fmamk_f32 v197, v5, 0x42100000, v3
    v_fmamk_f32 v198, v5, 0x42880000, v3
    v_fmamk_f32 v199, v5, 0x42c80000, v3
    v_fmamk_f32 v200, v5, 0x41000000, v3
    v_fmamk_f32 v201, v5, 0x42200000, v3
    v_fmamk_f32 v202, v5, 0x42900000, v3
    v_fmamk_f32 v203, v5, 0x42d00000, v3
    v_fmamk_f32 v204, v5, 0x41400000, v4
    v_fmamk_f32 v205, v5, 0x42300000, v4
    v_fmamk_f32 v206, v5, 0x42980000, v4
    v_fmamk_f32 v207, v5, 0x42d80000, v4
    v_cos_f32 v192, v192
    v_cos_f32 v193, v193
    v_cos_f32 v194, v194
    v_cos_f32 v195, v195
    v_cos_f32 v196, v196
    v_cos_f32 v197, v197
    v_cos_f32 v198, v198
    v_cos_f32 v199, v199
    v_cos_f32 v200, v200
    v_cos_f32 v201, v201
    v_cos_f32 v202, v202
    v_cos_f32 v203, v203
    v_cos_f32 v204, v204
    v_cos_f32 v205, v205
    v_cos_f32 v206, v206
    v_cos_f32 v207, v207
    s_branch fk_y5
    s_nop 3
fk_noy5:
    v_lshrrev_b32 v1, 1, v0
    v_and_b32 v45, 1, v0
    v_lshrrev_b32 v2, 4, v1
    v_and_b32 v3, 15, v1
    v_cmp_gt_u32 vcc, 8, v3
    v_sub_u32 v6, 16, v3
    v_and_b32 v6, 7, v6
    v_sub_u32 v5, 31, v2
    v_cndmask_b32 v6, v6, v3, vcc
    v_cndmask_b32 v5, v5, v2, vcc
    v_lshl_add_u32 v4, v6, 5, v5
    v_and_b32 v12, 63, v4
    v_lshrrev_b32 v13, 6, v4
    v_lshlrev_b32 v13, 2, v13
    v_lshl_add_u32 v12, v12, 4, v13
    s_mov_b32 s23, 0x13000
    s_mov_b32 s42, 0
    buffer_load_dword v47, v12, s[24:27], s23 offen sc1
    v_mul_u32_u24 v4, 8320, v4
    v_lshl_add_u32 v4, v45, 4, v4
    s_lshl_b32 s17, s3, 5
    s_add_u32 s17, s17, 0x268000
    v_cndmask_b32 v6, -1, 1, vcc
    v_cmp_eq_u32 vcc, 8, v3
    v_mul_u32_u24 v46, 8256, v45
    v_add_u32 v46, 138496, v46
    v_cndmask_b32 v6, v6, 15, vcc
    v_lshlrev_b32 v9, 2, v1
    v_lshl_add_u32 v10, v6, 1, v9
    v_add_u32 v9, v46, v9
    v_add_u32 v10, v46, v10
    s_mul_i32 s36, s16, 2064
    s_add_u32 s36, s36, 138496
    v_add_u32 v5, s36, v14
    s_sub_u32 s36, 7, s16
    s_cmp_eq_u32 s21, 0
    s_cselect_b32 s36, 0, s36
    s_cmp_eq_u32 s21, 1024
    s_cselect_b32 s36, 7, s36
    s_mul_i32 s36, s36, 2064
    s_add_u32 s36, s36, 139504
    v_sub_u32 v11, s36, v14
    s_lshl_b32 s36, s16, 2
    s_add_u32 s36, s36, 157088
    v_mov_b32 v6, s36
    s_mov_b32 s36, 0xffff0000
    s_mov_b32 s37, 0x3f803f80
    s_mov_b32 s38, 0x42800000
    s_waitcnt lgkmcnt(0)
    v_lshlrev_b32 v48, 16, v20
    v_and_b32 v49, s36, v20
    v_lshlrev_b32 v50, 16, v21
    v_and_b32 v51, s36, v21
    v_lshlrev_b32 v52, 16, v22
    v_and_b32 v53, s36, v22
    v_lshlrev_b32 v54, 16, v23
    v_and_b32 v55, s36, v23
    v_lshlrev_b32 v56, 16, v24
    v_and_b32 v57, s36, v24
    v_lshlrev_b32 v58, 16, v25
    v_and_b32 v59, s36, v25
    v_lshlrev_b32 v60, 16, v26
    v_and_b32 v61, s36, v26
    v_lshlrev_b32 v62, 16, v27
    v_and_b32 v63, s36, v27
    v_mov_b32 v44, 0
    v_dot2c_f32_bf16 v44, s37, v28
    v_dot2c_f32_bf16 v44, s37, v29
    v_dot2c_f32_bf16 v44, s37, v30
    v_dot2c_f32_bf16 v44, s37, v31
    v_dot2c_f32_bf16 v44, s37, v32
    v_dot2c_f32_bf16 v44, s37, v33
    v_dot2c_f32_bf16 v44, s37, v34
    v_dot2c_f32_bf16 v44, s37, v35
    s_nop 2
    v_add_f32_dpp v44, v44, v44 quad_perm:[1,0,3,2] row_mask:0xf bank_mask:0xf
    s_nop 1
    v_add_f32_dpp v44, v44, v44 quad_perm:[2,3,0,1] row_mask:0xf bank_mask:0xf
    s_nop 1
    v_add_f32_dpp v44, v44, v44 row_half_mirror row_mask:0xf bank_mask:0xf
    s_nop 1
    v_add_f32_dpp v44, v44, v44 row_mirror row_mask:0xf bank_mask:0xf
    s_nop 1
    v_add_f32_dpp v44, v44, v44 row_bcast:15 row_mask:0xa bank_mask:0xf
    s_nop 1
    v_add_f32_dpp v44, v44, v44 row_bcast:31 row_mask:0xc bank_mask:0xf
    s_nop 0
    v_readlane_b32 s39, v44, 63
    s_and_b32 s13, s18, 1
    s_mul_i32 s40, s13, 0x80008000
    s_branch fk_chkr1
    s_nop 1
fk_pollr1:
    buffer_load_dword v47, v12, s[24:27], s23 offen sc1
fk_chkr1:
    s_add_u32 s42, s42, 1
    s_waitcnt vmcnt(0)
    v_cmp_eq_u32 vcc, -1, v47
    s_cbranch_vccz fk_gotr1
    s_cmp_le_u32 s42, 0x40000
    s_cbranch_scc1 fk_pollr1
    s_nop 1
fk_gotr1:
    v_xor_b32 v47, s40, v47
    s_mov_b32 s42, 0
    s_nop 3
fk_polly:
    buffer_load_dwordx4 v[36:39], v4, s[24:27], s17 offen sc1
    s_add_u32 s42, s42, 1
    s_waitcnt vmcnt(0)
    v_max3_u32 v46, v36, v37, v38
    v_max_u32 v46, v46, v39
    v_cmp_eq_u32 vcc, -1, v46
    s_cbranch_vccz fk_goty
    s_cmp_le_u32 s42, 0x40000
    s_cbranch_scc1 fk_polly
    s_nop 1
fk_goty:
    v_pk_add_f16 v36, v36, v47
    v_pk_add_f16 v37, v37, v47
    v_pk_add_f16 v38, v38, v47
    v_pk_add_f16 v39, v39, v47
    ds_write_b16 v9, v36 offset:0
    ds_write_b16_d16_hi v10, v36 offset:0
    ds_write_b16 v9, v37 offset:2064
    ds_write_b16_d16_hi v10, v37 offset:2064
    ds_write_b16 v9, v38 offset:4128
    ds_write_b16_d16_hi v10, v38 offset:4128
    ds_write_b16 v9, v39 offset:6192
    ds_write_b16_d16_hi v10, v39 offset:6192
    s_mul_i32 s15, s16, 4
    s_add_u32 s15, s15, 0
    s_lshl_b32 s12, s15, 10
    s_add_u32 s12, s12, 32768
    s_mul_i32 s13, s15, 57344
    s_add_u32 s13, s13, s99
    v_xor_b32 v209, 64, v208
    v_mov_b32 v2, 0
    v_mov_b32 v3, 0
    v_mov_b32 v4, 0
    v_mov_b32 v7, 0
    v_mov_b32 v12, 157120
    s_waitcnt lgkmcnt(0)
    s_barrier
    ds_read_b128 v[36:39], v5
    ds_read_b128 v[40:43], v11
    ds_read_b32 v44, v6
    s_cmp_gt_u32 s3, 223
    s_cbranch_scc1 fk_wsc
    s_mov_b32 m0, s12
    s_nop 0
    buffer_load_dwordx4 v208, s[48:51], s13 offen lds
    s_add_u32 s12, s12, 1024
    s_add_u32 s13, s13, 57344
    s_mov_b32 m0, s12
    s_nop 0
    buffer_load_dwordx4 v209, s[48:51], s13 offen lds
    s_add_u32 s12, s12, 1024
    s_add_u32 s13, s13, 57344
    s_mov_b32 m0, s12
    s_nop 0
    buffer_load_dwordx4 v208, s[48:51], s13 offen lds
    s_add_u32 s12, s12, 1024
    s_add_u32 s13, s13, 57344
    s_mov_b32 m0, s12
    s_nop 0
    buffer_load_dwordx4 v209, s[48:51], s13 offen lds
fk_wsc:
    s_waitcnt lgkmcnt(2)
    v_fma_mix_f32 v48, v36, s38, v48 op_sel:[0,0,0] op_sel_hi:[1,0,0]
    v_fma_mix_f32 v49, v36, s38, v49 op_sel:[1,0,0] op_sel_hi:[1,0,0]
    v_fma_mix_f32 v50, v37, s38, v50 op_sel:[0,0,0] op_sel_hi:[1,0,0]
    v_fma_mix_f32 v51, v37, s38, v51 op_sel:[1,0,0] op_sel_hi:[1,0,0]
    v_fma_mix_f32 v52, v38, s38, v52 op_sel:[0,0,0] op_sel_hi:[1,0,0]
    v_fma_mix_f32 v53, v38, s38, v53 op_sel:[1,0,0] op_sel_hi:[1,0,0]
    v_fma_mix_f32 v54, v39, s38, v54 op_sel:[0,0,0] op_sel_hi:[1,0,0]
    v_fma_mix_f32 v55, v39, s38, v55 op_sel:[1,0,0] op_sel_hi:[1,0,0]
    s_waitcnt lgkmcnt(0)
    v_readfirstlane_b32 s13, v44
    v_mov_b32_dpp v8, v40 wave_shr:1 row_mask:0xf bank_mask:0xf
    v_fma_mix_f32 v57, v43, s38, v57 op_sel:[1,0,0] op_sel_hi:[1,0,0]
    v_fma_mix_f32 v58, v43, s38, v58 op_sel:[0,0,0] op_sel_hi:[1,0,0]
    v_fma_mix_f32 v59, v42, s38, v59 op_sel:[1,0,0] op_sel_hi:[1,0,0]
    v_fma_mix_f32 v60, v42, s38, v60 op_sel:[0,0,0] op_sel_hi:[1,0,0]
    v_writelane_b32 v8, s13, 0
    v_fma_mix_f32 v61, v41, s38, v61 op_sel:[1,0,0] op_sel_hi:[1,0,0]
    v_fma_mix_f32 v62, v41, s38, v62 op_sel:[0,0,0] op_sel_hi:[1,0,0]
    v_fma_mix_f32 v63, v40, s38, v63 op_sel:[1,0,0] op_sel_hi:[1,0,0]
    v_fma_mix_f32 v56, v8, s38, v56 op_sel:[0,0,0] op_sel_hi:[1,0,0]
    v_cvt_pk_bf16_f32 v80, v48, v49
    v_cvt_pk_bf16_f32 v81, v50, v51
    v_cvt_pk_bf16_f32 v82, v52, v53
    v_cvt_pk_bf16_f32 v83, v54, v55
    v_cvt_pk_bf16_f32 v85, v58, v59
    v_cvt_pk_bf16_f32 v86, v60, v61
    v_cvt_pk_bf16_f32 v87, v62, v63
    v_cvt_pk_bf16_f32 v84, v56, v57
    v_dot2c_f32_bf16 v2, s37, v80
    v_dot2c_f32_bf16 v3, v80, v80
    v_dot2c_f32_bf16 v4, v80, v28
    v_dot2c_f32_bf16 v2, s37, v81
    v_dot2c_f32_bf16 v3, v81, v81
    v_dot2c_f32_bf16 v4, v81, v29
    v_dot2c_f32_bf16 v2, s37, v82
    v_dot2c_f32_bf16 v3, v82, v82
    v_dot2c_f32_bf16 v4, v82, v30
    v_dot2c_f32_bf16 v2, s37, v83
    v_dot2c_f32_bf16 v3, v83, v83
    v_dot2c_f32_bf16 v4, v83, v31
    v_dot2c_f32_bf16 v2, s37, v85
    v_dot2c_f32_bf16 v3, v85, v85
    v_dot2c_f32_bf16 v4, v85, v33
    v_dot2c_f32_bf16 v2, s37, v86
    v_dot2c_f32_bf16 v3, v86, v86
    v_dot2c_f32_bf16 v4, v86, v34
    v_dot2c_f32_bf16 v2, s37, v87
    v_dot2c_f32_bf16 v3, v87, v87
    v_dot2c_f32_bf16 v4, v87, v35
    v_dot2c_f32_bf16 v2, s37, v84
    v_dot2c_f32_bf16 v3, v84, v84
    v_dot2c_f32_bf16 v4, v84, v32
    s_nop 2
    v_permlane32_swap_b32 v2, v4
    v_permlane32_swap_b32 v3, v7
    v_add_f32 v2, v2, v4
    v_add_f32 v3, v3, v7
    s_nop 1
    v_permlane16_swap_b32 v2, v3
    v_add_f32 v2, v2, v3
    s_nop 1
    v_add_f32_dpp v2, v2, v2 quad_perm:[1,0,3,2] row_mask:0xf bank_mask:0xf
    s_nop 1
    v_add_f32_dpp v2, v2, v2 quad_perm:[2,3,0,1] row_mask:0xf bank_mask:0xf
    s_nop 1
    v_add_f32_dpp v2, v2, v2 row_half_mirror row_mask:0xf bank_mask:0xf
    s_nop 1
    v_add_f32_dpp v2, v2, v2 row_mirror row_mask:0xf bank_mask:0xf
    s_nop 0
    v_readlane_b32 s13, v2, 32
    v_mov_b32_dpp v8, v2 row_bcast:15 row_mask:0xa bank_mask:0xf
    v_mul_f32 v9, 0x3a800000, v2
    v_mul_f32 v8, 0x3a800000, v8
    v_fma_f32 v9, -v8, v8, v9
    v_max_f32 v9, 0, v9
    v_cvt_pk_bf16_f32 v9, 0, v9
    v_cvt_pk_bf16_f32 v8, 0, v8
    v_add_f32 v9, 0x3727c5ac, v9
    v_cvt_pk_bf16_f32 v9, 0, v9
    v_sqrt_f32 v9, v9
    s_nop 0
    v_cvt_pk_bf16_f32 v9, 0, v9
    v_rcp_f32 v9, v9
    v_mov_b32 v10, s13
    v_fma_f32 v10, -v8, s39, v10
    v_mul_f32 v10, v10, v9
    v_mul_f32 v8, v8, v9
    v_readlane_b32 s43, v10, 16
    v_readlane_b32 s4, v9, 16
    v_readlane_b32 s6, v8, 16
    s_ashr_i32 s13, s43, 31
    s_or_b32 s13, s13, 0x80000000
    s_xor_b32 s43, s43, s13
    s_and_b32 s43, s43, 0xfffff800
    s_or_b32 s43, s43, s19
    s_min_u32 s43, s43, -2
    v_mov_b32 v2, s43
    s_mov_b64 exec, 1
    ds_max_u32 v12, v2
    s_mov_b64 exec, -1
    v_mov_b32 v10, s6
    v_add_f32 v8, 1.0, v9
    v_lshlrev_b32 v4, 12, v15
    s_lshl_b32 s17, s3, 4
    s_add_u32 s17, s17, 0x9000
    v_readlane_b32 s14, v8, 16
    s_waitcnt lgkmcnt(0)
    s_barrier
    ds_read_b32 v3, v12
    v_lshlrev_b32 v48, 16, v80
    v_and_b32 v49, s36, v80
    v_lshlrev_b32 v50, 16, v81
    v_and_b32 v51, s36, v81
    v_lshlrev_b32 v52, 16, v82
    v_and_b32 v53, s36, v82
    v_lshlrev_b32 v54, 16, v83
    v_and_b32 v55, s36, v83
    v_lshlrev_b32 v56, 16, v84
    v_and_b32 v57, s36, v84
    v_lshlrev_b32 v58, 16, v85
    v_and_b32 v59, s36, v85
    v_lshlrev_b32 v60, 16, v86
    v_and_b32 v61, s36, v86
    v_lshlrev_b32 v62, 16, v87
    v_and_b32 v63, s36, v87
    s_waitcnt lgkmcnt(0)
    v_readfirstlane_b32 s13, v3
    s_nop 1
    s_cmp_lg_u32 s13, s43
    s_cbranch_scc1 fk_other
    s_mov_b64 exec, 0xff
    buffer_store_dword v2, v4, s[24:27], s17 offen sc1
    s_mov_b64 exec, -1
    v_pk_fma_f32 v[64:65], v[48:49], s[4:5], v[10:11] op_sel_hi:[1,0,0] neg_lo:[0,0,1] neg_hi:[0,0,1]
    v_pk_fma_f32 v[66:67], v[50:51], s[4:5], v[10:11] op_sel_hi:[1,0,0] neg_lo:[0,0,1] neg_hi:[0,0,1]
    v_pk_fma_f32 v[68:69], v[52:53], s[4:5], v[10:11] op_sel_hi:[1,0,0] neg_lo:[0,0,1] neg_hi:[0,0,1]
    v_pk_fma_f32 v[70:71], v[54:55], s[4:5], v[10:11] op_sel_hi:[1,0,0] neg_lo:[0,0,1] neg_hi:[0,0,1]
    v_pk_fma_f32 v[72:73], v[56:57], s[4:5], v[10:11] op_sel_hi:[1,0,0] neg_lo:[0,0,1] neg_hi:[0,0,1]
    v_pk_fma_f32 v[74:75], v[58:59], s[4:5], v[10:11] op_sel_hi:[1,0,0] neg_lo:[0,0,1] neg_hi:[0,0,1]
    v_pk_fma_f32 v[76:77], v[60:61], s[4:5], v[10:11] op_sel_hi:[1,0,0] neg_lo:[0,0,1] neg_hi:[0,0,1]
    v_pk_fma_f32 v[78:79], v[62:63], s[4:5], v[10:11] op_sel_hi:[1,0,0] neg_lo:[0,0,1] neg_hi:[0,0,1]
    v_cvt_pk_bf16_f32 v96, v64, v65
    v_cvt_pk_bf16_f32 v97, v66, v67
    v_cvt_pk_bf16_f32 v98, v68, v69
    v_cvt_pk_bf16_f32 v99, v70, v71
    v_cvt_pk_bf16_f32 v100, v72, v73
    v_cvt_pk_bf16_f32 v101, v74, v75
    v_cvt_pk_bf16_f32 v102, v76, v77
    v_cvt_pk_bf16_f32 v103, v78, v79
    v_and_b32 v96, -2, v96
    v_and_b32 v97, -2, v97
    v_and_b32 v98, -2, v98
    v_and_b32 v99, -2, v99
    v_and_b32 v100, -2, v100
    v_and_b32 v101, -2, v101
    v_and_b32 v102, -2, v102
    v_and_b32 v103, -2, v103
    s_mul_i32 s13, s3, 9344
    s_add_u32 s13, s13, 0x20000
    buffer_store_dwordx4 v[96:99], v14, s[24:27], s13 offen sc1
    buffer_store_dwordx4 v[100:103], v14, s[24:27], s13 offen offset:1024 sc1
    v_and_b32 v80, -2, v80
    v_and_b32 v81, -2, v81
    v_and_b32 v82, -2, v82
    v_and_b32 v83, -2, v83
    v_and_b32 v84, -2, v84
    v_and_b32 v85, -2, v85
    v_and_b32 v86, -2, v86
    v_and_b32 v87, -2, v87
    buffer_store_dwordx4 v[80:83], v14, s[24:27], s13 offen offset:2048 sc1
    buffer_store_dwordx4 v[84:87], v14, s[24:27], s13 offen offset:3072 sc1
    v_pk_fma_f32 v[64:65], v[48:49], s[14:15], v[10:11] op_sel_hi:[1,0,0] neg_lo:[0,0,1] neg_hi:[0,0,1]
    v_pk_fma_f32 v[66:67], v[50:51], s[14:15], v[10:11] op_sel_hi:[1,0,0] neg_lo:[0,0,1] neg_hi:[0,0,1]
    v_pk_fma_f32 v[68:69], v[52:53], s[14:15], v[10:11] op_sel_hi:[1,0,0] neg_lo:[0,0,1] neg_hi:[0,0,1]
    v_pk_fma_f32 v[70:71], v[54:55], s[14:15], v[10:11] op_sel_hi:[1,0,0] neg_lo:[0,0,1] neg_hi:[0,0,1]
    v_pk_fma_f32 v[72:73], v[56:57], s[14:15], v[10:11] op_sel_hi:[1,0,0] neg_lo:[0,0,1] neg_hi:[0,0,1]
    v_pk_fma_f32 v[74:75], v[58:59], s[14:15], v[10:11] op_sel_hi:[1,0,0] neg_lo:[0,0,1] neg_hi:[0,0,1]
    v_pk_fma_f32 v[76:77], v[60:61], s[14:15], v[10:11] op_sel_hi:[1,0,0] neg_lo:[0,0,1] neg_hi:[0,0,1]
    v_pk_fma_f32 v[78:79], v[62:63], s[14:15], v[10:11] op_sel_hi:[1,0,0] neg_lo:[0,0,1] neg_hi:[0,0,1]
    v_cvt_pk_bf16_f32 v112, v64, v65
    v_cvt_pk_bf16_f32 v113, v66, v67
    v_cvt_pk_bf16_f32 v114, v68, v69
    v_cvt_pk_bf16_f32 v115, v70, v71
    v_cvt_pk_bf16_f32 v116, v72, v73
    v_cvt_pk_bf16_f32 v117, v74, v75
    v_cvt_pk_bf16_f32 v118, v76, v77
    v_cvt_pk_bf16_f32 v119, v78, v79
    v_lshrrev_b32 v1, 4, v15
    v_bfe_u32 v2, v15, 2, 2
    v_lshl_add_u32 v8, v1, 3, v2
    v_lshlrev_b32 v8, 7, v8
    v_and_b32 v3, 2, v2
    v_xor_b32 v9, s16, v3
    v_and_b32 v3, 1, v1
    v_lshlrev_b32 v4, 2, v3
    v_xor_b32 v9, v4, v9
    v_lshl_add_u32 v8, v9, 4, v8
    v_and_b32 v9, 1, v15
    v_lshl_add_u32 v8, v9, 3, v8
    v_bfe_u32 v9, v15, 1, 1
    v_lshl_add_u32 v8, v9, 15, v8
    v_lshrrev_b32 v7, 1, v1
    v_lshl_add_u32 v7, v7, 3, v2
    v_lshlrev_b32 v7, 9, v7
    v_lshl_add_u32 v7, v3, 5, v7
    v_and_b32 v3, 3, v15
    v_lshl_add_u32 v7, v3, 3, v7
    s_lshl_b32 s15, s16, 6
    s_add_u32 s15, s15, 65536
    v_add_u32 v7, s15, v7
    v_lshlrev_b32 v9, 4, v1
    v_add_u32 v9, 157312, v9
    s_and_b32 s13, s2, 7
    s_lshl_b32 s13, s13, 12
    s_add_u32 s13, s13, 0x9000
    s_mov_b32 s42, 0
    s_waitcnt vmcnt(4)
    v_mov_b32 v1, 157872
    v_mov_b32 v2, 1
    s_mov_b64 exec, 1
    ds_add_u32 v1, v2
    s_mov_b64 exec, -1
    s_nop 1
fk_pollk:
    buffer_load_dword v180, v14, s[24:27], s13 offen offset:0 sc1
    buffer_load_dword v181, v14, s[24:27], s13 offen offset:1024 sc1
    buffer_load_dword v182, v14, s[24:27], s13 offen offset:2048 sc1
    buffer_load_dword v183, v14, s[24:27], s13 offen offset:3072 sc1
    s_add_u32 s42, s42, 1
    s_waitcnt vmcnt(0)
    v_max3_u32 v3, v180, v181, v182
    v_max_u32 v3, v3, v183
    v_cmp_eq_u32 vcc, -1, v3
    s_cbranch_vccz fk_gotk
    s_cmp_le_u32 s42, 0x40000
    s_cbranch_scc1 fk_pollk
    s_nop 1
fk_gotk:
    v_max_u32_dpp v3, v3, v3 quad_perm:[1,0,3,2] row_mask:0xf bank_mask:0xf
    s_nop 1
    v_max_u32_dpp v3, v3, v3 quad_perm:[2,3,0,1] row_mask:0xf bank_mask:0xf
    s_nop 1
    v_max_u32_dpp v3, v3, v3 row_half_mirror row_mask:0xf bank_mask:0xf
    s_nop 1
    v_max_u32_dpp v3, v3, v3 row_mirror row_mask:0xf bank_mask:0xf
    s_nop 1
    v_max_u32_dpp v3, v3, v3 row_bcast:15 row_mask:0xa bank_mask:0xf
    s_nop 1
    v_max_u32_dpp v3, v3, v3 row_bcast:31 row_mask:0xc bank_mask:0xf
    s_nop 0
    v_readlane_b32 s40, v3, 63
    v_mov_b32 v4, 157136
    s_nop 0
    s_bfe_u32 s13, s40, 0x80003
    s_mul_i32 s13, s13, 9344
    s_and_b32 s14, s3, 3
    s_lshl_b32 s14, s14, 9
    s_add_u32 s13, s13, s14
    s_add_u32 s13, s13, 0x20000
    v_lshlrev_b32 v5, 3, v15
    v_mov_b32 v3, s40
    s_cmp_gt_u32 s3, 223
    s_cbranch_scc1 fk_norow
    s_mov_b32 s42, 0
    buffer_load_dwordx2 v[180:181], v5, s[24:27], s13 offen sc1
    s_nop 0
fk_landa:
    ds_read_b32 v2, v1
    s_waitcnt lgkmcnt(0)
    v_readfirstlane_b32 s15, v2
    s_nop 1
    s_cmp_lt_u32 s15, 8
    s_cbranch_scc1 fk_landa
    ds_read_b64_tr_b16 v[128:129], v8 offset:0
    ds_read_b64_tr_b16 v[130:131], v8 offset:512
    ds_read_b64_tr_b16 v[132:133], v8 offset:4096
    ds_read_b64_tr_b16 v[134:135], v8 offset:4608
    ds_read_b64_tr_b16 v[136:137], v8 offset:8192
    ds_read_b64_tr_b16 v[138:139], v8 offset:8704
    ds_read_b64_tr_b16 v[140:141], v8 offset:12288
    ds_read_b64_tr_b16 v[142:143], v8 offset:12800
    ds_read_b64_tr_b16 v[144:145], v8 offset:16384
    ds_read_b64_tr_b16 v[146:147], v8 offset:16896
    ds_read_b64_tr_b16 v[148:149], v8 offset:20480
    ds_read_b64_tr_b16 v[150:151], v8 offset:20992
    s_waitcnt lgkmcnt(4)
    ds_read_b64_tr_b16 v[152:153], v8 offset:24576
    ds_read_b64_tr_b16 v[154:155], v8 offset:25088
    ds_read_b64_tr_b16 v[156:157], v8 offset:28672
    ds_read_b64_tr_b16 v[158:159], v8 offset:29184
    s_branch fk_chkr
    s_nop 0
fk_pollr:
    buffer_load_dwordx2 v[180:181], v5, s[24:27], s13 offen sc1
fk_chkr:
    s_waitcnt vmcnt(0)
    v_or_b32 v6, v180, v181
    v_and_b32 v6, 1, v6
    v_cmp_eq_u32 vcc, 1, v6
    s_add_u32 s42, s42, 1
    s_cbranch_vccz fk_gotr
    s_cmp_le_u32 s42, 0x40000
    s_cbranch_scc1 fk_pollr
    s_nop 0
fk_gotr:
    v_add_u32 v5, 157312, v5
    ds_write_b64 v5, v[180:181]
    s_nop 3
fk_norow:
    ds_write_b32 v4, v3
    s_waitcnt lgkmcnt(0)
    s_barrier
    s_cmp_eq_u32 s40, s43
    s_cselect_b32 s22, 0x400000, s22
    s_branch fk_ffn
    s_nop 0
fk_other:
    v_pk_fma_f32 v[64:65], v[48:49], s[14:15], v[10:11] op_sel_hi:[1,0,0] neg_lo:[0,0,1] neg_hi:[0,0,1]
    v_pk_fma_f32 v[66:67], v[50:51], s[14:15], v[10:11] op_sel_hi:[1,0,0] neg_lo:[0,0,1] neg_hi:[0,0,1]
    v_pk_fma_f32 v[68:69], v[52:53], s[14:15], v[10:11] op_sel_hi:[1,0,0] neg_lo:[0,0,1] neg_hi:[0,0,1]
    v_pk_fma_f32 v[70:71], v[54:55], s[14:15], v[10:11] op_sel_hi:[1,0,0] neg_lo:[0,0,1] neg_hi:[0,0,1]
    v_pk_fma_f32 v[72:73], v[56:57], s[14:15], v[10:11] op_sel_hi:[1,0,0] neg_lo:[0,0,1] neg_hi:[0,0,1]
    v_pk_fma_f32 v[74:75], v[58:59], s[14:15], v[10:11] op_sel_hi:[1,0,0] neg_lo:[0,0,1] neg_hi:[0,0,1]
    v_pk_fma_f32 v[76:77], v[60:61], s[14:15], v[10:11] op_sel_hi:[1,0,0] neg_lo:[0,0,1] neg_hi:[0,0,1]
    v_pk_fma_f32 v[78:79], v[62:63], s[14:15], v[10:11] op_sel_hi:[1,0,0] neg_lo:[0,0,1] neg_hi:[0,0,1]
    v_cvt_pk_bf16_f32 v112, v64, v65
    v_cvt_pk_bf16_f32 v113, v66, v67
    v_cvt_pk_bf16_f32 v114, v68, v69
    v_cvt_pk_bf16_f32 v115, v70, v71
    v_cvt_pk_bf16_f32 v116, v72, v73
    v_cvt_pk_bf16_f32 v117, v74, v75
    v_cvt_pk_bf16_f32 v118, v76, v77
    v_cvt_pk_bf16_f32 v119, v78, v79
    s_and_b32 s13, s13, 7
    s_cmp_gt_u32 s16, s13
    s_cselect_b32 s13, 1, 0
    s_sub_u32 s17, s16, s13
    s_waitcnt vmcnt(0)
    v_lshrrev_b32 v1, 4, v15
    v_bfe_u32 v2, v15, 2, 2
    v_lshl_add_u32 v8, v1, 3, v2
    v_lshlrev_b32 v8, 7, v8
    v_and_b32 v3, 2, v2
    v_xor_b32 v9, s16, v3
    v_and_b32 v3, 1, v1
    v_lshlrev_b32 v4, 2, v3
    v_xor_b32 v9, v4, v9
    v_lshl_add_u32 v8, v9, 4, v8
    v_and_b32 v9, 1, v15
    v_lshl_add_u32 v8, v9, 3, v8
    v_bfe_u32 v9, v15, 1, 1
    v_lshl_add_u32 v8, v9, 15, v8
    v_lshrrev_b32 v7, 1, v1
    v_lshl_add_u32 v7, v7, 3, v2
    v_lshlrev_b32 v7, 9, v7
    v_lshl_add_u32 v7, v3, 5, v7
    v_and_b32 v3, 3, v15
    v_lshl_add_u32 v7, v3, 3, v7
    s_lshl_b32 s15, s16, 6
    s_add_u32 s15, s15, 65536
    v_add_u32 v7, s15, v7
    v_lshlrev_b32 v9, 4, v1
    v_add_u32 v9, 157312, v9
    v_mov_b32 v1, 157872
    v_mov_b32 v2, 1
    s_mov_b64 exec, 1
    ds_add_u32 v1, v2
    s_mov_b64 exec, -1
    s_mul_i32 s15, s17, 4
    s_add_u32 s15, s15, 8
    s_lshl_b32 s12, s15, 10
    s_add_u32 s12, s12, 65536
    s_mul_i32 s13, s15, 4096
    s_add_u32 s13, s13, s101
    s_cmp_gt_u32 s3, 223
    s_cbranch_scc1 fk_wsd
    s_mov_b32 m0, s12
    s_cmp_gt_u32 s12, 97280
    s_cbranch_scc1 fk_wsd
    buffer_load_dwordx4 v210, s[52:55], s13 offen lds
    s_add_u32 s12, s12, 1024
    s_add_u32 s13, s13, 4096
    s_mov_b32 m0, s12
    s_cmp_gt_u32 s12, 97280
    s_cbranch_scc1 fk_wsd
    buffer_load_dwordx4 v210, s[52:55], s13 offen lds
    s_add_u32 s12, s12, 1024
    s_add_u32 s13, s13, 4096
    s_mov_b32 m0, s12
    s_cmp_gt_u32 s12, 97280
    s_cbranch_scc1 fk_wsd
    buffer_load_dwordx4 v210, s[52:55], s13 offen lds
    s_add_u32 s12, s12, 1024
    s_add_u32 s13, s13, 4096
    s_mov_b32 m0, s12
    s_cmp_gt_u32 s12, 97280
    s_cbranch_scc1 fk_wsd
    buffer_load_dwordx4 v210, s[52:55], s13 offen lds
fk_wsd:
fk_landb:
    ds_read_b32 v2, v1
    s_waitcnt lgkmcnt(0)
    v_readfirstlane_b32 s15, v2
    s_nop 1
    s_cmp_lt_u32 s15, 8
    s_cbranch_scc1 fk_landb
    ds_read_b64_tr_b16 v[128:129], v8 offset:0
    ds_read_b64_tr_b16 v[130:131], v8 offset:512
    ds_read_b64_tr_b16 v[132:133], v8 offset:4096
    ds_read_b64_tr_b16 v[134:135], v8 offset:4608
    ds_read_b64_tr_b16 v[136:137], v8 offset:8192
    ds_read_b64_tr_b16 v[138:139], v8 offset:8704
    ds_read_b64_tr_b16 v[140:141], v8 offset:12288
    ds_read_b64_tr_b16 v[142:143], v8 offset:12800
    ds_read_b64_tr_b16 v[144:145], v8 offset:16384
    ds_read_b64_tr_b16 v[146:147], v8 offset:16896
    ds_read_b64_tr_b16 v[148:149], v8 offset:20480
    ds_read_b64_tr_b16 v[150:151], v8 offset:20992
    s_waitcnt lgkmcnt(4)
    ds_read_b64_tr_b16 v[152:153], v8 offset:24576
    ds_read_b64_tr_b16 v[154:155], v8 offset:25088
    ds_read_b64_tr_b16 v[156:157], v8 offset:28672
    ds_read_b64_tr_b16 v[158:159], v8 offset:29184
    s_waitcnt vmcnt(0) lgkmcnt(0)
    s_barrier
    s_nop 0
fk_ffn:
    buffer_store_dwordx4 v[112:115], v14, s[28:31], s22 offen nt
    buffer_store_dwordx4 v[116:119], v14, s[28:31], s22 offen offset:1024 nt
    s_cmp_gt_u32 s3, 223
    s_cbranch_scc1 fk_fin
    ds_read_b128 v[16:19], v9 offset:0
    ds_read_b128 v[20:23], v9 offset:64
    ds_read_b128 v[24:27], v9 offset:128
    ds_read_b128 v[28:31], v9 offset:192
    ds_read_b128 v[32:35], v9 offset:256
    ds_read_b128 v[36:39], v9 offset:320
    ds_read_b128 v[40:43], v9 offset:384
    ds_read_b128 v[44:47], v9 offset:448
    v_mov_b32 v3, 157136
    ds_read_b32 v12, v3
    v_lshlrev_b32 v4, 3, v15
    s_mul_i32 s41, s3, 9344
    s_lshl_b32 s14, s16, 6
    s_add_u32 s13, s41, s14
    s_add_u32 s13, s13, 0x21000
    s_waitcnt lgkmcnt(8)
    v_mfma_f32_16x16x32_bf16 v[176:179], v[16:19], v[128:131], 0
    s_waitcnt lgkmcnt(7)
    v_mfma_f32_16x16x32_bf16 v[176:179], v[20:23], v[132:135], v[176:179]
    s_waitcnt lgkmcnt(6)
    v_mfma_f32_16x16x32_bf16 v[176:179], v[24:27], v[136:139], v[176:179]
    s_waitcnt lgkmcnt(5)
    v_mfma_f32_16x16x32_bf16 v[176:179], v[28:31], v[140:143], v[176:179]
    s_waitcnt lgkmcnt(4)
    v_mfma_f32_16x16x32_bf16 v[176:179], v[32:35], v[144:147], v[176:179]
    s_waitcnt lgkmcnt(3)
    v_mfma_f32_16x16x32_bf16 v[176:179], v[36:39], v[148:151], v[176:179]
    s_waitcnt lgkmcnt(2)
    v_mfma_f32_16x16x32_bf16 v[176:179], v[40:43], v[152:155], v[176:179]
    s_waitcnt lgkmcnt(1)
    v_mfma_f32_16x16x32_bf16 v[176:179], v[44:47], v[156:159], v[176:179]
    v_lshlrev_b32 v5, 3, v15
    v_lshlrev_b32 v6, 2, v15
    v_lshrrev_b32 v9, 5, v15
    v_lshlrev_b32 v9, 4, v9
    v_add_u32 v9, 157184, v9
    s_lshl_b32 s14, s16, 7
    s_add_u32 s41, s41, s14
    s_add_u32 s41, s41, 0x21400
    v_and_b32 v176, -2, v176
    s_nop 1
    v_mov_b32_dpp v177, v176 row_shl:8 row_mask:0xf bank_mask:0xf
    v_mov_b32_dpp v178, v176 row_shl:1 row_mask:0xf bank_mask:0xf
    v_mov_b32_dpp v179, v176 row_shl:9 row_mask:0xf bank_mask:0xf
    s_mov_b64 exec, 0x55
    buffer_store_dwordx4 v[176:179], v4, s[24:27], s13 offen sc1
    s_mov_b64 exec, -1
    v_mov_b32 v1, 157876
    v_mov_b32 v8, 1
    ds_read_b64_tr_b16 v[160:161], v7 offset:0
    ds_read_b64_tr_b16 v[162:163], v7 offset:2048
    ds_read_b64_tr_b16 v[164:165], v7 offset:8192
    ds_read_b64_tr_b16 v[166:167], v7 offset:10240
    ds_read_b64_tr_b16 v[168:169], v7 offset:16384
    ds_read_b64_tr_b16 v[170:171], v7 offset:18432
    ds_read_b64_tr_b16 v[172:173], v7 offset:24576
    ds_read_b64_tr_b16 v[174:175], v7 offset:26624
    s_cmp_eq_u32 s16, 7
    s_cbranch_scc1 fk_c1
    s_cmp_lg_u32 s16, 0
    s_cbranch_scc1 fk_wait1
    s_and_b32 s13, s3, -4
    s_mul_i32 s13, s13, 9344
    s_add_u32 s36, s13, 0x21000
    s_add_u32 s37, s36, 9344
    s_add_u32 s38, s36, 18688
    s_add_u32 s39, s36, 28032
    s_mov_b32 s42, 0
    v_lshrrev_b32 v10, 2, v5
    v_add_u32 v10, 157184, v10
    s_waitcnt vmcnt(0)
    s_nop 3
fk_poll1:
    buffer_load_dwordx2 v[184:185], v5, s[24:27], s36 offen sc1
    buffer_load_dwordx2 v[186:187], v5, s[24:27], s37 offen sc1
    buffer_load_dwordx2 v[188:189], v5, s[24:27], s38 offen sc1
    buffer_load_dwordx2 v[190:191], v5, s[24:27], s39 offen sc1
    s_waitcnt vmcnt(0)
    v_or3_b32 v11, v184, v185, v186
    v_or3_b32 v11, v11, v187, v188
    v_or3_b32 v11, v11, v189, v190
    v_or_b32 v11, v11, v191
    v_and_b32 v11, 1, v11
    v_cmp_eq_u32 vcc, 1, v11
    s_add_u32 s42, s42, 1
    s_cbranch_vccz fk_got1
    s_cmp_le_u32 s42, 0x40000
    s_cbranch_scc1 fk_poll1
    s_nop 0
fk_got1:
    v_pk_add_f32 v[184:185], v[184:185], v[186:187]
    v_pk_add_f32 v[188:189], v[188:189], v[190:191]
    v_pk_add_f32 v[184:185], v[184:185], v[188:189]
    v_cvt_pk_bf16_f32 v184, 0, v184
    v_cvt_pk_bf16_f32 v185, 0, v185
    v_mul_f32 v186, 0xbfb8aa3b, v184
    v_exp_f32 v186, v186
    s_nop 0
    v_add_f32 v186, 1.0, v186
    v_rcp_f32 v186, v186
    s_nop 0
    v_mul_f32 v184, v184, v186
    v_cvt_pk_bf16_f32 v184, 0, v184
    v_mul_f32 v184, v184, v185
    v_cvt_pk_bf16_f32 v184, 0, v184
    ds_write_b16_d16_hi v10, v184
    s_branch fk_wait1
    s_nop 2
fk_c1:
    s_cmp_gt_u32 s3, 127
    s_cbranch_scc1 fk_wait1
    s_waitcnt lgkmcnt(0)
    v_readfirstlane_b32 s40, v12
    v_lshrrev_b32 v10, 4, v15
    v_and_b32 v11, 1, v15
    v_lshl_add_u32 v12, v11, 2, v10
    v_lshlrev_b32 v12, 1, v12
    v_and_b32 v11, 12, v12
    v_and_b32 v10, 1, v10
    s_bfe_u32 s13, s40, 0x80003
    s_mul_i32 s14, s13, 9344
    s_lshl_b32 s15, s3, 4
    s_add_u32 s14, s14, s15
    s_add_u32 s14, s14, 0x20000
    s_mov_b32 s42, 0
    s_nop 0
fk_pollh:
    buffer_load_dword v2, v11, s[24:27], s14 offen sc1
    buffer_load_dword v3, v11, s[24:27], s14 offen offset:2048 sc1
    s_waitcnt vmcnt(0)
    v_or_b32 v4, v2, v3
    v_and_b32 v4, 1, v4
    v_cmp_eq_u32 vcc, 1, v4
    s_add_u32 s42, s42, 1
    s_cbranch_vccz fk_goth
    s_cmp_le_u32 s42, 0x40000
    s_cbranch_scc1 fk_pollh
    s_nop 0
fk_goth:
    v_cmp_eq_u32 vcc, 1, v10
    v_lshlrev_b32 v4, 16, v2
    v_and_b32 v2, s36, v2
    v_cndmask_b32 v2, v4, v2, vcc
    v_lshlrev_b32 v4, 16, v3
    v_and_b32 v3, s36, v3
    v_cndmask_b32 v3, v4, v3, vcc
    s_lshr_b32 s14, s13, 4
    s_add_u32 s14, s14, 1
    s_cmp_ge_u32 s13, 248
    s_cselect_b32 s14, 0, s14
    s_cmp_ge_u32 s13, 240
    s_cselect_b32 s15, 7, 15
    s_and_b32 s15, s15, s13
    s_lshl_b32 s15, s15, 7
    s_add_u32 s14, s14, s15
    s_and_b32 s13, s40, 7
    s_sub_u32 s15, 7, s13
    s_min_u32 s15, s15, s13
    s_lshl_b32 s15, s15, 5
    s_add_u32 s14, s14, s15
    s_sub_u32 s15, 2048, s14
    s_and_b32 s15, s15, 2047
    s_cmp_lt_u32 s13, 4
    s_cselect_b32 s14, s14, s15
    s_and_b32 s13, s40, 0x7ff
    s_cmp_eq_u32 s13, 1991
    s_cselect_b32 s14, 1024, s14
    s_lshl_b32 s21, s14, 11
    s_lshl_b32 s15, s3, 4
    s_add_u32 s21, s21, s15
    s_ashr_i32 s13, s40, 31
    s_not_b32 s13, s13
    s_or_b32 s13, s13, 0x80000000
    s_xor_b32 s13, s40, s13
    s_and_b32 s13, s13, 0xfffff800
    v_mov_b32 v11, s13
    v_cvt_pk_bf16_f32 v11, 0, v11
    v_mul_f32 v11, 0xbfb8aa3b, v11
    v_exp_f32 v11, v11
    s_nop 0
    v_add_f32 v11, 1.0, v11
    v_rcp_f32 v11, v11
    s_nop 0
    v_cvt_pk_bf16_f32 v11, 0, v11
    v_lshrrev_b32 v4, 1, v15
    v_mul_u32_u24 v4, 37376, v4
    v_and_b32 v5, 1, v15
    v_lshl_add_u32 v4, v5, 4, v4
    v_add_u32 v5, 1196032, v4
    v_cmp_gt_u32 vcc, 48, v15
    s_nop 1
    v_cndmask_b32 v5, -16, v5, vcc
    s_lshr_b32 s40, s3, 5
    s_mul_i32 s40, s40, 9344
    s_and_b32 s15, s3, 31
    s_lshl_b32 s15, s15, 5
    s_add_u32 s40, s40, s15
    s_add_u32 s40, s40, 0x21400
    s_nop 0
fk_wait1:
    s_waitcnt lgkmcnt(0)
    s_barrier
    ds_read_b128 v[16:19], v9 offset:0
    ds_read_b128 v[20:23], v9 offset:32
    ds_read_b128 v[24:27], v9 offset:64
    ds_read_b128 v[28:31], v9 offset:96
    s_waitcnt lgkmcnt(3)
    v_mfma_f32_32x32x16_bf16 v[192:207], v[16:19], v[160:163], 0
    s_waitcnt lgkmcnt(2)
    v_mfma_f32_32x32x16_bf16 v[192:207], v[20:23], v[164:167], v[192:207]
    s_waitcnt lgkmcnt(1)
    v_mfma_f32_32x32x16_bf16 v[192:207], v[24:27], v[168:171], v[192:207]
    s_waitcnt lgkmcnt(0)
    v_mfma_f32_32x32x16_bf16 v[192:207], v[28:31], v[172:175], v[192:207]
    s_nop 11
    v_and_b32 v192, -2, v192
    s_nop 1
    v_mov_b32_dpp v193, v192 row_shl:1 row_mask:0xf bank_mask:0xf
    v_mov_b32_dpp v194, v192 row_shl:2 row_mask:0xf bank_mask:0xf
    v_mov_b32_dpp v195, v192 row_shl:3 row_mask:0xf bank_mask:0xf
    s_mov_b32 exec_lo, 0x11111111
    s_mov_b32 exec_hi, 0
    buffer_store_dwordx4 v[192:195], v6, s[24:27], s41 offen sc1
    s_mov_b64 exec, -1
    s_cmp_lg_u32 s16, 7
    s_cbranch_scc1 fk_fin
    s_cmp_gt_u32 s3, 127
    s_cbranch_scc1 fk_fin
    s_mov_b32 s42, 0
    s_waitcnt vmcnt(0)
    s_nop 0
fk_poll2:
    buffer_load_dwordx4 v[16:19], v4, s[24:27], s40 offen sc1
    buffer_load_dwordx4 v[20:23], v5, s[24:27], s40 offen sc1
    s_waitcnt vmcnt(0)
    v_or3_b32 v6, v16, v17, v18
    v_or3_b32 v6, v6, v19, v20
    v_or3_b32 v6, v6, v21, v22
    v_or_b32 v6, v6, v23
    v_and_b32 v6, 1, v6
    v_cmp_eq_u32 vcc, 1, v6
    s_add_u32 s42, s42, 1
    s_cbranch_vccz fk_got2
    s_cmp_le_u32 s42, 0x40000
    s_cbranch_scc1 fk_poll2
    s_nop 0
fk_got2:
    v_pk_add_f32 v[16:17], v[16:17], v[20:21]
    v_pk_add_f32 v[18:19], v[18:19], v[22:23]
    s_nop 1
    v_permlane32_swap_b32 v16, v18
    v_permlane32_swap_b32 v17, v19
    v_add_f32 v16, v16, v18
    v_add_f32 v17, v17, v19
    s_nop 1
    v_permlane16_swap_b32 v16, v17
    v_add_f32 v16, v16, v17
    s_nop 1
    v_add_f32_dpp v16, v16, v16 quad_perm:[2,3,0,1] row_mask:0xf bank_mask:0xf
    s_nop 1
    v_add_f32_dpp v16, v16, v16 row_ror:4 row_mask:0xf bank_mask:0xf
    s_nop 1
    v_add_f32_dpp v16, v16, v16 row_ror:8 row_mask:0xf bank_mask:0xf
    v_cvt_pk_bf16_f32 v16, 0, v16
    v_mul_f32 v16, v16, v11
    v_cvt_pk_bf16_f32 v16, 0, v16
    v_add_f32 v16, v16, v2
    v_cvt_pk_bf16_f32 v16, 0, v16
    v_add_f32 v16, v16, v3
    v_cvt_pk_bf16_f32 v16, 0, v16
    s_mov_b32 exec_lo, 0x00030003
    s_mov_b32 exec_hi, 0x00030003
    buffer_store_short_d16_hi v16, v12, s[28:31], s21 offen
    s_nop 1
fk_fin:
fk_end:
    s_endpgm
.section .rodata,"a"
.p2align 6
.amdhsa_kernel sequential_preLN__spectral_fnet__moe_arch_mod__prompt_kernel
  .amdhsa_next_free_vgpr 256
  .amdhsa_next_free_sgpr 102
  .amdhsa_accum_offset 256
  .amdhsa_group_segment_fixed_size 0
  .amdhsa_kernarg_size 104
  .amdhsa_user_sgpr_count 2
  .amdhsa_user_sgpr_kernarg_segment_ptr 1
  .amdhsa_system_sgpr_workgroup_id_x 1
.end_amdhsa_kernel
```

```asm
; @launch grid=(256,1,1) block=(512,1,1) lds=157952
.amdgcn_target "amdgcn-amd-amdhsa--gfx950"
.text
.globl sequential_preLN__spectral_fnet__moe_arch_mod__prompt_kernel
.p2align 8
.type sequential_preLN__spectral_fnet__moe_arch_mod__prompt_kernel,@function
sequential_preLN__spectral_fnet__moe_arch_mod__prompt_kernel:
    s_cmp_gt_u32 s2, 255
    s_cbranch_scc1 fk_end
    s_load_dwordx2 s[8:9], s[0:1], 0
    s_load_dwordx2 s[24:25], s[0:1], 96
    s_load_dwordx2 s[32:33], s[0:1], 48
    s_load_dwordx2 s[44:45], s[0:1], 56
    s_load_dwordx2 s[48:49], s[0:1], 64
    s_load_dwordx2 s[52:53], s[0:1], 72
    s_load_dwordx2 s[28:29], s[0:1], 80
    s_getpc_b64 s[40:41]
fk_pc:
    s_mov_b32 s42, fk_end-fk_pc
    s_mov_b32 s43, 0x00020000
    v_lshlrev_b32 v250, 6, v0
    buffer_load_dword v251, v250, s[40:43], 0 offen
    v_lshrrev_b32 v1, 6, v0
    v_and_b32 v15, 63, v0
    v_readfirstlane_b32 s16, v1
    s_and_b32 s3, s2, 0xe0
    s_and_b32 s17, s2, 7
    s_lshl_b32 s17, s17, 2
    s_or_b32 s3, s3, s17
    s_bfe_u32 s17, s2, 0x20003
    s_or_b32 s3, s3, s17
    s_lshr_b32 s17, s3, 4
    s_add_u32 s17, s17, 1
    s_cmp_ge_u32 s3, 248
    s_cselect_b32 s17, 0, s17
    s_cmp_ge_u32 s3, 240
    s_cselect_b32 s18, 7, 15
    s_and_b32 s18, s18, s3
    s_lshl_b32 s18, s18, 7
    s_add_u32 s18, s18, s17
    v_and_b32 v1, 31, v15
    v_lshrrev_b32 v2, 5, v15
    v_lshlrev_b32 v14, 4, v15
    s_mov_b32 s10, 0x400000
    s_mov_b32 s11, 0x00020000
    s_mov_b32 s26, 0x6b8000
    s_mov_b32 s27, 0x00020000
    s_mov_b32 s30, 0x400000
    s_mov_b32 s31, 0x00020000
    s_mov_b32 s34, 0x800
    s_mov_b32 s35, 0x00020000
    s_mov_b32 s46, 0x700000
    s_mov_b32 s47, 0x00020000
    s_mov_b32 s50, 0x700000
    s_mov_b32 s51, 0x00020000
    s_mov_b32 s54, 0x700000
    s_mov_b32 s55, 0x00020000
    s_cmp_eq_u32 s3, 255
    s_cselect_b32 s12, 5, 4
    s_cmp_ge_u32 s16, s12
    s_cbranch_scc1 fk_H
    s_cmp_eq_u32 s16, 4
    s_cbranch_scc1 fk_lowp
    s_setprio 3
fk_lowp:
    s_lshl_b32 s19, s16, 5
    s_add_u32 s19, s19, s18
    s_sub_u32 s20, 2048, s19
    s_and_b32 s20, s20, 2047
    s_lshl_b32 s21, s19, 11
    s_lshl_b32 s22, s20, 11
    s_lshl_b32 s12, s16, 12
    s_add_u32 s12, s12, 98304
    s_mov_b32 m0, s12
    v_mov_b32 v16, 0
    v_mov_b32 v17, 0
    v_mov_b32 v18, 0
    v_mov_b32 v19, 0
    v_mov_b32 v20, 0
    v_mov_b32 v21, 0
    v_mov_b32 v22, 0
    v_mov_b32 v23, 0
    v_mov_b32 v24, 0
    v_mov_b32 v25, 0
    v_mov_b32 v26, 0
    v_mov_b32 v27, 0
    v_mov_b32 v28, 0
    v_mov_b32 v29, 0
    v_mov_b32 v30, 0
    v_mov_b32 v31, 0
    v_mov_b32 v32, 0
    v_mov_b32 v33, 0
    v_mov_b32 v34, 0
    v_mov_b32 v35, 0
    v_mov_b32 v36, 0
    v_mov_b32 v37, 0
    v_mov_b32 v38, 0
    v_mov_b32 v39, 0
    v_mov_b32 v40, 0
    v_mov_b32 v41, 0
    v_mov_b32 v42, 0
    v_mov_b32 v43, 0
    v_mov_b32 v44, 0
    v_mov_b32 v45, 0
    v_mov_b32 v46, 0
    v_mov_b32 v47, 0
    v_cvt_f32_u32 v200, v1
    v_lshlrev_b32 v7, 2, v2
    v_cvt_f32_u32 v7, v7
    v_lshrrev_b32 v8, 1, v1
    v_and_b32 v9, 1, v1
    v_lshlrev_b32 v205, 2, v15
    v_and_b32 v205, 63, v205
    v_add_u32 v205, 157824, v205
    ds_write_b32 v205, v16
    ds_write_b32 v205, v16 offset:64
    s_waitcnt lgkmcnt(0)
    buffer_load_dwordx4 v14, s[8:11], s21 offen lds
    s_add_u32 s13, s12, 1024
    s_mov_b32 m0, s13
    s_add_u32 s14, s21, 1024
    buffer_load_dwordx4 v14, s[8:11], s14 offen lds
    s_add_u32 s13, s12, 2048
    s_mov_b32 m0, s13
    s_nop 0
    buffer_load_dwordx4 v14, s[8:11], s22 offen lds
    s_add_u32 s13, s12, 3072
    s_mov_b32 m0, s13
    s_add_u32 s14, s22, 1024
    buffer_load_dwordx4 v14, s[8:11], s14 offen lds
    s_barrier
    v_add_u32 v206, 138496, v14
    s_lshl_b32 s13, s16, 2
    s_add_u32 s13, s13, 157824
    v_mov_b32 v201, s13
    v_mov_b32 v202, 1
    s_cmp_eq_u32 s16, 1
    s_cbranch_scc1 fk_j1
    s_cmp_eq_u32 s16, 2
    s_cbranch_scc1 fk_j2
    s_cmp_eq_u32 s16, 3
    s_cbranch_scc1 fk_j3
    s_cmp_eq_u32 s16, 4
    s_cbranch_scc1 fk_jend
    v_cmp_eq_u32 vcc, 1, v1
    s_nop 1
    v_cndmask_b32 v10, v8, 16, vcc
    v_cndmask_b32 v11, v9, 0, vcc
    v_cvt_f32_u32 v10, v10
    v_cvt_f32_u32 v11, v11
    v_mul_f32 v10, 0x3d000000, v10
    v_mul_f32 v11, 0x3e800000, v11
    v_add_f32 v12, v7, v7
    v_fma_f32 v11, v10, v12, v11
    v_mov_b32 v128, v11
    v_fmamk_f32 v129, v10, 0x3f800000, v11
    v_fmamk_f32 v130, v10, 0x40000000, v11
    v_fmamk_f32 v131, v10, 0x40400000, v11
    v_fmamk_f32 v132, v10, 0x40800000, v11
    v_fmamk_f32 v133, v10, 0x40a00000, v11
    v_fmamk_f32 v134, v10, 0x40c00000, v11
    v_fmamk_f32 v135, v10, 0x40e00000, v11
    v_fmamk_f32 v136, v10, 0x41800000, v11
    v_fmamk_f32 v137, v10, 0x41880000, v11
    v_fmamk_f32 v138, v10, 0x41900000, v11
    v_fmamk_f32 v139, v10, 0x41980000, v11
    v_fmamk_f32 v140, v10, 0x41a00000, v11
    v_fmamk_f32 v141, v10, 0x41a80000, v11
    v_fmamk_f32 v142, v10, 0x41b00000, v11
    v_fmamk_f32 v143, v10, 0x41b80000, v11
    v_cos_f32 v144, v128
    v_cos_f32 v145, v129
    v_cos_f32 v146, v130
    v_cos_f32 v147, v131
    v_cos_f32 v148, v132
    v_cos_f32 v149, v133
    v_cos_f32 v150, v134
    v_cos_f32 v151, v135
    v_cos_f32 v152, v136
    v_cos_f32 v153, v137
    v_cos_f32 v154, v138
    v_cos_f32 v155, v139
    v_cos_f32 v156, v140
    v_cos_f32 v157, v141
    v_cos_f32 v158, v142
    v_cos_f32 v159, v143
    v_cvt_pk_f16_f32 v48, v144, v145
    v_cvt_pk_f16_f32 v49, v146, v147
    v_cvt_pk_f16_f32 v50, v148, v149
    v_cvt_pk_f16_f32 v51, v150, v151
    v_cvt_pk_f16_f32 v52, v152, v153
    v_cvt_pk_f16_f32 v53, v154, v155
    v_cvt_pk_f16_f32 v54, v156, v157
    v_cvt_pk_f16_f32 v55, v158, v159
    ds_write_b128 v206, v[48:51] offset:0
    ds_write_b128 v206, v[52:55] offset:1024
    s_branch fk_jsig
    s_nop 1
fk_j1:
    v_cvt_f32_u32 v10, v8
    v_lshlrev_b32 v11, 31, v9
    v_mul_f32 v10, 0x3a800000, v10
    v_xor_b32 v10, v11, v10
    v_mul_f32 v11, v10, v7
    v_mov_b32 v128, v11
    v_fmamk_f32 v129, v10, 0x3f800000, v11
    v_fmamk_f32 v130, v10, 0x40000000, v11
    v_fmamk_f32 v131, v10, 0x40400000, v11
    v_fmamk_f32 v132, v10, 0x41000000, v11
    v_fmamk_f32 v133, v10, 0x41100000, v11
    v_fmamk_f32 v134, v10, 0x41200000, v11
    v_fmamk_f32 v135, v10, 0x41300000, v11
    v_fmamk_f32 v136, v10, 0x41800000, v11
    v_fmamk_f32 v137, v10, 0x41880000, v11
    v_fmamk_f32 v138, v10, 0x41900000, v11
    v_fmamk_f32 v139, v10, 0x41980000, v11
    v_fmamk_f32 v140, v10, 0x41c00000, v11
    v_fmamk_f32 v141, v10, 0x41c80000, v11
    v_fmamk_f32 v142, v10, 0x41d00000, v11
    v_fmamk_f32 v143, v10, 0x41d80000, v11
    v_cos_f32 v56, v128
    v_cos_f32 v57, v129
    v_cos_f32 v58, v130
    v_cos_f32 v59, v131
    v_cos_f32 v60, v132
    v_cos_f32 v61, v133
    v_cos_f32 v62, v134
    v_cos_f32 v63, v135
    v_cos_f32 v64, v136
    v_cos_f32 v65, v137
    v_cos_f32 v66, v138
    v_cos_f32 v67, v139
    v_cos_f32 v68, v140
    v_cos_f32 v69, v141
    v_cos_f32 v70, v142
    v_cos_f32 v71, v143
    ds_write_b128 v206, v[56:59] offset:2048
    ds_write_b128 v206, v[60:63] offset:3072
    ds_write_b128 v206, v[64:67] offset:4096
    ds_write_b128 v206, v[68:71] offset:5120
    v_sin_f32 v72, v128
    v_sin_f32 v73, v129
    v_sin_f32 v74, v130
    v_sin_f32 v75, v131
    v_sin_f32 v76, v132
    v_sin_f32 v77, v133
    v_sin_f32 v78, v134
    v_sin_f32 v79, v135
    v_sin_f32 v80, v136
    v_sin_f32 v81, v137
    v_sin_f32 v82, v138
    v_sin_f32 v83, v139
    v_sin_f32 v84, v140
    v_sin_f32 v85, v141
    v_sin_f32 v86, v142
    v_sin_f32 v87, v143
    ds_write_b128 v206, v[72:75] offset:6144
    ds_write_b128 v206, v[76:79] offset:7168
    ds_write_b128 v206, v[80:83] offset:8192
    ds_write_b128 v206, v[84:87] offset:9216
    s_branch fk_jsig
    s_nop 0
fk_j2:
    v_mul_f32 v128, 0x3d000000, v200
    v_mul_f32 v129, v128, v7
    v_mov_b32 v130, v129
    v_fmamk_f32 v131, v128, 0x3f800000, v129
    v_fmamk_f32 v132, v128, 0x40000000, v129
    v_fmamk_f32 v133, v128, 0x40400000, v129
    v_fmamk_f32 v134, v128, 0x41000000, v129
    v_fmamk_f32 v135, v128, 0x41100000, v129
    v_fmamk_f32 v136, v128, 0x41200000, v129
    v_fmamk_f32 v137, v128, 0x41300000, v129
    v_fmamk_f32 v138, v128, 0x41800000, v129
    v_fmamk_f32 v139, v128, 0x41880000, v129
    v_fmamk_f32 v140, v128, 0x41900000, v129
    v_fmamk_f32 v141, v128, 0x41980000, v129
    v_fmamk_f32 v142, v128, 0x41c00000, v129
    v_fmamk_f32 v143, v128, 0x41c80000, v129
    v_fmamk_f32 v144, v128, 0x41d00000, v129
    v_fmamk_f32 v145, v128, 0x41d80000, v129
    v_cos_f32 v146, v130
    v_cos_f32 v147, v131
    v_cos_f32 v148, v132
    v_cos_f32 v149, v133
    v_cos_f32 v150, v134
    v_cos_f32 v151, v135
    v_cos_f32 v152, v136
    v_cos_f32 v153, v137
    v_cos_f32 v154, v138
    v_cos_f32 v155, v139
    v_cos_f32 v156, v140
    v_cos_f32 v157, v141
    v_cos_f32 v158, v142
    v_cos_f32 v159, v143
    v_cos_f32 v160, v144
    v_cos_f32 v161, v145
    v_cvt_pk_f16_f32 v96, v146, v147
    v_cvt_pk_f16_f32 v97, v148, v149
    v_cvt_pk_f16_f32 v98, v150, v151
    v_cvt_pk_f16_f32 v99, v152, v153
    v_cvt_pk_f16_f32 v100, v154, v155
    v_cvt_pk_f16_f32 v101, v156, v157
    v_cvt_pk_f16_f32 v102, v158, v159
    v_cvt_pk_f16_f32 v103, v160, v161
    v_sin_f32 v146, v130
    v_sin_f32 v147, v131
    v_sin_f32 v148, v132
    v_sin_f32 v149, v133
    v_sin_f32 v150, v134
    v_sin_f32 v151, v135
    v_sin_f32 v152, v136
    v_sin_f32 v153, v137
    v_sin_f32 v154, v138
    v_sin_f32 v155, v139
    v_sin_f32 v156, v140
    v_sin_f32 v157, v141
    v_sin_f32 v158, v142
    v_sin_f32 v159, v143
    v_sin_f32 v160, v144
    v_sin_f32 v161, v145
    v_cvt_pk_f16_f32 v104, v146, v147
    v_cvt_pk_f16_f32 v105, v148, v149
    v_cvt_pk_f16_f32 v106, v150, v151
    v_cvt_pk_f16_f32 v107, v152, v153
    v_cvt_pk_f16_f32 v108, v154, v155
    v_cvt_pk_f16_f32 v109, v156, v157
    v_cvt_pk_f16_f32 v110, v158, v159
    v_cvt_pk_f16_f32 v111, v160, v161
    ds_write_b128 v206, v[96:99] offset:12288
    ds_write_b128 v206, v[100:103] offset:13312
    ds_write_b128 v206, v[104:107] offset:14336
    ds_write_b128 v206, v[108:111] offset:15360
    s_branch fk_jsig
    s_nop 0
fk_j3:
    v_or_b32 v10, 16, v1
    v_cvt_f32_u32 v10, v10
    v_mov_b32 v11, 0x3c800000
    v_fmamk_f32 v10, v10, 0x3d000000, v11
    v_cmp_gt_u32 vcc, 16, v1
    v_mov_b32 v12, 0xbe800000
    s_nop 0
    v_cndmask_b32 v12, 0, v12, vcc
    v_fma_f32 v11, v10, v7, v12
    v_mov_b32 v128, v11
    v_fmamk_f32 v129, v10, 0x3f800000, v11
    v_fmamk_f32 v130, v10, 0x40000000, v11
    v_fmamk_f32 v131, v10, 0x40400000, v11
    v_fmamk_f32 v132, v10, 0x41000000, v11
    v_fmamk_f32 v133, v10, 0x41100000, v11
    v_fmamk_f32 v134, v10, 0x41200000, v11
    v_fmamk_f32 v135, v10, 0x41300000, v11
    v_fmamk_f32 v136, v10, 0x41800000, v11
    v_fmamk_f32 v137, v10, 0x41880000, v11
    v_fmamk_f32 v138, v10, 0x41900000, v11
    v_fmamk_f32 v139, v10, 0x41980000, v11
    v_fmamk_f32 v140, v10, 0x41c00000, v11
    v_fmamk_f32 v141, v10, 0x41c80000, v11
    v_fmamk_f32 v142, v10, 0x41d00000, v11
    v_fmamk_f32 v143, v10, 0x41d80000, v11
    v_cos_f32 v144, v128
    v_cos_f32 v145, v129
    v_cos_f32 v146, v130
    v_cos_f32 v147, v131
    v_cos_f32 v148, v132
    v_cos_f32 v149, v133
    v_cos_f32 v150, v134
    v_cos_f32 v151, v135
    v_cos_f32 v152, v136
    v_cos_f32 v153, v137
    v_cos_f32 v154, v138
    v_cos_f32 v155, v139
    v_cos_f32 v156, v140
    v_cos_f32 v157, v141
    v_cos_f32 v158, v142
    v_cos_f32 v159, v143
    v_cvt_pk_f16_f32 v88, v144, v145
    v_cvt_pk_f16_f32 v89, v146, v147
    v_cvt_pk_f16_f32 v90, v148, v149
    v_cvt_pk_f16_f32 v91, v150, v151
    v_cvt_pk_f16_f32 v92, v152, v153
    v_cvt_pk_f16_f32 v93, v154, v155
    v_cvt_pk_f16_f32 v94, v156, v157
    v_cvt_pk_f16_f32 v95, v158, v159
    ds_write_b128 v206, v[88:91] offset:10240
    ds_write_b128 v206, v[92:95] offset:11264
    s_nop 2
fk_jsig:
    ds_write_b32 v201, v202 offset:32
fk_jend:
    v_lshlrev_b32 v3, 9, v2
    v_lshl_add_u32 v3, v1, 1, v3
    v_sub_u32 v4, 576, v3
    v_sub_u32 v5, 2048, v3
    v_and_b32 v5, 2047, v5
    v_add_u32 v3, s12, v3
    v_add_u32 v4, s12, v4
    v_add_u32 v5, s12, v5
    s_lshl_b32 s13, s16, 10
    s_sub_u32 s14, 7232, s13
    s_cmp_ge_u32 s3, 248
    s_cselect_b32 s15, 1024, 0
    s_add_u32 s14, s14, s15
    s_cmp_eq_u32 s14, 8256
    s_cselect_b32 s14, 4160, s14
    s_cmp_eq_u32 s19, s20
    s_cselect_b32 s14, 8256, s14
    s_cmp_eq_u32 s16, 4
    s_cselect_b32 s13, 8256, s13
    s_cmp_lg_u32 s19, 0
    s_cbranch_scc1 fk_noz
    v_add_u32 v8, 124992, v14
    ds_write_b128 v8, v[16:19]
fk_noz:
    s_add_u32 s13, s13, 120832
    s_add_u32 s14, s14, 120832
    v_cmp_gt_u32 vcc, 16, v1
    v_mov_b32 v8, s13
    v_mov_b32 v9, s14
    v_cndmask_b32 v10, v9, v8, vcc
    v_cndmask_b32 v11, v8, v9, vcc
    v_lshl_add_u32 v10, v15, 2, v10
    v_lshl_add_u32 v11, v15, 2, v11
    v_lshrrev_b32 v6, 1, v15
    v_and_b32 v8, 1, v15
    v_mul_u32_u24 v9, 4160, v8
    v_and_b32 v12, 15, v6
    v_lshl_add_u32 v12, v12, 4, v2
    v_mul_u32_u24 v12, 9344, v12
    v_mul_u32_u24 v192, 18688, v8
    v_add_u32 v192, v192, v12
    v_lshl_add_u32 v12, v8, 4, v12
    v_lshrrev_b32 v194, 3, v15
    v_lshlrev_b32 v193, 4, v194
    v_lshl_add_u32 v193, v8, 7, v193
    v_and_b32 v6, 3, v6
    v_lshl_add_u32 v9, v6, 2, v9
    v_lshl_add_u32 v9, v194, 7, v9
    v_lshlrev_b32 v194, 10, v194
    v_and_b32 v6, 7, v15
    v_lshl_add_u32 v194, v6, 4, v194
    s_lshl_b32 s13, s16, 5
    s_add_u32 s13, s13, 120832
    v_add_u32 v6, s13, v9
    s_mul_i32 s36, s3, 9344
    s_lshl_b32 s13, s16, 8
    s_add_u32 s36, s36, s13
    s_add_u32 s36, s36, 0x20000
    s_mul_i32 s37, s16, 37376
    s_add_u32 s37, s37, 0x20000
    s_bfe_u32 s23, s3, 0x30002
    s_lshl_b32 s23, s23, 7
    s_lshr_b32 s12, s3, 5
    s_lshl_b32 s12, s12, 4
    s_add_u32 s23, s23, s12
    s_and_b32 s12, s3, 3
    s_lshl_b32 s12, s12, 2
    s_add_u32 s23, s23, s12
    s_add_u32 s23, s23, 8192
    s_add_u32 s23, s23, s37
    s_lshl_b32 s14, s3, 5
    s_add_u32 s37, s37, s14
    s_add_u32 s38, s37, 18688
    s_lshl_b32 s13, s16, 11
    s_add_u32 s13, s13, 130304
    v_add_u32 v7, s13, v14
    v_cmp_eq_u32 s[58:59], 1, v8
    s_cmp_eq_u32 s19, s20
    s_cselect_b32 s39, 0.5, 1.0
    s_lshl_b32 s13, s16, 2
    s_add_u32 s13, s13, 157056
    v_mov_b32 v9, s13
    s_mov_b32 s57, 47
    s_nop 3
fk_spinc:
    ds_read_b32 v203, v205
    s_waitcnt lgkmcnt(0)
    v_cmp_eq_u32 vcc, 0, v203
    s_nop 1
    s_and_b32 s13, vcc_lo, 0xf00
    s_cbranch_scc1 fk_spinc
    ds_read_b128 v[48:51], v206 offset:0
    ds_read_b128 v[52:55], v206 offset:1024
    ds_read_b128 v[56:59], v206 offset:2048
    ds_read_b128 v[60:63], v206 offset:3072
    ds_read_b128 v[64:67], v206 offset:4096
    ds_read_b128 v[68:71], v206 offset:5120
    ds_read_b128 v[72:75], v206 offset:6144
    ds_read_b128 v[76:79], v206 offset:7168
    ds_read_b128 v[80:83], v206 offset:8192
    ds_read_b128 v[84:87], v206 offset:9216
    ds_read_b128 v[88:91], v206 offset:10240
    ds_read_b128 v[92:95], v206 offset:11264
    s_waitcnt lgkmcnt(8)
    ds_read_b128 v[96:99], v206 offset:12288
    ds_read_b128 v[100:103], v206 offset:13312
    ds_read_b128 v[104:107], v206 offset:14336
    ds_read_b128 v[108:111], v206 offset:15360
    s_waitcnt vmcnt(0) lgkmcnt(0)
    ds_read_u16_d16_hi v16, v3 offset:0
    ds_read_u16_d16_hi v17, v3 offset:64
    ds_read_u16_d16_hi v18, v3 offset:128
    ds_read_u16_d16_hi v19, v3 offset:192
    ds_read_u16_d16_hi v20, v3 offset:256
    ds_read_u16_d16_hi v21, v3 offset:320
    ds_read_u16_d16_hi v22, v3 offset:384
    ds_read_u16_d16_hi v23, v3 offset:448
    ds_read_u16_d16_hi v24, v3 offset:1024
    ds_read_u16_d16_hi v25, v3 offset:1088
    ds_read_u16_d16_hi v26, v3 offset:1152
    ds_read_u16_d16_hi v27, v3 offset:1216
    ds_read_u16_d16_hi v28, v3 offset:1280
    ds_read_u16_d16_hi v29, v3 offset:1344
    ds_read_u16_d16_hi v30, v3 offset:1408
    ds_read_u16_d16_hi v31, v3 offset:1472
    s_waitcnt lgkmcnt(2)
    ds_read_u16_d16_hi v32, v5 offset:2048
    ds_read_u16_d16_hi v33, v4 offset:3456
    ds_read_u16_d16_hi v34, v4 offset:3392
    ds_read_u16_d16_hi v35, v4 offset:3328
    ds_read_u16_d16_hi v36, v4 offset:3264
    ds_read_u16_d16_hi v37, v4 offset:3200
    ds_read_u16_d16_hi v38, v4 offset:3136
    ds_read_u16_d16_hi v39, v4 offset:3072
    ds_read_u16_d16_hi v40, v4 offset:2496
    ds_read_u16_d16_hi v41, v4 offset:2432
    ds_read_u16_d16_hi v42, v4 offset:2368
    ds_read_u16_d16_hi v43, v4 offset:2304
    ds_read_u16_d16_hi v44, v4 offset:2240
    s_waitcnt lgkmcnt(8)
    ds_read_u16_d16_hi v45, v4 offset:2176
    ds_read_u16_d16_hi v46, v4 offset:2112
    ds_read_u16_d16_hi v47, v4 offset:2048
    v_pk_add_f32 v[128:129], v[16:17], v[18:19]
    v_pk_add_f32 v[130:131], v[20:21], v[22:23]
    v_pk_add_f32 v[132:133], v[24:25], v[26:27]
    v_pk_add_f32 v[134:135], v[28:29], v[30:31]
    v_pk_mul_f32 v[136:137], v[16:17], v[16:17]
    v_pk_mul_f32 v[138:139], v[18:19], v[18:19]
    v_pk_fma_f32 v[136:137], v[20:21], v[20:21], v[136:137]
    v_pk_fma_f32 v[138:139], v[22:23], v[22:23], v[138:139]
    v_pk_fma_f32 v[136:137], v[24:25], v[24:25], v[136:137]
    v_pk_fma_f32 v[138:139], v[26:27], v[26:27], v[138:139]
    v_pk_fma_f32 v[136:137], v[28:29], v[28:29], v[136:137]
    v_pk_fma_f32 v[138:139], v[30:31], v[30:31], v[138:139]
    v_pk_add_f32 v[128:129], v[128:129], v[130:131]
    v_pk_add_f32 v[132:133], v[132:133], v[134:135]
    v_pk_add_f32 v[136:137], v[136:137], v[138:139]
    v_pk_add_f32 v[128:129], v[128:129], v[132:133]
    v_add_f32 v136, v136, v137
    v_add_f32 v128, v128, v129
    s_waitcnt lgkmcnt(0)
    v_pk_add_f32 v[140:141], v[32:33], v[34:35]
    v_pk_add_f32 v[142:143], v[36:37], v[38:39]
    v_pk_add_f32 v[144:145], v[40:41], v[42:43]
    v_pk_add_f32 v[146:147], v[44:45], v[46:47]
    v_pk_mul_f32 v[148:149], v[32:33], v[32:33]
    v_pk_mul_f32 v[150:151], v[34:35], v[34:35]
    v_pk_fma_f32 v[148:149], v[36:37], v[36:37], v[148:149]
    v_pk_fma_f32 v[150:151], v[38:39], v[38:39], v[150:151]
    v_pk_fma_f32 v[148:149], v[40:41], v[40:41], v[148:149]
    v_pk_fma_f32 v[150:151], v[42:43], v[42:43], v[150:151]
    v_pk_fma_f32 v[148:149], v[44:45], v[44:45], v[148:149]
    v_pk_fma_f32 v[150:151], v[46:47], v[46:47], v[150:151]
    v_pk_add_f32 v[140:141], v[140:141], v[142:143]
    v_pk_add_f32 v[144:145], v[144:145], v[146:147]
    v_pk_add_f32 v[148:149], v[148:149], v[150:151]
    v_pk_add_f32 v[140:141], v[140:141], v[144:145]
    v_add_f32 v148, v148, v149
    v_add_f32 v140, v140, v141
    s_nop 1
    v_permlane32_swap_b32 v128, v140
    v_permlane32_swap_b32 v136, v148
    v_add_f32 v128, v128, v140
    v_add_f32 v136, v136, v148
    s_nop 1
    v_permlane16_swap_b32 v128, v136
    v_add_f32 v128, v128, v136
    s_nop 1
    v_add_f32_dpp v128, v128, v128 quad_perm:[1,0,3,2] row_mask:0xf bank_mask:0xf
    s_nop 1
    v_add_f32_dpp v128, v128, v128 quad_perm:[2,3,0,1] row_mask:0xf bank_mask:0xf
    s_nop 1
    v_add_f32_dpp v128, v128, v128 row_half_mirror row_mask:0xf bank_mask:0xf
    s_nop 1
    v_add_f32_dpp v128, v128, v128 row_mirror row_mask:0xf bank_mask:0xf
    s_nop 1
    v_mov_b32_dpp v129, v128 row_bcast:15 row_mask:0xa bank_mask:0xf
    v_mul_f32 v130, 0x3a800000, v128
    v_mul_f32 v129, 0x3a800000, v129
    v_fma_f32 v130, -v129, v129, v130
    v_max_f32 v130, 0, v130
    v_cvt_pk_bf16_f32 v130, 0, v130
    v_cvt_pk_bf16_f32 v129, 0, v129
    v_add_f32 v130, 0x3727c5ac, v130
    v_cvt_pk_bf16_f32 v130, 0, v130
    v_sqrt_f32 v130, v130
    s_nop 0
    v_cvt_pk_bf16_f32 v130, 0, v130
    v_rcp_f32 v130, v130
    s_nop 0
    v_mul_f32 v130, 0x3c000000, v130
    v_mul_f32 v129, v129, v130
    v_readlane_b32 s4, v130, 16
    v_readlane_b32 s6, v130, 48
    v_readlane_b32 s13, v129, 16
    v_readlane_b32 s14, v129, 48
    s_nop 0
    v_mov_b32 v132, s13
    v_add_f32 v132, s14, v132
    v_pk_fma_f32 v[32:33], v[32:33], s[6:7], v[132:133] op_sel_hi:[1,0,0] neg_lo:[0,0,1] neg_hi:[0,0,1]
    v_pk_fma_f32 v[34:35], v[34:35], s[6:7], v[132:133] op_sel_hi:[1,0,0] neg_lo:[0,0,1] neg_hi:[0,0,1]
    v_pk_fma_f32 v[36:37], v[36:37], s[6:7], v[132:133] op_sel_hi:[1,0,0] neg_lo:[0,0,1] neg_hi:[0,0,1]
    v_pk_fma_f32 v[38:39], v[38:39], s[6:7], v[132:133] op_sel_hi:[1,0,0] neg_lo:[0,0,1] neg_hi:[0,0,1]
    v_pk_fma_f32 v[40:41], v[40:41], s[6:7], v[132:133] op_sel_hi:[1,0,0] neg_lo:[0,0,1] neg_hi:[0,0,1]
    v_pk_fma_f32 v[42:43], v[42:43], s[6:7], v[132:133] op_sel_hi:[1,0,0] neg_lo:[0,0,1] neg_hi:[0,0,1]
    v_pk_fma_f32 v[44:45], v[44:45], s[6:7], v[132:133] op_sel_hi:[1,0,0] neg_lo:[0,0,1] neg_hi:[0,0,1]
    v_pk_fma_f32 v[46:47], v[46:47], s[6:7], v[132:133] op_sel_hi:[1,0,0] neg_lo:[0,0,1] neg_hi:[0,0,1]
    v_pk_fma_f32 v[16:17], v[16:17], s[4:5], v[32:33] op_sel_hi:[1,0,1]
    v_pk_fma_f32 v[18:19], v[18:19], s[4:5], v[34:35] op_sel_hi:[1,0,1]
    v_pk_fma_f32 v[20:21], v[20:21], s[4:5], v[36:37] op_sel_hi:[1,0,1]
    v_pk_fma_f32 v[22:23], v[22:23], s[4:5], v[38:39] op_sel_hi:[1,0,1]
    v_pk_fma_f32 v[24:25], v[24:25], s[4:5], v[40:41] op_sel_hi:[1,0,1]
    v_pk_fma_f32 v[26:27], v[26:27], s[4:5], v[42:43] op_sel_hi:[1,0,1]
    v_pk_fma_f32 v[28:29], v[28:29], s[4:5], v[44:45] op_sel_hi:[1,0,1]
    v_pk_fma_f32 v[30:31], v[30:31], s[4:5], v[46:47] op_sel_hi:[1,0,1]
    v_cvt_pk_f16_f32 v176, v16, v17
    v_cvt_pk_f16_f32 v177, v18, v19
    v_cvt_pk_f16_f32 v178, v20, v21
    v_cvt_pk_f16_f32 v179, v22, v23
    v_cvt_pk_f16_f32 v180, v24, v25
    v_cvt_pk_f16_f32 v181, v26, v27
    v_cvt_pk_f16_f32 v182, v28, v29
    v_cvt_pk_f16_f32 v183, v30, v31
    v_mfma_f32_32x32x16_f16 v[112:127], v[176:179], v[48:51], 0
    s_nop 0
    v_mfma_f32_32x32x16_f16 v[112:127], v[180:183], v[52:55], v[112:127]
    s_nop 11
    v_pk_mul_f32 v[16:17], v[112:113], v[56:57]
    v_pk_mul_f32 v[18:19], v[114:115], v[58:59]
    v_pk_mul_f32 v[20:21], v[116:117], v[60:61]
    v_pk_mul_f32 v[22:23], v[118:119], v[62:63]
    v_pk_mul_f32 v[24:25], v[120:121], v[64:65]
    v_pk_mul_f32 v[26:27], v[122:123], v[66:67]
    v_pk_mul_f32 v[28:29], v[124:125], v[68:69]
    v_pk_mul_f32 v[30:31], v[126:127], v[70:71]
    v_fmac_f32_dpp v16, v112, v72 quad_perm:[1,0,3,2] row_mask:0xf bank_mask:0xf
    v_fmac_f32_dpp v17, v113, v73 quad_perm:[1,0,3,2] row_mask:0xf bank_mask:0xf
    v_fmac_f32_dpp v18, v114, v74 quad_perm:[1,0,3,2] row_mask:0xf bank_mask:0xf
    v_fmac_f32_dpp v19, v115, v75 quad_perm:[1,0,3,2] row_mask:0xf bank_mask:0xf
    v_fmac_f32_dpp v20, v116, v76 quad_perm:[1,0,3,2] row_mask:0xf bank_mask:0xf
    v_fmac_f32_dpp v21, v117, v77 quad_perm:[1,0,3,2] row_mask:0xf bank_mask:0xf
    v_fmac_f32_dpp v22, v118, v78 quad_perm:[1,0,3,2] row_mask:0xf bank_mask:0xf
    v_fmac_f32_dpp v23, v119, v79 quad_perm:[1,0,3,2] row_mask:0xf bank_mask:0xf
    v_cvt_pk_f16_f32 v176, v16, v17
    v_cvt_pk_f16_f32 v177, v18, v19
    v_cvt_pk_f16_f32 v178, v20, v21
    v_cvt_pk_f16_f32 v179, v22, v23
    v_fmac_f32_dpp v24, v120, v80 quad_perm:[1,0,3,2] row_mask:0xf bank_mask:0xf
    v_fmac_f32_dpp v25, v121, v81 quad_perm:[1,0,3,2] row_mask:0xf bank_mask:0xf
    v_mfma_f32_32x32x16_f16 v[128:143], v[176:179], v[96:99], 0
    v_fmac_f32_dpp v26, v122, v82 quad_perm:[1,0,3,2] row_mask:0xf bank_mask:0xf
    v_fmac_f32_dpp v27, v123, v83 quad_perm:[1,0,3,2] row_mask:0xf bank_mask:0xf
    v_fmac_f32_dpp v28, v124, v84 quad_perm:[1,0,3,2] row_mask:0xf bank_mask:0xf
    v_fmac_f32_dpp v29, v125, v85 quad_perm:[1,0,3,2] row_mask:0xf bank_mask:0xf
    v_mfma_f32_32x32x16_f16 v[144:159], v[176:179], v[104:107], 0
    v_fmac_f32_dpp v30, v126, v86 quad_perm:[1,0,3,2] row_mask:0xf bank_mask:0xf
    v_fmac_f32_dpp v31, v127, v87 quad_perm:[1,0,3,2] row_mask:0xf bank_mask:0xf
    v_cvt_pk_f16_f32 v180, v24, v25
    v_cvt_pk_f16_f32 v181, v26, v27
    v_mfma_f32_32x32x16_f16 v[160:175], v[176:179], v[88:91], 0
    v_cvt_pk_f16_f32 v182, v28, v29
    v_cvt_pk_f16_f32 v183, v30, v31
    s_nop 1
    v_mfma_f32_32x32x16_f16 v[128:143], v[180:183], v[100:103], v[128:143]
    v_mfma_f32_32x32x16_f16 v[144:159], v[180:183], v[108:111], v[144:159]
    v_mfma_f32_32x32x16_f16 v[160:175], v[180:183], v[92:95], v[160:175]
    v_cmp_gt_u32 vcc, 16, v15
    v_cmp_gt_u32 s[40:41], 32, v15
    s_nop 8
    v_pk_add_f32 v[20:21], v[132:133], v[148:149] op_sel:[0,1] op_sel_hi:[1,0] neg_hi:[0,1]
    v_pk_add_f32 v[22:23], v[134:135], v[150:151] op_sel:[0,1] op_sel_hi:[1,0] neg_hi:[0,1]
    v_pk_add_f32 v[36:37], v[20:21], v[22:23] op_sel:[0,1] op_sel_hi:[1,0] neg_lo:[0,1]
    v_pk_add_f32 v[38:39], v[20:21], v[22:23] op_sel:[0,1] op_sel_hi:[1,0] neg_hi:[1,0]
    v_cvt_pk_f16_f32 v178, v36, v37
    v_cvt_pk_f16_f32 v179, v38, v39
    ds_write_b32 v10, v178 offset:256
    ds_write_b32 v11, v179 offset:256
    v_pk_add_f32 v[24:25], v[136:137], v[152:153] op_sel:[0,1] op_sel_hi:[1,0] neg_hi:[0,1]
    v_pk_add_f32 v[26:27], v[138:139], v[154:155] op_sel:[0,1] op_sel_hi:[1,0] neg_hi:[0,1]
    v_pk_add_f32 v[40:41], v[24:25], v[26:27] op_sel:[0,1] op_sel_hi:[1,0] neg_lo:[0,1]
    v_pk_add_f32 v[42:43], v[24:25], v[26:27] op_sel:[0,1] op_sel_hi:[1,0] neg_hi:[1,0]
    v_cvt_pk_f16_f32 v180, v40, v41
    v_cvt_pk_f16_f32 v181, v42, v43
    ds_write_b32 v10, v180 offset:512
    ds_write_b32 v11, v181 offset:512
    v_pk_add_f32 v[28:29], v[140:141], v[156:157] op_sel:[0,1] op_sel_hi:[1,0] neg_hi:[0,1]
    v_pk_add_f32 v[30:31], v[142:143], v[158:159] op_sel:[0,1] op_sel_hi:[1,0] neg_hi:[0,1]
    v_pk_add_f32 v[44:45], v[28:29], v[30:31] op_sel:[0,1] op_sel_hi:[1,0] neg_lo:[0,1]
    v_pk_add_f32 v[46:47], v[28:29], v[30:31] op_sel:[0,1] op_sel_hi:[1,0] neg_hi:[1,0]
    v_cvt_pk_f16_f32 v182, v44, v45
    v_cvt_pk_f16_f32 v183, v46, v47
    ds_write_b32 v10, v182 offset:768
    ds_write_b32 v11, v183 offset:768
    v_pk_add_f32 v[16:17], v[128:129], v[144:145] op_sel:[0,1] op_sel_hi:[1,0] neg_hi:[0,1]
    v_pk_add_f32 v[18:19], v[130:131], v[146:147] op_sel:[0,1] op_sel_hi:[1,0] neg_hi:[0,1]
    v_mul_f32 v8, s39, v128
    v_mov_b32 v3, v161
    s_nop 1
    v_permlane16_swap_b32 v4, v3
    v_cndmask_b32 v5, v161, v128, vcc
    v_cndmask_b32 v4, v4, v144, vcc
    v_cndmask_b32 v16, v16, v5, s[40:41]
    v_cndmask_b32 v17, v17, -v4, s[40:41]
    v_pk_add_f32 v[32:33], v[16:17], v[18:19] op_sel:[0,1] op_sel_hi:[1,0] neg_lo:[0,1]
    v_pk_add_f32 v[34:35], v[16:17], v[18:19] op_sel:[0,1] op_sel_hi:[1,0] neg_hi:[1,0]
    v_cvt_pk_f16_f32 v176, v32, v33
    v_cvt_pk_f16_f32 v177, v34, v35
    ds_write_b32 v10, v176 offset:0
    ds_write_b32 v11, v177 offset:0
    s_mov_b64 exec, 0x10000
    ds_write_b32 v9, v8
    ds_write_b32 v201, v202
    s_mov_b64 exec, -1
    s_cmp_eq_u32 s16, 4
    s_cbranch_scc1 fk_w4
    s_nop 0
fk_spin:
    ds_read_b32 v3, v205
    s_waitcnt lgkmcnt(0)
    v_cmp_eq_u32 vcc, 0, v3
    s_nop 1
    s_and_b32 s13, vcc_lo, s57
    s_cbranch_scc1 fk_spin
    s_nop 0
fk_staged:
    ds_read2st64_b32 v[184:185], v6 offset0:0 offset1:4
    ds_read2st64_b32 v[186:187], v6 offset0:8 offset1:12
    v_add_u32 v8, 16, v6
    ds_read2st64_b32 v[188:189], v8 offset0:0 offset1:4
    ds_read2st64_b32 v[190:191], v8 offset0:8 offset1:12
    v_readlane_b32 s43, v3, 7
    s_waitcnt lgkmcnt(2)
    buffer_store_dwordx4 v[184:187], v194, s[24:27], s36 offen offset:0 sc1
    s_waitcnt lgkmcnt(0)
    buffer_store_dwordx4 v[188:191], v194, s[24:27], s36 offen offset:128 sc1
    v_add3_u32 v3, v184, v185, v186
    v_add_u32 v3, v3, v187
    v_add3_u32 v4, v188, v189, v190
    v_add_u32 v4, v4, v191
    s_add_u32 s36, s36, 8192
    v_add_u32_dpp v3, v3, v3 quad_perm:[1,0,3,2] row_mask:0xf bank_mask:0xf
    v_add_u32_dpp v4, v4, v4 quad_perm:[1,0,3,2] row_mask:0xf bank_mask:0xf
    v_cndmask_b32 v3, v3, v4, s[58:59]
    v_add_u32 v196, s43, v3
    s_nop 1
    v_mov_b32_dpp v197, v196 row_shl:2 row_mask:0xf bank_mask:0xf
    v_mov_b32_dpp v198, v196 row_shl:4 row_mask:0xf bank_mask:0xf
    v_mov_b32_dpp v199, v196 row_shl:6 row_mask:0xf bank_mask:0xf
    s_mov_b32 exec_lo, 0x03030303
    s_mov_b32 exec_hi, 0x03030303
    buffer_store_dwordx4 v[196:199], v193, s[24:27], s36 offen sc1
    s_mov_b64 exec, -1
    s_cmp_lg_u32 s16, 0
    s_cbranch_scc1 fk_nog5
    v_and_b32 v9, 16, v14
    v_add_u32 v9, 157056, v9
    ds_read_b128 v[16:19], v9
    s_lshl_b32 s13, s3, 4
    s_add_u32 s13, s13, 0x11000
    s_nop 1
fk_g5s:
    ds_read_b32 v3, v205
    s_waitcnt lgkmcnt(0)
    v_cmp_eq_u32 vcc, 0, v3
    s_nop 1
    s_and_b32 s14, vcc_lo, 64
    s_cbranch_scc1 fk_g5s
    v_min_u32 v16, -2, v16
    v_min_u32 v17, -2, v17
    v_min_u32 v18, -2, v18
    v_min_u32 v19, -2, v19
    s_mov_b64 exec, 1
    buffer_store_dwordx4 v[16:19], v14, s[24:27], s13 offen sc1
    s_mov_b64 exec, -1
    s_nop 1
fk_nog5:
    v_lshrrev_b32 v208, 3, v15
    v_and_b32 v209, 7, v15
    v_and_b32 v210, 2, v208
    v_xor_b32 v209, v210, v209
    v_mul_u32_u24 v208, 7168, v208
    v_lshl_add_u32 v208, v209, 4, v208
    v_lshrrev_b32 v210, 5, v15
    v_lshlrev_b32 v210, 11, v210
    v_and_b32 v209, 31, v15
    v_lshl_add_u32 v210, v209, 4, v210
    s_and_b32 s12, s3, 3
    s_mul_i32 s100, s12, 1835008
    s_lshl_b32 s101, s12, 9
    s_lshr_b32 s12, s3, 2
    s_lshl_b32 s12, s12, 7
    s_add_u32 s100, s100, s12
    s_lshl_b32 s12, s12, 10
    s_add_u32 s101, s101, s12
    s_xor_b32 s99, s100, 0
    s_mov_b64 s[4:5], s[58:59]
    s_cmp_gt_u32 s3, 223
    s_cbranch_scc1 fk_win1
    s_mul_i32 s15, s16, 3
    s_add_u32 s15, s15, 12
    s_mov_b32 s58, 0x700000
    s_mov_b32 s59, 0x00020000
    s_cmp_gt_u32 s15, 95
    s_cbranch_scc1 fk_win1
    s_lshl_b32 s12, s15, 10
    s_mov_b32 m0, s12
    s_and_b32 s14, s12, 1024
    s_lshr_b32 s14, s14, 4
    v_xor_b32 v209, s14, v208
    s_cmp_lt_u32 s15, 32
    s_cselect_b64 s[56:57], s[44:45], s[48:49]
    s_cselect_b32 s12, s100, s99
    s_and_b32 s14, s15, 31
    s_mul_i32 s13, s14, 57344
    s_add_u32 s13, s13, s12
    s_lshl_b32 s14, s14, 12
    s_add_u32 s14, s14, s101
    s_cmp_lt_u32 s15, 64
    s_cselect_b64 s[56:57], s[56:57], s[52:53]
    s_cselect_b32 s13, s13, s14
    s_cselect_b64 vcc, -1, 0
    v_cndmask_b32 v209, v210, v209, vcc
    s_add_u32 s15, s15, 1
    buffer_load_dwordx4 v209, s[56:59], s13 offen lds
    s_cmp_gt_u32 s15, 95
    s_cbranch_scc1 fk_win1
    s_lshl_b32 s12, s15, 10
    s_mov_b32 m0, s12
    s_and_b32 s14, s12, 1024
    s_lshr_b32 s14, s14, 4
    v_xor_b32 v209, s14, v208
    s_cmp_lt_u32 s15, 32
    s_cselect_b64 s[56:57], s[44:45], s[48:49]
    s_cselect_b32 s12, s100, s99
    s_and_b32 s14, s15, 31
    s_mul_i32 s13, s14, 57344
    s_add_u32 s13, s13, s12
    s_lshl_b32 s14, s14, 12
    s_add_u32 s14, s14, s101
    s_cmp_lt_u32 s15, 64
    s_cselect_b64 s[56:57], s[56:57], s[52:53]
    s_cselect_b32 s13, s13, s14
    s_cselect_b64 vcc, -1, 0
    v_cndmask_b32 v209, v210, v209, vcc
    s_add_u32 s15, s15, 1
    buffer_load_dwordx4 v209, s[56:59], s13 offen lds
    s_cmp_gt_u32 s15, 95
    s_cbranch_scc1 fk_win1
    s_lshl_b32 s12, s15, 10
    s_mov_b32 m0, s12
    s_and_b32 s14, s12, 1024
    s_lshr_b32 s14, s14, 4
    v_xor_b32 v209, s14, v208
    s_cmp_lt_u32 s15, 32
    s_cselect_b64 s[56:57], s[44:45], s[48:49]
    s_cselect_b32 s12, s100, s99
    s_and_b32 s14, s15, 31
    s_mul_i32 s13, s14, 57344
    s_add_u32 s13, s13, s12
    s_lshl_b32 s14, s14, 12
    s_add_u32 s14, s14, s101
    s_cmp_lt_u32 s15, 64
    s_cselect_b64 s[56:57], s[56:57], s[52:53]
    s_cselect_b32 s13, s13, s14
    s_cselect_b64 vcc, -1, 0
    v_cndmask_b32 v209, v210, v209, vcc
    s_add_u32 s15, s15, 1
    buffer_load_dwordx4 v209, s[56:59], s13 offen lds
    s_nop 2
fk_win1:
    s_mov_b32 s42, 0
    s_waitcnt vmcnt(0)
    s_nop 0
fk_pollw:
    buffer_load_dwordx4 v[184:187], v12, s[24:27], s37 offen sc1
    buffer_load_dwordx4 v[188:191], v12, s[24:27], s38 offen sc1
    buffer_load_dword v5, v192, s[24:27], s23 offen sc1
    s_waitcnt vmcnt(1)
    v_add3_u32 v3, v184, v185, v186
    v_add_u32 v3, v3, v187
    v_add3_u32 v4, v188, v189, v190
    v_add_u32 v4, v4, v191
    ds_write_b128 v7, v[184:187]
    v_add_u32_dpp v3, v3, v3 quad_perm:[1,0,3,2] row_mask:0xf bank_mask:0xf
    v_add_u32_dpp v4, v4, v4 quad_perm:[1,0,3,2] row_mask:0xf bank_mask:0xf
    ds_write_b128 v7, v[188:191] offset:1024
    v_cndmask_b32 v3, v3, v4, s[4:5]
    v_add_u32 v3, s43, v3
    s_waitcnt vmcnt(0)
    v_cmp_ne_u32 vcc, v3, v5
    s_add_u32 s42, s42, 1
    s_cbranch_vccz fk_gotw
    s_cmp_le_u32 s42, 0x40000
    s_cbranch_scc1 fk_pollw
    s_nop 0
fk_gotw:
    s_waitcnt lgkmcnt(0)
    s_barrier
    s_setprio 0
    s_or_b32 s13, s3, s16
    s_cbranch_scc1 fk_nobump
    v_mov_b32 v3, s43
    s_mov_b64 exec, 1
    buffer_store_dword v3, v14, s[24:27], 0 offen sc1
    s_mov_b64 exec, -1
    s_nop 1
fk_nobump:
    s_lshl_b32 s13, s16, 10
    s_add_u32 s14, s13, 0x11000
    s_add_u32 s13, s13, 114688
    v_add_u32 v7, s13, v14
    v_mov_b32 v3, 4096
    s_mov_b32 s15, 0x11000
    v_mov_b32 v8, 157152
    buffer_load_dwordx4 v[184:187], v14, s[24:27], s14 offen sc1
    buffer_load_dword v188, v3, s[24:27], s15 offen sc1
    s_mov_b32 s40, s14
    s_mov_b32 s41, s15
    s_cmp_gt_u32 s3, 223
    s_cbranch_scc1 fk_win2
    s_mul_i32 s15, s16, 4
    s_add_u32 s15, s15, 24
    s_cmp_ge_u32 s15, 32
    s_cselect_b32 s12, 32, 0
    s_add_u32 s15, s15, s12
    s_mov_b32 s58, 0x700000
    s_mov_b32 s59, 0x00020000
    s_cmp_gt_u32 s15, 95
    s_cbranch_scc1 fk_win2
    s_lshl_b32 s12, s15, 10
    s_mov_b32 m0, s12
    s_and_b32 s14, s12, 1024
    s_lshr_b32 s14, s14, 4
    v_xor_b32 v209, s14, v208
    s_cmp_lt_u32 s15, 32
    s_cselect_b64 s[56:57], s[44:45], s[48:49]
    s_cselect_b32 s12, s100, s99
    s_and_b32 s14, s15, 31
    s_mul_i32 s13, s14, 57344
    s_add_u32 s13, s13, s12
    s_lshl_b32 s14, s14, 12
    s_add_u32 s14, s14, s101
    s_cmp_lt_u32 s15, 64
    s_cselect_b64 s[56:57], s[56:57], s[52:53]
    s_cselect_b32 s13, s13, s14
    s_cselect_b64 vcc, -1, 0
    v_cndmask_b32 v209, v210, v209, vcc
    s_add_u32 s15, s15, 1
    buffer_load_dwordx4 v209, s[56:59], s13 offen lds
    s_cmp_gt_u32 s15, 95
    s_cbranch_scc1 fk_win2
    s_lshl_b32 s12, s15, 10
    s_mov_b32 m0, s12
    s_and_b32 s14, s12, 1024
    s_lshr_b32 s14, s14, 4
    v_xor_b32 v209, s14, v208
    s_cmp_lt_u32 s15, 32
    s_cselect_b64 s[56:57], s[44:45], s[48:49]
    s_cselect_b32 s12, s100, s99
    s_and_b32 s14, s15, 31
    s_mul_i32 s13, s14, 57344
    s_add_u32 s13, s13, s12
    s_lshl_b32 s14, s14, 12
    s_add_u32 s14, s14, s101
    s_cmp_lt_u32 s15, 64
    s_cselect_b64 s[56:57], s[56:57], s[52:53]
    s_cselect_b32 s13, s13, s14
    s_cselect_b64 vcc, -1, 0
    v_cndmask_b32 v209, v210, v209, vcc
    s_add_u32 s15, s15, 1
    buffer_load_dwordx4 v209, s[56:59], s13 offen lds
    s_cmp_gt_u32 s15, 95
    s_cbranch_scc1 fk_win2
    s_lshl_b32 s12, s15, 10
    s_mov_b32 m0, s12
    s_and_b32 s14, s12, 1024
    s_lshr_b32 s14, s14, 4
    v_xor_b32 v209, s14, v208
    s_cmp_lt_u32 s15, 32
    s_cselect_b64 s[56:57], s[44:45], s[48:49]
    s_cselect_b32 s12, s100, s99
    s_and_b32 s14, s15, 31
    s_mul_i32 s13, s14, 57344
    s_add_u32 s13, s13, s12
    s_lshl_b32 s14, s14, 12
    s_add_u32 s14, s14, s101
    s_cmp_lt_u32 s15, 64
    s_cselect_b64 s[56:57], s[56:57], s[52:53]
    s_cselect_b32 s13, s13, s14
    s_cselect_b64 vcc, -1, 0
    v_cndmask_b32 v209, v210, v209, vcc
    s_add_u32 s15, s15, 1
    buffer_load_dwordx4 v209, s[56:59], s13 offen lds
    s_cmp_gt_u32 s15, 95
    s_cbranch_scc1 fk_win2
    s_lshl_b32 s12, s15, 10
    s_mov_b32 m0, s12
    s_and_b32 s14, s12, 1024
    s_lshr_b32 s14, s14, 4
    v_xor_b32 v209, s14, v208
    s_cmp_lt_u32 s15, 32
    s_cselect_b64 s[56:57], s[44:45], s[48:49]
    s_cselect_b32 s12, s100, s99
    s_and_b32 s14, s15, 31
    s_mul_i32 s13, s14, 57344
    s_add_u32 s13, s13, s12
    s_lshl_b32 s14, s14, 12
    s_add_u32 s14, s14, s101
    s_cmp_lt_u32 s15, 64
    s_cselect_b64 s[56:57], s[56:57], s[52:53]
    s_cselect_b32 s13, s13, s14
    s_cselect_b64 vcc, -1, 0
    v_cndmask_b32 v209, v210, v209, vcc
    s_add_u32 s15, s15, 1
    buffer_load_dwordx4 v209, s[56:59], s13 offen lds
    s_nop 2
fk_win2:
    s_mov_b32 s42, 0
    s_cmp_gt_u32 s3, 223
    s_cbranch_scc1 fk_pollg
    s_waitcnt vmcnt(4)
    s_branch fk_chkg
    s_nop 0
fk_pollg:
    buffer_load_dwordx4 v[184:187], v14, s[24:27], s40 offen sc1
    buffer_load_dword v188, v3, s[24:27], s41 offen sc1
    s_waitcnt vmcnt(0)
    s_nop 0
fk_chkg:
    s_add_u32 s42, s42, 1
    v_max3_u32 v4, v184, v185, v186
    v_max3_u32 v4, v4, v187, v188
    v_cmp_eq_u32 vcc, -1, v4
    s_cbranch_vccz fk_gotg
    s_cmp_le_u32 s42, 0x40000
    s_cbranch_scc1 fk_pollg
    s_nop 1
fk_gotg:
    ds_write_b128 v7, v[184:187]
    ds_write_b32 v8, v188
    s_branch fk_common
    s_nop 0
fk_w4:
    v_min_u32 v184, -2, v176
    v_min_u32 v185, -2, v178
    v_min_u32 v186, -2, v180
    v_min_u32 v187, -2, v182
    v_min_u32 v8, -2, v8
    v_mov_b32 v4, 4096
    s_mov_b32 s14, 0x13000
    s_mov_b32 s15, 0x11000
    s_nop 2
fk_w4s:
    ds_read_b32 v3, v205
    s_waitcnt lgkmcnt(0)
    v_cmp_eq_u32 vcc, 0, v3
    s_nop 1
    s_and_b32 s13, vcc_lo, 32
    s_cbranch_scc1 fk_w4s
    buffer_store_dwordx4 v[184:187], v14, s[24:27], s14 offen sc1
    s_mov_b64 exec, 0x10000
    buffer_store_dword v8, v4, s[24:27], s15 offen sc1
    s_mov_b64 exec, -1
    s_branch fk_Hconst
    s_nop 0
fk_H:
    s_barrier
    s_cmp_lg_u32 s16, 7
    s_cbranch_scc1 fk_Hconst
    v_mov_b32 v4, -1
    v_mov_b32 v5, -1
    v_mov_b32 v6, -1
    v_mov_b32 v7, -1
    v_mov_b32 v3, 157120
    v_mov_b32 v8, 0
    ds_write_b32 v3, v8
    v_lshlrev_b32 v3, 12, v15
    s_lshl_b32 s13, s3, 4
    s_add_u32 s14, s13, 0x9000
    s_add_u32 s15, s13, 0x11000
    v_mov_b32 v201, 157844
    v_mov_b32 v204, 1
    s_waitcnt lgkmcnt(0)
    s_load_dword s56, s[24:25], 0
    s_mov_b64 exec, 0xff
    buffer_store_dwordx4 v[4:7], v3, s[24:27], s14 offen sc1
    s_cmp_eq_u32 s3, 255
    s_cselect_b32 exec_lo, 3, 1
    buffer_store_dwordx4 v[4:7], v14, s[24:27], s15 offen sc1
    s_mov_b64 exec, -1
    s_mov_b32 m0, 155008
    s_mov_b32 s12, 0
    buffer_load_dwordx4 v14, s[32:35], s12 offen lds
    s_mov_b32 m0, 156032
    s_mov_b32 s12, 1024
    buffer_load_dwordx4 v14, s[32:35], s12 offen lds
    s_cmp_eq_u32 s3, 255
    s_cselect_b32 s12, 0x13000, s26
    buffer_store_dwordx4 v[4:7], v14, s[24:27], s12 offen sc1
    s_cmp_lg_u32 s3, 248
    s_cbranch_scc1 fk_no1024
    s_mov_b32 m0, 118784
    s_mov_b32 s14, 2097152
    buffer_load_dwordx4 v14, s[8:11], s14 offen lds
    s_mov_b32 m0, 119808
    s_mov_b32 s14, 2098176
    buffer_load_dwordx4 v14, s[8:11], s14 offen lds
fk_no1024:
    s_mul_i32 s38, s3, 8320
    s_add_u32 s38, s38, 0x268000
    s_add_u32 s39, s38, 4096
    s_waitcnt vmcnt(0) lgkmcnt(0)
    s_add_u32 s57, s56, 1
    v_mov_b32 v202, s57
    ds_write_b32 v201, v202 offset:8
    ds_write_b32 v201, v204
    buffer_store_dwordx4 v[4:7], v14, s[24:27], s38 offen offset:0 sc1
    buffer_store_dwordx4 v[4:7], v14, s[24:27], s38 offen offset:1024 sc1
    buffer_store_dwordx4 v[4:7], v14, s[24:27], s38 offen offset:2048 sc1
    buffer_store_dwordx4 v[4:7], v14, s[24:27], s38 offen offset:3072 sc1
    buffer_store_dwordx4 v[4:7], v14, s[24:27], s39 offen offset:0 sc1
    buffer_store_dwordx4 v[4:7], v14, s[24:27], s39 offen offset:1024 sc1
    buffer_store_dwordx4 v[4:7], v14, s[24:27], s39 offen offset:2048 sc1
    buffer_store_dwordx4 v[4:7], v14, s[24:27], s39 offen offset:3072 sc1
    s_mul_i32 s38, s3, 9344
    s_add_u32 s38, s38, 0x470000
    s_add_u32 s39, s38, 4096
    buffer_store_dwordx4 v[4:7], v14, s[24:27], s38 offen offset:0 sc1
    buffer_store_dwordx4 v[4:7], v14, s[24:27], s38 offen offset:1024 sc1
    buffer_store_dwordx4 v[4:7], v14, s[24:27], s38 offen offset:2048 sc1
    buffer_store_dwordx4 v[4:7], v14, s[24:27], s38 offen offset:3072 sc1
    buffer_store_dwordx4 v[4:7], v14, s[24:27], s39 offen offset:0 sc1
    buffer_store_dwordx4 v[4:7], v14, s[24:27], s39 offen offset:1024 sc1
    s_waitcnt lgkmcnt(0)
    s_add_u32 s56, s56, 1
    v_mov_b32 v202, s56
    ds_write_b32 v201, v202 offset:8
    s_waitcnt vmcnt(14)
    ds_write_b32 v201, v204
    s_waitcnt vmcnt(0)
    ds_write_b32 v201, v204 offset:4
fk_Hconst:
    s_sub_u32 s20, s16, 4
    v_lshrrev_b32 v208, 3, v15
    v_and_b32 v209, 7, v15
    v_and_b32 v210, 2, v208
    v_xor_b32 v209, v210, v209
    v_mul_u32_u24 v208, 7168, v208
    v_lshl_add_u32 v208, v209, 4, v208
    v_lshrrev_b32 v210, 5, v15
    v_lshlrev_b32 v210, 11, v210
    v_and_b32 v209, 31, v15
    v_lshl_add_u32 v210, v209, 4, v210
    s_and_b32 s12, s3, 3
    s_mul_i32 s100, s12, 1835008
    s_lshl_b32 s101, s12, 9
    s_lshr_b32 s12, s3, 2
    s_lshl_b32 s12, s12, 7
    s_add_u32 s100, s100, s12
    s_lshl_b32 s12, s12, 10
    s_add_u32 s101, s101, s12
    s_xor_b32 s99, s100, 0
    s_and_b32 s12, s20, 1
    s_lshl_b32 s12, s12, 6
    v_xor_b32 v206, s12, v208
    v_xor_b32 v207, 64, v206
    s_mov_b32 s6, 0x700000
    s_mov_b32 s7, 0x00020000
    s_cmp_gt_u32 s3, 223
    s_cselect_b32 s36, 3, s20
    s_waitcnt lgkmcnt(0)
    v_lshrrev_b32 v4, 1, v1
    v_and_b32 v5, 1, v4
    v_lshrrev_b32 v6, 2, v4
    v_lshl_add_u32 v5, v6, 1, v5
    v_and_b32 v6, 2, v4
    v_lshl_add_u32 v5, v6, 2, v5
    s_and_b32 s13, s20, 1
    s_mul_i32 s13, s13, 15
    v_xor_b32 v5, s13, v5
    s_lshl_b32 s13, s20, 4
    v_add_u32 v5, s13, v5
    v_cvt_f32_u32 v5, v5
    v_and_b32 v9, 1, v1
    v_lshlrev_b32 v7, 2, v2
    v_cvt_f32_u32 v7, v7
    v_cvt_f32_u32 v10, v9
    v_mul_f32 v8, 0x3c800000, v5
    v_mul_f32 v10, 0x3e800000, v10
    v_fma_f32 v10, v8, v7, v10
    v_mov_b32 v128, v10
    v_fmamk_f32 v129, v8, 0x3f800000, v10
    v_fmamk_f32 v130, v8, 0x40000000, v10
    v_fmamk_f32 v131, v8, 0x40400000, v10
    v_fmamk_f32 v132, v8, 0x41000000, v10
    v_fmamk_f32 v133, v8, 0x41100000, v10
    v_fmamk_f32 v134, v8, 0x41200000, v10
    v_fmamk_f32 v135, v8, 0x41300000, v10
    v_fmamk_f32 v136, v8, 0x41800000, v10
    v_fmamk_f32 v137, v8, 0x41880000, v10
    v_fmamk_f32 v138, v8, 0x41900000, v10
    v_fmamk_f32 v139, v8, 0x41980000, v10
    v_fmamk_f32 v140, v8, 0x41c00000, v10
    v_fmamk_f32 v141, v8, 0x41c80000, v10
    v_fmamk_f32 v142, v8, 0x41d00000, v10
    v_fmamk_f32 v143, v8, 0x41d80000, v10
    v_cos_f32 v144, v128
    v_cos_f32 v145, v129
    v_cos_f32 v146, v130
    v_cos_f32 v147, v131
    v_cos_f32 v148, v132
    v_cos_f32 v149, v133
    v_cos_f32 v150, v134
    v_cos_f32 v151, v135
    v_cos_f32 v152, v136
    v_cos_f32 v153, v137
    v_cos_f32 v154, v138
    v_cos_f32 v155, v139
    v_cos_f32 v156, v140
    v_cos_f32 v157, v141
    v_cos_f32 v158, v142
    v_cos_f32 v159, v143
    v_sin_f32 v160, v128
    v_sin_f32 v161, v129
    v_sin_f32 v162, v130
    v_sin_f32 v163, v131
    v_sin_f32 v164, v132
    v_sin_f32 v165, v133
    v_sin_f32 v166, v134
    v_sin_f32 v167, v135
    v_sin_f32 v168, v136
    v_sin_f32 v169, v137
    v_sin_f32 v170, v138
    v_sin_f32 v171, v139
    v_sin_f32 v172, v140
    v_sin_f32 v173, v141
    v_sin_f32 v174, v142
    v_sin_f32 v175, v143
    v_cvt_pk_f16_f32 v48, v144, v160
    v_cvt_pk_f16_f32 v49, v145, v161
    v_cvt_pk_f16_f32 v50, v146, v162
    v_cvt_pk_f16_f32 v51, v147, v163
    v_cvt_pk_f16_f32 v52, v148, v164
    v_cvt_pk_f16_f32 v53, v149, v165
    v_cvt_pk_f16_f32 v54, v150, v166
    v_cvt_pk_f16_f32 v55, v151, v167
    v_cvt_pk_f16_f32 v56, v152, v168
    v_cvt_pk_f16_f32 v57, v153, v169
    v_cvt_pk_f16_f32 v58, v154, v170
    v_cvt_pk_f16_f32 v59, v155, v171
    v_cvt_pk_f16_f32 v60, v156, v172
    v_cvt_pk_f16_f32 v61, v157, v173
    v_cvt_pk_f16_f32 v62, v158, v174
    s_cmp_eq_u32 s36, 3
    s_cbranch_scc1 fk_gu0
    s_add_u32 s37, s20, 0
    s_lshl_b32 s12, s37, 10
    s_mov_b32 m0, s12
    s_cmp_lt_u32 s37, 32
    s_cselect_b64 s[4:5], s[44:45], s[48:49]
    s_and_b32 s37, s37, 31
    s_mul_i32 s37, s37, 57344
    s_add_u32 s37, s37, s100
    buffer_load_dwordx4 v206, s[4:7], s37 offen lds
fk_gu0:
    s_cmp_eq_u32 s36, 3
    s_cbranch_scc1 fk_gu1
    s_add_u32 s37, s20, 3
    s_lshl_b32 s12, s37, 10
    s_mov_b32 m0, s12
    s_cmp_lt_u32 s37, 32
    s_cselect_b64 s[4:5], s[44:45], s[48:49]
    s_and_b32 s37, s37, 31
    s_mul_i32 s37, s37, 57344
    s_add_u32 s37, s37, s100
    buffer_load_dwordx4 v207, s[4:7], s37 offen lds
fk_gu1:
    s_cmp_eq_u32 s36, 3
    s_cbranch_scc1 fk_gu2
    s_add_u32 s37, s20, 6
    s_lshl_b32 s12, s37, 10
    s_mov_b32 m0, s12
    s_cmp_lt_u32 s37, 32
    s_cselect_b64 s[4:5], s[44:45], s[48:49]
    s_and_b32 s37, s37, 31
    s_mul_i32 s37, s37, 57344
    s_add_u32 s37, s37, s100
    buffer_load_dwordx4 v206, s[4:7], s37 offen lds
fk_gu2:
    s_cmp_eq_u32 s36, 3
    s_cbranch_scc1 fk_gu3
    s_add_u32 s37, s20, 9
    s_lshl_b32 s12, s37, 10
    s_mov_b32 m0, s12
    s_cmp_lt_u32 s37, 32
    s_cselect_b64 s[4:5], s[44:45], s[48:49]
    s_and_b32 s37, s37, 31
    s_mul_i32 s37, s37, 57344
    s_add_u32 s37, s37, s100
    buffer_load_dwordx4 v207, s[4:7], s37 offen lds
fk_gu3:
    v_cvt_pk_f16_f32 v63, v159, v175
    v_fmamk_f32 v128, v8, 0x42000000, v10
    v_fmamk_f32 v129, v8, 0x42040000, v10
    v_fmamk_f32 v130, v8, 0x42080000, v10
    v_fmamk_f32 v131, v8, 0x420c0000, v10
    v_fmamk_f32 v132, v8, 0x42200000, v10
    v_fmamk_f32 v133, v8, 0x42240000, v10
    v_fmamk_f32 v134, v8, 0x42280000, v10
    v_fmamk_f32 v135, v8, 0x422c0000, v10
    v_fmamk_f32 v136, v8, 0x42400000, v10
    v_fmamk_f32 v137, v8, 0x42440000, v10
    v_fmamk_f32 v138, v8, 0x42480000, v10
    v_fmamk_f32 v139, v8, 0x424c0000, v10
    v_fmamk_f32 v140, v8, 0x42600000, v10
    v_fmamk_f32 v141, v8, 0x42640000, v10
    v_fmamk_f32 v142, v8, 0x42680000, v10
    v_fmamk_f32 v143, v8, 0x426c0000, v10
    v_cos_f32 v144, v128
    v_cos_f32 v145, v129
    v_cos_f32 v146, v130
    v_cos_f32 v147, v131
    v_cos_f32 v148, v132
    v_cos_f32 v149, v133
    v_cos_f32 v150, v134
    v_cos_f32 v151, v135
    v_cos_f32 v152, v136
    v_cos_f32 v153, v137
    v_cos_f32 v154, v138
    v_cos_f32 v155, v139
    v_cos_f32 v156, v140
    v_cos_f32 v157, v141
    v_cos_f32 v158, v142
    v_cos_f32 v159, v143
    v_sin_f32 v160, v128
    v_sin_f32 v161, v129
    v_sin_f32 v162, v130
    v_sin_f32 v163, v131
    v_sin_f32 v164, v132
    v_sin_f32 v165, v133
    v_sin_f32 v166, v134
    v_sin_f32 v167, v135
    v_sin_f32 v168, v136
    v_sin_f32 v169, v137
    v_sin_f32 v170, v138
    v_sin_f32 v171, v139
    v_sin_f32 v172, v140
    v_sin_f32 v173, v141
    v_sin_f32 v174, v142
    v_sin_f32 v175, v143
    v_cvt_pk_f16_f32 v64, v144, v160
    v_cvt_pk_f16_f32 v65, v145, v161
    v_cvt_pk_f16_f32 v66, v146, v162
    v_cvt_pk_f16_f32 v67, v147, v163
    v_cvt_pk_f16_f32 v68, v148, v164
    v_cvt_pk_f16_f32 v69, v149, v165
    v_cvt_pk_f16_f32 v70, v150, v166
    v_cvt_pk_f16_f32 v71, v151, v167
    v_cvt_pk_f16_f32 v72, v152, v168
    v_cvt_pk_f16_f32 v73, v153, v169
    v_cvt_pk_f16_f32 v74, v154, v170
    v_cvt_pk_f16_f32 v75, v155, v171
    v_cvt_pk_f16_f32 v76, v156, v172
    v_cvt_pk_f16_f32 v77, v157, v173
    v_cvt_pk_f16_f32 v78, v158, v174
    v_cvt_pk_f16_f32 v79, v159, v175
    v_lshlrev_b32 v11, 31, v9
    v_mul_f32 v10, 0x3a000000, v5
    v_xor_b32 v10, v11, v10
    v_mul_f32 v11, v10, v7
    v_mov_b32 v128, v11
    v_fmamk_f32 v129, v10, 0x3f800000, v11
    v_fmamk_f32 v130, v10, 0x40000000, v11
    v_fmamk_f32 v131, v10, 0x40400000, v11
    v_fmamk_f32 v132, v10, 0x41000000, v11
    v_fmamk_f32 v133, v10, 0x41100000, v11
    v_fmamk_f32 v134, v10, 0x41200000, v11
    v_fmamk_f32 v135, v10, 0x41300000, v11
    v_fmamk_f32 v136, v10, 0x41800000, v11
    v_fmamk_f32 v137, v10, 0x41880000, v11
    v_fmamk_f32 v138, v10, 0x41900000, v11
    v_fmamk_f32 v139, v10, 0x41980000, v11
    v_fmamk_f32 v140, v10, 0x41c00000, v11
    v_fmamk_f32 v141, v10, 0x41c80000, v11
    v_fmamk_f32 v142, v10, 0x41d00000, v11
    v_fmamk_f32 v143, v10, 0x41d80000, v11
    v_cos_f32 v80, v128
    v_cos_f32 v81, v129
    v_cos_f32 v82, v130
    v_cos_f32 v83, v131
    v_cos_f32 v84, v132
    v_cos_f32 v85, v133
    v_cos_f32 v86, v134
    v_cos_f32 v87, v135
    v_cos_f32 v88, v136
    v_cos_f32 v89, v137
    v_cos_f32 v90, v138
    v_cos_f32 v91, v139
    v_cos_f32 v92, v140
    v_cos_f32 v93, v141
    v_cos_f32 v94, v142
    v_cos_f32 v95, v143
    v_sin_f32 v96, v128
    v_sin_f32 v97, v129
    v_sin_f32 v98, v130
    v_sin_f32 v99, v131
    v_sin_f32 v100, v132
    v_sin_f32 v101, v133
    v_sin_f32 v102, v134
    v_sin_f32 v103, v135
    v_sin_f32 v104, v136
    v_sin_f32 v105, v137
    v_sin_f32 v106, v138
    v_sin_f32 v107, v139
    v_sin_f32 v108, v140
    v_sin_f32 v109, v141
    v_sin_f32 v110, v142
    v_sin_f32 v111, v143
    v_sub_u32 v4, 31, v1
    v_subrev_u32 v5, 1, v1
    v_cmp_lt_u32 vcc, 16, v1
    s_nop 1
    v_cndmask_b32 v4, v5, v4, vcc
    v_and_b32 v4, 15, v4
    v_lshlrev_b32 v4, 5, v4
    v_add_u32 v4, 130304, v4
    v_lshlrev_b32 v5, 9, v2
    v_add_u32 v6, v4, v5
    v_sub_u32 v7, v4, v5
    v_add_u32 v7, 7696, v7
    v_cmp_eq_u32 s[38:39], 0, v1
    v_mov_b32 v8, 4096
    s_nop 0
    v_cndmask_b32 v8, 0, v8, s[38:39]
    v_add_u32 v6, v6, v8
    v_add_u32 v7, v7, v8
    v_and_b32 v8, 15, v1
    v_cmp_eq_u32 s[38:39], 0, v8
    s_nop 1
    s_or_b64 s[40:41], s[38:39], vcc
    v_add_u32 v184, 0, v6
    v_subrev_u32 v8, 0, v7
    v_cndmask_b32 v184, v184, v8, vcc
    v_add_u32 v185, 1024, v6
    v_subrev_u32 v8, 1024, v7
    v_cndmask_b32 v185, v185, v8, vcc
    v_add_u32 v186, 2048, v6
    v_subrev_u32 v8, 2048, v7
    v_cndmask_b32 v186, v186, v8, vcc
    v_add_u32 v187, 3072, v6
    v_subrev_u32 v8, 3072, v7
    v_cndmask_b32 v187, v187, v8, vcc
    v_add_u32 v188, 4096, v6
    v_subrev_u32 v8, 4096, v7
    v_cndmask_b32 v188, v188, v8, s[40:41]
    v_add_u32 v189, 5120, v6
    v_subrev_u32 v8, 5120, v7
    v_cndmask_b32 v189, v189, v8, s[40:41]
    v_add_u32 v190, 6144, v6
    v_subrev_u32 v8, 6144, v7
    v_cndmask_b32 v190, v190, v8, s[40:41]
    v_add_u32 v191, 7168, v6
    v_subrev_u32 v8, 7168, v7
    v_cndmask_b32 v191, v191, v8, s[40:41]
    v_add_u32 v212, 512, v188
    v_add_u32 v213, 512, v189
    v_add_u32 v214, 512, v190
    v_add_u32 v215, 512, v191
    v_subrev_u32 v8, 4096, v212
    v_cmp_eq_u32 vcc, 0, v2
    s_nop 1
    v_cndmask_b32 v212, v212, v8, vcc
    s_lshr_b32 s13, s20, 1
    v_lshl_add_u32 v3, v1, 1, s13
    s_and_b32 s13, s20, 1
    s_sub_u32 s14, 64, s13
    v_and_b32 v8, 3, v3
    v_lshlrev_b32 v8, 2, v8
    v_lshlrev_b32 v4, 3, v3
    v_sub_u32 v4, v4, v8
    v_sub_u32 v5, 63, v3
    v_and_b32 v8, 3, v5
    v_mul_u32_u24 v8, 12, v8
    v_lshlrev_b32 v6, 3, v5
    v_sub_u32 v6, v6, v8
    v_add_u32 v6, 28, v6
    v_sub_u32 v5, s14, v3
    v_and_b32 v8, 3, v5
    v_mul_u32_u24 v8, 12, v8
    v_lshlrev_b32 v7, 3, v5
    v_sub_u32 v7, v7, v8
    v_add_u32 v7, 28, v7
    v_cmp_gt_u32 vcc, 32, v3
    s_nop 1
    v_cndmask_b32 v7, v7, v4, vcc
    v_cmp_eq_u32 vcc, 32, v5
    s_nop 1
    v_cndmask_b32 v7, v7, 28, vcc
    s_cmp_eq_u32 s13, 0
    s_cselect_b32 s14, 256, 0
    s_cselect_b32 s15, 576, 0
    s_cselect_b64 s[38:39], -1, 0
    s_add_u32 s14, s14, 7680
    s_sub_u32 s15, 120832, s15
    v_cmp_gt_u32 vcc, 32, v3
    s_nop 1
    v_cndmask_b32 v7, v7, v4, vcc
    v_add_u32 v7, s14, v7
    v_cndmask_b32 v4, v6, v4, s[38:39]
    v_lshl_add_u32 v4, v2, 12, v4
    v_lshrrev_b32 v8, 7, v4
    v_lshl_add_u32 v4, v8, 4, v4
    v_lshrrev_b32 v8, 7, v7
    v_lshl_add_u32 v7, v8, 4, v7
    v_add_u32 v11, s15, v4
    v_add_u32 v7, 120832, v7
    v_add_u32 v12, 4032, v11
    v_cmp_eq_u32 vcc, s13, v2
    s_nop 1
    s_and_b64 s[40:41], vcc, s[38:39]
    s_andn2_b64 s[38:39], vcc, s[38:39]
    v_cndmask_b32 v10, v11, v7, s[40:41]
    v_cndmask_b32 v12, v12, v7, s[38:39]
    s_lshl_b32 s23, s20, 5
    s_add_u32 s23, s23, s18
    v_and_b32 v3, 15, v15
    v_lshrrev_b32 v4, 4, v15
    v_lshl_add_u32 v3, v3, 7, v4
    v_add_u32 v3, 1, v3
    v_cmp_le_u32 vcc, 56, v15
    v_mov_b32 v4, 1008
    s_nop 0
    v_cndmask_b32 v4, 0, v4, vcc
    v_add_u32 v4, v3, v4
    v_mul_u32_u24 v3, s23, v3
    v_and_b32 v3, 2047, v3
    v_cvt_f32_u32 v3, v3
    v_mul_f32 v3, 0x3a000000, v3
    v_mul_u32_u24 v4, s23, v4
    v_and_b32 v4, 2047, v4
    v_cvt_f32_u32 v4, v4
    v_mul_f32 v4, 0x3a000000, v4
    v_cvt_f32_u32 v5, s23
    v_mul_f32 v5, 0x3a000000, v5
    v_mov_b32 v192, v3
    v_fmamk_f32 v193, v5, 0x42000000, v3
    v_fmamk_f32 v194, v5, 0x42800000, v3
    v_fmamk_f32 v195, v5, 0x42c00000, v3
    v_fmamk_f32 v196, v5, 0x40800000, v3
    v_fmamk_f32 v197, v5, 0x42100000, v3
    v_fmamk_f32 v198, v5, 0x42880000, v3
    v_fmamk_f32 v199, v5, 0x42c80000, v3
    v_fmamk_f32 v200, v5, 0x41000000, v3
    v_fmamk_f32 v201, v5, 0x42200000, v3
    v_fmamk_f32 v202, v5, 0x42900000, v3
    v_fmamk_f32 v203, v5, 0x42d00000, v3
    v_fmamk_f32 v204, v5, 0x41400000, v4
    v_fmamk_f32 v205, v5, 0x42300000, v4
    v_fmamk_f32 v206, v5, 0x42980000, v4
    v_fmamk_f32 v207, v5, 0x42d80000, v4
    v_cos_f32 v192, v192
    v_cos_f32 v193, v193
    v_cos_f32 v194, v194
    v_cos_f32 v195, v195
    v_cos_f32 v196, v196
    v_cos_f32 v197, v197
    v_cos_f32 v198, v198
    v_cos_f32 v199, v199
    v_cos_f32 v200, v200
    v_cos_f32 v201, v201
    v_cos_f32 v202, v202
    v_cos_f32 v203, v203
    v_cos_f32 v204, v204
    v_cos_f32 v205, v205
    v_cos_f32 v206, v206
    v_cos_f32 v207, v207
    v_add_u32 v9, 138496, v14
    v_mov_b32 v3, 157864
    s_nop 4
fk_c2s:
    ds_read_b32 v4, v3
    s_waitcnt lgkmcnt(0)
    v_readfirstlane_b32 s13, v4
    s_nop 1
    s_cmp_eq_u32 s13, 0
    s_cbranch_scc1 fk_c2s
    ds_read_b128 v[112:115], v9 offset:12288
    ds_read_b128 v[116:119], v9 offset:13312
    ds_read_b128 v[120:123], v9 offset:14336
    ds_read_b128 v[124:127], v9 offset:15360
    s_setprio 2
    s_waitcnt lgkmcnt(0)
    s_barrier
    ds_read_b128 v[16:19], v184
    ds_read_b128 v[20:23], v185
    ds_read_b128 v[24:27], v186
    ds_read_b128 v[28:31], v187
    ds_read_b128 v[32:35], v188
    ds_read_b128 v[36:39], v189
    ds_read_b128 v[40:43], v190
    ds_read_b128 v[44:47], v191
    s_mov_b32 exec_lo, 1
    s_mov_b32 exec_hi, 1
    ds_read_b32 v32, v212
    ds_read_b32 v36, v213
    ds_read_b32 v40, v214
    ds_read_b32 v44, v215
    s_mov_b64 exec, -1
    s_waitcnt lgkmcnt(11)
    v_mfma_f32_32x32x16_f16 v[128:143], v[16:19], v[48:51], 0
    s_waitcnt lgkmcnt(10)
    v_mfma_f32_32x32x16_f16 v[128:143], v[20:23], v[52:55], v[128:143]
    s_waitcnt lgkmcnt(9)
    v_mfma_f32_32x32x16_f16 v[128:143], v[24:27], v[56:59], v[128:143]
    s_waitcnt lgkmcnt(8)
    v_mfma_f32_32x32x16_f16 v[128:143], v[28:31], v[60:63], v[128:143]
    s_waitcnt lgkmcnt(3)
    v_mfma_f32_32x32x16_f16 v[128:143], v[32:35], v[64:67], v[128:143]
    s_waitcnt lgkmcnt(2)
    v_mfma_f32_32x32x16_f16 v[128:143], v[36:39], v[68:71], v[128:143]
    s_waitcnt lgkmcnt(1)
    v_mfma_f32_32x32x16_f16 v[128:143], v[40:43], v[72:75], v[128:143]
    s_waitcnt lgkmcnt(0)
    v_mfma_f32_32x32x16_f16 v[128:143], v[44:47], v[76:79], v[128:143]
    s_nop 11
    v_pk_mul_f32 v[16:17], v[128:129], v[80:81]
    v_pk_mul_f32 v[18:19], v[130:131], v[82:83]
    v_pk_mul_f32 v[20:21], v[132:133], v[84:85]
    v_pk_mul_f32 v[22:23], v[134:135], v[86:87]
    v_pk_mul_f32 v[24:25], v[136:137], v[88:89]
    v_pk_mul_f32 v[26:27], v[138:139], v[90:91]
    v_pk_mul_f32 v[28:29], v[140:141], v[92:93]
    v_pk_mul_f32 v[30:31], v[142:143], v[94:95]
    v_fmac_f32_dpp v16, v128, v96 quad_perm:[1,0,3,2] row_mask:0xf bank_mask:0xf
    v_fmac_f32_dpp v17, v129, v97 quad_perm:[1,0,3,2] row_mask:0xf bank_mask:0xf
    v_fmac_f32_dpp v18, v130, v98 quad_perm:[1,0,3,2] row_mask:0xf bank_mask:0xf
    v_fmac_f32_dpp v19, v131, v99 quad_perm:[1,0,3,2] row_mask:0xf bank_mask:0xf
    v_fmac_f32_dpp v20, v132, v100 quad_perm:[1,0,3,2] row_mask:0xf bank_mask:0xf
    v_fmac_f32_dpp v21, v133, v101 quad_perm:[1,0,3,2] row_mask:0xf bank_mask:0xf
    v_fmac_f32_dpp v22, v134, v102 quad_perm:[1,0,3,2] row_mask:0xf bank_mask:0xf
    v_fmac_f32_dpp v23, v135, v103 quad_perm:[1,0,3,2] row_mask:0xf bank_mask:0xf
    v_cvt_pk_f16_f32 v176, v16, v17
    v_cvt_pk_f16_f32 v177, v18, v19
    v_cvt_pk_f16_f32 v178, v20, v21
    v_cvt_pk_f16_f32 v179, v22, v23
    v_fmac_f32_dpp v24, v136, v104 quad_perm:[1,0,3,2] row_mask:0xf bank_mask:0xf
    v_fmac_f32_dpp v25, v137, v105 quad_perm:[1,0,3,2] row_mask:0xf bank_mask:0xf
    v_mfma_f32_32x32x16_f16 v[144:159], v[176:179], v[112:115], 0
    v_fmac_f32_dpp v26, v138, v106 quad_perm:[1,0,3,2] row_mask:0xf bank_mask:0xf
    v_fmac_f32_dpp v27, v139, v107 quad_perm:[1,0,3,2] row_mask:0xf bank_mask:0xf
    v_fmac_f32_dpp v28, v140, v108 quad_perm:[1,0,3,2] row_mask:0xf bank_mask:0xf
    v_fmac_f32_dpp v29, v141, v109 quad_perm:[1,0,3,2] row_mask:0xf bank_mask:0xf
    v_fmac_f32_dpp v30, v142, v110 quad_perm:[1,0,3,2] row_mask:0xf bank_mask:0xf
    v_mfma_f32_32x32x16_f16 v[160:175], v[176:179], v[120:123], 0
    v_fmac_f32_dpp v31, v143, v111 quad_perm:[1,0,3,2] row_mask:0xf bank_mask:0xf
    v_cvt_pk_f16_f32 v180, v24, v25
    v_cvt_pk_f16_f32 v181, v26, v27
    v_cvt_pk_f16_f32 v182, v28, v29
    v_cvt_pk_f16_f32 v183, v30, v31
    s_nop 1
    v_mfma_f32_32x32x16_f16 v[144:159], v[180:183], v[116:119], v[144:159]
    v_mfma_f32_32x32x16_f16 v[160:175], v[180:183], v[124:127], v[160:175]
    s_nop 11
    v_pk_add_f32 v[16:17], v[144:145], v[160:161] op_sel:[0,1] op_sel_hi:[1,0] neg_hi:[0,1]
    v_pk_add_f32 v[18:19], v[146:147], v[162:163] op_sel:[0,1] op_sel_hi:[1,0] neg_hi:[0,1]
    v_pk_add_f32 v[20:21], v[148:149], v[164:165] op_sel:[0,1] op_sel_hi:[1,0] neg_hi:[0,1]
    v_pk_add_f32 v[22:23], v[150:151], v[166:167] op_sel:[0,1] op_sel_hi:[1,0] neg_hi:[0,1]
    v_pk_add_f32 v[24:25], v[152:153], v[168:169] op_sel:[0,1] op_sel_hi:[1,0] neg_hi:[0,1]
    v_pk_add_f32 v[26:27], v[154:155], v[170:171] op_sel:[0,1] op_sel_hi:[1,0] neg_hi:[0,1]
    v_pk_add_f32 v[28:29], v[156:157], v[172:173] op_sel:[0,1] op_sel_hi:[1,0] neg_hi:[0,1]
    v_pk_add_f32 v[30:31], v[158:159], v[174:175] op_sel:[0,1] op_sel_hi:[1,0] neg_hi:[0,1]
    v_cvt_pk_f16_f32 v48, v16, v17
    ds_write_b32 v10, v48
    v_cvt_pk_f16_f32 v49, v18, v19
    ds_write_b32 v11, v49 offset:576
    v_cvt_pk_f16_f32 v50, v20, v21
    ds_write_b32 v11, v50 offset:1152
    v_cvt_pk_f16_f32 v51, v22, v23
    ds_write_b32 v11, v51 offset:1728
    v_cvt_pk_f16_f32 v52, v24, v25
    ds_write_b32 v11, v52 offset:2304
    v_cvt_pk_f16_f32 v53, v26, v27
    ds_write_b32 v11, v53 offset:2880
    v_cvt_pk_f16_f32 v54, v28, v29
    ds_write_b32 v11, v54 offset:3456
    v_cvt_pk_f16_f32 v55, v30, v31
    ds_write_b32 v12, v55
    s_nop 3
fk_common:
    v_lshlrev_b32 v4, 4, v0
    v_lshrrev_b32 v5, 3, v0
    v_lshl_add_u32 v5, v5, 4, v4
    v_add_u32 v5, 120832, v5
    s_mul_i32 s17, s3, 8320
    s_add_u32 s17, s17, 0x268000
    s_waitcnt lgkmcnt(0)
    s_barrier
    s_setprio 0
    ds_read_b128 v[16:19], v5
    s_sub_u32 s13, 7, s16
    s_cmp_lt_u32 s16, 4
    s_cselect_b32 s13, s16, s13
    s_cselect_b32 s14, 0, 2048
    s_lshl_b32 s21, s13, 5
    s_add_u32 s21, s21, s18
    s_sub_u32 s22, 2048, s21
    s_and_b32 s22, s22, 2047
    s_cmp_lt_u32 s16, 4
    s_cselect_b32 s21, s21, s22
    s_lshl_b32 s13, s13, 12
    s_add_u32 s13, s13, s14
    s_add_u32 s13, s13, 98304
    s_lshl_b32 s14, s3, 3
    s_add_u32 s19, s14, s16
    s_cmp_eq_u32 s19, 1991
    s_cselect_b32 s21, 1024, s21
    s_cselect_b32 s13, 118784, s13
    s_lshl_b32 s22, s21, 11
    v_add_u32 v6, s13, v14
    v_add_u32 v7, 155008, v14
    s_waitcnt lgkmcnt(0)
    v_min_u32 v16, -2, v16
    v_min_u32 v17, -2, v17
    v_min_u32 v18, -2, v18
    v_min_u32 v19, -2, v19
    buffer_store_dwordx4 v[16:19], v4, s[24:27], s17 offen sc1
    ds_read_b128 v[20:23], v6
    ds_read_b128 v[24:27], v6 offset:1024
    ds_read_b128 v[28:31], v7
    ds_read_b128 v[32:35], v7 offset:1024
    s_cmp_lt_u32 s16, 4
    s_cbranch_scc1 fk_noy5
    v_add_u32 v3, 114688, v14
    v_mov_b32 v4, 157152
    ds_read_b128 v[128:131], v3 offset:0
    ds_read_b128 v[132:135], v3 offset:1024
    ds_read_b128 v[136:139], v3 offset:2048
    ds_read_b128 v[140:143], v3 offset:3072
    ds_read_b32 v9, v4
    s_lshl_b32 s38, s20, 2
    s_sub_u32 s39, 28, s38
    s_waitcnt lgkmcnt(0)
    s_nop 0
fk_y5:
    v_pk_mul_f32 v[144:145], v[128:129], v[192:193]
    v_pk_mul_f32 v[146:147], v[130:131], v[194:195]
    v_pk_fma_f32 v[144:145], v[132:133], v[196:197], v[144:145]
    v_pk_fma_f32 v[146:147], v[134:135], v[198:199], v[146:147]
    v_pk_fma_f32 v[144:145], v[136:137], v[200:201], v[144:145]
    v_pk_fma_f32 v[146:147], v[138:139], v[202:203], v[146:147]
    v_pk_fma_f32 v[144:145], v[140:141], v[204:205], v[144:145]
    v_pk_fma_f32 v[146:147], v[142:143], v[206:207], v[146:147]
    v_pk_add_f32 v[144:145], v[144:145], v[146:147]
    v_add_f32 v144, v144, v145
    s_lshl_b32 s13, s23, 31
    v_xor_b32 v12, s13, v9
    v_add_f32_dpp v144, v144, v144 quad_perm:[1,0,3,2] row_mask:0xf bank_mask:0xf
    s_nop 1
    v_add_f32_dpp v144, v144, v144 quad_perm:[2,3,0,1] row_mask:0xf bank_mask:0xf
    s_nop 1
    v_add_f32_dpp v144, v144, v144 row_half_mirror row_mask:0xf bank_mask:0xf
    s_nop 1
    v_add_f32_dpp v144, v144, v144 row_mirror row_mask:0xf bank_mask:0xf
    s_nop 1
    v_add_f32_dpp v144, v144, v144 row_bcast:15 row_mask:0xa bank_mask:0xf
    s_nop 1
    v_add_f32_dpp v144, v144, v144 row_bcast:31 row_mask:0xc bank_mask:0xf
    v_add_f32 v144, v144, v12
    v_add_f32 v144, v144, v144
    v_cvt_f16_f32 v144, v144
    s_add_u32 s13, s38, 157088
    s_add_u32 s14, s39, 157088
    v_mov_b32 v10, s13
    v_mov_b32 v11, s14
    s_mov_b32 exec_lo, 0
    s_mov_b32 exec_hi, 0x80000000
    ds_write_b32 v10, v144
    ds_write_b32 v11, v144
    s_mov_b64 exec, -1
    s_cmp_lg_u32 s23, 0
    s_cbranch_scc1 fk_noy5
    s_mov_b32 s23, 1024
    s_mov_b32 s38, 28
    v_and_b32 v3, 15, v15
    v_lshrrev_b32 v4, 4, v15
    v_lshl_add_u32 v3, v3, 7, v4
    v_add_u32 v3, 1, v3
    v_cmp_le_u32 vcc, 56, v15
    v_mov_b32 v4, 1008
    s_nop 0
    v_cndmask_b32 v4, 0, v4, vcc
    v_add_u32 v4, v3, v4
    v_mul_u32_u24 v3, s23, v3
    v_and_b32 v3, 2047, v3
    v_cvt_f32_u32 v3, v3
    v_mul_f32 v3, 0x3a000000, v3
    v_mul_u32_u24 v4, s23, v4
    v_and_b32 v4, 2047, v4
    v_cvt_f32_u32 v4, v4
    v_mul_f32 v4, 0x3a000000, v4
    v_cvt_f32_u32 v5, s23
    v_mul_f32 v5, 0x3a000000, v5
    v_mov_b32 v192, v3
    v_fmamk_f32 v193, v5, 0x42000000, v3
    v_fmamk_f32 v194, v5, 0x42800000, v3
    v_fmamk_f32 v195, v5, 0x42c00000, v3
    v_fmamk_f32 v196, v5, 0x40800000, v3
    v_fmamk_f32 v197, v5, 0x42100000, v3
    v_fmamk_f32 v198, v5, 0x42880000, v3
    v_fmamk_f32 v199, v5, 0x42c80000, v3
    v_fmamk_f32 v200, v5, 0x41000000, v3
    v_fmamk_f32 v201, v5, 0x42200000, v3
    v_fmamk_f32 v202, v5, 0x42900000, v3
    v_fmamk_f32 v203, v5, 0x42d00000, v3
    v_fmamk_f32 v204, v5, 0x41400000, v4
    v_fmamk_f32 v205, v5, 0x42300000, v4
    v_fmamk_f32 v206, v5, 0x42980000, v4
    v_fmamk_f32 v207, v5, 0x42d80000, v4
    v_cos_f32 v192, v192
    v_cos_f32 v193, v193
    v_cos_f32 v194, v194
    v_cos_f32 v195, v195
    v_cos_f32 v196, v196
    v_cos_f32 v197, v197
    v_cos_f32 v198, v198
    v_cos_f32 v199, v199
    v_cos_f32 v200, v200
    v_cos_f32 v201, v201
    v_cos_f32 v202, v202
    v_cos_f32 v203, v203
    v_cos_f32 v204, v204
    v_cos_f32 v205, v205
    v_cos_f32 v206, v206
    v_cos_f32 v207, v207
    s_branch fk_y5
    s_nop 3
fk_noy5:
    v_lshrrev_b32 v1, 1, v0
    v_and_b32 v45, 1, v0
    v_lshrrev_b32 v2, 4, v1
    v_and_b32 v3, 15, v1
    v_cmp_gt_u32 vcc, 8, v3
    v_sub_u32 v6, 16, v3
    v_and_b32 v6, 7, v6
    v_sub_u32 v5, 31, v2
    v_cndmask_b32 v6, v6, v3, vcc
    v_cndmask_b32 v5, v5, v2, vcc
    v_lshl_add_u32 v4, v6, 5, v5
    v_and_b32 v12, 63, v4
    v_lshrrev_b32 v13, 6, v4
    v_lshlrev_b32 v13, 2, v13
    v_lshl_add_u32 v12, v12, 4, v13
    s_mov_b32 s23, 0x13000
    s_mov_b32 s42, 0
    buffer_load_dword v47, v12, s[24:27], s23 offen sc1
    v_mul_u32_u24 v4, 8320, v4
    v_lshl_add_u32 v4, v45, 4, v4
    s_lshl_b32 s17, s3, 5
    s_add_u32 s17, s17, 0x268000
    v_cndmask_b32 v6, -1, 1, vcc
    v_cmp_eq_u32 vcc, 8, v3
    v_mul_u32_u24 v46, 8256, v45
    v_add_u32 v46, 138496, v46
    v_cndmask_b32 v6, v6, 15, vcc
    v_lshlrev_b32 v9, 2, v1
    v_lshl_add_u32 v10, v6, 1, v9
    v_add_u32 v9, v46, v9
    v_add_u32 v10, v46, v10
    s_mul_i32 s36, s16, 2064
    s_add_u32 s36, s36, 138496
    v_add_u32 v5, s36, v14
    s_sub_u32 s36, 7, s16
    s_cmp_eq_u32 s21, 0
    s_cselect_b32 s36, 0, s36
    s_cmp_eq_u32 s21, 1024
    s_cselect_b32 s36, 7, s36
    s_mul_i32 s36, s36, 2064
    s_add_u32 s36, s36, 139504
    v_sub_u32 v11, s36, v14
    s_lshl_b32 s36, s16, 2
    s_add_u32 s36, s36, 157088
    v_mov_b32 v6, s36
    s_mov_b32 s36, 0xffff0000
    s_mov_b32 s37, 0x3f803f80
    s_mov_b32 s38, 0x42800000
    s_waitcnt lgkmcnt(0)
    v_lshlrev_b32 v48, 16, v20
    v_and_b32 v49, s36, v20
    v_lshlrev_b32 v50, 16, v21
    v_and_b32 v51, s36, v21
    v_lshlrev_b32 v52, 16, v22
    v_and_b32 v53, s36, v22
    v_lshlrev_b32 v54, 16, v23
    v_and_b32 v55, s36, v23
    v_lshlrev_b32 v56, 16, v24
    v_and_b32 v57, s36, v24
    v_lshlrev_b32 v58, 16, v25
    v_and_b32 v59, s36, v25
    v_lshlrev_b32 v60, 16, v26
    v_and_b32 v61, s36, v26
    v_lshlrev_b32 v62, 16, v27
    v_and_b32 v63, s36, v27
    v_mov_b32 v44, 0
    v_dot2c_f32_bf16 v44, s37, v28
    v_dot2c_f32_bf16 v44, s37, v29
    v_dot2c_f32_bf16 v44, s37, v30
    v_dot2c_f32_bf16 v44, s37, v31
    v_dot2c_f32_bf16 v44, s37, v32
    v_dot2c_f32_bf16 v44, s37, v33
    v_dot2c_f32_bf16 v44, s37, v34
    v_dot2c_f32_bf16 v44, s37, v35
    s_nop 2
    v_add_f32_dpp v44, v44, v44 quad_perm:[1,0,3,2] row_mask:0xf bank_mask:0xf
    s_nop 1
    v_add_f32_dpp v44, v44, v44 quad_perm:[2,3,0,1] row_mask:0xf bank_mask:0xf
    s_nop 1
    v_add_f32_dpp v44, v44, v44 row_half_mirror row_mask:0xf bank_mask:0xf
    s_nop 1
    v_add_f32_dpp v44, v44, v44 row_mirror row_mask:0xf bank_mask:0xf
    s_nop 1
    v_add_f32_dpp v44, v44, v44 row_bcast:15 row_mask:0xa bank_mask:0xf
    s_nop 1
    v_add_f32_dpp v44, v44, v44 row_bcast:31 row_mask:0xc bank_mask:0xf
    s_nop 0
    v_readlane_b32 s39, v44, 63
    s_and_b32 s13, s18, 1
    s_mul_i32 s40, s13, 0x80008000
    s_branch fk_chkr1
    s_nop 1
fk_pollr1:
    buffer_load_dword v47, v12, s[24:27], s23 offen sc1
fk_chkr1:
    s_add_u32 s42, s42, 1
    s_waitcnt vmcnt(0)
    v_cmp_eq_u32 vcc, -1, v47
    s_cbranch_vccz fk_gotr1
    s_cmp_le_u32 s42, 0x40000
    s_cbranch_scc1 fk_pollr1
    s_nop 1
fk_gotr1:
    v_xor_b32 v47, s40, v47
    s_mov_b32 s42, 0
    s_nop 3
fk_polly:
    buffer_load_dwordx4 v[36:39], v4, s[24:27], s17 offen sc1
    s_add_u32 s42, s42, 1
    s_waitcnt vmcnt(0)
    v_max3_u32 v46, v36, v37, v38
    v_max_u32 v46, v46, v39
    v_cmp_eq_u32 vcc, -1, v46
    s_cbranch_vccz fk_goty
    s_cmp_le_u32 s42, 0x40000
    s_cbranch_scc1 fk_polly
    s_nop 1
fk_goty:
    v_pk_add_f16 v36, v36, v47
    v_pk_add_f16 v37, v37, v47
    v_pk_add_f16 v38, v38, v47
    v_pk_add_f16 v39, v39, v47
    ds_write_b16 v9, v36 offset:0
    ds_write_b16_d16_hi v10, v36 offset:0
    ds_write_b16 v9, v37 offset:2064
    ds_write_b16_d16_hi v10, v37 offset:2064
    ds_write_b16 v9, v38 offset:4128
    ds_write_b16_d16_hi v10, v38 offset:4128
    ds_write_b16 v9, v39 offset:6192
    ds_write_b16_d16_hi v10, v39 offset:6192
    s_mul_i32 s15, s16, 4
    s_add_u32 s15, s15, 0
    s_lshl_b32 s12, s15, 10
    s_add_u32 s12, s12, 32768
    s_mul_i32 s13, s15, 57344
    s_add_u32 s13, s13, s99
    v_xor_b32 v209, 64, v208
    v_mov_b32 v2, 0
    v_mov_b32 v3, 0
    v_mov_b32 v4, 0
    v_mov_b32 v7, 0
    v_mov_b32 v12, 157120
    s_waitcnt lgkmcnt(0)
    s_barrier
    ds_read_b128 v[36:39], v5
    ds_read_b128 v[40:43], v11
    ds_read_b32 v44, v6
    s_cmp_gt_u32 s3, 223
    s_cbranch_scc1 fk_wsc
    s_mov_b32 m0, s12
    s_nop 0
    buffer_load_dwordx4 v208, s[48:51], s13 offen lds
    s_add_u32 s12, s12, 1024
    s_add_u32 s13, s13, 57344
    s_mov_b32 m0, s12
    s_nop 0
    buffer_load_dwordx4 v209, s[48:51], s13 offen lds
    s_add_u32 s12, s12, 1024
    s_add_u32 s13, s13, 57344
    s_mov_b32 m0, s12
    s_nop 0
    buffer_load_dwordx4 v208, s[48:51], s13 offen lds
    s_add_u32 s12, s12, 1024
    s_add_u32 s13, s13, 57344
    s_mov_b32 m0, s12
    s_nop 0
    buffer_load_dwordx4 v209, s[48:51], s13 offen lds
fk_wsc:
    s_waitcnt lgkmcnt(2)
    v_fma_mix_f32 v48, v36, s38, v48 op_sel:[0,0,0] op_sel_hi:[1,0,0]
    v_fma_mix_f32 v49, v36, s38, v49 op_sel:[1,0,0] op_sel_hi:[1,0,0]
    v_fma_mix_f32 v50, v37, s38, v50 op_sel:[0,0,0] op_sel_hi:[1,0,0]
    v_fma_mix_f32 v51, v37, s38, v51 op_sel:[1,0,0] op_sel_hi:[1,0,0]
    v_fma_mix_f32 v52, v38, s38, v52 op_sel:[0,0,0] op_sel_hi:[1,0,0]
    v_fma_mix_f32 v53, v38, s38, v53 op_sel:[1,0,0] op_sel_hi:[1,0,0]
    v_fma_mix_f32 v54, v39, s38, v54 op_sel:[0,0,0] op_sel_hi:[1,0,0]
    v_fma_mix_f32 v55, v39, s38, v55 op_sel:[1,0,0] op_sel_hi:[1,0,0]
    s_waitcnt lgkmcnt(0)
    v_readfirstlane_b32 s13, v44
    v_mov_b32_dpp v8, v40 wave_shr:1 row_mask:0xf bank_mask:0xf
    v_fma_mix_f32 v57, v43, s38, v57 op_sel:[1,0,0] op_sel_hi:[1,0,0]
    v_fma_mix_f32 v58, v43, s38, v58 op_sel:[0,0,0] op_sel_hi:[1,0,0]
    v_fma_mix_f32 v59, v42, s38, v59 op_sel:[1,0,0] op_sel_hi:[1,0,0]
    v_fma_mix_f32 v60, v42, s38, v60 op_sel:[0,0,0] op_sel_hi:[1,0,0]
    v_writelane_b32 v8, s13, 0
    v_fma_mix_f32 v61, v41, s38, v61 op_sel:[1,0,0] op_sel_hi:[1,0,0]
    v_fma_mix_f32 v62, v41, s38, v62 op_sel:[0,0,0] op_sel_hi:[1,0,0]
    v_fma_mix_f32 v63, v40, s38, v63 op_sel:[1,0,0] op_sel_hi:[1,0,0]
    v_fma_mix_f32 v56, v8, s38, v56 op_sel:[0,0,0] op_sel_hi:[1,0,0]
    v_cvt_pk_bf16_f32 v80, v48, v49
    v_cvt_pk_bf16_f32 v81, v50, v51
    v_cvt_pk_bf16_f32 v82, v52, v53
    v_cvt_pk_bf16_f32 v83, v54, v55
    v_cvt_pk_bf16_f32 v85, v58, v59
    v_cvt_pk_bf16_f32 v86, v60, v61
    v_cvt_pk_bf16_f32 v87, v62, v63
    v_cvt_pk_bf16_f32 v84, v56, v57
    v_dot2c_f32_bf16 v2, s37, v80
    v_dot2c_f32_bf16 v3, v80, v80
    v_dot2c_f32_bf16 v4, v80, v28
    v_dot2c_f32_bf16 v2, s37, v81
    v_dot2c_f32_bf16 v3, v81, v81
    v_dot2c_f32_bf16 v4, v81, v29
    v_dot2c_f32_bf16 v2, s37, v82
    v_dot2c_f32_bf16 v3, v82, v82
    v_dot2c_f32_bf16 v4, v82, v30
    v_dot2c_f32_bf16 v2, s37, v83
    v_dot2c_f32_bf16 v3, v83, v83
    v_dot2c_f32_bf16 v4, v83, v31
    v_dot2c_f32_bf16 v2, s37, v85
    v_dot2c_f32_bf16 v3, v85, v85
    v_dot2c_f32_bf16 v4, v85, v33
    v_dot2c_f32_bf16 v2, s37, v86
    v_dot2c_f32_bf16 v3, v86, v86
    v_dot2c_f32_bf16 v4, v86, v34
    v_dot2c_f32_bf16 v2, s37, v87
    v_dot2c_f32_bf16 v3, v87, v87
    v_dot2c_f32_bf16 v4, v87, v35
    v_dot2c_f32_bf16 v2, s37, v84
    v_dot2c_f32_bf16 v3, v84, v84
    v_dot2c_f32_bf16 v4, v84, v32
    s_nop 2
    v_permlane32_swap_b32 v2, v4
    v_permlane32_swap_b32 v3, v7
    v_add_f32 v2, v2, v4
    v_add_f32 v3, v3, v7
    s_nop 1
    v_permlane16_swap_b32 v2, v3
    v_add_f32 v2, v2, v3
    s_nop 1
    v_add_f32_dpp v2, v2, v2 quad_perm:[1,0,3,2] row_mask:0xf bank_mask:0xf
    s_nop 1
    v_add_f32_dpp v2, v2, v2 quad_perm:[2,3,0,1] row_mask:0xf bank_mask:0xf
    s_nop 1
    v_add_f32_dpp v2, v2, v2 row_half_mirror row_mask:0xf bank_mask:0xf
    s_nop 1
    v_add_f32_dpp v2, v2, v2 row_mirror row_mask:0xf bank_mask:0xf
    s_nop 0
    v_readlane_b32 s13, v2, 32
    v_mov_b32_dpp v8, v2 row_bcast:15 row_mask:0xa bank_mask:0xf
    v_mul_f32 v9, 0x3a800000, v2
    v_mul_f32 v8, 0x3a800000, v8
    v_fma_f32 v9, -v8, v8, v9
    v_max_f32 v9, 0, v9
    v_cvt_pk_bf16_f32 v9, 0, v9
    v_cvt_pk_bf16_f32 v8, 0, v8
    v_add_f32 v9, 0x3727c5ac, v9
    v_cvt_pk_bf16_f32 v9, 0, v9
    v_sqrt_f32 v9, v9
    s_nop 0
    v_cvt_pk_bf16_f32 v9, 0, v9
    v_rcp_f32 v9, v9
    v_mov_b32 v10, s13
    v_fma_f32 v10, -v8, s39, v10
    v_mul_f32 v10, v10, v9
    v_mul_f32 v8, v8, v9
    v_readlane_b32 s43, v10, 16
    v_readlane_b32 s4, v9, 16
    v_readlane_b32 s6, v8, 16
    s_ashr_i32 s13, s43, 31
    s_or_b32 s13, s13, 0x80000000
    s_xor_b32 s43, s43, s13
    s_and_b32 s43, s43, 0xfffff800
    s_or_b32 s43, s43, s19
    s_min_u32 s43, s43, -2
    v_mov_b32 v2, s43
    s_mov_b64 exec, 1
    ds_max_u32 v12, v2
    s_mov_b64 exec, -1
    v_mov_b32 v10, s6
    v_add_f32 v8, 1.0, v9
    v_lshlrev_b32 v4, 12, v15
    s_lshl_b32 s17, s3, 4
    s_add_u32 s17, s17, 0x9000
    v_readlane_b32 s14, v8, 16
    s_waitcnt lgkmcnt(0)
    s_barrier
    ds_read_b32 v3, v12
    v_lshlrev_b32 v48, 16, v80
    v_and_b32 v49, s36, v80
    v_lshlrev_b32 v50, 16, v81
    v_and_b32 v51, s36, v81
    v_lshlrev_b32 v52, 16, v82
    v_and_b32 v53, s36, v82
    v_lshlrev_b32 v54, 16, v83
    v_and_b32 v55, s36, v83
    v_lshlrev_b32 v56, 16, v84
    v_and_b32 v57, s36, v84
    v_lshlrev_b32 v58, 16, v85
    v_and_b32 v59, s36, v85
    v_lshlrev_b32 v60, 16, v86
    v_and_b32 v61, s36, v86
    v_lshlrev_b32 v62, 16, v87
    v_and_b32 v63, s36, v87
    s_waitcnt lgkmcnt(0)
    v_readfirstlane_b32 s13, v3
    s_nop 1
    s_cmp_lg_u32 s13, s43
    s_cbranch_scc1 fk_other
    s_mov_b64 exec, 0xff
    buffer_store_dword v2, v4, s[24:27], s17 offen sc1
    s_mov_b64 exec, -1
    v_pk_fma_f32 v[64:65], v[48:49], s[4:5], v[10:11] op_sel_hi:[1,0,0] neg_lo:[0,0,1] neg_hi:[0,0,1]
    v_pk_fma_f32 v[66:67], v[50:51], s[4:5], v[10:11] op_sel_hi:[1,0,0] neg_lo:[0,0,1] neg_hi:[0,0,1]
    v_pk_fma_f32 v[68:69], v[52:53], s[4:5], v[10:11] op_sel_hi:[1,0,0] neg_lo:[0,0,1] neg_hi:[0,0,1]
    v_pk_fma_f32 v[70:71], v[54:55], s[4:5], v[10:11] op_sel_hi:[1,0,0] neg_lo:[0,0,1] neg_hi:[0,0,1]
    v_pk_fma_f32 v[72:73], v[56:57], s[4:5], v[10:11] op_sel_hi:[1,0,0] neg_lo:[0,0,1] neg_hi:[0,0,1]
    v_pk_fma_f32 v[74:75], v[58:59], s[4:5], v[10:11] op_sel_hi:[1,0,0] neg_lo:[0,0,1] neg_hi:[0,0,1]
    v_pk_fma_f32 v[76:77], v[60:61], s[4:5], v[10:11] op_sel_hi:[1,0,0] neg_lo:[0,0,1] neg_hi:[0,0,1]
    v_pk_fma_f32 v[78:79], v[62:63], s[4:5], v[10:11] op_sel_hi:[1,0,0] neg_lo:[0,0,1] neg_hi:[0,0,1]
    v_cvt_pk_bf16_f32 v96, v64, v65
    v_cvt_pk_bf16_f32 v97, v66, v67
    v_cvt_pk_bf16_f32 v98, v68, v69
    v_cvt_pk_bf16_f32 v99, v70, v71
    v_cvt_pk_bf16_f32 v100, v72, v73
    v_cvt_pk_bf16_f32 v101, v74, v75
    v_cvt_pk_bf16_f32 v102, v76, v77
    v_cvt_pk_bf16_f32 v103, v78, v79
    v_min_u32 v96, -2, v96
    v_min_u32 v97, -2, v97
    v_min_u32 v98, -2, v98
    v_min_u32 v99, -2, v99
    v_min_u32 v100, -2, v100
    v_min_u32 v101, -2, v101
    v_min_u32 v102, -2, v102
    v_min_u32 v103, -2, v103
    s_mul_i32 s13, s3, 9344
    s_add_u32 s13, s13, 0x470000
    buffer_store_dwordx4 v[96:99], v14, s[24:27], s13 offen sc1
    buffer_store_dwordx4 v[100:103], v14, s[24:27], s13 offen offset:1024 sc1
    v_min_u32 v80, -2, v80
    v_min_u32 v81, -2, v81
    v_min_u32 v82, -2, v82
    v_min_u32 v83, -2, v83
    v_min_u32 v84, -2, v84
    v_min_u32 v85, -2, v85
    v_min_u32 v86, -2, v86
    v_min_u32 v87, -2, v87
    buffer_store_dwordx4 v[80:83], v14, s[24:27], s13 offen offset:2048 sc1
    buffer_store_dwordx4 v[84:87], v14, s[24:27], s13 offen offset:3072 sc1
    v_pk_fma_f32 v[64:65], v[48:49], s[14:15], v[10:11] op_sel_hi:[1,0,0] neg_lo:[0,0,1] neg_hi:[0,0,1]
    v_pk_fma_f32 v[66:67], v[50:51], s[14:15], v[10:11] op_sel_hi:[1,0,0] neg_lo:[0,0,1] neg_hi:[0,0,1]
    v_pk_fma_f32 v[68:69], v[52:53], s[14:15], v[10:11] op_sel_hi:[1,0,0] neg_lo:[0,0,1] neg_hi:[0,0,1]
    v_pk_fma_f32 v[70:71], v[54:55], s[14:15], v[10:11] op_sel_hi:[1,0,0] neg_lo:[0,0,1] neg_hi:[0,0,1]
    v_pk_fma_f32 v[72:73], v[56:57], s[14:15], v[10:11] op_sel_hi:[1,0,0] neg_lo:[0,0,1] neg_hi:[0,0,1]
    v_pk_fma_f32 v[74:75], v[58:59], s[14:15], v[10:11] op_sel_hi:[1,0,0] neg_lo:[0,0,1] neg_hi:[0,0,1]
    v_pk_fma_f32 v[76:77], v[60:61], s[14:15], v[10:11] op_sel_hi:[1,0,0] neg_lo:[0,0,1] neg_hi:[0,0,1]
    v_pk_fma_f32 v[78:79], v[62:63], s[14:15], v[10:11] op_sel_hi:[1,0,0] neg_lo:[0,0,1] neg_hi:[0,0,1]
    v_cvt_pk_bf16_f32 v112, v64, v65
    v_cvt_pk_bf16_f32 v113, v66, v67
    v_cvt_pk_bf16_f32 v114, v68, v69
    v_cvt_pk_bf16_f32 v115, v70, v71
    v_cvt_pk_bf16_f32 v116, v72, v73
    v_cvt_pk_bf16_f32 v117, v74, v75
    v_cvt_pk_bf16_f32 v118, v76, v77
    v_cvt_pk_bf16_f32 v119, v78, v79
    v_lshrrev_b32 v1, 4, v15
    v_bfe_u32 v2, v15, 2, 2
    v_lshl_add_u32 v8, v1, 3, v2
    v_lshlrev_b32 v8, 7, v8
    v_and_b32 v3, 2, v2
    v_xor_b32 v9, s16, v3
    v_and_b32 v3, 1, v1
    v_lshlrev_b32 v4, 2, v3
    v_xor_b32 v9, v4, v9
    v_lshl_add_u32 v8, v9, 4, v8
    v_and_b32 v9, 1, v15
    v_lshl_add_u32 v8, v9, 3, v8
    v_bfe_u32 v9, v15, 1, 1
    v_lshl_add_u32 v8, v9, 15, v8
    v_lshrrev_b32 v7, 1, v1
    v_lshl_add_u32 v7, v7, 3, v2
    v_lshlrev_b32 v7, 9, v7
    v_lshl_add_u32 v7, v3, 5, v7
    v_and_b32 v3, 3, v15
    v_lshl_add_u32 v7, v3, 3, v7
    s_lshl_b32 s15, s16, 6
    s_add_u32 s15, s15, 65536
    v_add_u32 v7, s15, v7
    v_lshlrev_b32 v9, 4, v1
    v_add_u32 v9, 157312, v9
    s_and_b32 s13, s2, 7
    s_lshl_b32 s13, s13, 12
    s_add_u32 s13, s13, 0x9000
    s_mov_b32 s42, 0
    s_waitcnt vmcnt(4)
    v_mov_b32 v1, 157872
    v_mov_b32 v2, 1
    s_mov_b64 exec, 1
    ds_add_u32 v1, v2
    s_mov_b64 exec, -1
    s_nop 1
fk_pollk:
    buffer_load_dword v180, v14, s[24:27], s13 offen offset:0 sc1
    buffer_load_dword v181, v14, s[24:27], s13 offen offset:1024 sc1
    buffer_load_dword v182, v14, s[24:27], s13 offen offset:2048 sc1
    buffer_load_dword v183, v14, s[24:27], s13 offen offset:3072 sc1
    s_add_u32 s42, s42, 1
    s_waitcnt vmcnt(0)
    v_max3_u32 v3, v180, v181, v182
    v_max_u32 v3, v3, v183
    v_cmp_eq_u32 vcc, -1, v3
    s_cbranch_vccz fk_gotk
    s_cmp_le_u32 s42, 0x40000
    s_cbranch_scc1 fk_pollk
    s_nop 1
fk_gotk:
    v_max_u32_dpp v3, v3, v3 quad_perm:[1,0,3,2] row_mask:0xf bank_mask:0xf
    s_nop 1
    v_max_u32_dpp v3, v3, v3 quad_perm:[2,3,0,1] row_mask:0xf bank_mask:0xf
    s_nop 1
    v_max_u32_dpp v3, v3, v3 row_half_mirror row_mask:0xf bank_mask:0xf
    s_nop 1
    v_max_u32_dpp v3, v3, v3 row_mirror row_mask:0xf bank_mask:0xf
    s_nop 1
    v_max_u32_dpp v3, v3, v3 row_bcast:15 row_mask:0xa bank_mask:0xf
    s_nop 1
    v_max_u32_dpp v3, v3, v3 row_bcast:31 row_mask:0xc bank_mask:0xf
    s_nop 0
    v_readlane_b32 s40, v3, 63
    v_mov_b32 v4, 157136
    s_nop 0
    s_bfe_u32 s13, s40, 0x80003
    s_mul_i32 s13, s13, 9344
    s_and_b32 s14, s3, 3
    s_lshl_b32 s14, s14, 9
    s_add_u32 s13, s13, s14
    s_add_u32 s13, s13, 0x470000
    v_lshlrev_b32 v5, 3, v15
    v_mov_b32 v3, s40
    s_cmp_gt_u32 s3, 223
    s_cbranch_scc1 fk_norow
    s_mov_b32 s42, 0
    buffer_load_dwordx2 v[180:181], v5, s[24:27], s13 offen sc1
    s_nop 0
fk_landa:
    ds_read_b32 v2, v1
    s_waitcnt lgkmcnt(0)
    v_readfirstlane_b32 s15, v2
    s_nop 1
    s_cmp_lt_u32 s15, 8
    s_cbranch_scc1 fk_landa
    ds_read_b64_tr_b16 v[128:129], v8 offset:0
    ds_read_b64_tr_b16 v[130:131], v8 offset:512
    ds_read_b64_tr_b16 v[132:133], v8 offset:4096
    ds_read_b64_tr_b16 v[134:135], v8 offset:4608
    ds_read_b64_tr_b16 v[136:137], v8 offset:8192
    ds_read_b64_tr_b16 v[138:139], v8 offset:8704
    ds_read_b64_tr_b16 v[140:141], v8 offset:12288
    ds_read_b64_tr_b16 v[142:143], v8 offset:12800
    ds_read_b64_tr_b16 v[144:145], v8 offset:16384
    ds_read_b64_tr_b16 v[146:147], v8 offset:16896
    ds_read_b64_tr_b16 v[148:149], v8 offset:20480
    ds_read_b64_tr_b16 v[150:151], v8 offset:20992
    s_waitcnt lgkmcnt(4)
    ds_read_b64_tr_b16 v[152:153], v8 offset:24576
    ds_read_b64_tr_b16 v[154:155], v8 offset:25088
    ds_read_b64_tr_b16 v[156:157], v8 offset:28672
    ds_read_b64_tr_b16 v[158:159], v8 offset:29184
    s_branch fk_chkr
    s_nop 0
fk_pollr:
    buffer_load_dwordx2 v[180:181], v5, s[24:27], s13 offen sc1
fk_chkr:
    s_add_u32 s42, s42, 1
    s_waitcnt vmcnt(0)
    v_max_u32 v6, v180, v181
    v_cmp_eq_u32 vcc, -1, v6
    s_cbranch_vccz fk_gotr
    s_cmp_le_u32 s42, 0x40000
    s_cbranch_scc1 fk_pollr
    s_nop 1
fk_gotr:
    v_add_u32 v5, 157312, v5
    ds_write_b64 v5, v[180:181]
    s_nop 3
fk_norow:
    ds_write_b32 v4, v3
    s_waitcnt lgkmcnt(0)
    s_barrier
    s_cmp_eq_u32 s40, s43
    s_cselect_b32 s22, 0x400000, s22
    s_branch fk_ffn
    s_nop 0
fk_other:
    v_pk_fma_f32 v[64:65], v[48:49], s[14:15], v[10:11] op_sel_hi:[1,0,0] neg_lo:[0,0,1] neg_hi:[0,0,1]
    v_pk_fma_f32 v[66:67], v[50:51], s[14:15], v[10:11] op_sel_hi:[1,0,0] neg_lo:[0,0,1] neg_hi:[0,0,1]
    v_pk_fma_f32 v[68:69], v[52:53], s[14:15], v[10:11] op_sel_hi:[1,0,0] neg_lo:[0,0,1] neg_hi:[0,0,1]
    v_pk_fma_f32 v[70:71], v[54:55], s[14:15], v[10:11] op_sel_hi:[1,0,0] neg_lo:[0,0,1] neg_hi:[0,0,1]
    v_pk_fma_f32 v[72:73], v[56:57], s[14:15], v[10:11] op_sel_hi:[1,0,0] neg_lo:[0,0,1] neg_hi:[0,0,1]
    v_pk_fma_f32 v[74:75], v[58:59], s[14:15], v[10:11] op_sel_hi:[1,0,0] neg_lo:[0,0,1] neg_hi:[0,0,1]
    v_pk_fma_f32 v[76:77], v[60:61], s[14:15], v[10:11] op_sel_hi:[1,0,0] neg_lo:[0,0,1] neg_hi:[0,0,1]
    v_pk_fma_f32 v[78:79], v[62:63], s[14:15], v[10:11] op_sel_hi:[1,0,0] neg_lo:[0,0,1] neg_hi:[0,0,1]
    v_cvt_pk_bf16_f32 v112, v64, v65
    v_cvt_pk_bf16_f32 v113, v66, v67
    v_cvt_pk_bf16_f32 v114, v68, v69
    v_cvt_pk_bf16_f32 v115, v70, v71
    v_cvt_pk_bf16_f32 v116, v72, v73
    v_cvt_pk_bf16_f32 v117, v74, v75
    v_cvt_pk_bf16_f32 v118, v76, v77
    v_cvt_pk_bf16_f32 v119, v78, v79
    s_and_b32 s13, s13, 7
    s_cmp_gt_u32 s16, s13
    s_cselect_b32 s13, 1, 0
    s_sub_u32 s17, s16, s13
    s_waitcnt vmcnt(0)
    v_lshrrev_b32 v1, 4, v15
    v_bfe_u32 v2, v15, 2, 2
    v_lshl_add_u32 v8, v1, 3, v2
    v_lshlrev_b32 v8, 7, v8
    v_and_b32 v3, 2, v2
    v_xor_b32 v9, s16, v3
    v_and_b32 v3, 1, v1
    v_lshlrev_b32 v4, 2, v3
    v_xor_b32 v9, v4, v9
    v_lshl_add_u32 v8, v9, 4, v8
    v_and_b32 v9, 1, v15
    v_lshl_add_u32 v8, v9, 3, v8
    v_bfe_u32 v9, v15, 1, 1
    v_lshl_add_u32 v8, v9, 15, v8
    v_lshrrev_b32 v7, 1, v1
    v_lshl_add_u32 v7, v7, 3, v2
    v_lshlrev_b32 v7, 9, v7
    v_lshl_add_u32 v7, v3, 5, v7
    v_and_b32 v3, 3, v15
    v_lshl_add_u32 v7, v3, 3, v7
    s_lshl_b32 s15, s16, 6
    s_add_u32 s15, s15, 65536
    v_add_u32 v7, s15, v7
    v_lshlrev_b32 v9, 4, v1
    v_add_u32 v9, 157312, v9
    v_mov_b32 v1, 157872
    v_mov_b32 v2, 1
    s_mov_b64 exec, 1
    ds_add_u32 v1, v2
    s_mov_b64 exec, -1
    s_mul_i32 s15, s17, 4
    s_add_u32 s15, s15, 8
    s_lshl_b32 s12, s15, 10
    s_add_u32 s12, s12, 65536
    s_mul_i32 s13, s15, 4096
    s_add_u32 s13, s13, s101
    s_cmp_gt_u32 s3, 223
    s_cbranch_scc1 fk_wsd
    s_mov_b32 m0, s12
    s_cmp_gt_u32 s12, 97280
    s_cbranch_scc1 fk_wsd
    buffer_load_dwordx4 v210, s[52:55], s13 offen lds
    s_add_u32 s12, s12, 1024
    s_add_u32 s13, s13, 4096
    s_mov_b32 m0, s12
    s_cmp_gt_u32 s12, 97280
    s_cbranch_scc1 fk_wsd
    buffer_load_dwordx4 v210, s[52:55], s13 offen lds
    s_add_u32 s12, s12, 1024
    s_add_u32 s13, s13, 4096
    s_mov_b32 m0, s12
    s_cmp_gt_u32 s12, 97280
    s_cbranch_scc1 fk_wsd
    buffer_load_dwordx4 v210, s[52:55], s13 offen lds
    s_add_u32 s12, s12, 1024
    s_add_u32 s13, s13, 4096
    s_mov_b32 m0, s12
    s_cmp_gt_u32 s12, 97280
    s_cbranch_scc1 fk_wsd
    buffer_load_dwordx4 v210, s[52:55], s13 offen lds
fk_wsd:
fk_landb:
    ds_read_b32 v2, v1
    s_waitcnt lgkmcnt(0)
    v_readfirstlane_b32 s15, v2
    s_nop 1
    s_cmp_lt_u32 s15, 8
    s_cbranch_scc1 fk_landb
    ds_read_b64_tr_b16 v[128:129], v8 offset:0
    ds_read_b64_tr_b16 v[130:131], v8 offset:512
    ds_read_b64_tr_b16 v[132:133], v8 offset:4096
    ds_read_b64_tr_b16 v[134:135], v8 offset:4608
    ds_read_b64_tr_b16 v[136:137], v8 offset:8192
    ds_read_b64_tr_b16 v[138:139], v8 offset:8704
    ds_read_b64_tr_b16 v[140:141], v8 offset:12288
    ds_read_b64_tr_b16 v[142:143], v8 offset:12800
    ds_read_b64_tr_b16 v[144:145], v8 offset:16384
    ds_read_b64_tr_b16 v[146:147], v8 offset:16896
    ds_read_b64_tr_b16 v[148:149], v8 offset:20480
    ds_read_b64_tr_b16 v[150:151], v8 offset:20992
    s_waitcnt lgkmcnt(4)
    ds_read_b64_tr_b16 v[152:153], v8 offset:24576
    ds_read_b64_tr_b16 v[154:155], v8 offset:25088
    ds_read_b64_tr_b16 v[156:157], v8 offset:28672
    ds_read_b64_tr_b16 v[158:159], v8 offset:29184
    s_waitcnt vmcnt(0) lgkmcnt(0)
    s_barrier
    s_nop 0
fk_ffn:
    buffer_store_dwordx4 v[112:115], v14, s[28:31], s22 offen nt
    buffer_store_dwordx4 v[116:119], v14, s[28:31], s22 offen offset:1024 nt
    s_cmp_gt_u32 s3, 223
    s_cbranch_scc1 fk_fin
    ds_read_b128 v[16:19], v9 offset:0
    ds_read_b128 v[20:23], v9 offset:64
    ds_read_b128 v[24:27], v9 offset:128
    ds_read_b128 v[28:31], v9 offset:192
    ds_read_b128 v[32:35], v9 offset:256
    ds_read_b128 v[36:39], v9 offset:320
    ds_read_b128 v[40:43], v9 offset:384
    ds_read_b128 v[44:47], v9 offset:448
    v_mov_b32 v3, 157136
    ds_read_b32 v12, v3
    v_lshlrev_b32 v4, 3, v15
    s_mul_i32 s41, s3, 9344
    s_lshl_b32 s14, s16, 6
    s_add_u32 s13, s41, s14
    s_add_u32 s13, s13, 0x471000
    s_waitcnt lgkmcnt(8)
    v_mfma_f32_16x16x32_bf16 v[176:179], v[16:19], v[128:131], 0
    s_waitcnt lgkmcnt(7)
    v_mfma_f32_16x16x32_bf16 v[176:179], v[20:23], v[132:135], v[176:179]
    s_waitcnt lgkmcnt(6)
    v_mfma_f32_16x16x32_bf16 v[176:179], v[24:27], v[136:139], v[176:179]
    s_waitcnt lgkmcnt(5)
    v_mfma_f32_16x16x32_bf16 v[176:179], v[28:31], v[140:143], v[176:179]
    s_waitcnt lgkmcnt(4)
    v_mfma_f32_16x16x32_bf16 v[176:179], v[32:35], v[144:147], v[176:179]
    s_waitcnt lgkmcnt(3)
    v_mfma_f32_16x16x32_bf16 v[176:179], v[36:39], v[148:151], v[176:179]
    s_waitcnt lgkmcnt(2)
    v_mfma_f32_16x16x32_bf16 v[176:179], v[40:43], v[152:155], v[176:179]
    s_waitcnt lgkmcnt(1)
    v_mfma_f32_16x16x32_bf16 v[176:179], v[44:47], v[156:159], v[176:179]
    v_lshlrev_b32 v5, 3, v15
    v_lshlrev_b32 v6, 2, v15
    v_lshrrev_b32 v9, 5, v15
    v_lshlrev_b32 v9, 4, v9
    v_add_u32 v9, 157184, v9
    s_lshl_b32 s14, s16, 7
    s_add_u32 s41, s41, s14
    s_add_u32 s41, s41, 0x471400
    v_min_u32 v176, -2, v176
    s_nop 1
    v_mov_b32_dpp v177, v176 row_shl:8 row_mask:0xf bank_mask:0xf
    v_mov_b32_dpp v178, v176 row_shl:1 row_mask:0xf bank_mask:0xf
    v_mov_b32_dpp v179, v176 row_shl:9 row_mask:0xf bank_mask:0xf
    s_mov_b64 exec, 0x55
    buffer_store_dwordx4 v[176:179], v4, s[24:27], s13 offen sc1
    s_mov_b64 exec, -1
    v_mov_b32 v1, 157876
    v_mov_b32 v8, 1
    ds_read_b64_tr_b16 v[160:161], v7 offset:0
    ds_read_b64_tr_b16 v[162:163], v7 offset:2048
    ds_read_b64_tr_b16 v[164:165], v7 offset:8192
    ds_read_b64_tr_b16 v[166:167], v7 offset:10240
    ds_read_b64_tr_b16 v[168:169], v7 offset:16384
    ds_read_b64_tr_b16 v[170:171], v7 offset:18432
    ds_read_b64_tr_b16 v[172:173], v7 offset:24576
    ds_read_b64_tr_b16 v[174:175], v7 offset:26624
    s_cmp_eq_u32 s16, 7
    s_cbranch_scc1 fk_c1
    s_cmp_lg_u32 s16, 0
    s_cbranch_scc1 fk_wait1
    s_and_b32 s13, s3, -4
    s_mul_i32 s13, s13, 9344
    s_add_u32 s36, s13, 0x471000
    s_add_u32 s37, s36, 9344
    s_add_u32 s38, s36, 18688
    s_add_u32 s39, s36, 28032
    s_mov_b32 s42, 0
    v_lshrrev_b32 v10, 2, v5
    v_add_u32 v10, 157184, v10
    s_waitcnt vmcnt(0)
    s_nop 3
fk_poll1:
    buffer_load_dwordx2 v[184:185], v5, s[24:27], s36 offen sc1
    buffer_load_dwordx2 v[186:187], v5, s[24:27], s37 offen sc1
    buffer_load_dwordx2 v[188:189], v5, s[24:27], s38 offen sc1
    buffer_load_dwordx2 v[190:191], v5, s[24:27], s39 offen sc1
    s_add_u32 s42, s42, 1
    s_waitcnt vmcnt(0)
    v_max3_u32 v11, v184, v185, v186
    v_max3_u32 v11, v11, v187, v188
    v_max3_u32 v11, v11, v189, v190
    v_max_u32 v11, v11, v191
    v_cmp_eq_u32 vcc, -1, v11
    s_cbranch_vccz fk_got1
    s_cmp_le_u32 s42, 0x40000
    s_cbranch_scc1 fk_poll1
    s_nop 1
fk_got1:
    v_pk_add_f32 v[184:185], v[184:185], v[186:187]
    v_pk_add_f32 v[188:189], v[188:189], v[190:191]
    v_pk_add_f32 v[184:185], v[184:185], v[188:189]
    v_cvt_pk_bf16_f32 v184, 0, v184
    v_cvt_pk_bf16_f32 v185, 0, v185
    v_mul_f32 v186, 0xbfb8aa3b, v184
    v_exp_f32 v186, v186
    s_nop 0
    v_add_f32 v186, 1.0, v186
    v_rcp_f32 v186, v186
    s_nop 0
    v_mul_f32 v184, v184, v186
    v_cvt_pk_bf16_f32 v184, 0, v184
    v_mul_f32 v184, v184, v185
    v_cvt_pk_bf16_f32 v184, 0, v184
    ds_write_b16_d16_hi v10, v184
    s_branch fk_wait1
    s_nop 2
fk_c1:
    s_cmp_gt_u32 s3, 127
    s_cbranch_scc1 fk_wait1
    s_waitcnt lgkmcnt(0)
    v_readfirstlane_b32 s40, v12
    v_lshrrev_b32 v10, 4, v15
    v_and_b32 v11, 1, v15
    v_lshl_add_u32 v12, v11, 2, v10
    v_lshlrev_b32 v12, 1, v12
    v_and_b32 v11, 12, v12
    v_and_b32 v10, 1, v10
    s_bfe_u32 s13, s40, 0x80003
    s_mul_i32 s14, s13, 9344
    s_lshl_b32 s15, s3, 4
    s_add_u32 s14, s14, s15
    s_add_u32 s14, s14, 0x470000
    s_mov_b32 s42, 0
    s_nop 0
fk_pollh:
    buffer_load_dword v2, v11, s[24:27], s14 offen sc1
    buffer_load_dword v3, v11, s[24:27], s14 offen offset:2048 sc1
    s_add_u32 s42, s42, 1
    s_waitcnt vmcnt(0)
    v_max_u32 v4, v2, v3
    v_cmp_eq_u32 vcc, -1, v4
    s_cbranch_vccz fk_goth
    s_cmp_le_u32 s42, 0x40000
    s_cbranch_scc1 fk_pollh
    s_nop 1
fk_goth:
    v_cmp_eq_u32 vcc, 1, v10
    v_lshlrev_b32 v4, 16, v2
    v_and_b32 v2, s36, v2
    v_cndmask_b32 v2, v4, v2, vcc
    v_lshlrev_b32 v4, 16, v3
    v_and_b32 v3, s36, v3
    v_cndmask_b32 v3, v4, v3, vcc
    s_lshr_b32 s14, s13, 4
    s_add_u32 s14, s14, 1
    s_cmp_ge_u32 s13, 248
    s_cselect_b32 s14, 0, s14
    s_cmp_ge_u32 s13, 240
    s_cselect_b32 s15, 7, 15
    s_and_b32 s15, s15, s13
    s_lshl_b32 s15, s15, 7
    s_add_u32 s14, s14, s15
    s_and_b32 s13, s40, 7
    s_sub_u32 s15, 7, s13
    s_min_u32 s15, s15, s13
    s_lshl_b32 s15, s15, 5
    s_add_u32 s14, s14, s15
    s_sub_u32 s15, 2048, s14
    s_and_b32 s15, s15, 2047
    s_cmp_lt_u32 s13, 4
    s_cselect_b32 s14, s14, s15
    s_and_b32 s13, s40, 0x7ff
    s_cmp_eq_u32 s13, 1991
    s_cselect_b32 s14, 1024, s14
    s_lshl_b32 s21, s14, 11
    s_lshl_b32 s15, s3, 4
    s_add_u32 s21, s21, s15
    s_ashr_i32 s13, s40, 31
    s_not_b32 s13, s13
    s_or_b32 s13, s13, 0x80000000
    s_xor_b32 s13, s40, s13
    s_and_b32 s13, s13, 0xfffff800
    v_mov_b32 v11, s13
    v_cvt_pk_bf16_f32 v11, 0, v11
    v_mul_f32 v11, 0xbfb8aa3b, v11
    v_exp_f32 v11, v11
    s_nop 0
    v_add_f32 v11, 1.0, v11
    v_rcp_f32 v11, v11
    s_nop 0
    v_cvt_pk_bf16_f32 v11, 0, v11
    v_lshrrev_b32 v4, 1, v15
    v_mul_u32_u24 v4, 37376, v4
    v_and_b32 v5, 1, v15
    v_lshl_add_u32 v4, v5, 4, v4
    v_add_u32 v5, 1196032, v4
    v_cmp_gt_u32 vcc, 48, v15
    s_nop 1
    v_cndmask_b32 v5, -16, v5, vcc
    s_lshr_b32 s40, s3, 5
    s_mul_i32 s40, s40, 9344
    s_and_b32 s15, s3, 31
    s_lshl_b32 s15, s15, 5
    s_add_u32 s40, s40, s15
    s_add_u32 s40, s40, 0x471400
    s_nop 0
fk_wait1:
    s_waitcnt lgkmcnt(0)
    s_barrier
    ds_read_b128 v[16:19], v9 offset:0
    ds_read_b128 v[20:23], v9 offset:32
    ds_read_b128 v[24:27], v9 offset:64
    ds_read_b128 v[28:31], v9 offset:96
    s_waitcnt lgkmcnt(3)
    v_mfma_f32_32x32x16_bf16 v[192:207], v[16:19], v[160:163], 0
    s_waitcnt lgkmcnt(2)
    v_mfma_f32_32x32x16_bf16 v[192:207], v[20:23], v[164:167], v[192:207]
    s_waitcnt lgkmcnt(1)
    v_mfma_f32_32x32x16_bf16 v[192:207], v[24:27], v[168:171], v[192:207]
    s_waitcnt lgkmcnt(0)
    v_mfma_f32_32x32x16_bf16 v[192:207], v[28:31], v[172:175], v[192:207]
    s_nop 11
    v_min_u32 v192, -2, v192
    s_nop 1
    v_mov_b32_dpp v193, v192 row_shl:1 row_mask:0xf bank_mask:0xf
    v_mov_b32_dpp v194, v192 row_shl:2 row_mask:0xf bank_mask:0xf
    v_mov_b32_dpp v195, v192 row_shl:3 row_mask:0xf bank_mask:0xf
    s_mov_b32 exec_lo, 0x11111111
    s_mov_b32 exec_hi, 0
    buffer_store_dwordx4 v[192:195], v6, s[24:27], s41 offen sc1
    s_mov_b64 exec, -1
    s_cmp_lg_u32 s16, 7
    s_cbranch_scc1 fk_fin
    s_cmp_gt_u32 s3, 127
    s_cbranch_scc1 fk_fin
    s_mov_b32 s42, 0
    s_waitcnt vmcnt(0)
    s_nop 0
fk_poll2:
    buffer_load_dwordx4 v[16:19], v4, s[24:27], s40 offen sc1
    buffer_load_dwordx4 v[20:23], v5, s[24:27], s40 offen sc1
    s_add_u32 s42, s42, 1
    s_waitcnt vmcnt(0)
    v_max3_u32 v6, v16, v17, v18
    v_max3_u32 v6, v6, v19, v20
    v_max3_u32 v6, v6, v21, v22
    v_max_u32 v6, v6, v23
    v_cmp_eq_u32 vcc, -1, v6
    s_cbranch_vccz fk_got2
    s_cmp_le_u32 s42, 0x40000
    s_cbranch_scc1 fk_poll2
    s_nop 1
fk_got2:
    v_pk_add_f32 v[16:17], v[16:17], v[20:21]
    v_pk_add_f32 v[18:19], v[18:19], v[22:23]
    s_nop 1
    v_permlane32_swap_b32 v16, v18
    v_permlane32_swap_b32 v17, v19
    v_add_f32 v16, v16, v18
    v_add_f32 v17, v17, v19
    s_nop 1
    v_permlane16_swap_b32 v16, v17
    v_add_f32 v16, v16, v17
    s_nop 1
    v_add_f32_dpp v16, v16, v16 quad_perm:[2,3,0,1] row_mask:0xf bank_mask:0xf
    s_nop 1
    v_add_f32_dpp v16, v16, v16 row_ror:4 row_mask:0xf bank_mask:0xf
    s_nop 1
    v_add_f32_dpp v16, v16, v16 row_ror:8 row_mask:0xf bank_mask:0xf
    v_cvt_pk_bf16_f32 v16, 0, v16
    v_mul_f32 v16, v16, v11
    v_cvt_pk_bf16_f32 v16, 0, v16
    v_add_f32 v16, v16, v2
    v_cvt_pk_bf16_f32 v16, 0, v16
    v_add_f32 v16, v16, v3
    v_cvt_pk_bf16_f32 v16, 0, v16
    s_mov_b32 exec_lo, 0x00030003
    s_mov_b32 exec_hi, 0x00030003
    buffer_store_short_d16_hi v16, v12, s[28:31], s21 offen
    s_nop 1
fk_fin:
fk_end:
    s_endpgm
.section .rodata,"a"
.p2align 6
.amdhsa_kernel sequential_preLN__spectral_fnet__moe_arch_mod__prompt_kernel
  .amdhsa_next_free_vgpr 256
  .amdhsa_next_free_sgpr 102
  .amdhsa_accum_offset 256
  .amdhsa_group_segment_fixed_size 0
  .amdhsa_kernarg_size 104
  .amdhsa_user_sgpr_count 2
  .amdhsa_user_sgpr_kernarg_segment_ptr 1
  .amdhsa_system_sgpr_workgroup_id_x 1
.end_amdhsa_kernel
```

```asm
; @launch grid=(256,1,1) block=(512,1,1) lds=157952
.amdgcn_target "amdgcn-amd-amdhsa--gfx950"
.text
.globl sequential_preLN__spectral_fnet__moe_arch_mod__prompt_kernel
.p2align 8
.type sequential_preLN__spectral_fnet__moe_arch_mod__prompt_kernel,@function
sequential_preLN__spectral_fnet__moe_arch_mod__prompt_kernel:
    s_cmp_gt_u32 s2, 255
    s_cbranch_scc1 fk_end
    s_load_dwordx2 s[8:9], s[0:1], 0
    s_load_dwordx2 s[24:25], s[0:1], 96
    s_load_dwordx2 s[32:33], s[0:1], 48
    s_load_dwordx2 s[44:45], s[0:1], 56
    s_load_dwordx2 s[48:49], s[0:1], 64
    s_load_dwordx2 s[52:53], s[0:1], 72
    s_load_dwordx2 s[28:29], s[0:1], 80
    s_getpc_b64 s[40:41]
fk_pc:
    s_mov_b32 s42, fk_end-fk_pc
    s_mov_b32 s43, 0x00020000
    v_lshlrev_b32 v250, 6, v0
    buffer_load_dword v251, v250, s[40:43], 0 offen
    v_lshrrev_b32 v1, 6, v0
    v_and_b32 v15, 63, v0
    v_readfirstlane_b32 s16, v1
    s_and_b32 s3, s2, 0xe0
    s_and_b32 s17, s2, 7
    s_lshl_b32 s17, s17, 2
    s_or_b32 s3, s3, s17
    s_bfe_u32 s17, s2, 0x20003
    s_or_b32 s3, s3, s17
    s_lshr_b32 s17, s3, 4
    s_add_u32 s17, s17, 1
    s_cmp_ge_u32 s3, 248
    s_cselect_b32 s17, 0, s17
    s_cmp_ge_u32 s3, 240
    s_cselect_b32 s18, 7, 15
    s_and_b32 s18, s18, s3
    s_lshl_b32 s18, s18, 7
    s_add_u32 s18, s18, s17
    v_and_b32 v1, 31, v15
    v_lshrrev_b32 v2, 5, v15
    v_lshlrev_b32 v14, 4, v15
    s_mov_b32 s10, 0x400000
    s_mov_b32 s11, 0x00020000
    s_mov_b32 s26, 0x6b8000
    s_mov_b32 s27, 0x00020000
    s_mov_b32 s30, 0x400000
    s_mov_b32 s31, 0x00020000
    s_mov_b32 s34, 0x800
    s_mov_b32 s35, 0x00020000
    s_mov_b32 s46, 0x700000
    s_mov_b32 s47, 0x00020000
    s_mov_b32 s50, 0x700000
    s_mov_b32 s51, 0x00020000
    s_mov_b32 s54, 0x700000
    s_mov_b32 s55, 0x00020000
    s_cmp_eq_u32 s3, 255
    s_cselect_b32 s12, 5, 4
    s_cmp_ge_u32 s16, s12
    s_cbranch_scc1 fk_H
    s_cmp_eq_u32 s16, 4
    s_cbranch_scc1 fk_lowp
    s_setprio 3
fk_lowp:
    s_lshl_b32 s19, s16, 5
    s_add_u32 s19, s19, s18
    s_sub_u32 s20, 2048, s19
    s_and_b32 s20, s20, 2047
    s_lshl_b32 s21, s19, 11
    s_lshl_b32 s22, s20, 11
    s_lshl_b32 s12, s16, 12
    s_add_u32 s12, s12, 98304
    s_mov_b32 m0, s12
    v_mov_b32 v16, 0
    v_mov_b32 v17, 0
    v_mov_b32 v18, 0
    v_mov_b32 v19, 0
    v_mov_b32 v20, 0
    v_mov_b32 v21, 0
    v_mov_b32 v22, 0
    v_mov_b32 v23, 0
    v_mov_b32 v24, 0
    v_mov_b32 v25, 0
    v_mov_b32 v26, 0
    v_mov_b32 v27, 0
    v_mov_b32 v28, 0
    v_mov_b32 v29, 0
    v_mov_b32 v30, 0
    v_mov_b32 v31, 0
    v_mov_b32 v32, 0
    v_mov_b32 v33, 0
    v_mov_b32 v34, 0
    v_mov_b32 v35, 0
    v_mov_b32 v36, 0
    v_mov_b32 v37, 0
    v_mov_b32 v38, 0
    v_mov_b32 v39, 0
    v_mov_b32 v40, 0
    v_mov_b32 v41, 0
    v_mov_b32 v42, 0
    v_mov_b32 v43, 0
    v_mov_b32 v44, 0
    v_mov_b32 v45, 0
    v_mov_b32 v46, 0
    v_mov_b32 v47, 0
    v_cvt_f32_u32 v200, v1
    v_lshlrev_b32 v7, 2, v2
    v_cvt_f32_u32 v7, v7
    v_lshrrev_b32 v8, 1, v1
    v_and_b32 v9, 1, v1
    v_lshlrev_b32 v205, 2, v15
    v_and_b32 v205, 63, v205
    v_add_u32 v205, 157824, v205
    ds_write_b32 v205, v16
    ds_write_b32 v205, v16 offset:64
    s_waitcnt lgkmcnt(0)
    buffer_load_dwordx4 v14, s[8:11], s21 offen lds
    s_add_u32 s13, s12, 1024
    s_mov_b32 m0, s13
    s_add_u32 s14, s21, 1024
    buffer_load_dwordx4 v14, s[8:11], s14 offen lds
    s_add_u32 s13, s12, 2048
    s_mov_b32 m0, s13
    s_nop 0
    buffer_load_dwordx4 v14, s[8:11], s22 offen lds
    s_add_u32 s13, s12, 3072
    s_mov_b32 m0, s13
    s_add_u32 s14, s22, 1024
    buffer_load_dwordx4 v14, s[8:11], s14 offen lds
    s_barrier
    v_add_u32 v206, 138496, v14
    s_lshl_b32 s13, s16, 2
    s_add_u32 s13, s13, 157824
    v_mov_b32 v201, s13
    v_mov_b32 v202, 1
    s_cmp_eq_u32 s16, 1
    s_cbranch_scc1 fk_j1
    s_cmp_eq_u32 s16, 2
    s_cbranch_scc1 fk_j2
    s_cmp_eq_u32 s16, 3
    s_cbranch_scc1 fk_j3
    s_cmp_eq_u32 s16, 4
    s_cbranch_scc1 fk_jend
    v_cmp_eq_u32 vcc, 1, v1
    s_nop 1
    v_cndmask_b32 v10, v8, 16, vcc
    v_cndmask_b32 v11, v9, 0, vcc
    v_cvt_f32_u32 v10, v10
    v_cvt_f32_u32 v11, v11
    v_mul_f32 v10, 0x3d000000, v10
    v_mul_f32 v11, 0x3e800000, v11
    v_add_f32 v12, v7, v7
    v_fma_f32 v11, v10, v12, v11
    v_mov_b32 v128, v11
    v_fmamk_f32 v129, v10, 0x3f800000, v11
    v_fmamk_f32 v130, v10, 0x40000000, v11
    v_fmamk_f32 v131, v10, 0x40400000, v11
    v_fmamk_f32 v132, v10, 0x40800000, v11
    v_fmamk_f32 v133, v10, 0x40a00000, v11
    v_fmamk_f32 v134, v10, 0x40c00000, v11
    v_fmamk_f32 v135, v10, 0x40e00000, v11
    v_fmamk_f32 v136, v10, 0x41800000, v11
    v_fmamk_f32 v137, v10, 0x41880000, v11
    v_fmamk_f32 v138, v10, 0x41900000, v11
    v_fmamk_f32 v139, v10, 0x41980000, v11
    v_fmamk_f32 v140, v10, 0x41a00000, v11
    v_fmamk_f32 v141, v10, 0x41a80000, v11
    v_fmamk_f32 v142, v10, 0x41b00000, v11
    v_fmamk_f32 v143, v10, 0x41b80000, v11
    v_cos_f32 v144, v128
    v_cos_f32 v145, v129
    v_cos_f32 v146, v130
    v_cos_f32 v147, v131
    v_cos_f32 v148, v132
    v_cos_f32 v149, v133
    v_cos_f32 v150, v134
    v_cos_f32 v151, v135
    v_cos_f32 v152, v136
    v_cos_f32 v153, v137
    v_cos_f32 v154, v138
    v_cos_f32 v155, v139
    v_cos_f32 v156, v140
    v_cos_f32 v157, v141
    v_cos_f32 v158, v142
    v_cos_f32 v159, v143
    v_cvt_pk_f16_f32 v48, v144, v145
    v_cvt_pk_f16_f32 v49, v146, v147
    v_cvt_pk_f16_f32 v50, v148, v149
    v_cvt_pk_f16_f32 v51, v150, v151
    v_cvt_pk_f16_f32 v52, v152, v153
    v_cvt_pk_f16_f32 v53, v154, v155
    v_cvt_pk_f16_f32 v54, v156, v157
    v_cvt_pk_f16_f32 v55, v158, v159
    ds_write_b128 v206, v[48:51] offset:0
    ds_write_b128 v206, v[52:55] offset:1024
    s_branch fk_jsig
    s_nop 1
fk_j1:
    v_cvt_f32_u32 v10, v8
    v_lshlrev_b32 v11, 31, v9
    v_mul_f32 v10, 0x3a800000, v10
    v_xor_b32 v10, v11, v10
    v_mul_f32 v11, v10, v7
    v_mov_b32 v128, v11
    v_fmamk_f32 v129, v10, 0x3f800000, v11
    v_fmamk_f32 v130, v10, 0x40000000, v11
    v_fmamk_f32 v131, v10, 0x40400000, v11
    v_fmamk_f32 v132, v10, 0x41000000, v11
    v_fmamk_f32 v133, v10, 0x41100000, v11
    v_fmamk_f32 v134, v10, 0x41200000, v11
    v_fmamk_f32 v135, v10, 0x41300000, v11
    v_fmamk_f32 v136, v10, 0x41800000, v11
    v_fmamk_f32 v137, v10, 0x41880000, v11
    v_fmamk_f32 v138, v10, 0x41900000, v11
    v_fmamk_f32 v139, v10, 0x41980000, v11
    v_fmamk_f32 v140, v10, 0x41c00000, v11
    v_fmamk_f32 v141, v10, 0x41c80000, v11
    v_fmamk_f32 v142, v10, 0x41d00000, v11
    v_fmamk_f32 v143, v10, 0x41d80000, v11
    v_cos_f32 v56, v128
    v_cos_f32 v57, v129
    v_cos_f32 v58, v130
    v_cos_f32 v59, v131
    v_cos_f32 v60, v132
    v_cos_f32 v61, v133
    v_cos_f32 v62, v134
    v_cos_f32 v63, v135
    v_cos_f32 v64, v136
    v_cos_f32 v65, v137
    v_cos_f32 v66, v138
    v_cos_f32 v67, v139
    v_cos_f32 v68, v140
    v_cos_f32 v69, v141
    v_cos_f32 v70, v142
    v_cos_f32 v71, v143
    ds_write_b128 v206, v[56:59] offset:2048
    ds_write_b128 v206, v[60:63] offset:3072
    ds_write_b128 v206, v[64:67] offset:4096
    ds_write_b128 v206, v[68:71] offset:5120
    v_sin_f32 v72, v128
    v_sin_f32 v73, v129
    v_sin_f32 v74, v130
    v_sin_f32 v75, v131
    v_sin_f32 v76, v132
    v_sin_f32 v77, v133
    v_sin_f32 v78, v134
    v_sin_f32 v79, v135
    v_sin_f32 v80, v136
    v_sin_f32 v81, v137
    v_sin_f32 v82, v138
    v_sin_f32 v83, v139
    v_sin_f32 v84, v140
    v_sin_f32 v85, v141
    v_sin_f32 v86, v142
    v_sin_f32 v87, v143
    ds_write_b128 v206, v[72:75] offset:6144
    ds_write_b128 v206, v[76:79] offset:7168
    ds_write_b128 v206, v[80:83] offset:8192
    ds_write_b128 v206, v[84:87] offset:9216
    s_branch fk_jsig
    s_nop 0
fk_j2:
    v_mul_f32 v128, 0x3d000000, v200
    v_mul_f32 v129, v128, v7
    v_mov_b32 v130, v129
    v_fmamk_f32 v131, v128, 0x3f800000, v129
    v_fmamk_f32 v132, v128, 0x40000000, v129
    v_fmamk_f32 v133, v128, 0x40400000, v129
    v_fmamk_f32 v134, v128, 0x41000000, v129
    v_fmamk_f32 v135, v128, 0x41100000, v129
    v_fmamk_f32 v136, v128, 0x41200000, v129
    v_fmamk_f32 v137, v128, 0x41300000, v129
    v_fmamk_f32 v138, v128, 0x41800000, v129
    v_fmamk_f32 v139, v128, 0x41880000, v129
    v_fmamk_f32 v140, v128, 0x41900000, v129
    v_fmamk_f32 v141, v128, 0x41980000, v129
    v_fmamk_f32 v142, v128, 0x41c00000, v129
    v_fmamk_f32 v143, v128, 0x41c80000, v129
    v_fmamk_f32 v144, v128, 0x41d00000, v129
    v_fmamk_f32 v145, v128, 0x41d80000, v129
    v_cos_f32 v146, v130
    v_cos_f32 v147, v131
    v_cos_f32 v148, v132
    v_cos_f32 v149, v133
    v_cos_f32 v150, v134
    v_cos_f32 v151, v135
    v_cos_f32 v152, v136
    v_cos_f32 v153, v137
    v_cos_f32 v154, v138
    v_cos_f32 v155, v139
    v_cos_f32 v156, v140
    v_cos_f32 v157, v141
    v_cos_f32 v158, v142
    v_cos_f32 v159, v143
    v_cos_f32 v160, v144
    v_cos_f32 v161, v145
    v_cvt_pk_f16_f32 v96, v146, v147
    v_cvt_pk_f16_f32 v97, v148, v149
    v_cvt_pk_f16_f32 v98, v150, v151
    v_cvt_pk_f16_f32 v99, v152, v153
    v_cvt_pk_f16_f32 v100, v154, v155
    v_cvt_pk_f16_f32 v101, v156, v157
    v_cvt_pk_f16_f32 v102, v158, v159
    v_cvt_pk_f16_f32 v103, v160, v161
    v_sin_f32 v146, v130
    v_sin_f32 v147, v131
    v_sin_f32 v148, v132
    v_sin_f32 v149, v133
    v_sin_f32 v150, v134
    v_sin_f32 v151, v135
    v_sin_f32 v152, v136
    v_sin_f32 v153, v137
    v_sin_f32 v154, v138
    v_sin_f32 v155, v139
    v_sin_f32 v156, v140
    v_sin_f32 v157, v141
    v_sin_f32 v158, v142
    v_sin_f32 v159, v143
    v_sin_f32 v160, v144
    v_sin_f32 v161, v145
    v_cvt_pk_f16_f32 v104, v146, v147
    v_cvt_pk_f16_f32 v105, v148, v149
    v_cvt_pk_f16_f32 v106, v150, v151
    v_cvt_pk_f16_f32 v107, v152, v153
    v_cvt_pk_f16_f32 v108, v154, v155
    v_cvt_pk_f16_f32 v109, v156, v157
    v_cvt_pk_f16_f32 v110, v158, v159
    v_cvt_pk_f16_f32 v111, v160, v161
    ds_write_b128 v206, v[96:99] offset:12288
    ds_write_b128 v206, v[100:103] offset:13312
    ds_write_b128 v206, v[104:107] offset:14336
    ds_write_b128 v206, v[108:111] offset:15360
    s_branch fk_jsig
    s_nop 0
fk_j3:
    v_or_b32 v10, 16, v1
    v_cvt_f32_u32 v10, v10
    v_mov_b32 v11, 0x3c800000
    v_fmamk_f32 v10, v10, 0x3d000000, v11
    v_cmp_gt_u32 vcc, 16, v1
    v_mov_b32 v12, 0xbe800000
    s_nop 0
    v_cndmask_b32 v12, 0, v12, vcc
    v_fma_f32 v11, v10, v7, v12
    v_mov_b32 v128, v11
    v_fmamk_f32 v129, v10, 0x3f800000, v11
    v_fmamk_f32 v130, v10, 0x40000000, v11
    v_fmamk_f32 v131, v10, 0x40400000, v11
    v_fmamk_f32 v132, v10, 0x41000000, v11
    v_fmamk_f32 v133, v10, 0x41100000, v11
    v_fmamk_f32 v134, v10, 0x41200000, v11
    v_fmamk_f32 v135, v10, 0x41300000, v11
    v_fmamk_f32 v136, v10, 0x41800000, v11
    v_fmamk_f32 v137, v10, 0x41880000, v11
    v_fmamk_f32 v138, v10, 0x41900000, v11
    v_fmamk_f32 v139, v10, 0x41980000, v11
    v_fmamk_f32 v140, v10, 0x41c00000, v11
    v_fmamk_f32 v141, v10, 0x41c80000, v11
    v_fmamk_f32 v142, v10, 0x41d00000, v11
    v_fmamk_f32 v143, v10, 0x41d80000, v11
    v_cos_f32 v144, v128
    v_cos_f32 v145, v129
    v_cos_f32 v146, v130
    v_cos_f32 v147, v131
    v_cos_f32 v148, v132
    v_cos_f32 v149, v133
    v_cos_f32 v150, v134
    v_cos_f32 v151, v135
    v_cos_f32 v152, v136
    v_cos_f32 v153, v137
    v_cos_f32 v154, v138
    v_cos_f32 v155, v139
    v_cos_f32 v156, v140
    v_cos_f32 v157, v141
    v_cos_f32 v158, v142
    v_cos_f32 v159, v143
    v_cvt_pk_f16_f32 v88, v144, v145
    v_cvt_pk_f16_f32 v89, v146, v147
    v_cvt_pk_f16_f32 v90, v148, v149
    v_cvt_pk_f16_f32 v91, v150, v151
    v_cvt_pk_f16_f32 v92, v152, v153
    v_cvt_pk_f16_f32 v93, v154, v155
    v_cvt_pk_f16_f32 v94, v156, v157
    v_cvt_pk_f16_f32 v95, v158, v159
    ds_write_b128 v206, v[88:91] offset:10240
    ds_write_b128 v206, v[92:95] offset:11264
    s_nop 2
fk_jsig:
    ds_write_b32 v201, v202 offset:32
fk_jend:
    v_lshlrev_b32 v3, 9, v2
    v_lshl_add_u32 v3, v1, 1, v3
    v_sub_u32 v4, 576, v3
    v_sub_u32 v5, 2048, v3
    v_and_b32 v5, 2047, v5
    v_add_u32 v3, s12, v3
    v_add_u32 v4, s12, v4
    v_add_u32 v5, s12, v5
    s_lshl_b32 s13, s16, 10
    s_sub_u32 s14, 7232, s13
    s_cmp_ge_u32 s3, 248
    s_cselect_b32 s15, 1024, 0
    s_add_u32 s14, s14, s15
    s_cmp_eq_u32 s14, 8256
    s_cselect_b32 s14, 4160, s14
    s_cmp_eq_u32 s19, s20
    s_cselect_b32 s14, 8256, s14
    s_cmp_eq_u32 s16, 4
    s_cselect_b32 s13, 8256, s13
    s_cmp_lg_u32 s19, 0
    s_cbranch_scc1 fk_noz
    v_add_u32 v8, 124992, v14
    ds_write_b128 v8, v[16:19]
fk_noz:
    s_add_u32 s13, s13, 120832
    s_add_u32 s14, s14, 120832
    v_cmp_gt_u32 vcc, 16, v1
    v_mov_b32 v8, s13
    v_mov_b32 v9, s14
    v_cndmask_b32 v10, v9, v8, vcc
    v_cndmask_b32 v11, v8, v9, vcc
    v_lshl_add_u32 v10, v15, 2, v10
    v_lshl_add_u32 v11, v15, 2, v11
    v_lshrrev_b32 v6, 1, v15
    v_and_b32 v8, 1, v15
    v_mul_u32_u24 v9, 4160, v8
    v_and_b32 v12, 15, v6
    v_lshl_add_u32 v12, v12, 4, v2
    v_mul_u32_u24 v12, 9344, v12
    v_mul_u32_u24 v192, 18688, v8
    v_add_u32 v192, v192, v12
    v_lshl_add_u32 v12, v8, 4, v12
    v_lshrrev_b32 v194, 3, v15
    v_lshlrev_b32 v193, 4, v194
    v_lshl_add_u32 v193, v8, 7, v193
    v_and_b32 v6, 3, v6
    v_lshl_add_u32 v9, v6, 2, v9
    v_lshl_add_u32 v9, v194, 7, v9
    v_lshlrev_b32 v194, 10, v194
    v_and_b32 v6, 7, v15
    v_lshl_add_u32 v194, v6, 4, v194
    s_lshl_b32 s13, s16, 5
    s_add_u32 s13, s13, 120832
    v_add_u32 v6, s13, v9
    s_mul_i32 s36, s3, 9344
    s_lshl_b32 s13, s16, 8
    s_add_u32 s36, s36, s13
    s_add_u32 s36, s36, 0x20000
    s_mul_i32 s37, s16, 37376
    s_add_u32 s37, s37, 0x20000
    s_bfe_u32 s23, s3, 0x30002
    s_lshl_b32 s23, s23, 7
    s_lshr_b32 s12, s3, 5
    s_lshl_b32 s12, s12, 4
    s_add_u32 s23, s23, s12
    s_and_b32 s12, s3, 3
    s_lshl_b32 s12, s12, 2
    s_add_u32 s23, s23, s12
    s_add_u32 s23, s23, 8192
    s_add_u32 s23, s23, s37
    s_lshl_b32 s14, s3, 5
    s_add_u32 s37, s37, s14
    s_add_u32 s38, s37, 18688
    s_lshl_b32 s13, s16, 11
    s_add_u32 s13, s13, 130304
    v_add_u32 v7, s13, v14
    v_cmp_eq_u32 s[58:59], 1, v8
    s_cmp_eq_u32 s19, s20
    s_cselect_b32 s39, 0.5, 1.0
    s_lshl_b32 s13, s16, 2
    s_add_u32 s13, s13, 157056
    v_mov_b32 v9, s13
    s_mov_b32 s57, 47
    s_nop 3
fk_spinc:
    ds_read_b32 v203, v205
    s_waitcnt lgkmcnt(0)
    v_cmp_eq_u32 vcc, 0, v203
    s_nop 1
    s_and_b32 s13, vcc_lo, 0xf00
    s_cbranch_scc1 fk_spinc
    ds_read_b128 v[48:51], v206 offset:0
    ds_read_b128 v[52:55], v206 offset:1024
    ds_read_b128 v[56:59], v206 offset:2048
    ds_read_b128 v[60:63], v206 offset:3072
    ds_read_b128 v[64:67], v206 offset:4096
    ds_read_b128 v[68:71], v206 offset:5120
    ds_read_b128 v[72:75], v206 offset:6144
    ds_read_b128 v[76:79], v206 offset:7168
    ds_read_b128 v[80:83], v206 offset:8192
    ds_read_b128 v[84:87], v206 offset:9216
    ds_read_b128 v[88:91], v206 offset:10240
    ds_read_b128 v[92:95], v206 offset:11264
    s_waitcnt lgkmcnt(8)
    ds_read_b128 v[96:99], v206 offset:12288
    ds_read_b128 v[100:103], v206 offset:13312
    ds_read_b128 v[104:107], v206 offset:14336
    ds_read_b128 v[108:111], v206 offset:15360
    s_waitcnt vmcnt(0) lgkmcnt(0)
    ds_read_u16_d16_hi v16, v3 offset:0
    ds_read_u16_d16_hi v17, v3 offset:64
    ds_read_u16_d16_hi v18, v3 offset:128
    ds_read_u16_d16_hi v19, v3 offset:192
    ds_read_u16_d16_hi v20, v3 offset:256
    ds_read_u16_d16_hi v21, v3 offset:320
    ds_read_u16_d16_hi v22, v3 offset:384
    ds_read_u16_d16_hi v23, v3 offset:448
    ds_read_u16_d16_hi v24, v3 offset:1024
    ds_read_u16_d16_hi v25, v3 offset:1088
    ds_read_u16_d16_hi v26, v3 offset:1152
    ds_read_u16_d16_hi v27, v3 offset:1216
    ds_read_u16_d16_hi v28, v3 offset:1280
    ds_read_u16_d16_hi v29, v3 offset:1344
    ds_read_u16_d16_hi v30, v3 offset:1408
    ds_read_u16_d16_hi v31, v3 offset:1472
    s_waitcnt lgkmcnt(2)
    ds_read_u16_d16_hi v32, v5 offset:2048
    ds_read_u16_d16_hi v33, v4 offset:3456
    ds_read_u16_d16_hi v34, v4 offset:3392
    ds_read_u16_d16_hi v35, v4 offset:3328
    ds_read_u16_d16_hi v36, v4 offset:3264
    ds_read_u16_d16_hi v37, v4 offset:3200
    ds_read_u16_d16_hi v38, v4 offset:3136
    ds_read_u16_d16_hi v39, v4 offset:3072
    ds_read_u16_d16_hi v40, v4 offset:2496
    ds_read_u16_d16_hi v41, v4 offset:2432
    ds_read_u16_d16_hi v42, v4 offset:2368
    ds_read_u16_d16_hi v43, v4 offset:2304
    ds_read_u16_d16_hi v44, v4 offset:2240
    s_waitcnt lgkmcnt(8)
    ds_read_u16_d16_hi v45, v4 offset:2176
    ds_read_u16_d16_hi v46, v4 offset:2112
    ds_read_u16_d16_hi v47, v4 offset:2048
    v_pk_add_f32 v[128:129], v[16:17], v[18:19]
    v_pk_add_f32 v[130:131], v[20:21], v[22:23]
    v_pk_add_f32 v[132:133], v[24:25], v[26:27]
    v_pk_add_f32 v[134:135], v[28:29], v[30:31]
    v_pk_mul_f32 v[136:137], v[16:17], v[16:17]
    v_pk_mul_f32 v[138:139], v[18:19], v[18:19]
    v_pk_fma_f32 v[136:137], v[20:21], v[20:21], v[136:137]
    v_pk_fma_f32 v[138:139], v[22:23], v[22:23], v[138:139]
    v_pk_fma_f32 v[136:137], v[24:25], v[24:25], v[136:137]
    v_pk_fma_f32 v[138:139], v[26:27], v[26:27], v[138:139]
    v_pk_fma_f32 v[136:137], v[28:29], v[28:29], v[136:137]
    v_pk_fma_f32 v[138:139], v[30:31], v[30:31], v[138:139]
    v_pk_add_f32 v[128:129], v[128:129], v[130:131]
    v_pk_add_f32 v[132:133], v[132:133], v[134:135]
    v_pk_add_f32 v[136:137], v[136:137], v[138:139]
    v_pk_add_f32 v[128:129], v[128:129], v[132:133]
    v_add_f32 v136, v136, v137
    v_add_f32 v128, v128, v129
    s_waitcnt lgkmcnt(0)
    v_pk_add_f32 v[140:141], v[32:33], v[34:35]
    v_pk_add_f32 v[142:143], v[36:37], v[38:39]
    v_pk_add_f32 v[144:145], v[40:41], v[42:43]
    v_pk_add_f32 v[146:147], v[44:45], v[46:47]
    v_pk_mul_f32 v[148:149], v[32:33], v[32:33]
    v_pk_mul_f32 v[150:151], v[34:35], v[34:35]
    v_pk_fma_f32 v[148:149], v[36:37], v[36:37], v[148:149]
    v_pk_fma_f32 v[150:151], v[38:39], v[38:39], v[150:151]
    v_pk_fma_f32 v[148:149], v[40:41], v[40:41], v[148:149]
    v_pk_fma_f32 v[150:151], v[42:43], v[42:43], v[150:151]
    v_pk_fma_f32 v[148:149], v[44:45], v[44:45], v[148:149]
    v_pk_fma_f32 v[150:151], v[46:47], v[46:47], v[150:151]
    v_pk_add_f32 v[140:141], v[140:141], v[142:143]
    v_pk_add_f32 v[144:145], v[144:145], v[146:147]
    v_pk_add_f32 v[148:149], v[148:149], v[150:151]
    v_pk_add_f32 v[140:141], v[140:141], v[144:145]
    v_add_f32 v148, v148, v149
    v_add_f32 v140, v140, v141
    s_nop 1
    v_permlane32_swap_b32 v128, v140
    v_permlane32_swap_b32 v136, v148
    v_add_f32 v128, v128, v140
    v_add_f32 v136, v136, v148
    s_nop 1
    v_permlane16_swap_b32 v128, v136
    v_add_f32 v128, v128, v136
    s_nop 1
    v_add_f32_dpp v128, v128, v128 quad_perm:[1,0,3,2] row_mask:0xf bank_mask:0xf
    s_nop 1
    v_add_f32_dpp v128, v128, v128 quad_perm:[2,3,0,1] row_mask:0xf bank_mask:0xf
    s_nop 1
    v_add_f32_dpp v128, v128, v128 row_half_mirror row_mask:0xf bank_mask:0xf
    s_nop 1
    v_add_f32_dpp v128, v128, v128 row_mirror row_mask:0xf bank_mask:0xf
    s_nop 1
    v_mov_b32_dpp v129, v128 row_bcast:15 row_mask:0xa bank_mask:0xf
    v_mul_f32 v130, 0x3a800000, v128
    v_mul_f32 v129, 0x3a800000, v129
    v_fma_f32 v130, -v129, v129, v130
    v_max_f32 v130, 0, v130
    v_cvt_pk_bf16_f32 v130, 0, v130
    v_cvt_pk_bf16_f32 v129, 0, v129
    v_add_f32 v130, 0x3727c5ac, v130
    v_cvt_pk_bf16_f32 v130, 0, v130
    v_sqrt_f32 v130, v130
    s_nop 0
    v_cvt_pk_bf16_f32 v130, 0, v130
    v_rcp_f32 v130, v130
    s_nop 0
    v_mul_f32 v130, 0x3c000000, v130
    v_mul_f32 v129, v129, v130
    v_readlane_b32 s4, v130, 16
    v_readlane_b32 s6, v130, 48
    v_readlane_b32 s13, v129, 16
    v_readlane_b32 s14, v129, 48
    s_nop 0
    v_mov_b32 v132, s13
    v_add_f32 v132, s14, v132
    v_pk_fma_f32 v[32:33], v[32:33], s[6:7], v[132:133] op_sel_hi:[1,0,0] neg_lo:[0,0,1] neg_hi:[0,0,1]
    v_pk_fma_f32 v[34:35], v[34:35], s[6:7], v[132:133] op_sel_hi:[1,0,0] neg_lo:[0,0,1] neg_hi:[0,0,1]
    v_pk_fma_f32 v[36:37], v[36:37], s[6:7], v[132:133] op_sel_hi:[1,0,0] neg_lo:[0,0,1] neg_hi:[0,0,1]
    v_pk_fma_f32 v[38:39], v[38:39], s[6:7], v[132:133] op_sel_hi:[1,0,0] neg_lo:[0,0,1] neg_hi:[0,0,1]
    v_pk_fma_f32 v[40:41], v[40:41], s[6:7], v[132:133] op_sel_hi:[1,0,0] neg_lo:[0,0,1] neg_hi:[0,0,1]
    v_pk_fma_f32 v[42:43], v[42:43], s[6:7], v[132:133] op_sel_hi:[1,0,0] neg_lo:[0,0,1] neg_hi:[0,0,1]
    v_pk_fma_f32 v[44:45], v[44:45], s[6:7], v[132:133] op_sel_hi:[1,0,0] neg_lo:[0,0,1] neg_hi:[0,0,1]
    v_pk_fma_f32 v[46:47], v[46:47], s[6:7], v[132:133] op_sel_hi:[1,0,0] neg_lo:[0,0,1] neg_hi:[0,0,1]
    v_pk_fma_f32 v[16:17], v[16:17], s[4:5], v[32:33] op_sel_hi:[1,0,1]
    v_pk_fma_f32 v[18:19], v[18:19], s[4:5], v[34:35] op_sel_hi:[1,0,1]
    v_pk_fma_f32 v[20:21], v[20:21], s[4:5], v[36:37] op_sel_hi:[1,0,1]
    v_pk_fma_f32 v[22:23], v[22:23], s[4:5], v[38:39] op_sel_hi:[1,0,1]
    v_pk_fma_f32 v[24:25], v[24:25], s[4:5], v[40:41] op_sel_hi:[1,0,1]
    v_pk_fma_f32 v[26:27], v[26:27], s[4:5], v[42:43] op_sel_hi:[1,0,1]
    v_pk_fma_f32 v[28:29], v[28:29], s[4:5], v[44:45] op_sel_hi:[1,0,1]
    v_pk_fma_f32 v[30:31], v[30:31], s[4:5], v[46:47] op_sel_hi:[1,0,1]
    v_cvt_pk_f16_f32 v176, v16, v17
    v_cvt_pk_f16_f32 v177, v18, v19
    v_cvt_pk_f16_f32 v178, v20, v21
    v_cvt_pk_f16_f32 v179, v22, v23
    v_cvt_pk_f16_f32 v180, v24, v25
    v_cvt_pk_f16_f32 v181, v26, v27
    v_cvt_pk_f16_f32 v182, v28, v29
    v_cvt_pk_f16_f32 v183, v30, v31
    v_mfma_f32_32x32x16_f16 v[112:127], v[176:179], v[48:51], 0
    s_nop 0
    v_mfma_f32_32x32x16_f16 v[112:127], v[180:183], v[52:55], v[112:127]
    s_nop 11
    v_pk_mul_f32 v[16:17], v[112:113], v[56:57]
    v_pk_mul_f32 v[18:19], v[114:115], v[58:59]
    v_pk_mul_f32 v[20:21], v[116:117], v[60:61]
    v_pk_mul_f32 v[22:23], v[118:119], v[62:63]
    v_pk_mul_f32 v[24:25], v[120:121], v[64:65]
    v_pk_mul_f32 v[26:27], v[122:123], v[66:67]
    v_pk_mul_f32 v[28:29], v[124:125], v[68:69]
    v_pk_mul_f32 v[30:31], v[126:127], v[70:71]
    v_fmac_f32_dpp v16, v112, v72 quad_perm:[1,0,3,2] row_mask:0xf bank_mask:0xf
    v_fmac_f32_dpp v17, v113, v73 quad_perm:[1,0,3,2] row_mask:0xf bank_mask:0xf
    v_fmac_f32_dpp v18, v114, v74 quad_perm:[1,0,3,2] row_mask:0xf bank_mask:0xf
    v_fmac_f32_dpp v19, v115, v75 quad_perm:[1,0,3,2] row_mask:0xf bank_mask:0xf
    v_fmac_f32_dpp v20, v116, v76 quad_perm:[1,0,3,2] row_mask:0xf bank_mask:0xf
    v_fmac_f32_dpp v21, v117, v77 quad_perm:[1,0,3,2] row_mask:0xf bank_mask:0xf
    v_fmac_f32_dpp v22, v118, v78 quad_perm:[1,0,3,2] row_mask:0xf bank_mask:0xf
    v_fmac_f32_dpp v23, v119, v79 quad_perm:[1,0,3,2] row_mask:0xf bank_mask:0xf
    v_cvt_pk_f16_f32 v176, v16, v17
    v_cvt_pk_f16_f32 v177, v18, v19
    v_cvt_pk_f16_f32 v178, v20, v21
    v_cvt_pk_f16_f32 v179, v22, v23
    v_fmac_f32_dpp v24, v120, v80 quad_perm:[1,0,3,2] row_mask:0xf bank_mask:0xf
    v_fmac_f32_dpp v25, v121, v81 quad_perm:[1,0,3,2] row_mask:0xf bank_mask:0xf
    v_mfma_f32_32x32x16_f16 v[128:143], v[176:179], v[96:99], 0
    v_fmac_f32_dpp v26, v122, v82 quad_perm:[1,0,3,2] row_mask:0xf bank_mask:0xf
    v_fmac_f32_dpp v27, v123, v83 quad_perm:[1,0,3,2] row_mask:0xf bank_mask:0xf
    v_fmac_f32_dpp v28, v124, v84 quad_perm:[1,0,3,2] row_mask:0xf bank_mask:0xf
    v_fmac_f32_dpp v29, v125, v85 quad_perm:[1,0,3,2] row_mask:0xf bank_mask:0xf
    v_mfma_f32_32x32x16_f16 v[144:159], v[176:179], v[104:107], 0
    v_fmac_f32_dpp v30, v126, v86 quad_perm:[1,0,3,2] row_mask:0xf bank_mask:0xf
    v_fmac_f32_dpp v31, v127, v87 quad_perm:[1,0,3,2] row_mask:0xf bank_mask:0xf
    v_cvt_pk_f16_f32 v180, v24, v25
    v_cvt_pk_f16_f32 v181, v26, v27
    v_mfma_f32_32x32x16_f16 v[160:175], v[176:179], v[88:91], 0
    v_cvt_pk_f16_f32 v182, v28, v29
    v_cvt_pk_f16_f32 v183, v30, v31
    s_nop 1
    v_mfma_f32_32x32x16_f16 v[128:143], v[180:183], v[100:103], v[128:143]
    v_mfma_f32_32x32x16_f16 v[144:159], v[180:183], v[108:111], v[144:159]
    v_mfma_f32_32x32x16_f16 v[160:175], v[180:183], v[92:95], v[160:175]
    v_cmp_gt_u32 vcc, 16, v15
    v_cmp_gt_u32 s[40:41], 32, v15
    s_nop 8
    v_pk_add_f32 v[20:21], v[132:133], v[148:149] op_sel:[0,1] op_sel_hi:[1,0] neg_hi:[0,1]
    v_pk_add_f32 v[22:23], v[134:135], v[150:151] op_sel:[0,1] op_sel_hi:[1,0] neg_hi:[0,1]
    v_pk_add_f32 v[36:37], v[20:21], v[22:23] op_sel:[0,1] op_sel_hi:[1,0] neg_lo:[0,1]
    v_pk_add_f32 v[38:39], v[20:21], v[22:23] op_sel:[0,1] op_sel_hi:[1,0] neg_hi:[1,0]
    v_cvt_pk_f16_f32 v178, v36, v37
    v_cvt_pk_f16_f32 v179, v38, v39
    ds_write_b32 v10, v178 offset:256
    ds_write_b32 v11, v179 offset:256
    v_pk_add_f32 v[24:25], v[136:137], v[152:153] op_sel:[0,1] op_sel_hi:[1,0] neg_hi:[0,1]
    v_pk_add_f32 v[26:27], v[138:139], v[154:155] op_sel:[0,1] op_sel_hi:[1,0] neg_hi:[0,1]
    v_pk_add_f32 v[40:41], v[24:25], v[26:27] op_sel:[0,1] op_sel_hi:[1,0] neg_lo:[0,1]
    v_pk_add_f32 v[42:43], v[24:25], v[26:27] op_sel:[0,1] op_sel_hi:[1,0] neg_hi:[1,0]
    v_cvt_pk_f16_f32 v180, v40, v41
    v_cvt_pk_f16_f32 v181, v42, v43
    ds_write_b32 v10, v180 offset:512
    ds_write_b32 v11, v181 offset:512
    v_pk_add_f32 v[28:29], v[140:141], v[156:157] op_sel:[0,1] op_sel_hi:[1,0] neg_hi:[0,1]
    v_pk_add_f32 v[30:31], v[142:143], v[158:159] op_sel:[0,1] op_sel_hi:[1,0] neg_hi:[0,1]
    v_pk_add_f32 v[44:45], v[28:29], v[30:31] op_sel:[0,1] op_sel_hi:[1,0] neg_lo:[0,1]
    v_pk_add_f32 v[46:47], v[28:29], v[30:31] op_sel:[0,1] op_sel_hi:[1,0] neg_hi:[1,0]
    v_cvt_pk_f16_f32 v182, v44, v45
    v_cvt_pk_f16_f32 v183, v46, v47
    ds_write_b32 v10, v182 offset:768
    ds_write_b32 v11, v183 offset:768
    v_pk_add_f32 v[16:17], v[128:129], v[144:145] op_sel:[0,1] op_sel_hi:[1,0] neg_hi:[0,1]
    v_pk_add_f32 v[18:19], v[130:131], v[146:147] op_sel:[0,1] op_sel_hi:[1,0] neg_hi:[0,1]
    v_mul_f32 v8, s39, v128
    v_mov_b32 v3, v161
    s_nop 1
    v_permlane16_swap_b32 v4, v3
    v_cndmask_b32 v5, v161, v128, vcc
    v_cndmask_b32 v4, v4, v144, vcc
    v_cndmask_b32 v16, v16, v5, s[40:41]
    v_cndmask_b32 v17, v17, -v4, s[40:41]
    v_pk_add_f32 v[32:33], v[16:17], v[18:19] op_sel:[0,1] op_sel_hi:[1,0] neg_lo:[0,1]
    v_pk_add_f32 v[34:35], v[16:17], v[18:19] op_sel:[0,1] op_sel_hi:[1,0] neg_hi:[1,0]
    v_cvt_pk_f16_f32 v176, v32, v33
    v_cvt_pk_f16_f32 v177, v34, v35
    ds_write_b32 v10, v176 offset:0
    ds_write_b32 v11, v177 offset:0
    s_mov_b64 exec, 0x10000
    ds_write_b32 v9, v8
    ds_write_b32 v201, v202
    s_mov_b64 exec, -1
    s_cmp_eq_u32 s16, 4
    s_cbranch_scc1 fk_w4
    s_nop 0
fk_spin:
    ds_read_b32 v3, v205
    s_waitcnt lgkmcnt(0)
    v_cmp_eq_u32 vcc, 0, v3
    s_nop 1
    s_and_b32 s13, vcc_lo, s57
    s_cbranch_scc1 fk_spin
    s_nop 0
fk_staged:
    ds_read2st64_b32 v[184:185], v6 offset0:0 offset1:4
    ds_read2st64_b32 v[186:187], v6 offset0:8 offset1:12
    v_add_u32 v8, 16, v6
    ds_read2st64_b32 v[188:189], v8 offset0:0 offset1:4
    ds_read2st64_b32 v[190:191], v8 offset0:8 offset1:12
    v_readlane_b32 s43, v3, 7
    s_waitcnt lgkmcnt(2)
    buffer_store_dwordx4 v[184:187], v194, s[24:27], s36 offen offset:0 sc1
    s_waitcnt lgkmcnt(0)
    buffer_store_dwordx4 v[188:191], v194, s[24:27], s36 offen offset:128 sc1
    v_add3_u32 v3, v184, v185, v186
    v_add_u32 v3, v3, v187
    v_add3_u32 v4, v188, v189, v190
    v_add_u32 v4, v4, v191
    s_add_u32 s36, s36, 8192
    v_add_u32_dpp v3, v3, v3 quad_perm:[1,0,3,2] row_mask:0xf bank_mask:0xf
    v_add_u32_dpp v4, v4, v4 quad_perm:[1,0,3,2] row_mask:0xf bank_mask:0xf
    v_cndmask_b32 v3, v3, v4, s[58:59]
    v_add_u32 v196, s43, v3
    s_nop 1
    v_mov_b32_dpp v197, v196 row_shl:2 row_mask:0xf bank_mask:0xf
    v_mov_b32_dpp v198, v196 row_shl:4 row_mask:0xf bank_mask:0xf
    v_mov_b32_dpp v199, v196 row_shl:6 row_mask:0xf bank_mask:0xf
    s_mov_b32 exec_lo, 0x03030303
    s_mov_b32 exec_hi, 0x03030303
    buffer_store_dwordx4 v[196:199], v193, s[24:27], s36 offen sc1
    s_mov_b64 exec, -1
    s_cmp_lg_u32 s16, 0
    s_cbranch_scc1 fk_nog5
    v_and_b32 v9, 16, v14
    v_add_u32 v9, 157056, v9
    ds_read_b128 v[16:19], v9
    s_lshl_b32 s13, s3, 4
    s_add_u32 s13, s13, 0x11000
    s_nop 1
fk_g5s:
    ds_read_b32 v3, v205
    s_waitcnt lgkmcnt(0)
    v_cmp_eq_u32 vcc, 0, v3
    s_nop 1
    s_and_b32 s14, vcc_lo, 64
    s_cbranch_scc1 fk_g5s
    v_min_u32 v16, -2, v16
    v_min_u32 v17, -2, v17
    v_min_u32 v18, -2, v18
    v_min_u32 v19, -2, v19
    s_mov_b64 exec, 1
    buffer_store_dwordx4 v[16:19], v14, s[24:27], s13 offen sc1
    s_mov_b64 exec, -1
    s_nop 1
fk_nog5:
    v_lshrrev_b32 v208, 3, v15
    v_and_b32 v209, 7, v15
    v_and_b32 v210, 2, v208
    v_xor_b32 v209, v210, v209
    v_mul_u32_u24 v208, 7168, v208
    v_lshl_add_u32 v208, v209, 4, v208
    v_lshrrev_b32 v210, 5, v15
    v_lshlrev_b32 v210, 11, v210
    v_and_b32 v209, 31, v15
    v_lshl_add_u32 v210, v209, 4, v210
    s_and_b32 s12, s3, 3
    s_mul_i32 s100, s12, 1835008
    s_lshl_b32 s101, s12, 9
    s_lshr_b32 s12, s3, 2
    s_lshl_b32 s12, s12, 7
    s_add_u32 s100, s100, s12
    s_lshl_b32 s12, s12, 10
    s_add_u32 s101, s101, s12
    s_xor_b32 s99, s100, 0
    s_mov_b64 s[4:5], s[58:59]
    s_cmp_gt_u32 s3, 223
    s_cbranch_scc1 fk_win1
    s_mul_i32 s15, s16, 3
    s_add_u32 s15, s15, 12
    s_mov_b32 s58, 0x700000
    s_mov_b32 s59, 0x00020000
    s_cmp_gt_u32 s15, 95
    s_cbranch_scc1 fk_win1
    s_lshl_b32 s12, s15, 10
    s_mov_b32 m0, s12
    s_and_b32 s14, s12, 1024
    s_lshr_b32 s14, s14, 4
    v_xor_b32 v209, s14, v208
    s_cmp_lt_u32 s15, 32
    s_cselect_b64 s[56:57], s[44:45], s[48:49]
    s_cselect_b32 s12, s100, s99
    s_and_b32 s14, s15, 31
    s_mul_i32 s13, s14, 57344
    s_add_u32 s13, s13, s12
    s_lshl_b32 s14, s14, 12
    s_add_u32 s14, s14, s101
    s_cmp_lt_u32 s15, 64
    s_cselect_b64 s[56:57], s[56:57], s[52:53]
    s_cselect_b32 s13, s13, s14
    s_cselect_b64 vcc, -1, 0
    v_cndmask_b32 v209, v210, v209, vcc
    s_add_u32 s15, s15, 1
    buffer_load_dwordx4 v209, s[56:59], s13 offen lds
    s_cmp_gt_u32 s15, 95
    s_cbranch_scc1 fk_win1
    s_lshl_b32 s12, s15, 10
    s_mov_b32 m0, s12
    s_and_b32 s14, s12, 1024
    s_lshr_b32 s14, s14, 4
    v_xor_b32 v209, s14, v208
    s_cmp_lt_u32 s15, 32
    s_cselect_b64 s[56:57], s[44:45], s[48:49]
    s_cselect_b32 s12, s100, s99
    s_and_b32 s14, s15, 31
    s_mul_i32 s13, s14, 57344
    s_add_u32 s13, s13, s12
    s_lshl_b32 s14, s14, 12
    s_add_u32 s14, s14, s101
    s_cmp_lt_u32 s15, 64
    s_cselect_b64 s[56:57], s[56:57], s[52:53]
    s_cselect_b32 s13, s13, s14
    s_cselect_b64 vcc, -1, 0
    v_cndmask_b32 v209, v210, v209, vcc
    s_add_u32 s15, s15, 1
    buffer_load_dwordx4 v209, s[56:59], s13 offen lds
    s_cmp_gt_u32 s15, 95
    s_cbranch_scc1 fk_win1
    s_lshl_b32 s12, s15, 10
    s_mov_b32 m0, s12
    s_and_b32 s14, s12, 1024
    s_lshr_b32 s14, s14, 4
    v_xor_b32 v209, s14, v208
    s_cmp_lt_u32 s15, 32
    s_cselect_b64 s[56:57], s[44:45], s[48:49]
    s_cselect_b32 s12, s100, s99
    s_and_b32 s14, s15, 31
    s_mul_i32 s13, s14, 57344
    s_add_u32 s13, s13, s12
    s_lshl_b32 s14, s14, 12
    s_add_u32 s14, s14, s101
    s_cmp_lt_u32 s15, 64
    s_cselect_b64 s[56:57], s[56:57], s[52:53]
    s_cselect_b32 s13, s13, s14
    s_cselect_b64 vcc, -1, 0
    v_cndmask_b32 v209, v210, v209, vcc
    s_add_u32 s15, s15, 1
    buffer_load_dwordx4 v209, s[56:59], s13 offen lds
    s_nop 2
fk_win1:
    s_mov_b32 s42, 0
    s_waitcnt vmcnt(0)
    s_nop 0
fk_pollw:
    buffer_load_dwordx4 v[184:187], v12, s[24:27], s37 offen sc1
    buffer_load_dwordx4 v[188:191], v12, s[24:27], s38 offen sc1
    buffer_load_dword v5, v192, s[24:27], s23 offen sc1
    s_waitcnt vmcnt(1)
    v_add3_u32 v3, v184, v185, v186
    v_add_u32 v3, v3, v187
    v_add3_u32 v4, v188, v189, v190
    v_add_u32 v4, v4, v191
    ds_write_b128 v7, v[184:187]
    v_add_u32_dpp v3, v3, v3 quad_perm:[1,0,3,2] row_mask:0xf bank_mask:0xf
    v_add_u32_dpp v4, v4, v4 quad_perm:[1,0,3,2] row_mask:0xf bank_mask:0xf
    ds_write_b128 v7, v[188:191] offset:1024
    v_cndmask_b32 v3, v3, v4, s[4:5]
    v_add_u32 v3, s43, v3
    s_waitcnt vmcnt(0)
    v_cmp_ne_u32 vcc, v3, v5
    s_add_u32 s42, s42, 1
    s_cbranch_vccz fk_gotw
    s_cmp_le_u32 s42, 0x40000
    s_cbranch_scc1 fk_pollw
    s_nop 0
fk_gotw:
    s_waitcnt lgkmcnt(0)
    s_barrier
    s_setprio 0
    s_or_b32 s13, s3, s16
    s_cbranch_scc1 fk_nobump
    v_mov_b32 v3, s43
    s_mov_b64 exec, 1
    buffer_store_dword v3, v14, s[24:27], 0 offen sc1
    s_mov_b64 exec, -1
    s_nop 1
fk_nobump:
    s_lshl_b32 s13, s16, 10
    s_add_u32 s14, s13, 0x11000
    s_add_u32 s13, s13, 114688
    v_add_u32 v7, s13, v14
    v_mov_b32 v3, 4096
    s_mov_b32 s15, 0x11000
    v_mov_b32 v8, 157152
    buffer_load_dwordx4 v[184:187], v14, s[24:27], s14 offen sc1
    buffer_load_dword v188, v3, s[24:27], s15 offen sc1
    s_mov_b32 s40, s14
    s_mov_b32 s41, s15
    s_cmp_gt_u32 s3, 223
    s_cbranch_scc1 fk_win2
    s_mul_i32 s15, s16, 4
    s_add_u32 s15, s15, 24
    s_cmp_ge_u32 s15, 32
    s_cselect_b32 s12, 32, 0
    s_add_u32 s15, s15, s12
    s_mov_b32 s58, 0x700000
    s_mov_b32 s59, 0x00020000
    s_cmp_gt_u32 s15, 95
    s_cbranch_scc1 fk_win2
    s_lshl_b32 s12, s15, 10
    s_mov_b32 m0, s12
    s_and_b32 s14, s12, 1024
    s_lshr_b32 s14, s14, 4
    v_xor_b32 v209, s14, v208
    s_cmp_lt_u32 s15, 32
    s_cselect_b64 s[56:57], s[44:45], s[48:49]
    s_cselect_b32 s12, s100, s99
    s_and_b32 s14, s15, 31
    s_mul_i32 s13, s14, 57344
    s_add_u32 s13, s13, s12
    s_lshl_b32 s14, s14, 12
    s_add_u32 s14, s14, s101
    s_cmp_lt_u32 s15, 64
    s_cselect_b64 s[56:57], s[56:57], s[52:53]
    s_cselect_b32 s13, s13, s14
    s_cselect_b64 vcc, -1, 0
    v_cndmask_b32 v209, v210, v209, vcc
    s_add_u32 s15, s15, 1
    buffer_load_dwordx4 v209, s[56:59], s13 offen lds
    s_cmp_gt_u32 s15, 95
    s_cbranch_scc1 fk_win2
    s_lshl_b32 s12, s15, 10
    s_mov_b32 m0, s12
    s_and_b32 s14, s12, 1024
    s_lshr_b32 s14, s14, 4
    v_xor_b32 v209, s14, v208
    s_cmp_lt_u32 s15, 32
    s_cselect_b64 s[56:57], s[44:45], s[48:49]
    s_cselect_b32 s12, s100, s99
    s_and_b32 s14, s15, 31
    s_mul_i32 s13, s14, 57344
    s_add_u32 s13, s13, s12
    s_lshl_b32 s14, s14, 12
    s_add_u32 s14, s14, s101
    s_cmp_lt_u32 s15, 64
    s_cselect_b64 s[56:57], s[56:57], s[52:53]
    s_cselect_b32 s13, s13, s14
    s_cselect_b64 vcc, -1, 0
    v_cndmask_b32 v209, v210, v209, vcc
    s_add_u32 s15, s15, 1
    buffer_load_dwordx4 v209, s[56:59], s13 offen lds
    s_cmp_gt_u32 s15, 95
    s_cbranch_scc1 fk_win2
    s_lshl_b32 s12, s15, 10
    s_mov_b32 m0, s12
    s_and_b32 s14, s12, 1024
    s_lshr_b32 s14, s14, 4
    v_xor_b32 v209, s14, v208
    s_cmp_lt_u32 s15, 32
    s_cselect_b64 s[56:57], s[44:45], s[48:49]
    s_cselect_b32 s12, s100, s99
    s_and_b32 s14, s15, 31
    s_mul_i32 s13, s14, 57344
    s_add_u32 s13, s13, s12
    s_lshl_b32 s14, s14, 12
    s_add_u32 s14, s14, s101
    s_cmp_lt_u32 s15, 64
    s_cselect_b64 s[56:57], s[56:57], s[52:53]
    s_cselect_b32 s13, s13, s14
    s_cselect_b64 vcc, -1, 0
    v_cndmask_b32 v209, v210, v209, vcc
    s_add_u32 s15, s15, 1
    buffer_load_dwordx4 v209, s[56:59], s13 offen lds
    s_cmp_gt_u32 s15, 95
    s_cbranch_scc1 fk_win2
    s_lshl_b32 s12, s15, 10
    s_mov_b32 m0, s12
    s_and_b32 s14, s12, 1024
    s_lshr_b32 s14, s14, 4
    v_xor_b32 v209, s14, v208
    s_cmp_lt_u32 s15, 32
    s_cselect_b64 s[56:57], s[44:45], s[48:49]
    s_cselect_b32 s12, s100, s99
    s_and_b32 s14, s15, 31
    s_mul_i32 s13, s14, 57344
    s_add_u32 s13, s13, s12
    s_lshl_b32 s14, s14, 12
    s_add_u32 s14, s14, s101
    s_cmp_lt_u32 s15, 64
    s_cselect_b64 s[56:57], s[56:57], s[52:53]
    s_cselect_b32 s13, s13, s14
    s_cselect_b64 vcc, -1, 0
    v_cndmask_b32 v209, v210, v209, vcc
    s_add_u32 s15, s15, 1
    buffer_load_dwordx4 v209, s[56:59], s13 offen lds
    s_nop 2
fk_win2:
    s_mov_b32 s42, 0
    s_cmp_gt_u32 s3, 223
    s_cbranch_scc1 fk_pollg
    s_waitcnt vmcnt(4)
    s_branch fk_chkg
    s_nop 0
fk_pollg:
    buffer_load_dwordx4 v[184:187], v14, s[24:27], s40 offen sc1
    buffer_load_dword v188, v3, s[24:27], s41 offen sc1
    s_waitcnt vmcnt(0)
    s_nop 0
fk_chkg:
    s_add_u32 s42, s42, 1
    v_max3_u32 v4, v184, v185, v186
    v_max3_u32 v4, v4, v187, v188
    v_cmp_eq_u32 vcc, -1, v4
    s_cbranch_vccz fk_gotg
    s_cmp_le_u32 s42, 0x40000
    s_cbranch_scc1 fk_pollg
    s_nop 1
fk_gotg:
    ds_write_b128 v7, v[184:187]
    ds_write_b32 v8, v188
    s_branch fk_common
    s_nop 0
fk_w4:
    v_min_u32 v184, -2, v176
    v_min_u32 v185, -2, v178
    v_min_u32 v186, -2, v180
    v_min_u32 v187, -2, v182
    v_min_u32 v8, -2, v8
    v_mov_b32 v4, 4096
    s_mov_b32 s14, 0x13000
    s_mov_b32 s15, 0x11000
    s_nop 2
fk_w4s:
    ds_read_b32 v3, v205
    s_waitcnt lgkmcnt(0)
    v_cmp_eq_u32 vcc, 0, v3
    s_nop 1
    s_and_b32 s13, vcc_lo, 32
    s_cbranch_scc1 fk_w4s
    buffer_store_dwordx4 v[184:187], v14, s[24:27], s14 offen sc1
    s_mov_b64 exec, 0x10000
    buffer_store_dword v8, v4, s[24:27], s15 offen sc1
    s_mov_b64 exec, -1
    s_branch fk_Hconst
    s_nop 0
fk_H:
    s_barrier
    s_cmp_lg_u32 s16, 7
    s_cbranch_scc1 fk_Hconst
    v_mov_b32 v4, -1
    v_mov_b32 v5, -1
    v_mov_b32 v6, -1
    v_mov_b32 v7, -1
    v_mov_b32 v3, 157120
    v_mov_b32 v8, 0
    ds_write_b32 v3, v8
    v_lshlrev_b32 v3, 12, v15
    s_lshl_b32 s13, s3, 4
    s_add_u32 s14, s13, 0x9000
    s_add_u32 s15, s13, 0x11000
    v_mov_b32 v201, 157844
    v_mov_b32 v204, 1
    s_waitcnt lgkmcnt(0)
    s_load_dword s56, s[24:25], 0
    s_mov_b64 exec, 0xff
    buffer_store_dwordx4 v[4:7], v3, s[24:27], s14 offen sc1
    s_cmp_eq_u32 s3, 255
    s_cselect_b32 exec_lo, 3, 1
    buffer_store_dwordx4 v[4:7], v14, s[24:27], s15 offen sc1
    s_mov_b64 exec, -1
    s_mov_b32 m0, 155008
    s_mov_b32 s12, 0
    buffer_load_dwordx4 v14, s[32:35], s12 offen lds
    s_mov_b32 m0, 156032
    s_mov_b32 s12, 1024
    buffer_load_dwordx4 v14, s[32:35], s12 offen lds
    s_cmp_eq_u32 s3, 255
    s_cselect_b32 s12, 0x13000, s26
    buffer_store_dwordx4 v[4:7], v14, s[24:27], s12 offen sc1
    s_cmp_lg_u32 s3, 248
    s_cbranch_scc1 fk_no1024
    s_mov_b32 m0, 118784
    s_mov_b32 s14, 2097152
    buffer_load_dwordx4 v14, s[8:11], s14 offen lds
    s_mov_b32 m0, 119808
    s_mov_b32 s14, 2098176
    buffer_load_dwordx4 v14, s[8:11], s14 offen lds
fk_no1024:
    s_mul_i32 s38, s3, 8320
    s_add_u32 s38, s38, 0x268000
    s_add_u32 s39, s38, 4096
    s_waitcnt vmcnt(0) lgkmcnt(0)
    s_add_u32 s57, s56, 1
    v_mov_b32 v202, s57
    ds_write_b32 v201, v202 offset:8
    ds_write_b32 v201, v204
    buffer_store_dwordx4 v[4:7], v14, s[24:27], s38 offen offset:0 sc1
    buffer_store_dwordx4 v[4:7], v14, s[24:27], s38 offen offset:1024 sc1
    buffer_store_dwordx4 v[4:7], v14, s[24:27], s38 offen offset:2048 sc1
    buffer_store_dwordx4 v[4:7], v14, s[24:27], s38 offen offset:3072 sc1
    buffer_store_dwordx4 v[4:7], v14, s[24:27], s39 offen offset:0 sc1
    buffer_store_dwordx4 v[4:7], v14, s[24:27], s39 offen offset:1024 sc1
    buffer_store_dwordx4 v[4:7], v14, s[24:27], s39 offen offset:2048 sc1
    buffer_store_dwordx4 v[4:7], v14, s[24:27], s39 offen offset:3072 sc1
    s_mul_i32 s38, s3, 9344
    s_add_u32 s38, s38, 0x470000
    s_add_u32 s39, s38, 4096
    buffer_store_dwordx4 v[4:7], v14, s[24:27], s38 offen offset:0 sc1
    buffer_store_dwordx4 v[4:7], v14, s[24:27], s38 offen offset:1024 sc1
    buffer_store_dwordx4 v[4:7], v14, s[24:27], s38 offen offset:2048 sc1
    buffer_store_dwordx4 v[4:7], v14, s[24:27], s38 offen offset:3072 sc1
    buffer_store_dwordx4 v[4:7], v14, s[24:27], s39 offen offset:0 sc1
    buffer_store_dwordx4 v[4:7], v14, s[24:27], s39 offen offset:1024 sc1
    s_waitcnt lgkmcnt(0)
    s_add_u32 s56, s56, 1
    v_mov_b32 v202, s56
    ds_write_b32 v201, v202 offset:8
    s_waitcnt vmcnt(14)
    ds_write_b32 v201, v204
    s_waitcnt vmcnt(0)
    ds_write_b32 v201, v204 offset:4
fk_Hconst:
    s_sub_u32 s20, s16, 4
    v_lshrrev_b32 v208, 3, v15
    v_and_b32 v209, 7, v15
    v_and_b32 v210, 2, v208
    v_xor_b32 v209, v210, v209
    v_mul_u32_u24 v208, 7168, v208
    v_lshl_add_u32 v208, v209, 4, v208
    v_lshrrev_b32 v210, 5, v15
    v_lshlrev_b32 v210, 11, v210
    v_and_b32 v209, 31, v15
    v_lshl_add_u32 v210, v209, 4, v210
    s_and_b32 s12, s3, 3
    s_mul_i32 s100, s12, 1835008
    s_lshl_b32 s101, s12, 9
    s_lshr_b32 s12, s3, 2
    s_lshl_b32 s12, s12, 7
    s_add_u32 s100, s100, s12
    s_lshl_b32 s12, s12, 10
    s_add_u32 s101, s101, s12
    s_xor_b32 s99, s100, 0
    s_and_b32 s12, s20, 1
    s_lshl_b32 s12, s12, 6
    v_xor_b32 v206, s12, v208
    v_xor_b32 v207, 64, v206
    s_mov_b32 s6, 0x700000
    s_mov_b32 s7, 0x00020000
    s_cmp_gt_u32 s3, 223
    s_cselect_b32 s36, 3, s20
    s_waitcnt lgkmcnt(0)
    v_lshrrev_b32 v4, 1, v1
    v_and_b32 v5, 1, v4
    v_lshrrev_b32 v6, 2, v4
    v_lshl_add_u32 v5, v6, 1, v5
    v_and_b32 v6, 2, v4
    v_lshl_add_u32 v5, v6, 2, v5
    s_and_b32 s13, s20, 1
    s_mul_i32 s13, s13, 15
    v_xor_b32 v5, s13, v5
    s_lshl_b32 s13, s20, 4
    v_add_u32 v5, s13, v5
    v_cvt_f32_u32 v5, v5
    v_and_b32 v9, 1, v1
    v_lshlrev_b32 v7, 2, v2
    v_cvt_f32_u32 v7, v7
    v_cvt_f32_u32 v10, v9
    v_mul_f32 v8, 0x3c800000, v5
    v_mul_f32 v10, 0x3e800000, v10
    v_fma_f32 v10, v8, v7, v10
    v_mov_b32 v128, v10
    v_fmamk_f32 v129, v8, 0x3f800000, v10
    v_fmamk_f32 v130, v8, 0x40000000, v10
    v_fmamk_f32 v131, v8, 0x40400000, v10
    v_fmamk_f32 v132, v8, 0x41000000, v10
    v_fmamk_f32 v133, v8, 0x41100000, v10
    v_fmamk_f32 v134, v8, 0x41200000, v10
    v_fmamk_f32 v135, v8, 0x41300000, v10
    v_fmamk_f32 v136, v8, 0x41800000, v10
    v_fmamk_f32 v137, v8, 0x41880000, v10
    v_fmamk_f32 v138, v8, 0x41900000, v10
    v_fmamk_f32 v139, v8, 0x41980000, v10
    v_fmamk_f32 v140, v8, 0x41c00000, v10
    v_fmamk_f32 v141, v8, 0x41c80000, v10
    v_fmamk_f32 v142, v8, 0x41d00000, v10
    v_fmamk_f32 v143, v8, 0x41d80000, v10
    v_cos_f32 v144, v128
    v_cos_f32 v145, v129
    v_cos_f32 v146, v130
    v_cos_f32 v147, v131
    v_cos_f32 v148, v132
    v_cos_f32 v149, v133
    v_cos_f32 v150, v134
    v_cos_f32 v151, v135
    v_cos_f32 v152, v136
    v_cos_f32 v153, v137
    v_cos_f32 v154, v138
    v_cos_f32 v155, v139
    v_cos_f32 v156, v140
    v_cos_f32 v157, v141
    v_cos_f32 v158, v142
    v_cos_f32 v159, v143
    v_sin_f32 v160, v128
    v_sin_f32 v161, v129
    v_sin_f32 v162, v130
    v_sin_f32 v163, v131
    v_sin_f32 v164, v132
    v_sin_f32 v165, v133
    v_sin_f32 v166, v134
    v_sin_f32 v167, v135
    v_sin_f32 v168, v136
    v_sin_f32 v169, v137
    v_sin_f32 v170, v138
    v_sin_f32 v171, v139
    v_sin_f32 v172, v140
    v_sin_f32 v173, v141
    v_sin_f32 v174, v142
    v_sin_f32 v175, v143
    v_cvt_pk_f16_f32 v48, v144, v160
    v_cvt_pk_f16_f32 v49, v145, v161
    v_cvt_pk_f16_f32 v50, v146, v162
    v_cvt_pk_f16_f32 v51, v147, v163
    v_cvt_pk_f16_f32 v52, v148, v164
    v_cvt_pk_f16_f32 v53, v149, v165
    v_cvt_pk_f16_f32 v54, v150, v166
    v_cvt_pk_f16_f32 v55, v151, v167
    v_cvt_pk_f16_f32 v56, v152, v168
    v_cvt_pk_f16_f32 v57, v153, v169
    v_cvt_pk_f16_f32 v58, v154, v170
    v_cvt_pk_f16_f32 v59, v155, v171
    v_cvt_pk_f16_f32 v60, v156, v172
    v_cvt_pk_f16_f32 v61, v157, v173
    v_cvt_pk_f16_f32 v62, v158, v174
    s_cmp_eq_u32 s36, 3
    s_cbranch_scc1 fk_gu0
    s_add_u32 s37, s20, 0
    s_lshl_b32 s12, s37, 10
    s_mov_b32 m0, s12
    s_cmp_lt_u32 s37, 32
    s_cselect_b64 s[4:5], s[44:45], s[48:49]
    s_and_b32 s37, s37, 31
    s_mul_i32 s37, s37, 57344
    s_add_u32 s37, s37, s100
    buffer_load_dwordx4 v206, s[4:7], s37 offen lds
fk_gu0:
    s_cmp_eq_u32 s36, 3
    s_cbranch_scc1 fk_gu1
    s_add_u32 s37, s20, 3
    s_lshl_b32 s12, s37, 10
    s_mov_b32 m0, s12
    s_cmp_lt_u32 s37, 32
    s_cselect_b64 s[4:5], s[44:45], s[48:49]
    s_and_b32 s37, s37, 31
    s_mul_i32 s37, s37, 57344
    s_add_u32 s37, s37, s100
    buffer_load_dwordx4 v207, s[4:7], s37 offen lds
fk_gu1:
    s_cmp_eq_u32 s36, 3
    s_cbranch_scc1 fk_gu2
    s_add_u32 s37, s20, 6
    s_lshl_b32 s12, s37, 10
    s_mov_b32 m0, s12
    s_cmp_lt_u32 s37, 32
    s_cselect_b64 s[4:5], s[44:45], s[48:49]
    s_and_b32 s37, s37, 31
    s_mul_i32 s37, s37, 57344
    s_add_u32 s37, s37, s100
    buffer_load_dwordx4 v206, s[4:7], s37 offen lds
fk_gu2:
    s_cmp_eq_u32 s36, 3
    s_cbranch_scc1 fk_gu3
    s_add_u32 s37, s20, 9
    s_lshl_b32 s12, s37, 10
    s_mov_b32 m0, s12
    s_cmp_lt_u32 s37, 32
    s_cselect_b64 s[4:5], s[44:45], s[48:49]
    s_and_b32 s37, s37, 31
    s_mul_i32 s37, s37, 57344
    s_add_u32 s37, s37, s100
    buffer_load_dwordx4 v207, s[4:7], s37 offen lds
fk_gu3:
    v_cvt_pk_f16_f32 v63, v159, v175
    v_fmamk_f32 v128, v8, 0x42000000, v10
    v_fmamk_f32 v129, v8, 0x42040000, v10
    v_fmamk_f32 v130, v8, 0x42080000, v10
    v_fmamk_f32 v131, v8, 0x420c0000, v10
    v_fmamk_f32 v132, v8, 0x42200000, v10
    v_fmamk_f32 v133, v8, 0x42240000, v10
    v_fmamk_f32 v134, v8, 0x42280000, v10
    v_fmamk_f32 v135, v8, 0x422c0000, v10
    v_fmamk_f32 v136, v8, 0x42400000, v10
    v_fmamk_f32 v137, v8, 0x42440000, v10
    v_fmamk_f32 v138, v8, 0x42480000, v10
    v_fmamk_f32 v139, v8, 0x424c0000, v10
    v_fmamk_f32 v140, v8, 0x42600000, v10
    v_fmamk_f32 v141, v8, 0x42640000, v10
    v_fmamk_f32 v142, v8, 0x42680000, v10
    v_fmamk_f32 v143, v8, 0x426c0000, v10
    v_cos_f32 v144, v128
    v_cos_f32 v145, v129
    v_cos_f32 v146, v130
    v_cos_f32 v147, v131
    v_cos_f32 v148, v132
    v_cos_f32 v149, v133
    v_cos_f32 v150, v134
    v_cos_f32 v151, v135
    v_cos_f32 v152, v136
    v_cos_f32 v153, v137
    v_cos_f32 v154, v138
    v_cos_f32 v155, v139
    v_cos_f32 v156, v140
    v_cos_f32 v157, v141
    v_cos_f32 v158, v142
    v_cos_f32 v159, v143
    v_sin_f32 v160, v128
    v_sin_f32 v161, v129
    v_sin_f32 v162, v130
    v_sin_f32 v163, v131
    v_sin_f32 v164, v132
    v_sin_f32 v165, v133
    v_sin_f32 v166, v134
    v_sin_f32 v167, v135
    v_sin_f32 v168, v136
    v_sin_f32 v169, v137
    v_sin_f32 v170, v138
    v_sin_f32 v171, v139
    v_sin_f32 v172, v140
    v_sin_f32 v173, v141
    v_sin_f32 v174, v142
    v_sin_f32 v175, v143
    v_cvt_pk_f16_f32 v64, v144, v160
    v_cvt_pk_f16_f32 v65, v145, v161
    v_cvt_pk_f16_f32 v66, v146, v162
    v_cvt_pk_f16_f32 v67, v147, v163
    v_cvt_pk_f16_f32 v68, v148, v164
    v_cvt_pk_f16_f32 v69, v149, v165
    v_cvt_pk_f16_f32 v70, v150, v166
    v_cvt_pk_f16_f32 v71, v151, v167
    v_cvt_pk_f16_f32 v72, v152, v168
    v_cvt_pk_f16_f32 v73, v153, v169
    v_cvt_pk_f16_f32 v74, v154, v170
    v_cvt_pk_f16_f32 v75, v155, v171
    v_cvt_pk_f16_f32 v76, v156, v172
    v_cvt_pk_f16_f32 v77, v157, v173
    v_cvt_pk_f16_f32 v78, v158, v174
    v_cvt_pk_f16_f32 v79, v159, v175
    v_lshlrev_b32 v11, 31, v9
    v_mul_f32 v10, 0x3a000000, v5
    v_xor_b32 v10, v11, v10
    v_mul_f32 v11, v10, v7
    v_mov_b32 v128, v11
    v_fmamk_f32 v129, v10, 0x3f800000, v11
    v_fmamk_f32 v130, v10, 0x40000000, v11
    v_fmamk_f32 v131, v10, 0x40400000, v11
    v_fmamk_f32 v132, v10, 0x41000000, v11
    v_fmamk_f32 v133, v10, 0x41100000, v11
    v_fmamk_f32 v134, v10, 0x41200000, v11
    v_fmamk_f32 v135, v10, 0x41300000, v11
    v_fmamk_f32 v136, v10, 0x41800000, v11
    v_fmamk_f32 v137, v10, 0x41880000, v11
    v_fmamk_f32 v138, v10, 0x41900000, v11
    v_fmamk_f32 v139, v10, 0x41980000, v11
    v_fmamk_f32 v140, v10, 0x41c00000, v11
    v_fmamk_f32 v141, v10, 0x41c80000, v11
    v_fmamk_f32 v142, v10, 0x41d00000, v11
    v_fmamk_f32 v143, v10, 0x41d80000, v11
    v_cos_f32 v80, v128
    v_cos_f32 v81, v129
    v_cos_f32 v82, v130
    v_cos_f32 v83, v131
    v_cos_f32 v84, v132
    v_cos_f32 v85, v133
    v_cos_f32 v86, v134
    v_cos_f32 v87, v135
    v_cos_f32 v88, v136
    v_cos_f32 v89, v137
    v_cos_f32 v90, v138
    v_cos_f32 v91, v139
    v_cos_f32 v92, v140
    v_cos_f32 v93, v141
    v_cos_f32 v94, v142
    v_cos_f32 v95, v143
    v_sin_f32 v96, v128
    v_sin_f32 v97, v129
    v_sin_f32 v98, v130
    v_sin_f32 v99, v131
    v_sin_f32 v100, v132
    v_sin_f32 v101, v133
    v_sin_f32 v102, v134
    v_sin_f32 v103, v135
    v_sin_f32 v104, v136
    v_sin_f32 v105, v137
    v_sin_f32 v106, v138
    v_sin_f32 v107, v139
    v_sin_f32 v108, v140
    v_sin_f32 v109, v141
    v_sin_f32 v110, v142
    v_sin_f32 v111, v143
    v_sub_u32 v4, 31, v1
    v_subrev_u32 v5, 1, v1
    v_cmp_lt_u32 vcc, 16, v1
    s_nop 1
    v_cndmask_b32 v4, v5, v4, vcc
    v_and_b32 v4, 15, v4
    v_lshlrev_b32 v4, 5, v4
    v_add_u32 v4, 130304, v4
    v_lshlrev_b32 v5, 9, v2
    v_add_u32 v6, v4, v5
    v_sub_u32 v7, v4, v5
    v_add_u32 v7, 7696, v7
    v_cmp_eq_u32 s[38:39], 0, v1
    v_mov_b32 v8, 4096
    s_nop 0
    v_cndmask_b32 v8, 0, v8, s[38:39]
    v_add_u32 v6, v6, v8
    v_add_u32 v7, v7, v8
    v_and_b32 v8, 15, v1
    v_cmp_eq_u32 s[38:39], 0, v8
    s_nop 1
    s_or_b64 s[40:41], s[38:39], vcc
    v_add_u32 v184, 0, v6
    v_subrev_u32 v8, 0, v7
    v_cndmask_b32 v184, v184, v8, vcc
    v_add_u32 v185, 1024, v6
    v_subrev_u32 v8, 1024, v7
    v_cndmask_b32 v185, v185, v8, vcc
    v_add_u32 v186, 2048, v6
    v_subrev_u32 v8, 2048, v7
    v_cndmask_b32 v186, v186, v8, vcc
    v_add_u32 v187, 3072, v6
    v_subrev_u32 v8, 3072, v7
    v_cndmask_b32 v187, v187, v8, vcc
    v_add_u32 v188, 4096, v6
    v_subrev_u32 v8, 4096, v7
    v_cndmask_b32 v188, v188, v8, s[40:41]
    v_add_u32 v189, 5120, v6
    v_subrev_u32 v8, 5120, v7
    v_cndmask_b32 v189, v189, v8, s[40:41]
    v_add_u32 v190, 6144, v6
    v_subrev_u32 v8, 6144, v7
    v_cndmask_b32 v190, v190, v8, s[40:41]
    v_add_u32 v191, 7168, v6
    v_subrev_u32 v8, 7168, v7
    v_cndmask_b32 v191, v191, v8, s[40:41]
    v_add_u32 v212, 512, v188
    v_add_u32 v213, 512, v189
    v_add_u32 v214, 512, v190
    v_add_u32 v215, 512, v191
    v_subrev_u32 v8, 4096, v212
    v_cmp_eq_u32 vcc, 0, v2
    s_nop 1
    v_cndmask_b32 v212, v212, v8, vcc
    s_lshr_b32 s13, s20, 1
    v_lshl_add_u32 v3, v1, 1, s13
    s_and_b32 s13, s20, 1
    s_sub_u32 s14, 64, s13
    v_and_b32 v8, 3, v3
    v_lshlrev_b32 v8, 2, v8
    v_lshlrev_b32 v4, 3, v3
    v_sub_u32 v4, v4, v8
    v_sub_u32 v5, 63, v3
    v_and_b32 v8, 3, v5
    v_mul_u32_u24 v8, 12, v8
    v_lshlrev_b32 v6, 3, v5
    v_sub_u32 v6, v6, v8
    v_add_u32 v6, 28, v6
    v_sub_u32 v5, s14, v3
    v_and_b32 v8, 3, v5
    v_mul_u32_u24 v8, 12, v8
    v_lshlrev_b32 v7, 3, v5
    v_sub_u32 v7, v7, v8
    v_add_u32 v7, 28, v7
    v_cmp_gt_u32 vcc, 32, v3
    s_nop 1
    v_cndmask_b32 v7, v7, v4, vcc
    v_cmp_eq_u32 vcc, 32, v5
    s_nop 1
    v_cndmask_b32 v7, v7, 28, vcc
    s_cmp_eq_u32 s13, 0
    s_cselect_b32 s14, 256, 0
    s_cselect_b32 s15, 576, 0
    s_cselect_b64 s[38:39], -1, 0
    s_add_u32 s14, s14, 7680
    s_sub_u32 s15, 120832, s15
    v_cmp_gt_u32 vcc, 32, v3
    s_nop 1
    v_cndmask_b32 v7, v7, v4, vcc
    v_add_u32 v7, s14, v7
    v_cndmask_b32 v4, v6, v4, s[38:39]
    v_lshl_add_u32 v4, v2, 12, v4
    v_lshrrev_b32 v8, 7, v4
    v_lshl_add_u32 v4, v8, 4, v4
    v_lshrrev_b32 v8, 7, v7
    v_lshl_add_u32 v7, v8, 4, v7
    v_add_u32 v11, s15, v4
    v_add_u32 v7, 120832, v7
    v_add_u32 v12, 4032, v11
    v_cmp_eq_u32 vcc, s13, v2
    s_nop 1
    s_and_b64 s[40:41], vcc, s[38:39]
    s_andn2_b64 s[38:39], vcc, s[38:39]
    v_cndmask_b32 v10, v11, v7, s[40:41]
    v_cndmask_b32 v12, v12, v7, s[38:39]
    s_lshl_b32 s23, s20, 5
    s_add_u32 s23, s23, s18
    v_and_b32 v3, 15, v15
    v_lshrrev_b32 v4, 4, v15
    v_lshl_add_u32 v3, v3, 7, v4
    v_add_u32 v3, 1, v3
    v_cmp_le_u32 vcc, 56, v15
    v_mov_b32 v4, 1008
    s_nop 0
    v_cndmask_b32 v4, 0, v4, vcc
    v_add_u32 v4, v3, v4
    v_mul_u32_u24 v3, s23, v3
    v_and_b32 v3, 2047, v3
    v_cvt_f32_u32 v3, v3
    v_mul_f32 v3, 0x3a000000, v3
    v_mul_u32_u24 v4, s23, v4
    v_and_b32 v4, 2047, v4
    v_cvt_f32_u32 v4, v4
    v_mul_f32 v4, 0x3a000000, v4
    v_cvt_f32_u32 v5, s23
    v_mul_f32 v5, 0x3a000000, v5
    v_mov_b32 v192, v3
    v_fmamk_f32 v193, v5, 0x42000000, v3
    v_fmamk_f32 v194, v5, 0x42800000, v3
    v_fmamk_f32 v195, v5, 0x42c00000, v3
    v_fmamk_f32 v196, v5, 0x40800000, v3
    v_fmamk_f32 v197, v5, 0x42100000, v3
    v_fmamk_f32 v198, v5, 0x42880000, v3
    v_fmamk_f32 v199, v5, 0x42c80000, v3
    v_fmamk_f32 v200, v5, 0x41000000, v3
    v_fmamk_f32 v201, v5, 0x42200000, v3
    v_fmamk_f32 v202, v5, 0x42900000, v3
    v_fmamk_f32 v203, v5, 0x42d00000, v3
    v_fmamk_f32 v204, v5, 0x41400000, v4
    v_fmamk_f32 v205, v5, 0x42300000, v4
    v_fmamk_f32 v206, v5, 0x42980000, v4
    v_fmamk_f32 v207, v5, 0x42d80000, v4
    v_cos_f32 v192, v192
    v_cos_f32 v193, v193
    v_cos_f32 v194, v194
    v_cos_f32 v195, v195
    v_cos_f32 v196, v196
    v_cos_f32 v197, v197
    v_cos_f32 v198, v198
    v_cos_f32 v199, v199
    v_cos_f32 v200, v200
    v_cos_f32 v201, v201
    v_cos_f32 v202, v202
    v_cos_f32 v203, v203
    v_cos_f32 v204, v204
    v_cos_f32 v205, v205
    v_cos_f32 v206, v206
    v_cos_f32 v207, v207
    v_add_u32 v9, 138496, v14
    v_mov_b32 v3, 157864
    s_nop 4
fk_c2s:
    ds_read_b32 v4, v3
    s_waitcnt lgkmcnt(0)
    v_readfirstlane_b32 s13, v4
    s_nop 1
    s_cmp_eq_u32 s13, 0
    s_cbranch_scc1 fk_c2s
    ds_read_b128 v[112:115], v9 offset:12288
    ds_read_b128 v[116:119], v9 offset:13312
    ds_read_b128 v[120:123], v9 offset:14336
    ds_read_b128 v[124:127], v9 offset:15360
    s_setprio 2
    s_waitcnt lgkmcnt(0)
    s_barrier
    ds_read_b128 v[16:19], v184
    ds_read_b128 v[20:23], v185
    ds_read_b128 v[24:27], v186
    ds_read_b128 v[28:31], v187
    ds_read_b128 v[32:35], v188
    ds_read_b128 v[36:39], v189
    ds_read_b128 v[40:43], v190
    ds_read_b128 v[44:47], v191
    s_mov_b32 exec_lo, 1
    s_mov_b32 exec_hi, 1
    ds_read_b32 v32, v212
    ds_read_b32 v36, v213
    ds_read_b32 v40, v214
    ds_read_b32 v44, v215
    s_mov_b64 exec, -1
    s_waitcnt lgkmcnt(11)
    v_mfma_f32_32x32x16_f16 v[128:143], v[16:19], v[48:51], 0
    s_waitcnt lgkmcnt(10)
    v_mfma_f32_32x32x16_f16 v[128:143], v[20:23], v[52:55], v[128:143]
    s_waitcnt lgkmcnt(9)
    v_mfma_f32_32x32x16_f16 v[128:143], v[24:27], v[56:59], v[128:143]
    s_waitcnt lgkmcnt(8)
    v_mfma_f32_32x32x16_f16 v[128:143], v[28:31], v[60:63], v[128:143]
    s_waitcnt lgkmcnt(3)
    v_mfma_f32_32x32x16_f16 v[128:143], v[32:35], v[64:67], v[128:143]
    s_waitcnt lgkmcnt(2)
    v_mfma_f32_32x32x16_f16 v[128:143], v[36:39], v[68:71], v[128:143]
    s_waitcnt lgkmcnt(1)
    v_mfma_f32_32x32x16_f16 v[128:143], v[40:43], v[72:75], v[128:143]
    s_waitcnt lgkmcnt(0)
    v_mfma_f32_32x32x16_f16 v[128:143], v[44:47], v[76:79], v[128:143]
    s_nop 11
    v_pk_mul_f32 v[16:17], v[128:129], v[80:81]
    v_pk_mul_f32 v[18:19], v[130:131], v[82:83]
    v_pk_mul_f32 v[20:21], v[132:133], v[84:85]
    v_pk_mul_f32 v[22:23], v[134:135], v[86:87]
    v_pk_mul_f32 v[24:25], v[136:137], v[88:89]
    v_pk_mul_f32 v[26:27], v[138:139], v[90:91]
    v_pk_mul_f32 v[28:29], v[140:141], v[92:93]
    v_pk_mul_f32 v[30:31], v[142:143], v[94:95]
    v_fmac_f32_dpp v16, v128, v96 quad_perm:[1,0,3,2] row_mask:0xf bank_mask:0xf
    v_fmac_f32_dpp v17, v129, v97 quad_perm:[1,0,3,2] row_mask:0xf bank_mask:0xf
    v_fmac_f32_dpp v18, v130, v98 quad_perm:[1,0,3,2] row_mask:0xf bank_mask:0xf
    v_fmac_f32_dpp v19, v131, v99 quad_perm:[1,0,3,2] row_mask:0xf bank_mask:0xf
    v_fmac_f32_dpp v20, v132, v100 quad_perm:[1,0,3,2] row_mask:0xf bank_mask:0xf
    v_fmac_f32_dpp v21, v133, v101 quad_perm:[1,0,3,2] row_mask:0xf bank_mask:0xf
    v_fmac_f32_dpp v22, v134, v102 quad_perm:[1,0,3,2] row_mask:0xf bank_mask:0xf
    v_fmac_f32_dpp v23, v135, v103 quad_perm:[1,0,3,2] row_mask:0xf bank_mask:0xf
    v_cvt_pk_f16_f32 v176, v16, v17
    v_cvt_pk_f16_f32 v177, v18, v19
    v_cvt_pk_f16_f32 v178, v20, v21
    v_cvt_pk_f16_f32 v179, v22, v23
    v_fmac_f32_dpp v24, v136, v104 quad_perm:[1,0,3,2] row_mask:0xf bank_mask:0xf
    v_fmac_f32_dpp v25, v137, v105 quad_perm:[1,0,3,2] row_mask:0xf bank_mask:0xf
    v_mfma_f32_32x32x16_f16 v[144:159], v[176:179], v[112:115], 0
    v_fmac_f32_dpp v26, v138, v106 quad_perm:[1,0,3,2] row_mask:0xf bank_mask:0xf
    v_fmac_f32_dpp v27, v139, v107 quad_perm:[1,0,3,2] row_mask:0xf bank_mask:0xf
    v_fmac_f32_dpp v28, v140, v108 quad_perm:[1,0,3,2] row_mask:0xf bank_mask:0xf
    v_fmac_f32_dpp v29, v141, v109 quad_perm:[1,0,3,2] row_mask:0xf bank_mask:0xf
    v_fmac_f32_dpp v30, v142, v110 quad_perm:[1,0,3,2] row_mask:0xf bank_mask:0xf
    v_mfma_f32_32x32x16_f16 v[160:175], v[176:179], v[120:123], 0
    v_fmac_f32_dpp v31, v143, v111 quad_perm:[1,0,3,2] row_mask:0xf bank_mask:0xf
    v_cvt_pk_f16_f32 v180, v24, v25
    v_cvt_pk_f16_f32 v181, v26, v27
    v_cvt_pk_f16_f32 v182, v28, v29
    v_cvt_pk_f16_f32 v183, v30, v31
    s_nop 1
    v_mfma_f32_32x32x16_f16 v[144:159], v[180:183], v[116:119], v[144:159]
    v_mfma_f32_32x32x16_f16 v[160:175], v[180:183], v[124:127], v[160:175]
    s_nop 11
    v_pk_add_f32 v[16:17], v[144:145], v[160:161] op_sel:[0,1] op_sel_hi:[1,0] neg_hi:[0,1]
    v_pk_add_f32 v[18:19], v[146:147], v[162:163] op_sel:[0,1] op_sel_hi:[1,0] neg_hi:[0,1]
    v_pk_add_f32 v[20:21], v[148:149], v[164:165] op_sel:[0,1] op_sel_hi:[1,0] neg_hi:[0,1]
    v_pk_add_f32 v[22:23], v[150:151], v[166:167] op_sel:[0,1] op_sel_hi:[1,0] neg_hi:[0,1]
    v_pk_add_f32 v[24:25], v[152:153], v[168:169] op_sel:[0,1] op_sel_hi:[1,0] neg_hi:[0,1]
    v_pk_add_f32 v[26:27], v[154:155], v[170:171] op_sel:[0,1] op_sel_hi:[1,0] neg_hi:[0,1]
    v_pk_add_f32 v[28:29], v[156:157], v[172:173] op_sel:[0,1] op_sel_hi:[1,0] neg_hi:[0,1]
    v_pk_add_f32 v[30:31], v[158:159], v[174:175] op_sel:[0,1] op_sel_hi:[1,0] neg_hi:[0,1]
    v_cvt_pk_f16_f32 v48, v16, v17
    ds_write_b32 v10, v48
    v_cvt_pk_f16_f32 v49, v18, v19
    ds_write_b32 v11, v49 offset:576
    v_cvt_pk_f16_f32 v50, v20, v21
    ds_write_b32 v11, v50 offset:1152
    v_cvt_pk_f16_f32 v51, v22, v23
    ds_write_b32 v11, v51 offset:1728
    v_cvt_pk_f16_f32 v52, v24, v25
    ds_write_b32 v11, v52 offset:2304
    v_cvt_pk_f16_f32 v53, v26, v27
    ds_write_b32 v11, v53 offset:2880
    v_cvt_pk_f16_f32 v54, v28, v29
    ds_write_b32 v11, v54 offset:3456
    v_cvt_pk_f16_f32 v55, v30, v31
    ds_write_b32 v12, v55
    s_nop 3
fk_common:
    v_lshlrev_b32 v4, 4, v0
    v_lshrrev_b32 v5, 3, v0
    v_lshl_add_u32 v5, v5, 4, v4
    v_add_u32 v5, 120832, v5
    s_mul_i32 s17, s3, 8320
    s_add_u32 s17, s17, 0x268000
    s_waitcnt lgkmcnt(0)
    s_barrier
    s_setprio 0
    ds_read_b128 v[16:19], v5
    s_sub_u32 s13, 7, s16
    s_cmp_lt_u32 s16, 4
    s_cselect_b32 s13, s16, s13
    s_cselect_b32 s14, 0, 2048
    s_lshl_b32 s21, s13, 5
    s_add_u32 s21, s21, s18
    s_sub_u32 s22, 2048, s21
    s_and_b32 s22, s22, 2047
    s_cmp_lt_u32 s16, 4
    s_cselect_b32 s21, s21, s22
    s_lshl_b32 s13, s13, 12
    s_add_u32 s13, s13, s14
    s_add_u32 s13, s13, 98304
    s_lshl_b32 s14, s3, 3
    s_add_u32 s19, s14, s16
    s_cmp_eq_u32 s19, 1991
    s_cselect_b32 s21, 1024, s21
    s_cselect_b32 s13, 118784, s13
    s_lshl_b32 s22, s21, 11
    v_add_u32 v6, s13, v14
    v_add_u32 v7, 155008, v14
    s_waitcnt lgkmcnt(0)
    v_min_u32 v16, -2, v16
    v_min_u32 v17, -2, v17
    v_min_u32 v18, -2, v18
    v_min_u32 v19, -2, v19
    buffer_store_dwordx4 v[16:19], v4, s[24:27], s17 offen sc1
    ds_read_b128 v[20:23], v6
    ds_read_b128 v[24:27], v6 offset:1024
    ds_read_b128 v[28:31], v7
    ds_read_b128 v[32:35], v7 offset:1024
    s_cmp_lt_u32 s16, 4
    s_cbranch_scc1 fk_noy5
    v_add_u32 v3, 114688, v14
    v_mov_b32 v4, 157152
    ds_read_b128 v[128:131], v3 offset:0
    ds_read_b128 v[132:135], v3 offset:1024
    ds_read_b128 v[136:139], v3 offset:2048
    ds_read_b128 v[140:143], v3 offset:3072
    ds_read_b32 v9, v4
    s_lshl_b32 s38, s20, 2
    s_sub_u32 s39, 28, s38
    s_waitcnt lgkmcnt(0)
    s_nop 0
fk_y5:
    v_pk_mul_f32 v[144:145], v[128:129], v[192:193]
    v_pk_mul_f32 v[146:147], v[130:131], v[194:195]
    v_pk_fma_f32 v[144:145], v[132:133], v[196:197], v[144:145]
    v_pk_fma_f32 v[146:147], v[134:135], v[198:199], v[146:147]
    v_pk_fma_f32 v[144:145], v[136:137], v[200:201], v[144:145]
    v_pk_fma_f32 v[146:147], v[138:139], v[202:203], v[146:147]
    v_pk_fma_f32 v[144:145], v[140:141], v[204:205], v[144:145]
    v_pk_fma_f32 v[146:147], v[142:143], v[206:207], v[146:147]
    v_pk_add_f32 v[144:145], v[144:145], v[146:147]
    v_add_f32 v144, v144, v145
    s_lshl_b32 s13, s23, 31
    v_xor_b32 v12, s13, v9
    v_add_f32_dpp v144, v144, v144 quad_perm:[1,0,3,2] row_mask:0xf bank_mask:0xf
    s_nop 1
    v_add_f32_dpp v144, v144, v144 quad_perm:[2,3,0,1] row_mask:0xf bank_mask:0xf
    s_nop 1
    v_add_f32_dpp v144, v144, v144 row_half_mirror row_mask:0xf bank_mask:0xf
    s_nop 1
    v_add_f32_dpp v144, v144, v144 row_mirror row_mask:0xf bank_mask:0xf
    s_nop 1
    v_add_f32_dpp v144, v144, v144 row_bcast:15 row_mask:0xa bank_mask:0xf
    s_nop 1
    v_add_f32_dpp v144, v144, v144 row_bcast:31 row_mask:0xc bank_mask:0xf
    v_add_f32 v144, v144, v12
    v_add_f32 v144, v144, v144
    v_cvt_f16_f32 v144, v144
    s_add_u32 s13, s38, 157088
    s_add_u32 s14, s39, 157088
    v_mov_b32 v10, s13
    v_mov_b32 v11, s14
    s_mov_b32 exec_lo, 0
    s_mov_b32 exec_hi, 0x80000000
    ds_write_b32 v10, v144
    ds_write_b32 v11, v144
    s_mov_b64 exec, -1
    s_cmp_lg_u32 s23, 0
    s_cbranch_scc1 fk_noy5
    s_mov_b32 s23, 1024
    s_mov_b32 s38, 28
    v_and_b32 v3, 15, v15
    v_lshrrev_b32 v4, 4, v15
    v_lshl_add_u32 v3, v3, 7, v4
    v_add_u32 v3, 1, v3
    v_cmp_le_u32 vcc, 56, v15
    v_mov_b32 v4, 1008
    s_nop 0
    v_cndmask_b32 v4, 0, v4, vcc
    v_add_u32 v4, v3, v4
    v_mul_u32_u24 v3, s23, v3
    v_and_b32 v3, 2047, v3
    v_cvt_f32_u32 v3, v3
    v_mul_f32 v3, 0x3a000000, v3
    v_mul_u32_u24 v4, s23, v4
    v_and_b32 v4, 2047, v4
    v_cvt_f32_u32 v4, v4
    v_mul_f32 v4, 0x3a000000, v4
    v_cvt_f32_u32 v5, s23
    v_mul_f32 v5, 0x3a000000, v5
    v_mov_b32 v192, v3
    v_fmamk_f32 v193, v5, 0x42000000, v3
    v_fmamk_f32 v194, v5, 0x42800000, v3
    v_fmamk_f32 v195, v5, 0x42c00000, v3
    v_fmamk_f32 v196, v5, 0x40800000, v3
    v_fmamk_f32 v197, v5, 0x42100000, v3
    v_fmamk_f32 v198, v5, 0x42880000, v3
    v_fmamk_f32 v199, v5, 0x42c80000, v3
    v_fmamk_f32 v200, v5, 0x41000000, v3
    v_fmamk_f32 v201, v5, 0x42200000, v3
    v_fmamk_f32 v202, v5, 0x42900000, v3
    v_fmamk_f32 v203, v5, 0x42d00000, v3
    v_fmamk_f32 v204, v5, 0x41400000, v4
    v_fmamk_f32 v205, v5, 0x42300000, v4
    v_fmamk_f32 v206, v5, 0x42980000, v4
    v_fmamk_f32 v207, v5, 0x42d80000, v4
    v_cos_f32 v192, v192
    v_cos_f32 v193, v193
    v_cos_f32 v194, v194
    v_cos_f32 v195, v195
    v_cos_f32 v196, v196
    v_cos_f32 v197, v197
    v_cos_f32 v198, v198
    v_cos_f32 v199, v199
    v_cos_f32 v200, v200
    v_cos_f32 v201, v201
    v_cos_f32 v202, v202
    v_cos_f32 v203, v203
    v_cos_f32 v204, v204
    v_cos_f32 v205, v205
    v_cos_f32 v206, v206
    v_cos_f32 v207, v207
    s_branch fk_y5
    s_nop 3
fk_noy5:
    v_lshrrev_b32 v1, 1, v0
    v_and_b32 v45, 1, v0
    v_lshrrev_b32 v2, 4, v1
    v_and_b32 v3, 15, v1
    v_cmp_gt_u32 vcc, 8, v3
    v_sub_u32 v6, 16, v3
    v_and_b32 v6, 7, v6
    v_sub_u32 v5, 31, v2
    v_cndmask_b32 v6, v6, v3, vcc
    v_cndmask_b32 v5, v5, v2, vcc
    v_lshl_add_u32 v4, v6, 5, v5
    v_and_b32 v12, 63, v4
    v_lshrrev_b32 v13, 6, v4
    v_lshlrev_b32 v13, 2, v13
    v_lshl_add_u32 v12, v12, 4, v13
    s_mov_b32 s23, 0x13000
    s_mov_b32 s42, 0
    buffer_load_dword v47, v12, s[24:27], s23 offen sc1
    v_mul_u32_u24 v4, 8320, v4
    v_lshl_add_u32 v4, v45, 4, v4
    s_lshl_b32 s17, s3, 5
    s_add_u32 s17, s17, 0x268000
    v_cndmask_b32 v6, -1, 1, vcc
    v_cmp_eq_u32 vcc, 8, v3
    v_mul_u32_u24 v46, 8256, v45
    v_add_u32 v46, 138496, v46
    v_cndmask_b32 v6, v6, 15, vcc
    v_lshlrev_b32 v9, 2, v1
    v_lshl_add_u32 v10, v6, 1, v9
    v_add_u32 v9, v46, v9
    v_add_u32 v10, v46, v10
    s_mul_i32 s36, s16, 2064
    s_add_u32 s36, s36, 138496
    v_add_u32 v5, s36, v14
    s_sub_u32 s36, 7, s16
    s_cmp_eq_u32 s21, 0
    s_cselect_b32 s36, 0, s36
    s_cmp_eq_u32 s21, 1024
    s_cselect_b32 s36, 7, s36
    s_mul_i32 s36, s36, 2064
    s_add_u32 s36, s36, 139504
    v_sub_u32 v11, s36, v14
    s_lshl_b32 s36, s16, 2
    s_add_u32 s36, s36, 157088
    v_mov_b32 v6, s36
    s_mov_b32 s36, 0xffff0000
    s_mov_b32 s37, 0x3f803f80
    s_mov_b32 s38, 0x42800000
    s_waitcnt lgkmcnt(0)
    v_lshlrev_b32 v48, 16, v20
    v_and_b32 v49, s36, v20
    v_lshlrev_b32 v50, 16, v21
    v_and_b32 v51, s36, v21
    v_lshlrev_b32 v52, 16, v22
    v_and_b32 v53, s36, v22
    v_lshlrev_b32 v54, 16, v23
    v_and_b32 v55, s36, v23
    v_lshlrev_b32 v56, 16, v24
    v_and_b32 v57, s36, v24
    v_lshlrev_b32 v58, 16, v25
    v_and_b32 v59, s36, v25
    v_lshlrev_b32 v60, 16, v26
    v_and_b32 v61, s36, v26
    v_lshlrev_b32 v62, 16, v27
    v_and_b32 v63, s36, v27
    v_mov_b32 v44, 0
    v_dot2c_f32_bf16 v44, s37, v28
    v_dot2c_f32_bf16 v44, s37, v29
    v_dot2c_f32_bf16 v44, s37, v30
    v_dot2c_f32_bf16 v44, s37, v31
    v_dot2c_f32_bf16 v44, s37, v32
    v_dot2c_f32_bf16 v44, s37, v33
    v_dot2c_f32_bf16 v44, s37, v34
    v_dot2c_f32_bf16 v44, s37, v35
    s_nop 2
    v_add_f32_dpp v44, v44, v44 quad_perm:[1,0,3,2] row_mask:0xf bank_mask:0xf
    s_nop 1
    v_add_f32_dpp v44, v44, v44 quad_perm:[2,3,0,1] row_mask:0xf bank_mask:0xf
    s_nop 1
    v_add_f32_dpp v44, v44, v44 row_half_mirror row_mask:0xf bank_mask:0xf
    s_nop 1
    v_add_f32_dpp v44, v44, v44 row_mirror row_mask:0xf bank_mask:0xf
    s_nop 1
    v_add_f32_dpp v44, v44, v44 row_bcast:15 row_mask:0xa bank_mask:0xf
    s_nop 1
    v_add_f32_dpp v44, v44, v44 row_bcast:31 row_mask:0xc bank_mask:0xf
    s_nop 0
    v_readlane_b32 s39, v44, 63
    s_and_b32 s13, s18, 1
    s_mul_i32 s40, s13, 0x80008000
    s_branch fk_chkr1
    s_nop 1
fk_pollr1:
    buffer_load_dword v47, v12, s[24:27], s23 offen sc1
fk_chkr1:
    s_add_u32 s42, s42, 1
    s_waitcnt vmcnt(0)
    v_cmp_eq_u32 vcc, -1, v47
    s_cbranch_vccz fk_gotr1
    s_cmp_le_u32 s42, 0x40000
    s_cbranch_scc1 fk_pollr1
    s_nop 1
fk_gotr1:
    v_xor_b32 v47, s40, v47
    s_mov_b32 s42, 0
    s_nop 3
fk_polly:
    buffer_load_dwordx4 v[36:39], v4, s[24:27], s17 offen sc1
    s_add_u32 s42, s42, 1
    s_waitcnt vmcnt(0)
    v_max3_u32 v46, v36, v37, v38
    v_max_u32 v46, v46, v39
    v_cmp_eq_u32 vcc, -1, v46
    s_cbranch_vccz fk_goty
    s_cmp_le_u32 s42, 0x40000
    s_cbranch_scc1 fk_polly
    s_nop 1
fk_goty:
    v_pk_add_f16 v36, v36, v47
    v_pk_add_f16 v37, v37, v47
    v_pk_add_f16 v38, v38, v47
    v_pk_add_f16 v39, v39, v47
    ds_write_b16 v9, v36 offset:0
    ds_write_b16_d16_hi v10, v36 offset:0
    ds_write_b16 v9, v37 offset:2064
    ds_write_b16_d16_hi v10, v37 offset:2064
    ds_write_b16 v9, v38 offset:4128
    ds_write_b16_d16_hi v10, v38 offset:4128
    ds_write_b16 v9, v39 offset:6192
    ds_write_b16_d16_hi v10, v39 offset:6192
    s_mul_i32 s15, s16, 4
    s_add_u32 s15, s15, 0
    s_lshl_b32 s12, s15, 10
    s_add_u32 s12, s12, 32768
    s_mul_i32 s13, s15, 57344
    s_add_u32 s13, s13, s99
    v_xor_b32 v209, 64, v208
    v_mov_b32 v2, 0
    v_mov_b32 v3, 0
    v_mov_b32 v4, 0
    v_mov_b32 v7, 0
    v_mov_b32 v12, 157120
    s_waitcnt lgkmcnt(0)
    s_barrier
    ds_read_b128 v[36:39], v5
    ds_read_b128 v[40:43], v11
    ds_read_b32 v44, v6
    s_cmp_gt_u32 s3, 223
    s_cbranch_scc1 fk_wsc
    s_mov_b32 m0, s12
    s_nop 0
    buffer_load_dwordx4 v208, s[48:51], s13 offen lds
    s_add_u32 s12, s12, 1024
    s_add_u32 s13, s13, 57344
    s_mov_b32 m0, s12
    s_nop 0
    buffer_load_dwordx4 v209, s[48:51], s13 offen lds
    s_add_u32 s12, s12, 1024
    s_add_u32 s13, s13, 57344
    s_mov_b32 m0, s12
    s_nop 0
    buffer_load_dwordx4 v208, s[48:51], s13 offen lds
    s_add_u32 s12, s12, 1024
    s_add_u32 s13, s13, 57344
    s_mov_b32 m0, s12
    s_nop 0
    buffer_load_dwordx4 v209, s[48:51], s13 offen lds
fk_wsc:
    s_waitcnt lgkmcnt(2)
    v_fma_mix_f32 v48, v36, s38, v48 op_sel:[0,0,0] op_sel_hi:[1,0,0]
    v_fma_mix_f32 v49, v36, s38, v49 op_sel:[1,0,0] op_sel_hi:[1,0,0]
    v_fma_mix_f32 v50, v37, s38, v50 op_sel:[0,0,0] op_sel_hi:[1,0,0]
    v_fma_mix_f32 v51, v37, s38, v51 op_sel:[1,0,0] op_sel_hi:[1,0,0]
    v_fma_mix_f32 v52, v38, s38, v52 op_sel:[0,0,0] op_sel_hi:[1,0,0]
    v_fma_mix_f32 v53, v38, s38, v53 op_sel:[1,0,0] op_sel_hi:[1,0,0]
    v_fma_mix_f32 v54, v39, s38, v54 op_sel:[0,0,0] op_sel_hi:[1,0,0]
    v_fma_mix_f32 v55, v39, s38, v55 op_sel:[1,0,0] op_sel_hi:[1,0,0]
    s_waitcnt lgkmcnt(0)
    v_readfirstlane_b32 s13, v44
    v_mov_b32_dpp v8, v40 wave_shr:1 row_mask:0xf bank_mask:0xf
    v_fma_mix_f32 v57, v43, s38, v57 op_sel:[1,0,0] op_sel_hi:[1,0,0]
    v_fma_mix_f32 v58, v43, s38, v58 op_sel:[0,0,0] op_sel_hi:[1,0,0]
    v_fma_mix_f32 v59, v42, s38, v59 op_sel:[1,0,0] op_sel_hi:[1,0,0]
    v_fma_mix_f32 v60, v42, s38, v60 op_sel:[0,0,0] op_sel_hi:[1,0,0]
    v_writelane_b32 v8, s13, 0
    v_fma_mix_f32 v61, v41, s38, v61 op_sel:[1,0,0] op_sel_hi:[1,0,0]
    v_fma_mix_f32 v62, v41, s38, v62 op_sel:[0,0,0] op_sel_hi:[1,0,0]
    v_fma_mix_f32 v63, v40, s38, v63 op_sel:[1,0,0] op_sel_hi:[1,0,0]
    v_fma_mix_f32 v56, v8, s38, v56 op_sel:[0,0,0] op_sel_hi:[1,0,0]
    v_cvt_pk_bf16_f32 v80, v48, v49
    v_cvt_pk_bf16_f32 v81, v50, v51
    v_cvt_pk_bf16_f32 v82, v52, v53
    v_cvt_pk_bf16_f32 v83, v54, v55
    v_cvt_pk_bf16_f32 v85, v58, v59
    v_cvt_pk_bf16_f32 v86, v60, v61
    v_cvt_pk_bf16_f32 v87, v62, v63
    v_cvt_pk_bf16_f32 v84, v56, v57
    v_dot2c_f32_bf16 v2, s37, v80
    v_dot2c_f32_bf16 v3, v80, v80
    v_dot2c_f32_bf16 v4, v80, v28
    v_dot2c_f32_bf16 v2, s37, v81
    v_dot2c_f32_bf16 v3, v81, v81
    v_dot2c_f32_bf16 v4, v81, v29
    v_dot2c_f32_bf16 v2, s37, v82
    v_dot2c_f32_bf16 v3, v82, v82
    v_dot2c_f32_bf16 v4, v82, v30
    v_dot2c_f32_bf16 v2, s37, v83
    v_dot2c_f32_bf16 v3, v83, v83
    v_dot2c_f32_bf16 v4, v83, v31
    v_dot2c_f32_bf16 v2, s37, v85
    v_dot2c_f32_bf16 v3, v85, v85
    v_dot2c_f32_bf16 v4, v85, v33
    v_dot2c_f32_bf16 v2, s37, v86
    v_dot2c_f32_bf16 v3, v86, v86
    v_dot2c_f32_bf16 v4, v86, v34
    v_dot2c_f32_bf16 v2, s37, v87
    v_dot2c_f32_bf16 v3, v87, v87
    v_dot2c_f32_bf16 v4, v87, v35
    v_dot2c_f32_bf16 v2, s37, v84
    v_dot2c_f32_bf16 v3, v84, v84
    v_dot2c_f32_bf16 v4, v84, v32
    s_nop 2
    v_permlane32_swap_b32 v2, v4
    v_permlane32_swap_b32 v3, v7
    v_add_f32 v2, v2, v4
    v_add_f32 v3, v3, v7
    s_nop 1
    v_permlane16_swap_b32 v2, v3
    v_add_f32 v2, v2, v3
    s_nop 1
    v_add_f32_dpp v2, v2, v2 quad_perm:[1,0,3,2] row_mask:0xf bank_mask:0xf
    s_nop 1
    v_add_f32_dpp v2, v2, v2 quad_perm:[2,3,0,1] row_mask:0xf bank_mask:0xf
    s_nop 1
    v_add_f32_dpp v2, v2, v2 row_half_mirror row_mask:0xf bank_mask:0xf
    s_nop 1
    v_add_f32_dpp v2, v2, v2 row_mirror row_mask:0xf bank_mask:0xf
    s_nop 0
    v_readlane_b32 s13, v2, 32
    v_mov_b32_dpp v8, v2 row_bcast:15 row_mask:0xa bank_mask:0xf
    v_mul_f32 v9, 0x3a800000, v2
    v_mul_f32 v8, 0x3a800000, v8
    v_fma_f32 v9, -v8, v8, v9
    v_max_f32 v9, 0, v9
    v_cvt_pk_bf16_f32 v9, 0, v9
    v_cvt_pk_bf16_f32 v8, 0, v8
    v_add_f32 v9, 0x3727c5ac, v9
    v_cvt_pk_bf16_f32 v9, 0, v9
    v_sqrt_f32 v9, v9
    s_nop 0
    v_cvt_pk_bf16_f32 v9, 0, v9
    v_rcp_f32 v9, v9
    v_mov_b32 v10, s13
    v_fma_f32 v10, -v8, s39, v10
    v_mul_f32 v10, v10, v9
    v_mul_f32 v8, v8, v9
    v_readlane_b32 s43, v10, 16
    v_readlane_b32 s4, v9, 16
    v_readlane_b32 s6, v8, 16
    s_ashr_i32 s13, s43, 31
    s_or_b32 s13, s13, 0x80000000
    s_xor_b32 s43, s43, s13
    s_and_b32 s43, s43, 0xfffff800
    s_or_b32 s43, s43, s19
    s_min_u32 s43, s43, -2
    v_mov_b32 v2, s43
    s_mov_b64 exec, 1
    ds_max_u32 v12, v2
    s_mov_b64 exec, -1
    v_mov_b32 v10, s6
    v_add_f32 v8, 1.0, v9
    v_lshlrev_b32 v4, 12, v15
    s_lshl_b32 s17, s3, 4
    s_add_u32 s17, s17, 0x9000
    v_readlane_b32 s14, v8, 16
    s_waitcnt lgkmcnt(0)
    s_barrier
    ds_read_b32 v3, v12
    v_lshlrev_b32 v48, 16, v80
    v_and_b32 v49, s36, v80
    v_lshlrev_b32 v50, 16, v81
    v_and_b32 v51, s36, v81
    v_lshlrev_b32 v52, 16, v82
    v_and_b32 v53, s36, v82
    v_lshlrev_b32 v54, 16, v83
    v_and_b32 v55, s36, v83
    v_lshlrev_b32 v56, 16, v84
    v_and_b32 v57, s36, v84
    v_lshlrev_b32 v58, 16, v85
    v_and_b32 v59, s36, v85
    v_lshlrev_b32 v60, 16, v86
    v_and_b32 v61, s36, v86
    v_lshlrev_b32 v62, 16, v87
    v_and_b32 v63, s36, v87
    s_waitcnt lgkmcnt(0)
    v_readfirstlane_b32 s13, v3
    s_nop 1
    s_cmp_lg_u32 s13, s43
    s_cbranch_scc1 fk_other
    s_mov_b64 exec, 0xff
    buffer_store_dword v2, v4, s[24:27], s17 offen sc1
    s_mov_b64 exec, -1
    v_pk_fma_f32 v[64:65], v[48:49], s[4:5], v[10:11] op_sel_hi:[1,0,0] neg_lo:[0,0,1] neg_hi:[0,0,1]
    v_pk_fma_f32 v[66:67], v[50:51], s[4:5], v[10:11] op_sel_hi:[1,0,0] neg_lo:[0,0,1] neg_hi:[0,0,1]
    v_pk_fma_f32 v[68:69], v[52:53], s[4:5], v[10:11] op_sel_hi:[1,0,0] neg_lo:[0,0,1] neg_hi:[0,0,1]
    v_pk_fma_f32 v[70:71], v[54:55], s[4:5], v[10:11] op_sel_hi:[1,0,0] neg_lo:[0,0,1] neg_hi:[0,0,1]
    v_pk_fma_f32 v[72:73], v[56:57], s[4:5], v[10:11] op_sel_hi:[1,0,0] neg_lo:[0,0,1] neg_hi:[0,0,1]
    v_pk_fma_f32 v[74:75], v[58:59], s[4:5], v[10:11] op_sel_hi:[1,0,0] neg_lo:[0,0,1] neg_hi:[0,0,1]
    v_pk_fma_f32 v[76:77], v[60:61], s[4:5], v[10:11] op_sel_hi:[1,0,0] neg_lo:[0,0,1] neg_hi:[0,0,1]
    v_pk_fma_f32 v[78:79], v[62:63], s[4:5], v[10:11] op_sel_hi:[1,0,0] neg_lo:[0,0,1] neg_hi:[0,0,1]
    v_cvt_pk_bf16_f32 v96, v64, v65
    v_cvt_pk_bf16_f32 v97, v66, v67
    v_cvt_pk_bf16_f32 v98, v68, v69
    v_cvt_pk_bf16_f32 v99, v70, v71
    v_cvt_pk_bf16_f32 v100, v72, v73
    v_cvt_pk_bf16_f32 v101, v74, v75
    v_cvt_pk_bf16_f32 v102, v76, v77
    v_cvt_pk_bf16_f32 v103, v78, v79
    v_min_u32 v96, -2, v96
    v_min_u32 v97, -2, v97
    v_min_u32 v98, -2, v98
    v_min_u32 v99, -2, v99
    v_min_u32 v100, -2, v100
    v_min_u32 v101, -2, v101
    v_min_u32 v102, -2, v102
    v_min_u32 v103, -2, v103
    s_mul_i32 s13, s3, 9344
    s_add_u32 s13, s13, 0x470000
    buffer_store_dwordx4 v[96:99], v14, s[24:27], s13 offen sc1
    buffer_store_dwordx4 v[100:103], v14, s[24:27], s13 offen offset:1024 sc1
    v_min_u32 v80, -2, v80
    v_min_u32 v81, -2, v81
    v_min_u32 v82, -2, v82
    v_min_u32 v83, -2, v83
    v_min_u32 v84, -2, v84
    v_min_u32 v85, -2, v85
    v_min_u32 v86, -2, v86
    v_min_u32 v87, -2, v87
    buffer_store_dwordx4 v[80:83], v14, s[24:27], s13 offen offset:2048 sc1
    buffer_store_dwordx4 v[84:87], v14, s[24:27], s13 offen offset:3072 sc1
    v_pk_fma_f32 v[64:65], v[48:49], s[14:15], v[10:11] op_sel_hi:[1,0,0] neg_lo:[0,0,1] neg_hi:[0,0,1]
    v_pk_fma_f32 v[66:67], v[50:51], s[14:15], v[10:11] op_sel_hi:[1,0,0] neg_lo:[0,0,1] neg_hi:[0,0,1]
    v_pk_fma_f32 v[68:69], v[52:53], s[14:15], v[10:11] op_sel_hi:[1,0,0] neg_lo:[0,0,1] neg_hi:[0,0,1]
    v_pk_fma_f32 v[70:71], v[54:55], s[14:15], v[10:11] op_sel_hi:[1,0,0] neg_lo:[0,0,1] neg_hi:[0,0,1]
    v_pk_fma_f32 v[72:73], v[56:57], s[14:15], v[10:11] op_sel_hi:[1,0,0] neg_lo:[0,0,1] neg_hi:[0,0,1]
    v_pk_fma_f32 v[74:75], v[58:59], s[14:15], v[10:11] op_sel_hi:[1,0,0] neg_lo:[0,0,1] neg_hi:[0,0,1]
    v_pk_fma_f32 v[76:77], v[60:61], s[14:15], v[10:11] op_sel_hi:[1,0,0] neg_lo:[0,0,1] neg_hi:[0,0,1]
    v_pk_fma_f32 v[78:79], v[62:63], s[14:15], v[10:11] op_sel_hi:[1,0,0] neg_lo:[0,0,1] neg_hi:[0,0,1]
    v_cvt_pk_bf16_f32 v112, v64, v65
    v_cvt_pk_bf16_f32 v113, v66, v67
    v_cvt_pk_bf16_f32 v114, v68, v69
    v_cvt_pk_bf16_f32 v115, v70, v71
    v_cvt_pk_bf16_f32 v116, v72, v73
    v_cvt_pk_bf16_f32 v117, v74, v75
    v_cvt_pk_bf16_f32 v118, v76, v77
    v_cvt_pk_bf16_f32 v119, v78, v79
    v_lshrrev_b32 v1, 4, v15
    v_bfe_u32 v2, v15, 2, 2
    v_lshl_add_u32 v8, v1, 3, v2
    v_lshlrev_b32 v8, 7, v8
    v_and_b32 v3, 2, v2
    v_xor_b32 v9, s16, v3
    v_and_b32 v3, 1, v1
    v_lshlrev_b32 v4, 2, v3
    v_xor_b32 v9, v4, v9
    v_lshl_add_u32 v8, v9, 4, v8
    v_and_b32 v9, 1, v15
    v_lshl_add_u32 v8, v9, 3, v8
    v_bfe_u32 v9, v15, 1, 1
    v_lshl_add_u32 v8, v9, 15, v8
    v_lshrrev_b32 v7, 1, v1
    v_lshl_add_u32 v7, v7, 3, v2
    v_lshlrev_b32 v7, 9, v7
    v_lshl_add_u32 v7, v3, 5, v7
    v_and_b32 v3, 3, v15
    v_lshl_add_u32 v7, v3, 3, v7
    s_lshl_b32 s15, s16, 6
    s_add_u32 s15, s15, 65536
    v_add_u32 v7, s15, v7
    v_lshlrev_b32 v9, 4, v1
    v_add_u32 v9, 157312, v9
    s_and_b32 s13, s2, 7
    s_lshl_b32 s13, s13, 12
    s_add_u32 s13, s13, 0x9000
    s_mov_b32 s42, 0
    s_waitcnt vmcnt(4)
    v_mov_b32 v1, 157872
    v_mov_b32 v2, 1
    s_mov_b64 exec, 1
    ds_add_u32 v1, v2
    s_mov_b64 exec, -1
    s_nop 1
fk_pollk:
    buffer_load_dword v180, v14, s[24:27], s13 offen offset:0 sc1
    buffer_load_dword v181, v14, s[24:27], s13 offen offset:1024 sc1
    buffer_load_dword v182, v14, s[24:27], s13 offen offset:2048 sc1
    buffer_load_dword v183, v14, s[24:27], s13 offen offset:3072 sc1
    s_add_u32 s42, s42, 1
    s_waitcnt vmcnt(0)
    v_max3_u32 v3, v180, v181, v182
    v_max_u32 v3, v3, v183
    v_cmp_eq_u32 vcc, -1, v3
    s_cbranch_vccz fk_gotk
    s_cmp_le_u32 s42, 0x40000
    s_cbranch_scc1 fk_pollk
    s_nop 1
fk_gotk:
    v_max_u32_dpp v3, v3, v3 quad_perm:[1,0,3,2] row_mask:0xf bank_mask:0xf
    s_nop 1
    v_max_u32_dpp v3, v3, v3 quad_perm:[2,3,0,1] row_mask:0xf bank_mask:0xf
    s_nop 1
    v_max_u32_dpp v3, v3, v3 row_half_mirror row_mask:0xf bank_mask:0xf
    s_nop 1
    v_max_u32_dpp v3, v3, v3 row_mirror row_mask:0xf bank_mask:0xf
    s_nop 1
    v_max_u32_dpp v3, v3, v3 row_bcast:15 row_mask:0xa bank_mask:0xf
    s_nop 1
    v_max_u32_dpp v3, v3, v3 row_bcast:31 row_mask:0xc bank_mask:0xf
    s_nop 0
    v_readlane_b32 s40, v3, 63
    v_mov_b32 v4, 157136
    s_nop 0
    s_bfe_u32 s13, s40, 0x80003
    s_mul_i32 s13, s13, 9344
    s_and_b32 s14, s3, 3
    s_lshl_b32 s14, s14, 9
    s_add_u32 s13, s13, s14
    s_add_u32 s13, s13, 0x470000
    v_lshlrev_b32 v5, 3, v15
    v_mov_b32 v3, s40
    s_cmp_gt_u32 s3, 223
    s_cbranch_scc1 fk_norow
    s_mov_b32 s42, 0
    buffer_load_dwordx2 v[180:181], v5, s[24:27], s13 offen sc1
    s_nop 0
fk_landa:
    ds_read_b32 v2, v1
    s_waitcnt lgkmcnt(0)
    v_readfirstlane_b32 s15, v2
    s_nop 1
    s_cmp_lt_u32 s15, 8
    s_cbranch_scc1 fk_landa
    ds_read_b64_tr_b16 v[128:129], v8 offset:0
    ds_read_b64_tr_b16 v[130:131], v8 offset:512
    ds_read_b64_tr_b16 v[132:133], v8 offset:4096
    ds_read_b64_tr_b16 v[134:135], v8 offset:4608
    ds_read_b64_tr_b16 v[136:137], v8 offset:8192
    ds_read_b64_tr_b16 v[138:139], v8 offset:8704
    ds_read_b64_tr_b16 v[140:141], v8 offset:12288
    ds_read_b64_tr_b16 v[142:143], v8 offset:12800
    ds_read_b64_tr_b16 v[144:145], v8 offset:16384
    ds_read_b64_tr_b16 v[146:147], v8 offset:16896
    ds_read_b64_tr_b16 v[148:149], v8 offset:20480
    ds_read_b64_tr_b16 v[150:151], v8 offset:20992
    s_waitcnt lgkmcnt(4)
    ds_read_b64_tr_b16 v[152:153], v8 offset:24576
    ds_read_b64_tr_b16 v[154:155], v8 offset:25088
    ds_read_b64_tr_b16 v[156:157], v8 offset:28672
    ds_read_b64_tr_b16 v[158:159], v8 offset:29184
    s_branch fk_chkr
    s_nop 0
fk_pollr:
    buffer_load_dwordx2 v[180:181], v5, s[24:27], s13 offen sc1
fk_chkr:
    s_add_u32 s42, s42, 1
    s_waitcnt vmcnt(0)
    v_max_u32 v6, v180, v181
    v_cmp_eq_u32 vcc, -1, v6
    s_cbranch_vccz fk_gotr
    s_cmp_le_u32 s42, 0x40000
    s_cbranch_scc1 fk_pollr
    s_nop 1
fk_gotr:
    v_add_u32 v5, 157312, v5
    ds_write_b64 v5, v[180:181]
    s_nop 3
fk_norow:
    ds_write_b32 v4, v3
    s_waitcnt lgkmcnt(0)
    s_barrier
    s_cmp_eq_u32 s40, s43
    s_cselect_b32 s22, 0x400000, s22
    s_branch fk_ffn
    s_nop 0
fk_other:
    v_pk_fma_f32 v[64:65], v[48:49], s[14:15], v[10:11] op_sel_hi:[1,0,0] neg_lo:[0,0,1] neg_hi:[0,0,1]
    v_pk_fma_f32 v[66:67], v[50:51], s[14:15], v[10:11] op_sel_hi:[1,0,0] neg_lo:[0,0,1] neg_hi:[0,0,1]
    v_pk_fma_f32 v[68:69], v[52:53], s[14:15], v[10:11] op_sel_hi:[1,0,0] neg_lo:[0,0,1] neg_hi:[0,0,1]
    v_pk_fma_f32 v[70:71], v[54:55], s[14:15], v[10:11] op_sel_hi:[1,0,0] neg_lo:[0,0,1] neg_hi:[0,0,1]
    v_pk_fma_f32 v[72:73], v[56:57], s[14:15], v[10:11] op_sel_hi:[1,0,0] neg_lo:[0,0,1] neg_hi:[0,0,1]
    v_pk_fma_f32 v[74:75], v[58:59], s[14:15], v[10:11] op_sel_hi:[1,0,0] neg_lo:[0,0,1] neg_hi:[0,0,1]
    v_pk_fma_f32 v[76:77], v[60:61], s[14:15], v[10:11] op_sel_hi:[1,0,0] neg_lo:[0,0,1] neg_hi:[0,0,1]
    v_pk_fma_f32 v[78:79], v[62:63], s[14:15], v[10:11] op_sel_hi:[1,0,0] neg_lo:[0,0,1] neg_hi:[0,0,1]
    v_cvt_pk_bf16_f32 v112, v64, v65
    v_cvt_pk_bf16_f32 v113, v66, v67
    v_cvt_pk_bf16_f32 v114, v68, v69
    v_cvt_pk_bf16_f32 v115, v70, v71
    v_cvt_pk_bf16_f32 v116, v72, v73
    v_cvt_pk_bf16_f32 v117, v74, v75
    v_cvt_pk_bf16_f32 v118, v76, v77
    v_cvt_pk_bf16_f32 v119, v78, v79
    s_and_b32 s13, s13, 7
    s_cmp_gt_u32 s16, s13
    s_cselect_b32 s13, 1, 0
    s_sub_u32 s17, s16, s13
    s_waitcnt vmcnt(0)
    v_lshrrev_b32 v1, 4, v15
    v_bfe_u32 v2, v15, 2, 2
    v_lshl_add_u32 v8, v1, 3, v2
    v_lshlrev_b32 v8, 7, v8
    v_and_b32 v3, 2, v2
    v_xor_b32 v9, s16, v3
    v_and_b32 v3, 1, v1
    v_lshlrev_b32 v4, 2, v3
    v_xor_b32 v9, v4, v9
    v_lshl_add_u32 v8, v9, 4, v8
    v_and_b32 v9, 1, v15
    v_lshl_add_u32 v8, v9, 3, v8
    v_bfe_u32 v9, v15, 1, 1
    v_lshl_add_u32 v8, v9, 15, v8
    v_lshrrev_b32 v7, 1, v1
    v_lshl_add_u32 v7, v7, 3, v2
    v_lshlrev_b32 v7, 9, v7
    v_lshl_add_u32 v7, v3, 5, v7
    v_and_b32 v3, 3, v15
    v_lshl_add_u32 v7, v3, 3, v7
    s_lshl_b32 s15, s16, 6
    s_add_u32 s15, s15, 65536
    v_add_u32 v7, s15, v7
    v_lshlrev_b32 v9, 4, v1
    v_add_u32 v9, 157312, v9
    v_mov_b32 v1, 157872
    v_mov_b32 v2, 1
    s_mov_b64 exec, 1
    ds_add_u32 v1, v2
    s_mov_b64 exec, -1
    s_mul_i32 s15, s17, 4
    s_add_u32 s15, s15, 8
    s_lshl_b32 s12, s15, 10
    s_add_u32 s12, s12, 65536
    s_mul_i32 s13, s15, 4096
    s_add_u32 s13, s13, s101
    s_cmp_gt_u32 s3, 223
    s_cbranch_scc1 fk_wsd
    s_mov_b32 m0, s12
    s_cmp_gt_u32 s12, 97280
    s_cbranch_scc1 fk_wsd
    buffer_load_dwordx4 v210, s[52:55], s13 offen lds
    s_add_u32 s12, s12, 1024
    s_add_u32 s13, s13, 4096
    s_mov_b32 m0, s12
    s_cmp_gt_u32 s12, 97280
    s_cbranch_scc1 fk_wsd
    buffer_load_dwordx4 v210, s[52:55], s13 offen lds
    s_add_u32 s12, s12, 1024
    s_add_u32 s13, s13, 4096
    s_mov_b32 m0, s12
    s_cmp_gt_u32 s12, 97280
    s_cbranch_scc1 fk_wsd
    buffer_load_dwordx4 v210, s[52:55], s13 offen lds
    s_add_u32 s12, s12, 1024
    s_add_u32 s13, s13, 4096
    s_mov_b32 m0, s12
    s_cmp_gt_u32 s12, 97280
    s_cbranch_scc1 fk_wsd
    buffer_load_dwordx4 v210, s[52:55], s13 offen lds
fk_wsd:
fk_landb:
    ds_read_b32 v2, v1
    s_waitcnt lgkmcnt(0)
    v_readfirstlane_b32 s15, v2
    s_nop 1
    s_cmp_lt_u32 s15, 8
    s_cbranch_scc1 fk_landb
    ds_read_b64_tr_b16 v[128:129], v8 offset:0
    ds_read_b64_tr_b16 v[130:131], v8 offset:512
    ds_read_b64_tr_b16 v[132:133], v8 offset:4096
    ds_read_b64_tr_b16 v[134:135], v8 offset:4608
    ds_read_b64_tr_b16 v[136:137], v8 offset:8192
    ds_read_b64_tr_b16 v[138:139], v8 offset:8704
    ds_read_b64_tr_b16 v[140:141], v8 offset:12288
    ds_read_b64_tr_b16 v[142:143], v8 offset:12800
    ds_read_b64_tr_b16 v[144:145], v8 offset:16384
    ds_read_b64_tr_b16 v[146:147], v8 offset:16896
    ds_read_b64_tr_b16 v[148:149], v8 offset:20480
    ds_read_b64_tr_b16 v[150:151], v8 offset:20992
    s_waitcnt lgkmcnt(4)
    ds_read_b64_tr_b16 v[152:153], v8 offset:24576
    ds_read_b64_tr_b16 v[154:155], v8 offset:25088
    ds_read_b64_tr_b16 v[156:157], v8 offset:28672
    ds_read_b64_tr_b16 v[158:159], v8 offset:29184
    s_waitcnt vmcnt(0) lgkmcnt(0)
    s_barrier
    s_nop 0
fk_ffn:
    ds_read_b128 v[16:19], v9 offset:0
    ds_read_b128 v[20:23], v9 offset:64
    ds_read_b128 v[24:27], v9 offset:128
    ds_read_b128 v[28:31], v9 offset:192
    ds_read_b128 v[32:35], v9 offset:256
    ds_read_b128 v[36:39], v9 offset:320
    ds_read_b128 v[40:43], v9 offset:384
    ds_read_b128 v[44:47], v9 offset:448
    buffer_store_dwordx4 v[112:115], v14, s[28:31], s22 offen nt
    buffer_store_dwordx4 v[116:119], v14, s[28:31], s22 offen offset:1024 nt
    s_cmp_gt_u32 s3, 223
    s_cbranch_scc1 fk_fin
    v_mov_b32 v3, 157136
    ds_read_b32 v12, v3
    v_lshlrev_b32 v4, 3, v15
    s_mul_i32 s41, s3, 9344
    s_lshl_b32 s14, s16, 6
    s_add_u32 s13, s41, s14
    s_add_u32 s13, s13, 0x471000
    s_waitcnt lgkmcnt(8)
    v_mfma_f32_16x16x32_bf16 v[176:179], v[16:19], v[128:131], 0
    s_waitcnt lgkmcnt(7)
    v_mfma_f32_16x16x32_bf16 v[176:179], v[20:23], v[132:135], v[176:179]
    s_waitcnt lgkmcnt(6)
    v_mfma_f32_16x16x32_bf16 v[176:179], v[24:27], v[136:139], v[176:179]
    s_waitcnt lgkmcnt(5)
    v_mfma_f32_16x16x32_bf16 v[176:179], v[28:31], v[140:143], v[176:179]
    s_waitcnt lgkmcnt(4)
    v_mfma_f32_16x16x32_bf16 v[176:179], v[32:35], v[144:147], v[176:179]
    s_waitcnt lgkmcnt(3)
    v_mfma_f32_16x16x32_bf16 v[176:179], v[36:39], v[148:151], v[176:179]
    s_waitcnt lgkmcnt(2)
    v_mfma_f32_16x16x32_bf16 v[176:179], v[40:43], v[152:155], v[176:179]
    s_waitcnt lgkmcnt(1)
    v_mfma_f32_16x16x32_bf16 v[176:179], v[44:47], v[156:159], v[176:179]
    v_lshlrev_b32 v5, 3, v15
    v_lshlrev_b32 v6, 2, v15
    v_lshrrev_b32 v9, 5, v15
    v_lshlrev_b32 v9, 4, v9
    v_add_u32 v9, 157184, v9
    s_lshl_b32 s14, s16, 7
    s_add_u32 s41, s41, s14
    s_add_u32 s41, s41, 0x471400
    v_min_u32 v176, -2, v176
    s_nop 1
    v_mov_b32_dpp v177, v176 row_shl:8 row_mask:0xf bank_mask:0xf
    v_mov_b32_dpp v178, v176 row_shl:1 row_mask:0xf bank_mask:0xf
    v_mov_b32_dpp v179, v176 row_shl:9 row_mask:0xf bank_mask:0xf
    s_mov_b64 exec, 0x55
    buffer_store_dwordx4 v[176:179], v4, s[24:27], s13 offen sc1
    s_mov_b64 exec, -1
    v_mov_b32 v1, 157876
    v_mov_b32 v8, 1
    ds_read_b64_tr_b16 v[160:161], v7 offset:0
    ds_read_b64_tr_b16 v[162:163], v7 offset:2048
    ds_read_b64_tr_b16 v[164:165], v7 offset:8192
    ds_read_b64_tr_b16 v[166:167], v7 offset:10240
    ds_read_b64_tr_b16 v[168:169], v7 offset:16384
    ds_read_b64_tr_b16 v[170:171], v7 offset:18432
    ds_read_b64_tr_b16 v[172:173], v7 offset:24576
    ds_read_b64_tr_b16 v[174:175], v7 offset:26624
    s_cmp_eq_u32 s16, 7
    s_cbranch_scc1 fk_c1
    s_cmp_lg_u32 s16, 0
    s_cbranch_scc1 fk_wait1
    s_and_b32 s13, s3, -4
    s_mul_i32 s13, s13, 9344
    s_add_u32 s36, s13, 0x471000
    s_add_u32 s37, s36, 9344
    s_add_u32 s38, s36, 18688
    s_add_u32 s39, s36, 28032
    s_mov_b32 s42, 0
    v_lshrrev_b32 v10, 2, v5
    v_add_u32 v10, 157184, v10
    s_waitcnt vmcnt(0)
    s_nop 3
fk_poll1:
    buffer_load_dwordx2 v[184:185], v5, s[24:27], s36 offen sc1
    buffer_load_dwordx2 v[186:187], v5, s[24:27], s37 offen sc1
    buffer_load_dwordx2 v[188:189], v5, s[24:27], s38 offen sc1
    buffer_load_dwordx2 v[190:191], v5, s[24:27], s39 offen sc1
    s_add_u32 s42, s42, 1
    s_waitcnt vmcnt(0)
    v_max3_u32 v11, v184, v185, v186
    v_max3_u32 v11, v11, v187, v188
    v_max3_u32 v11, v11, v189, v190
    v_max_u32 v11, v11, v191
    v_cmp_eq_u32 vcc, -1, v11
    s_cbranch_vccz fk_got1
    s_cmp_le_u32 s42, 0x40000
    s_cbranch_scc1 fk_poll1
    s_nop 1
fk_got1:
    v_pk_add_f32 v[184:185], v[184:185], v[186:187]
    v_pk_add_f32 v[188:189], v[188:189], v[190:191]
    v_pk_add_f32 v[184:185], v[184:185], v[188:189]
    v_cvt_pk_bf16_f32 v184, 0, v184
    v_cvt_pk_bf16_f32 v185, 0, v185
    v_mul_f32 v186, 0xbfb8aa3b, v184
    v_exp_f32 v186, v186
    s_nop 0
    v_add_f32 v186, 1.0, v186
    v_rcp_f32 v186, v186
    s_nop 0
    v_mul_f32 v184, v184, v186
    v_cvt_pk_bf16_f32 v184, 0, v184
    v_mul_f32 v184, v184, v185
    v_cvt_pk_bf16_f32 v184, 0, v184
    ds_write_b16_d16_hi v10, v184
    s_branch fk_wait1
    s_nop 2
fk_c1:
    s_cmp_gt_u32 s3, 127
    s_cbranch_scc1 fk_wait1
    s_waitcnt lgkmcnt(0)
    v_readfirstlane_b32 s40, v12
    v_lshrrev_b32 v10, 4, v15
    v_and_b32 v11, 1, v15
    v_lshl_add_u32 v12, v11, 2, v10
    v_lshlrev_b32 v12, 1, v12
    v_and_b32 v11, 12, v12
    v_and_b32 v10, 1, v10
    s_bfe_u32 s13, s40, 0x80003
    s_mul_i32 s14, s13, 9344
    s_lshl_b32 s15, s3, 4
    s_add_u32 s14, s14, s15
    s_add_u32 s14, s14, 0x470000
    s_mov_b32 s42, 0
    s_nop 0
fk_pollh:
    buffer_load_dword v2, v11, s[24:27], s14 offen sc1
    buffer_load_dword v3, v11, s[24:27], s14 offen offset:2048 sc1
    s_add_u32 s42, s42, 1
    s_waitcnt vmcnt(0)
    v_max_u32 v4, v2, v3
    v_cmp_eq_u32 vcc, -1, v4
    s_cbranch_vccz fk_goth
    s_cmp_le_u32 s42, 0x40000
    s_cbranch_scc1 fk_pollh
    s_nop 1
fk_goth:
    v_cmp_eq_u32 vcc, 1, v10
    v_lshlrev_b32 v4, 16, v2
    v_and_b32 v2, s36, v2
    v_cndmask_b32 v2, v4, v2, vcc
    v_lshlrev_b32 v4, 16, v3
    v_and_b32 v3, s36, v3
    v_cndmask_b32 v3, v4, v3, vcc
    s_lshr_b32 s14, s13, 4
    s_add_u32 s14, s14, 1
    s_cmp_ge_u32 s13, 248
    s_cselect_b32 s14, 0, s14
    s_cmp_ge_u32 s13, 240
    s_cselect_b32 s15, 7, 15
    s_and_b32 s15, s15, s13
    s_lshl_b32 s15, s15, 7
    s_add_u32 s14, s14, s15
    s_and_b32 s13, s40, 7
    s_sub_u32 s15, 7, s13
    s_min_u32 s15, s15, s13
    s_lshl_b32 s15, s15, 5
    s_add_u32 s14, s14, s15
    s_sub_u32 s15, 2048, s14
    s_and_b32 s15, s15, 2047
    s_cmp_lt_u32 s13, 4
    s_cselect_b32 s14, s14, s15
    s_and_b32 s13, s40, 0x7ff
    s_cmp_eq_u32 s13, 1991
    s_cselect_b32 s14, 1024, s14
    s_lshl_b32 s21, s14, 11
    s_lshl_b32 s15, s3, 4
    s_add_u32 s21, s21, s15
    s_ashr_i32 s13, s40, 31
    s_not_b32 s13, s13
    s_or_b32 s13, s13, 0x80000000
    s_xor_b32 s13, s40, s13
    s_and_b32 s13, s13, 0xfffff800
    v_mov_b32 v11, s13
    v_cvt_pk_bf16_f32 v11, 0, v11
    v_mul_f32 v11, 0xbfb8aa3b, v11
    v_exp_f32 v11, v11
    s_nop 0
    v_add_f32 v11, 1.0, v11
    v_rcp_f32 v11, v11
    s_nop 0
    v_cvt_pk_bf16_f32 v11, 0, v11
    v_lshrrev_b32 v4, 1, v15
    v_mul_u32_u24 v4, 37376, v4
    v_and_b32 v5, 1, v15
    v_lshl_add_u32 v4, v5, 4, v4
    v_add_u32 v5, 1196032, v4
    v_cmp_gt_u32 vcc, 48, v15
    s_nop 1
    v_cndmask_b32 v5, -16, v5, vcc
    s_lshr_b32 s40, s3, 5
    s_mul_i32 s40, s40, 9344
    s_and_b32 s15, s3, 31
    s_lshl_b32 s15, s15, 5
    s_add_u32 s40, s40, s15
    s_add_u32 s40, s40, 0x471400
    s_nop 0
fk_wait1:
    s_waitcnt lgkmcnt(0)
    s_barrier
    ds_read_b128 v[16:19], v9 offset:0
    ds_read_b128 v[20:23], v9 offset:32
    ds_read_b128 v[24:27], v9 offset:64
    ds_read_b128 v[28:31], v9 offset:96
    s_waitcnt lgkmcnt(3)
    v_mfma_f32_32x32x16_bf16 v[192:207], v[16:19], v[160:163], 0
    s_waitcnt lgkmcnt(2)
    v_mfma_f32_32x32x16_bf16 v[192:207], v[20:23], v[164:167], v[192:207]
    s_waitcnt lgkmcnt(1)
    v_mfma_f32_32x32x16_bf16 v[192:207], v[24:27], v[168:171], v[192:207]
    s_waitcnt lgkmcnt(0)
    v_mfma_f32_32x32x16_bf16 v[192:207], v[28:31], v[172:175], v[192:207]
    s_nop 11
    v_min_u32 v192, -2, v192
    s_nop 1
    v_mov_b32_dpp v193, v192 row_shl:1 row_mask:0xf bank_mask:0xf
    v_mov_b32_dpp v194, v192 row_shl:2 row_mask:0xf bank_mask:0xf
    v_mov_b32_dpp v195, v192 row_shl:3 row_mask:0xf bank_mask:0xf
    s_mov_b32 exec_lo, 0x11111111
    s_mov_b32 exec_hi, 0
    buffer_store_dwordx4 v[192:195], v6, s[24:27], s41 offen sc1
    s_mov_b64 exec, -1
    s_cmp_lg_u32 s16, 7
    s_cbranch_scc1 fk_fin
    s_cmp_gt_u32 s3, 127
    s_cbranch_scc1 fk_fin
    s_mov_b32 s42, 0
    s_waitcnt vmcnt(0)
    s_nop 0
fk_poll2:
    buffer_load_dwordx4 v[16:19], v4, s[24:27], s40 offen sc1
    buffer_load_dwordx4 v[20:23], v5, s[24:27], s40 offen sc1
    s_add_u32 s42, s42, 1
    s_waitcnt vmcnt(0)
    v_max3_u32 v6, v16, v17, v18
    v_max3_u32 v6, v6, v19, v20
    v_max3_u32 v6, v6, v21, v22
    v_max_u32 v6, v6, v23
    v_cmp_eq_u32 vcc, -1, v6
    s_cbranch_vccz fk_got2
    s_cmp_le_u32 s42, 0x40000
    s_cbranch_scc1 fk_poll2
    s_nop 1
fk_got2:
    v_pk_add_f32 v[16:17], v[16:17], v[20:21]
    v_pk_add_f32 v[18:19], v[18:19], v[22:23]
    s_nop 1
    v_permlane32_swap_b32 v16, v18
    v_permlane32_swap_b32 v17, v19
    v_add_f32 v16, v16, v18
    v_add_f32 v17, v17, v19
    s_nop 1
    v_permlane16_swap_b32 v16, v17
    v_add_f32 v16, v16, v17
    s_nop 1
    v_add_f32_dpp v16, v16, v16 quad_perm:[2,3,0,1] row_mask:0xf bank_mask:0xf
    s_nop 1
    v_add_f32_dpp v16, v16, v16 row_ror:4 row_mask:0xf bank_mask:0xf
    s_nop 1
    v_add_f32_dpp v16, v16, v16 row_ror:8 row_mask:0xf bank_mask:0xf
    v_cvt_pk_bf16_f32 v16, 0, v16
    v_mul_f32 v16, v16, v11
    v_cvt_pk_bf16_f32 v16, 0, v16
    v_add_f32 v16, v16, v2
    v_cvt_pk_bf16_f32 v16, 0, v16
    v_add_f32 v16, v16, v3
    v_cvt_pk_bf16_f32 v16, 0, v16
    s_mov_b32 exec_lo, 0x00030003
    s_mov_b32 exec_hi, 0x00030003
    buffer_store_short_d16_hi v16, v12, s[28:31], s21 offen
    s_nop 1
fk_fin:
fk_end:
    s_endpgm
.section .rodata,"a"
.p2align 6
.amdhsa_kernel sequential_preLN__spectral_fnet__moe_arch_mod__prompt_kernel
  .amdhsa_next_free_vgpr 256
  .amdhsa_next_free_sgpr 102
  .amdhsa_accum_offset 256
  .amdhsa_group_segment_fixed_size 0
  .amdhsa_kernarg_size 104
  .amdhsa_user_sgpr_count 2
  .amdhsa_user_sgpr_kernarg_segment_ptr 1
  .amdhsa_system_sgpr_workgroup_id_x 1
.end_amdhsa_kernel
```
